```python
import torch

def _softmax(x, axis=-1):
    return torch.softmax(x, dim=axis)

def _gelu(x):
    return torch.nn.functional.gelu(x, approximate='tanh')

def _silu(x):
    return torch.nn.functional.silu(x)

def _sigmoid(x):
    return torch.sigmoid(x)

def _layernorm(x, axis=-1, eps=1e-05):
    m = x.mean(dim=axis, keepdim=True)
    v = x.var(dim=axis, keepdim=True, unbiased=False)
    return (x - m) / torch.sqrt(v + eps)

def _scatter_add(tgt, idx, src, axis=0):
    return tgt.clone().index_add_(axis, idx, src)

def _segment_sum(src, seg, n):
    out = torch.zeros((n,) + src.shape[1:], dtype=src.dtype)
    return out.index_add_(0, seg, src)

def _pad(x, pw):
    flat = tuple((v for pair in reversed(pw) for v in pair))
    return torch.nn.functional.pad(x, flat)
kernel_name = 'adaLN_cond__sliding_block_cached__moe_arch_mod__decode'

def setup_inputs():

    _w = lambda a: (lambda t: t.to(torch.bfloat16) if t.is_floating_point() else t)(torch.as_tensor(a))

    def _A_setup():
        B, Sq, D = (8, 1, 576)
        Hq, Hkv, Sk, Dh = (32, 16, 8192, 128)
        assert Hq % Hkv == 0, (Hq, Hkv)
        return {'x': _w((lambda *s: torch.randn(*s, dtype=torch.bfloat16) * 0.1)(B, Sq, D)), 'k_cache': _w((lambda *s: torch.randn(*s, dtype=torch.bfloat16) * 0.8)(B, Hkv, Sk, Dh)), 'v_cache': _w((lambda *s: torch.randn(*s, dtype=torch.bfloat16) * 0.8)(B, Hkv, Sk, Dh)), 'wq': _w((lambda *s: torch.randn(*s, dtype=torch.bfloat16) * 0.8)(D, Hq * Dh) * D ** (-0.5)), 'wo': _w((lambda *s: torch.randn(*s, dtype=torch.bfloat16) * 0.8)(Hq * Dh, D) * (Hq * Dh) ** (-0.5))}
    _A_in = _A_setup()

    def _B_setup():
        B, S, D, F, C = (8, 1, 576, 4608, 1)
        return {'x': _w((lambda *s: torch.randn(*s, dtype=torch.bfloat16) * 0.1)(B, S, D)), 'w_r': _w((lambda *s: torch.randn(*s, dtype=torch.bfloat16) * 0.2)(D)), 'w_gate': _w((lambda *s: torch.randn(*s, dtype=torch.bfloat16) * 0.1)(D, F)), 'w_up': _w((lambda *s: torch.randn(*s, dtype=torch.bfloat16) * 0.1)(D, F)), 'w_down': _w((lambda *s: torch.randn(*s, dtype=torch.bfloat16) * 0.1)(F, D))}
    _B_in = _B_setup()
    return {'A_x': _A_in['x'], 'A_k_cache': _A_in['k_cache'], 'A_v_cache': _A_in['v_cache'], 'A_wq': _A_in['wq'], 'A_wo': _A_in['wo'], 'B_x': _B_in['x'], 'B_w_r': _B_in['w_r'], 'B_w_gate': _B_in['w_gate'], 'B_w_up': _B_in['w_up'], 'B_w_down': _B_in['w_down'], 'c': _w((lambda *s: torch.randn(*s, dtype=torch.bfloat16) * 0.4)(8, 576) * 8.0), 'w_mod': _w((lambda *s: torch.randn(*s, dtype=torch.bfloat16) * 0.4)(576, 6 * 576) * 576 ** (-0.5) * 8.0)}

def reference(A_x, A_k_cache, A_v_cache, A_wq, A_wo, B_x, B_w_r, B_w_gate, B_w_up, B_w_down, c, w_mod):

    def _A_ref(x, k_cache, v_cache, wq, wo):
        B, Sq, D = x.shape
        Hq, Dh = (32, 128)
        Hkv, Sk = (k_cache.shape[1], k_cache.shape[2])
        W = min(4096, max(256, Sk // 4))
        rep = Hq // Hkv
        q = (lambda x, *d: x.permute(*d))((x @ wq).reshape(B, Sq, Hq, Dh), 0, 2, 1, 3)
        k = (lambda x, n, axis: torch.repeat_interleave(x, n, dim=axis))(k_cache[:, :, Sk - W:, :], rep, axis=1)
        v = (lambda x, n, axis: torch.repeat_interleave(x, n, dim=axis))(v_cache[:, :, Sk - W:, :], rep, axis=1)
        scores = torch.einsum('bhqd,bhkd->bhqk', q, k) * Dh ** (-0.5)
        p = _softmax(scores, axis=-1)
        o = torch.einsum('bhqk,bhkd->bhqd', p, v)
        return (lambda x, *d: x.permute(*d))(o, 0, 2, 1, 3).reshape(B, Sq, Hq * Dh) @ wo

    def _B_ref(x, w_r, w_gate, w_up, w_down):
        B, S, D = x.shape
        C = 1
        r = x @ w_r
        idx = torch.argsort(-r, axis=-1)[:, :C]
        idx_e = (lambda x, n, axis: torch.repeat_interleave(x, n, dim=axis))(idx.reshape(B, C, 1), D, axis=2)
        x_sel = (lambda x, i, axis: torch.take_along_dim(x, i, dim=axis))(x, idx_e, axis=1)
        g = _silu(x_sel @ w_gate)
        u = x_sel @ w_up
        y = g * u @ w_down
        r_sel = _sigmoid((lambda x, i, axis: torch.take_along_dim(x, i, dim=axis))(r, idx, axis=1))
        y = y * r_sel.reshape(B, C, 1)
        b_off = (torch.arange(B) * S).reshape(B, 1)
        flat_idx = (idx + b_off).reshape(B * C)
        zero = (x * 0.0).reshape(B * S, D)
        upd = _scatter_add(zero, flat_idx, y.reshape(B * C, D), axis=0)
        return x + upd.reshape(B, S, D)
    x = A_x
    mod = (_silu(c) @ w_mod).reshape(c.shape[0], 6, 1, -1)
    sa, ca, ga, sb, cb, gb = (mod[:, 0].clone(), mod[:, 1].clone(), mod[:, 2].clone(), mod[:, 3].clone(), mod[:, 4].clone(), mod[:, 5].clone())
    h = _layernorm(x, axis=-1) * (1 + ca) + sa
    x = x + ga * _A_ref(h, A_k_cache, A_v_cache, A_wq, A_wo)
    h = _layernorm(x, axis=-1) * (1 + cb) + sb
    x = x + gb * _B_ref(h, B_w_r, B_w_gate, B_w_up, B_w_down)
    return x
```

```asm
; @launch grid=(256,1,1) block=(512,1,1) lds=159104
.amdgcn_target "amdgcn-amd-amdhsa--gfx950"
.text
.globl adaLN_cond__sliding_block_cached__moe_arch_mod__decode_kernel
.p2align 8
.type adaLN_cond__sliding_block_cached__moe_arch_mod__decode_kernel,@function
adaLN_cond__sliding_block_cached__moe_arch_mod__decode_kernel:
    s_cmp_ge_u32 s2, 256
    s_cbranch_scc1 .Lend
    s_load_dwordx16 s[4:19], s[0:1], 0
    s_load_dwordx8 s[20:27], s[0:1], 64
    s_load_dwordx4 s[28:31], s[0:1], 96
    s_load_dwordx2 s[32:33], s[0:1], 112
    s_memrealtime s[70:71]
    v_lshrrev_b32 v1, 6, v0
    v_and_b32 v0, 63, v0
    v_readfirstlane_b32 s3, v1
    s_mov_b32 s35, 0x3ffff
    s_mov_b32 s98, 0xbfb8aa3b
    s_mov_b32 s94, 0x05040100
    s_mov_b32 s95, 0x07060302
    s_mov_b32 s96, 0xaaaaaaaa
    s_mov_b32 s97, 0xaaaaaaaa
    s_and_b32 s64, s2, 7
    s_lshr_b32 s65, s2, 3
    s_and_b32 s66, s65, 7
    s_lshr_b32 s67, s2, 7
    s_lshl1_add_u32 s67, s64, s67
    s_bfe_u32 s68, s2, 0x10006
    s_lshl4_add_u32 s69, s66, s67
    s_lshl_b32 s69, s69, 21
    s_lshl_b32 s56, s68, 16
    s_add_u32 s69, s69, s56
    s_lshl_b32 s56, s3, 10
    s_add_u32 s69, s69, s56
    s_add_u32 s69, s69, 0x180000
    v_bfe_u32 v1, v0, 2, 2
    v_lshrrev_b32 v2, 4, v0
    v_lshl_add_u32 v1, v1, 2, v2
    v_and_b32 v2, 3, v0
    v_lshl_add_u32 v1, v1, 2, v2
    v_lshlrev_b32 v1, 4, v1
    v_lshlrev_b32 v2, 4, v0
    v_lshlrev_b32 v3, 3, v0
    v_and_b32 v4, 31, v0
    v_lshlrev_b32 v4, 2, v4
    v_add_u32 v4, 1024, v4
    v_lshlrev_b32 v5, 1, v4
    s_waitcnt lgkmcnt(0)
    s_load_dword s34, s[32:33], 0
    s_mov_b32 s40, s6
    s_and_b32 s41, s7, 0xffff
    s_mov_b32 s42, 0x10000000
    s_mov_b32 s43, 0x00020000
    s_add_u32 s63, s69, 0
    buffer_load_dwordx4 v[32:35], v1, s[40:43], s63 offen nt
    s_add_u32 s63, s69, 8192
    buffer_load_dwordx4 v[36:39], v1, s[40:43], s63 offen nt
    s_add_u32 s63, s69, 16384
    buffer_load_dwordx4 v[64:67], v1, s[40:43], s63 offen nt
    s_add_u32 s63, s69, 24576
    buffer_load_dwordx4 v[68:71], v1, s[40:43], s63 offen nt
    s_mov_b32 s44, s8
    s_and_b32 s45, s9, 0xffff
    s_mov_b32 s46, 0x10000000
    s_mov_b32 s47, 0x00020000
    s_mov_b32 s36, s32
    s_and_b32 s37, s33, 0xffff
    s_mov_b32 s38, 0x40000000
    s_mov_b32 s39, 0x00020000
    s_lshl3_add_u32 s56, s3, s2
    s_cmp_lt_u32 s56, 8
    s_cbranch_scc0 .Let_no
    s_lshl2_add_u32 s56, s2, 0x400
    v_mov_b32 v7, s70
    s_mov_b64 exec, 1
    buffer_store_dword v7, v2, s[36:39], s56 offen sc1
    s_mov_b64 exec, -1
.Let_no:
    s_cmp_lt_u32 s3, 4
    s_cbranch_scc1 1
    s_setprio 1
.Lresume:
    s_cmp_lt_u32 s65, 9
    s_cbranch_scc1 .Le_a
    s_sub_u32 s56, 3, s64
    s_and_b32 s56, s56, 7
    s_lshl1_add_u32 s56, s56, 9
    s_sub_u32 s56, s65, s56
    s_cselect_b32 s57, 18, 0
    s_add_u32 s56, s56, s57
    s_sub_u32 s101, s56, 2
    s_cmp_ge_u32 s56, 5
    s_addc_u32 s101, s101, 0
    s_sub_u32 s99, s56, 5
    s_min_u32 s99, s99, 7
    s_cmp_lt_u32 s65, 27
    s_cbranch_scc1 .Lrole_bc
    s_mov_b32 s101, 3
    s_sub_u32 s99, s65, 27
    s_cmp_eq_u32 s65, 31
    s_cselect_b32 s56, 2, 9
.Lrole_bc:
    s_lshl3_add_u32 s99, s99, s64
    s_sub_u32 s56, s56, 2
    s_cmp_lt_u32 s56, 7
    s_cbranch_scc1 .Le_q
    s_cmp_lt_u32 s99, 18
    s_cbranch_scc1 .Le_mc
    s_cmp_lt_u32 s99, 54
    s_mov_b32 s14, 0xfdff7fdf
    s_cselect_b32 s14, 0x6b5ad6b5, s14
    s_mov_b32 s15, 0xff7fdff7
    s_cselect_b32 s15, 0x5ad6b5ad, s15
    s_add_u32 s30, s70, 0
    s_sub_u32 s56, s65, 9
    s_lshr_b32 s56, s56, 1
    s_add_u32 s56, s56, s64
    s_and_b32 s56, s56, 7
    s_cmp_eq_u32 s56, 3
    s_cselect_b32 s56, -60, 0
    s_cmp_lt_u32 s99, 54
    s_cselect_b32 s56, 0, s56
    s_add_u32 s30, s30, s56
    s_waitcnt vmcnt(3)
    s_bitcmp1_b64 s[14:15], 4
    s_cbranch_scc0 1
    s_waitcnt vmcnt(2)
    s_add_u32 s63, s69, 32768
    buffer_load_dwordx4 v[96:99], v1, s[40:43], s63 offen nt
    s_memrealtime s[8:9]
    s_waitcnt lgkmcnt(0)
    s_sub_u32 s8, s8, s30
    s_cmpk_ge_u32 s8, 290
    s_cbranch_scc1 .ap_1
    s_waitcnt vmcnt(4)
    s_cmpk_ge_u32 s8, 225
    s_cbranch_scc1 .ap_1
    s_waitcnt vmcnt(3)
    s_bitcmp1_b64 s[14:15], 5
    s_cbranch_scc0 1
    s_waitcnt vmcnt(2)
    s_cmpk_ge_u32 s8, 150
    s_cbranch_scc1 .ap_1
    s_waitcnt vmcnt(1)
.ap_1:
    s_add_u32 s63, s69, 40960
    buffer_load_dwordx4 v[100:103], v1, s[40:43], s63 offen nt
    s_memrealtime s[8:9]
    s_waitcnt lgkmcnt(0)
    s_sub_u32 s8, s8, s30
    s_cmpk_ge_u32 s8, 315
    s_cbranch_scc1 .ap_2
    s_waitcnt vmcnt(5)
    s_cmpk_ge_u32 s8, 250
    s_cbranch_scc1 .ap_2
    s_waitcnt vmcnt(3)
    s_bitcmp1_b64 s[14:15], 6
    s_cbranch_scc0 1
    s_waitcnt vmcnt(2)
    s_cmpk_ge_u32 s8, 175
    s_cbranch_scc1 .ap_2
    s_waitcnt vmcnt(1)
.ap_2:
    s_add_u32 s63, s69, 49152
    buffer_load_dwordx4 v[128:131], v1, s[40:43], s63 offen nt
    s_memrealtime s[8:9]
    s_waitcnt lgkmcnt(0)
    s_sub_u32 s8, s8, s30
    s_cmpk_ge_u32 s8, 340
    s_cbranch_scc1 .ap_3
    s_waitcnt vmcnt(5)
    s_cmpk_ge_u32 s8, 275
    s_cbranch_scc1 .ap_3
    s_waitcnt vmcnt(3)
    s_bitcmp1_b64 s[14:15], 7
    s_cbranch_scc0 1
    s_waitcnt vmcnt(2)
    s_cmpk_ge_u32 s8, 200
    s_cbranch_scc1 .ap_3
    s_waitcnt vmcnt(1)
.ap_3:
    s_add_u32 s63, s69, 57344
    buffer_load_dwordx4 v[132:135], v1, s[40:43], s63 offen nt
    s_memrealtime s[8:9]
    s_waitcnt lgkmcnt(0)
    s_sub_u32 s8, s8, s30
    s_cmpk_ge_u32 s8, 365
    s_cbranch_scc1 .ap_4
    s_waitcnt vmcnt(5)
    s_cmpk_ge_u32 s8, 300
    s_cbranch_scc1 .ap_4
    s_waitcnt vmcnt(3)
    s_bitcmp1_b64 s[14:15], 8
    s_cbranch_scc0 1
    s_waitcnt vmcnt(2)
    s_cmpk_ge_u32 s8, 225
    s_cbranch_scc1 .ap_4
    s_waitcnt vmcnt(1)
.ap_4:
    s_add_u32 s63, s69, 131072
    buffer_load_dwordx4 v[40:43], v1, s[40:43], s63 offen nt
    s_memrealtime s[8:9]
    s_waitcnt lgkmcnt(0)
    s_sub_u32 s8, s8, s30
    s_cmpk_ge_u32 s8, 390
    s_cbranch_scc1 .ap_5
    s_waitcnt vmcnt(5)
    s_cmpk_ge_u32 s8, 325
    s_cbranch_scc1 .ap_5
    s_waitcnt vmcnt(3)
    s_bitcmp1_b64 s[14:15], 9
    s_cbranch_scc0 1
    s_waitcnt vmcnt(2)
    s_cmpk_ge_u32 s8, 250
    s_cbranch_scc1 .ap_5
    s_waitcnt vmcnt(1)
.ap_5:
    s_add_u32 s63, s69, 139264
    buffer_load_dwordx4 v[44:47], v1, s[40:43], s63 offen nt
    s_waitcnt lgkmcnt(0)
    s_add_u32 s34, s34, 1
    s_getreg_b32 s1, hwreg(HW_REG_XCC_ID)
    s_lshl_b32 s1, s1, 24
    s_add_u32 s1, s1, s34
    s_lshr_b32 s0, s2, 3
    s_lshl3_add_u32 s63, s64, s3
    s_lshl_b32 s63, s63, 5
    s_add_u32 s0, s0, s63
    s_lshl2_add_u32 s0, s0, 0x1000
    v_mov_b32 v30, s1
    s_mov_b64 exec, 1
    buffer_store_dword v30, v2, s[36:39], s0 offen sc1
    s_mov_b64 exec, -1
    s_cmp_lt_u32 s99, 54
    s_cbranch_scc1 .Le_mr
    s_memrealtime s[8:9]
    s_waitcnt vmcnt(8)
    s_waitcnt lgkmcnt(0)
    s_sub_u32 s8, s8, s30
    s_cmpk_ge_u32 s8, 436
    s_cbranch_scc1 .ap_6
    s_waitcnt vmcnt(5)
    s_cmpk_ge_u32 s8, 371
    s_cbranch_scc1 .ap_6
    s_waitcnt vmcnt(3)
    s_bitcmp1_b64 s[14:15], 10
    s_cbranch_scc0 1
    s_waitcnt vmcnt(2)
    s_cmpk_ge_u32 s8, 296
    s_cbranch_scc1 .ap_6
    s_waitcnt vmcnt(1)
.ap_6:
    s_add_u32 s63, s69, 147456
    buffer_load_dwordx4 v[72:75], v1, s[40:43], s63 offen nt
    s_memrealtime s[8:9]
    s_waitcnt vmcnt(8)
    s_waitcnt lgkmcnt(0)
    s_sub_u32 s8, s8, s30
    s_cmpk_ge_u32 s8, 482
    s_cbranch_scc1 .ap_7
    s_waitcnt vmcnt(5)
    s_cmpk_ge_u32 s8, 417
    s_cbranch_scc1 .ap_7
    s_waitcnt vmcnt(3)
    s_bitcmp1_b64 s[14:15], 11
    s_cbranch_scc0 1
    s_waitcnt vmcnt(2)
    s_cmpk_ge_u32 s8, 342
    s_cbranch_scc1 .ap_7
    s_waitcnt vmcnt(1)
.ap_7:
    s_add_u32 s63, s69, 155648
    buffer_load_dwordx4 v[76:79], v1, s[40:43], s63 offen nt
    s_memrealtime s[8:9]
    s_waitcnt vmcnt(8)
    s_waitcnt lgkmcnt(0)
    s_sub_u32 s8, s8, s30
    s_cmpk_ge_u32 s8, 528
    s_cbranch_scc1 .ap_8
    s_waitcnt vmcnt(5)
    s_cmpk_ge_u32 s8, 463
    s_cbranch_scc1 .ap_8
    s_waitcnt vmcnt(3)
    s_bitcmp1_b64 s[14:15], 12
    s_cbranch_scc0 1
    s_waitcnt vmcnt(2)
    s_cmpk_ge_u32 s8, 388
    s_cbranch_scc1 .ap_8
    s_waitcnt vmcnt(1)
.ap_8:
    s_add_u32 s63, s69, 163840
    buffer_load_dwordx4 v[104:107], v1, s[40:43], s63 offen nt
    s_memrealtime s[8:9]
    s_waitcnt vmcnt(8)
    s_waitcnt lgkmcnt(0)
    s_sub_u32 s8, s8, s30
    s_cmpk_ge_u32 s8, 574
    s_cbranch_scc1 .ap_9
    s_waitcnt vmcnt(5)
    s_cmpk_ge_u32 s8, 509
    s_cbranch_scc1 .ap_9
    s_waitcnt vmcnt(3)
    s_bitcmp1_b64 s[14:15], 13
    s_cbranch_scc0 1
    s_waitcnt vmcnt(2)
    s_cmpk_ge_u32 s8, 434
    s_cbranch_scc1 .ap_9
    s_waitcnt vmcnt(1)
.ap_9:
    s_add_u32 s63, s69, 172032
    buffer_load_dwordx4 v[108:111], v1, s[40:43], s63 offen nt
    s_memrealtime s[8:9]
    s_waitcnt vmcnt(8)
    s_waitcnt lgkmcnt(0)
    s_sub_u32 s8, s8, s30
    s_cmpk_ge_u32 s8, 620
    s_cbranch_scc1 .ap_10
    s_waitcnt vmcnt(5)
    s_cmpk_ge_u32 s8, 555
    s_cbranch_scc1 .ap_10
    s_waitcnt vmcnt(3)
    s_bitcmp1_b64 s[14:15], 14
    s_cbranch_scc0 1
    s_waitcnt vmcnt(2)
    s_cmpk_ge_u32 s8, 480
    s_cbranch_scc1 .ap_10
    s_waitcnt vmcnt(1)
.ap_10:
    s_add_u32 s63, s69, 180224
    buffer_load_dwordx4 v[136:139], v1, s[40:43], s63 offen nt
    s_memrealtime s[8:9]
    s_waitcnt vmcnt(8)
    s_waitcnt lgkmcnt(0)
    s_sub_u32 s8, s8, s30
    s_cmpk_ge_u32 s8, 666
    s_cbranch_scc1 .ap_11
    s_waitcnt vmcnt(5)
    s_cmpk_ge_u32 s8, 601
    s_cbranch_scc1 .ap_11
    s_waitcnt vmcnt(3)
    s_bitcmp1_b64 s[14:15], 15
    s_cbranch_scc0 1
    s_waitcnt vmcnt(2)
    s_cmpk_ge_u32 s8, 526
    s_cbranch_scc1 .ap_11
    s_waitcnt vmcnt(1)
.ap_11:
    s_add_u32 s63, s69, 188416
    buffer_load_dwordx4 v[140:143], v1, s[40:43], s63 offen nt
    s_memrealtime s[8:9]
    s_waitcnt vmcnt(8)
    s_waitcnt lgkmcnt(0)
    s_sub_u32 s8, s8, s30
    s_cmpk_ge_u32 s8, 712
    s_cbranch_scc1 .ap_12
    s_waitcnt vmcnt(5)
    s_cmpk_ge_u32 s8, 647
    s_cbranch_scc1 .ap_12
    s_waitcnt vmcnt(3)
    s_bitcmp1_b64 s[14:15], 16
    s_cbranch_scc0 1
    s_waitcnt vmcnt(2)
    s_cmpk_ge_u32 s8, 572
    s_cbranch_scc1 .ap_12
    s_waitcnt vmcnt(1)
.ap_12:
    s_add_u32 s63, s69, 262144
    buffer_load_dwordx4 v[48:51], v1, s[40:43], s63 offen nt
    s_memrealtime s[8:9]
    s_waitcnt vmcnt(8)
    s_waitcnt lgkmcnt(0)
    s_sub_u32 s8, s8, s30
    s_cmpk_ge_u32 s8, 758
    s_cbranch_scc1 .ap_13
    s_waitcnt vmcnt(5)
    s_cmpk_ge_u32 s8, 693
    s_cbranch_scc1 .ap_13
    s_waitcnt vmcnt(3)
    s_bitcmp1_b64 s[14:15], 17
    s_cbranch_scc0 1
    s_waitcnt vmcnt(2)
    s_cmpk_ge_u32 s8, 618
    s_cbranch_scc1 .ap_13
    s_waitcnt vmcnt(1)
.ap_13:
    s_add_u32 s63, s69, 270336
    buffer_load_dwordx4 v[52:55], v1, s[40:43], s63 offen nt
    s_memrealtime s[8:9]
    s_waitcnt vmcnt(8)
    s_waitcnt lgkmcnt(0)
    s_sub_u32 s8, s8, s30
    s_cmpk_ge_u32 s8, 804
    s_cbranch_scc1 .ap_14
    s_waitcnt vmcnt(5)
    s_cmpk_ge_u32 s8, 739
    s_cbranch_scc1 .ap_14
    s_waitcnt vmcnt(3)
    s_bitcmp1_b64 s[14:15], 18
    s_cbranch_scc0 1
    s_waitcnt vmcnt(2)
    s_cmpk_ge_u32 s8, 664
    s_cbranch_scc1 .ap_14
    s_waitcnt vmcnt(1)
.ap_14:
    s_add_u32 s63, s69, 278528
    buffer_load_dwordx4 v[80:83], v1, s[40:43], s63 offen nt
    v_and_b32 v157, 7, v0
    v_lshlrev_b32 v157, 2, v157
    s_mov_b32 s63, 0x400
    buffer_load_dword v156, v157, s[36:39], s63 offen
    s_memrealtime s[8:9]
    s_waitcnt vmcnt(9)
    s_waitcnt lgkmcnt(0)
    s_sub_u32 s8, s8, s30
    s_cmpk_ge_u32 s8, 850
    s_cbranch_scc1 .ap_15
    s_waitcnt vmcnt(6)
    s_cmpk_ge_u32 s8, 785
    s_cbranch_scc1 .ap_15
    s_waitcnt vmcnt(4)
    s_bitcmp1_b64 s[14:15], 19
    s_cbranch_scc0 1
    s_waitcnt vmcnt(3)
    s_cmpk_ge_u32 s8, 710
    s_cbranch_scc1 .ap_15
    s_waitcnt vmcnt(2)
.ap_15:
    s_add_u32 s63, s69, 286720
    buffer_load_dwordx4 v[84:87], v1, s[40:43], s63 offen nt
    s_memrealtime s[8:9]
    s_waitcnt vmcnt(9)
    s_waitcnt lgkmcnt(0)
    s_sub_u32 s8, s8, s30
    s_cmpk_ge_u32 s8, 895
    s_cbranch_scc1 .ap_16
    s_waitcnt vmcnt(6)
    s_cmpk_ge_u32 s8, 830
    s_cbranch_scc1 .ap_16
    s_waitcnt vmcnt(4)
    s_bitcmp1_b64 s[14:15], 20
    s_cbranch_scc0 1
    s_waitcnt vmcnt(3)
    s_cmpk_ge_u32 s8, 755
    s_cbranch_scc1 .ap_16
    s_waitcnt vmcnt(2)
.ap_16:
    s_add_u32 s63, s69, 294912
    buffer_load_dwordx4 v[112:115], v1, s[40:43], s63 offen nt
    s_memrealtime s[8:9]
    s_waitcnt vmcnt(9)
    s_waitcnt lgkmcnt(0)
    s_sub_u32 s8, s8, s30
    s_cmpk_ge_u32 s8, 940
    s_cbranch_scc1 .ap_17
    s_waitcnt vmcnt(6)
    s_cmpk_ge_u32 s8, 875
    s_cbranch_scc1 .ap_17
    s_waitcnt vmcnt(4)
    s_bitcmp1_b64 s[14:15], 21
    s_cbranch_scc0 1
    s_waitcnt vmcnt(3)
    s_cmpk_ge_u32 s8, 800
    s_cbranch_scc1 .ap_17
    s_waitcnt vmcnt(1)
.ap_17:
    s_add_u32 s63, s69, 303104
    buffer_load_dwordx4 v[116:119], v1, s[40:43], s63 offen nt
    s_memrealtime s[8:9]
    s_waitcnt vmcnt(9)
    s_waitcnt lgkmcnt(0)
    s_sub_u32 s8, s8, s30
    s_cmpk_ge_u32 s8, 985
    s_cbranch_scc1 .ap_18
    s_waitcnt vmcnt(6)
    s_cmpk_ge_u32 s8, 920
    s_cbranch_scc1 .ap_18
    s_waitcnt vmcnt(4)
    s_bitcmp1_b64 s[14:15], 22
    s_cbranch_scc0 1
    s_waitcnt vmcnt(2)
    s_cmpk_ge_u32 s8, 845
    s_cbranch_scc1 .ap_18
    s_waitcnt vmcnt(1)
.ap_18:
    s_add_u32 s63, s69, 311296
    buffer_load_dwordx4 v[144:147], v1, s[40:43], s63 offen nt
    s_waitcnt vmcnt(4)
    s_sub_u32 s63, s70, 300
    v_subrev_u32 v156, s63, v156
    v_mov_b32 v157, 600
    v_cmp_lt_u32 s[8:9], v156, v157
    v_add_u32_dpp v156, v156, v156 quad_perm:[1,0,3,2] row_mask:0xf bank_mask:0xf
    s_nop 1
    v_add_u32_dpp v156, v156, v156 quad_perm:[2,3,0,1] row_mask:0xf bank_mask:0xf
    s_nop 1
    v_add_u32_dpp v156, v156, v156 row_ror:4 row_mask:0xf bank_mask:0xf
    s_nop 0
    v_readfirstlane_b32 s63, v156
    s_cmp_eq_u64 s[8:9], -1
    s_nop 3
    s_cbranch_scc0 .et_19
    s_lshr_b32 s63, s63, 3
    s_sub_u32 s63, s63, 300
    s_add_u32 s30, s30, s63
.et_19:
    s_memrealtime s[8:9]
    s_waitcnt lgkmcnt(0)
    s_sub_u32 s8, s8, s30
    s_cmpk_ge_u32 s8, 1030
    s_cbranch_scc1 .ap_20
    s_waitcnt vmcnt(4)
    s_cmpk_ge_u32 s8, 965
    s_cbranch_scc1 .ap_20
    s_waitcnt vmcnt(3)
    s_bitcmp1_b64 s[14:15], 23
    s_cbranch_scc0 1
    s_waitcnt vmcnt(2)
    s_cmpk_ge_u32 s8, 890
    s_cbranch_scc1 .ap_20
    s_waitcnt vmcnt(1)
.ap_20:
    s_add_u32 s63, s69, 319488
    buffer_load_dwordx4 v[148:151], v1, s[40:43], s63 offen nt
    s_memrealtime s[8:9]
    s_waitcnt lgkmcnt(0)
    s_sub_u32 s8, s8, s30
    s_cmpk_ge_u32 s8, 1075
    s_cbranch_scc1 .ap_21
    s_waitcnt vmcnt(5)
    s_cmpk_ge_u32 s8, 1010
    s_cbranch_scc1 .ap_21
    s_waitcnt vmcnt(3)
    s_bitcmp1_b64 s[14:15], 24
    s_cbranch_scc0 1
    s_waitcnt vmcnt(2)
    s_cmpk_ge_u32 s8, 935
    s_cbranch_scc1 .ap_21
    s_waitcnt vmcnt(1)
.ap_21:
    s_add_u32 s63, s69, 393216
    buffer_load_dwordx4 v[56:59], v1, s[40:43], s63 offen nt
    s_memrealtime s[8:9]
    s_waitcnt lgkmcnt(0)
    s_sub_u32 s8, s8, s30
    s_cmpk_ge_u32 s8, 1120
    s_cbranch_scc1 .ap_22
    s_waitcnt vmcnt(5)
    s_cmpk_ge_u32 s8, 1055
    s_cbranch_scc1 .ap_22
    s_waitcnt vmcnt(3)
    s_bitcmp1_b64 s[14:15], 25
    s_cbranch_scc0 1
    s_waitcnt vmcnt(2)
    s_cmpk_ge_u32 s8, 980
    s_cbranch_scc1 .ap_22
    s_waitcnt vmcnt(1)
.ap_22:
    s_add_u32 s63, s69, 401408
    buffer_load_dwordx4 v[60:63], v1, s[40:43], s63 offen nt
    s_branch .Latt_bc
.Le_mr:
    s_mul_i32 s58, s3, 1152
    s_mov_b32 s52, s24
    s_and_b32 s53, s25, 0xffff
    s_mov_b32 s54, 0x2400
    s_mov_b32 s55, 0x00020000
    buffer_load_dwordx2 v[246:247], v3, s[52:55], s58 offen
    buffer_load_dwordx2 v[248:249], v3, s[52:55], s58 offen offset:512
    buffer_load_dword v250, v4, s[52:55], s58 offen
    s_mov_b32 s48, s26
    s_and_b32 s49, s27, 0xffff
    s_mov_b32 s50, 0x3cc000
    s_mov_b32 s51, 0x00020000
    v_bfe_u32 v12, v0, 4, 1
    s_and_b32 s56, s3, 3
    s_lshl_b32 s56, s56, 1
    v_or_b32 v12, s56, v12
    v_and_b32 v19, 7, v0
    v_xor_b32 v12, v12, v19
    v_lshrrev_b32 v19, 3, v0
    v_mul_u32_u24 v19, 6912, v19
    v_lshl_add_u32 v19, v12, 4, v19
    s_mul_i32 s57, s3, 55296
    s_lshl_b32 s59, s99, 7
    s_add_u32 s57, s57, s59
    s_lshl_b32 s100, s3, 10
    s_add_u32 m0, s100, 0
    s_add_u32 s56, s57, 0
    buffer_load_dwordx4 v19, s[48:51], s56 offen nt lds
    s_add_u32 m0, s100, 8192
    s_add_u32 s56, s57, 442368
    buffer_load_dwordx4 v19, s[48:51], s56 offen nt lds
    s_add_u32 m0, s100, 16384
    s_add_u32 s56, s57, 884736
    buffer_load_dwordx4 v19, s[48:51], s56 offen nt lds
    s_add_u32 m0, s100, 24576
    s_add_u32 s56, s57, 1327104
    buffer_load_dwordx4 v19, s[48:51], s56 offen nt lds
    s_add_u32 m0, s100, 32768
    s_add_u32 s56, s57, 1769472
    buffer_load_dwordx4 v19, s[48:51], s56 offen nt lds
    s_add_u32 m0, s100, 40960
    s_add_u32 s56, s57, 2211840
    buffer_load_dwordx4 v19, s[48:51], s56 offen nt lds
    s_add_u32 m0, s100, 49152
    s_add_u32 s56, s57, 2654208
    buffer_load_dwordx4 v19, s[48:51], s56 offen nt lds
    s_add_u32 m0, s100, 57344
    s_add_u32 s56, s57, 3096576
    buffer_load_dwordx4 v19, s[48:51], s56 offen nt lds
    s_add_u32 m0, s100, 65536
    s_add_u32 s56, s57, 3538944
    buffer_load_dwordx4 v19, s[48:51], s56 offen nt lds
    v_bfe_u32 v16, v0, 1, 3
    v_mul_u32_u24 v16, 1312, v16
    v_lshrrev_b32 v12, 4, v0
    v_lshl_add_u32 v16, v12, 5, v16
    v_and_b32 v12, 1, v0
    v_lshl_add_u32 v16, v12, 4, v16
    v_add_u32 v16, 147456, v16
    s_mul_i32 s56, s3, 1312
    s_add_u32 s56, s56, 147456
    v_add_u32 v17, s56, v3
    v_add_u32 v18, s56, v4
    v_lshrrev_b32 v12, 4, v0
    v_bfe_u32 v13, v0, 1, 1
    v_lshl_add_u32 v12, v12, 1, v13
    v_bfe_u32 v13, v0, 2, 2
    v_lshl_add_u32 v20, v12, 3, v13
    v_lshlrev_b32 v20, 7, v20
    v_and_b32 v12, 3, v12
    v_lshrrev_b32 v13, 1, v13
    v_lshl_add_u32 v12, v12, 1, v13
    v_xor_b32 v12, s3, v12
    v_lshl_add_u32 v20, v12, 4, v20
    v_and_b32 v12, 1, v0
    v_lshl_add_u32 v20, v12, 3, v20
    v_bfe_u32 v23, v0, 1, 3
    v_mul_u32_u24 v23, 144, v23
    v_bfe_u32 v12, v0, 4, 1
    v_lshl_add_u32 v23, v12, 3, v23
    v_lshrrev_b32 v12, 5, v0
    v_lshl_add_u32 v23, v12, 2, v23
    v_and_b32 v12, 1, v0
    v_lshl_add_u32 v23, v12, 1, v23
    s_lshl_b32 s56, s3, 4
    s_add_u32 s56, s56, 157952
    v_add_u32 v23, s56, v23
    v_and_b32 v24, 15, v0
    v_lshlrev_b32 v24, 3, v24
    s_mul_i32 s56, s3, 144
    s_add_u32 s56, s56, 157952
    v_add_u32 v24, s56, v24
    v_add_u32 v21, 32768, v20
    s_lshl_b32 s100, s3, 10
    v_lshrrev_b32 v12, 4, v0
    v_mul_u32_u24 v12, 18432, v12
    v_and_b32 v13, 15, v0
    v_lshl_add_u32 v22, v13, 4, v12
    s_mul_i32 s57, s99, 57
    s_lshr_b32 s57, s57, 9
    s_mul_i32 s58, s57, 9
    s_sub_u32 s58, s99, s58
    s_mul_i32 s59, s57, 36864
    s_lshl_b32 s58, s58, 8
    s_add_u32 s59, s59, s58
    s_mul_i32 s58, s3, 2304
    s_add_u32 s59, s59, s58
    s_add_u32 s59, s59, 0x3000
    s_mov_b32 s58, 0
    s_cmp_eq_u32 s57, 1
    s_cselect_b32 s58, 1.0, s58
    s_cmp_eq_u32 s57, 4
    s_cselect_b32 s58, 1.0, s58
    s_waitcnt vmcnt(9)
    v_lshlrev_b32 v236, 16, v246
    v_and_b32 v237, 0xffff0000, v246
    v_max_f32 v236, 0xc2ae0000, v236
    v_min_f32 v242, 0x43000000, v236
    v_mul_f32 v238, 0xbfb8aa3b, v242
    v_fma_f32 v240, v242, s98, -v238
    v_fmac_f32 v240, 0xb2a57060, v242
    v_exp_f32 v238, v238
    v_mul_f32 v240, 0x3f317218, v240
    v_fmac_f32 v238, v238, v240
    v_add_f32 v238, 1.0, v238
    v_rcp_f32 v240, v238
    s_nop 0
    v_mul_f32 v242, v236, v240
    v_fma_f32 v238, -v242, v238, v236
    v_fma_f32 v236, v238, v240, v242
    v_max_f32 v237, 0xc2ae0000, v237
    v_min_f32 v243, 0x43000000, v237
    v_mul_f32 v239, 0xbfb8aa3b, v243
    v_fma_f32 v241, v243, s98, -v239
    v_fmac_f32 v241, 0xb2a57060, v243
    v_exp_f32 v239, v239
    v_mul_f32 v241, 0x3f317218, v241
    v_fmac_f32 v239, v239, v241
    v_add_f32 v239, 1.0, v239
    v_rcp_f32 v241, v239
    s_nop 0
    v_mul_f32 v243, v237, v241
    v_fma_f32 v239, -v243, v239, v237
    v_fma_f32 v237, v239, v241, v243
    v_cvt_pk_bf16_f32 v246, v236, v237
    v_lshlrev_b32 v236, 16, v247
    v_and_b32 v237, 0xffff0000, v247
    v_max_f32 v236, 0xc2ae0000, v236
    v_min_f32 v242, 0x43000000, v236
    v_mul_f32 v238, 0xbfb8aa3b, v242
    v_fma_f32 v240, v242, s98, -v238
    v_fmac_f32 v240, 0xb2a57060, v242
    v_exp_f32 v238, v238
    v_mul_f32 v240, 0x3f317218, v240
    v_fmac_f32 v238, v238, v240
    v_add_f32 v238, 1.0, v238
    v_rcp_f32 v240, v238
    s_nop 0
    v_mul_f32 v242, v236, v240
    v_fma_f32 v238, -v242, v238, v236
    v_fma_f32 v236, v238, v240, v242
    v_max_f32 v237, 0xc2ae0000, v237
    v_min_f32 v243, 0x43000000, v237
    v_mul_f32 v239, 0xbfb8aa3b, v243
    v_fma_f32 v241, v243, s98, -v239
    v_fmac_f32 v241, 0xb2a57060, v243
    v_exp_f32 v239, v239
    v_mul_f32 v241, 0x3f317218, v241
    v_fmac_f32 v239, v239, v241
    v_add_f32 v239, 1.0, v239
    v_rcp_f32 v241, v239
    s_nop 0
    v_mul_f32 v243, v237, v241
    v_fma_f32 v239, -v243, v239, v237
    v_fma_f32 v237, v239, v241, v243
    v_cvt_pk_bf16_f32 v247, v236, v237
    v_lshlrev_b32 v236, 16, v248
    v_and_b32 v237, 0xffff0000, v248
    v_max_f32 v236, 0xc2ae0000, v236
    v_min_f32 v242, 0x43000000, v236
    v_mul_f32 v238, 0xbfb8aa3b, v242
    v_fma_f32 v240, v242, s98, -v238
    v_fmac_f32 v240, 0xb2a57060, v242
    v_exp_f32 v238, v238
    v_mul_f32 v240, 0x3f317218, v240
    v_fmac_f32 v238, v238, v240
    v_add_f32 v238, 1.0, v238
    v_rcp_f32 v240, v238
    s_nop 0
    v_mul_f32 v242, v236, v240
    v_fma_f32 v238, -v242, v238, v236
    v_fma_f32 v236, v238, v240, v242
    v_max_f32 v237, 0xc2ae0000, v237
    v_min_f32 v243, 0x43000000, v237
    v_mul_f32 v239, 0xbfb8aa3b, v243
    v_fma_f32 v241, v243, s98, -v239
    v_fmac_f32 v241, 0xb2a57060, v243
    v_exp_f32 v239, v239
    v_mul_f32 v241, 0x3f317218, v241
    v_fmac_f32 v239, v239, v241
    v_add_f32 v239, 1.0, v239
    v_rcp_f32 v241, v239
    s_nop 0
    v_mul_f32 v243, v237, v241
    v_fma_f32 v239, -v243, v239, v237
    v_fma_f32 v237, v239, v241, v243
    v_cvt_pk_bf16_f32 v248, v236, v237
    v_lshlrev_b32 v236, 16, v249
    v_and_b32 v237, 0xffff0000, v249
    v_max_f32 v236, 0xc2ae0000, v236
    v_min_f32 v242, 0x43000000, v236
    v_mul_f32 v238, 0xbfb8aa3b, v242
    v_fma_f32 v240, v242, s98, -v238
    v_fmac_f32 v240, 0xb2a57060, v242
    v_exp_f32 v238, v238
    v_mul_f32 v240, 0x3f317218, v240
    v_fmac_f32 v238, v238, v240
    v_add_f32 v238, 1.0, v238
    v_rcp_f32 v240, v238
    s_nop 0
    v_mul_f32 v242, v236, v240
    v_fma_f32 v238, -v242, v238, v236
    v_fma_f32 v236, v238, v240, v242
    v_max_f32 v237, 0xc2ae0000, v237
    v_min_f32 v243, 0x43000000, v237
    v_mul_f32 v239, 0xbfb8aa3b, v243
    v_fma_f32 v241, v243, s98, -v239
    v_fmac_f32 v241, 0xb2a57060, v243
    v_exp_f32 v239, v239
    v_mul_f32 v241, 0x3f317218, v241
    v_fmac_f32 v239, v239, v241
    v_add_f32 v239, 1.0, v239
    v_rcp_f32 v241, v239
    s_nop 0
    v_mul_f32 v243, v237, v241
    v_fma_f32 v239, -v243, v239, v237
    v_fma_f32 v237, v239, v241, v243
    v_cvt_pk_bf16_f32 v249, v236, v237
    v_lshlrev_b32 v236, 16, v250
    v_and_b32 v237, 0xffff0000, v250
    v_max_f32 v236, 0xc2ae0000, v236
    v_min_f32 v242, 0x43000000, v236
    v_mul_f32 v238, 0xbfb8aa3b, v242
    v_fma_f32 v240, v242, s98, -v238
    v_fmac_f32 v240, 0xb2a57060, v242
    v_exp_f32 v238, v238
    v_mul_f32 v240, 0x3f317218, v240
    v_fmac_f32 v238, v238, v240
    v_add_f32 v238, 1.0, v238
    v_rcp_f32 v240, v238
    s_nop 0
    v_mul_f32 v242, v236, v240
    v_fma_f32 v238, -v242, v238, v236
    v_fma_f32 v236, v238, v240, v242
    v_max_f32 v237, 0xc2ae0000, v237
    v_min_f32 v243, 0x43000000, v237
    v_mul_f32 v239, 0xbfb8aa3b, v243
    v_fma_f32 v241, v243, s98, -v239
    v_fmac_f32 v241, 0xb2a57060, v243
    v_exp_f32 v239, v239
    v_mul_f32 v241, 0x3f317218, v241
    v_fmac_f32 v239, v239, v241
    v_add_f32 v239, 1.0, v239
    v_rcp_f32 v241, v239
    s_nop 0
    v_mul_f32 v243, v237, v241
    v_fma_f32 v239, -v243, v239, v237
    v_fma_f32 v237, v239, v241, v243
    v_cvt_pk_bf16_f32 v250, v236, v237
    ds_write_b64 v17, v[246:247]
    ds_write_b64 v17, v[248:249] offset:512
    ds_write_b32 v18, v250
    s_waitcnt vmcnt(3)
    s_add_u32 s63, s69, 147456
    buffer_load_dwordx4 v[72:75], v1, s[40:43], s63 offen nt
    s_waitcnt vmcnt(3)
    s_add_u32 s63, s69, 155648
    buffer_load_dwordx4 v[76:79], v1, s[40:43], s63 offen nt
    s_waitcnt vmcnt(3)
    s_add_u32 s63, s69, 163840
    buffer_load_dwordx4 v[104:107], v1, s[40:43], s63 offen nt
    s_waitcnt vmcnt(3)
    s_add_u32 s63, s69, 172032
    buffer_load_dwordx4 v[108:111], v1, s[40:43], s63 offen nt
    s_waitcnt vmcnt(3)
    s_add_u32 s63, s69, 180224
    buffer_load_dwordx4 v[136:139], v1, s[40:43], s63 offen nt
    s_waitcnt vmcnt(3)
    s_add_u32 s63, s69, 188416
    buffer_load_dwordx4 v[140:143], v1, s[40:43], s63 offen nt
    s_waitcnt vmcnt(3)
    s_add_u32 s63, s69, 262144
    buffer_load_dwordx4 v[48:51], v1, s[40:43], s63 offen nt
    s_waitcnt vmcnt(3)
    s_add_u32 s63, s69, 270336
    buffer_load_dwordx4 v[52:55], v1, s[40:43], s63 offen nt
    s_waitcnt lgkmcnt(0)
    s_barrier
    ds_read_b64_tr_b16 v[160:161], v20 offset:0
    ds_read_b64_tr_b16 v[162:163], v20 offset:512
    ds_read_b64_tr_b16 v[164:165], v20 offset:8192
    ds_read_b64_tr_b16 v[166:167], v20 offset:8704
    ds_read_b64_tr_b16 v[168:169], v20 offset:16384
    ds_read_b64_tr_b16 v[170:171], v20 offset:16896
    ds_read_b64_tr_b16 v[172:173], v20 offset:24576
    ds_read_b64_tr_b16 v[174:175], v20 offset:25088
    ds_read_b64_tr_b16 v[176:177], v21 offset:0
    ds_read_b64_tr_b16 v[178:179], v21 offset:512
    ds_read_b64_tr_b16 v[180:181], v21 offset:8192
    ds_read_b64_tr_b16 v[182:183], v21 offset:8704
    ds_read_b64_tr_b16 v[184:185], v21 offset:16384
    ds_read_b64_tr_b16 v[186:187], v21 offset:16896
    ds_read_b64_tr_b16 v[188:189], v21 offset:24576
    ds_read_b64_tr_b16 v[190:191], v21 offset:25088
    ds_read_b64_tr_b16 v[192:193], v21 offset:32768
    ds_read_b64_tr_b16 v[194:195], v21 offset:33280
    ds_read_b128 v[196:199], v16 offset:0
    ds_read_b128 v[200:203], v16 offset:128
    ds_read_b128 v[204:207], v16 offset:256
    ds_read_b128 v[208:211], v16 offset:384
    ds_read_b128 v[212:215], v16 offset:512
    ds_read_b128 v[216:219], v16 offset:640
    ds_read_b128 v[220:223], v16 offset:768
    ds_read_b128 v[224:227], v16 offset:896
    ds_read_b128 v[228:231], v16 offset:1024
    s_waitcnt lgkmcnt(8)
    v_mfma_f32_16x16x32_bf16 v[232:235], v[160:163], v[196:199], 0
    s_waitcnt lgkmcnt(7)
    v_mfma_f32_16x16x32_bf16 v[232:235], v[164:167], v[200:203], v[232:235]
    s_waitcnt lgkmcnt(6)
    v_mfma_f32_16x16x32_bf16 v[232:235], v[168:171], v[204:207], v[232:235]
    s_waitcnt lgkmcnt(5)
    v_mfma_f32_16x16x32_bf16 v[232:235], v[172:175], v[208:211], v[232:235]
    s_waitcnt lgkmcnt(4)
    v_mfma_f32_16x16x32_bf16 v[232:235], v[176:179], v[212:215], v[232:235]
    s_waitcnt lgkmcnt(3)
    v_mfma_f32_16x16x32_bf16 v[232:235], v[180:183], v[216:219], v[232:235]
    s_waitcnt lgkmcnt(2)
    v_mfma_f32_16x16x32_bf16 v[232:235], v[184:187], v[220:223], v[232:235]
    s_waitcnt lgkmcnt(1)
    v_mfma_f32_16x16x32_bf16 v[232:235], v[188:191], v[224:227], v[232:235]
    s_waitcnt lgkmcnt(0)
    v_mfma_f32_16x16x32_bf16 v[232:235], v[192:195], v[228:231], v[232:235]
    s_nop 7
    v_permlane32_swap_b32 v232, v234
    v_permlane32_swap_b32 v233, v235
    v_cndmask_b32 v233, v233, v234, s[96:97]
    v_cndmask_b32 v232, v232, v235, s[96:97]
    s_nop 1
    v_add_f32_dpp v236, v233, v232 quad_perm:[1,0,3,2] row_mask:0xf bank_mask:0xf
    v_cvt_pk_bf16_f32 v236, v236, v236
    v_lshlrev_b32 v236, 16, v236
    v_add_f32 v236, s58, v236
    v_cvt_pk_bf16_f32 v236, v236, v236
    ds_write_b16 v23, v236
    v_mov_b32 v243, s34
    s_waitcnt lgkmcnt(0)
    s_barrier
    ds_read2_b32 v[244:245], v24 offset1:1
    v_mov_b32 v241, s34
    s_waitcnt lgkmcnt(0)
    v_mov_b32 v240, v244
    v_mov_b32 v242, v245
    s_mov_b64 exec, 0xffff
    buffer_store_dwordx4 v[240:243], v22, s[36:39], s59 offen sc1
    s_mov_b64 exec, -1
    s_nop 0
    s_branch .Le_m2
.Le_mc:
    s_mul_i32 s58, s3, 1152
    s_mov_b32 s52, s24
    s_and_b32 s53, s25, 0xffff
    s_mov_b32 s54, 0x2400
    s_mov_b32 s55, 0x00020000
    buffer_load_dwordx2 v[246:247], v3, s[52:55], s58 offen
    buffer_load_dwordx2 v[248:249], v3, s[52:55], s58 offen offset:512
    buffer_load_dword v250, v4, s[52:55], s58 offen
    s_mov_b32 s48, s26
    s_and_b32 s49, s27, 0xffff
    s_mov_b32 s50, 0x3cc000
    s_mov_b32 s51, 0x00020000
    v_bfe_u32 v12, v0, 4, 1
    s_and_b32 s56, s3, 3
    s_lshl_b32 s56, s56, 1
    v_or_b32 v12, s56, v12
    v_and_b32 v19, 7, v0
    v_xor_b32 v12, v12, v19
    v_lshrrev_b32 v19, 3, v0
    v_mul_u32_u24 v19, 6912, v19
    v_lshl_add_u32 v19, v12, 4, v19
    s_mul_i32 s57, s3, 55296
    s_lshl_b32 s59, s99, 7
    s_add_u32 s57, s57, s59
    s_lshl_b32 s100, s3, 10
    s_add_u32 m0, s100, 0
    s_add_u32 s56, s57, 0
    buffer_load_dwordx4 v19, s[48:51], s56 offen nt lds
    s_add_u32 m0, s100, 8192
    s_add_u32 s56, s57, 442368
    buffer_load_dwordx4 v19, s[48:51], s56 offen nt lds
    s_add_u32 m0, s100, 16384
    s_add_u32 s56, s57, 884736
    buffer_load_dwordx4 v19, s[48:51], s56 offen nt lds
    s_add_u32 m0, s100, 24576
    s_add_u32 s56, s57, 1327104
    buffer_load_dwordx4 v19, s[48:51], s56 offen nt lds
    s_add_u32 m0, s100, 32768
    s_add_u32 s56, s57, 1769472
    buffer_load_dwordx4 v19, s[48:51], s56 offen nt lds
    s_add_u32 m0, s100, 40960
    s_add_u32 s56, s57, 2211840
    buffer_load_dwordx4 v19, s[48:51], s56 offen nt lds
    s_add_u32 m0, s100, 49152
    s_add_u32 s56, s57, 2654208
    buffer_load_dwordx4 v19, s[48:51], s56 offen nt lds
    s_add_u32 m0, s100, 57344
    s_add_u32 s56, s57, 3096576
    buffer_load_dwordx4 v19, s[48:51], s56 offen nt lds
    s_add_u32 m0, s100, 65536
    s_add_u32 s56, s57, 3538944
    buffer_load_dwordx4 v19, s[48:51], s56 offen nt lds
    v_bfe_u32 v16, v0, 1, 3
    v_mul_u32_u24 v16, 1312, v16
    v_lshrrev_b32 v12, 4, v0
    v_lshl_add_u32 v16, v12, 5, v16
    v_and_b32 v12, 1, v0
    v_lshl_add_u32 v16, v12, 4, v16
    v_add_u32 v16, 147456, v16
    s_mul_i32 s56, s3, 1312
    s_add_u32 s56, s56, 147456
    v_add_u32 v17, s56, v3
    v_add_u32 v18, s56, v4
    v_lshrrev_b32 v12, 4, v0
    v_bfe_u32 v13, v0, 1, 1
    v_lshl_add_u32 v12, v12, 1, v13
    v_bfe_u32 v13, v0, 2, 2
    v_lshl_add_u32 v20, v12, 3, v13
    v_lshlrev_b32 v20, 7, v20
    v_and_b32 v12, 3, v12
    v_lshrrev_b32 v13, 1, v13
    v_lshl_add_u32 v12, v12, 1, v13
    v_xor_b32 v12, s3, v12
    v_lshl_add_u32 v20, v12, 4, v20
    v_and_b32 v12, 1, v0
    v_lshl_add_u32 v20, v12, 3, v20
    v_bfe_u32 v23, v0, 1, 3
    v_mul_u32_u24 v23, 144, v23
    v_bfe_u32 v12, v0, 4, 1
    v_lshl_add_u32 v23, v12, 3, v23
    v_lshrrev_b32 v12, 5, v0
    v_lshl_add_u32 v23, v12, 2, v23
    v_and_b32 v12, 1, v0
    v_lshl_add_u32 v23, v12, 1, v23
    s_lshl_b32 s56, s3, 4
    s_add_u32 s56, s56, 157952
    v_add_u32 v23, s56, v23
    v_and_b32 v24, 15, v0
    v_lshlrev_b32 v24, 3, v24
    s_mul_i32 s56, s3, 144
    s_add_u32 s56, s56, 157952
    v_add_u32 v24, s56, v24
    v_add_u32 v21, 32768, v20
    s_lshl_b32 s100, s3, 10
    s_waitcnt lgkmcnt(0)
    s_add_u32 s34, s34, 1
    s_getreg_b32 s1, hwreg(HW_REG_XCC_ID)
    s_lshl_b32 s1, s1, 24
    s_add_u32 s1, s1, s34
    s_lshr_b32 s0, s2, 3
    s_lshl3_add_u32 s63, s64, s3
    s_lshl_b32 s63, s63, 5
    s_add_u32 s0, s0, s63
    s_lshl2_add_u32 s0, s0, 0x1000
    v_mov_b32 v30, s1
    s_mov_b64 exec, 1
    buffer_store_dword v30, v2, s[36:39], s0 offen sc1
    s_mov_b64 exec, -1
    v_lshrrev_b32 v12, 4, v0
    v_mul_u32_u24 v12, 18432, v12
    v_and_b32 v13, 15, v0
    v_lshl_add_u32 v22, v13, 4, v12
    s_mul_i32 s57, s99, 57
    s_lshr_b32 s57, s57, 9
    s_mul_i32 s58, s57, 9
    s_sub_u32 s58, s99, s58
    s_mul_i32 s59, s57, 36864
    s_lshl_b32 s58, s58, 8
    s_add_u32 s59, s59, s58
    s_mul_i32 s58, s3, 2304
    s_add_u32 s59, s59, s58
    s_add_u32 s59, s59, 0x3000
    s_mov_b32 s58, 0
    s_cmp_eq_u32 s57, 1
    s_cselect_b32 s58, 1.0, s58
    s_cmp_eq_u32 s57, 4
    s_cselect_b32 s58, 1.0, s58
    s_waitcnt vmcnt(9)
    v_lshlrev_b32 v236, 16, v246
    v_and_b32 v237, 0xffff0000, v246
    v_max_f32 v236, 0xc2ae0000, v236
    v_min_f32 v242, 0x43000000, v236
    v_mul_f32 v238, 0xbfb8aa3b, v242
    v_fma_f32 v240, v242, s98, -v238
    v_fmac_f32 v240, 0xb2a57060, v242
    v_exp_f32 v238, v238
    v_mul_f32 v240, 0x3f317218, v240
    v_fmac_f32 v238, v238, v240
    v_add_f32 v238, 1.0, v238
    v_rcp_f32 v240, v238
    s_nop 0
    v_mul_f32 v242, v236, v240
    v_fma_f32 v238, -v242, v238, v236
    v_fma_f32 v236, v238, v240, v242
    v_max_f32 v237, 0xc2ae0000, v237
    v_min_f32 v243, 0x43000000, v237
    v_mul_f32 v239, 0xbfb8aa3b, v243
    v_fma_f32 v241, v243, s98, -v239
    v_fmac_f32 v241, 0xb2a57060, v243
    v_exp_f32 v239, v239
    v_mul_f32 v241, 0x3f317218, v241
    v_fmac_f32 v239, v239, v241
    v_add_f32 v239, 1.0, v239
    v_rcp_f32 v241, v239
    s_nop 0
    v_mul_f32 v243, v237, v241
    v_fma_f32 v239, -v243, v239, v237
    v_fma_f32 v237, v239, v241, v243
    v_cvt_pk_bf16_f32 v246, v236, v237
    v_lshlrev_b32 v236, 16, v247
    v_and_b32 v237, 0xffff0000, v247
    v_max_f32 v236, 0xc2ae0000, v236
    v_min_f32 v242, 0x43000000, v236
    v_mul_f32 v238, 0xbfb8aa3b, v242
    v_fma_f32 v240, v242, s98, -v238
    v_fmac_f32 v240, 0xb2a57060, v242
    v_exp_f32 v238, v238
    v_mul_f32 v240, 0x3f317218, v240
    v_fmac_f32 v238, v238, v240
    v_add_f32 v238, 1.0, v238
    v_rcp_f32 v240, v238
    s_nop 0
    v_mul_f32 v242, v236, v240
    v_fma_f32 v238, -v242, v238, v236
    v_fma_f32 v236, v238, v240, v242
    v_max_f32 v237, 0xc2ae0000, v237
    v_min_f32 v243, 0x43000000, v237
    v_mul_f32 v239, 0xbfb8aa3b, v243
    v_fma_f32 v241, v243, s98, -v239
    v_fmac_f32 v241, 0xb2a57060, v243
    v_exp_f32 v239, v239
    v_mul_f32 v241, 0x3f317218, v241
    v_fmac_f32 v239, v239, v241
    v_add_f32 v239, 1.0, v239
    v_rcp_f32 v241, v239
    s_nop 0
    v_mul_f32 v243, v237, v241
    v_fma_f32 v239, -v243, v239, v237
    v_fma_f32 v237, v239, v241, v243
    v_cvt_pk_bf16_f32 v247, v236, v237
    v_lshlrev_b32 v236, 16, v248
    v_and_b32 v237, 0xffff0000, v248
    v_max_f32 v236, 0xc2ae0000, v236
    v_min_f32 v242, 0x43000000, v236
    v_mul_f32 v238, 0xbfb8aa3b, v242
    v_fma_f32 v240, v242, s98, -v238
    v_fmac_f32 v240, 0xb2a57060, v242
    v_exp_f32 v238, v238
    v_mul_f32 v240, 0x3f317218, v240
    v_fmac_f32 v238, v238, v240
    v_add_f32 v238, 1.0, v238
    v_rcp_f32 v240, v238
    s_nop 0
    v_mul_f32 v242, v236, v240
    v_fma_f32 v238, -v242, v238, v236
    v_fma_f32 v236, v238, v240, v242
    v_max_f32 v237, 0xc2ae0000, v237
    v_min_f32 v243, 0x43000000, v237
    v_mul_f32 v239, 0xbfb8aa3b, v243
    v_fma_f32 v241, v243, s98, -v239
    v_fmac_f32 v241, 0xb2a57060, v243
    v_exp_f32 v239, v239
    v_mul_f32 v241, 0x3f317218, v241
    v_fmac_f32 v239, v239, v241
    v_add_f32 v239, 1.0, v239
    v_rcp_f32 v241, v239
    s_nop 0
    v_mul_f32 v243, v237, v241
    v_fma_f32 v239, -v243, v239, v237
    v_fma_f32 v237, v239, v241, v243
    v_cvt_pk_bf16_f32 v248, v236, v237
    v_lshlrev_b32 v236, 16, v249
    v_and_b32 v237, 0xffff0000, v249
    v_max_f32 v236, 0xc2ae0000, v236
    v_min_f32 v242, 0x43000000, v236
    v_mul_f32 v238, 0xbfb8aa3b, v242
    v_fma_f32 v240, v242, s98, -v238
    v_fmac_f32 v240, 0xb2a57060, v242
    v_exp_f32 v238, v238
    v_mul_f32 v240, 0x3f317218, v240
    v_fmac_f32 v238, v238, v240
    v_add_f32 v238, 1.0, v238
    v_rcp_f32 v240, v238
    s_nop 0
    v_mul_f32 v242, v236, v240
    v_fma_f32 v238, -v242, v238, v236
    v_fma_f32 v236, v238, v240, v242
    v_max_f32 v237, 0xc2ae0000, v237
    v_min_f32 v243, 0x43000000, v237
    v_mul_f32 v239, 0xbfb8aa3b, v243
    v_fma_f32 v241, v243, s98, -v239
    v_fmac_f32 v241, 0xb2a57060, v243
    v_exp_f32 v239, v239
    v_mul_f32 v241, 0x3f317218, v241
    v_fmac_f32 v239, v239, v241
    v_add_f32 v239, 1.0, v239
    v_rcp_f32 v241, v239
    s_nop 0
    v_mul_f32 v243, v237, v241
    v_fma_f32 v239, -v243, v239, v237
    v_fma_f32 v237, v239, v241, v243
    v_cvt_pk_bf16_f32 v249, v236, v237
    v_lshlrev_b32 v236, 16, v250
    v_and_b32 v237, 0xffff0000, v250
    v_max_f32 v236, 0xc2ae0000, v236
    v_min_f32 v242, 0x43000000, v236
    v_mul_f32 v238, 0xbfb8aa3b, v242
    v_fma_f32 v240, v242, s98, -v238
    v_fmac_f32 v240, 0xb2a57060, v242
    v_exp_f32 v238, v238
    v_mul_f32 v240, 0x3f317218, v240
    v_fmac_f32 v238, v238, v240
    v_add_f32 v238, 1.0, v238
    v_rcp_f32 v240, v238
    s_nop 0
    v_mul_f32 v242, v236, v240
    v_fma_f32 v238, -v242, v238, v236
    v_fma_f32 v236, v238, v240, v242
    v_max_f32 v237, 0xc2ae0000, v237
    v_min_f32 v243, 0x43000000, v237
    v_mul_f32 v239, 0xbfb8aa3b, v243
    v_fma_f32 v241, v243, s98, -v239
    v_fmac_f32 v241, 0xb2a57060, v243
    v_exp_f32 v239, v239
    v_mul_f32 v241, 0x3f317218, v241
    v_fmac_f32 v239, v239, v241
    v_add_f32 v239, 1.0, v239
    v_rcp_f32 v241, v239
    s_nop 0
    v_mul_f32 v243, v237, v241
    v_fma_f32 v239, -v243, v239, v237
    v_fma_f32 v237, v239, v241, v243
    v_cvt_pk_bf16_f32 v250, v236, v237
    ds_write_b64 v17, v[246:247]
    ds_write_b64 v17, v[248:249] offset:512
    ds_write_b32 v18, v250
    s_waitcnt vmcnt(0)
    s_waitcnt lgkmcnt(0)
    s_barrier
    ds_read_b64_tr_b16 v[160:161], v20 offset:0
    ds_read_b64_tr_b16 v[162:163], v20 offset:512
    ds_read_b64_tr_b16 v[164:165], v20 offset:8192
    ds_read_b64_tr_b16 v[166:167], v20 offset:8704
    ds_read_b64_tr_b16 v[168:169], v20 offset:16384
    ds_read_b64_tr_b16 v[170:171], v20 offset:16896
    ds_read_b64_tr_b16 v[172:173], v20 offset:24576
    ds_read_b64_tr_b16 v[174:175], v20 offset:25088
    ds_read_b64_tr_b16 v[176:177], v21 offset:0
    ds_read_b64_tr_b16 v[178:179], v21 offset:512
    ds_read_b64_tr_b16 v[180:181], v21 offset:8192
    ds_read_b64_tr_b16 v[182:183], v21 offset:8704
    ds_read_b64_tr_b16 v[184:185], v21 offset:16384
    ds_read_b64_tr_b16 v[186:187], v21 offset:16896
    ds_read_b64_tr_b16 v[188:189], v21 offset:24576
    ds_read_b64_tr_b16 v[190:191], v21 offset:25088
    ds_read_b64_tr_b16 v[192:193], v21 offset:32768
    ds_read_b64_tr_b16 v[194:195], v21 offset:33280
    ds_read_b128 v[196:199], v16 offset:0
    ds_read_b128 v[200:203], v16 offset:128
    ds_read_b128 v[204:207], v16 offset:256
    ds_read_b128 v[208:211], v16 offset:384
    ds_read_b128 v[212:215], v16 offset:512
    ds_read_b128 v[216:219], v16 offset:640
    ds_read_b128 v[220:223], v16 offset:768
    ds_read_b128 v[224:227], v16 offset:896
    ds_read_b128 v[228:231], v16 offset:1024
    s_waitcnt lgkmcnt(8)
    v_mfma_f32_16x16x32_bf16 v[232:235], v[160:163], v[196:199], 0
    s_waitcnt lgkmcnt(7)
    v_mfma_f32_16x16x32_bf16 v[232:235], v[164:167], v[200:203], v[232:235]
    s_waitcnt lgkmcnt(6)
    v_mfma_f32_16x16x32_bf16 v[232:235], v[168:171], v[204:207], v[232:235]
    s_waitcnt lgkmcnt(5)
    v_mfma_f32_16x16x32_bf16 v[232:235], v[172:175], v[208:211], v[232:235]
    s_waitcnt lgkmcnt(4)
    v_mfma_f32_16x16x32_bf16 v[232:235], v[176:179], v[212:215], v[232:235]
    s_waitcnt lgkmcnt(3)
    v_mfma_f32_16x16x32_bf16 v[232:235], v[180:183], v[216:219], v[232:235]
    s_waitcnt lgkmcnt(2)
    v_mfma_f32_16x16x32_bf16 v[232:235], v[184:187], v[220:223], v[232:235]
    s_waitcnt lgkmcnt(1)
    v_mfma_f32_16x16x32_bf16 v[232:235], v[188:191], v[224:227], v[232:235]
    s_waitcnt lgkmcnt(0)
    v_mfma_f32_16x16x32_bf16 v[232:235], v[192:195], v[228:231], v[232:235]
    s_nop 7
    v_permlane32_swap_b32 v232, v234
    v_permlane32_swap_b32 v233, v235
    v_cndmask_b32 v233, v233, v234, s[96:97]
    v_cndmask_b32 v232, v232, v235, s[96:97]
    s_nop 1
    v_add_f32_dpp v236, v233, v232 quad_perm:[1,0,3,2] row_mask:0xf bank_mask:0xf
    v_cvt_pk_bf16_f32 v236, v236, v236
    v_lshlrev_b32 v236, 16, v236
    v_add_f32 v236, s58, v236
    v_cvt_pk_bf16_f32 v236, v236, v236
    ds_write_b16 v23, v236
    v_mov_b32 v243, s34
    s_waitcnt lgkmcnt(0)
    s_barrier
    ds_read2_b32 v[244:245], v24 offset1:1
    v_mov_b32 v241, s34
    s_waitcnt lgkmcnt(0)
    v_mov_b32 v240, v244
    v_mov_b32 v242, v245
    s_mov_b64 exec, 0xffffffff
    buffer_store_dwordx4 v[240:243], v22, s[36:39], s59 offen sc1
    s_mov_b64 exec, -1
    s_mov_b32 s14, 0x6b5ad6b5
    s_mov_b32 s15, 0x5ad6b5ad
    s_add_u32 s30, s70, 0
    s_add_u32 s63, s69, 32768
    buffer_load_dwordx4 v[96:99], v1, s[40:43], s63 offen nt
    s_add_u32 s63, s69, 40960
    buffer_load_dwordx4 v[100:103], v1, s[40:43], s63 offen nt
    s_add_u32 s63, s69, 49152
    buffer_load_dwordx4 v[128:131], v1, s[40:43], s63 offen nt
    s_add_u32 s63, s69, 57344
    buffer_load_dwordx4 v[132:135], v1, s[40:43], s63 offen nt
    s_waitcnt vmcnt(3)
    s_add_u32 s63, s69, 131072
    buffer_load_dwordx4 v[40:43], v1, s[40:43], s63 offen nt
    s_waitcnt vmcnt(3)
    s_add_u32 s63, s69, 139264
    buffer_load_dwordx4 v[44:47], v1, s[40:43], s63 offen nt
    s_waitcnt vmcnt(3)
    s_add_u32 s63, s69, 147456
    buffer_load_dwordx4 v[72:75], v1, s[40:43], s63 offen nt
    s_waitcnt vmcnt(3)
    s_add_u32 s63, s69, 155648
    buffer_load_dwordx4 v[76:79], v1, s[40:43], s63 offen nt
    s_waitcnt vmcnt(3)
    s_add_u32 s63, s69, 163840
    buffer_load_dwordx4 v[104:107], v1, s[40:43], s63 offen nt
    s_waitcnt vmcnt(3)
    s_add_u32 s63, s69, 172032
    buffer_load_dwordx4 v[108:111], v1, s[40:43], s63 offen nt
    s_waitcnt vmcnt(3)
    s_add_u32 s63, s69, 180224
    buffer_load_dwordx4 v[136:139], v1, s[40:43], s63 offen nt
    s_waitcnt vmcnt(3)
    s_add_u32 s63, s69, 188416
    buffer_load_dwordx4 v[140:143], v1, s[40:43], s63 offen nt
    s_waitcnt vmcnt(3)
    s_add_u32 s63, s69, 262144
    buffer_load_dwordx4 v[48:51], v1, s[40:43], s63 offen nt
    s_waitcnt vmcnt(3)
    s_add_u32 s63, s69, 270336
    buffer_load_dwordx4 v[52:55], v1, s[40:43], s63 offen nt
.Le_m2:
    s_waitcnt vmcnt(3)
    s_bitcmp1_b64 s[14:15], 18
    s_cbranch_scc0 1
    s_waitcnt vmcnt(2)
    s_add_u32 s63, s69, 278528
    buffer_load_dwordx4 v[80:83], v1, s[40:43], s63 offen nt
    v_and_b32 v157, 7, v0
    v_lshlrev_b32 v157, 2, v157
    s_mov_b32 s63, 0x400
    buffer_load_dword v156, v157, s[36:39], s63 offen
    s_memrealtime s[8:9]
    s_waitcnt lgkmcnt(0)
    s_sub_u32 s8, s8, s30
    s_cmpk_ge_u32 s8, 850
    s_cbranch_scc1 .ap_23
    s_waitcnt vmcnt(5)
    s_cmpk_ge_u32 s8, 785
    s_cbranch_scc1 .ap_23
    s_waitcnt vmcnt(4)
    s_bitcmp1_b64 s[14:15], 19
    s_cbranch_scc0 1
    s_waitcnt vmcnt(3)
    s_cmpk_ge_u32 s8, 710
    s_cbranch_scc1 .ap_23
    s_waitcnt vmcnt(2)
.ap_23:
    s_add_u32 s63, s69, 286720
    buffer_load_dwordx4 v[84:87], v1, s[40:43], s63 offen nt
    s_memrealtime s[8:9]
    s_waitcnt lgkmcnt(0)
    s_sub_u32 s8, s8, s30
    s_cmpk_ge_u32 s8, 895
    s_cbranch_scc1 .ap_24
    s_waitcnt vmcnt(6)
    s_cmpk_ge_u32 s8, 830
    s_cbranch_scc1 .ap_24
    s_waitcnt vmcnt(4)
    s_bitcmp1_b64 s[14:15], 20
    s_cbranch_scc0 1
    s_waitcnt vmcnt(3)
    s_cmpk_ge_u32 s8, 755
    s_cbranch_scc1 .ap_24
    s_waitcnt vmcnt(2)
.ap_24:
    s_add_u32 s63, s69, 294912
    buffer_load_dwordx4 v[112:115], v1, s[40:43], s63 offen nt
    s_memrealtime s[8:9]
    s_waitcnt lgkmcnt(0)
    s_sub_u32 s8, s8, s30
    s_cmpk_ge_u32 s8, 940
    s_cbranch_scc1 .ap_25
    s_waitcnt vmcnt(6)
    s_cmpk_ge_u32 s8, 875
    s_cbranch_scc1 .ap_25
    s_waitcnt vmcnt(4)
    s_bitcmp1_b64 s[14:15], 21
    s_cbranch_scc0 1
    s_waitcnt vmcnt(3)
    s_cmpk_ge_u32 s8, 800
    s_cbranch_scc1 .ap_25
    s_waitcnt vmcnt(1)
.ap_25:
    s_add_u32 s63, s69, 303104
    buffer_load_dwordx4 v[116:119], v1, s[40:43], s63 offen nt
    s_memrealtime s[8:9]
    s_waitcnt lgkmcnt(0)
    s_sub_u32 s8, s8, s30
    s_cmpk_ge_u32 s8, 985
    s_cbranch_scc1 .ap_26
    s_waitcnt vmcnt(6)
    s_cmpk_ge_u32 s8, 920
    s_cbranch_scc1 .ap_26
    s_waitcnt vmcnt(4)
    s_bitcmp1_b64 s[14:15], 22
    s_cbranch_scc0 1
    s_waitcnt vmcnt(2)
    s_cmpk_ge_u32 s8, 845
    s_cbranch_scc1 .ap_26
    s_waitcnt vmcnt(1)
.ap_26:
    s_add_u32 s63, s69, 311296
    buffer_load_dwordx4 v[144:147], v1, s[40:43], s63 offen nt
    s_waitcnt vmcnt(4)
    s_sub_u32 s63, s70, 300
    v_subrev_u32 v156, s63, v156
    v_mov_b32 v157, 600
    v_cmp_lt_u32 s[8:9], v156, v157
    v_add_u32_dpp v156, v156, v156 quad_perm:[1,0,3,2] row_mask:0xf bank_mask:0xf
    s_nop 1
    v_add_u32_dpp v156, v156, v156 quad_perm:[2,3,0,1] row_mask:0xf bank_mask:0xf
    s_nop 1
    v_add_u32_dpp v156, v156, v156 row_ror:4 row_mask:0xf bank_mask:0xf
    s_nop 0
    v_readfirstlane_b32 s63, v156
    s_cmp_eq_u64 s[8:9], -1
    s_nop 3
    s_cbranch_scc0 .et_27
    s_lshr_b32 s63, s63, 3
    s_sub_u32 s63, s63, 300
    s_add_u32 s30, s30, s63
.et_27:
    s_memrealtime s[8:9]
    s_waitcnt lgkmcnt(0)
    s_sub_u32 s8, s8, s30
    s_cmpk_ge_u32 s8, 1030
    s_cbranch_scc1 .ap_28
    s_waitcnt vmcnt(4)
    s_cmpk_ge_u32 s8, 965
    s_cbranch_scc1 .ap_28
    s_waitcnt vmcnt(3)
    s_bitcmp1_b64 s[14:15], 23
    s_cbranch_scc0 1
    s_waitcnt vmcnt(2)
    s_cmpk_ge_u32 s8, 890
    s_cbranch_scc1 .ap_28
    s_waitcnt vmcnt(1)
.ap_28:
    s_add_u32 s63, s69, 319488
    buffer_load_dwordx4 v[148:151], v1, s[40:43], s63 offen nt
    s_memrealtime s[8:9]
    s_waitcnt lgkmcnt(0)
    s_sub_u32 s8, s8, s30
    s_cmpk_ge_u32 s8, 1075
    s_cbranch_scc1 .ap_29
    s_waitcnt vmcnt(5)
    s_cmpk_ge_u32 s8, 1010
    s_cbranch_scc1 .ap_29
    s_waitcnt vmcnt(3)
    s_bitcmp1_b64 s[14:15], 24
    s_cbranch_scc0 1
    s_waitcnt vmcnt(2)
    s_cmpk_ge_u32 s8, 935
    s_cbranch_scc1 .ap_29
    s_waitcnt vmcnt(1)
.ap_29:
    s_add_u32 s63, s69, 393216
    buffer_load_dwordx4 v[56:59], v1, s[40:43], s63 offen nt
    s_memrealtime s[8:9]
    s_waitcnt lgkmcnt(0)
    s_sub_u32 s8, s8, s30
    s_cmpk_ge_u32 s8, 1120
    s_cbranch_scc1 .ap_30
    s_waitcnt vmcnt(5)
    s_cmpk_ge_u32 s8, 1055
    s_cbranch_scc1 .ap_30
    s_waitcnt vmcnt(3)
    s_bitcmp1_b64 s[14:15], 25
    s_cbranch_scc0 1
    s_waitcnt vmcnt(2)
    s_cmpk_ge_u32 s8, 980
    s_cbranch_scc1 .ap_30
    s_waitcnt vmcnt(1)
.ap_30:
    s_add_u32 s63, s69, 401408
    buffer_load_dwordx4 v[60:63], v1, s[40:43], s63 offen nt
    s_cmp_lt_u32 s2, 216
    s_cbranch_scc1 .Latt_bc
    s_branch .Latt_n
.Le_q:
    s_cmp_eq_u32 s65, 31
    s_mov_b32 s14, 0x94a5294a
    s_cselect_b32 s14, 0x0, s14
    s_mov_b32 s15, 0xa5294a52
    s_cselect_b32 s15, 0x0, s15
    s_add_u32 s30, s70, 0
    s_mul_i32 s58, s3, 1152
    s_mov_b32 s52, s4
    s_and_b32 s53, s5, 0xffff
    s_mov_b32 s54, 0x2400
    s_mov_b32 s55, 0x00020000
    buffer_load_dwordx2 v[246:247], v3, s[52:55], s58 offen
    buffer_load_dwordx2 v[248:249], v3, s[52:55], s58 offen offset:512
    buffer_load_dword v250, v4, s[52:55], s58 offen
    s_mov_b32 s48, s10
    s_and_b32 s49, s11, 0xffff
    s_mov_b32 s50, 0x480000
    s_mov_b32 s51, 0x00020000
    v_bfe_u32 v12, v0, 4, 1
    s_and_b32 s56, s3, 3
    s_lshl_b32 s56, s56, 1
    v_or_b32 v12, s56, v12
    v_and_b32 v19, 7, v0
    v_xor_b32 v12, v12, v19
    v_lshrrev_b32 v19, 3, v0
    v_mul_u32_u24 v19, 8192, v19
    v_lshl_add_u32 v19, v12, 4, v19
    s_lshl3_add_u32 s101, s64, s101
    s_lshl_b32 s99, s3, 16
    s_lshl_b32 s59, s101, 7
    s_add_u32 s99, s99, s59
    s_lshl_b32 s100, s3, 10
    s_add_u32 m0, s100, 0
    s_add_u32 s56, s99, 0
    buffer_load_dwordx4 v19, s[48:51], s56 offen nt lds
    s_add_u32 s63, s69, 32768
    buffer_load_dwordx4 v[96:99], v1, s[40:43], s63 offen nt
    v_bfe_u32 v16, v0, 1, 3
    v_mul_u32_u24 v16, 1312, v16
    v_lshrrev_b32 v12, 4, v0
    v_lshl_add_u32 v16, v12, 5, v16
    v_and_b32 v12, 1, v0
    v_lshl_add_u32 v16, v12, 4, v16
    v_add_u32 v16, 147456, v16
    s_mul_i32 s56, s3, 1312
    s_add_u32 s56, s56, 147456
    v_add_u32 v17, s56, v3
    v_add_u32 v18, s56, v4
    v_lshrrev_b32 v12, 4, v0
    v_bfe_u32 v13, v0, 1, 1
    v_lshl_add_u32 v12, v12, 1, v13
    v_bfe_u32 v13, v0, 2, 2
    v_lshl_add_u32 v20, v12, 3, v13
    v_lshlrev_b32 v20, 7, v20
    v_and_b32 v12, 3, v12
    v_lshrrev_b32 v13, 1, v13
    v_lshl_add_u32 v12, v12, 1, v13
    v_xor_b32 v12, s3, v12
    v_lshl_add_u32 v20, v12, 4, v20
    v_and_b32 v12, 1, v0
    v_lshl_add_u32 v20, v12, 3, v20
    v_bfe_u32 v23, v0, 1, 3
    v_mul_u32_u24 v23, 144, v23
    v_bfe_u32 v12, v0, 4, 1
    v_lshl_add_u32 v23, v12, 3, v23
    v_lshrrev_b32 v12, 5, v0
    v_lshl_add_u32 v23, v12, 2, v23
    v_and_b32 v12, 1, v0
    v_lshl_add_u32 v23, v12, 1, v23
    s_lshl_b32 s56, s3, 4
    s_add_u32 s56, s56, 157952
    v_add_u32 v23, s56, v23
    v_and_b32 v24, 15, v0
    v_lshlrev_b32 v24, 3, v24
    s_mul_i32 s56, s3, 144
    s_add_u32 s56, s56, 157952
    v_add_u32 v24, s56, v24
    v_add_u32 v21, 32768, v20
    s_lshl_b32 s100, s3, 10
    s_waitcnt lgkmcnt(0)
    s_add_u32 s34, s34, 1
    s_getreg_b32 s1, hwreg(HW_REG_XCC_ID)
    s_lshl_b32 s1, s1, 24
    s_add_u32 s1, s1, s34
    s_lshr_b32 s0, s2, 3
    s_lshl3_add_u32 s63, s64, s3
    s_lshl_b32 s63, s63, 5
    s_add_u32 s0, s0, s63
    s_lshl2_add_u32 s0, s0, 0x1000
    v_mov_b32 v30, s1
    s_mov_b64 exec, 1
    buffer_store_dword v30, v2, s[36:39], s0 offen sc1
    s_mov_b64 exec, -1
    s_lshl_b32 s101, s101, 8
    s_lshl_b32 s58, s3, 14
    s_add_u32 s101, s101, s58
    s_add_u32 s101, s101, 0x40000
    s_and_b32 s58, s64, 1
    s_mul_i32 s58, s58, 18432
    s_mul_i32 s59, s3, 2304
    s_add_u32 s58, s58, s59
    s_add_u32 s58, s58, 0x3000
    s_add_u32 s59, s58, 36864
    s_waitcnt vmcnt(5)
    s_add_u32 m0, s100, 8192
    s_add_u32 s56, s99, 524288
    buffer_load_dwordx4 v19, s[48:51], s56 offen nt lds
    s_waitcnt vmcnt(5)
    s_add_u32 s63, s69, 40960
    buffer_load_dwordx4 v[100:103], v1, s[40:43], s63 offen nt
    s_waitcnt vmcnt(5)
    s_add_u32 m0, s100, 16384
    s_add_u32 s56, s99, 1048576
    buffer_load_dwordx4 v19, s[48:51], s56 offen nt lds
    s_waitcnt vmcnt(5)
    s_add_u32 s63, s69, 49152
    buffer_load_dwordx4 v[128:131], v1, s[40:43], s63 offen nt
    v_lshlrev_b32 v236, 16, v246
    v_and_b32 v237, 0xffff0000, v246
    v_lshlrev_b32 v238, 16, v247
    v_and_b32 v239, 0xffff0000, v247
    v_lshlrev_b32 v240, 16, v248
    v_and_b32 v241, 0xffff0000, v248
    v_lshlrev_b32 v242, 16, v249
    v_and_b32 v243, 0xffff0000, v249
    v_lshlrev_b32 v244, 16, v250
    v_and_b32 v245, 0xffff0000, v250
    s_mov_b32 s56, 0x3f803f80
    v_dot2_f32_bf16 v10, v246, s56, 0
    v_dot2_f32_bf16 v11, v246, v246, 0
    v_dot2_f32_bf16 v10, v247, s56, v10
    v_dot2_f32_bf16 v11, v247, v247, v11
    v_dot2_f32_bf16 v10, v248, s56, v10
    v_dot2_f32_bf16 v11, v248, v248, v11
    v_dot2_f32_bf16 v10, v249, s56, v10
    v_dot2_f32_bf16 v11, v249, v249, v11
    s_mov_b64 exec, 0xffffffff
    v_dot2_f32_bf16 v10, v250, s56, v10
    v_dot2_f32_bf16 v11, v250, v250, v11
    s_mov_b64 exec, -1
    s_nop 1
    v_permlane32_swap_b32 v10, v11
    v_add_f32 v10, v10, v11
    v_mov_b32 v12, v10
    s_nop 1
    v_permlane16_swap_b32 v12, v10
    v_add_f32 v10, v12, v10
    s_nop 1
    v_add_f32_dpp v10, v10, v10 row_ror:8 row_mask:0xf bank_mask:0xf
    s_nop 1
    v_add_f32_dpp v10, v10, v10 row_ror:4 row_mask:0xf bank_mask:0xf
    s_nop 1
    v_add_f32_dpp v10, v10, v10 quad_perm:[2,3,0,1] row_mask:0xf bank_mask:0xf
    s_nop 1
    v_add_f32_dpp v10, v10, v10 quad_perm:[1,0,3,2] row_mask:0xf bank_mask:0xf
    v_mul_f32 v10, 0x3ae38e39, v10
    s_nop 0
    v_readlane_b32 s56, v10, 0
    v_readlane_b32 s57, v10, 32
    s_nop 0
    v_mov_b32 v10, s56
    v_fma_f32 v11, -v10, v10, s57
    v_max_f32 v11, 0, v11
    v_cvt_pk_bf16_f32 v12, -v10, v11
    v_and_b32 v13, 0xffff0000, v12
    v_add_f32 v13, 0x3727c5ac, v13
    v_lshlrev_b32 v10, 16, v12
    v_cvt_pk_bf16_f32 v13, v13, v13
    v_lshlrev_b32 v13, 16, v13
    v_sqrt_f32 v13, v13
    v_mov_b32 v11, v10
    v_cvt_pk_bf16_f32 v13, v13, v13
    v_lshlrev_b32 v13, 16, v13
    v_rcp_f32 v12, v13
    v_rcp_f32 v13, v13
    v_pk_add_f32 v[236:237], v[236:237], v[10:11]
    v_pk_add_f32 v[238:239], v[238:239], v[10:11]
    v_pk_add_f32 v[240:241], v[240:241], v[10:11]
    v_pk_add_f32 v[242:243], v[242:243], v[10:11]
    v_pk_add_f32 v[244:245], v[244:245], v[10:11]
    v_cvt_pk_bf16_f32 v236, v236, v237
    v_and_b32 v237, 0xffff0000, v236
    v_lshlrev_b32 v236, 16, v236
    v_cvt_pk_bf16_f32 v238, v238, v239
    v_and_b32 v239, 0xffff0000, v238
    v_lshlrev_b32 v238, 16, v238
    v_cvt_pk_bf16_f32 v240, v240, v241
    v_and_b32 v241, 0xffff0000, v240
    v_lshlrev_b32 v240, 16, v240
    v_cvt_pk_bf16_f32 v242, v242, v243
    v_and_b32 v243, 0xffff0000, v242
    v_lshlrev_b32 v242, 16, v242
    v_cvt_pk_bf16_f32 v244, v244, v245
    v_and_b32 v245, 0xffff0000, v244
    v_lshlrev_b32 v244, 16, v244
    v_pk_mul_f32 v[236:237], v[236:237], v[12:13]
    v_pk_mul_f32 v[238:239], v[238:239], v[12:13]
    v_pk_mul_f32 v[240:241], v[240:241], v[12:13]
    v_pk_mul_f32 v[242:243], v[242:243], v[12:13]
    v_pk_mul_f32 v[244:245], v[244:245], v[12:13]
    v_cvt_pk_bf16_f32 v236, v236, v237
    v_and_b32 v237, 0xffff0000, v236
    v_lshlrev_b32 v236, 16, v236
    v_cvt_pk_bf16_f32 v238, v238, v239
    v_and_b32 v239, 0xffff0000, v238
    v_lshlrev_b32 v238, 16, v238
    v_cvt_pk_bf16_f32 v240, v240, v241
    v_and_b32 v241, 0xffff0000, v240
    v_lshlrev_b32 v240, 16, v240
    v_cvt_pk_bf16_f32 v242, v242, v243
    v_and_b32 v243, 0xffff0000, v242
    v_lshlrev_b32 v242, 16, v242
    v_cvt_pk_bf16_f32 v244, v244, v245
    v_and_b32 v245, 0xffff0000, v244
    v_lshlrev_b32 v244, 16, v244
    s_waitcnt vmcnt(5)
    s_add_u32 m0, s100, 24576
    s_add_u32 s56, s99, 1572864
    buffer_load_dwordx4 v19, s[48:51], s56 offen nt lds
    s_waitcnt vmcnt(5)
    s_add_u32 s63, s69, 57344
    buffer_load_dwordx4 v[132:135], v1, s[40:43], s63 offen nt
    s_waitcnt vmcnt(5)
    s_add_u32 m0, s100, 32768
    s_add_u32 s56, s99, 2097152
    buffer_load_dwordx4 v19, s[48:51], s56 offen nt lds
    s_waitcnt vmcnt(5)
    s_add_u32 s63, s69, 131072
    buffer_load_dwordx4 v[40:43], v1, s[40:43], s63 offen nt
    s_waitcnt vmcnt(5)
    s_add_u32 m0, s100, 40960
    s_add_u32 s56, s99, 2621440
    buffer_load_dwordx4 v19, s[48:51], s56 offen nt lds
    s_waitcnt vmcnt(5)
    s_add_u32 s63, s69, 139264
    buffer_load_dwordx4 v[44:47], v1, s[40:43], s63 offen nt
    s_waitcnt vmcnt(5)
    s_add_u32 m0, s100, 49152
    s_add_u32 s56, s99, 3145728
    buffer_load_dwordx4 v19, s[48:51], s56 offen nt lds
    s_waitcnt vmcnt(5)
    s_add_u32 s63, s69, 147456
    buffer_load_dwordx4 v[72:75], v1, s[40:43], s63 offen nt
    s_waitcnt vmcnt(5)
    s_add_u32 m0, s100, 57344
    s_add_u32 s56, s99, 3670016
    buffer_load_dwordx4 v19, s[48:51], s56 offen nt lds
    s_waitcnt vmcnt(5)
    s_add_u32 s63, s69, 155648
    buffer_load_dwordx4 v[76:79], v1, s[40:43], s63 offen nt
    s_waitcnt vmcnt(5)
    s_add_u32 m0, s100, 65536
    s_add_u32 s56, s99, 4194304
    buffer_load_dwordx4 v19, s[48:51], s56 offen nt lds
    s_waitcnt vmcnt(5)
    s_add_u32 s63, s69, 163840
    buffer_load_dwordx4 v[104:107], v1, s[40:43], s63 offen nt
    s_waitcnt vmcnt(5)
    s_add_u32 s63, s69, 172032
    buffer_load_dwordx4 v[108:111], v1, s[40:43], s63 offen nt
    buffer_load_dwordx4 v[196:199], v2, s[36:39], s58 offen offset:0 sc1
    buffer_load_dwordx4 v[200:203], v2, s[36:39], s58 offen offset:1024 sc1
    buffer_load_dwordx2 v[204:205], v5, s[36:39], s58 offen offset:0 sc1
    buffer_load_dwordx4 v[206:209], v2, s[36:39], s59 offen offset:0 sc1
    buffer_load_dwordx4 v[210:213], v2, s[36:39], s59 offen offset:1024 sc1
    buffer_load_dwordx2 v[214:215], v5, s[36:39], s59 offen offset:0 sc1
    s_add_u32 s63, s69, 180224
    buffer_load_dwordx4 v[136:139], v1, s[40:43], s63 offen nt
    s_add_u32 s63, s69, 188416
    buffer_load_dwordx4 v[140:143], v1, s[40:43], s63 offen nt
    s_add_u32 s63, s69, 262144
    buffer_load_dwordx4 v[48:51], v1, s[40:43], s63 offen nt
    s_add_u32 s63, s69, 270336
    buffer_load_dwordx4 v[52:55], v1, s[40:43], s63 offen nt
    s_waitcnt vmcnt(12)
    s_barrier
    ds_read_b64_tr_b16 v[160:161], v20 offset:0
    ds_read_b64_tr_b16 v[162:163], v20 offset:512
    ds_read_b64_tr_b16 v[164:165], v20 offset:8192
    ds_read_b64_tr_b16 v[166:167], v20 offset:8704
    ds_read_b64_tr_b16 v[168:169], v20 offset:16384
    ds_read_b64_tr_b16 v[170:171], v20 offset:16896
    ds_read_b64_tr_b16 v[172:173], v20 offset:24576
    ds_read_b64_tr_b16 v[174:175], v20 offset:25088
    ds_read_b64_tr_b16 v[176:177], v21 offset:0
    ds_read_b64_tr_b16 v[178:179], v21 offset:512
    ds_read_b64_tr_b16 v[180:181], v21 offset:8192
    ds_read_b64_tr_b16 v[182:183], v21 offset:8704
    ds_read_b64_tr_b16 v[184:185], v21 offset:16384
    ds_read_b64_tr_b16 v[186:187], v21 offset:16896
    ds_read_b64_tr_b16 v[188:189], v21 offset:24576
    ds_read_b64_tr_b16 v[190:191], v21 offset:25088
    ds_read_b64_tr_b16 v[192:193], v21 offset:32768
    ds_read_b64_tr_b16 v[194:195], v21 offset:33280
    s_waitcnt vmcnt(4)
    s_branch .gpc_32
.gp_31:
    buffer_load_dwordx4 v[196:199], v2, s[36:39], s58 offen offset:0 sc1
    buffer_load_dwordx4 v[200:203], v2, s[36:39], s58 offen offset:1024 sc1
    buffer_load_dwordx2 v[204:205], v5, s[36:39], s58 offen offset:0 sc1
    buffer_load_dwordx4 v[206:209], v2, s[36:39], s59 offen offset:0 sc1
    buffer_load_dwordx4 v[210:213], v2, s[36:39], s59 offen offset:1024 sc1
    buffer_load_dwordx2 v[214:215], v5, s[36:39], s59 offen offset:0 sc1
    s_waitcnt vmcnt(0)
.gpc_32:
    v_min_u32 v10, v197, v199
    v_max_u32 v11, v197, v199
    v_min3_u32 v10, v10, v201, v203
    v_max3_u32 v11, v11, v201, v203
    v_min3_u32 v10, v10, v205, v207
    v_max3_u32 v11, v11, v205, v207
    v_min3_u32 v10, v10, v209, v211
    v_max3_u32 v11, v11, v209, v211
    v_min3_u32 v10, v10, v213, v215
    v_max3_u32 v11, v11, v213, v215
    v_cmp_eq_u32 vcc, s34, v10
    v_cmp_eq_u32 s[56:57], s34, v11
    s_and_b64 vcc, vcc, s[56:57]
    s_cmp_eq_u64 vcc, exec
    s_nop 2
    s_cbranch_scc1 .gpd_33
    s_sub_u32 s35, s35, 1
    s_cbranch_scc1 .Lexit
    s_branch .gp_31
.gpd_33:
    v_and_b32 v207, 0xffff0000, v206
    v_lshlrev_b32 v206, 16, v206
    v_and_b32 v209, 0xffff0000, v208
    v_lshlrev_b32 v208, 16, v208
    v_and_b32 v211, 0xffff0000, v210
    v_lshlrev_b32 v210, 16, v210
    v_and_b32 v213, 0xffff0000, v212
    v_lshlrev_b32 v212, 16, v212
    v_and_b32 v215, 0xffff0000, v214
    v_lshlrev_b32 v214, 16, v214
    v_and_b32 v197, 0xffff0000, v196
    v_lshlrev_b32 v196, 16, v196
    v_and_b32 v199, 0xffff0000, v198
    v_lshlrev_b32 v198, 16, v198
    v_and_b32 v201, 0xffff0000, v200
    v_lshlrev_b32 v200, 16, v200
    v_and_b32 v203, 0xffff0000, v202
    v_lshlrev_b32 v202, 16, v202
    v_and_b32 v205, 0xffff0000, v204
    v_lshlrev_b32 v204, 16, v204
    v_pk_mul_f32 v[236:237], v[236:237], v[206:207]
    v_pk_mul_f32 v[238:239], v[238:239], v[208:209]
    v_pk_mul_f32 v[240:241], v[240:241], v[210:211]
    v_pk_mul_f32 v[242:243], v[242:243], v[212:213]
    v_pk_mul_f32 v[244:245], v[244:245], v[214:215]
    v_cvt_pk_bf16_f32 v236, v236, v237
    v_and_b32 v237, 0xffff0000, v236
    v_lshlrev_b32 v236, 16, v236
    v_cvt_pk_bf16_f32 v238, v238, v239
    v_and_b32 v239, 0xffff0000, v238
    v_lshlrev_b32 v238, 16, v238
    v_cvt_pk_bf16_f32 v240, v240, v241
    v_and_b32 v241, 0xffff0000, v240
    v_lshlrev_b32 v240, 16, v240
    v_cvt_pk_bf16_f32 v242, v242, v243
    v_and_b32 v243, 0xffff0000, v242
    v_lshlrev_b32 v242, 16, v242
    v_cvt_pk_bf16_f32 v244, v244, v245
    v_and_b32 v245, 0xffff0000, v244
    v_lshlrev_b32 v244, 16, v244
    v_pk_add_f32 v[236:237], v[236:237], v[196:197]
    v_pk_add_f32 v[238:239], v[238:239], v[198:199]
    v_pk_add_f32 v[240:241], v[240:241], v[200:201]
    v_pk_add_f32 v[242:243], v[242:243], v[202:203]
    v_pk_add_f32 v[244:245], v[244:245], v[204:205]
    v_cvt_pk_bf16_f32 v246, v236, v237
    v_cvt_pk_bf16_f32 v247, v238, v239
    v_cvt_pk_bf16_f32 v248, v240, v241
    v_cvt_pk_bf16_f32 v249, v242, v243
    v_cvt_pk_bf16_f32 v250, v244, v245
    ds_write_b64 v17, v[246:247]
    ds_write_b64 v17, v[248:249] offset:512
    ds_write_b32 v18, v250
    s_waitcnt lgkmcnt(0)
    s_barrier
    ds_read_b128 v[196:199], v16 offset:0
    ds_read_b128 v[200:203], v16 offset:128
    ds_read_b128 v[204:207], v16 offset:256
    ds_read_b128 v[208:211], v16 offset:384
    ds_read_b128 v[212:215], v16 offset:512
    ds_read_b128 v[216:219], v16 offset:640
    ds_read_b128 v[220:223], v16 offset:768
    ds_read_b128 v[224:227], v16 offset:896
    ds_read_b128 v[228:231], v16 offset:1024
    s_waitcnt lgkmcnt(8)
    v_mfma_f32_16x16x32_bf16 v[232:235], v[160:163], v[196:199], 0
    s_waitcnt lgkmcnt(7)
    v_mfma_f32_16x16x32_bf16 v[232:235], v[164:167], v[200:203], v[232:235]
    s_waitcnt lgkmcnt(6)
    v_mfma_f32_16x16x32_bf16 v[232:235], v[168:171], v[204:207], v[232:235]
    s_waitcnt lgkmcnt(5)
    v_mfma_f32_16x16x32_bf16 v[232:235], v[172:175], v[208:211], v[232:235]
    s_waitcnt lgkmcnt(4)
    v_mfma_f32_16x16x32_bf16 v[232:235], v[176:179], v[212:215], v[232:235]
    s_waitcnt lgkmcnt(3)
    v_mfma_f32_16x16x32_bf16 v[232:235], v[180:183], v[216:219], v[232:235]
    s_waitcnt lgkmcnt(2)
    v_mfma_f32_16x16x32_bf16 v[232:235], v[184:187], v[220:223], v[232:235]
    s_waitcnt lgkmcnt(1)
    v_mfma_f32_16x16x32_bf16 v[232:235], v[188:191], v[224:227], v[232:235]
    s_waitcnt lgkmcnt(0)
    v_mfma_f32_16x16x32_bf16 v[232:235], v[192:195], v[228:231], v[232:235]
    s_nop 7
    v_permlane32_swap_b32 v232, v234
    v_permlane32_swap_b32 v233, v235
    v_cndmask_b32 v233, v233, v234, s[96:97]
    v_cndmask_b32 v232, v232, v235, s[96:97]
    s_nop 1
    v_add_f32_dpp v236, v233, v232 quad_perm:[1,0,3,2] row_mask:0xf bank_mask:0xf
    v_cvt_pk_bf16_f32 v236, v236, v236
    ds_write_b16 v23, v236
    v_mov_b32 v243, s34
    s_waitcnt lgkmcnt(0)
    s_barrier
    ds_read2_b32 v[244:245], v24 offset1:1
    v_mov_b32 v241, s34
    s_waitcnt lgkmcnt(0)
    v_mov_b32 v240, v244
    v_mov_b32 v242, v245
    s_mov_b64 exec, 0xffff
    buffer_store_dwordx4 v[240:243], v2, s[36:39], s101 offen sc1
    s_mov_b64 exec, -1
    s_waitcnt vmcnt(3)
    s_bitcmp1_b64 s[14:15], 18
    s_cbranch_scc0 1
    s_waitcnt vmcnt(2)
    s_add_u32 s63, s69, 278528
    buffer_load_dwordx4 v[80:83], v1, s[40:43], s63 offen nt
    v_and_b32 v157, 7, v0
    v_lshlrev_b32 v157, 2, v157
    s_mov_b32 s63, 0x400
    buffer_load_dword v156, v157, s[36:39], s63 offen
    s_memrealtime s[8:9]
    s_waitcnt lgkmcnt(0)
    s_sub_u32 s8, s8, s30
    s_cmpk_ge_u32 s8, 850
    s_cbranch_scc1 .ap_34
    s_waitcnt vmcnt(5)
    s_cmpk_ge_u32 s8, 785
    s_cbranch_scc1 .ap_34
    s_waitcnt vmcnt(4)
    s_bitcmp1_b64 s[14:15], 19
    s_cbranch_scc0 1
    s_waitcnt vmcnt(3)
    s_cmpk_ge_u32 s8, 710
    s_cbranch_scc1 .ap_34
    s_waitcnt vmcnt(2)
.ap_34:
    s_add_u32 s63, s69, 286720
    buffer_load_dwordx4 v[84:87], v1, s[40:43], s63 offen nt
    s_memrealtime s[8:9]
    s_waitcnt lgkmcnt(0)
    s_sub_u32 s8, s8, s30
    s_cmpk_ge_u32 s8, 895
    s_cbranch_scc1 .ap_35
    s_waitcnt vmcnt(6)
    s_cmpk_ge_u32 s8, 830
    s_cbranch_scc1 .ap_35
    s_waitcnt vmcnt(4)
    s_bitcmp1_b64 s[14:15], 20
    s_cbranch_scc0 1
    s_waitcnt vmcnt(3)
    s_cmpk_ge_u32 s8, 755
    s_cbranch_scc1 .ap_35
    s_waitcnt vmcnt(2)
.ap_35:
    s_add_u32 s63, s69, 294912
    buffer_load_dwordx4 v[112:115], v1, s[40:43], s63 offen nt
    s_memrealtime s[8:9]
    s_waitcnt lgkmcnt(0)
    s_sub_u32 s8, s8, s30
    s_cmpk_ge_u32 s8, 940
    s_cbranch_scc1 .ap_36
    s_waitcnt vmcnt(6)
    s_cmpk_ge_u32 s8, 875
    s_cbranch_scc1 .ap_36
    s_waitcnt vmcnt(4)
    s_bitcmp1_b64 s[14:15], 21
    s_cbranch_scc0 1
    s_waitcnt vmcnt(3)
    s_cmpk_ge_u32 s8, 800
    s_cbranch_scc1 .ap_36
    s_waitcnt vmcnt(1)
.ap_36:
    s_add_u32 s63, s69, 303104
    buffer_load_dwordx4 v[116:119], v1, s[40:43], s63 offen nt
    s_memrealtime s[8:9]
    s_waitcnt lgkmcnt(0)
    s_sub_u32 s8, s8, s30
    s_cmpk_ge_u32 s8, 985
    s_cbranch_scc1 .ap_37
    s_waitcnt vmcnt(6)
    s_cmpk_ge_u32 s8, 920
    s_cbranch_scc1 .ap_37
    s_waitcnt vmcnt(4)
    s_bitcmp1_b64 s[14:15], 22
    s_cbranch_scc0 1
    s_waitcnt vmcnt(2)
    s_cmpk_ge_u32 s8, 845
    s_cbranch_scc1 .ap_37
    s_waitcnt vmcnt(1)
.ap_37:
    s_add_u32 s63, s69, 311296
    buffer_load_dwordx4 v[144:147], v1, s[40:43], s63 offen nt
    s_waitcnt vmcnt(4)
    s_sub_u32 s63, s70, 300
    v_subrev_u32 v156, s63, v156
    v_mov_b32 v157, 600
    v_cmp_lt_u32 s[8:9], v156, v157
    v_add_u32_dpp v156, v156, v156 quad_perm:[1,0,3,2] row_mask:0xf bank_mask:0xf
    s_nop 1
    v_add_u32_dpp v156, v156, v156 quad_perm:[2,3,0,1] row_mask:0xf bank_mask:0xf
    s_nop 1
    v_add_u32_dpp v156, v156, v156 row_ror:4 row_mask:0xf bank_mask:0xf
    s_nop 0
    v_readfirstlane_b32 s63, v156
    s_cmp_eq_u64 s[8:9], -1
    s_nop 3
    s_cbranch_scc0 .et_38
    s_lshr_b32 s63, s63, 3
    s_sub_u32 s63, s63, 300
    s_add_u32 s30, s30, s63
.et_38:
    s_memrealtime s[8:9]
    s_waitcnt lgkmcnt(0)
    s_sub_u32 s8, s8, s30
    s_cmpk_ge_u32 s8, 1030
    s_cbranch_scc1 .ap_39
    s_waitcnt vmcnt(4)
    s_cmpk_ge_u32 s8, 965
    s_cbranch_scc1 .ap_39
    s_waitcnt vmcnt(3)
    s_bitcmp1_b64 s[14:15], 23
    s_cbranch_scc0 1
    s_waitcnt vmcnt(2)
    s_cmpk_ge_u32 s8, 890
    s_cbranch_scc1 .ap_39
    s_waitcnt vmcnt(1)
.ap_39:
    s_add_u32 s63, s69, 319488
    buffer_load_dwordx4 v[148:151], v1, s[40:43], s63 offen nt
    s_memrealtime s[8:9]
    s_waitcnt lgkmcnt(0)
    s_sub_u32 s8, s8, s30
    s_cmpk_ge_u32 s8, 1075
    s_cbranch_scc1 .ap_40
    s_waitcnt vmcnt(5)
    s_cmpk_ge_u32 s8, 1010
    s_cbranch_scc1 .ap_40
    s_waitcnt vmcnt(3)
    s_bitcmp1_b64 s[14:15], 24
    s_cbranch_scc0 1
    s_waitcnt vmcnt(2)
    s_cmpk_ge_u32 s8, 935
    s_cbranch_scc1 .ap_40
    s_waitcnt vmcnt(1)
.ap_40:
    s_add_u32 s63, s69, 393216
    buffer_load_dwordx4 v[56:59], v1, s[40:43], s63 offen nt
    s_memrealtime s[8:9]
    s_waitcnt lgkmcnt(0)
    s_sub_u32 s8, s8, s30
    s_cmpk_ge_u32 s8, 1120
    s_cbranch_scc1 .ap_41
    s_waitcnt vmcnt(5)
    s_cmpk_ge_u32 s8, 1055
    s_cbranch_scc1 .ap_41
    s_waitcnt vmcnt(3)
    s_bitcmp1_b64 s[14:15], 25
    s_cbranch_scc0 1
    s_waitcnt vmcnt(2)
    s_cmpk_ge_u32 s8, 980
    s_cbranch_scc1 .ap_41
    s_waitcnt vmcnt(1)
.ap_41:
    s_add_u32 s63, s69, 401408
    buffer_load_dwordx4 v[60:63], v1, s[40:43], s63 offen nt
    s_cmp_lt_u32 s2, 216
    s_cbranch_scc1 .Latt_bc
    s_branch .Latt_n
.Le_a:
    s_mov_b32 s14, 0x6ddb76dd
    s_mov_b32 s15, 0xdb76ddb7
    s_add_u32 s30, s70, -60
    s_mov_b32 s48, s12
    s_and_b32 s49, s13, 0xffff
    s_mov_b32 s50, 0x480000
    s_mov_b32 s51, 0x00020000
    v_bfe_u32 v12, v0, 4, 1
    s_and_b32 s56, s3, 1
    s_lshl_b32 s56, s56, 2
    v_lshl_or_b32 v12, v12, 1, s56
    v_and_b32 v13, 7, v0
    v_xor_b32 v12, v12, v13
    v_lshrrev_b32 v13, 3, v0
    v_mul_u32_u24 v13, 1152, v13
    v_lshl_add_u32 v6, v12, 4, v13
    s_lshl_b32 s101, s64, 6
    s_add_u32 s101, s101, s3
    s_mul_i32 s101, s101, 9216
    s_lshl_b32 s56, s65, 7
    s_add_u32 s101, s101, s56
    s_lshl_b32 s100, s3, 10
    s_waitcnt vmcnt(3)
    s_add_u32 m0, s100, 0
    s_add_u32 s56, s101, 0
    buffer_load_dwordx4 v6, s[48:51], s56 offen nt lds
    s_waitcnt vmcnt(3)
    s_bitcmp1_b64 s[14:15], 4
    s_cbranch_scc0 1
    s_waitcnt vmcnt(2)
    s_add_u32 s63, s69, 32768
    buffer_load_dwordx4 v[96:99], v1, s[40:43], s63 offen nt
    s_waitcnt vmcnt(3)
    s_add_u32 m0, s100, 8192
    s_add_u32 s56, s101, 73728
    buffer_load_dwordx4 v6, s[48:51], s56 offen nt lds
    s_waitcnt vmcnt(3)
    s_bitcmp1_b64 s[14:15], 5
    s_cbranch_scc0 1
    s_waitcnt vmcnt(2)
    s_add_u32 s63, s69, 40960
    buffer_load_dwordx4 v[100:103], v1, s[40:43], s63 offen nt
    s_waitcnt vmcnt(3)
    s_bitcmp1_b64 s[14:15], 6
    s_cbranch_scc0 1
    s_waitcnt vmcnt(2)
    s_add_u32 s63, s69, 49152
    buffer_load_dwordx4 v[128:131], v1, s[40:43], s63 offen nt
    s_waitcnt vmcnt(3)
    s_bitcmp1_b64 s[14:15], 7
    s_cbranch_scc0 1
    s_waitcnt vmcnt(2)
    s_add_u32 s63, s69, 57344
    buffer_load_dwordx4 v[132:135], v1, s[40:43], s63 offen nt
    s_waitcnt vmcnt(3)
    s_add_u32 m0, s100, 16384
    s_add_u32 s56, s101, 147456
    buffer_load_dwordx4 v6, s[48:51], s56 offen nt lds
    s_waitcnt vmcnt(3)
    s_bitcmp1_b64 s[14:15], 8
    s_cbranch_scc0 1
    s_waitcnt vmcnt(2)
    s_add_u32 s63, s69, 131072
    buffer_load_dwordx4 v[40:43], v1, s[40:43], s63 offen nt
    s_waitcnt vmcnt(3)
    s_bitcmp1_b64 s[14:15], 9
    s_cbranch_scc0 1
    s_waitcnt vmcnt(2)
    s_add_u32 s63, s69, 139264
    buffer_load_dwordx4 v[44:47], v1, s[40:43], s63 offen nt
    s_memrealtime s[8:9]
    s_waitcnt lgkmcnt(0)
    s_sub_u32 s8, s8, s30
    s_cmpk_ge_u32 s8, 436
    s_cbranch_scc1 .ap_42
    s_waitcnt vmcnt(4)
    s_cmpk_ge_u32 s8, 371
    s_cbranch_scc1 .ap_42
    s_waitcnt vmcnt(3)
    s_bitcmp1_b64 s[14:15], 10
    s_cbranch_scc0 1
    s_waitcnt vmcnt(2)
    s_cmpk_ge_u32 s8, 296
    s_cbranch_scc1 .ap_42
    s_waitcnt vmcnt(1)
.ap_42:
    s_add_u32 s63, s69, 147456
    buffer_load_dwordx4 v[72:75], v1, s[40:43], s63 offen nt
    s_waitcnt vmcnt(3)
    s_add_u32 m0, s100, 24576
    s_add_u32 s56, s101, 221184
    buffer_load_dwordx4 v6, s[48:51], s56 offen nt lds
    s_memrealtime s[8:9]
    s_waitcnt lgkmcnt(0)
    s_sub_u32 s8, s8, s30
    s_cmpk_ge_u32 s8, 482
    s_cbranch_scc1 .ap_43
    s_waitcnt vmcnt(4)
    s_cmpk_ge_u32 s8, 417
    s_cbranch_scc1 .ap_43
    s_waitcnt vmcnt(3)
    s_bitcmp1_b64 s[14:15], 11
    s_cbranch_scc0 1
    s_waitcnt vmcnt(2)
    s_cmpk_ge_u32 s8, 342
    s_cbranch_scc1 .ap_43
    s_waitcnt vmcnt(1)
.ap_43:
    s_add_u32 s63, s69, 155648
    buffer_load_dwordx4 v[76:79], v1, s[40:43], s63 offen nt
    s_waitcnt lgkmcnt(0)
    s_add_u32 s34, s34, 1
    s_getreg_b32 s1, hwreg(HW_REG_XCC_ID)
    s_lshl_b32 s1, s1, 24
    s_add_u32 s1, s1, s34
    s_lshr_b32 s0, s2, 3
    s_lshl3_add_u32 s63, s64, s3
    s_lshl_b32 s63, s63, 5
    s_add_u32 s0, s0, s63
    s_lshl2_add_u32 s0, s0, 0x1000
    v_mov_b32 v30, s1
    s_mov_b64 exec, 1
    buffer_store_dword v30, v2, s[36:39], s0 offen sc1
    s_mov_b64 exec, -1
    s_memrealtime s[8:9]
    s_waitcnt lgkmcnt(0)
    s_sub_u32 s8, s8, s30
    s_cmpk_ge_u32 s8, 528
    s_cbranch_scc1 .ap_44
    s_waitcnt vmcnt(5)
    s_cmpk_ge_u32 s8, 463
    s_cbranch_scc1 .ap_44
    s_waitcnt vmcnt(3)
    s_bitcmp1_b64 s[14:15], 12
    s_cbranch_scc0 1
    s_waitcnt vmcnt(2)
    s_cmpk_ge_u32 s8, 388
    s_cbranch_scc1 .ap_44
    s_waitcnt vmcnt(1)
.ap_44:
    s_add_u32 s63, s69, 163840
    buffer_load_dwordx4 v[104:107], v1, s[40:43], s63 offen nt
    s_memrealtime s[8:9]
    s_waitcnt lgkmcnt(0)
    s_sub_u32 s8, s8, s30
    s_cmpk_ge_u32 s8, 574
    s_cbranch_scc1 .ap_45
    s_waitcnt vmcnt(5)
    s_cmpk_ge_u32 s8, 509
    s_cbranch_scc1 .ap_45
    s_waitcnt vmcnt(3)
    s_bitcmp1_b64 s[14:15], 13
    s_cbranch_scc0 1
    s_waitcnt vmcnt(2)
    s_cmpk_ge_u32 s8, 434
    s_cbranch_scc1 .ap_45
    s_waitcnt vmcnt(1)
.ap_45:
    s_add_u32 s63, s69, 172032
    buffer_load_dwordx4 v[108:111], v1, s[40:43], s63 offen nt
    s_waitcnt vmcnt(3)
    s_add_u32 m0, s100, 32768
    s_add_u32 s56, s101, 294912
    buffer_load_dwordx4 v6, s[48:51], s56 offen nt lds
    s_memrealtime s[8:9]
    s_waitcnt lgkmcnt(0)
    s_sub_u32 s8, s8, s30
    s_cmpk_ge_u32 s8, 620
    s_cbranch_scc1 .ap_46
    s_waitcnt vmcnt(4)
    s_cmpk_ge_u32 s8, 555
    s_cbranch_scc1 .ap_46
    s_waitcnt vmcnt(3)
    s_bitcmp1_b64 s[14:15], 14
    s_cbranch_scc0 1
    s_waitcnt vmcnt(2)
    s_cmpk_ge_u32 s8, 480
    s_cbranch_scc1 .ap_46
    s_waitcnt vmcnt(1)
.ap_46:
    s_add_u32 s63, s69, 180224
    buffer_load_dwordx4 v[136:139], v1, s[40:43], s63 offen nt
    s_memrealtime s[8:9]
    s_waitcnt lgkmcnt(0)
    s_sub_u32 s8, s8, s30
    s_cmpk_ge_u32 s8, 666
    s_cbranch_scc1 .ap_47
    s_waitcnt vmcnt(5)
    s_cmpk_ge_u32 s8, 601
    s_cbranch_scc1 .ap_47
    s_waitcnt vmcnt(3)
    s_bitcmp1_b64 s[14:15], 15
    s_cbranch_scc0 1
    s_waitcnt vmcnt(2)
    s_cmpk_ge_u32 s8, 526
    s_cbranch_scc1 .ap_47
    s_waitcnt vmcnt(1)
.ap_47:
    s_add_u32 s63, s69, 188416
    buffer_load_dwordx4 v[140:143], v1, s[40:43], s63 offen nt
    s_memrealtime s[8:9]
    s_waitcnt lgkmcnt(0)
    s_sub_u32 s8, s8, s30
    s_cmpk_ge_u32 s8, 712
    s_cbranch_scc1 .ap_48
    s_waitcnt vmcnt(5)
    s_cmpk_ge_u32 s8, 647
    s_cbranch_scc1 .ap_48
    s_waitcnt vmcnt(3)
    s_bitcmp1_b64 s[14:15], 16
    s_cbranch_scc0 1
    s_waitcnt vmcnt(2)
    s_cmpk_ge_u32 s8, 572
    s_cbranch_scc1 .ap_48
    s_waitcnt vmcnt(1)
.ap_48:
    s_add_u32 s63, s69, 262144
    buffer_load_dwordx4 v[48:51], v1, s[40:43], s63 offen nt
    s_waitcnt vmcnt(3)
    s_add_u32 m0, s100, 40960
    s_add_u32 s56, s101, 368640
    buffer_load_dwordx4 v6, s[48:51], s56 offen nt lds
    s_memrealtime s[8:9]
    s_waitcnt lgkmcnt(0)
    s_sub_u32 s8, s8, s30
    s_cmpk_ge_u32 s8, 758
    s_cbranch_scc1 .ap_49
    s_waitcnt vmcnt(4)
    s_cmpk_ge_u32 s8, 693
    s_cbranch_scc1 .ap_49
    s_waitcnt vmcnt(3)
    s_bitcmp1_b64 s[14:15], 17
    s_cbranch_scc0 1
    s_waitcnt vmcnt(2)
    s_cmpk_ge_u32 s8, 618
    s_cbranch_scc1 .ap_49
    s_waitcnt vmcnt(1)
.ap_49:
    s_add_u32 s63, s69, 270336
    buffer_load_dwordx4 v[52:55], v1, s[40:43], s63 offen nt
    s_memrealtime s[8:9]
    s_waitcnt lgkmcnt(0)
    s_sub_u32 s8, s8, s30
    s_cmpk_ge_u32 s8, 804
    s_cbranch_scc1 .ap_50
    s_waitcnt vmcnt(5)
    s_cmpk_ge_u32 s8, 739
    s_cbranch_scc1 .ap_50
    s_waitcnt vmcnt(3)
    s_bitcmp1_b64 s[14:15], 18
    s_cbranch_scc0 1
    s_waitcnt vmcnt(2)
    s_cmpk_ge_u32 s8, 664
    s_cbranch_scc1 .ap_50
    s_waitcnt vmcnt(1)
.ap_50:
    s_add_u32 s63, s69, 278528
    buffer_load_dwordx4 v[80:83], v1, s[40:43], s63 offen nt
    v_and_b32 v157, 7, v0
    v_lshlrev_b32 v157, 2, v157
    s_mov_b32 s63, 0x400
    buffer_load_dword v156, v157, s[36:39], s63 offen
    s_memrealtime s[8:9]
    s_waitcnt lgkmcnt(0)
    s_sub_u32 s8, s8, s30
    s_cmpk_ge_u32 s8, 850
    s_cbranch_scc1 .ap_51
    s_waitcnt vmcnt(6)
    s_cmpk_ge_u32 s8, 785
    s_cbranch_scc1 .ap_51
    s_waitcnt vmcnt(4)
    s_bitcmp1_b64 s[14:15], 19
    s_cbranch_scc0 1
    s_waitcnt vmcnt(3)
    s_cmpk_ge_u32 s8, 710
    s_cbranch_scc1 .ap_51
    s_waitcnt vmcnt(2)
.ap_51:
    s_add_u32 s63, s69, 286720
    buffer_load_dwordx4 v[84:87], v1, s[40:43], s63 offen nt
    s_waitcnt vmcnt(4)
    s_add_u32 m0, s100, 49152
    s_add_u32 s56, s101, 442368
    buffer_load_dwordx4 v6, s[48:51], s56 offen nt lds
    s_memrealtime s[8:9]
    s_waitcnt lgkmcnt(0)
    s_sub_u32 s8, s8, s30
    s_cmpk_ge_u32 s8, 895
    s_cbranch_scc1 .ap_52
    s_waitcnt vmcnt(5)
    s_cmpk_ge_u32 s8, 830
    s_cbranch_scc1 .ap_52
    s_waitcnt vmcnt(4)
    s_bitcmp1_b64 s[14:15], 20
    s_cbranch_scc0 1
    s_waitcnt vmcnt(3)
    s_cmpk_ge_u32 s8, 755
    s_cbranch_scc1 .ap_52
    s_waitcnt vmcnt(1)
.ap_52:
    s_add_u32 s63, s69, 294912
    buffer_load_dwordx4 v[112:115], v1, s[40:43], s63 offen nt
    s_memrealtime s[8:9]
    s_waitcnt lgkmcnt(0)
    s_sub_u32 s8, s8, s30
    s_cmpk_ge_u32 s8, 940
    s_cbranch_scc1 .ap_53
    s_waitcnt vmcnt(6)
    s_cmpk_ge_u32 s8, 875
    s_cbranch_scc1 .ap_53
    s_waitcnt vmcnt(4)
    s_bitcmp1_b64 s[14:15], 21
    s_cbranch_scc0 1
    s_waitcnt vmcnt(2)
    s_cmpk_ge_u32 s8, 800
    s_cbranch_scc1 .ap_53
    s_waitcnt vmcnt(1)
.ap_53:
    s_add_u32 s63, s69, 303104
    buffer_load_dwordx4 v[116:119], v1, s[40:43], s63 offen nt
    s_memrealtime s[8:9]
    s_waitcnt lgkmcnt(0)
    s_sub_u32 s8, s8, s30
    s_cmpk_ge_u32 s8, 985
    s_cbranch_scc1 .ap_54
    s_waitcnt vmcnt(6)
    s_cmpk_ge_u32 s8, 920
    s_cbranch_scc1 .ap_54
    s_waitcnt vmcnt(3)
    s_bitcmp1_b64 s[14:15], 22
    s_cbranch_scc0 1
    s_waitcnt vmcnt(2)
    s_cmpk_ge_u32 s8, 845
    s_cbranch_scc1 .ap_54
    s_waitcnt vmcnt(1)
.ap_54:
    s_add_u32 s63, s69, 311296
    buffer_load_dwordx4 v[144:147], v1, s[40:43], s63 offen nt
    s_waitcnt vmcnt(5)
    s_sub_u32 s63, s70, 300
    v_subrev_u32 v156, s63, v156
    v_mov_b32 v157, 600
    v_cmp_lt_u32 s[8:9], v156, v157
    v_add_u32_dpp v156, v156, v156 quad_perm:[1,0,3,2] row_mask:0xf bank_mask:0xf
    s_nop 1
    v_add_u32_dpp v156, v156, v156 quad_perm:[2,3,0,1] row_mask:0xf bank_mask:0xf
    s_nop 1
    v_add_u32_dpp v156, v156, v156 row_ror:4 row_mask:0xf bank_mask:0xf
    s_nop 0
    v_readfirstlane_b32 s63, v156
    s_cmp_eq_u64 s[8:9], -1
    s_nop 3
    s_cbranch_scc0 .et_55
    s_lshr_b32 s63, s63, 3
    s_sub_u32 s63, s63, 300
    s_add_u32 s30, s30, s63
.et_55:
    s_waitcnt vmcnt(3)
    s_add_u32 m0, s100, 57344
    s_add_u32 s56, s101, 516096
    buffer_load_dwordx4 v6, s[48:51], s56 offen nt lds
    s_memrealtime s[8:9]
    s_waitcnt lgkmcnt(0)
    s_sub_u32 s8, s8, s30
    s_cmpk_ge_u32 s8, 1030
    s_cbranch_scc1 .ap_56
    s_waitcnt vmcnt(4)
    s_cmpk_ge_u32 s8, 965
    s_cbranch_scc1 .ap_56
    s_waitcnt vmcnt(3)
    s_bitcmp1_b64 s[14:15], 23
    s_cbranch_scc0 1
    s_waitcnt vmcnt(2)
    s_cmpk_ge_u32 s8, 890
    s_cbranch_scc1 .ap_56
    s_waitcnt vmcnt(1)
.ap_56:
    s_add_u32 s63, s69, 319488
    buffer_load_dwordx4 v[148:151], v1, s[40:43], s63 offen nt
    s_memrealtime s[8:9]
    s_waitcnt lgkmcnt(0)
    s_sub_u32 s8, s8, s30
    s_cmpk_ge_u32 s8, 1075
    s_cbranch_scc1 .ap_57
    s_waitcnt vmcnt(5)
    s_cmpk_ge_u32 s8, 1010
    s_cbranch_scc1 .ap_57
    s_waitcnt vmcnt(3)
    s_bitcmp1_b64 s[14:15], 24
    s_cbranch_scc0 1
    s_waitcnt vmcnt(2)
    s_cmpk_ge_u32 s8, 935
    s_cbranch_scc1 .ap_57
    s_waitcnt vmcnt(1)
.ap_57:
    s_add_u32 s63, s69, 393216
    buffer_load_dwordx4 v[56:59], v1, s[40:43], s63 offen nt
    s_memrealtime s[8:9]
    s_waitcnt lgkmcnt(0)
    s_sub_u32 s8, s8, s30
    s_cmpk_ge_u32 s8, 1120
    s_cbranch_scc1 .ap_58
    s_waitcnt vmcnt(5)
    s_cmpk_ge_u32 s8, 1055
    s_cbranch_scc1 .ap_58
    s_waitcnt vmcnt(3)
    s_bitcmp1_b64 s[14:15], 25
    s_cbranch_scc0 1
    s_waitcnt vmcnt(2)
    s_cmpk_ge_u32 s8, 980
    s_cbranch_scc1 .ap_58
    s_waitcnt vmcnt(1)
.ap_58:
    s_add_u32 s63, s69, 401408
    buffer_load_dwordx4 v[60:63], v1, s[40:43], s63 offen nt
.Latt_ar:
    v_and_b32 v8, 1, v0
    v_lshlrev_b32 v8, 8, v8
    v_and_b32 v9, 0x3c, v0
    v_lshl_add_u32 v9, v9, 2, v8
    v_lshlrev_b32 v7, 1, v9
    v_and_b32 v9, 0x3c, v0
    v_lshrrev_b32 v8, 4, v8
    v_lshl_add_u32 v9, v9, 3, v8
    s_lshl_b32 s58, s66, 14
    s_lshl_b32 s59, s67, 10
    s_add_u32 s58, s58, s59
    s_add_u32 s58, s58, 0x40000
    s_lshl4_add_u32 s59, s66, s67
    s_lshl_b32 s59, s59, 9
    s_add_u32 s59, s59, 0x200000
    s_memrealtime s[8:9]
    s_waitcnt vmcnt(8)
    s_waitcnt lgkmcnt(0)
    s_sub_u32 s8, s8, s30
    s_cmpk_ge_u32 s8, 1147
    s_cbranch_scc1 .ap_59
    s_waitcnt vmcnt(5)
    s_cmpk_ge_u32 s8, 1082
    s_cbranch_scc1 .ap_59
    s_waitcnt vmcnt(3)
    s_bitcmp1_b64 s[14:15], 26
    s_cbranch_scc0 1
    s_waitcnt vmcnt(2)
    s_cmpk_ge_u32 s8, 1007
    s_cbranch_scc1 .ap_59
    s_waitcnt vmcnt(1)
.ap_59:
    s_add_u32 s63, s69, 409600
    buffer_load_dwordx4 v[88:91], v1, s[40:43], s63 offen nt
    s_memrealtime s[8:9]
    s_waitcnt vmcnt(8)
    s_waitcnt lgkmcnt(0)
    s_sub_u32 s8, s8, s30
    s_cmpk_ge_u32 s8, 1174
    s_cbranch_scc1 .ap_60
    s_waitcnt vmcnt(5)
    s_cmpk_ge_u32 s8, 1109
    s_cbranch_scc1 .ap_60
    s_waitcnt vmcnt(3)
    s_bitcmp1_b64 s[14:15], 27
    s_cbranch_scc0 1
    s_waitcnt vmcnt(2)
    s_cmpk_ge_u32 s8, 1034
    s_cbranch_scc1 .ap_60
    s_waitcnt vmcnt(1)
.ap_60:
    s_add_u32 s63, s69, 417792
    buffer_load_dwordx4 v[92:95], v1, s[40:43], s63 offen nt
    s_memrealtime s[8:9]
    s_waitcnt vmcnt(8)
    s_waitcnt lgkmcnt(0)
    s_sub_u32 s8, s8, s30
    s_cmpk_ge_u32 s8, 1201
    s_cbranch_scc1 .ap_61
    s_waitcnt vmcnt(5)
    s_cmpk_ge_u32 s8, 1136
    s_cbranch_scc1 .ap_61
    s_waitcnt vmcnt(3)
    s_bitcmp1_b64 s[14:15], 28
    s_cbranch_scc0 1
    s_waitcnt vmcnt(2)
    s_cmpk_ge_u32 s8, 1061
    s_cbranch_scc1 .ap_61
    s_waitcnt vmcnt(1)
.ap_61:
    s_add_u32 s63, s69, 425984
    buffer_load_dwordx4 v[120:123], v1, s[40:43], s63 offen nt
    s_memrealtime s[8:9]
    s_waitcnt vmcnt(8)
    s_waitcnt lgkmcnt(0)
    s_sub_u32 s8, s8, s30
    s_cmpk_ge_u32 s8, 1228
    s_cbranch_scc1 .ap_62
    s_waitcnt vmcnt(5)
    s_cmpk_ge_u32 s8, 1163
    s_cbranch_scc1 .ap_62
    s_waitcnt vmcnt(3)
    s_bitcmp1_b64 s[14:15], 29
    s_cbranch_scc0 1
    s_waitcnt vmcnt(2)
    s_cmpk_ge_u32 s8, 1088
    s_cbranch_scc1 .ap_62
    s_waitcnt vmcnt(1)
.ap_62:
    s_add_u32 s63, s69, 434176
    buffer_load_dwordx4 v[124:127], v1, s[40:43], s63 offen nt
    s_memrealtime s[8:9]
    s_waitcnt vmcnt(8)
    s_waitcnt lgkmcnt(0)
    s_sub_u32 s8, s8, s30
    s_cmpk_ge_u32 s8, 1255
    s_cbranch_scc1 .ap_63
    s_waitcnt vmcnt(5)
    s_cmpk_ge_u32 s8, 1190
    s_cbranch_scc1 .ap_63
    s_waitcnt vmcnt(3)
    s_bitcmp1_b64 s[14:15], 30
    s_cbranch_scc0 1
    s_waitcnt vmcnt(2)
    s_cmpk_ge_u32 s8, 1115
    s_cbranch_scc1 .ap_63
    s_waitcnt vmcnt(1)
.ap_63:
    s_add_u32 s63, s69, 442368
    buffer_load_dwordx4 v[152:155], v1, s[40:43], s63 offen nt
    s_memrealtime s[8:9]
    s_waitcnt vmcnt(8)
    s_waitcnt lgkmcnt(0)
    s_sub_u32 s8, s8, s30
    s_cmpk_ge_u32 s8, 1282
    s_cbranch_scc1 .ap_64
    s_waitcnt vmcnt(5)
    s_cmpk_ge_u32 s8, 1217
    s_cbranch_scc1 .ap_64
    s_waitcnt vmcnt(3)
    s_bitcmp1_b64 s[14:15], 31
    s_cbranch_scc0 1
    s_waitcnt vmcnt(2)
    s_cmpk_ge_u32 s8, 1142
    s_cbranch_scc1 .ap_64
    s_waitcnt vmcnt(1)
.ap_64:
    s_add_u32 s63, s69, 450560
    buffer_load_dwordx4 v[156:159], v1, s[40:43], s63 offen nt
    buffer_load_dwordx4 v[16:19], v7, s[36:39], s58 offen offset:0 sc1
    buffer_load_dwordx4 v[20:23], v7, s[36:39], s58 offen offset:16 sc1
    s_memrealtime s[8:9]
    s_waitcnt vmcnt(8)
    s_waitcnt lgkmcnt(0)
    s_sub_u32 s8, s8, s30
    s_cmpk_ge_u32 s8, 1309
    s_cbranch_scc1 .ap_65
    s_waitcnt vmcnt(5)
    s_cmpk_ge_u32 s8, 1244
    s_cbranch_scc1 .ap_65
    s_waitcnt vmcnt(3)
    s_bitcmp1_b64 s[14:15], 32
    s_cbranch_scc0 1
    s_waitcnt vmcnt(2)
    s_cmpk_ge_u32 s8, 1169
    s_cbranch_scc1 .ap_65
    s_waitcnt vmcnt(1)
.ap_65:
    s_add_u32 s63, s69, 0
    buffer_load_dwordx4 v[160:163], v2, s[44:47], s63 offen nt
    s_memrealtime s[8:9]
    s_waitcnt vmcnt(8)
    s_waitcnt lgkmcnt(0)
    s_sub_u32 s8, s8, s30
    s_cmpk_ge_u32 s8, 1336
    s_cbranch_scc1 .ap_66
    s_waitcnt vmcnt(5)
    s_cmpk_ge_u32 s8, 1271
    s_cbranch_scc1 .ap_66
    s_waitcnt vmcnt(3)
    s_bitcmp1_b64 s[14:15], 33
    s_cbranch_scc0 1
    s_waitcnt vmcnt(2)
    s_cmpk_ge_u32 s8, 1196
    s_cbranch_scc1 .ap_66
    s_waitcnt vmcnt(1)
.ap_66:
    s_add_u32 s63, s69, 8192
    buffer_load_dwordx4 v[164:167], v2, s[44:47], s63 offen nt
    s_memrealtime s[8:9]
    s_waitcnt vmcnt(8)
    s_waitcnt lgkmcnt(0)
    s_sub_u32 s8, s8, s30
    s_cmpk_ge_u32 s8, 1363
    s_cbranch_scc1 .ap_67
    s_waitcnt vmcnt(5)
    s_cmpk_ge_u32 s8, 1298
    s_cbranch_scc1 .ap_67
    s_waitcnt vmcnt(3)
    s_bitcmp1_b64 s[14:15], 34
    s_cbranch_scc0 1
    s_waitcnt vmcnt(2)
    s_cmpk_ge_u32 s8, 1223
    s_cbranch_scc1 .ap_67
    s_waitcnt vmcnt(1)
.ap_67:
    s_add_u32 s63, s69, 16384
    buffer_load_dwordx4 v[168:171], v2, s[44:47], s63 offen nt
    s_waitcnt vmcnt(3)
    s_branch .gpc_69
.gp_68:
    buffer_load_dwordx4 v[16:19], v7, s[36:39], s58 offen offset:0 sc1
    buffer_load_dwordx4 v[20:23], v7, s[36:39], s58 offen offset:16 sc1
    s_waitcnt vmcnt(0)
.gpc_69:
    v_min_u32 v10, v17, v19
    v_max_u32 v11, v17, v19
    v_min3_u32 v10, v10, v21, v23
    v_max3_u32 v11, v11, v21, v23
    v_cmp_eq_u32 vcc, s34, v10
    v_cmp_eq_u32 s[56:57], s34, v11
    s_and_b64 vcc, vcc, s[56:57]
    s_cmp_eq_u64 vcc, exec
    s_nop 2
    s_cbranch_scc1 .gpd_70
    s_sub_u32 s35, s35, 1
    s_cbranch_scc1 .Lexit
    s_sleep 1
    s_branch .gp_68
.gpd_70:
    s_mov_b32 vcc_lo, 0xcccccccc
    s_mov_b32 vcc_hi, 0xcccccccc
    v_cndmask_b32_e64 v24, v16, 0, vcc
    v_cndmask_b32_e64 v25, v18, 0, vcc
    v_cndmask_b32_e64 v26, v20, 0, vcc
    v_cndmask_b32_e64 v27, v22, 0, vcc
    v_cndmask_b32_e32 v28, 0, v16, vcc
    v_cndmask_b32_e32 v29, 0, v18, vcc
    v_cndmask_b32_e32 v30, 0, v20, vcc
    v_cndmask_b32_e32 v31, 0, v22, vcc
    v_mfma_f32_16x16x32_bf16 v[16:19], v[32:35], v[24:27], 0
    v_mfma_f32_16x16x32_bf16 v[32:35], v[40:43], v[24:27], 0
    v_mfma_f32_16x16x32_bf16 v[16:19], v[36:39], v[28:31], v[16:19]
    v_mfma_f32_16x16x32_bf16 v[40:43], v[48:51], v[24:27], 0
    v_mfma_f32_16x16x32_bf16 v[32:35], v[44:47], v[28:31], v[32:35]
    v_mfma_f32_16x16x32_bf16 v[48:51], v[56:59], v[24:27], 0
    v_mfma_f32_16x16x32_bf16 v[40:43], v[52:55], v[28:31], v[40:43]
    v_mfma_f32_16x16x32_bf16 v[56:59], v[64:67], v[24:27], 0
    v_mfma_f32_16x16x32_bf16 v[48:51], v[60:63], v[28:31], v[48:51]
    s_nop 1
    v_add_f32_dpp v10, v17, v16 row_ror:12 row_mask:0xf bank_mask:0x1
    s_memrealtime s[8:9]
    s_waitcnt lgkmcnt(0)
    s_sub_u32 s8, s8, s30
    s_cmpk_ge_u32 s8, 1390
    s_nop 0
    s_cbranch_scc1 .ap_71
    s_waitcnt vmcnt(3)
    s_cmpk_ge_u32 s8, 1325
    s_cbranch_scc1 .ap_71
    s_waitcnt vmcnt(3)
    s_bitcmp1_b64 s[14:15], 35
    s_cbranch_scc0 1
    s_waitcnt vmcnt(2)
    s_cmpk_ge_u32 s8, 1250
    s_cbranch_scc1 .ap_71
    s_waitcnt vmcnt(1)
.ap_71:
    s_add_u32 s63, s69, 24576
    buffer_load_dwordx4 v[172:175], v2, s[44:47], s63 offen nt
    v_mfma_f32_16x16x32_bf16 v[64:67], v[72:75], v[24:27], 0
    v_mfma_f32_16x16x32_bf16 v[56:59], v[68:71], v[28:31], v[56:59]
    v_add_f32_dpp v11, v33, v32 row_ror:12 row_mask:0xf bank_mask:0x1
    v_add_f32_dpp v10, v18, v10 row_ror:8 row_mask:0xf bank_mask:0x1
    v_mfma_f32_16x16x32_bf16 v[72:75], v[80:83], v[24:27], 0
    v_mfma_f32_16x16x32_bf16 v[64:67], v[76:79], v[28:31], v[64:67]
    v_add_f32_dpp v12, v41, v40 row_ror:12 row_mask:0xf bank_mask:0x1
    v_add_f32_dpp v11, v34, v11 row_ror:8 row_mask:0xf bank_mask:0x1
    v_add_f32_dpp v10, v19, v10 row_ror:4 row_mask:0xf bank_mask:0x1
    v_mfma_f32_16x16x32_bf16 v[80:83], v[88:91], v[24:27], 0
    v_mfma_f32_16x16x32_bf16 v[72:75], v[84:87], v[28:31], v[72:75]
    v_add_f32_dpp v13, v49, v48 row_ror:12 row_mask:0xf bank_mask:0x1
    v_add_f32_dpp v12, v42, v12 row_ror:8 row_mask:0xf bank_mask:0x1
    v_add_f32_dpp v11, v35, v11 row_ror:4 row_mask:0xf bank_mask:0x1
    v_mfma_f32_16x16x32_bf16 v[88:91], v[96:99], v[24:27], 0
    v_mfma_f32_16x16x32_bf16 v[80:83], v[92:95], v[28:31], v[80:83]
    v_add_f32_dpp v10, v58, v57 row_ror:12 row_mask:0xf bank_mask:0x2
    v_add_f32_dpp v13, v50, v13 row_ror:8 row_mask:0xf bank_mask:0x1
    v_add_f32_dpp v12, v43, v12 row_ror:4 row_mask:0xf bank_mask:0x1
    s_memrealtime s[8:9]
    s_waitcnt lgkmcnt(0)
    s_sub_u32 s8, s8, s30
    s_cmpk_ge_u32 s8, 1417
    s_nop 0
    s_cbranch_scc1 .ap_72
    s_waitcnt vmcnt(4)
    s_cmpk_ge_u32 s8, 1352
    s_cbranch_scc1 .ap_72
    s_waitcnt vmcnt(3)
    s_bitcmp1_b64 s[14:15], 36
    s_cbranch_scc0 1
    s_waitcnt vmcnt(2)
    s_cmpk_ge_u32 s8, 1277
    s_cbranch_scc1 .ap_72
    s_waitcnt vmcnt(1)
.ap_72:
    s_add_u32 s63, s69, 32768
    buffer_load_dwordx4 v[176:179], v2, s[44:47], s63 offen nt
    v_mfma_f32_16x16x32_bf16 v[96:99], v[104:107], v[24:27], 0
    v_mfma_f32_16x16x32_bf16 v[88:91], v[100:103], v[28:31], v[88:91]
    v_add_f32_dpp v11, v66, v65 row_ror:12 row_mask:0xf bank_mask:0x2
    v_add_f32_dpp v10, v59, v10 row_ror:8 row_mask:0xf bank_mask:0x2
    v_add_f32_dpp v13, v51, v13 row_ror:4 row_mask:0xf bank_mask:0x1
    v_mfma_f32_16x16x32_bf16 v[104:107], v[112:115], v[24:27], 0
    v_mfma_f32_16x16x32_bf16 v[96:99], v[108:111], v[28:31], v[96:99]
    v_add_f32_dpp v12, v74, v73 row_ror:12 row_mask:0xf bank_mask:0x2
    v_add_f32_dpp v11, v67, v11 row_ror:8 row_mask:0xf bank_mask:0x2
    v_add_f32_dpp v10, v56, v10 row_ror:4 row_mask:0xf bank_mask:0x2
    v_mfma_f32_16x16x32_bf16 v[112:115], v[120:123], v[24:27], 0
    v_mfma_f32_16x16x32_bf16 v[104:107], v[116:119], v[28:31], v[104:107]
    v_add_f32_dpp v13, v82, v81 row_ror:12 row_mask:0xf bank_mask:0x2
    v_add_f32_dpp v12, v75, v12 row_ror:8 row_mask:0xf bank_mask:0x2
    v_add_f32_dpp v11, v64, v11 row_ror:4 row_mask:0xf bank_mask:0x2
    v_mfma_f32_16x16x32_bf16 v[120:123], v[128:131], v[24:27], 0
    v_mfma_f32_16x16x32_bf16 v[112:115], v[124:127], v[28:31], v[112:115]
    v_add_f32_dpp v10, v91, v90 row_ror:12 row_mask:0xf bank_mask:0x4
    v_add_f32_dpp v13, v83, v13 row_ror:8 row_mask:0xf bank_mask:0x2
    v_add_f32_dpp v12, v72, v12 row_ror:4 row_mask:0xf bank_mask:0x2
    s_memrealtime s[8:9]
    s_waitcnt lgkmcnt(0)
    s_sub_u32 s8, s8, s30
    s_cmpk_ge_u32 s8, 1444
    s_nop 0
    s_cbranch_scc1 .ap_73
    s_waitcnt vmcnt(5)
    s_cmpk_ge_u32 s8, 1379
    s_cbranch_scc1 .ap_73
    s_waitcnt vmcnt(3)
    s_bitcmp1_b64 s[14:15], 37
    s_cbranch_scc0 1
    s_waitcnt vmcnt(2)
    s_cmpk_ge_u32 s8, 1304
    s_cbranch_scc1 .ap_73
    s_waitcnt vmcnt(1)
.ap_73:
    s_add_u32 s63, s69, 40960
    buffer_load_dwordx4 v[180:183], v2, s[44:47], s63 offen nt
    v_mfma_f32_16x16x32_bf16 v[128:131], v[136:139], v[24:27], 0
    v_mfma_f32_16x16x32_bf16 v[120:123], v[132:135], v[28:31], v[120:123]
    v_add_f32_dpp v11, v99, v98 row_ror:12 row_mask:0xf bank_mask:0x4
    v_add_f32_dpp v10, v88, v10 row_ror:8 row_mask:0xf bank_mask:0x4
    v_add_f32_dpp v13, v80, v13 row_ror:4 row_mask:0xf bank_mask:0x2
    v_mfma_f32_16x16x32_bf16 v[136:139], v[144:147], v[24:27], 0
    v_mfma_f32_16x16x32_bf16 v[128:131], v[140:143], v[28:31], v[128:131]
    v_add_f32_dpp v12, v107, v106 row_ror:12 row_mask:0xf bank_mask:0x4
    v_add_f32_dpp v11, v96, v11 row_ror:8 row_mask:0xf bank_mask:0x4
    v_add_f32_dpp v10, v89, v10 row_ror:4 row_mask:0xf bank_mask:0x4
    v_mfma_f32_16x16x32_bf16 v[144:147], v[152:155], v[24:27], 0
    v_mfma_f32_16x16x32_bf16 v[136:139], v[148:151], v[28:31], v[136:139]
    v_add_f32_dpp v13, v115, v114 row_ror:12 row_mask:0xf bank_mask:0x4
    v_add_f32_dpp v12, v104, v12 row_ror:8 row_mask:0xf bank_mask:0x4
    v_add_f32_dpp v11, v97, v11 row_ror:4 row_mask:0xf bank_mask:0x4
    v_mfma_f32_16x16x32_bf16 v[144:147], v[156:159], v[28:31], v[144:147]
    v_add_f32_dpp v10, v120, v123 row_ror:12 row_mask:0xf bank_mask:0x8
    v_add_f32_dpp v13, v112, v13 row_ror:8 row_mask:0xf bank_mask:0x4
    v_add_f32_dpp v12, v105, v12 row_ror:4 row_mask:0xf bank_mask:0x4
    s_memrealtime s[8:9]
    s_waitcnt lgkmcnt(0)
    s_sub_u32 s8, s8, s30
    s_cmpk_ge_u32 s8, 1471
    s_nop 0
    s_cbranch_scc1 .ap_74
    s_waitcnt vmcnt(5)
    s_cmpk_ge_u32 s8, 1406
    s_cbranch_scc1 .ap_74
    s_waitcnt vmcnt(3)
    s_bitcmp1_b64 s[14:15], 38
    s_cbranch_scc0 1
    s_waitcnt vmcnt(2)
    s_cmpk_ge_u32 s8, 1331
    s_cbranch_scc1 .ap_74
    s_waitcnt vmcnt(1)
.ap_74:
    s_add_u32 s63, s69, 49152
    buffer_load_dwordx4 v[184:187], v2, s[44:47], s63 offen nt
    v_add_f32_dpp v11, v128, v131 row_ror:12 row_mask:0xf bank_mask:0x8
    v_add_f32_dpp v10, v121, v10 row_ror:8 row_mask:0xf bank_mask:0x8
    v_add_f32_dpp v13, v113, v13 row_ror:4 row_mask:0xf bank_mask:0x4
    v_add_f32_dpp v12, v136, v139 row_ror:12 row_mask:0xf bank_mask:0x8
    v_add_f32_dpp v11, v129, v11 row_ror:8 row_mask:0xf bank_mask:0x8
    v_add_f32_dpp v10, v122, v10 row_ror:4 row_mask:0xf bank_mask:0x8
    v_add_f32_dpp v13, v144, v147 row_ror:12 row_mask:0xf bank_mask:0x8
    v_add_f32_dpp v12, v137, v12 row_ror:8 row_mask:0xf bank_mask:0x8
    v_add_f32_dpp v11, v130, v11 row_ror:4 row_mask:0xf bank_mask:0x8
    v_add_f32_dpp v13, v145, v13 row_ror:8 row_mask:0xf bank_mask:0x8
    v_add_f32_dpp v12, v138, v12 row_ror:4 row_mask:0xf bank_mask:0x8
    s_memrealtime s[8:9]
    s_waitcnt lgkmcnt(0)
    s_sub_u32 s8, s8, s30
    s_cmpk_ge_u32 s8, 1498
    s_cbranch_scc1 .ap_75
    s_waitcnt vmcnt(5)
    s_cmpk_ge_u32 s8, 1433
    s_cbranch_scc1 .ap_75
    s_waitcnt vmcnt(3)
    s_bitcmp1_b64 s[14:15], 39
    s_cbranch_scc0 1
    s_waitcnt vmcnt(2)
    s_cmpk_ge_u32 s8, 1358
    s_cbranch_scc1 .ap_75
    s_waitcnt vmcnt(1)
.ap_75:
    s_add_u32 s63, s69, 57344
    buffer_load_dwordx4 v[188:191], v2, s[44:47], s63 offen nt
    v_add_f32_dpp v13, v146, v13 row_ror:4 row_mask:0xf bank_mask:0x8
    s_mov_b32 s60, 0x3db504f3
    s_mov_b32 s61, 0x3db504f3
    v_cvt_pk_bf16_f32 v10, v10, v11
    v_and_b32 v11, 0xffff0000, v10
    v_lshlrev_b32 v10, 16, v10
    v_cvt_pk_bf16_f32 v12, v12, v13
    v_and_b32 v13, 0xffff0000, v12
    v_lshlrev_b32 v12, 16, v12
    v_pk_mul_f32 v[10:11], v[10:11], s[60:61]
    v_pk_mul_f32 v[12:13], v[12:13], s[60:61]
    v_cvt_pk_bf16_f32 v10, v10, v11
    v_and_b32 v11, 0xffff0000, v10
    v_lshlrev_b32 v10, 16, v10
    v_cvt_pk_bf16_f32 v12, v12, v13
    v_and_b32 v13, 0xffff0000, v12
    v_lshlrev_b32 v12, 16, v12
    v_max_f32 v14, v10, v11
    v_max3_f32 v14, v14, v12, v13
    s_mov_b32 s60, 0x3fb8aa3b
    v_mov_b32 v22, s34
    v_mov_b32 v23, s34
    v_max_f32_dpp v14, v14, v14 quad_perm:[2,3,0,1] row_mask:0xf bank_mask:0xf
    s_nop 1
    v_max_f32_dpp v14, v14, v14 row_ror:4 row_mask:0xf bank_mask:0xf
    s_nop 1
    v_max_f32_dpp v14, v14, v14 row_ror:8 row_mask:0xf bank_mask:0xf
    v_mov_b32 v15, v14
    s_nop 1
    v_permlane16_swap_b32 v15, v14
    v_max_f32 v14, v15, v14
    v_mov_b32 v15, v14
    s_nop 1
    v_permlane32_swap_b32 v15, v14
    v_max_f32 v14, v15, v14
    v_mul_f32 v15, 0xbfb8aa3b, v14
    v_fma_f32 v10, v10, s60, v15
    v_fma_f32 v11, v11, s60, v15
    v_fma_f32 v12, v12, s60, v15
    v_fma_f32 v13, v13, s60, v15
    v_exp_f32 v10, v10
    v_exp_f32 v11, v11
    v_exp_f32 v12, v12
    v_exp_f32 v13, v13
    v_mov_b32 v20, v14
    v_pk_add_f32 v[16:17], v[10:11], v[12:13]
    v_add_f32 v21, v16, v17
    s_lshl3_add_u32 s60, s68, s3
    s_lshl_b32 s60, s60, 5
    s_add_u32 s60, s60, s59
    v_add_f32_dpp v21, v21, v21 quad_perm:[2,3,0,1] row_mask:0xf bank_mask:0xf
    s_nop 1
    v_add_f32_dpp v21, v21, v21 row_ror:4 row_mask:0xf bank_mask:0xf
    s_nop 1
    v_add_f32_dpp v21, v21, v21 row_ror:8 row_mask:0xf bank_mask:0xf
    v_mov_b32 v15, v21
    s_nop 1
    v_permlane16_swap_b32 v15, v21
    v_add_f32 v21, v15, v21
    v_mov_b32 v15, v21
    s_nop 1
    v_permlane32_swap_b32 v15, v21
    v_add_f32 v21, v15, v21
    s_mov_b64 exec, 3
    buffer_store_dwordx4 v[20:23], v2, s[36:39], s60 offen sc1
    s_mov_b64 exec, -1
    s_memrealtime s[8:9]
    s_waitcnt vmcnt(8)
    s_waitcnt lgkmcnt(0)
    s_sub_u32 s8, s8, s30
    s_cmpk_ge_u32 s8, 1525
    s_cbranch_scc1 .ap_76
    s_waitcnt vmcnt(5)
    s_cmpk_ge_u32 s8, 1460
    s_cbranch_scc1 .ap_76
    s_waitcnt vmcnt(3)
    s_bitcmp1_b64 s[14:15], 40
    s_cbranch_scc0 1
    s_waitcnt vmcnt(2)
    s_cmpk_ge_u32 s8, 1385
    s_cbranch_scc1 .ap_76
    s_waitcnt vmcnt(1)
.ap_76:
    s_add_u32 s63, s69, 131072
    buffer_load_dwordx4 v[192:195], v2, s[44:47], s63 offen nt
    s_memrealtime s[8:9]
    s_waitcnt vmcnt(8)
    s_waitcnt lgkmcnt(0)
    s_sub_u32 s8, s8, s30
    s_cmpk_ge_u32 s8, 1552
    s_cbranch_scc1 .ap_77
    s_waitcnt vmcnt(5)
    s_cmpk_ge_u32 s8, 1487
    s_cbranch_scc1 .ap_77
    s_waitcnt vmcnt(3)
    s_bitcmp1_b64 s[14:15], 41
    s_cbranch_scc0 1
    s_waitcnt vmcnt(2)
    s_cmpk_ge_u32 s8, 1412
    s_cbranch_scc1 .ap_77
    s_waitcnt vmcnt(1)
.ap_77:
    s_add_u32 s63, s69, 139264
    buffer_load_dwordx4 v[196:199], v2, s[44:47], s63 offen nt
    s_memrealtime s[8:9]
    s_waitcnt vmcnt(8)
    s_waitcnt lgkmcnt(0)
    s_sub_u32 s8, s8, s30
    s_cmpk_ge_u32 s8, 1579
    s_cbranch_scc1 .ap_78
    s_waitcnt vmcnt(5)
    s_cmpk_ge_u32 s8, 1514
    s_cbranch_scc1 .ap_78
    s_waitcnt vmcnt(3)
    s_bitcmp1_b64 s[14:15], 42
    s_cbranch_scc0 1
    s_waitcnt vmcnt(2)
    s_cmpk_ge_u32 s8, 1439
    s_cbranch_scc1 .ap_78
    s_waitcnt vmcnt(1)
.ap_78:
    s_add_u32 s63, s69, 147456
    buffer_load_dwordx4 v[200:203], v2, s[44:47], s63 offen nt
    s_memrealtime s[8:9]
    s_waitcnt vmcnt(8)
    s_waitcnt lgkmcnt(0)
    s_sub_u32 s8, s8, s30
    s_cmpk_ge_u32 s8, 1606
    s_cbranch_scc1 .ap_79
    s_waitcnt vmcnt(5)
    s_cmpk_ge_u32 s8, 1541
    s_cbranch_scc1 .ap_79
    s_waitcnt vmcnt(3)
    s_bitcmp1_b64 s[14:15], 43
    s_cbranch_scc0 1
    s_waitcnt vmcnt(2)
    s_cmpk_ge_u32 s8, 1466
    s_cbranch_scc1 .ap_79
    s_waitcnt vmcnt(1)
.ap_79:
    s_add_u32 s63, s69, 155648
    buffer_load_dwordx4 v[204:207], v2, s[44:47], s63 offen nt
    s_memrealtime s[8:9]
    s_waitcnt vmcnt(8)
    s_waitcnt lgkmcnt(0)
    s_sub_u32 s8, s8, s30
    s_cmpk_ge_u32 s8, 1633
    s_cbranch_scc1 .ap_80
    s_waitcnt vmcnt(5)
    s_cmpk_ge_u32 s8, 1568
    s_cbranch_scc1 .ap_80
    s_waitcnt vmcnt(3)
    s_bitcmp1_b64 s[14:15], 44
    s_cbranch_scc0 1
    s_waitcnt vmcnt(2)
    s_cmpk_ge_u32 s8, 1493
    s_cbranch_scc1 .ap_80
    s_waitcnt vmcnt(1)
.ap_80:
    s_add_u32 s63, s69, 163840
    buffer_load_dwordx4 v[208:211], v2, s[44:47], s63 offen nt
    v_and_b32 v16, 15, v0
    v_lshrrev_b32 v17, 4, v0
    v_lshl_add_u32 v16, v16, 2, v17
    v_lshlrev_b32 v31, 1, v16
    s_lshl_b32 s56, s65, 7
    v_add_u32 v31, s56, v31
    v_and_b32 v6, -4, v31
    v_lshlrev_b32 v6, 1, v6
    s_mul_i32 s56, s3, 1152
    s_mov_b32 s52, s4
    s_and_b32 s53, s5, 0xffff
    s_mov_b32 s54, 0x2400
    s_mov_b32 s55, 0x00020000
    buffer_load_ushort v29, v31, s[52:55], s56 offen
    s_mul_i32 s101, s3, 2304
    s_add_u32 s101, s101, 0x15000
    s_add_u32 s99, s101, 36864
    s_add_u32 s100, s101, 73728
    s_add_u32 s33, s101, 110592
    buffer_load_dwordx2 v[72:73], v6, s[36:39], s101 offen offset:0
    s_cmp_lg_u32 s3, s64
    s_cbranch_scc1 .rin_81
    buffer_load_dwordx4 v[32:35], v2, s[36:39], s99 offen offset:0
    buffer_load_dwordx4 v[40:43], v2, s[36:39], s99 offen offset:1024
    buffer_load_dwordx2 v[48:49], v5, s[36:39], s99 offen offset:0
    buffer_load_dwordx4 v[56:59], v2, s[36:39], s100 offen offset:0
    buffer_load_dwordx4 v[64:67], v2, s[36:39], s100 offen offset:1024
    buffer_load_dwordx2 v[50:51], v5, s[36:39], s100 offen offset:0
    buffer_load_dwordx2 v[74:75], v6, s[36:39], s99 offen offset:0
    buffer_load_dwordx2 v[80:81], v6, s[36:39], s100 offen offset:0
    buffer_load_dwordx2 v[82:83], v6, s[36:39], s33 offen offset:0
    s_mov_b32 s48, s16
    s_and_b32 s49, s17, 0xffff
    s_mov_b32 s50, 0x480
    s_mov_b32 s51, 0x00020000
    buffer_load_dwordx2 v[88:89], v3, s[48:51], 0 offen
    buffer_load_dwordx2 v[90:91], v3, s[48:51], 0 offen offset:512
    buffer_load_dword v30, v4, s[48:51], 0 offen
    s_mov_b32 s48, s28
    s_and_b32 s49, s29, 0xffff
    s_mov_b32 s50, 0x2400
    s_mov_b32 s51, 0x00020000
    buffer_load_ushort v17, v31, s[48:51], s56 offen nt
.rin_81:
    s_memrealtime s[8:9]
    s_waitcnt vmcnt(10)
    s_waitcnt lgkmcnt(0)
    s_sub_u32 s8, s8, s30
    s_cmpk_ge_u32 s8, 1660
    s_cbranch_scc1 .ap_82
    s_waitcnt vmcnt(7)
    s_cmpk_ge_u32 s8, 1595
    s_cbranch_scc1 .ap_82
    s_waitcnt vmcnt(5)
    s_bitcmp1_b64 s[14:15], 45
    s_cbranch_scc0 1
    s_waitcnt vmcnt(4)
    s_cmpk_ge_u32 s8, 1520
    s_cbranch_scc1 .ap_82
    s_waitcnt vmcnt(3)
.ap_82:
    s_add_u32 s63, s69, 172032
    buffer_load_dwordx4 v[212:215], v2, s[44:47], s63 offen nt
    s_memrealtime s[8:9]
    s_waitcnt vmcnt(10)
    s_waitcnt lgkmcnt(0)
    s_sub_u32 s8, s8, s30
    s_cmpk_ge_u32 s8, 1691
    s_cbranch_scc1 .ap_83
    s_waitcnt vmcnt(7)
    s_cmpk_ge_u32 s8, 1626
    s_cbranch_scc1 .ap_83
    s_waitcnt vmcnt(5)
    s_bitcmp1_b64 s[14:15], 46
    s_cbranch_scc0 1
    s_waitcnt vmcnt(4)
    s_cmpk_ge_u32 s8, 1551
    s_cbranch_scc1 .ap_83
    s_waitcnt vmcnt(3)
.ap_83:
    s_add_u32 s63, s69, 180224
    buffer_load_dwordx4 v[216:219], v2, s[44:47], s63 offen nt
    s_memrealtime s[8:9]
    s_waitcnt vmcnt(10)
    s_waitcnt lgkmcnt(0)
    s_sub_u32 s8, s8, s30
    s_cmpk_ge_u32 s8, 1722
    s_cbranch_scc1 .ap_84
    s_waitcnt vmcnt(7)
    s_cmpk_ge_u32 s8, 1657
    s_cbranch_scc1 .ap_84
    s_waitcnt vmcnt(5)
    s_bitcmp1_b64 s[14:15], 47
    s_cbranch_scc0 1
    s_waitcnt vmcnt(4)
    s_cmpk_ge_u32 s8, 1582
    s_cbranch_scc1 .ap_84
    s_waitcnt vmcnt(1)
.ap_84:
    s_add_u32 s63, s69, 188416
    buffer_load_dwordx4 v[220:223], v2, s[44:47], s63 offen nt
    s_memrealtime s[8:9]
    s_waitcnt vmcnt(10)
    s_waitcnt lgkmcnt(0)
    s_sub_u32 s8, s8, s30
    s_cmpk_ge_u32 s8, 1753
    s_cbranch_scc1 .ap_85
    s_waitcnt vmcnt(7)
    s_cmpk_ge_u32 s8, 1688
    s_cbranch_scc1 .ap_85
    s_waitcnt vmcnt(5)
    s_bitcmp1_b64 s[14:15], 48
    s_cbranch_scc0 1
    s_waitcnt vmcnt(2)
    s_cmpk_ge_u32 s8, 1613
    s_cbranch_scc1 .ap_85
    s_waitcnt vmcnt(1)
.ap_85:
    s_add_u32 s63, s69, 262144
    buffer_load_dwordx4 v[224:227], v2, s[44:47], s63 offen nt
    s_memrealtime s[8:9]
    s_waitcnt vmcnt(10)
    s_waitcnt lgkmcnt(0)
    s_sub_u32 s8, s8, s30
    s_cmpk_ge_u32 s8, 1784
    s_cbranch_scc1 .ap_86
    s_waitcnt vmcnt(7)
    s_cmpk_ge_u32 s8, 1719
    s_cbranch_scc1 .ap_86
    s_waitcnt vmcnt(3)
    s_bitcmp1_b64 s[14:15], 49
    s_cbranch_scc0 1
    s_waitcnt vmcnt(2)
    s_cmpk_ge_u32 s8, 1644
    s_cbranch_scc1 .ap_86
    s_waitcnt vmcnt(1)
.ap_86:
    s_add_u32 s63, s69, 270336
    buffer_load_dwordx4 v[228:231], v2, s[44:47], s63 offen nt
    s_memrealtime s[8:9]
    s_waitcnt vmcnt(10)
    s_waitcnt lgkmcnt(0)
    s_sub_u32 s8, s8, s30
    s_cmpk_ge_u32 s8, 1815
    s_cbranch_scc1 .ap_87
    s_waitcnt vmcnt(7)
    s_cmpk_ge_u32 s8, 1750
    s_cbranch_scc1 .ap_87
    s_waitcnt vmcnt(3)
    s_bitcmp1_b64 s[14:15], 50
    s_cbranch_scc0 1
    s_waitcnt vmcnt(2)
    s_cmpk_ge_u32 s8, 1675
    s_cbranch_scc1 .ap_87
    s_waitcnt vmcnt(1)
.ap_87:
    s_add_u32 s63, s69, 278528
    buffer_load_dwordx4 v[232:235], v2, s[44:47], s63 offen nt
    s_memrealtime s[8:9]
    s_waitcnt vmcnt(10)
    s_waitcnt lgkmcnt(0)
    s_sub_u32 s8, s8, s30
    s_cmpk_ge_u32 s8, 1846
    s_cbranch_scc1 .ap_88
    s_waitcnt vmcnt(5)
    s_cmpk_ge_u32 s8, 1781
    s_cbranch_scc1 .ap_88
    s_waitcnt vmcnt(3)
    s_bitcmp1_b64 s[14:15], 51
    s_cbranch_scc0 1
    s_waitcnt vmcnt(2)
    s_cmpk_ge_u32 s8, 1706
    s_cbranch_scc1 .ap_88
    s_waitcnt vmcnt(1)
.ap_88:
    s_add_u32 s63, s69, 286720
    buffer_load_dwordx4 v[236:239], v2, s[44:47], s63 offen nt
    s_memrealtime s[8:9]
    s_waitcnt vmcnt(10)
    s_waitcnt lgkmcnt(0)
    s_sub_u32 s8, s8, s30
    s_cmpk_ge_u32 s8, 1877
    s_cbranch_scc1 .ap_89
    s_waitcnt vmcnt(5)
    s_cmpk_ge_u32 s8, 1812
    s_cbranch_scc1 .ap_89
    s_waitcnt vmcnt(3)
    s_bitcmp1_b64 s[14:15], 52
    s_cbranch_scc0 1
    s_waitcnt vmcnt(2)
    s_cmpk_ge_u32 s8, 1737
    s_cbranch_scc1 .ap_89
    s_waitcnt vmcnt(1)
.ap_89:
    s_add_u32 s63, s69, 294912
    buffer_load_dwordx4 v[240:243], v2, s[44:47], s63 offen nt
    s_memrealtime s[8:9]
    s_waitcnt vmcnt(10)
    s_waitcnt lgkmcnt(0)
    s_sub_u32 s8, s8, s30
    s_cmpk_ge_u32 s8, 1908
    s_cbranch_scc1 .ap_90
    s_waitcnt vmcnt(5)
    s_cmpk_ge_u32 s8, 1843
    s_cbranch_scc1 .ap_90
    s_waitcnt vmcnt(3)
    s_bitcmp1_b64 s[14:15], 53
    s_cbranch_scc0 1
    s_waitcnt vmcnt(2)
    s_cmpk_ge_u32 s8, 1768
    s_cbranch_scc1 .ap_90
    s_waitcnt vmcnt(1)
.ap_90:
    s_add_u32 s63, s69, 303104
    buffer_load_dwordx4 v[244:247], v2, s[44:47], s63 offen nt
    s_and_b32 s0, s0, 0xffffff80
    s_sub_u32 s0, s0, 1024
    buffer_load_dword v28, v4, s[36:39], s0 offen sc1
    buffer_load_dwordx4 v[24:27], v9, s[36:39], s59 offen offset:0 sc1
    s_memrealtime s[8:9]
    s_waitcnt vmcnt(9)
    s_waitcnt lgkmcnt(0)
    s_sub_u32 s8, s8, s30
    s_cmpk_ge_u32 s8, 1939
    s_cbranch_scc1 .ap_91
    s_waitcnt vmcnt(6)
    s_cmpk_ge_u32 s8, 1874
    s_cbranch_scc1 .ap_91
    s_waitcnt vmcnt(4)
    s_bitcmp1_b64 s[14:15], 54
    s_cbranch_scc0 1
    s_waitcnt vmcnt(3)
    s_cmpk_ge_u32 s8, 1799
    s_cbranch_scc1 .ap_91
    s_waitcnt vmcnt(2)
.ap_91:
    s_add_u32 s63, s69, 311296
    buffer_load_dwordx4 v[248:251], v2, s[44:47], s63 offen nt
    s_memrealtime s[8:9]
    s_waitcnt vmcnt(9)
    s_waitcnt lgkmcnt(0)
    s_sub_u32 s8, s8, s30
    s_cmpk_ge_u32 s8, 1970
    s_cbranch_scc1 .ap_92
    s_waitcnt vmcnt(6)
    s_cmpk_ge_u32 s8, 1905
    s_cbranch_scc1 .ap_92
    s_waitcnt vmcnt(4)
    s_bitcmp1_b64 s[14:15], 55
    s_cbranch_scc0 1
    s_waitcnt vmcnt(3)
    s_cmpk_ge_u32 s8, 1830
    s_cbranch_scc1 .ap_92
    s_waitcnt vmcnt(1)
.ap_92:
    s_add_u32 s63, s69, 319488
    buffer_load_dwordx4 v[252:255], v2, s[44:47], s63 offen nt
    s_memrealtime s[8:9]
    s_waitcnt vmcnt(9)
    s_waitcnt lgkmcnt(0)
    s_sub_u32 s8, s8, s30
    s_cmpk_ge_u32 s8, 2001
    s_cbranch_scc1 .ap_93
    s_waitcnt vmcnt(6)
    s_cmpk_ge_u32 s8, 1936
    s_cbranch_scc1 .ap_93
    s_waitcnt vmcnt(4)
    s_bitcmp1_b64 s[14:15], 56
    s_cbranch_scc0 1
    s_waitcnt vmcnt(2)
    s_cmpk_ge_u32 s8, 1861
    s_cbranch_scc1 .ap_93
    s_waitcnt vmcnt(1)
.ap_93:
    s_add_u32 s63, s69, 393216
    buffer_load_dwordx4 v[36:39], v2, s[44:47], s63 offen nt
    s_memrealtime s[8:9]
    s_waitcnt vmcnt(9)
    s_waitcnt lgkmcnt(0)
    s_sub_u32 s8, s8, s30
    s_cmpk_ge_u32 s8, 2032
    s_cbranch_scc1 .ap_94
    s_waitcnt vmcnt(6)
    s_cmpk_ge_u32 s8, 1967
    s_cbranch_scc1 .ap_94
    s_waitcnt vmcnt(3)
    s_bitcmp1_b64 s[14:15], 57
    s_cbranch_scc0 1
    s_waitcnt vmcnt(2)
    s_cmpk_ge_u32 s8, 1892
    s_cbranch_scc1 .ap_94
    s_waitcnt vmcnt(1)
.ap_94:
    s_add_u32 s63, s69, 401408
    buffer_load_dwordx4 v[44:47], v2, s[44:47], s63 offen nt
    s_memrealtime s[8:9]
    s_waitcnt vmcnt(9)
    s_waitcnt lgkmcnt(0)
    s_sub_u32 s8, s8, s30
    s_cmpk_ge_u32 s8, 2063
    s_cbranch_scc1 .ap_95
    s_waitcnt vmcnt(6)
    s_cmpk_ge_u32 s8, 1998
    s_cbranch_scc1 .ap_95
    s_waitcnt vmcnt(3)
    s_bitcmp1_b64 s[14:15], 58
    s_cbranch_scc0 1
    s_waitcnt vmcnt(2)
    s_cmpk_ge_u32 s8, 1923
    s_cbranch_scc1 .ap_95
    s_waitcnt vmcnt(1)
.ap_95:
    s_add_u32 s63, s69, 409600
    buffer_load_dwordx4 v[52:55], v2, s[44:47], s63 offen nt
    s_waitcnt vmcnt(5)
    s_branch .gpc_97
.gp_96:
    buffer_load_dwordx4 v[24:27], v9, s[36:39], s59 offen offset:0 sc1
    s_waitcnt vmcnt(0)
.gpc_97:
    v_cmp_eq_u32 vcc, s34, v26
    s_cmp_eq_u64 vcc, exec
    s_nop 3
    s_cbranch_scc1 .gpd_98
    s_sub_u32 s35, s35, 1
    s_cbranch_scc1 .Lexit
    s_sleep 1
    s_branch .gp_96
.gpd_98:
    v_cmp_eq_u32 vcc, s1, v28
    s_cmp_eq_u64 vcc, -1
    s_cselect_b32 s0, 0xac000, 0
    v_mov_b32 v16, v24
    s_nop 1
    v_max_f32_dpp v16, v16, v16 row_ror:8 row_mask:0xf bank_mask:0xf
    s_nop 1
    v_max_f32_dpp v16, v16, v16 row_ror:4 row_mask:0xf bank_mask:0xf
    v_mov_b32 v17, v16
    s_nop 1
    v_permlane16_swap_b32 v17, v16
    v_max_f32 v16, v17, v16
    v_mov_b32 v17, v16
    s_nop 1
    v_permlane32_swap_b32 v17, v16
    v_max_f32 v16, v17, v16
    v_sub_f32 v17, v24, v16
    v_sub_f32 v18, v14, v16
    v_mul_f32 v17, 0x3fb8aa3b, v17
    v_mul_f32 v18, 0x3fb8aa3b, v18
    v_exp_f32 v17, v17
    v_exp_f32 v18, v18
    v_mul_f32 v17, v17, v25
    s_nop 1
    v_add_f32_dpp v17, v17, v17 row_ror:8 row_mask:0xf bank_mask:0xf
    s_nop 1
    v_add_f32_dpp v17, v17, v17 row_ror:4 row_mask:0xf bank_mask:0xf
    v_mov_b32 v19, v17
    s_nop 1
    v_permlane16_swap_b32 v19, v17
    v_add_f32 v17, v19, v17
    v_mov_b32 v19, v17
    s_nop 1
    v_permlane32_swap_b32 v19, v17
    v_add_f32 v17, v19, v17
    v_rcp_f32 v19, v17
    s_nop 0
    v_fma_f32 v15, -v17, v19, 1.0
    v_fma_f32 v19, v15, v19, v19
    v_mul_f32 v18, v18, v19
    v_mul_f32 v10, v10, v18
    v_mul_f32 v11, v11, v18
    v_mul_f32 v12, v12, v18
    v_mul_f32 v13, v13, v18
    v_mov_b32_dpp v112, v10 quad_perm:[2,3,0,1] row_mask:0xf bank_mask:0xf
    v_mov_b32_dpp v113, v11 quad_perm:[2,3,0,1] row_mask:0xf bank_mask:0xf
    v_mov_b32_dpp v114, v12 quad_perm:[2,3,0,1] row_mask:0xf bank_mask:0xf
    v_mov_b32_dpp v115, v13 quad_perm:[2,3,0,1] row_mask:0xf bank_mask:0xf
    v_cvt_pk_bf16_f32 v96, v10, v112
    v_cvt_pk_bf16_f32 v100, v11, v113
    v_cvt_pk_bf16_f32 v104, v12, v114
    v_cvt_pk_bf16_f32 v108, v13, v115
    v_mov_b32_dpp v97, v96 row_ror:12 row_mask:0xf bank_mask:0xf
    v_mov_b32_dpp v101, v100 row_ror:12 row_mask:0xf bank_mask:0xf
    v_mov_b32_dpp v105, v104 row_ror:12 row_mask:0xf bank_mask:0xf
    v_mov_b32_dpp v109, v108 row_ror:12 row_mask:0xf bank_mask:0xf
    v_mov_b32_dpp v98, v96 row_ror:8 row_mask:0xf bank_mask:0xf
    v_mov_b32_dpp v102, v100 row_ror:8 row_mask:0xf bank_mask:0xf
    v_mov_b32_dpp v106, v104 row_ror:8 row_mask:0xf bank_mask:0xf
    v_mov_b32_dpp v110, v108 row_ror:8 row_mask:0xf bank_mask:0xf
    v_mov_b32_dpp v99, v96 row_ror:4 row_mask:0xf bank_mask:0xf
    v_mov_b32_dpp v103, v100 row_ror:4 row_mask:0xf bank_mask:0xf
    v_mov_b32_dpp v107, v104 row_ror:4 row_mask:0xf bank_mask:0xf
    v_mov_b32_dpp v111, v108 row_ror:4 row_mask:0xf bank_mask:0xf
    s_memrealtime s[8:9]
    s_waitcnt lgkmcnt(0)
    s_sub_u32 s8, s8, s30
    s_cmpk_ge_u32 s8, 2094
    s_cbranch_scc1 .ap_99
    s_waitcnt vmcnt(5)
    s_cmpk_ge_u32 s8, 2029
    s_cbranch_scc1 .ap_99
    s_waitcnt vmcnt(3)
    s_bitcmp1_b64 s[14:15], 59
    s_cbranch_scc0 1
    s_waitcnt vmcnt(2)
    s_cmpk_ge_u32 s8, 1954
    s_cbranch_scc1 .ap_99
    s_waitcnt vmcnt(1)
.ap_99:
    s_add_u32 s63, s69, 417792
    buffer_load_dwordx4 v[60:63], v2, s[44:47], s63 offen nt
    s_lshl_b32 s60, s3, 10
    s_add_u32 s60, s60, 132096
    v_lshlrev_b32 v10, 5, v0
    v_add_u32 v10, s60, v10
    v_lshrrev_b32 v11, 5, v0
    v_lshlrev_b32 v11, 13, v11
    v_and_b32 v12, 31, v0
    v_lshl_add_u32 v11, v12, 4, v11
    v_add_u32 v9, 132096, v2
    v_mov_b32 v15, s34
    v_lshrrev_b32 v25, 4, v0
    v_bfe_u32 v26, v0, 2, 2
    v_lshl_add_u32 v16, v25, 3, v26
    v_lshlrev_b32 v16, 7, v16
    v_and_b32 v25, 1, v25
    v_lshrrev_b32 v26, 1, v26
    v_lshl_add_u32 v25, v25, 1, v26
    s_and_b32 s56, s3, 1
    s_lshl_b32 s56, s56, 1
    v_xor_b32 v25, s56, v25
    v_and_b32 v26, 3, v0
    v_lshl_add_u32 v16, v26, 3, v16
    s_lshr_b32 s56, s3, 1
    s_mul_i32 s56, s56, 16384
    v_add_u32 v16, s56, v16
    v_xor_b32 v26, 1, v25
    v_lshl_add_u32 v17, v26, 5, v16
    v_lshl_add_u32 v16, v25, 5, v16
    v_bfe_u32 v25, v0, 1, 3
    v_mul_u32_u24 v19, 1312, v25
    v_mul_u32_u24 v20, 272, v25
    v_and_b32 v25, 48, v0
    s_lshr_b32 s56, s3, 1
    s_mul_i32 s57, s56, 256
    s_add_u32 s57, s57, 147456
    v_add3_u32 v19, v19, v25, s57
    s_mul_i32 s56, s56, 2176
    s_and_b32 s57, s3, 1
    s_lshl_b32 s57, s57, 7
    s_add_u32 s56, s56, s57
    s_add_u32 s56, s56, 122880
    v_add3_u32 v20, v20, v25, s56
    v_and_b32 v25, 1, v0
    v_lshl_add_u32 v20, v25, 6, v20
    v_and_b32 v25, 15, v0
    s_mul_i32 s56, s3, 272
    s_add_u32 s56, s56, 122880
    v_lshl_add_u32 v21, v25, 4, s56
    v_and_b32 v18, 31, v0
    v_lshlrev_b32 v18, 3, v18
    v_lshrrev_b32 v25, 5, v0
    v_lshl_add_u32 v18, v25, 2, v18
    s_mul_i32 s56, s3, 1312
    s_add_u32 s56, s56, 147456
    v_add_u32 v18, s56, v18
    v_add_u32 v7, 8192, v2
    v_add_u32 v8, 16384, v2
    v_add_u32 v22, 24576, v2
    s_nop 1
    s_branch .gpc_101
.gp_100:
    buffer_load_dwordx2 v[72:73], v6, s[36:39], s101 offen offset:0 sc1
    s_waitcnt vmcnt(0)
.gpc_101:
    v_cmp_eq_u32 vcc, s34, v73
    s_cmp_eq_u64 vcc, exec
    s_nop 3
    s_cbranch_scc1 .gpd_102
    s_sub_u32 s35, s35, 1
    s_cbranch_scc1 .Lexit
    s_sleep 2
    s_branch .gp_100
.gpd_102:
    v_lshlrev_b32 v23, 16, v72
    v_and_b32 v72, 0xffff0000, v72
    s_mov_b32 vcc_lo, 0xffff0000
    s_mov_b32 vcc_hi, 0xffff0000
    v_cndmask_b32 v23, v23, v72, vcc
    v_lshlrev_b32 v29, 16, v29
    s_memrealtime s[8:9]
    s_waitcnt lgkmcnt(0)
    s_sub_u32 s8, s8, s30
    s_cmpk_ge_u32 s8, 2125
    s_cbranch_scc1 .ap_103
    s_waitcnt vmcnt(5)
    s_cmpk_ge_u32 s8, 2060
    s_cbranch_scc1 .ap_103
    s_waitcnt vmcnt(3)
    s_bitcmp1_b64 s[14:15], 60
    s_cbranch_scc0 1
    s_waitcnt vmcnt(2)
    s_cmpk_ge_u32 s8, 1985
    s_cbranch_scc1 .ap_103
    s_waitcnt vmcnt(1)
.ap_103:
    s_add_u32 s63, s69, 425984
    buffer_load_dwordx4 v[68:71], v2, s[44:47], s63 offen nt
    v_perm_b32 v112, v164, v160, s94
    v_perm_b32 v113, v172, v168, s94
    v_perm_b32 v114, v180, v176, s94
    v_perm_b32 v115, v188, v184, s94
    s_nop 1
    v_mfma_f32_16x16x32_bf16 v[128:131], v[96:99], v[112:115], 0
    v_perm_b32 v116, v164, v160, s95
    v_perm_b32 v117, v172, v168, s95
    v_perm_b32 v118, v180, v176, s95
    v_perm_b32 v119, v188, v184, s95
    s_nop 1
    v_mfma_f32_16x16x32_bf16 v[132:135], v[96:99], v[116:119], 0
    v_perm_b32 v120, v165, v161, s94
    v_perm_b32 v121, v173, v169, s94
    v_perm_b32 v122, v181, v177, s94
    v_perm_b32 v123, v189, v185, s94
    s_nop 1
    v_mfma_f32_16x16x32_bf16 v[136:139], v[96:99], v[120:123], 0
    v_perm_b32 v124, v165, v161, s95
    v_perm_b32 v125, v173, v169, s95
    v_perm_b32 v126, v181, v177, s95
    v_perm_b32 v127, v189, v185, s95
    s_nop 1
    v_mfma_f32_16x16x32_bf16 v[140:143], v[96:99], v[124:127], 0
    v_perm_b32 v112, v166, v162, s94
    v_perm_b32 v113, v174, v170, s94
    v_perm_b32 v114, v182, v178, s94
    v_perm_b32 v115, v190, v186, s94
    s_nop 1
    v_mfma_f32_16x16x32_bf16 v[144:147], v[96:99], v[112:115], 0
    v_perm_b32 v116, v166, v162, s95
    v_perm_b32 v117, v174, v170, s95
    v_perm_b32 v118, v182, v178, s95
    v_perm_b32 v119, v190, v186, s95
    s_nop 1
    v_mfma_f32_16x16x32_bf16 v[148:151], v[96:99], v[116:119], 0
    v_perm_b32 v120, v167, v163, s94
    v_perm_b32 v121, v175, v171, s94
    v_perm_b32 v122, v183, v179, s94
    v_perm_b32 v123, v191, v187, s94
    s_nop 1
    v_mfma_f32_16x16x32_bf16 v[152:155], v[96:99], v[120:123], 0
    v_perm_b32 v124, v167, v163, s95
    v_perm_b32 v125, v175, v171, s95
    v_perm_b32 v126, v183, v179, s95
    v_perm_b32 v127, v191, v187, s95
    s_nop 1
    v_mfma_f32_16x16x32_bf16 v[156:159], v[96:99], v[124:127], 0
    s_memrealtime s[8:9]
    s_waitcnt lgkmcnt(0)
    s_sub_u32 s8, s8, s30
    s_cmpk_ge_u32 s8, 2156
    s_nop 3
    s_cbranch_scc1 .ap_104
    s_waitcnt vmcnt(5)
    s_cmpk_ge_u32 s8, 2091
    s_cbranch_scc1 .ap_104
    s_waitcnt vmcnt(3)
    s_bitcmp1_b64 s[14:15], 61
    s_cbranch_scc0 1
    s_waitcnt vmcnt(2)
    s_cmpk_ge_u32 s8, 2016
    s_cbranch_scc1 .ap_104
    s_waitcnt vmcnt(1)
.ap_104:
    s_add_u32 s63, s69, 434176
    buffer_load_dwordx4 v[76:79], v2, s[44:47], s63 offen nt
    v_perm_b32 v112, v196, v192, s94
    v_perm_b32 v113, v204, v200, s94
    v_perm_b32 v114, v212, v208, s94
    v_perm_b32 v115, v220, v216, s94
    s_nop 1
    v_mfma_f32_16x16x32_bf16 v[128:131], v[100:103], v[112:115], v[128:131]
    v_perm_b32 v116, v196, v192, s95
    v_perm_b32 v117, v204, v200, s95
    v_perm_b32 v118, v212, v208, s95
    v_perm_b32 v119, v220, v216, s95
    s_nop 1
    v_mfma_f32_16x16x32_bf16 v[132:135], v[100:103], v[116:119], v[132:135]
    v_perm_b32 v120, v197, v193, s94
    v_perm_b32 v121, v205, v201, s94
    v_perm_b32 v122, v213, v209, s94
    v_perm_b32 v123, v221, v217, s94
    s_nop 1
    v_mfma_f32_16x16x32_bf16 v[136:139], v[100:103], v[120:123], v[136:139]
    v_perm_b32 v124, v197, v193, s95
    v_perm_b32 v125, v205, v201, s95
    v_perm_b32 v126, v213, v209, s95
    v_perm_b32 v127, v221, v217, s95
    s_nop 1
    v_mfma_f32_16x16x32_bf16 v[140:143], v[100:103], v[124:127], v[140:143]
    v_perm_b32 v112, v198, v194, s94
    v_perm_b32 v113, v206, v202, s94
    v_perm_b32 v114, v214, v210, s94
    v_perm_b32 v115, v222, v218, s94
    s_nop 1
    v_mfma_f32_16x16x32_bf16 v[144:147], v[100:103], v[112:115], v[144:147]
    v_perm_b32 v116, v198, v194, s95
    v_perm_b32 v117, v206, v202, s95
    v_perm_b32 v118, v214, v210, s95
    v_perm_b32 v119, v222, v218, s95
    s_nop 1
    v_mfma_f32_16x16x32_bf16 v[148:151], v[100:103], v[116:119], v[148:151]
    v_perm_b32 v120, v199, v195, s94
    v_perm_b32 v121, v207, v203, s94
    v_perm_b32 v122, v215, v211, s94
    v_perm_b32 v123, v223, v219, s94
    s_nop 1
    v_mfma_f32_16x16x32_bf16 v[152:155], v[100:103], v[120:123], v[152:155]
    v_perm_b32 v124, v199, v195, s95
    v_perm_b32 v125, v207, v203, s95
    v_perm_b32 v126, v215, v211, s95
    v_perm_b32 v127, v223, v219, s95
    s_nop 1
    v_mfma_f32_16x16x32_bf16 v[156:159], v[100:103], v[124:127], v[156:159]
    s_memrealtime s[8:9]
    s_waitcnt lgkmcnt(0)
    s_sub_u32 s8, s8, s30
    s_cmpk_ge_u32 s8, 2187
    s_nop 3
    s_cbranch_scc1 .ap_105
    s_waitcnt vmcnt(5)
    s_cmpk_ge_u32 s8, 2122
    s_cbranch_scc1 .ap_105
    s_waitcnt vmcnt(3)
    s_bitcmp1_b64 s[14:15], 62
    s_cbranch_scc0 1
    s_waitcnt vmcnt(2)
    s_cmpk_ge_u32 s8, 2047
    s_cbranch_scc1 .ap_105
    s_waitcnt vmcnt(1)
.ap_105:
    s_add_u32 s63, s69, 442368
    buffer_load_dwordx4 v[84:87], v2, s[44:47], s63 offen nt
    s_waitcnt vmcnt(7)
    v_perm_b32 v112, v228, v224, s94
    v_perm_b32 v113, v236, v232, s94
    v_perm_b32 v114, v244, v240, s94
    v_perm_b32 v115, v252, v248, s94
    s_nop 1
    v_mfma_f32_16x16x32_bf16 v[128:131], v[104:107], v[112:115], v[128:131]
    v_perm_b32 v116, v228, v224, s95
    v_perm_b32 v117, v236, v232, s95
    v_perm_b32 v118, v244, v240, s95
    v_perm_b32 v119, v252, v248, s95
    s_nop 1
    v_mfma_f32_16x16x32_bf16 v[132:135], v[104:107], v[116:119], v[132:135]
    v_perm_b32 v120, v229, v225, s94
    v_perm_b32 v121, v237, v233, s94
    v_perm_b32 v122, v245, v241, s94
    v_perm_b32 v123, v253, v249, s94
    s_nop 1
    v_mfma_f32_16x16x32_bf16 v[136:139], v[104:107], v[120:123], v[136:139]
    v_perm_b32 v124, v229, v225, s95
    v_perm_b32 v125, v237, v233, s95
    v_perm_b32 v126, v245, v241, s95
    v_perm_b32 v127, v253, v249, s95
    s_nop 1
    v_mfma_f32_16x16x32_bf16 v[140:143], v[104:107], v[124:127], v[140:143]
    v_perm_b32 v112, v230, v226, s94
    v_perm_b32 v113, v238, v234, s94
    v_perm_b32 v114, v246, v242, s94
    v_perm_b32 v115, v254, v250, s94
    s_nop 1
    v_mfma_f32_16x16x32_bf16 v[144:147], v[104:107], v[112:115], v[144:147]
    v_perm_b32 v116, v230, v226, s95
    v_perm_b32 v117, v238, v234, s95
    v_perm_b32 v118, v246, v242, s95
    v_perm_b32 v119, v254, v250, s95
    s_nop 1
    v_mfma_f32_16x16x32_bf16 v[148:151], v[104:107], v[116:119], v[148:151]
    v_perm_b32 v120, v231, v227, s94
    v_perm_b32 v121, v239, v235, s94
    v_perm_b32 v122, v247, v243, s94
    v_perm_b32 v123, v255, v251, s94
    s_nop 1
    v_mfma_f32_16x16x32_bf16 v[152:155], v[104:107], v[120:123], v[152:155]
    v_perm_b32 v124, v231, v227, s95
    v_perm_b32 v125, v239, v235, s95
    v_perm_b32 v126, v247, v243, s95
    v_perm_b32 v127, v255, v251, s95
    s_nop 1
    v_mfma_f32_16x16x32_bf16 v[156:159], v[104:107], v[124:127], v[156:159]
    s_memrealtime s[8:9]
    s_waitcnt lgkmcnt(0)
    s_sub_u32 s8, s8, s30
    s_cmpk_ge_u32 s8, 2218
    s_nop 3
    s_cbranch_scc1 .ap_106
    s_waitcnt vmcnt(5)
    s_cmpk_ge_u32 s8, 2153
    s_cbranch_scc1 .ap_106
    s_waitcnt vmcnt(3)
    s_bitcmp1_b64 s[14:15], 63
    s_cbranch_scc0 1
    s_waitcnt vmcnt(2)
    s_cmpk_ge_u32 s8, 2078
    s_cbranch_scc1 .ap_106
    s_waitcnt vmcnt(1)
.ap_106:
    s_add_u32 s63, s69, 450560
    buffer_load_dwordx4 v[92:95], v2, s[44:47], s63 offen nt
    s_setprio 0
    s_waitcnt vmcnt(6)
    v_perm_b32 v160, v44, v36, s94
    v_perm_b32 v164, v44, v36, s95
    v_perm_b32 v168, v45, v37, s94
    v_perm_b32 v172, v45, v37, s95
    v_perm_b32 v176, v46, v38, s94
    v_perm_b32 v180, v46, v38, s95
    v_perm_b32 v184, v47, v39, s94
    v_perm_b32 v188, v47, v39, s95
    s_waitcnt vmcnt(4)
    v_perm_b32 v161, v60, v52, s94
    v_perm_b32 v165, v60, v52, s95
    v_perm_b32 v169, v61, v53, s94
    v_perm_b32 v173, v61, v53, s95
    v_perm_b32 v177, v62, v54, s94
    v_perm_b32 v181, v62, v54, s95
    v_perm_b32 v185, v63, v55, s94
    v_perm_b32 v189, v63, v55, s95
    s_waitcnt vmcnt(2)
    v_perm_b32 v162, v76, v68, s94
    v_perm_b32 v166, v76, v68, s95
    v_perm_b32 v170, v77, v69, s94
    v_perm_b32 v174, v77, v69, s95
    v_perm_b32 v178, v78, v70, s94
    v_perm_b32 v182, v78, v70, s95
    v_perm_b32 v186, v79, v71, s94
    v_perm_b32 v190, v79, v71, s95
.Ltail_ar:
    s_waitcnt vmcnt(0)
    v_perm_b32 v163, v92, v84, s94
    v_perm_b32 v167, v92, v84, s95
    v_perm_b32 v171, v93, v85, s94
    v_perm_b32 v175, v93, v85, s95
    v_perm_b32 v179, v94, v86, s94
    v_perm_b32 v183, v94, v86, s95
    v_perm_b32 v187, v95, v87, s94
    v_perm_b32 v191, v95, v87, s95
    v_mfma_f32_16x16x32_bf16 v[128:131], v[108:111], v[160:163], v[128:131]
    v_mfma_f32_16x16x32_bf16 v[132:135], v[108:111], v[164:167], v[132:135]
    v_mfma_f32_16x16x32_bf16 v[136:139], v[108:111], v[168:171], v[136:139]
    v_mfma_f32_16x16x32_bf16 v[140:143], v[108:111], v[172:175], v[140:143]
    v_mfma_f32_16x16x32_bf16 v[144:147], v[108:111], v[176:179], v[144:147]
    v_mfma_f32_16x16x32_bf16 v[148:151], v[108:111], v[180:183], v[148:151]
    v_mfma_f32_16x16x32_bf16 v[152:155], v[108:111], v[184:187], v[152:155]
    v_mfma_f32_16x16x32_bf16 v[156:159], v[108:111], v[188:191], v[156:159]
    s_lshl4_add_u32 s56, s67, s66
    s_lshl1_add_u32 s56, s56, s68
    s_lshl_b32 s56, s56, 9
    s_add_u32 s56, s56, 0x210000
    s_mov_b32 s60, 0x07060503
    s_mov_b32 s61, 0x07060502
    s_mov_b32 s62, 0x07060501
    s_mov_b64 exec, 0xffff
    ds_write2_b32 v10, v128, v129 offset0:0 offset1:128
    ds_write2_b32 v10, v132, v133 offset0:1 offset1:129
    ds_write2_b32 v10, v136, v137 offset0:2 offset1:130
    ds_write2_b32 v10, v140, v141 offset0:3 offset1:131
    ds_write2_b32 v10, v144, v145 offset0:4 offset1:132
    ds_write2_b32 v10, v148, v149 offset0:5 offset1:133
    ds_write2_b32 v10, v152, v153 offset0:6 offset1:134
    ds_write2_b32 v10, v156, v157 offset0:7 offset1:135
    s_mov_b64 exec, -1
    s_waitcnt lgkmcnt(0)
    s_barrier
    s_cmp_lg_u32 s3, 7
    s_cbranch_scc1 .opub_107
    ds_read_b128 v[196:199], v9 offset:0
    ds_read_b128 v[200:203], v9 offset:1024
    ds_read_b128 v[204:207], v9 offset:2048
    ds_read_b128 v[208:211], v9 offset:3072
    ds_read_b128 v[212:215], v9 offset:4096
    ds_read_b128 v[216:219], v9 offset:5120
    ds_read_b128 v[220:223], v9 offset:6144
    ds_read_b128 v[224:227], v9 offset:7168
    s_waitcnt lgkmcnt(6)
    v_pk_add_f32 v[196:197], v[196:197], v[200:201]
    v_pk_add_f32 v[198:199], v[198:199], v[202:203]
    s_waitcnt lgkmcnt(4)
    v_pk_add_f32 v[204:205], v[204:205], v[208:209]
    v_pk_add_f32 v[206:207], v[206:207], v[210:211]
    v_pk_add_f32 v[196:197], v[196:197], v[204:205]
    v_pk_add_f32 v[198:199], v[198:199], v[206:207]
    s_waitcnt lgkmcnt(2)
    v_pk_add_f32 v[212:213], v[212:213], v[216:217]
    v_pk_add_f32 v[214:215], v[214:215], v[218:219]
    s_waitcnt lgkmcnt(0)
    v_pk_add_f32 v[220:221], v[220:221], v[224:225]
    v_pk_add_f32 v[222:223], v[222:223], v[226:227]
    v_pk_add_f32 v[212:213], v[212:213], v[220:221]
    v_pk_add_f32 v[214:215], v[214:215], v[222:223]
    v_pk_add_f32 v[196:197], v[196:197], v[212:213]
    v_pk_add_f32 v[198:199], v[198:199], v[214:215]
    v_perm_b32 v12, v196, v199, s60
    v_perm_b32 v13, v197, v199, s61
    v_perm_b32 v14, v198, v199, s62
    s_add_u32 s57, s56, 0xac000
    buffer_store_dwordx4 v[12:15], v11, s[36:39], s57 offen
    buffer_store_dwordx4 v[12:15], v11, s[36:39], s56 offen sc1
.opub_107:
    ds_read_b64_tr_b16 v[160:161], v16 offset:0
    ds_read_b64_tr_b16 v[162:163], v16 offset:512
    ds_read_b64_tr_b16 v[176:177], v17 offset:0
    ds_read_b64_tr_b16 v[178:179], v17 offset:512
    ds_read_b64_tr_b16 v[164:165], v16 offset:4096
    ds_read_b64_tr_b16 v[166:167], v16 offset:4608
    ds_read_b64_tr_b16 v[180:181], v17 offset:4096
    ds_read_b64_tr_b16 v[182:183], v17 offset:4608
    ds_read_b64_tr_b16 v[168:169], v16 offset:8192
    ds_read_b64_tr_b16 v[170:171], v16 offset:8704
    ds_read_b64_tr_b16 v[184:185], v17 offset:8192
    ds_read_b64_tr_b16 v[186:187], v17 offset:8704
    ds_read_b64_tr_b16 v[172:173], v16 offset:12288
    ds_read_b64_tr_b16 v[174:175], v16 offset:12800
    ds_read_b64_tr_b16 v[188:189], v17 offset:12288
    ds_read_b64_tr_b16 v[190:191], v17 offset:12800
    s_lshl_b32 s59, s64, 5
    s_add_u32 s59, s59, s3
    s_lshl_b32 s59, s59, 10
    s_add_u32 s59, s59, 0x210000
    s_mov_b32 s60, 0x04000c0c
    s_mov_b32 s61, 0x0706000c
    v_mov_b32 v143, s34
    s_add_u32 s58, s59, s0
    s_mov_b32 s32, 0
    s_mov_b64 s[88:89], exec
    s_mov_b64 s[90:91], exec
    s_mov_b64 s[92:93], exec
    s_mov_b64 s[56:57], exec
.mp_108:
    s_mov_b64 exec, s[88:89]
    buffer_load_dwordx4 v[192:195], v2, s[36:39], s58 offen offset:0 sc1
    s_mov_b64 exec, s[90:91]
    buffer_load_dwordx4 v[196:199], v7, s[36:39], s58 offen offset:0 sc1
    s_mov_b64 exec, s[92:93]
    buffer_load_dwordx4 v[200:203], v8, s[36:39], s58 offen offset:0 sc1
    s_mov_b64 exec, s[56:57]
    buffer_load_dwordx4 v[204:207], v22, s[36:39], s58 offen offset:0 sc1
    s_mov_b64 exec, -1
    s_sub_u32 s35, s35, 1
    s_cbranch_scc1 .Lexit
    s_add_u32 s32, s32, 1
    s_cmp_eq_u32 s32, 64
    s_cselect_b32 s58, s59, s58
    s_waitcnt vmcnt(0)
.mpj_109:
    v_cmp_ne_u32 s[88:89], s34, v195
    v_cmp_ne_u32 s[90:91], s34, v199
    v_cmp_ne_u32 s[92:93], s34, v203
    v_cmp_ne_u32 s[56:57], s34, v207
    s_or_b64 vcc, s[88:89], s[90:91]
    s_or_b64 vcc, vcc, s[92:93]
    s_or_b64 vcc, vcc, s[56:57]
    s_nop 1
    s_cbranch_scc1 .mp_108
    v_perm_b32 v195, v192, v193, s60
    v_perm_b32 v199, v196, v197, s60
    v_perm_b32 v203, v200, v201, s60
    v_perm_b32 v207, v204, v205, s60
    v_perm_b32 v195, v195, v194, s61
    v_perm_b32 v199, v199, v198, s61
    v_perm_b32 v203, v203, v202, s61
    v_perm_b32 v207, v207, v206, s61
    v_permlane32_swap_b32 v192, v194
    v_permlane32_swap_b32 v193, v195
    v_permlane32_swap_b32 v196, v198
    v_permlane32_swap_b32 v197, v199
    v_permlane32_swap_b32 v200, v202
    v_permlane32_swap_b32 v201, v203
    v_permlane32_swap_b32 v204, v206
    v_permlane32_swap_b32 v205, v207
    v_pk_add_f32 v[192:193], v[192:193], v[194:195]
    v_pk_add_f32 v[196:197], v[196:197], v[198:199]
    v_pk_add_f32 v[200:201], v[200:201], v[202:203]
    v_pk_add_f32 v[204:205], v[204:205], v[206:207]
    v_cvt_pk_bf16_f32 v192, v192, v193
    v_cvt_pk_bf16_f32 v196, v196, v197
    v_cvt_pk_bf16_f32 v200, v200, v201
    v_cvt_pk_bf16_f32 v204, v204, v205
    ds_write2_b32 v18, v192, v196 offset1:64
    ds_write2_b32 v18, v200, v204 offset0:128 offset1:192
    s_mul_i32 s59, s3, 9
    s_add_u32 s59, s59, s65
    s_lshl_b32 s59, s59, 11
    s_add_u32 s58, s59, 0x368000
    s_lshl_b32 s63, s64, 8
    s_add_u32 s63, s63, s58
    s_waitcnt lgkmcnt(0)
    s_barrier
    ds_read_b128 v[224:227], v19 offset:0
    ds_read_b128 v[228:231], v19 offset:64
    ds_read_b128 v[232:235], v19 offset:128
    ds_read_b128 v[236:239], v19 offset:192
    s_waitcnt lgkmcnt(3)
    v_mfma_f32_16x16x32_bf16 v[132:135], v[160:163], v[224:227], 0
    v_mfma_f32_16x16x32_bf16 v[136:139], v[176:179], v[224:227], 0
    s_waitcnt lgkmcnt(2)
    v_mfma_f32_16x16x32_bf16 v[132:135], v[164:167], v[228:231], v[132:135]
    v_mfma_f32_16x16x32_bf16 v[136:139], v[180:183], v[228:231], v[136:139]
    s_waitcnt lgkmcnt(1)
    v_mfma_f32_16x16x32_bf16 v[132:135], v[168:171], v[232:235], v[132:135]
    v_mfma_f32_16x16x32_bf16 v[136:139], v[184:187], v[232:235], v[136:139]
    s_waitcnt lgkmcnt(0)
    v_mfma_f32_16x16x32_bf16 v[132:135], v[172:175], v[236:239], v[132:135]
    v_mfma_f32_16x16x32_bf16 v[136:139], v[188:191], v[236:239], v[136:139]
    s_nop 7
    v_cndmask_b32 v132, v132, v136, s[96:97]
    v_cndmask_b32 v133, v133, v137, s[96:97]
    v_cndmask_b32 v134, v134, v138, s[96:97]
    v_cndmask_b32 v135, v135, v139, s[96:97]
    ds_write_b128 v20, v[132:135]
    s_waitcnt lgkmcnt(0)
    s_barrier
    ds_read_b128 v[224:227], v21 offset:0
    ds_read_b128 v[228:231], v21 offset:2176
    ds_read_b128 v[232:235], v21 offset:4352
    ds_read_b128 v[236:239], v21 offset:6528
    s_mov_b32 s60, 0x07060503
    s_mov_b32 s61, 0x07060502
    s_mov_b32 s62, 0x07060501
    s_waitcnt lgkmcnt(2)
    v_pk_add_f32 v[224:225], v[224:225], v[228:229]
    v_pk_add_f32 v[226:227], v[226:227], v[230:231]
    s_waitcnt lgkmcnt(0)
    v_pk_add_f32 v[232:233], v[232:233], v[236:237]
    v_pk_add_f32 v[234:235], v[234:235], v[238:239]
    v_pk_add_f32 v[224:225], v[224:225], v[232:233]
    v_pk_add_f32 v[226:227], v[226:227], v[234:235]
    v_perm_b32 v140, v224, v227, s60
    v_perm_b32 v141, v225, v227, s61
    v_perm_b32 v142, v226, v227, s62
    s_mov_b64 exec, 0xffff
    buffer_store_dwordx4 v[140:143], v2, s[36:39], s63 offen sc1
    s_mov_b64 exec, -1
    s_barrier
    s_mov_b32 s60, 0x04000c0c
    s_mov_b32 s61, 0x0706000c
    s_mul_i32 s101, s64, 18432
    s_mul_i32 s56, s3, 2304
    s_add_u32 s101, s101, s56
    s_add_u32 s101, s101, 0x250000
    s_lshl_b32 s63, s65, 8
    s_add_u32 s63, s63, s101
    v_mov_b32 v253, s34
    v_mov_b32 v255, s34
    s_mov_b64 s[88:89], exec
    s_mov_b64 s[90:91], exec
.mp_112:
    s_mov_b64 exec, s[88:89]
    buffer_load_dwordx4 v[108:111], v2, s[36:39], s58 offen offset:0 sc1
    s_mov_b64 exec, s[90:91]
    buffer_load_dwordx4 v[112:115], v2, s[36:39], s58 offen offset:1024 sc1
    s_mov_b64 exec, -1
    s_sub_u32 s35, s35, 1
    s_cbranch_scc1 .Lexit
    s_waitcnt vmcnt(0)
.mpj_113:
    v_cmp_ne_u32 s[88:89], s34, v111
    v_cmp_ne_u32 s[90:91], s34, v115
    s_or_b64 vcc, s[88:89], s[90:91]
    s_nop 3
    s_cbranch_scc1 .mp_112
    v_perm_b32 v111, v108, v109, s60
    v_perm_b32 v115, v112, v113, s60
    v_perm_b32 v111, v111, v110, s61
    v_perm_b32 v115, v115, v114, s61
    v_pk_add_f32 v[248:249], v[108:109], v[112:113]
    v_pk_add_f32 v[250:251], v[110:111], v[114:115]
    s_nop 1
    v_permlane32_swap_b32 v248, v250
    v_permlane32_swap_b32 v249, v251
    v_pk_add_f32 v[248:249], v[248:249], v[250:251]
    s_nop 1
    v_permlane16_swap_b32 v248, v249
    v_add_f32 v248, v248, v249
    v_cvt_pk_bf16_f32 v248, v248, v248
    v_lshlrev_b32 v248, 16, v248
    v_mul_f32 v248, v248, v23
    v_cvt_pk_bf16_f32 v248, v248, v248
    v_lshlrev_b32 v248, 16, v248
    v_add_f32 v249, v248, v29
    v_add_f32 v248, v248, v29
    v_mov_b32 v24, v248
    s_nop 0
    v_permlane16_swap_b32 v248, v249
    v_cvt_pk_bf16_f32 v252, v248, v249
    v_cvt_pk_bf16_f32 v254, v248, v249
    s_nop 1
    v_permlane32_swap_b32 v252, v254
    s_mov_b64 exec, 0xffff
    s_add_u32 s57, s63, 0xac000
    buffer_store_dwordx4 v[252:255], v2, s[36:39], s57 offen
    buffer_store_dwordx4 v[252:255], v2, s[36:39], s63 offen sc1
    s_mov_b64 exec, -1
    s_cmp_eq_u32 s3, s64
    s_cbranch_scc1 .r2_116
    s_branch .Lexit
.r2_116:
    v_cvt_pk_bf16_f32 v24, v24, v24
    v_lshlrev_b32 v24, 16, v24
    s_nop 1
    s_branch .gpc_118
.gp_117:
    buffer_load_dwordx4 v[32:35], v2, s[36:39], s99 offen offset:0 sc1
    buffer_load_dwordx4 v[40:43], v2, s[36:39], s99 offen offset:1024 sc1
    buffer_load_dwordx2 v[48:49], v5, s[36:39], s99 offen offset:0 sc1
    buffer_load_dwordx4 v[56:59], v2, s[36:39], s100 offen offset:0 sc1
    buffer_load_dwordx4 v[64:67], v2, s[36:39], s100 offen offset:1024 sc1
    buffer_load_dwordx2 v[50:51], v5, s[36:39], s100 offen offset:0 sc1
    buffer_load_dwordx2 v[74:75], v6, s[36:39], s99 offen offset:0 sc1
    buffer_load_dwordx2 v[80:81], v6, s[36:39], s100 offen offset:0 sc1
    buffer_load_dwordx2 v[82:83], v6, s[36:39], s33 offen offset:0 sc1
    s_waitcnt vmcnt(0)
.gpc_118:
    v_min3_u32 v25, v33, v35, v41
    v_max3_u32 v26, v33, v35, v41
    v_min3_u32 v25, v25, v43, v49
    v_max3_u32 v26, v26, v43, v49
    v_min3_u32 v25, v25, v57, v59
    v_max3_u32 v26, v26, v57, v59
    v_min3_u32 v25, v25, v65, v67
    v_max3_u32 v26, v26, v65, v67
    v_min3_u32 v25, v25, v51, v75
    v_max3_u32 v26, v26, v51, v75
    v_min3_u32 v25, v25, v81, v83
    v_max3_u32 v26, v26, v81, v83
    v_cmp_eq_u32 vcc, s34, v25
    v_cmp_eq_u32 s[56:57], s34, v26
    s_and_b64 vcc, vcc, s[56:57]
    s_cmp_eq_u64 vcc, exec
    s_nop 2
    s_cbranch_scc1 .gpd_119
    s_sub_u32 s35, s35, 1
    s_cbranch_scc1 .Lexit
    s_sleep 2
    s_branch .gp_117
.gpd_119:
    v_lshlrev_b32 v160, 16, v32
    v_and_b32 v161, 0xffff0000, v32
    v_lshlrev_b32 v170, 16, v56
    v_and_b32 v171, 0xffff0000, v56
    v_lshlrev_b32 v162, 16, v34
    v_and_b32 v163, 0xffff0000, v34
    v_lshlrev_b32 v172, 16, v58
    v_and_b32 v173, 0xffff0000, v58
    v_lshlrev_b32 v164, 16, v40
    v_and_b32 v165, 0xffff0000, v40
    v_lshlrev_b32 v174, 16, v64
    v_and_b32 v175, 0xffff0000, v64
    v_lshlrev_b32 v166, 16, v42
    v_and_b32 v167, 0xffff0000, v42
    v_lshlrev_b32 v176, 16, v66
    v_and_b32 v177, 0xffff0000, v66
    v_lshlrev_b32 v168, 16, v48
    v_and_b32 v169, 0xffff0000, v48
    v_lshlrev_b32 v178, 16, v50
    v_and_b32 v179, 0xffff0000, v50
    v_lshlrev_b32 v75, 16, v74
    v_and_b32 v74, 0xffff0000, v74
    s_mov_b32 vcc_lo, 0xffff0000
    s_mov_b32 vcc_hi, 0xffff0000
    v_cndmask_b32 v75, v75, v74, vcc
    v_lshlrev_b32 v81, 16, v80
    v_and_b32 v80, 0xffff0000, v80
    s_mov_b32 vcc_lo, 0xffff0000
    s_mov_b32 vcc_hi, 0xffff0000
    v_cndmask_b32 v81, v81, v80, vcc
    v_lshlrev_b32 v83, 16, v82
    v_and_b32 v82, 0xffff0000, v82
    s_mov_b32 vcc_lo, 0xffff0000
    s_mov_b32 vcc_hi, 0xffff0000
    v_cndmask_b32 v83, v83, v82, vcc
    s_waitcnt vmcnt(0)
    s_add_u32 s58, s101, s0
    s_mov_b32 s32, 0
    s_mov_b64 s[88:89], exec
    s_mov_b64 s[90:91], exec
    s_mov_b64 s[92:93], exec
.mp_120:
    s_mov_b64 exec, s[88:89]
    buffer_load_dwordx4 v[180:183], v2, s[36:39], s58 offen offset:0 sc1
    s_mov_b64 exec, s[90:91]
    buffer_load_dwordx4 v[184:187], v2, s[36:39], s58 offen offset:1024 sc1
    s_mov_b64 exec, s[92:93]
    buffer_load_dwordx2 v[188:189], v5, s[36:39], s58 offen offset:0 sc1
    s_mov_b64 exec, -1
    s_sub_u32 s35, s35, 1
    s_cbranch_scc1 .Lexit
    s_add_u32 s32, s32, 1
    s_cmp_eq_u32 s32, 64
    s_cselect_b32 s58, s101, s58
    s_waitcnt vmcnt(0)
.mpj_121:
    v_cmp_ne_u32 s[88:89], s34, v181
    v_cmp_ne_u32 vcc, s34, v183
    s_or_b64 s[88:89], s[88:89], vcc
    v_cmp_ne_u32 s[90:91], s34, v185
    v_cmp_ne_u32 vcc, s34, v187
    s_or_b64 s[90:91], s[90:91], vcc
    v_cmp_ne_u32 s[92:93], s34, v189
    s_or_b64 vcc, s[88:89], s[90:91]
    s_or_b64 vcc, vcc, s[92:93]
    s_nop 2
    s_cbranch_scc1 .mp_120
    s_mov_b32 s56, 0x3f803f80
    v_dot2_f32_bf16 v200, v180, s56, 0
    v_dot2_f32_bf16 v201, v180, v180, 0
    v_dot2_f32_bf16 v200, v182, s56, v200
    v_dot2_f32_bf16 v201, v182, v182, v201
    v_dot2_f32_bf16 v200, v184, s56, v200
    v_dot2_f32_bf16 v201, v184, v184, v201
    v_dot2_f32_bf16 v200, v186, s56, v200
    v_dot2_f32_bf16 v201, v186, v186, v201
    s_mov_b64 exec, 0xffffffff
    v_dot2_f32_bf16 v200, v188, s56, v200
    v_dot2_f32_bf16 v201, v188, v188, v201
    s_mov_b64 exec, -1
    s_nop 1
    v_permlane32_swap_b32 v200, v201
    v_add_f32 v200, v200, v201
    v_mov_b32 v202, v200
    s_nop 1
    v_permlane16_swap_b32 v202, v200
    v_add_f32 v200, v202, v200
    v_lshlrev_b32 v190, 16, v180
    v_and_b32 v191, 0xffff0000, v180
    v_add_f32_dpp v200, v200, v200 row_ror:8 row_mask:0xf bank_mask:0xf
    v_lshlrev_b32 v192, 16, v182
    v_and_b32 v193, 0xffff0000, v182
    v_add_f32_dpp v200, v200, v200 row_ror:4 row_mask:0xf bank_mask:0xf
    v_lshlrev_b32 v194, 16, v184
    v_and_b32 v195, 0xffff0000, v184
    v_add_f32_dpp v200, v200, v200 quad_perm:[2,3,0,1] row_mask:0xf bank_mask:0xf
    v_lshlrev_b32 v196, 16, v186
    v_and_b32 v197, 0xffff0000, v186
    v_add_f32_dpp v200, v200, v200 quad_perm:[1,0,3,2] row_mask:0xf bank_mask:0xf
    v_mul_f32 v200, 0x3ae38e39, v200
    v_lshlrev_b32 v198, 16, v188
    v_and_b32 v199, 0xffff0000, v188
    v_readlane_b32 s56, v200, 0
    v_readlane_b32 s57, v200, 32
    s_nop 0
    v_mov_b32 v200, s56
    v_fma_f32 v201, -v200, v200, s57
    v_max_f32 v201, 0, v201
    v_cvt_pk_bf16_f32 v202, -v200, v201
    v_and_b32 v203, 0xffff0000, v202
    v_add_f32 v203, 0x3727c5ac, v203
    v_lshlrev_b32 v200, 16, v202
    v_cvt_pk_bf16_f32 v203, v203, v203
    v_lshlrev_b32 v203, 16, v203
    v_sqrt_f32 v203, v203
    v_mov_b32 v201, v200
    v_cvt_pk_bf16_f32 v203, v203, v203
    v_lshlrev_b32 v203, 16, v203
    v_rcp_f32 v202, v203
    v_rcp_f32 v203, v203
    v_pk_add_f32 v[190:191], v[190:191], v[200:201]
    v_pk_add_f32 v[192:193], v[192:193], v[200:201]
    v_pk_add_f32 v[194:195], v[194:195], v[200:201]
    v_pk_add_f32 v[196:197], v[196:197], v[200:201]
    v_pk_add_f32 v[198:199], v[198:199], v[200:201]
    v_cvt_pk_bf16_f32 v190, v190, v191
    v_and_b32 v191, 0xffff0000, v190
    v_lshlrev_b32 v190, 16, v190
    v_cvt_pk_bf16_f32 v192, v192, v193
    v_and_b32 v193, 0xffff0000, v192
    v_lshlrev_b32 v192, 16, v192
    v_cvt_pk_bf16_f32 v194, v194, v195
    v_and_b32 v195, 0xffff0000, v194
    v_lshlrev_b32 v194, 16, v194
    v_cvt_pk_bf16_f32 v196, v196, v197
    v_and_b32 v197, 0xffff0000, v196
    v_lshlrev_b32 v196, 16, v196
    v_cvt_pk_bf16_f32 v198, v198, v199
    v_and_b32 v199, 0xffff0000, v198
    v_lshlrev_b32 v198, 16, v198
    v_pk_mul_f32 v[190:191], v[190:191], v[202:203]
    v_pk_mul_f32 v[192:193], v[192:193], v[202:203]
    v_pk_mul_f32 v[194:195], v[194:195], v[202:203]
    v_pk_mul_f32 v[196:197], v[196:197], v[202:203]
    v_pk_mul_f32 v[198:199], v[198:199], v[202:203]
    v_cvt_pk_bf16_f32 v190, v190, v191
    v_and_b32 v191, 0xffff0000, v190
    v_lshlrev_b32 v190, 16, v190
    v_cvt_pk_bf16_f32 v192, v192, v193
    v_and_b32 v193, 0xffff0000, v192
    v_lshlrev_b32 v192, 16, v192
    v_cvt_pk_bf16_f32 v194, v194, v195
    v_and_b32 v195, 0xffff0000, v194
    v_lshlrev_b32 v194, 16, v194
    v_cvt_pk_bf16_f32 v196, v196, v197
    v_and_b32 v197, 0xffff0000, v196
    v_lshlrev_b32 v196, 16, v196
    v_cvt_pk_bf16_f32 v198, v198, v199
    v_and_b32 v199, 0xffff0000, v198
    v_lshlrev_b32 v198, 16, v198
    v_pk_mul_f32 v[190:191], v[190:191], v[170:171]
    v_pk_mul_f32 v[192:193], v[192:193], v[172:173]
    v_pk_mul_f32 v[194:195], v[194:195], v[174:175]
    v_pk_mul_f32 v[196:197], v[196:197], v[176:177]
    v_pk_mul_f32 v[198:199], v[198:199], v[178:179]
    v_cvt_pk_bf16_f32 v190, v190, v191
    v_and_b32 v191, 0xffff0000, v190
    v_lshlrev_b32 v190, 16, v190
    v_cvt_pk_bf16_f32 v192, v192, v193
    v_and_b32 v193, 0xffff0000, v192
    v_lshlrev_b32 v192, 16, v192
    v_cvt_pk_bf16_f32 v194, v194, v195
    v_and_b32 v195, 0xffff0000, v194
    v_lshlrev_b32 v194, 16, v194
    v_cvt_pk_bf16_f32 v196, v196, v197
    v_and_b32 v197, 0xffff0000, v196
    v_lshlrev_b32 v196, 16, v196
    v_cvt_pk_bf16_f32 v198, v198, v199
    v_and_b32 v199, 0xffff0000, v198
    v_lshlrev_b32 v198, 16, v198
    v_pk_add_f32 v[190:191], v[190:191], v[160:161]
    v_pk_add_f32 v[192:193], v[192:193], v[162:163]
    v_pk_add_f32 v[194:195], v[194:195], v[164:165]
    v_pk_add_f32 v[196:197], v[196:197], v[166:167]
    v_pk_add_f32 v[198:199], v[198:199], v[168:169]
    v_cvt_pk_bf16_f32 v206, v190, v191
    v_cvt_pk_bf16_f32 v207, v192, v193
    v_cvt_pk_bf16_f32 v208, v194, v195
    v_cvt_pk_bf16_f32 v209, v196, v197
    v_cvt_pk_bf16_f32 v210, v198, v199
    v_dot2_f32_bf16 v14, v206, v88, 0
    v_dot2_f32_bf16 v14, v207, v89, v14
    v_dot2_f32_bf16 v14, v208, v90, v14
    v_dot2_f32_bf16 v14, v209, v91, v14
    s_mov_b64 exec, 0xffffffff
    v_dot2_f32_bf16 v14, v210, v30, v14
    s_mov_b64 exec, -1
    s_nop 1
    v_mov_b32 v15, v14
    s_nop 1
    v_permlane32_swap_b32 v15, v14
    v_add_f32 v14, v15, v14
    v_mov_b32 v15, v14
    s_nop 1
    v_permlane16_swap_b32 v15, v14
    v_add_f32 v14, v15, v14
    s_nop 1
    v_add_f32_dpp v14, v14, v14 row_ror:8 row_mask:0xf bank_mask:0xf
    s_nop 1
    v_add_f32_dpp v14, v14, v14 row_ror:4 row_mask:0xf bank_mask:0xf
    s_nop 1
    v_add_f32_dpp v14, v14, v14 quad_perm:[2,3,0,1] row_mask:0xf bank_mask:0xf
    s_nop 1
    v_add_f32_dpp v14, v14, v14 quad_perm:[1,0,3,2] row_mask:0xf bank_mask:0xf
    v_cvt_pk_bf16_f32 v14, v14, v14
    v_lshlrev_b32 v14, 16, v14
    v_max_f32 v14, 0xc2ae0000, v14
    v_min_f32 v14, 0x43000000, v14
    v_mul_f32 v15, 0xbfb8aa3b, v14
    v_fma_f32 v16, v14, s98, -v15
    v_fmac_f32 v16, 0xb2a57060, v14
    v_exp_f32 v15, v15
    v_mul_f32 v16, 0x3f317218, v16
    v_fmac_f32 v15, v15, v16
    v_add_f32 v15, 1.0, v15
    v_rcp_f32 v16, v15
    s_nop 0
    v_fma_f32 v15, -v15, v16, 1.0
    v_fma_f32 v14, v15, v16, v16
    v_cvt_pk_bf16_f32 v14, v14, v14
    v_lshlrev_b32 v14, 16, v14
    v_add_f32 v17, v24, v200
    v_cvt_pk_bf16_f32 v17, v17, v17
    v_lshlrev_b32 v17, 16, v17
    v_mul_f32 v17, v17, v202
    v_cvt_pk_bf16_f32 v17, v17, v17
    v_lshlrev_b32 v17, 16, v17
    v_mul_f32 v17, v17, v81
    v_cvt_pk_bf16_f32 v17, v17, v17
    v_lshlrev_b32 v17, 16, v17
    v_add_f32 v17, v17, v75
    v_cvt_pk_bf16_f32 v17, v17, v17
    v_lshlrev_b32 v17, 16, v17
    s_lshl_b32 s59, s59, 1
    s_add_u32 s58, s59, 0x38c000
    s_mov_b32 s60, 0x04000c0c
    s_mov_b32 s61, 0x0706000c
    s_mov_b32 s48, s28
    s_and_b32 s49, s29, 0xffff
    s_mov_b32 s50, 0x2400
    s_mov_b32 s51, 0x00020000
    s_mul_i32 s63, s3, 1152
    s_mov_b64 s[88:89], exec
    s_mov_b64 s[90:91], exec
    s_mov_b64 s[92:93], exec
    s_mov_b64 s[56:57], exec
.mp_124:
    s_mov_b64 exec, s[88:89]
    buffer_load_dwordx4 v[96:99], v2, s[36:39], s58 offen offset:0 sc1
    s_mov_b64 exec, s[90:91]
    buffer_load_dwordx4 v[100:103], v2, s[36:39], s58 offen offset:1024 sc1
    s_mov_b64 exec, s[92:93]
    buffer_load_dwordx4 v[104:107], v2, s[36:39], s58 offen offset:2048 sc1
    s_mov_b64 exec, s[56:57]
    buffer_load_dwordx4 v[108:111], v2, s[36:39], s58 offen offset:3072 sc1
    s_mov_b64 exec, -1
    s_sub_u32 s35, s35, 1
    s_cbranch_scc1 .Lexit
    s_waitcnt vmcnt(0)
.mpj_125:
    v_cmp_ne_u32 s[88:89], s34, v99
    v_cmp_ne_u32 s[90:91], s34, v103
    v_cmp_ne_u32 s[92:93], s34, v107
    v_cmp_ne_u32 s[56:57], s34, v111
    s_or_b64 vcc, s[88:89], s[90:91]
    s_or_b64 vcc, vcc, s[92:93]
    s_or_b64 vcc, vcc, s[56:57]
    s_nop 1
    s_cbranch_scc1 .mp_124
    v_perm_b32 v99, v96, v97, s60
    v_perm_b32 v103, v100, v101, s60
    v_perm_b32 v107, v104, v105, s60
    v_perm_b32 v111, v108, v109, s60
    v_perm_b32 v99, v99, v98, s61
    v_perm_b32 v103, v103, v102, s61
    v_perm_b32 v107, v107, v106, s61
    v_perm_b32 v111, v111, v110, s61
    v_pk_add_f32 v[96:97], v[96:97], v[100:101]
    v_pk_add_f32 v[98:99], v[98:99], v[102:103]
    v_pk_add_f32 v[248:249], v[104:105], v[108:109]
    v_pk_add_f32 v[250:251], v[106:107], v[110:111]
    v_pk_add_f32 v[248:249], v[248:249], v[96:97]
    v_pk_add_f32 v[250:251], v[250:251], v[98:99]
    s_nop 1
    v_permlane32_swap_b32 v248, v250
    v_permlane32_swap_b32 v249, v251
    v_pk_add_f32 v[248:249], v[248:249], v[250:251]
    s_nop 1
    v_permlane16_swap_b32 v248, v249
    v_add_f32 v248, v248, v249
    v_cvt_pk_bf16_f32 v248, v248, v248
    v_lshlrev_b32 v248, 16, v248
    v_mul_f32 v248, v248, v14
    v_cvt_pk_bf16_f32 v248, v248, v248
    v_lshlrev_b32 v248, 16, v248
    v_add_f32 v248, v248, v17
    v_cvt_pk_bf16_f32 v248, v248, v248
    v_lshlrev_b32 v248, 16, v248
    v_mul_f32 v248, v248, v83
    v_cvt_pk_bf16_f32 v248, v248, v248
    v_lshlrev_b32 v248, 16, v248
    v_add_f32 v248, v248, v24
    v_cvt_pk_bf16_f32 v248, v248, v248
    buffer_store_short v248, v31, s[48:51], s63 offen
    s_cmp_lg_u32 s2, 0
    s_cbranch_scc1 .Lexit
    v_mov_b32 v13, s34
    s_mov_b64 exec, 1
    buffer_store_dword v13, v2, s[36:39], 0 offen
    s_mov_b64 exec, -1
    s_branch .Lexit
.Latt_bc:
    v_and_b32 v8, 1, v0
    v_lshlrev_b32 v8, 8, v8
    v_and_b32 v9, 0x3c, v0
    v_lshl_add_u32 v9, v9, 2, v8
    v_lshlrev_b32 v7, 1, v9
    v_and_b32 v9, 0x3c, v0
    v_lshrrev_b32 v8, 4, v8
    v_lshl_add_u32 v9, v9, 3, v8
    s_lshl_b32 s58, s66, 14
    s_lshl_b32 s59, s67, 10
    s_add_u32 s58, s58, s59
    s_add_u32 s58, s58, 0x40000
    s_lshl4_add_u32 s59, s66, s67
    s_lshl_b32 s59, s59, 9
    s_add_u32 s59, s59, 0x200000
    s_memrealtime s[8:9]
    s_waitcnt vmcnt(8)
    s_waitcnt lgkmcnt(0)
    s_sub_u32 s8, s8, s30
    s_cmpk_ge_u32 s8, 1147
    s_cbranch_scc1 .ap_128
    s_waitcnt vmcnt(5)
    s_cmpk_ge_u32 s8, 1082
    s_cbranch_scc1 .ap_128
    s_waitcnt vmcnt(3)
    s_bitcmp1_b64 s[14:15], 26
    s_cbranch_scc0 1
    s_waitcnt vmcnt(2)
    s_cmpk_ge_u32 s8, 1007
    s_cbranch_scc1 .ap_128
    s_waitcnt vmcnt(1)
.ap_128:
    s_add_u32 s63, s69, 409600
    buffer_load_dwordx4 v[88:91], v1, s[40:43], s63 offen nt
    s_memrealtime s[8:9]
    s_waitcnt vmcnt(8)
    s_waitcnt lgkmcnt(0)
    s_sub_u32 s8, s8, s30
    s_cmpk_ge_u32 s8, 1174
    s_cbranch_scc1 .ap_129
    s_waitcnt vmcnt(5)
    s_cmpk_ge_u32 s8, 1109
    s_cbranch_scc1 .ap_129
    s_waitcnt vmcnt(3)
    s_bitcmp1_b64 s[14:15], 27
    s_cbranch_scc0 1
    s_waitcnt vmcnt(2)
    s_cmpk_ge_u32 s8, 1034
    s_cbranch_scc1 .ap_129
    s_waitcnt vmcnt(1)
.ap_129:
    s_add_u32 s63, s69, 417792
    buffer_load_dwordx4 v[92:95], v1, s[40:43], s63 offen nt
    s_memrealtime s[8:9]
    s_waitcnt vmcnt(8)
    s_waitcnt lgkmcnt(0)
    s_sub_u32 s8, s8, s30
    s_cmpk_ge_u32 s8, 1201
    s_cbranch_scc1 .ap_130
    s_waitcnt vmcnt(5)
    s_cmpk_ge_u32 s8, 1136
    s_cbranch_scc1 .ap_130
    s_waitcnt vmcnt(3)
    s_bitcmp1_b64 s[14:15], 28
    s_cbranch_scc0 1
    s_waitcnt vmcnt(2)
    s_cmpk_ge_u32 s8, 1061
    s_cbranch_scc1 .ap_130
    s_waitcnt vmcnt(1)
.ap_130:
    s_add_u32 s63, s69, 425984
    buffer_load_dwordx4 v[120:123], v1, s[40:43], s63 offen nt
    s_memrealtime s[8:9]
    s_waitcnt vmcnt(8)
    s_waitcnt lgkmcnt(0)
    s_sub_u32 s8, s8, s30
    s_cmpk_ge_u32 s8, 1228
    s_cbranch_scc1 .ap_131
    s_waitcnt vmcnt(5)
    s_cmpk_ge_u32 s8, 1163
    s_cbranch_scc1 .ap_131
    s_waitcnt vmcnt(3)
    s_bitcmp1_b64 s[14:15], 29
    s_cbranch_scc0 1
    s_waitcnt vmcnt(2)
    s_cmpk_ge_u32 s8, 1088
    s_cbranch_scc1 .ap_131
    s_waitcnt vmcnt(1)
.ap_131:
    s_add_u32 s63, s69, 434176
    buffer_load_dwordx4 v[124:127], v1, s[40:43], s63 offen nt
    s_memrealtime s[8:9]
    s_waitcnt vmcnt(8)
    s_waitcnt lgkmcnt(0)
    s_sub_u32 s8, s8, s30
    s_cmpk_ge_u32 s8, 1255
    s_cbranch_scc1 .ap_132
    s_waitcnt vmcnt(5)
    s_cmpk_ge_u32 s8, 1190
    s_cbranch_scc1 .ap_132
    s_waitcnt vmcnt(3)
    s_bitcmp1_b64 s[14:15], 30
    s_cbranch_scc0 1
    s_waitcnt vmcnt(2)
    s_cmpk_ge_u32 s8, 1115
    s_cbranch_scc1 .ap_132
    s_waitcnt vmcnt(1)
.ap_132:
    s_add_u32 s63, s69, 442368
    buffer_load_dwordx4 v[152:155], v1, s[40:43], s63 offen nt
    s_memrealtime s[8:9]
    s_waitcnt vmcnt(8)
    s_waitcnt lgkmcnt(0)
    s_sub_u32 s8, s8, s30
    s_cmpk_ge_u32 s8, 1282
    s_cbranch_scc1 .ap_133
    s_waitcnt vmcnt(5)
    s_cmpk_ge_u32 s8, 1217
    s_cbranch_scc1 .ap_133
    s_waitcnt vmcnt(3)
    s_bitcmp1_b64 s[14:15], 31
    s_cbranch_scc0 1
    s_waitcnt vmcnt(2)
    s_cmpk_ge_u32 s8, 1142
    s_cbranch_scc1 .ap_133
    s_waitcnt vmcnt(1)
.ap_133:
    s_add_u32 s63, s69, 450560
    buffer_load_dwordx4 v[156:159], v1, s[40:43], s63 offen nt
    buffer_load_dwordx4 v[16:19], v7, s[36:39], s58 offen offset:0 sc1
    buffer_load_dwordx4 v[20:23], v7, s[36:39], s58 offen offset:16 sc1
    s_memrealtime s[8:9]
    s_waitcnt vmcnt(8)
    s_waitcnt lgkmcnt(0)
    s_sub_u32 s8, s8, s30
    s_cmpk_ge_u32 s8, 1309
    s_cbranch_scc1 .ap_134
    s_waitcnt vmcnt(5)
    s_cmpk_ge_u32 s8, 1244
    s_cbranch_scc1 .ap_134
    s_waitcnt vmcnt(3)
    s_bitcmp1_b64 s[14:15], 32
    s_cbranch_scc0 1
    s_waitcnt vmcnt(2)
    s_cmpk_ge_u32 s8, 1169
    s_cbranch_scc1 .ap_134
    s_waitcnt vmcnt(1)
.ap_134:
    s_add_u32 s63, s69, 0
    buffer_load_dwordx4 v[160:163], v2, s[44:47], s63 offen nt
    s_memrealtime s[8:9]
    s_waitcnt vmcnt(8)
    s_waitcnt lgkmcnt(0)
    s_sub_u32 s8, s8, s30
    s_cmpk_ge_u32 s8, 1336
    s_cbranch_scc1 .ap_135
    s_waitcnt vmcnt(5)
    s_cmpk_ge_u32 s8, 1271
    s_cbranch_scc1 .ap_135
    s_waitcnt vmcnt(3)
    s_bitcmp1_b64 s[14:15], 33
    s_cbranch_scc0 1
    s_waitcnt vmcnt(2)
    s_cmpk_ge_u32 s8, 1196
    s_cbranch_scc1 .ap_135
    s_waitcnt vmcnt(1)
.ap_135:
    s_add_u32 s63, s69, 8192
    buffer_load_dwordx4 v[164:167], v2, s[44:47], s63 offen nt
    s_memrealtime s[8:9]
    s_waitcnt vmcnt(8)
    s_waitcnt lgkmcnt(0)
    s_sub_u32 s8, s8, s30
    s_cmpk_ge_u32 s8, 1363
    s_cbranch_scc1 .ap_136
    s_waitcnt vmcnt(5)
    s_cmpk_ge_u32 s8, 1298
    s_cbranch_scc1 .ap_136
    s_waitcnt vmcnt(3)
    s_bitcmp1_b64 s[14:15], 34
    s_cbranch_scc0 1
    s_waitcnt vmcnt(2)
    s_cmpk_ge_u32 s8, 1223
    s_cbranch_scc1 .ap_136
    s_waitcnt vmcnt(1)
.ap_136:
    s_add_u32 s63, s69, 16384
    buffer_load_dwordx4 v[168:171], v2, s[44:47], s63 offen nt
    s_waitcnt vmcnt(3)
    s_branch .gpc_138
.gp_137:
    buffer_load_dwordx4 v[16:19], v7, s[36:39], s58 offen offset:0 sc1
    buffer_load_dwordx4 v[20:23], v7, s[36:39], s58 offen offset:16 sc1
    s_waitcnt vmcnt(0)
.gpc_138:
    v_min_u32 v10, v17, v19
    v_max_u32 v11, v17, v19
    v_min3_u32 v10, v10, v21, v23
    v_max3_u32 v11, v11, v21, v23
    v_cmp_eq_u32 vcc, s34, v10
    v_cmp_eq_u32 s[56:57], s34, v11
    s_and_b64 vcc, vcc, s[56:57]
    s_cmp_eq_u64 vcc, exec
    s_nop 2
    s_cbranch_scc1 .gpd_139
    s_sub_u32 s35, s35, 1
    s_cbranch_scc1 .Lexit
    s_sleep 1
    s_branch .gp_137
.gpd_139:
    s_mov_b32 vcc_lo, 0xcccccccc
    s_mov_b32 vcc_hi, 0xcccccccc
    v_cndmask_b32_e64 v24, v16, 0, vcc
    v_cndmask_b32_e64 v25, v18, 0, vcc
    v_cndmask_b32_e64 v26, v20, 0, vcc
    v_cndmask_b32_e64 v27, v22, 0, vcc
    v_cndmask_b32_e32 v28, 0, v16, vcc
    v_cndmask_b32_e32 v29, 0, v18, vcc
    v_cndmask_b32_e32 v30, 0, v20, vcc
    v_cndmask_b32_e32 v31, 0, v22, vcc
    v_mfma_f32_16x16x32_bf16 v[16:19], v[32:35], v[24:27], 0
    v_mfma_f32_16x16x32_bf16 v[32:35], v[40:43], v[24:27], 0
    v_mfma_f32_16x16x32_bf16 v[16:19], v[36:39], v[28:31], v[16:19]
    v_mfma_f32_16x16x32_bf16 v[40:43], v[48:51], v[24:27], 0
    v_mfma_f32_16x16x32_bf16 v[32:35], v[44:47], v[28:31], v[32:35]
    v_mfma_f32_16x16x32_bf16 v[48:51], v[56:59], v[24:27], 0
    v_mfma_f32_16x16x32_bf16 v[40:43], v[52:55], v[28:31], v[40:43]
    v_mfma_f32_16x16x32_bf16 v[56:59], v[64:67], v[24:27], 0
    v_mfma_f32_16x16x32_bf16 v[48:51], v[60:63], v[28:31], v[48:51]
    s_nop 1
    v_add_f32_dpp v10, v17, v16 row_ror:12 row_mask:0xf bank_mask:0x1
    s_memrealtime s[8:9]
    s_waitcnt lgkmcnt(0)
    s_sub_u32 s8, s8, s30
    s_cmpk_ge_u32 s8, 1390
    s_nop 0
    s_cbranch_scc1 .ap_140
    s_waitcnt vmcnt(3)
    s_cmpk_ge_u32 s8, 1325
    s_cbranch_scc1 .ap_140
    s_waitcnt vmcnt(3)
    s_bitcmp1_b64 s[14:15], 35
    s_cbranch_scc0 1
    s_waitcnt vmcnt(2)
    s_cmpk_ge_u32 s8, 1250
    s_cbranch_scc1 .ap_140
    s_waitcnt vmcnt(1)
.ap_140:
    s_add_u32 s63, s69, 24576
    buffer_load_dwordx4 v[172:175], v2, s[44:47], s63 offen nt
    v_mfma_f32_16x16x32_bf16 v[64:67], v[72:75], v[24:27], 0
    v_mfma_f32_16x16x32_bf16 v[56:59], v[68:71], v[28:31], v[56:59]
    v_add_f32_dpp v11, v33, v32 row_ror:12 row_mask:0xf bank_mask:0x1
    v_add_f32_dpp v10, v18, v10 row_ror:8 row_mask:0xf bank_mask:0x1
    v_mfma_f32_16x16x32_bf16 v[72:75], v[80:83], v[24:27], 0
    v_mfma_f32_16x16x32_bf16 v[64:67], v[76:79], v[28:31], v[64:67]
    v_add_f32_dpp v12, v41, v40 row_ror:12 row_mask:0xf bank_mask:0x1
    v_add_f32_dpp v11, v34, v11 row_ror:8 row_mask:0xf bank_mask:0x1
    v_add_f32_dpp v10, v19, v10 row_ror:4 row_mask:0xf bank_mask:0x1
    v_mfma_f32_16x16x32_bf16 v[80:83], v[88:91], v[24:27], 0
    v_mfma_f32_16x16x32_bf16 v[72:75], v[84:87], v[28:31], v[72:75]
    v_add_f32_dpp v13, v49, v48 row_ror:12 row_mask:0xf bank_mask:0x1
    v_add_f32_dpp v12, v42, v12 row_ror:8 row_mask:0xf bank_mask:0x1
    v_add_f32_dpp v11, v35, v11 row_ror:4 row_mask:0xf bank_mask:0x1
    v_mfma_f32_16x16x32_bf16 v[88:91], v[96:99], v[24:27], 0
    v_mfma_f32_16x16x32_bf16 v[80:83], v[92:95], v[28:31], v[80:83]
    v_add_f32_dpp v10, v58, v57 row_ror:12 row_mask:0xf bank_mask:0x2
    v_add_f32_dpp v13, v50, v13 row_ror:8 row_mask:0xf bank_mask:0x1
    v_add_f32_dpp v12, v43, v12 row_ror:4 row_mask:0xf bank_mask:0x1
    s_memrealtime s[8:9]
    s_waitcnt lgkmcnt(0)
    s_sub_u32 s8, s8, s30
    s_cmpk_ge_u32 s8, 1417
    s_nop 0
    s_cbranch_scc1 .ap_141
    s_waitcnt vmcnt(4)
    s_cmpk_ge_u32 s8, 1352
    s_cbranch_scc1 .ap_141
    s_waitcnt vmcnt(3)
    s_bitcmp1_b64 s[14:15], 36
    s_cbranch_scc0 1
    s_waitcnt vmcnt(2)
    s_cmpk_ge_u32 s8, 1277
    s_cbranch_scc1 .ap_141
    s_waitcnt vmcnt(1)
.ap_141:
    s_add_u32 s63, s69, 32768
    buffer_load_dwordx4 v[176:179], v2, s[44:47], s63 offen nt
    v_mfma_f32_16x16x32_bf16 v[96:99], v[104:107], v[24:27], 0
    v_mfma_f32_16x16x32_bf16 v[88:91], v[100:103], v[28:31], v[88:91]
    v_add_f32_dpp v11, v66, v65 row_ror:12 row_mask:0xf bank_mask:0x2
    v_add_f32_dpp v10, v59, v10 row_ror:8 row_mask:0xf bank_mask:0x2
    v_add_f32_dpp v13, v51, v13 row_ror:4 row_mask:0xf bank_mask:0x1
    v_mfma_f32_16x16x32_bf16 v[104:107], v[112:115], v[24:27], 0
    v_mfma_f32_16x16x32_bf16 v[96:99], v[108:111], v[28:31], v[96:99]
    v_add_f32_dpp v12, v74, v73 row_ror:12 row_mask:0xf bank_mask:0x2
    v_add_f32_dpp v11, v67, v11 row_ror:8 row_mask:0xf bank_mask:0x2
    v_add_f32_dpp v10, v56, v10 row_ror:4 row_mask:0xf bank_mask:0x2
    v_mfma_f32_16x16x32_bf16 v[112:115], v[120:123], v[24:27], 0
    v_mfma_f32_16x16x32_bf16 v[104:107], v[116:119], v[28:31], v[104:107]
    v_add_f32_dpp v13, v82, v81 row_ror:12 row_mask:0xf bank_mask:0x2
    v_add_f32_dpp v12, v75, v12 row_ror:8 row_mask:0xf bank_mask:0x2
    v_add_f32_dpp v11, v64, v11 row_ror:4 row_mask:0xf bank_mask:0x2
    v_mfma_f32_16x16x32_bf16 v[120:123], v[128:131], v[24:27], 0
    v_mfma_f32_16x16x32_bf16 v[112:115], v[124:127], v[28:31], v[112:115]
    v_add_f32_dpp v10, v91, v90 row_ror:12 row_mask:0xf bank_mask:0x4
    v_add_f32_dpp v13, v83, v13 row_ror:8 row_mask:0xf bank_mask:0x2
    v_add_f32_dpp v12, v72, v12 row_ror:4 row_mask:0xf bank_mask:0x2
    s_memrealtime s[8:9]
    s_waitcnt lgkmcnt(0)
    s_sub_u32 s8, s8, s30
    s_cmpk_ge_u32 s8, 1444
    s_nop 0
    s_cbranch_scc1 .ap_142
    s_waitcnt vmcnt(5)
    s_cmpk_ge_u32 s8, 1379
    s_cbranch_scc1 .ap_142
    s_waitcnt vmcnt(3)
    s_bitcmp1_b64 s[14:15], 37
    s_cbranch_scc0 1
    s_waitcnt vmcnt(2)
    s_cmpk_ge_u32 s8, 1304
    s_cbranch_scc1 .ap_142
    s_waitcnt vmcnt(1)
.ap_142:
    s_add_u32 s63, s69, 40960
    buffer_load_dwordx4 v[180:183], v2, s[44:47], s63 offen nt
    v_mfma_f32_16x16x32_bf16 v[128:131], v[136:139], v[24:27], 0
    v_mfma_f32_16x16x32_bf16 v[120:123], v[132:135], v[28:31], v[120:123]
    v_add_f32_dpp v11, v99, v98 row_ror:12 row_mask:0xf bank_mask:0x4
    v_add_f32_dpp v10, v88, v10 row_ror:8 row_mask:0xf bank_mask:0x4
    v_add_f32_dpp v13, v80, v13 row_ror:4 row_mask:0xf bank_mask:0x2
    v_mfma_f32_16x16x32_bf16 v[136:139], v[144:147], v[24:27], 0
    v_mfma_f32_16x16x32_bf16 v[128:131], v[140:143], v[28:31], v[128:131]
    v_add_f32_dpp v12, v107, v106 row_ror:12 row_mask:0xf bank_mask:0x4
    v_add_f32_dpp v11, v96, v11 row_ror:8 row_mask:0xf bank_mask:0x4
    v_add_f32_dpp v10, v89, v10 row_ror:4 row_mask:0xf bank_mask:0x4
    v_mfma_f32_16x16x32_bf16 v[144:147], v[152:155], v[24:27], 0
    v_mfma_f32_16x16x32_bf16 v[136:139], v[148:151], v[28:31], v[136:139]
    v_add_f32_dpp v13, v115, v114 row_ror:12 row_mask:0xf bank_mask:0x4
    v_add_f32_dpp v12, v104, v12 row_ror:8 row_mask:0xf bank_mask:0x4
    v_add_f32_dpp v11, v97, v11 row_ror:4 row_mask:0xf bank_mask:0x4
    v_mfma_f32_16x16x32_bf16 v[144:147], v[156:159], v[28:31], v[144:147]
    v_add_f32_dpp v10, v120, v123 row_ror:12 row_mask:0xf bank_mask:0x8
    v_add_f32_dpp v13, v112, v13 row_ror:8 row_mask:0xf bank_mask:0x4
    v_add_f32_dpp v12, v105, v12 row_ror:4 row_mask:0xf bank_mask:0x4
    s_memrealtime s[8:9]
    s_waitcnt lgkmcnt(0)
    s_sub_u32 s8, s8, s30
    s_cmpk_ge_u32 s8, 1471
    s_nop 0
    s_cbranch_scc1 .ap_143
    s_waitcnt vmcnt(5)
    s_cmpk_ge_u32 s8, 1406
    s_cbranch_scc1 .ap_143
    s_waitcnt vmcnt(3)
    s_bitcmp1_b64 s[14:15], 38
    s_cbranch_scc0 1
    s_waitcnt vmcnt(2)
    s_cmpk_ge_u32 s8, 1331
    s_cbranch_scc1 .ap_143
    s_waitcnt vmcnt(1)
.ap_143:
    s_add_u32 s63, s69, 49152
    buffer_load_dwordx4 v[184:187], v2, s[44:47], s63 offen nt
    v_add_f32_dpp v11, v128, v131 row_ror:12 row_mask:0xf bank_mask:0x8
    v_add_f32_dpp v10, v121, v10 row_ror:8 row_mask:0xf bank_mask:0x8
    v_add_f32_dpp v13, v113, v13 row_ror:4 row_mask:0xf bank_mask:0x4
    v_add_f32_dpp v12, v136, v139 row_ror:12 row_mask:0xf bank_mask:0x8
    v_add_f32_dpp v11, v129, v11 row_ror:8 row_mask:0xf bank_mask:0x8
    v_add_f32_dpp v10, v122, v10 row_ror:4 row_mask:0xf bank_mask:0x8
    v_add_f32_dpp v13, v144, v147 row_ror:12 row_mask:0xf bank_mask:0x8
    v_add_f32_dpp v12, v137, v12 row_ror:8 row_mask:0xf bank_mask:0x8
    v_add_f32_dpp v11, v130, v11 row_ror:4 row_mask:0xf bank_mask:0x8
    v_add_f32_dpp v13, v145, v13 row_ror:8 row_mask:0xf bank_mask:0x8
    v_add_f32_dpp v12, v138, v12 row_ror:4 row_mask:0xf bank_mask:0x8
    s_memrealtime s[8:9]
    s_waitcnt lgkmcnt(0)
    s_sub_u32 s8, s8, s30
    s_cmpk_ge_u32 s8, 1498
    s_cbranch_scc1 .ap_144
    s_waitcnt vmcnt(5)
    s_cmpk_ge_u32 s8, 1433
    s_cbranch_scc1 .ap_144
    s_waitcnt vmcnt(3)
    s_bitcmp1_b64 s[14:15], 39
    s_cbranch_scc0 1
    s_waitcnt vmcnt(2)
    s_cmpk_ge_u32 s8, 1358
    s_cbranch_scc1 .ap_144
    s_waitcnt vmcnt(1)
.ap_144:
    s_add_u32 s63, s69, 57344
    buffer_load_dwordx4 v[188:191], v2, s[44:47], s63 offen nt
    v_add_f32_dpp v13, v146, v13 row_ror:4 row_mask:0xf bank_mask:0x8
    s_mov_b32 s60, 0x3db504f3
    s_mov_b32 s61, 0x3db504f3
    v_cvt_pk_bf16_f32 v10, v10, v11
    v_and_b32 v11, 0xffff0000, v10
    v_lshlrev_b32 v10, 16, v10
    v_cvt_pk_bf16_f32 v12, v12, v13
    v_and_b32 v13, 0xffff0000, v12
    v_lshlrev_b32 v12, 16, v12
    v_pk_mul_f32 v[10:11], v[10:11], s[60:61]
    v_pk_mul_f32 v[12:13], v[12:13], s[60:61]
    v_cvt_pk_bf16_f32 v10, v10, v11
    v_and_b32 v11, 0xffff0000, v10
    v_lshlrev_b32 v10, 16, v10
    v_cvt_pk_bf16_f32 v12, v12, v13
    v_and_b32 v13, 0xffff0000, v12
    v_lshlrev_b32 v12, 16, v12
    v_max_f32 v14, v10, v11
    v_max3_f32 v14, v14, v12, v13
    s_mov_b32 s60, 0x3fb8aa3b
    v_mov_b32 v22, s34
    v_mov_b32 v23, s34
    v_max_f32_dpp v14, v14, v14 quad_perm:[2,3,0,1] row_mask:0xf bank_mask:0xf
    s_nop 1
    v_max_f32_dpp v14, v14, v14 row_ror:4 row_mask:0xf bank_mask:0xf
    s_nop 1
    v_max_f32_dpp v14, v14, v14 row_ror:8 row_mask:0xf bank_mask:0xf
    v_mov_b32 v15, v14
    s_nop 1
    v_permlane16_swap_b32 v15, v14
    v_max_f32 v14, v15, v14
    v_mov_b32 v15, v14
    s_nop 1
    v_permlane32_swap_b32 v15, v14
    v_max_f32 v14, v15, v14
    v_mul_f32 v15, 0xbfb8aa3b, v14
    v_fma_f32 v10, v10, s60, v15
    v_fma_f32 v11, v11, s60, v15
    v_fma_f32 v12, v12, s60, v15
    v_fma_f32 v13, v13, s60, v15
    v_exp_f32 v10, v10
    v_exp_f32 v11, v11
    v_exp_f32 v12, v12
    v_exp_f32 v13, v13
    v_mov_b32 v20, v14
    v_pk_add_f32 v[16:17], v[10:11], v[12:13]
    v_add_f32 v21, v16, v17
    s_lshl3_add_u32 s60, s68, s3
    s_lshl_b32 s60, s60, 5
    s_add_u32 s60, s60, s59
    v_add_f32_dpp v21, v21, v21 quad_perm:[2,3,0,1] row_mask:0xf bank_mask:0xf
    s_nop 1
    v_add_f32_dpp v21, v21, v21 row_ror:4 row_mask:0xf bank_mask:0xf
    s_nop 1
    v_add_f32_dpp v21, v21, v21 row_ror:8 row_mask:0xf bank_mask:0xf
    v_mov_b32 v15, v21
    s_nop 1
    v_permlane16_swap_b32 v15, v21
    v_add_f32 v21, v15, v21
    v_mov_b32 v15, v21
    s_nop 1
    v_permlane32_swap_b32 v15, v21
    v_add_f32 v21, v15, v21
    s_mov_b64 exec, 3
    buffer_store_dwordx4 v[20:23], v2, s[36:39], s60 offen sc1
    s_mov_b64 exec, -1
    s_memrealtime s[8:9]
    s_waitcnt vmcnt(8)
    s_waitcnt lgkmcnt(0)
    s_sub_u32 s8, s8, s30
    s_cmpk_ge_u32 s8, 1525
    s_cbranch_scc1 .ap_145
    s_waitcnt vmcnt(5)
    s_cmpk_ge_u32 s8, 1460
    s_cbranch_scc1 .ap_145
    s_waitcnt vmcnt(3)
    s_bitcmp1_b64 s[14:15], 40
    s_cbranch_scc0 1
    s_waitcnt vmcnt(2)
    s_cmpk_ge_u32 s8, 1385
    s_cbranch_scc1 .ap_145
    s_waitcnt vmcnt(1)
.ap_145:
    s_add_u32 s63, s69, 131072
    buffer_load_dwordx4 v[192:195], v2, s[44:47], s63 offen nt
    s_sub_u32 s57, s65, 9
    s_bitcmp1_b32 s57, 0
    s_cselect_b32 s48, s20, s18
    s_cselect_b32 s49, s21, s19
    s_cselect_b32 s33, 36, 0
    s_and_b32 s49, s49, 0xffff
    s_mov_b32 s50, 0x510000
    s_mov_b32 s51, 0x00020000
    s_mov_b32 s52, s22
    s_and_b32 s53, s23, 0xffff
    s_mov_b32 s54, 0x510000
    s_mov_b32 s55, 0x00020000
    s_lshr_b32 s57, s57, 1
    s_lshl_b32 s57, s57, 7
    s_mul_i32 s101, s64, 1152
    s_add_u32 s101, s101, s57
    s_mul_i32 s56, s3, 73728
    s_add_u32 s101, s101, s56
    s_mul_i32 s56, s64, 72
    s_add_u32 s33, s33, s56
    s_add_u32 s33, s33, s3
    s_mul_i32 s33, s33, 9216
    s_add_u32 s33, s33, s57
    s_bfe_u32 s56, s101, 0x30007
    s_cmp_eq_u32 s56, 3
    s_cselect_b32 s43, 1, 0
    v_bfe_u32 v16, v0, 4, 1
    s_and_b32 s56, s3, 3
    s_lshl_b32 s56, s56, 1
    v_or_b32 v16, s56, v16
    v_and_b32 v6, 7, v0
    v_xor_b32 v16, v16, v6
    v_lshrrev_b32 v6, 3, v0
    v_mul_u32_u24 v6, 9216, v6
    v_lshl_add_u32 v6, v16, 4, v6
    v_bfe_u32 v16, v0, 4, 1
    s_and_b32 s56, s3, 1
    s_lshl_b32 s56, s56, 2
    v_lshl_or_b32 v16, v16, 1, s56
    v_and_b32 v17, 7, v0
    v_xor_b32 v16, v16, v17
    v_lshrrev_b32 v17, 3, v0
    v_mul_u32_u24 v17, 1152, v17
    v_lshl_add_u32 v31, v16, 4, v17
    s_memrealtime s[8:9]
    s_waitcnt vmcnt(8)
    s_waitcnt lgkmcnt(0)
    s_sub_u32 s8, s8, s30
    s_cmpk_ge_u32 s8, 1552
    s_cbranch_scc1 .ap_146
    s_waitcnt vmcnt(5)
    s_cmpk_ge_u32 s8, 1487
    s_cbranch_scc1 .ap_146
    s_waitcnt vmcnt(3)
    s_bitcmp1_b64 s[14:15], 41
    s_cbranch_scc0 1
    s_waitcnt vmcnt(2)
    s_cmpk_ge_u32 s8, 1412
    s_cbranch_scc1 .ap_146
    s_waitcnt vmcnt(1)
.ap_146:
    s_add_u32 s63, s69, 139264
    buffer_load_dwordx4 v[196:199], v2, s[44:47], s63 offen nt
    s_cmp_eq_u32 s43, 0
    s_cbranch_scc1 .sl_147
    s_lshl_b32 s32, s3, 10
    s_add_u32 m0, s32, 0
    s_add_u32 s56, s101, 0
    buffer_load_dwordx4 v6, s[48:51], s56 offen nt lds
.sl_147:
    s_memrealtime s[8:9]
    s_waitcnt vmcnt(8)
    s_waitcnt lgkmcnt(0)
    s_sub_u32 s8, s8, s30
    s_cmpk_ge_u32 s8, 1579
    s_cbranch_scc1 .ap_148
    s_waitcnt vmcnt(5)
    s_cmpk_ge_u32 s8, 1514
    s_cbranch_scc1 .ap_148
    s_waitcnt vmcnt(3)
    s_bitcmp1_b64 s[14:15], 42
    s_cbranch_scc0 1
    s_waitcnt vmcnt(2)
    s_cmpk_ge_u32 s8, 1439
    s_cbranch_scc1 .ap_148
    s_waitcnt vmcnt(1)
.ap_148:
    s_add_u32 s63, s69, 147456
    buffer_load_dwordx4 v[200:203], v2, s[44:47], s63 offen nt
    s_memrealtime s[8:9]
    s_waitcnt vmcnt(8)
    s_waitcnt lgkmcnt(0)
    s_sub_u32 s8, s8, s30
    s_cmpk_ge_u32 s8, 1606
    s_cbranch_scc1 .ap_149
    s_waitcnt vmcnt(5)
    s_cmpk_ge_u32 s8, 1541
    s_cbranch_scc1 .ap_149
    s_waitcnt vmcnt(3)
    s_bitcmp1_b64 s[14:15], 43
    s_cbranch_scc0 1
    s_waitcnt vmcnt(2)
    s_cmpk_ge_u32 s8, 1466
    s_cbranch_scc1 .ap_149
    s_waitcnt vmcnt(1)
.ap_149:
    s_add_u32 s63, s69, 155648
    buffer_load_dwordx4 v[204:207], v2, s[44:47], s63 offen nt
    s_cmp_eq_u32 s43, 0
    s_cbranch_scc1 .sl_150
    s_lshl_b32 s32, s3, 10
    s_add_u32 m0, s32, 8192
    s_add_u32 s56, s101, 589824
    buffer_load_dwordx4 v6, s[48:51], s56 offen nt lds
.sl_150:
    s_memrealtime s[8:9]
    s_waitcnt vmcnt(8)
    s_waitcnt lgkmcnt(0)
    s_sub_u32 s8, s8, s30
    s_cmpk_ge_u32 s8, 1633
    s_cbranch_scc1 .ap_151
    s_waitcnt vmcnt(5)
    s_cmpk_ge_u32 s8, 1568
    s_cbranch_scc1 .ap_151
    s_waitcnt vmcnt(3)
    s_bitcmp1_b64 s[14:15], 44
    s_cbranch_scc0 1
    s_waitcnt vmcnt(2)
    s_cmpk_ge_u32 s8, 1493
    s_cbranch_scc1 .ap_151
    s_waitcnt vmcnt(1)
.ap_151:
    s_add_u32 s63, s69, 163840
    buffer_load_dwordx4 v[208:211], v2, s[44:47], s63 offen nt
    s_memrealtime s[8:9]
    s_waitcnt vmcnt(8)
    s_waitcnt lgkmcnt(0)
    s_sub_u32 s8, s8, s30
    s_cmpk_ge_u32 s8, 1660
    s_cbranch_scc1 .ap_152
    s_waitcnt vmcnt(5)
    s_cmpk_ge_u32 s8, 1595
    s_cbranch_scc1 .ap_152
    s_waitcnt vmcnt(3)
    s_bitcmp1_b64 s[14:15], 45
    s_cbranch_scc0 1
    s_waitcnt vmcnt(2)
    s_cmpk_ge_u32 s8, 1520
    s_cbranch_scc1 .ap_152
    s_waitcnt vmcnt(1)
.ap_152:
    s_add_u32 s63, s69, 172032
    buffer_load_dwordx4 v[212:215], v2, s[44:47], s63 offen nt
    s_cmp_eq_u32 s43, 0
    s_cbranch_scc1 .sl_153
    s_lshl_b32 s32, s3, 10
    s_add_u32 m0, s32, 16384
    s_add_u32 s56, s101, 1179648
    buffer_load_dwordx4 v6, s[48:51], s56 offen nt lds
.sl_153:
    s_memrealtime s[8:9]
    s_waitcnt vmcnt(8)
    s_waitcnt lgkmcnt(0)
    s_sub_u32 s8, s8, s30
    s_cmpk_ge_u32 s8, 1691
    s_cbranch_scc1 .ap_154
    s_waitcnt vmcnt(5)
    s_cmpk_ge_u32 s8, 1626
    s_cbranch_scc1 .ap_154
    s_waitcnt vmcnt(3)
    s_bitcmp1_b64 s[14:15], 46
    s_cbranch_scc0 1
    s_waitcnt vmcnt(2)
    s_cmpk_ge_u32 s8, 1551
    s_cbranch_scc1 .ap_154
    s_waitcnt vmcnt(1)
.ap_154:
    s_add_u32 s63, s69, 180224
    buffer_load_dwordx4 v[216:219], v2, s[44:47], s63 offen nt
    s_memrealtime s[8:9]
    s_waitcnt vmcnt(8)
    s_waitcnt lgkmcnt(0)
    s_sub_u32 s8, s8, s30
    s_cmpk_ge_u32 s8, 1722
    s_cbranch_scc1 .ap_155
    s_waitcnt vmcnt(5)
    s_cmpk_ge_u32 s8, 1657
    s_cbranch_scc1 .ap_155
    s_waitcnt vmcnt(3)
    s_bitcmp1_b64 s[14:15], 47
    s_cbranch_scc0 1
    s_waitcnt vmcnt(2)
    s_cmpk_ge_u32 s8, 1582
    s_cbranch_scc1 .ap_155
    s_waitcnt vmcnt(1)
.ap_155:
    s_add_u32 s63, s69, 188416
    buffer_load_dwordx4 v[220:223], v2, s[44:47], s63 offen nt
    s_mul_i32 s99, s3, 2304
    s_add_u32 s99, s99, 0x1e000
    buffer_load_dwordx4 v[32:35], v2, s[36:39], s99 offen offset:0
    buffer_load_dwordx4 v[40:43], v2, s[36:39], s99 offen offset:1024
    buffer_load_dwordx2 v[48:49], v5, s[36:39], s99 offen offset:0
    s_memrealtime s[8:9]
    s_waitcnt vmcnt(11)
    s_waitcnt lgkmcnt(0)
    s_sub_u32 s8, s8, s30
    s_cmpk_ge_u32 s8, 1753
    s_cbranch_scc1 .ap_156
    s_waitcnt vmcnt(8)
    s_cmpk_ge_u32 s8, 1688
    s_cbranch_scc1 .ap_156
    s_waitcnt vmcnt(6)
    s_bitcmp1_b64 s[14:15], 48
    s_cbranch_scc0 1
    s_waitcnt vmcnt(5)
    s_cmpk_ge_u32 s8, 1613
    s_cbranch_scc1 .ap_156
    s_waitcnt vmcnt(4)
.ap_156:
    s_add_u32 s63, s69, 262144
    buffer_load_dwordx4 v[224:227], v2, s[44:47], s63 offen nt
    s_memrealtime s[8:9]
    s_waitcnt vmcnt(11)
    s_waitcnt lgkmcnt(0)
    s_sub_u32 s8, s8, s30
    s_cmpk_ge_u32 s8, 1784
    s_cbranch_scc1 .ap_157
    s_waitcnt vmcnt(8)
    s_cmpk_ge_u32 s8, 1719
    s_cbranch_scc1 .ap_157
    s_waitcnt vmcnt(6)
    s_bitcmp1_b64 s[14:15], 49
    s_cbranch_scc0 1
    s_waitcnt vmcnt(5)
    s_cmpk_ge_u32 s8, 1644
    s_cbranch_scc1 .ap_157
    s_waitcnt vmcnt(4)
.ap_157:
    s_add_u32 s63, s69, 270336
    buffer_load_dwordx4 v[228:231], v2, s[44:47], s63 offen nt
    s_mul_i32 s100, s3, 2304
    s_add_u32 s100, s100, 0x27000
    buffer_load_dwordx4 v[56:59], v2, s[36:39], s100 offen offset:0
    buffer_load_dwordx4 v[64:67], v2, s[36:39], s100 offen offset:1024
    buffer_load_dwordx2 v[50:51], v5, s[36:39], s100 offen offset:0
    s_memrealtime s[8:9]
    s_waitcnt vmcnt(14)
    s_waitcnt lgkmcnt(0)
    s_sub_u32 s8, s8, s30
    s_cmpk_ge_u32 s8, 1815
    s_cbranch_scc1 .ap_158
    s_waitcnt vmcnt(11)
    s_cmpk_ge_u32 s8, 1750
    s_cbranch_scc1 .ap_158
    s_waitcnt vmcnt(9)
    s_bitcmp1_b64 s[14:15], 50
    s_cbranch_scc0 1
    s_waitcnt vmcnt(8)
    s_cmpk_ge_u32 s8, 1675
    s_cbranch_scc1 .ap_158
    s_waitcnt vmcnt(4)
.ap_158:
    s_add_u32 s63, s69, 278528
    buffer_load_dwordx4 v[232:235], v2, s[44:47], s63 offen nt
    s_memrealtime s[8:9]
    s_waitcnt vmcnt(14)
    s_waitcnt lgkmcnt(0)
    s_sub_u32 s8, s8, s30
    s_cmpk_ge_u32 s8, 1846
    s_cbranch_scc1 .ap_159
    s_waitcnt vmcnt(11)
    s_cmpk_ge_u32 s8, 1781
    s_cbranch_scc1 .ap_159
    s_waitcnt vmcnt(9)
    s_bitcmp1_b64 s[14:15], 51
    s_cbranch_scc0 1
    s_waitcnt vmcnt(5)
    s_cmpk_ge_u32 s8, 1706
    s_cbranch_scc1 .ap_159
    s_waitcnt vmcnt(4)
.ap_159:
    s_add_u32 s63, s69, 286720
    buffer_load_dwordx4 v[236:239], v2, s[44:47], s63 offen nt
    s_memrealtime s[8:9]
    s_waitcnt vmcnt(14)
    s_waitcnt lgkmcnt(0)
    s_sub_u32 s8, s8, s30
    s_cmpk_ge_u32 s8, 1877
    s_cbranch_scc1 .ap_160
    s_waitcnt vmcnt(11)
    s_cmpk_ge_u32 s8, 1812
    s_cbranch_scc1 .ap_160
    s_waitcnt vmcnt(6)
    s_bitcmp1_b64 s[14:15], 52
    s_cbranch_scc0 1
    s_waitcnt vmcnt(5)
    s_cmpk_ge_u32 s8, 1737
    s_cbranch_scc1 .ap_160
    s_waitcnt vmcnt(1)
.ap_160:
    s_add_u32 s63, s69, 294912
    buffer_load_dwordx4 v[240:243], v2, s[44:47], s63 offen nt
    s_memrealtime s[8:9]
    s_waitcnt vmcnt(14)
    s_waitcnt lgkmcnt(0)
    s_sub_u32 s8, s8, s30
    s_cmpk_ge_u32 s8, 1908
    s_cbranch_scc1 .ap_161
    s_waitcnt vmcnt(11)
    s_cmpk_ge_u32 s8, 1843
    s_cbranch_scc1 .ap_161
    s_waitcnt vmcnt(6)
    s_bitcmp1_b64 s[14:15], 53
    s_cbranch_scc0 1
    s_waitcnt vmcnt(2)
    s_cmpk_ge_u32 s8, 1768
    s_cbranch_scc1 .ap_161
    s_waitcnt vmcnt(1)
.ap_161:
    s_add_u32 s63, s69, 303104
    buffer_load_dwordx4 v[244:247], v2, s[44:47], s63 offen nt
    s_and_b32 s0, s0, 0xffffff80
    s_sub_u32 s0, s0, 1024
    buffer_load_dword v28, v4, s[36:39], s0 offen sc1
    buffer_load_dwordx4 v[24:27], v9, s[36:39], s59 offen offset:0 sc1
    s_memrealtime s[8:9]
    s_waitcnt vmcnt(15)
    s_waitcnt lgkmcnt(0)
    s_sub_u32 s8, s8, s30
    s_cmpk_ge_u32 s8, 1939
    s_cbranch_scc1 .ap_162
    s_waitcnt vmcnt(9)
    s_cmpk_ge_u32 s8, 1874
    s_cbranch_scc1 .ap_162
    s_waitcnt vmcnt(4)
    s_bitcmp1_b64 s[14:15], 54
    s_cbranch_scc0 1
    s_waitcnt vmcnt(3)
    s_cmpk_ge_u32 s8, 1799
    s_cbranch_scc1 .ap_162
    s_waitcnt vmcnt(2)
.ap_162:
    s_add_u32 s63, s69, 311296
    buffer_load_dwordx4 v[248:251], v2, s[44:47], s63 offen nt
    s_memrealtime s[8:9]
    s_waitcnt vmcnt(15)
    s_waitcnt lgkmcnt(0)
    s_sub_u32 s8, s8, s30
    s_cmpk_ge_u32 s8, 1970
    s_cbranch_scc1 .ap_163
    s_waitcnt vmcnt(6)
    s_cmpk_ge_u32 s8, 1905
    s_cbranch_scc1 .ap_163
    s_waitcnt vmcnt(4)
    s_bitcmp1_b64 s[14:15], 55
    s_cbranch_scc0 1
    s_waitcnt vmcnt(3)
    s_cmpk_ge_u32 s8, 1830
    s_cbranch_scc1 .ap_163
    s_waitcnt vmcnt(1)
.ap_163:
    s_add_u32 s63, s69, 319488
    buffer_load_dwordx4 v[252:255], v2, s[44:47], s63 offen nt
    s_memrealtime s[8:9]
    s_waitcnt vmcnt(12)
    s_waitcnt lgkmcnt(0)
    s_sub_u32 s8, s8, s30
    s_cmpk_ge_u32 s8, 2001
    s_cbranch_scc1 .ap_164
    s_waitcnt vmcnt(6)
    s_cmpk_ge_u32 s8, 1936
    s_cbranch_scc1 .ap_164
    s_waitcnt vmcnt(4)
    s_bitcmp1_b64 s[14:15], 56
    s_cbranch_scc0 1
    s_waitcnt vmcnt(2)
    s_cmpk_ge_u32 s8, 1861
    s_cbranch_scc1 .ap_164
    s_waitcnt vmcnt(1)
.ap_164:
    s_add_u32 s63, s69, 393216
    buffer_load_dwordx4 v[36:39], v2, s[44:47], s63 offen nt
    s_memrealtime s[8:9]
    s_waitcnt vmcnt(12)
    s_waitcnt lgkmcnt(0)
    s_sub_u32 s8, s8, s30
    s_cmpk_ge_u32 s8, 2032
    s_cbranch_scc1 .ap_165
    s_waitcnt vmcnt(6)
    s_cmpk_ge_u32 s8, 1967
    s_cbranch_scc1 .ap_165
    s_waitcnt vmcnt(3)
    s_bitcmp1_b64 s[14:15], 57
    s_cbranch_scc0 1
    s_waitcnt vmcnt(2)
    s_cmpk_ge_u32 s8, 1892
    s_cbranch_scc1 .ap_165
    s_waitcnt vmcnt(1)
.ap_165:
    s_add_u32 s63, s69, 401408
    buffer_load_dwordx4 v[44:47], v2, s[44:47], s63 offen nt
    s_memrealtime s[8:9]
    s_waitcnt vmcnt(9)
    s_waitcnt lgkmcnt(0)
    s_sub_u32 s8, s8, s30
    s_cmpk_ge_u32 s8, 2063
    s_cbranch_scc1 .ap_166
    s_waitcnt vmcnt(6)
    s_cmpk_ge_u32 s8, 1998
    s_cbranch_scc1 .ap_166
    s_waitcnt vmcnt(3)
    s_bitcmp1_b64 s[14:15], 58
    s_cbranch_scc0 1
    s_waitcnt vmcnt(2)
    s_cmpk_ge_u32 s8, 1923
    s_cbranch_scc1 .ap_166
    s_waitcnt vmcnt(1)
.ap_166:
    s_add_u32 s63, s69, 409600
    buffer_load_dwordx4 v[52:55], v2, s[44:47], s63 offen nt
    s_waitcnt vmcnt(5)
    s_branch .gpc_168
.gp_167:
    buffer_load_dwordx4 v[24:27], v9, s[36:39], s59 offen offset:0 sc1
    s_waitcnt vmcnt(0)
.gpc_168:
    v_cmp_eq_u32 vcc, s34, v26
    s_cmp_eq_u64 vcc, exec
    s_nop 3
    s_cbranch_scc1 .gpd_169
    s_sub_u32 s35, s35, 1
    s_cbranch_scc1 .Lexit
    s_sleep 1
    s_branch .gp_167
.gpd_169:
    v_cmp_eq_u32 vcc, s1, v28
    s_cmp_eq_u64 vcc, -1
    s_cselect_b32 s0, 0xac000, 0
    v_mov_b32 v16, v24
    s_nop 1
    v_max_f32_dpp v16, v16, v16 row_ror:8 row_mask:0xf bank_mask:0xf
    s_nop 1
    v_max_f32_dpp v16, v16, v16 row_ror:4 row_mask:0xf bank_mask:0xf
    v_mov_b32 v17, v16
    s_nop 1
    v_permlane16_swap_b32 v17, v16
    v_max_f32 v16, v17, v16
    v_mov_b32 v17, v16
    s_nop 1
    v_permlane32_swap_b32 v17, v16
    v_max_f32 v16, v17, v16
    v_sub_f32 v17, v24, v16
    v_sub_f32 v18, v14, v16
    v_mul_f32 v17, 0x3fb8aa3b, v17
    v_mul_f32 v18, 0x3fb8aa3b, v18
    v_exp_f32 v17, v17
    v_exp_f32 v18, v18
    v_mul_f32 v17, v17, v25
    s_nop 1
    v_add_f32_dpp v17, v17, v17 row_ror:8 row_mask:0xf bank_mask:0xf
    s_nop 1
    v_add_f32_dpp v17, v17, v17 row_ror:4 row_mask:0xf bank_mask:0xf
    v_mov_b32 v19, v17
    s_nop 1
    v_permlane16_swap_b32 v19, v17
    v_add_f32 v17, v19, v17
    v_mov_b32 v19, v17
    s_nop 1
    v_permlane32_swap_b32 v19, v17
    v_add_f32 v17, v19, v17
    v_rcp_f32 v19, v17
    s_nop 0
    v_fma_f32 v15, -v17, v19, 1.0
    v_fma_f32 v19, v15, v19, v19
    v_mul_f32 v18, v18, v19
    v_mul_f32 v10, v10, v18
    v_mul_f32 v11, v11, v18
    v_mul_f32 v12, v12, v18
    v_mul_f32 v13, v13, v18
    v_mov_b32_dpp v112, v10 quad_perm:[2,3,0,1] row_mask:0xf bank_mask:0xf
    v_mov_b32_dpp v113, v11 quad_perm:[2,3,0,1] row_mask:0xf bank_mask:0xf
    v_mov_b32_dpp v114, v12 quad_perm:[2,3,0,1] row_mask:0xf bank_mask:0xf
    v_mov_b32_dpp v115, v13 quad_perm:[2,3,0,1] row_mask:0xf bank_mask:0xf
    v_cvt_pk_bf16_f32 v96, v10, v112
    v_cvt_pk_bf16_f32 v100, v11, v113
    v_cvt_pk_bf16_f32 v104, v12, v114
    v_cvt_pk_bf16_f32 v108, v13, v115
    v_mov_b32_dpp v97, v96 row_ror:12 row_mask:0xf bank_mask:0xf
    v_mov_b32_dpp v101, v100 row_ror:12 row_mask:0xf bank_mask:0xf
    v_mov_b32_dpp v105, v104 row_ror:12 row_mask:0xf bank_mask:0xf
    v_mov_b32_dpp v109, v108 row_ror:12 row_mask:0xf bank_mask:0xf
    v_mov_b32_dpp v98, v96 row_ror:8 row_mask:0xf bank_mask:0xf
    v_mov_b32_dpp v102, v100 row_ror:8 row_mask:0xf bank_mask:0xf
    v_mov_b32_dpp v106, v104 row_ror:8 row_mask:0xf bank_mask:0xf
    v_mov_b32_dpp v110, v108 row_ror:8 row_mask:0xf bank_mask:0xf
    v_mov_b32_dpp v99, v96 row_ror:4 row_mask:0xf bank_mask:0xf
    v_mov_b32_dpp v103, v100 row_ror:4 row_mask:0xf bank_mask:0xf
    v_mov_b32_dpp v107, v104 row_ror:4 row_mask:0xf bank_mask:0xf
    v_mov_b32_dpp v111, v108 row_ror:4 row_mask:0xf bank_mask:0xf
    s_memrealtime s[8:9]
    s_waitcnt lgkmcnt(0)
    s_sub_u32 s8, s8, s30
    s_cmpk_ge_u32 s8, 2094
    s_cbranch_scc1 .ap_170
    s_waitcnt vmcnt(5)
    s_cmpk_ge_u32 s8, 2029
    s_cbranch_scc1 .ap_170
    s_waitcnt vmcnt(3)
    s_bitcmp1_b64 s[14:15], 59
    s_cbranch_scc0 1
    s_waitcnt vmcnt(2)
    s_cmpk_ge_u32 s8, 1954
    s_cbranch_scc1 .ap_170
    s_waitcnt vmcnt(1)
.ap_170:
    s_add_u32 s63, s69, 417792
    buffer_load_dwordx4 v[60:63], v2, s[44:47], s63 offen nt
    s_lshl_b32 s60, s3, 10
    s_add_u32 s60, s60, 132096
    v_lshlrev_b32 v10, 5, v0
    v_add_u32 v10, s60, v10
    v_lshrrev_b32 v11, 5, v0
    v_lshlrev_b32 v11, 13, v11
    v_and_b32 v12, 31, v0
    v_lshl_add_u32 v11, v12, 4, v11
    v_add_u32 v9, 132096, v2
    v_mov_b32 v15, s34
    v_mov_b32 v13, 110592
    s_mov_b32 s1, s43
    v_bfe_u32 v16, v0, 1, 3
    v_mul_u32_u24 v16, 1312, v16
    v_lshrrev_b32 v7, 4, v0
    v_lshl_add_u32 v16, v7, 5, v16
    v_and_b32 v7, 1, v0
    v_lshl_add_u32 v16, v7, 4, v16
    v_add_u32 v16, 147456, v16
    s_mul_i32 s56, s3, 1312
    s_add_u32 s56, s56, 147456
    v_add_u32 v17, s56, v3
    v_add_u32 v18, s56, v4
    v_lshrrev_b32 v7, 4, v0
    v_bfe_u32 v8, v0, 1, 1
    v_lshl_add_u32 v7, v7, 1, v8
    v_bfe_u32 v8, v0, 2, 2
    v_lshl_add_u32 v19, v7, 3, v8
    v_lshlrev_b32 v19, 7, v19
    v_and_b32 v7, 3, v7
    v_lshrrev_b32 v8, 1, v8
    v_lshl_add_u32 v7, v7, 1, v8
    v_xor_b32 v7, s3, v7
    v_lshl_add_u32 v19, v7, 4, v19
    v_and_b32 v7, 1, v0
    v_lshl_add_u32 v19, v7, 3, v19
    v_add_u32 v20, 32768, v19
    v_lshrrev_b32 v7, 4, v0
    v_bfe_u32 v8, v0, 2, 2
    v_lshl_add_u32 v21, v7, 3, v8
    v_lshlrev_b32 v21, 7, v21
    v_and_b32 v7, 1, v7
    v_lshrrev_b32 v8, 1, v8
    v_lshl_add_u32 v7, v7, 1, v8
    s_and_b32 s56, s3, 1
    s_lshl_b32 s56, s56, 1
    v_xor_b32 v7, s56, v7
    v_and_b32 v8, 3, v0
    v_lshl_add_u32 v21, v8, 3, v21
    s_lshr_b32 s56, s3, 1
    s_mul_i32 s56, s56, 12288
    s_add_u32 s56, s56, 73728
    v_add_u32 v21, s56, v21
    v_xor_b32 v8, 1, v7
    v_lshl_add_u32 v22, v8, 5, v21
    v_lshl_add_u32 v21, v7, 5, v21
    v_bfe_u32 v7, v0, 1, 3
    v_mul_u32_u24 v23, 1312, v7
    v_mul_u32_u24 v24, 272, v7
    v_and_b32 v7, 48, v0
    s_lshr_b32 s56, s3, 1
    s_mul_i32 s57, s56, 192
    s_add_u32 s57, s57, 110592
    v_add3_u32 v23, v23, v7, s57
    s_mul_i32 s56, s56, 2176
    s_and_b32 s57, s3, 1
    s_lshl_b32 s57, s57, 7
    s_add_u32 s56, s56, s57
    s_add_u32 s56, s56, 122880
    v_add3_u32 v24, v24, v7, s56
    v_and_b32 v7, 1, v0
    v_lshl_add_u32 v24, v7, 6, v24
    v_and_b32 v7, 15, v0
    s_mul_i32 s56, s3, 272
    s_add_u32 s56, s56, 122880
    v_lshl_add_u32 v25, v7, 4, s56
    v_bfe_u32 v26, v0, 1, 4
    v_lshlrev_b32 v26, 4, v26
    s_mul_i32 s56, s3, 72
    v_add_u32 v7, s56, v0
    v_lshrrev_b32 v8, 4, v7
    v_lshlrev_b32 v27, 9, v8
    v_and_b32 v29, 15, v7
    v_lshl_add_u32 v27, v29, 4, v27
    v_and_b32 v29, 7, v7
    v_mul_u32_u24 v29, 1312, v29
    v_and_b32 v7, -8, v7
    v_add3_u32 v29, v29, v7, v13
    v_and_b32 v7, 7, v0
    v_add3_u32 v7, v7, s56, 64
    v_lshrrev_b32 v8, 4, v7
    v_lshlrev_b32 v28, 9, v8
    v_and_b32 v30, 15, v7
    v_lshl_add_u32 v28, v30, 4, v28
    v_and_b32 v30, 7, v7
    v_mul_u32_u24 v30, 1312, v30
    v_and_b32 v7, -8, v7
    v_add3_u32 v30, v30, v7, v13
    s_memrealtime s[8:9]
    s_waitcnt lgkmcnt(0)
    s_sub_u32 s8, s8, s30
    s_cmpk_ge_u32 s8, 2125
    s_cbranch_scc1 .ap_171
    s_waitcnt vmcnt(5)
    s_cmpk_ge_u32 s8, 2060
    s_cbranch_scc1 .ap_171
    s_waitcnt vmcnt(3)
    s_bitcmp1_b64 s[14:15], 60
    s_cbranch_scc0 1
    s_waitcnt vmcnt(2)
    s_cmpk_ge_u32 s8, 1985
    s_cbranch_scc1 .ap_171
    s_waitcnt vmcnt(1)
.ap_171:
    s_add_u32 s63, s69, 425984
    buffer_load_dwordx4 v[68:71], v2, s[44:47], s63 offen nt
    v_perm_b32 v112, v164, v160, s94
    v_perm_b32 v113, v172, v168, s94
    v_perm_b32 v114, v180, v176, s94
    v_perm_b32 v115, v188, v184, s94
    s_nop 1
    v_mfma_f32_16x16x32_bf16 v[128:131], v[96:99], v[112:115], 0
    v_perm_b32 v116, v164, v160, s95
    v_perm_b32 v117, v172, v168, s95
    v_perm_b32 v118, v180, v176, s95
    v_perm_b32 v119, v188, v184, s95
    s_nop 1
    v_mfma_f32_16x16x32_bf16 v[132:135], v[96:99], v[116:119], 0
    v_perm_b32 v120, v165, v161, s94
    v_perm_b32 v121, v173, v169, s94
    v_perm_b32 v122, v181, v177, s94
    v_perm_b32 v123, v189, v185, s94
    s_nop 1
    v_mfma_f32_16x16x32_bf16 v[136:139], v[96:99], v[120:123], 0
    v_perm_b32 v124, v165, v161, s95
    v_perm_b32 v125, v173, v169, s95
    v_perm_b32 v126, v181, v177, s95
    v_perm_b32 v127, v189, v185, s95
    s_nop 1
    v_mfma_f32_16x16x32_bf16 v[140:143], v[96:99], v[124:127], 0
    v_perm_b32 v112, v166, v162, s94
    v_perm_b32 v113, v174, v170, s94
    v_perm_b32 v114, v182, v178, s94
    v_perm_b32 v115, v190, v186, s94
    s_nop 1
    v_mfma_f32_16x16x32_bf16 v[144:147], v[96:99], v[112:115], 0
    v_perm_b32 v116, v166, v162, s95
    v_perm_b32 v117, v174, v170, s95
    v_perm_b32 v118, v182, v178, s95
    v_perm_b32 v119, v190, v186, s95
    s_nop 1
    v_mfma_f32_16x16x32_bf16 v[148:151], v[96:99], v[116:119], 0
    v_perm_b32 v120, v167, v163, s94
    v_perm_b32 v121, v175, v171, s94
    v_perm_b32 v122, v183, v179, s94
    v_perm_b32 v123, v191, v187, s94
    s_nop 1
    v_mfma_f32_16x16x32_bf16 v[152:155], v[96:99], v[120:123], 0
    v_perm_b32 v124, v167, v163, s95
    v_perm_b32 v125, v175, v171, s95
    v_perm_b32 v126, v183, v179, s95
    v_perm_b32 v127, v191, v187, s95
    s_nop 1
    v_mfma_f32_16x16x32_bf16 v[156:159], v[96:99], v[124:127], 0
    s_memrealtime s[8:9]
    s_waitcnt lgkmcnt(0)
    s_sub_u32 s8, s8, s30
    s_cmpk_ge_u32 s8, 2156
    s_nop 3
    s_cbranch_scc1 .ap_172
    s_waitcnt vmcnt(5)
    s_cmpk_ge_u32 s8, 2091
    s_cbranch_scc1 .ap_172
    s_waitcnt vmcnt(3)
    s_bitcmp1_b64 s[14:15], 61
    s_cbranch_scc0 1
    s_waitcnt vmcnt(2)
    s_cmpk_ge_u32 s8, 2016
    s_cbranch_scc1 .ap_172
    s_waitcnt vmcnt(1)
.ap_172:
    s_add_u32 s63, s69, 434176
    buffer_load_dwordx4 v[76:79], v2, s[44:47], s63 offen nt
    v_perm_b32 v112, v196, v192, s94
    v_perm_b32 v113, v204, v200, s94
    v_perm_b32 v114, v212, v208, s94
    v_perm_b32 v115, v220, v216, s94
    s_nop 1
    v_mfma_f32_16x16x32_bf16 v[128:131], v[100:103], v[112:115], v[128:131]
    v_perm_b32 v116, v196, v192, s95
    v_perm_b32 v117, v204, v200, s95
    v_perm_b32 v118, v212, v208, s95
    v_perm_b32 v119, v220, v216, s95
    s_nop 1
    v_mfma_f32_16x16x32_bf16 v[132:135], v[100:103], v[116:119], v[132:135]
    v_perm_b32 v120, v197, v193, s94
    v_perm_b32 v121, v205, v201, s94
    v_perm_b32 v122, v213, v209, s94
    v_perm_b32 v123, v221, v217, s94
    s_nop 1
    v_mfma_f32_16x16x32_bf16 v[136:139], v[100:103], v[120:123], v[136:139]
    v_perm_b32 v124, v197, v193, s95
    v_perm_b32 v125, v205, v201, s95
    v_perm_b32 v126, v213, v209, s95
    v_perm_b32 v127, v221, v217, s95
    s_nop 1
    v_mfma_f32_16x16x32_bf16 v[140:143], v[100:103], v[124:127], v[140:143]
    v_perm_b32 v112, v198, v194, s94
    v_perm_b32 v113, v206, v202, s94
    v_perm_b32 v114, v214, v210, s94
    v_perm_b32 v115, v222, v218, s94
    s_nop 1
    v_mfma_f32_16x16x32_bf16 v[144:147], v[100:103], v[112:115], v[144:147]
    v_perm_b32 v116, v198, v194, s95
    v_perm_b32 v117, v206, v202, s95
    v_perm_b32 v118, v214, v210, s95
    v_perm_b32 v119, v222, v218, s95
    s_nop 1
    v_mfma_f32_16x16x32_bf16 v[148:151], v[100:103], v[116:119], v[148:151]
    v_perm_b32 v120, v199, v195, s94
    v_perm_b32 v121, v207, v203, s94
    v_perm_b32 v122, v215, v211, s94
    v_perm_b32 v123, v223, v219, s94
    s_nop 1
    v_mfma_f32_16x16x32_bf16 v[152:155], v[100:103], v[120:123], v[152:155]
    v_perm_b32 v124, v199, v195, s95
    v_perm_b32 v125, v207, v203, s95
    v_perm_b32 v126, v215, v211, s95
    v_perm_b32 v127, v223, v219, s95
    s_nop 1
    v_mfma_f32_16x16x32_bf16 v[156:159], v[100:103], v[124:127], v[156:159]
    s_memrealtime s[8:9]
    s_waitcnt lgkmcnt(0)
    s_sub_u32 s8, s8, s30
    s_cmpk_ge_u32 s8, 2187
    s_nop 3
    s_cbranch_scc1 .ap_173
    s_waitcnt vmcnt(5)
    s_cmpk_ge_u32 s8, 2122
    s_cbranch_scc1 .ap_173
    s_waitcnt vmcnt(3)
    s_bitcmp1_b64 s[14:15], 62
    s_cbranch_scc0 1
    s_waitcnt vmcnt(2)
    s_cmpk_ge_u32 s8, 2047
    s_cbranch_scc1 .ap_173
    s_waitcnt vmcnt(1)
.ap_173:
    s_add_u32 s63, s69, 442368
    buffer_load_dwordx4 v[84:87], v2, s[44:47], s63 offen nt
    s_waitcnt vmcnt(7)
    v_perm_b32 v112, v228, v224, s94
    v_perm_b32 v113, v236, v232, s94
    v_perm_b32 v114, v244, v240, s94
    v_perm_b32 v115, v252, v248, s94
    s_nop 1
    v_mfma_f32_16x16x32_bf16 v[128:131], v[104:107], v[112:115], v[128:131]
    v_perm_b32 v116, v228, v224, s95
    v_perm_b32 v117, v236, v232, s95
    v_perm_b32 v118, v244, v240, s95
    v_perm_b32 v119, v252, v248, s95
    s_nop 1
    v_mfma_f32_16x16x32_bf16 v[132:135], v[104:107], v[116:119], v[132:135]
    v_perm_b32 v120, v229, v225, s94
    v_perm_b32 v121, v237, v233, s94
    v_perm_b32 v122, v245, v241, s94
    v_perm_b32 v123, v253, v249, s94
    s_nop 1
    v_mfma_f32_16x16x32_bf16 v[136:139], v[104:107], v[120:123], v[136:139]
    v_perm_b32 v124, v229, v225, s95
    v_perm_b32 v125, v237, v233, s95
    v_perm_b32 v126, v245, v241, s95
    v_perm_b32 v127, v253, v249, s95
    s_nop 1
    v_mfma_f32_16x16x32_bf16 v[140:143], v[104:107], v[124:127], v[140:143]
    v_perm_b32 v112, v230, v226, s94
    v_perm_b32 v113, v238, v234, s94
    v_perm_b32 v114, v246, v242, s94
    v_perm_b32 v115, v254, v250, s94
    s_nop 1
    v_mfma_f32_16x16x32_bf16 v[144:147], v[104:107], v[112:115], v[144:147]
    v_perm_b32 v116, v230, v226, s95
    v_perm_b32 v117, v238, v234, s95
    v_perm_b32 v118, v246, v242, s95
    v_perm_b32 v119, v254, v250, s95
    s_nop 1
    v_mfma_f32_16x16x32_bf16 v[148:151], v[104:107], v[116:119], v[148:151]
    v_perm_b32 v120, v231, v227, s94
    v_perm_b32 v121, v239, v235, s94
    v_perm_b32 v122, v247, v243, s94
    v_perm_b32 v123, v255, v251, s94
    s_nop 1
    v_mfma_f32_16x16x32_bf16 v[152:155], v[104:107], v[120:123], v[152:155]
    v_perm_b32 v124, v231, v227, s95
    v_perm_b32 v125, v239, v235, s95
    v_perm_b32 v126, v247, v243, s95
    v_perm_b32 v127, v255, v251, s95
    s_nop 1
    v_mfma_f32_16x16x32_bf16 v[156:159], v[104:107], v[124:127], v[156:159]
    s_memrealtime s[8:9]
    s_waitcnt lgkmcnt(0)
    s_sub_u32 s8, s8, s30
    s_cmpk_ge_u32 s8, 2218
    s_nop 3
    s_cbranch_scc1 .ap_174
    s_waitcnt vmcnt(5)
    s_cmpk_ge_u32 s8, 2153
    s_cbranch_scc1 .ap_174
    s_waitcnt vmcnt(3)
    s_bitcmp1_b64 s[14:15], 63
    s_cbranch_scc0 1
    s_waitcnt vmcnt(2)
    s_cmpk_ge_u32 s8, 2078
    s_cbranch_scc1 .ap_174
    s_waitcnt vmcnt(1)
.ap_174:
    s_add_u32 s63, s69, 450560
    buffer_load_dwordx4 v[92:95], v2, s[44:47], s63 offen nt
    s_setprio 0
    s_waitcnt vmcnt(6)
    v_perm_b32 v160, v44, v36, s94
    v_perm_b32 v164, v44, v36, s95
    v_perm_b32 v168, v45, v37, s94
    v_perm_b32 v172, v45, v37, s95
    v_perm_b32 v176, v46, v38, s94
    v_perm_b32 v180, v46, v38, s95
    v_perm_b32 v184, v47, v39, s94
    v_perm_b32 v188, v47, v39, s95
    s_waitcnt vmcnt(4)
    v_perm_b32 v161, v60, v52, s94
    v_perm_b32 v165, v60, v52, s95
    v_perm_b32 v169, v61, v53, s94
    v_perm_b32 v173, v61, v53, s95
    v_perm_b32 v177, v62, v54, s94
    v_perm_b32 v181, v62, v54, s95
    v_perm_b32 v185, v63, v55, s94
    v_perm_b32 v189, v63, v55, s95
    s_waitcnt vmcnt(2)
    v_perm_b32 v162, v76, v68, s94
    v_perm_b32 v166, v76, v68, s95
    v_perm_b32 v170, v77, v69, s94
    v_perm_b32 v174, v77, v69, s95
    v_perm_b32 v178, v78, v70, s94
    v_perm_b32 v182, v78, v70, s95
    v_perm_b32 v186, v79, v71, s94
    v_perm_b32 v190, v79, v71, s95
.Ltail_bc:
    s_waitcnt vmcnt(0)
    v_perm_b32 v163, v92, v84, s94
    v_perm_b32 v167, v92, v84, s95
    v_perm_b32 v171, v93, v85, s94
    v_perm_b32 v175, v93, v85, s95
    v_perm_b32 v179, v94, v86, s94
    v_perm_b32 v183, v94, v86, s95
    v_perm_b32 v187, v95, v87, s94
    v_perm_b32 v191, v95, v87, s95
    v_mfma_f32_16x16x32_bf16 v[128:131], v[108:111], v[160:163], v[128:131]
    v_mfma_f32_16x16x32_bf16 v[132:135], v[108:111], v[164:167], v[132:135]
    v_mfma_f32_16x16x32_bf16 v[136:139], v[108:111], v[168:171], v[136:139]
    v_mfma_f32_16x16x32_bf16 v[140:143], v[108:111], v[172:175], v[140:143]
    v_mfma_f32_16x16x32_bf16 v[144:147], v[108:111], v[176:179], v[144:147]
    v_mfma_f32_16x16x32_bf16 v[148:151], v[108:111], v[180:183], v[148:151]
    v_mfma_f32_16x16x32_bf16 v[152:155], v[108:111], v[184:187], v[152:155]
    v_mfma_f32_16x16x32_bf16 v[156:159], v[108:111], v[188:191], v[156:159]
    s_lshl_b32 s32, s3, 10
    s_add_u32 m0, s32, 24576
    s_add_u32 s56, s101, 1769472
    buffer_load_dwordx4 v6, s[48:51], s56 offen nt lds
    s_add_u32 m0, s32, 32768
    s_add_u32 s56, s101, 2359296
    buffer_load_dwordx4 v6, s[48:51], s56 offen nt lds
    s_add_u32 m0, s32, 40960
    s_add_u32 s56, s101, 2949120
    buffer_load_dwordx4 v6, s[48:51], s56 offen nt lds
    s_add_u32 m0, s32, 49152
    s_add_u32 s56, s101, 3538944
    buffer_load_dwordx4 v6, s[48:51], s56 offen nt lds
    s_lshl4_add_u32 s56, s67, s66
    s_lshl1_add_u32 s56, s56, s68
    s_lshl_b32 s56, s56, 9
    s_add_u32 s56, s56, 0x210000
    s_mov_b32 s60, 0x07060503
    s_mov_b32 s61, 0x07060502
    s_mov_b32 s62, 0x07060501
    s_mov_b64 exec, 0xffff
    ds_write2_b32 v10, v128, v129 offset0:0 offset1:128
    ds_write2_b32 v10, v132, v133 offset0:1 offset1:129
    ds_write2_b32 v10, v136, v137 offset0:2 offset1:130
    ds_write2_b32 v10, v140, v141 offset0:3 offset1:131
    ds_write2_b32 v10, v144, v145 offset0:4 offset1:132
    ds_write2_b32 v10, v148, v149 offset0:5 offset1:133
    ds_write2_b32 v10, v152, v153 offset0:6 offset1:134
    ds_write2_b32 v10, v156, v157 offset0:7 offset1:135
    s_mov_b64 exec, -1
    s_waitcnt lgkmcnt(0)
    s_barrier
    s_cmp_lg_u32 s3, 7
    s_cbranch_scc1 .opub_175
    ds_read_b128 v[196:199], v9 offset:0
    ds_read_b128 v[200:203], v9 offset:1024
    ds_read_b128 v[204:207], v9 offset:2048
    ds_read_b128 v[208:211], v9 offset:3072
    ds_read_b128 v[212:215], v9 offset:4096
    ds_read_b128 v[216:219], v9 offset:5120
    ds_read_b128 v[220:223], v9 offset:6144
    ds_read_b128 v[224:227], v9 offset:7168
    s_waitcnt lgkmcnt(6)
    v_pk_add_f32 v[196:197], v[196:197], v[200:201]
    v_pk_add_f32 v[198:199], v[198:199], v[202:203]
    s_waitcnt lgkmcnt(4)
    v_pk_add_f32 v[204:205], v[204:205], v[208:209]
    v_pk_add_f32 v[206:207], v[206:207], v[210:211]
    v_pk_add_f32 v[196:197], v[196:197], v[204:205]
    v_pk_add_f32 v[198:199], v[198:199], v[206:207]
    s_waitcnt lgkmcnt(2)
    v_pk_add_f32 v[212:213], v[212:213], v[216:217]
    v_pk_add_f32 v[214:215], v[214:215], v[218:219]
    s_waitcnt lgkmcnt(0)
    v_pk_add_f32 v[220:221], v[220:221], v[224:225]
    v_pk_add_f32 v[222:223], v[222:223], v[226:227]
    v_pk_add_f32 v[212:213], v[212:213], v[220:221]
    v_pk_add_f32 v[214:215], v[214:215], v[222:223]
    v_pk_add_f32 v[196:197], v[196:197], v[212:213]
    v_pk_add_f32 v[198:199], v[198:199], v[214:215]
    v_perm_b32 v12, v196, v199, s60
    v_perm_b32 v13, v197, v199, s61
    v_perm_b32 v14, v198, v199, s62
    s_add_u32 s57, s56, 0xac000
    buffer_store_dwordx4 v[12:15], v11, s[36:39], s57 offen
    buffer_store_dwordx4 v[12:15], v11, s[36:39], s56 offen sc1
.opub_175:
    s_barrier
    s_bitcmp1_b32 s1, 0
    s_cbranch_scc1 .lt_176
    s_lshl_b32 s32, s3, 10
    s_add_u32 m0, s32, 0
    s_add_u32 s56, s101, 0
    buffer_load_dwordx4 v6, s[48:51], s56 offen nt lds
    s_add_u32 m0, s32, 8192
    s_add_u32 s56, s101, 589824
    buffer_load_dwordx4 v6, s[48:51], s56 offen nt lds
    s_add_u32 m0, s32, 16384
    s_add_u32 s56, s101, 1179648
    buffer_load_dwordx4 v6, s[48:51], s56 offen nt lds
.lt_176:
    s_lshl_b32 s32, s3, 10
    s_add_u32 m0, s32, 57344
    s_add_u32 s56, s101, 4128768
    buffer_load_dwordx4 v6, s[48:51], s56 offen nt lds
    s_add_u32 m0, s32, 65536
    s_add_u32 s56, s101, 4718592
    buffer_load_dwordx4 v6, s[48:51], s56 offen nt lds
    s_add_u32 m0, s32, 73728
    s_add_u32 s56, s33, 0
    buffer_load_dwordx4 v31, s[52:55], s56 offen nt lds
    s_add_u32 m0, s32, 81920
    s_add_u32 s56, s33, 73728
    buffer_load_dwordx4 v31, s[52:55], s56 offen nt lds
    s_add_u32 m0, s32, 90112
    s_add_u32 s56, s33, 147456
    buffer_load_dwordx4 v31, s[52:55], s56 offen nt lds
    s_add_u32 m0, s32, 98304
    s_add_u32 s56, s33, 221184
    buffer_load_dwordx4 v31, s[52:55], s56 offen nt lds
    s_cmp_ge_u32 s3, 4
    s_cbranch_scc1 .nod_177
    s_add_u32 m0, s32, 106496
    s_add_u32 s56, s33, 294912
    buffer_load_dwordx4 v31, s[52:55], s56 offen nt lds
.nod_177:
    s_branch .gpc_179
.gp_178:
    buffer_load_dwordx4 v[32:35], v2, s[36:39], s99 offen offset:0 sc1
    buffer_load_dwordx4 v[40:43], v2, s[36:39], s99 offen offset:1024 sc1
    buffer_load_dwordx2 v[48:49], v5, s[36:39], s99 offen offset:0 sc1
    buffer_load_dwordx4 v[56:59], v2, s[36:39], s100 offen offset:0 sc1
    buffer_load_dwordx4 v[64:67], v2, s[36:39], s100 offen offset:1024 sc1
    buffer_load_dwordx2 v[50:51], v5, s[36:39], s100 offen offset:0 sc1
    s_waitcnt vmcnt(0)
.gpc_179:
    v_min_u32 v7, v33, v35
    v_max_u32 v8, v33, v35
    v_min3_u32 v7, v7, v41, v43
    v_max3_u32 v8, v8, v41, v43
    v_min3_u32 v7, v7, v49, v57
    v_max3_u32 v8, v8, v49, v57
    v_min3_u32 v7, v7, v59, v65
    v_max3_u32 v8, v8, v59, v65
    v_min3_u32 v7, v7, v67, v51
    v_max3_u32 v8, v8, v67, v51
    v_cmp_eq_u32 vcc, s34, v7
    v_cmp_eq_u32 s[56:57], s34, v8
    s_and_b64 vcc, vcc, s[56:57]
    s_cmp_eq_u64 vcc, exec
    s_nop 2
    s_cbranch_scc1 .gpd_180
    s_sub_u32 s35, s35, 1
    s_cbranch_scc1 .Lexit
    s_sleep 2
    s_branch .gp_178
.gpd_180:
    v_lshlrev_b32 v230, 16, v32
    v_and_b32 v231, 0xffff0000, v32
    v_lshlrev_b32 v240, 16, v56
    v_and_b32 v241, 0xffff0000, v56
    v_lshlrev_b32 v232, 16, v34
    v_and_b32 v233, 0xffff0000, v34
    v_lshlrev_b32 v242, 16, v58
    v_and_b32 v243, 0xffff0000, v58
    v_lshlrev_b32 v234, 16, v40
    v_and_b32 v235, 0xffff0000, v40
    v_lshlrev_b32 v244, 16, v64
    v_and_b32 v245, 0xffff0000, v64
    v_lshlrev_b32 v236, 16, v42
    v_and_b32 v237, 0xffff0000, v42
    v_lshlrev_b32 v246, 16, v66
    v_and_b32 v247, 0xffff0000, v66
    v_lshlrev_b32 v238, 16, v48
    v_and_b32 v239, 0xffff0000, v48
    v_lshlrev_b32 v248, 16, v50
    v_and_b32 v249, 0xffff0000, v50
    s_sub_u32 s63, s65, 9
    s_mul_i32 s42, s64, 18432
    s_mul_i32 s56, s3, 2304
    s_add_u32 s42, s42, s56
    s_add_u32 s42, s42, 0x250000
    s_mul_i32 s41, s64, 36864
    s_add_u32 s41, s41, 0x274000
    s_lshr_b32 s57, s63, 1
    s_lshl3_add_u32 s40, s57, s3
    s_and_b32 s63, s63, 1
    s_lshl1_add_u32 s40, s40, s63
    s_lshl_b32 s40, s40, 8
    s_add_u32 s40, s40, s41
    s_mul_i32 s56, s63, 18432
    s_add_u32 s41, s41, s56
    s_mul_i32 s43, s3, 9
    s_add_u32 s43, s43, s57
    s_lshl3_add_u32 s43, s43, s64
    s_lshl1_add_u32 s43, s43, s63
    s_lshl_b32 s43, s43, 8
    s_add_u32 s43, s43, 0x38c000
    v_mov_b32 v143, s34
    s_add_u32 s57, s40, 0xac000
    s_mov_b64 exec, 0xffff
    buffer_load_dwordx4 v[80:83], v2, s[36:39], s57 offen offset:0
    s_mov_b64 exec, -1
    s_waitcnt vmcnt(5)
    s_barrier
    ds_read_b64_tr_b16 v[160:161], v19 offset:0
    ds_read_b64_tr_b16 v[162:163], v19 offset:512
    ds_read_b64_tr_b16 v[164:165], v19 offset:8192
    ds_read_b64_tr_b16 v[166:167], v19 offset:8704
    ds_read_b64_tr_b16 v[168:169], v19 offset:16384
    ds_read_b64_tr_b16 v[170:171], v19 offset:16896
    ds_read_b64_tr_b16 v[172:173], v19 offset:24576
    ds_read_b64_tr_b16 v[174:175], v19 offset:25088
    ds_read_b64_tr_b16 v[176:177], v20 offset:0
    ds_read_b64_tr_b16 v[178:179], v20 offset:512
    ds_read_b64_tr_b16 v[180:181], v20 offset:8192
    ds_read_b64_tr_b16 v[182:183], v20 offset:8704
    ds_read_b64_tr_b16 v[184:185], v20 offset:16384
    ds_read_b64_tr_b16 v[186:187], v20 offset:16896
    ds_read_b64_tr_b16 v[188:189], v20 offset:24576
    ds_read_b64_tr_b16 v[190:191], v20 offset:25088
    ds_read_b64_tr_b16 v[192:193], v20 offset:32768
    ds_read_b64_tr_b16 v[194:195], v20 offset:33280
    s_waitcnt vmcnt(0)
    s_barrier
    ds_read_b64_tr_b16 v[196:197], v21 offset:0
    ds_read_b64_tr_b16 v[198:199], v21 offset:512
    ds_read_b64_tr_b16 v[208:209], v22 offset:0
    ds_read_b64_tr_b16 v[210:211], v22 offset:512
    ds_read_b64_tr_b16 v[200:201], v21 offset:4096
    ds_read_b64_tr_b16 v[202:203], v21 offset:4608
    ds_read_b64_tr_b16 v[212:213], v22 offset:4096
    ds_read_b64_tr_b16 v[214:215], v22 offset:4608
    ds_read_b64_tr_b16 v[204:205], v21 offset:8192
    ds_read_b64_tr_b16 v[206:207], v21 offset:8704
    ds_read_b64_tr_b16 v[216:217], v22 offset:8192
    ds_read_b64_tr_b16 v[218:219], v22 offset:8704
.Lbc_x:
    s_add_u32 s58, s42, s0
    s_mov_b32 s32, 0
    s_mov_b64 s[88:89], exec
    s_mov_b64 s[90:91], exec
    s_mov_b64 s[92:93], exec
.mp_181:
    s_mov_b64 exec, s[88:89]
    buffer_load_dwordx4 v[144:147], v2, s[36:39], s58 offen offset:0 sc1
    s_mov_b64 exec, s[90:91]
    buffer_load_dwordx4 v[148:151], v2, s[36:39], s58 offen offset:1024 sc1
    s_mov_b64 exec, s[92:93]
    buffer_load_dwordx2 v[152:153], v5, s[36:39], s58 offen offset:0 sc1
    s_mov_b64 exec, -1
    s_sub_u32 s35, s35, 1
    s_cbranch_scc1 .Lexit
    s_add_u32 s32, s32, 1
    s_cmp_eq_u32 s32, 64
    s_cselect_b32 s58, s42, s58
    s_waitcnt vmcnt(0)
.mpj_182:
    v_cmp_ne_u32 s[88:89], s34, v145
    v_cmp_ne_u32 vcc, s34, v147
    s_or_b64 s[88:89], s[88:89], vcc
    v_cmp_ne_u32 s[90:91], s34, v149
    v_cmp_ne_u32 vcc, s34, v151
    s_or_b64 s[90:91], s[90:91], vcc
    v_cmp_ne_u32 s[92:93], s34, v153
    s_or_b64 vcc, s[88:89], s[90:91]
    s_or_b64 vcc, vcc, s[92:93]
    s_nop 2
    s_cbranch_scc1 .mp_181
    s_mov_b32 s56, 0x3f803f80
    v_dot2_f32_bf16 v250, v144, s56, 0
    v_dot2_f32_bf16 v251, v144, v144, 0
    v_dot2_f32_bf16 v250, v146, s56, v250
    v_dot2_f32_bf16 v251, v146, v146, v251
    v_dot2_f32_bf16 v250, v148, s56, v250
    v_dot2_f32_bf16 v251, v148, v148, v251
    v_dot2_f32_bf16 v250, v150, s56, v250
    v_dot2_f32_bf16 v251, v150, v150, v251
    s_mov_b64 exec, 0xffffffff
    v_dot2_f32_bf16 v250, v152, s56, v250
    v_dot2_f32_bf16 v251, v152, v152, v251
    s_mov_b64 exec, -1
    s_nop 1
    v_permlane32_swap_b32 v250, v251
    v_add_f32 v250, v250, v251
    v_mov_b32 v252, v250
    s_nop 1
    v_permlane16_swap_b32 v252, v250
    v_add_f32 v250, v252, v250
    v_lshlrev_b32 v220, 16, v144
    v_and_b32 v221, 0xffff0000, v144
    v_add_f32_dpp v250, v250, v250 row_ror:8 row_mask:0xf bank_mask:0xf
    v_lshlrev_b32 v222, 16, v146
    v_and_b32 v223, 0xffff0000, v146
    v_add_f32_dpp v250, v250, v250 row_ror:4 row_mask:0xf bank_mask:0xf
    v_lshlrev_b32 v224, 16, v148
    v_and_b32 v225, 0xffff0000, v148
    v_add_f32_dpp v250, v250, v250 quad_perm:[2,3,0,1] row_mask:0xf bank_mask:0xf
    v_lshlrev_b32 v226, 16, v150
    v_and_b32 v227, 0xffff0000, v150
    v_add_f32_dpp v250, v250, v250 quad_perm:[1,0,3,2] row_mask:0xf bank_mask:0xf
    v_mul_f32 v250, 0x3ae38e39, v250
    v_lshlrev_b32 v228, 16, v152
    v_and_b32 v229, 0xffff0000, v152
    v_readlane_b32 s56, v250, 0
    v_readlane_b32 s57, v250, 32
    s_nop 0
    v_mov_b32 v250, s56
    v_fma_f32 v251, -v250, v250, s57
    v_max_f32 v251, 0, v251
    v_cvt_pk_bf16_f32 v252, -v250, v251
    v_and_b32 v253, 0xffff0000, v252
    v_add_f32 v253, 0x3727c5ac, v253
    v_lshlrev_b32 v250, 16, v252
    v_cvt_pk_bf16_f32 v253, v253, v253
    v_lshlrev_b32 v253, 16, v253
    v_sqrt_f32 v253, v253
    v_mov_b32 v251, v250
    v_cvt_pk_bf16_f32 v253, v253, v253
    v_lshlrev_b32 v253, 16, v253
    v_rcp_f32 v252, v253
    v_rcp_f32 v253, v253
    v_pk_add_f32 v[220:221], v[220:221], v[250:251]
    v_pk_add_f32 v[222:223], v[222:223], v[250:251]
    v_pk_add_f32 v[224:225], v[224:225], v[250:251]
    v_pk_add_f32 v[226:227], v[226:227], v[250:251]
    v_pk_add_f32 v[228:229], v[228:229], v[250:251]
    v_cvt_pk_bf16_f32 v220, v220, v221
    v_and_b32 v221, 0xffff0000, v220
    v_lshlrev_b32 v220, 16, v220
    v_cvt_pk_bf16_f32 v222, v222, v223
    v_and_b32 v223, 0xffff0000, v222
    v_lshlrev_b32 v222, 16, v222
    v_cvt_pk_bf16_f32 v224, v224, v225
    v_and_b32 v225, 0xffff0000, v224
    v_lshlrev_b32 v224, 16, v224
    v_cvt_pk_bf16_f32 v226, v226, v227
    v_and_b32 v227, 0xffff0000, v226
    v_lshlrev_b32 v226, 16, v226
    v_cvt_pk_bf16_f32 v228, v228, v229
    v_and_b32 v229, 0xffff0000, v228
    v_lshlrev_b32 v228, 16, v228
    v_pk_mul_f32 v[220:221], v[220:221], v[252:253]
    v_pk_mul_f32 v[222:223], v[222:223], v[252:253]
    v_pk_mul_f32 v[224:225], v[224:225], v[252:253]
    v_pk_mul_f32 v[226:227], v[226:227], v[252:253]
    v_pk_mul_f32 v[228:229], v[228:229], v[252:253]
    v_cvt_pk_bf16_f32 v220, v220, v221
    v_and_b32 v221, 0xffff0000, v220
    v_lshlrev_b32 v220, 16, v220
    v_cvt_pk_bf16_f32 v222, v222, v223
    v_and_b32 v223, 0xffff0000, v222
    v_lshlrev_b32 v222, 16, v222
    v_cvt_pk_bf16_f32 v224, v224, v225
    v_and_b32 v225, 0xffff0000, v224
    v_lshlrev_b32 v224, 16, v224
    v_cvt_pk_bf16_f32 v226, v226, v227
    v_and_b32 v227, 0xffff0000, v226
    v_lshlrev_b32 v226, 16, v226
    v_cvt_pk_bf16_f32 v228, v228, v229
    v_and_b32 v229, 0xffff0000, v228
    v_lshlrev_b32 v228, 16, v228
    v_pk_mul_f32 v[220:221], v[220:221], v[240:241]
    v_pk_mul_f32 v[222:223], v[222:223], v[242:243]
    v_pk_mul_f32 v[224:225], v[224:225], v[244:245]
    v_pk_mul_f32 v[226:227], v[226:227], v[246:247]
    v_pk_mul_f32 v[228:229], v[228:229], v[248:249]
    v_cvt_pk_bf16_f32 v220, v220, v221
    v_and_b32 v221, 0xffff0000, v220
    v_lshlrev_b32 v220, 16, v220
    v_cvt_pk_bf16_f32 v222, v222, v223
    v_and_b32 v223, 0xffff0000, v222
    v_lshlrev_b32 v222, 16, v222
    v_cvt_pk_bf16_f32 v224, v224, v225
    v_and_b32 v225, 0xffff0000, v224
    v_lshlrev_b32 v224, 16, v224
    v_cvt_pk_bf16_f32 v226, v226, v227
    v_and_b32 v227, 0xffff0000, v226
    v_lshlrev_b32 v226, 16, v226
    v_cvt_pk_bf16_f32 v228, v228, v229
    v_and_b32 v229, 0xffff0000, v228
    v_lshlrev_b32 v228, 16, v228
    v_pk_add_f32 v[220:221], v[220:221], v[230:231]
    v_pk_add_f32 v[222:223], v[222:223], v[232:233]
    v_pk_add_f32 v[224:225], v[224:225], v[234:235]
    v_pk_add_f32 v[226:227], v[226:227], v[236:237]
    v_pk_add_f32 v[228:229], v[228:229], v[238:239]
    v_cvt_pk_bf16_f32 v154, v220, v221
    v_cvt_pk_bf16_f32 v155, v222, v223
    v_cvt_pk_bf16_f32 v156, v224, v225
    v_cvt_pk_bf16_f32 v157, v226, v227
    v_cvt_pk_bf16_f32 v158, v228, v229
    ds_write_b64 v17, v[154:155]
    ds_write_b64 v17, v[156:157] offset:512
    ds_write_b32 v18, v158
    s_waitcnt lgkmcnt(0)
    s_barrier
    ds_read_b128 v[96:99], v16 offset:0
    ds_read_b128 v[100:103], v16 offset:128
    ds_read_b128 v[104:107], v16 offset:256
    ds_read_b128 v[108:111], v16 offset:384
    ds_read_b128 v[112:115], v16 offset:512
    ds_read_b128 v[116:119], v16 offset:640
    ds_read_b128 v[120:123], v16 offset:768
    ds_read_b128 v[124:127], v16 offset:896
    ds_read_b128 v[128:131], v16 offset:1024
    s_waitcnt lgkmcnt(8)
    v_mfma_f32_16x16x32_bf16 v[132:135], v[160:163], v[96:99], 0
    s_waitcnt lgkmcnt(7)
    v_mfma_f32_16x16x32_bf16 v[132:135], v[164:167], v[100:103], v[132:135]
    s_waitcnt lgkmcnt(6)
    v_mfma_f32_16x16x32_bf16 v[132:135], v[168:171], v[104:107], v[132:135]
    s_waitcnt lgkmcnt(5)
    v_mfma_f32_16x16x32_bf16 v[132:135], v[172:175], v[108:111], v[132:135]
    s_waitcnt lgkmcnt(4)
    v_mfma_f32_16x16x32_bf16 v[132:135], v[176:179], v[112:115], v[132:135]
    s_waitcnt lgkmcnt(3)
    v_mfma_f32_16x16x32_bf16 v[132:135], v[180:183], v[116:119], v[132:135]
    s_waitcnt lgkmcnt(2)
    v_mfma_f32_16x16x32_bf16 v[132:135], v[184:187], v[120:123], v[132:135]
    s_waitcnt lgkmcnt(1)
    v_mfma_f32_16x16x32_bf16 v[132:135], v[188:191], v[124:127], v[132:135]
    s_waitcnt lgkmcnt(0)
    v_mfma_f32_16x16x32_bf16 v[132:135], v[192:195], v[128:131], v[132:135]
    s_nop 7
    v_permlane32_swap_b32 v132, v134
    v_permlane32_swap_b32 v133, v135
    v_cndmask_b32 v133, v133, v134, s[96:97]
    v_cndmask_b32 v132, v132, v135, s[96:97]
    s_nop 1
    v_add_f32_dpp v12, v133, v132 quad_perm:[1,0,3,2] row_mask:0xf bank_mask:0xf
    v_cvt_pk_bf16_f32 v12, v12, v12
    v_lshlrev_b32 v12, 16, v12
    s_cmp_lg_u32 s63, 0
    s_nop 0
    s_cbranch_scc1 .up_185
    v_max_f32 v12, 0xc2ae0000, v12
    v_min_f32 v9, 0x43000000, v12
    v_mul_f32 v7, 0xbfb8aa3b, v9
    v_fma_f32 v8, v9, s98, -v7
    v_fmac_f32 v8, 0xb2a57060, v9
    v_exp_f32 v7, v7
    v_mul_f32 v8, 0x3f317218, v8
    v_fmac_f32 v7, v7, v8
    v_add_f32 v7, 1.0, v7
    v_rcp_f32 v8, v7
    s_nop 0
    v_mul_f32 v9, v12, v8
    v_fma_f32 v7, -v9, v7, v12
    v_fma_f32 v12, v7, v8, v9
.up_185:
    s_nop 1
    v_mov_b32_dpp v137, v12 quad_perm:[0,0,2,2] row_mask:0xf bank_mask:0xf
    v_mov_b32_dpp v139, v12 quad_perm:[1,1,3,3] row_mask:0xf bank_mask:0xf
    v_cvt_pk_bf16_f32 v136, v137, v139
    v_cvt_pk_bf16_f32 v138, v137, v139
    v_mov_b32 v137, s34
    v_mov_b32 v139, s34
    v_permlane32_swap_b32 v136, v138
    s_mov_b64 exec, 0x55555555
    s_add_u32 s57, s40, 0xac000
    buffer_store_dwordx4 v[136:139], v26, s[36:39], s57 offen
    s_cmp_lg_u32 s0, 0
    s_cbranch_scc1 2
    buffer_store_dwordx4 v[136:139], v26, s[36:39], s40 offen sc1
    s_mov_b64 exec, -1
    s_barrier
    s_add_u32 s58, s41, s0
    s_mov_b32 s32, 0
    s_mov_b64 s[88:89], exec
    s_mov_b64 s[90:91], exec
    s_and_b64 s[92:93], exec, 0xff
    s_and_b64 s[56:57], exec, 0xff
.mp_186:
    s_mov_b64 exec, s[88:89]
    buffer_load_dwordx4 v[160:163], v27, s[36:39], s58 offen offset:0 sc1
    s_mov_b64 exec, s[90:91]
    buffer_load_dwordx4 v[164:167], v27, s[36:39], s58 offen offset:256 sc1
    s_mov_b64 exec, s[92:93]
    buffer_load_dwordx4 v[168:171], v28, s[36:39], s58 offen offset:0 sc1
    s_mov_b64 exec, s[56:57]
    buffer_load_dwordx4 v[172:175], v28, s[36:39], s58 offen offset:256 sc1
    s_mov_b64 exec, -1
    s_sub_u32 s35, s35, 1
    s_cbranch_scc1 .Lexit
    s_add_u32 s32, s32, 1
    s_cmp_eq_u32 s32, 64
    s_cselect_b32 s58, s41, s58
    s_cbranch_scc0 .mpi_188
    s_mov_b64 exec, 0x55555555
    buffer_store_dwordx4 v[136:139], v26, s[36:39], s40 offen sc1
    s_mov_b64 exec, -1
.mpi_188:
    s_waitcnt vmcnt(0)
.mpj_187:
    v_cmp_ne_u32 s[88:89], s34, v161
    v_cmp_ne_u32 vcc, s34, v163
    s_or_b64 s[88:89], s[88:89], vcc
    v_cmp_ne_u32 s[90:91], s34, v165
    v_cmp_ne_u32 vcc, s34, v167
    s_or_b64 s[90:91], s[90:91], vcc
    v_cmp_ne_u32 s[92:93], s34, v169
    v_cmp_ne_u32 vcc, s34, v171
    s_or_b64 s[92:93], s[92:93], vcc
    s_and_b64 s[92:93], s[92:93], 0xff
    v_cmp_ne_u32 s[56:57], s34, v173
    v_cmp_ne_u32 vcc, s34, v175
    s_or_b64 s[56:57], s[56:57], vcc
    s_and_b64 s[56:57], s[56:57], 0xff
    s_or_b64 vcc, s[88:89], s[90:91]
    s_or_b64 vcc, vcc, s[92:93]
    s_or_b64 vcc, vcc, s[56:57]
    s_cbranch_scc1 .mp_186
    v_and_b32 v161, 0xffff0000, v160
    v_lshlrev_b32 v160, 16, v160
    v_and_b32 v163, 0xffff0000, v162
    v_lshlrev_b32 v162, 16, v162
    v_and_b32 v165, 0xffff0000, v164
    v_lshlrev_b32 v164, 16, v164
    v_and_b32 v167, 0xffff0000, v166
    v_lshlrev_b32 v166, 16, v166
    v_and_b32 v169, 0xffff0000, v168
    v_lshlrev_b32 v168, 16, v168
    v_and_b32 v171, 0xffff0000, v170
    v_lshlrev_b32 v170, 16, v170
    v_and_b32 v173, 0xffff0000, v172
    v_lshlrev_b32 v172, 16, v172
    v_and_b32 v175, 0xffff0000, v174
    v_lshlrev_b32 v174, 16, v174
    v_pk_mul_f32 v[160:161], v[160:161], v[164:165]
    v_pk_mul_f32 v[162:163], v[162:163], v[166:167]
    v_pk_mul_f32 v[168:169], v[168:169], v[172:173]
    v_pk_mul_f32 v[170:171], v[170:171], v[174:175]
    v_cvt_pk_bf16_f32 v160, v160, v161
    v_cvt_pk_bf16_f32 v161, v162, v163
    v_cvt_pk_bf16_f32 v168, v168, v169
    v_cvt_pk_bf16_f32 v169, v170, v171
    ds_write_b64 v29, v[160:161]
    s_mov_b64 exec, 0xff
    ds_write_b64 v30, v[168:169]
    s_mov_b64 exec, -1
    s_mov_b64 exec, 0x55555555
    buffer_store_dwordx4 v[136:139], v26, s[36:39], s40 offen sc1
    s_mov_b64 exec, -1
    s_waitcnt lgkmcnt(0)
    s_barrier
    s_cmp_ge_u32 s3, 6
    s_cbranch_scc1 .tg_190
    ds_read_b128 v[96:99], v23 offset:0
    ds_read_b128 v[100:103], v23 offset:64
    ds_read_b128 v[104:107], v23 offset:128
    s_waitcnt lgkmcnt(2)
    v_mfma_f32_16x16x32_bf16 v[132:135], v[196:199], v[96:99], 0
    v_mfma_f32_16x16x32_bf16 v[136:139], v[208:211], v[96:99], 0
    s_waitcnt lgkmcnt(1)
    v_mfma_f32_16x16x32_bf16 v[132:135], v[200:203], v[100:103], v[132:135]
    v_mfma_f32_16x16x32_bf16 v[136:139], v[212:215], v[100:103], v[136:139]
    s_waitcnt lgkmcnt(0)
    v_mfma_f32_16x16x32_bf16 v[132:135], v[204:207], v[104:107], v[132:135]
    v_mfma_f32_16x16x32_bf16 v[136:139], v[216:219], v[104:107], v[136:139]
    s_nop 7
    v_cndmask_b32 v132, v132, v136, s[96:97]
    v_cndmask_b32 v133, v133, v137, s[96:97]
    v_cndmask_b32 v134, v134, v138, s[96:97]
    v_cndmask_b32 v135, v135, v139, s[96:97]
    ds_write_b128 v24, v[132:135]
    s_waitcnt lgkmcnt(0)
.tg_190:
    s_barrier
    ds_read_b128 v[112:115], v25 offset:0
    ds_read_b128 v[116:119], v25 offset:2176
    ds_read_b128 v[120:123], v25 offset:4352
    s_mov_b32 s60, 0x07060503
    s_mov_b32 s61, 0x07060502
    s_mov_b32 s62, 0x07060501
    s_waitcnt lgkmcnt(1)
    v_pk_add_f32 v[112:113], v[112:113], v[116:117]
    v_pk_add_f32 v[114:115], v[114:115], v[118:119]
    s_waitcnt lgkmcnt(0)
    v_pk_add_f32 v[112:113], v[112:113], v[120:121]
    v_pk_add_f32 v[114:115], v[114:115], v[122:123]
    v_perm_b32 v140, v112, v115, s60
    v_perm_b32 v141, v113, v115, s61
    v_perm_b32 v142, v114, v115, s62
    s_mov_b64 exec, 0xffff
    buffer_store_dwordx4 v[140:143], v2, s[36:39], s43 offen sc1
    s_mov_b64 exec, -1
    s_nop 0
    s_branch .Lexit
.Latt_n:
    v_and_b32 v8, 1, v0
    v_lshlrev_b32 v8, 8, v8
    v_and_b32 v9, 0x3c, v0
    v_lshl_add_u32 v9, v9, 2, v8
    v_lshlrev_b32 v7, 1, v9
    v_and_b32 v9, 0x3c, v0
    v_lshrrev_b32 v8, 4, v8
    v_lshl_add_u32 v9, v9, 3, v8
    s_lshl_b32 s58, s66, 14
    s_lshl_b32 s59, s67, 10
    s_add_u32 s58, s58, s59
    s_add_u32 s58, s58, 0x40000
    s_lshl4_add_u32 s59, s66, s67
    s_lshl_b32 s59, s59, 9
    s_add_u32 s59, s59, 0x200000
    s_memrealtime s[8:9]
    s_waitcnt vmcnt(8)
    s_waitcnt lgkmcnt(0)
    s_sub_u32 s8, s8, s30
    s_cmpk_ge_u32 s8, 1147
    s_cbranch_scc1 .ap_191
    s_waitcnt vmcnt(5)
    s_cmpk_ge_u32 s8, 1082
    s_cbranch_scc1 .ap_191
    s_waitcnt vmcnt(3)
    s_bitcmp1_b64 s[14:15], 26
    s_cbranch_scc0 1
    s_waitcnt vmcnt(2)
    s_cmpk_ge_u32 s8, 1007
    s_cbranch_scc1 .ap_191
    s_waitcnt vmcnt(1)
.ap_191:
    s_add_u32 s63, s69, 409600
    buffer_load_dwordx4 v[88:91], v1, s[40:43], s63 offen nt
    s_memrealtime s[8:9]
    s_waitcnt vmcnt(8)
    s_waitcnt lgkmcnt(0)
    s_sub_u32 s8, s8, s30
    s_cmpk_ge_u32 s8, 1174
    s_cbranch_scc1 .ap_192
    s_waitcnt vmcnt(5)
    s_cmpk_ge_u32 s8, 1109
    s_cbranch_scc1 .ap_192
    s_waitcnt vmcnt(3)
    s_bitcmp1_b64 s[14:15], 27
    s_cbranch_scc0 1
    s_waitcnt vmcnt(2)
    s_cmpk_ge_u32 s8, 1034
    s_cbranch_scc1 .ap_192
    s_waitcnt vmcnt(1)
.ap_192:
    s_add_u32 s63, s69, 417792
    buffer_load_dwordx4 v[92:95], v1, s[40:43], s63 offen nt
    s_memrealtime s[8:9]
    s_waitcnt vmcnt(8)
    s_waitcnt lgkmcnt(0)
    s_sub_u32 s8, s8, s30
    s_cmpk_ge_u32 s8, 1201
    s_cbranch_scc1 .ap_193
    s_waitcnt vmcnt(5)
    s_cmpk_ge_u32 s8, 1136
    s_cbranch_scc1 .ap_193
    s_waitcnt vmcnt(3)
    s_bitcmp1_b64 s[14:15], 28
    s_cbranch_scc0 1
    s_waitcnt vmcnt(2)
    s_cmpk_ge_u32 s8, 1061
    s_cbranch_scc1 .ap_193
    s_waitcnt vmcnt(1)
.ap_193:
    s_add_u32 s63, s69, 425984
    buffer_load_dwordx4 v[120:123], v1, s[40:43], s63 offen nt
    s_memrealtime s[8:9]
    s_waitcnt vmcnt(8)
    s_waitcnt lgkmcnt(0)
    s_sub_u32 s8, s8, s30
    s_cmpk_ge_u32 s8, 1228
    s_cbranch_scc1 .ap_194
    s_waitcnt vmcnt(5)
    s_cmpk_ge_u32 s8, 1163
    s_cbranch_scc1 .ap_194
    s_waitcnt vmcnt(3)
    s_bitcmp1_b64 s[14:15], 29
    s_cbranch_scc0 1
    s_waitcnt vmcnt(2)
    s_cmpk_ge_u32 s8, 1088
    s_cbranch_scc1 .ap_194
    s_waitcnt vmcnt(1)
.ap_194:
    s_add_u32 s63, s69, 434176
    buffer_load_dwordx4 v[124:127], v1, s[40:43], s63 offen nt
    s_memrealtime s[8:9]
    s_waitcnt vmcnt(8)
    s_waitcnt lgkmcnt(0)
    s_sub_u32 s8, s8, s30
    s_cmpk_ge_u32 s8, 1255
    s_cbranch_scc1 .ap_195
    s_waitcnt vmcnt(5)
    s_cmpk_ge_u32 s8, 1190
    s_cbranch_scc1 .ap_195
    s_waitcnt vmcnt(3)
    s_bitcmp1_b64 s[14:15], 30
    s_cbranch_scc0 1
    s_waitcnt vmcnt(2)
    s_cmpk_ge_u32 s8, 1115
    s_cbranch_scc1 .ap_195
    s_waitcnt vmcnt(1)
.ap_195:
    s_add_u32 s63, s69, 442368
    buffer_load_dwordx4 v[152:155], v1, s[40:43], s63 offen nt
    s_memrealtime s[8:9]
    s_waitcnt vmcnt(8)
    s_waitcnt lgkmcnt(0)
    s_sub_u32 s8, s8, s30
    s_cmpk_ge_u32 s8, 1282
    s_cbranch_scc1 .ap_196
    s_waitcnt vmcnt(5)
    s_cmpk_ge_u32 s8, 1217
    s_cbranch_scc1 .ap_196
    s_waitcnt vmcnt(3)
    s_bitcmp1_b64 s[14:15], 31
    s_cbranch_scc0 1
    s_waitcnt vmcnt(2)
    s_cmpk_ge_u32 s8, 1142
    s_cbranch_scc1 .ap_196
    s_waitcnt vmcnt(1)
.ap_196:
    s_add_u32 s63, s69, 450560
    buffer_load_dwordx4 v[156:159], v1, s[40:43], s63 offen nt
    buffer_load_dwordx4 v[16:19], v7, s[36:39], s58 offen offset:0 sc1
    buffer_load_dwordx4 v[20:23], v7, s[36:39], s58 offen offset:16 sc1
    s_memrealtime s[8:9]
    s_waitcnt vmcnt(8)
    s_waitcnt lgkmcnt(0)
    s_sub_u32 s8, s8, s30
    s_cmpk_ge_u32 s8, 1309
    s_cbranch_scc1 .ap_197
    s_waitcnt vmcnt(5)
    s_cmpk_ge_u32 s8, 1244
    s_cbranch_scc1 .ap_197
    s_waitcnt vmcnt(3)
    s_bitcmp1_b64 s[14:15], 32
    s_cbranch_scc0 1
    s_waitcnt vmcnt(2)
    s_cmpk_ge_u32 s8, 1169
    s_cbranch_scc1 .ap_197
    s_waitcnt vmcnt(1)
.ap_197:
    s_add_u32 s63, s69, 0
    buffer_load_dwordx4 v[160:163], v2, s[44:47], s63 offen nt
    s_memrealtime s[8:9]
    s_waitcnt vmcnt(8)
    s_waitcnt lgkmcnt(0)
    s_sub_u32 s8, s8, s30
    s_cmpk_ge_u32 s8, 1336
    s_cbranch_scc1 .ap_198
    s_waitcnt vmcnt(5)
    s_cmpk_ge_u32 s8, 1271
    s_cbranch_scc1 .ap_198
    s_waitcnt vmcnt(3)
    s_bitcmp1_b64 s[14:15], 33
    s_cbranch_scc0 1
    s_waitcnt vmcnt(2)
    s_cmpk_ge_u32 s8, 1196
    s_cbranch_scc1 .ap_198
    s_waitcnt vmcnt(1)
.ap_198:
    s_add_u32 s63, s69, 8192
    buffer_load_dwordx4 v[164:167], v2, s[44:47], s63 offen nt
    s_memrealtime s[8:9]
    s_waitcnt vmcnt(8)
    s_waitcnt lgkmcnt(0)
    s_sub_u32 s8, s8, s30
    s_cmpk_ge_u32 s8, 1363
    s_cbranch_scc1 .ap_199
    s_waitcnt vmcnt(5)
    s_cmpk_ge_u32 s8, 1298
    s_cbranch_scc1 .ap_199
    s_waitcnt vmcnt(3)
    s_bitcmp1_b64 s[14:15], 34
    s_cbranch_scc0 1
    s_waitcnt vmcnt(2)
    s_cmpk_ge_u32 s8, 1223
    s_cbranch_scc1 .ap_199
    s_waitcnt vmcnt(1)
.ap_199:
    s_add_u32 s63, s69, 16384
    buffer_load_dwordx4 v[168:171], v2, s[44:47], s63 offen nt
    s_waitcnt vmcnt(3)
    s_branch .gpc_201
.gp_200:
    buffer_load_dwordx4 v[16:19], v7, s[36:39], s58 offen offset:0 sc1
    buffer_load_dwordx4 v[20:23], v7, s[36:39], s58 offen offset:16 sc1
    s_waitcnt vmcnt(0)
.gpc_201:
    v_min_u32 v10, v17, v19
    v_max_u32 v11, v17, v19
    v_min3_u32 v10, v10, v21, v23
    v_max3_u32 v11, v11, v21, v23
    v_cmp_eq_u32 vcc, s34, v10
    v_cmp_eq_u32 s[56:57], s34, v11
    s_and_b64 vcc, vcc, s[56:57]
    s_cmp_eq_u64 vcc, exec
    s_nop 2
    s_cbranch_scc1 .gpd_202
    s_sub_u32 s35, s35, 1
    s_cbranch_scc1 .Lexit
    s_sleep 1
    s_branch .gp_200
.gpd_202:
    s_mov_b32 vcc_lo, 0xcccccccc
    s_mov_b32 vcc_hi, 0xcccccccc
    v_cndmask_b32_e64 v24, v16, 0, vcc
    v_cndmask_b32_e64 v25, v18, 0, vcc
    v_cndmask_b32_e64 v26, v20, 0, vcc
    v_cndmask_b32_e64 v27, v22, 0, vcc
    v_cndmask_b32_e32 v28, 0, v16, vcc
    v_cndmask_b32_e32 v29, 0, v18, vcc
    v_cndmask_b32_e32 v30, 0, v20, vcc
    v_cndmask_b32_e32 v31, 0, v22, vcc
    v_mfma_f32_16x16x32_bf16 v[16:19], v[32:35], v[24:27], 0
    v_mfma_f32_16x16x32_bf16 v[32:35], v[40:43], v[24:27], 0
    v_mfma_f32_16x16x32_bf16 v[16:19], v[36:39], v[28:31], v[16:19]
    v_mfma_f32_16x16x32_bf16 v[40:43], v[48:51], v[24:27], 0
    v_mfma_f32_16x16x32_bf16 v[32:35], v[44:47], v[28:31], v[32:35]
    v_mfma_f32_16x16x32_bf16 v[48:51], v[56:59], v[24:27], 0
    v_mfma_f32_16x16x32_bf16 v[40:43], v[52:55], v[28:31], v[40:43]
    v_mfma_f32_16x16x32_bf16 v[56:59], v[64:67], v[24:27], 0
    v_mfma_f32_16x16x32_bf16 v[48:51], v[60:63], v[28:31], v[48:51]
    s_nop 1
    v_add_f32_dpp v10, v17, v16 row_ror:12 row_mask:0xf bank_mask:0x1
    s_memrealtime s[8:9]
    s_waitcnt lgkmcnt(0)
    s_sub_u32 s8, s8, s30
    s_cmpk_ge_u32 s8, 1390
    s_nop 0
    s_cbranch_scc1 .ap_203
    s_waitcnt vmcnt(3)
    s_cmpk_ge_u32 s8, 1325
    s_cbranch_scc1 .ap_203
    s_waitcnt vmcnt(3)
    s_bitcmp1_b64 s[14:15], 35
    s_cbranch_scc0 1
    s_waitcnt vmcnt(2)
    s_cmpk_ge_u32 s8, 1250
    s_cbranch_scc1 .ap_203
    s_waitcnt vmcnt(1)
.ap_203:
    s_add_u32 s63, s69, 24576
    buffer_load_dwordx4 v[172:175], v2, s[44:47], s63 offen nt
    v_mfma_f32_16x16x32_bf16 v[64:67], v[72:75], v[24:27], 0
    v_mfma_f32_16x16x32_bf16 v[56:59], v[68:71], v[28:31], v[56:59]
    v_add_f32_dpp v11, v33, v32 row_ror:12 row_mask:0xf bank_mask:0x1
    v_add_f32_dpp v10, v18, v10 row_ror:8 row_mask:0xf bank_mask:0x1
    v_mfma_f32_16x16x32_bf16 v[72:75], v[80:83], v[24:27], 0
    v_mfma_f32_16x16x32_bf16 v[64:67], v[76:79], v[28:31], v[64:67]
    v_add_f32_dpp v12, v41, v40 row_ror:12 row_mask:0xf bank_mask:0x1
    v_add_f32_dpp v11, v34, v11 row_ror:8 row_mask:0xf bank_mask:0x1
    v_add_f32_dpp v10, v19, v10 row_ror:4 row_mask:0xf bank_mask:0x1
    v_mfma_f32_16x16x32_bf16 v[80:83], v[88:91], v[24:27], 0
    v_mfma_f32_16x16x32_bf16 v[72:75], v[84:87], v[28:31], v[72:75]
    v_add_f32_dpp v13, v49, v48 row_ror:12 row_mask:0xf bank_mask:0x1
    v_add_f32_dpp v12, v42, v12 row_ror:8 row_mask:0xf bank_mask:0x1
    v_add_f32_dpp v11, v35, v11 row_ror:4 row_mask:0xf bank_mask:0x1
    v_mfma_f32_16x16x32_bf16 v[88:91], v[96:99], v[24:27], 0
    v_mfma_f32_16x16x32_bf16 v[80:83], v[92:95], v[28:31], v[80:83]
    v_add_f32_dpp v10, v58, v57 row_ror:12 row_mask:0xf bank_mask:0x2
    v_add_f32_dpp v13, v50, v13 row_ror:8 row_mask:0xf bank_mask:0x1
    v_add_f32_dpp v12, v43, v12 row_ror:4 row_mask:0xf bank_mask:0x1
    s_memrealtime s[8:9]
    s_waitcnt lgkmcnt(0)
    s_sub_u32 s8, s8, s30
    s_cmpk_ge_u32 s8, 1417
    s_nop 0
    s_cbranch_scc1 .ap_204
    s_waitcnt vmcnt(4)
    s_cmpk_ge_u32 s8, 1352
    s_cbranch_scc1 .ap_204
    s_waitcnt vmcnt(3)
    s_bitcmp1_b64 s[14:15], 36
    s_cbranch_scc0 1
    s_waitcnt vmcnt(2)
    s_cmpk_ge_u32 s8, 1277
    s_cbranch_scc1 .ap_204
    s_waitcnt vmcnt(1)
.ap_204:
    s_add_u32 s63, s69, 32768
    buffer_load_dwordx4 v[176:179], v2, s[44:47], s63 offen nt
    v_mfma_f32_16x16x32_bf16 v[96:99], v[104:107], v[24:27], 0
    v_mfma_f32_16x16x32_bf16 v[88:91], v[100:103], v[28:31], v[88:91]
    v_add_f32_dpp v11, v66, v65 row_ror:12 row_mask:0xf bank_mask:0x2
    v_add_f32_dpp v10, v59, v10 row_ror:8 row_mask:0xf bank_mask:0x2
    v_add_f32_dpp v13, v51, v13 row_ror:4 row_mask:0xf bank_mask:0x1
    v_mfma_f32_16x16x32_bf16 v[104:107], v[112:115], v[24:27], 0
    v_mfma_f32_16x16x32_bf16 v[96:99], v[108:111], v[28:31], v[96:99]
    v_add_f32_dpp v12, v74, v73 row_ror:12 row_mask:0xf bank_mask:0x2
    v_add_f32_dpp v11, v67, v11 row_ror:8 row_mask:0xf bank_mask:0x2
    v_add_f32_dpp v10, v56, v10 row_ror:4 row_mask:0xf bank_mask:0x2
    v_mfma_f32_16x16x32_bf16 v[112:115], v[120:123], v[24:27], 0
    v_mfma_f32_16x16x32_bf16 v[104:107], v[116:119], v[28:31], v[104:107]
    v_add_f32_dpp v13, v82, v81 row_ror:12 row_mask:0xf bank_mask:0x2
    v_add_f32_dpp v12, v75, v12 row_ror:8 row_mask:0xf bank_mask:0x2
    v_add_f32_dpp v11, v64, v11 row_ror:4 row_mask:0xf bank_mask:0x2
    v_mfma_f32_16x16x32_bf16 v[120:123], v[128:131], v[24:27], 0
    v_mfma_f32_16x16x32_bf16 v[112:115], v[124:127], v[28:31], v[112:115]
    v_add_f32_dpp v10, v91, v90 row_ror:12 row_mask:0xf bank_mask:0x4
    v_add_f32_dpp v13, v83, v13 row_ror:8 row_mask:0xf bank_mask:0x2
    v_add_f32_dpp v12, v72, v12 row_ror:4 row_mask:0xf bank_mask:0x2
    s_memrealtime s[8:9]
    s_waitcnt lgkmcnt(0)
    s_sub_u32 s8, s8, s30
    s_cmpk_ge_u32 s8, 1444
    s_nop 0
    s_cbranch_scc1 .ap_205
    s_waitcnt vmcnt(5)
    s_cmpk_ge_u32 s8, 1379
    s_cbranch_scc1 .ap_205
    s_waitcnt vmcnt(3)
    s_bitcmp1_b64 s[14:15], 37
    s_cbranch_scc0 1
    s_waitcnt vmcnt(2)
    s_cmpk_ge_u32 s8, 1304
    s_cbranch_scc1 .ap_205
    s_waitcnt vmcnt(1)
.ap_205:
    s_add_u32 s63, s69, 40960
    buffer_load_dwordx4 v[180:183], v2, s[44:47], s63 offen nt
    v_mfma_f32_16x16x32_bf16 v[128:131], v[136:139], v[24:27], 0
    v_mfma_f32_16x16x32_bf16 v[120:123], v[132:135], v[28:31], v[120:123]
    v_add_f32_dpp v11, v99, v98 row_ror:12 row_mask:0xf bank_mask:0x4
    v_add_f32_dpp v10, v88, v10 row_ror:8 row_mask:0xf bank_mask:0x4
    v_add_f32_dpp v13, v80, v13 row_ror:4 row_mask:0xf bank_mask:0x2
    v_mfma_f32_16x16x32_bf16 v[136:139], v[144:147], v[24:27], 0
    v_mfma_f32_16x16x32_bf16 v[128:131], v[140:143], v[28:31], v[128:131]
    v_add_f32_dpp v12, v107, v106 row_ror:12 row_mask:0xf bank_mask:0x4
    v_add_f32_dpp v11, v96, v11 row_ror:8 row_mask:0xf bank_mask:0x4
    v_add_f32_dpp v10, v89, v10 row_ror:4 row_mask:0xf bank_mask:0x4
    v_mfma_f32_16x16x32_bf16 v[144:147], v[152:155], v[24:27], 0
    v_mfma_f32_16x16x32_bf16 v[136:139], v[148:151], v[28:31], v[136:139]
    v_add_f32_dpp v13, v115, v114 row_ror:12 row_mask:0xf bank_mask:0x4
    v_add_f32_dpp v12, v104, v12 row_ror:8 row_mask:0xf bank_mask:0x4
    v_add_f32_dpp v11, v97, v11 row_ror:4 row_mask:0xf bank_mask:0x4
    v_mfma_f32_16x16x32_bf16 v[144:147], v[156:159], v[28:31], v[144:147]
    v_add_f32_dpp v10, v120, v123 row_ror:12 row_mask:0xf bank_mask:0x8
    v_add_f32_dpp v13, v112, v13 row_ror:8 row_mask:0xf bank_mask:0x4
    v_add_f32_dpp v12, v105, v12 row_ror:4 row_mask:0xf bank_mask:0x4
    s_memrealtime s[8:9]
    s_waitcnt lgkmcnt(0)
    s_sub_u32 s8, s8, s30
    s_cmpk_ge_u32 s8, 1471
    s_nop 0
    s_cbranch_scc1 .ap_206
    s_waitcnt vmcnt(5)
    s_cmpk_ge_u32 s8, 1406
    s_cbranch_scc1 .ap_206
    s_waitcnt vmcnt(3)
    s_bitcmp1_b64 s[14:15], 38
    s_cbranch_scc0 1
    s_waitcnt vmcnt(2)
    s_cmpk_ge_u32 s8, 1331
    s_cbranch_scc1 .ap_206
    s_waitcnt vmcnt(1)
.ap_206:
    s_add_u32 s63, s69, 49152
    buffer_load_dwordx4 v[184:187], v2, s[44:47], s63 offen nt
    v_add_f32_dpp v11, v128, v131 row_ror:12 row_mask:0xf bank_mask:0x8
    v_add_f32_dpp v10, v121, v10 row_ror:8 row_mask:0xf bank_mask:0x8
    v_add_f32_dpp v13, v113, v13 row_ror:4 row_mask:0xf bank_mask:0x4
    v_add_f32_dpp v12, v136, v139 row_ror:12 row_mask:0xf bank_mask:0x8
    v_add_f32_dpp v11, v129, v11 row_ror:8 row_mask:0xf bank_mask:0x8
    v_add_f32_dpp v10, v122, v10 row_ror:4 row_mask:0xf bank_mask:0x8
    v_add_f32_dpp v13, v144, v147 row_ror:12 row_mask:0xf bank_mask:0x8
    v_add_f32_dpp v12, v137, v12 row_ror:8 row_mask:0xf bank_mask:0x8
    v_add_f32_dpp v11, v130, v11 row_ror:4 row_mask:0xf bank_mask:0x8
    v_add_f32_dpp v13, v145, v13 row_ror:8 row_mask:0xf bank_mask:0x8
    v_add_f32_dpp v12, v138, v12 row_ror:4 row_mask:0xf bank_mask:0x8
    s_memrealtime s[8:9]
    s_waitcnt lgkmcnt(0)
    s_sub_u32 s8, s8, s30
    s_cmpk_ge_u32 s8, 1498
    s_cbranch_scc1 .ap_207
    s_waitcnt vmcnt(5)
    s_cmpk_ge_u32 s8, 1433
    s_cbranch_scc1 .ap_207
    s_waitcnt vmcnt(3)
    s_bitcmp1_b64 s[14:15], 39
    s_cbranch_scc0 1
    s_waitcnt vmcnt(2)
    s_cmpk_ge_u32 s8, 1358
    s_cbranch_scc1 .ap_207
    s_waitcnt vmcnt(1)
.ap_207:
    s_add_u32 s63, s69, 57344
    buffer_load_dwordx4 v[188:191], v2, s[44:47], s63 offen nt
    v_add_f32_dpp v13, v146, v13 row_ror:4 row_mask:0xf bank_mask:0x8
    s_mov_b32 s60, 0x3db504f3
    s_mov_b32 s61, 0x3db504f3
    v_cvt_pk_bf16_f32 v10, v10, v11
    v_and_b32 v11, 0xffff0000, v10
    v_lshlrev_b32 v10, 16, v10
    v_cvt_pk_bf16_f32 v12, v12, v13
    v_and_b32 v13, 0xffff0000, v12
    v_lshlrev_b32 v12, 16, v12
    v_pk_mul_f32 v[10:11], v[10:11], s[60:61]
    v_pk_mul_f32 v[12:13], v[12:13], s[60:61]
    v_cvt_pk_bf16_f32 v10, v10, v11
    v_and_b32 v11, 0xffff0000, v10
    v_lshlrev_b32 v10, 16, v10
    v_cvt_pk_bf16_f32 v12, v12, v13
    v_and_b32 v13, 0xffff0000, v12
    v_lshlrev_b32 v12, 16, v12
    v_max_f32 v14, v10, v11
    v_max3_f32 v14, v14, v12, v13
    s_mov_b32 s60, 0x3fb8aa3b
    v_mov_b32 v22, s34
    v_mov_b32 v23, s34
    v_max_f32_dpp v14, v14, v14 quad_perm:[2,3,0,1] row_mask:0xf bank_mask:0xf
    s_nop 1
    v_max_f32_dpp v14, v14, v14 row_ror:4 row_mask:0xf bank_mask:0xf
    s_nop 1
    v_max_f32_dpp v14, v14, v14 row_ror:8 row_mask:0xf bank_mask:0xf
    v_mov_b32 v15, v14
    s_nop 1
    v_permlane16_swap_b32 v15, v14
    v_max_f32 v14, v15, v14
    v_mov_b32 v15, v14
    s_nop 1
    v_permlane32_swap_b32 v15, v14
    v_max_f32 v14, v15, v14
    v_mul_f32 v15, 0xbfb8aa3b, v14
    v_fma_f32 v10, v10, s60, v15
    v_fma_f32 v11, v11, s60, v15
    v_fma_f32 v12, v12, s60, v15
    v_fma_f32 v13, v13, s60, v15
    v_exp_f32 v10, v10
    v_exp_f32 v11, v11
    v_exp_f32 v12, v12
    v_exp_f32 v13, v13
    v_mov_b32 v20, v14
    v_pk_add_f32 v[16:17], v[10:11], v[12:13]
    v_add_f32 v21, v16, v17
    s_lshl3_add_u32 s60, s68, s3
    s_lshl_b32 s60, s60, 5
    s_add_u32 s60, s60, s59
    v_add_f32_dpp v21, v21, v21 quad_perm:[2,3,0,1] row_mask:0xf bank_mask:0xf
    s_nop 1
    v_add_f32_dpp v21, v21, v21 row_ror:4 row_mask:0xf bank_mask:0xf
    s_nop 1
    v_add_f32_dpp v21, v21, v21 row_ror:8 row_mask:0xf bank_mask:0xf
    v_mov_b32 v15, v21
    s_nop 1
    v_permlane16_swap_b32 v15, v21
    v_add_f32 v21, v15, v21
    v_mov_b32 v15, v21
    s_nop 1
    v_permlane32_swap_b32 v15, v21
    v_add_f32 v21, v15, v21
    s_mov_b64 exec, 3
    buffer_store_dwordx4 v[20:23], v2, s[36:39], s60 offen sc1
    s_mov_b64 exec, -1
    s_memrealtime s[8:9]
    s_waitcnt vmcnt(8)
    s_waitcnt lgkmcnt(0)
    s_sub_u32 s8, s8, s30
    s_cmpk_ge_u32 s8, 1525
    s_cbranch_scc1 .ap_208
    s_waitcnt vmcnt(5)
    s_cmpk_ge_u32 s8, 1460
    s_cbranch_scc1 .ap_208
    s_waitcnt vmcnt(3)
    s_bitcmp1_b64 s[14:15], 40
    s_cbranch_scc0 1
    s_waitcnt vmcnt(2)
    s_cmpk_ge_u32 s8, 1385
    s_cbranch_scc1 .ap_208
    s_waitcnt vmcnt(1)
.ap_208:
    s_add_u32 s63, s69, 131072
    buffer_load_dwordx4 v[192:195], v2, s[44:47], s63 offen nt
    s_memrealtime s[8:9]
    s_waitcnt vmcnt(8)
    s_waitcnt lgkmcnt(0)
    s_sub_u32 s8, s8, s30
    s_cmpk_ge_u32 s8, 1552
    s_cbranch_scc1 .ap_209
    s_waitcnt vmcnt(5)
    s_cmpk_ge_u32 s8, 1487
    s_cbranch_scc1 .ap_209
    s_waitcnt vmcnt(3)
    s_bitcmp1_b64 s[14:15], 41
    s_cbranch_scc0 1
    s_waitcnt vmcnt(2)
    s_cmpk_ge_u32 s8, 1412
    s_cbranch_scc1 .ap_209
    s_waitcnt vmcnt(1)
.ap_209:
    s_add_u32 s63, s69, 139264
    buffer_load_dwordx4 v[196:199], v2, s[44:47], s63 offen nt
    s_memrealtime s[8:9]
    s_waitcnt vmcnt(8)
    s_waitcnt lgkmcnt(0)
    s_sub_u32 s8, s8, s30
    s_cmpk_ge_u32 s8, 1579
    s_cbranch_scc1 .ap_210
    s_waitcnt vmcnt(5)
    s_cmpk_ge_u32 s8, 1514
    s_cbranch_scc1 .ap_210
    s_waitcnt vmcnt(3)
    s_bitcmp1_b64 s[14:15], 42
    s_cbranch_scc0 1
    s_waitcnt vmcnt(2)
    s_cmpk_ge_u32 s8, 1439
    s_cbranch_scc1 .ap_210
    s_waitcnt vmcnt(1)
.ap_210:
    s_add_u32 s63, s69, 147456
    buffer_load_dwordx4 v[200:203], v2, s[44:47], s63 offen nt
    s_memrealtime s[8:9]
    s_waitcnt vmcnt(8)
    s_waitcnt lgkmcnt(0)
    s_sub_u32 s8, s8, s30
    s_cmpk_ge_u32 s8, 1606
    s_cbranch_scc1 .ap_211
    s_waitcnt vmcnt(5)
    s_cmpk_ge_u32 s8, 1541
    s_cbranch_scc1 .ap_211
    s_waitcnt vmcnt(3)
    s_bitcmp1_b64 s[14:15], 43
    s_cbranch_scc0 1
    s_waitcnt vmcnt(2)
    s_cmpk_ge_u32 s8, 1466
    s_cbranch_scc1 .ap_211
    s_waitcnt vmcnt(1)
.ap_211:
    s_add_u32 s63, s69, 155648
    buffer_load_dwordx4 v[204:207], v2, s[44:47], s63 offen nt
    s_memrealtime s[8:9]
    s_waitcnt vmcnt(8)
    s_waitcnt lgkmcnt(0)
    s_sub_u32 s8, s8, s30
    s_cmpk_ge_u32 s8, 1633
    s_cbranch_scc1 .ap_212
    s_waitcnt vmcnt(5)
    s_cmpk_ge_u32 s8, 1568
    s_cbranch_scc1 .ap_212
    s_waitcnt vmcnt(3)
    s_bitcmp1_b64 s[14:15], 44
    s_cbranch_scc0 1
    s_waitcnt vmcnt(2)
    s_cmpk_ge_u32 s8, 1493
    s_cbranch_scc1 .ap_212
    s_waitcnt vmcnt(1)
.ap_212:
    s_add_u32 s63, s69, 163840
    buffer_load_dwordx4 v[208:211], v2, s[44:47], s63 offen nt
    s_memrealtime s[8:9]
    s_waitcnt vmcnt(8)
    s_waitcnt lgkmcnt(0)
    s_sub_u32 s8, s8, s30
    s_cmpk_ge_u32 s8, 1660
    s_cbranch_scc1 .ap_213
    s_waitcnt vmcnt(5)
    s_cmpk_ge_u32 s8, 1595
    s_cbranch_scc1 .ap_213
    s_waitcnt vmcnt(3)
    s_bitcmp1_b64 s[14:15], 45
    s_cbranch_scc0 1
    s_waitcnt vmcnt(2)
    s_cmpk_ge_u32 s8, 1520
    s_cbranch_scc1 .ap_213
    s_waitcnt vmcnt(1)
.ap_213:
    s_add_u32 s63, s69, 172032
    buffer_load_dwordx4 v[212:215], v2, s[44:47], s63 offen nt
    s_memrealtime s[8:9]
    s_waitcnt vmcnt(8)
    s_waitcnt lgkmcnt(0)
    s_sub_u32 s8, s8, s30
    s_cmpk_ge_u32 s8, 1691
    s_cbranch_scc1 .ap_214
    s_waitcnt vmcnt(5)
    s_cmpk_ge_u32 s8, 1626
    s_cbranch_scc1 .ap_214
    s_waitcnt vmcnt(3)
    s_bitcmp1_b64 s[14:15], 46
    s_cbranch_scc0 1
    s_waitcnt vmcnt(2)
    s_cmpk_ge_u32 s8, 1551
    s_cbranch_scc1 .ap_214
    s_waitcnt vmcnt(1)
.ap_214:
    s_add_u32 s63, s69, 180224
    buffer_load_dwordx4 v[216:219], v2, s[44:47], s63 offen nt
    s_memrealtime s[8:9]
    s_waitcnt vmcnt(8)
    s_waitcnt lgkmcnt(0)
    s_sub_u32 s8, s8, s30
    s_cmpk_ge_u32 s8, 1722
    s_cbranch_scc1 .ap_215
    s_waitcnt vmcnt(5)
    s_cmpk_ge_u32 s8, 1657
    s_cbranch_scc1 .ap_215
    s_waitcnt vmcnt(3)
    s_bitcmp1_b64 s[14:15], 47
    s_cbranch_scc0 1
    s_waitcnt vmcnt(2)
    s_cmpk_ge_u32 s8, 1582
    s_cbranch_scc1 .ap_215
    s_waitcnt vmcnt(1)
.ap_215:
    s_add_u32 s63, s69, 188416
    buffer_load_dwordx4 v[220:223], v2, s[44:47], s63 offen nt
    s_memrealtime s[8:9]
    s_waitcnt vmcnt(8)
    s_waitcnt lgkmcnt(0)
    s_sub_u32 s8, s8, s30
    s_cmpk_ge_u32 s8, 1753
    s_cbranch_scc1 .ap_216
    s_waitcnt vmcnt(5)
    s_cmpk_ge_u32 s8, 1688
    s_cbranch_scc1 .ap_216
    s_waitcnt vmcnt(3)
    s_bitcmp1_b64 s[14:15], 48
    s_cbranch_scc0 1
    s_waitcnt vmcnt(2)
    s_cmpk_ge_u32 s8, 1613
    s_cbranch_scc1 .ap_216
    s_waitcnt vmcnt(1)
.ap_216:
    s_add_u32 s63, s69, 262144
    buffer_load_dwordx4 v[224:227], v2, s[44:47], s63 offen nt
    s_memrealtime s[8:9]
    s_waitcnt vmcnt(8)
    s_waitcnt lgkmcnt(0)
    s_sub_u32 s8, s8, s30
    s_cmpk_ge_u32 s8, 1784
    s_cbranch_scc1 .ap_217
    s_waitcnt vmcnt(5)
    s_cmpk_ge_u32 s8, 1719
    s_cbranch_scc1 .ap_217
    s_waitcnt vmcnt(3)
    s_bitcmp1_b64 s[14:15], 49
    s_cbranch_scc0 1
    s_waitcnt vmcnt(2)
    s_cmpk_ge_u32 s8, 1644
    s_cbranch_scc1 .ap_217
    s_waitcnt vmcnt(1)
.ap_217:
    s_add_u32 s63, s69, 270336
    buffer_load_dwordx4 v[228:231], v2, s[44:47], s63 offen nt
    s_memrealtime s[8:9]
    s_waitcnt vmcnt(8)
    s_waitcnt lgkmcnt(0)
    s_sub_u32 s8, s8, s30
    s_cmpk_ge_u32 s8, 1815
    s_cbranch_scc1 .ap_218
    s_waitcnt vmcnt(5)
    s_cmpk_ge_u32 s8, 1750
    s_cbranch_scc1 .ap_218
    s_waitcnt vmcnt(3)
    s_bitcmp1_b64 s[14:15], 50
    s_cbranch_scc0 1
    s_waitcnt vmcnt(2)
    s_cmpk_ge_u32 s8, 1675
    s_cbranch_scc1 .ap_218
    s_waitcnt vmcnt(1)
.ap_218:
    s_add_u32 s63, s69, 278528
    buffer_load_dwordx4 v[232:235], v2, s[44:47], s63 offen nt
    s_memrealtime s[8:9]
    s_waitcnt vmcnt(8)
    s_waitcnt lgkmcnt(0)
    s_sub_u32 s8, s8, s30
    s_cmpk_ge_u32 s8, 1846
    s_cbranch_scc1 .ap_219
    s_waitcnt vmcnt(5)
    s_cmpk_ge_u32 s8, 1781
    s_cbranch_scc1 .ap_219
    s_waitcnt vmcnt(3)
    s_bitcmp1_b64 s[14:15], 51
    s_cbranch_scc0 1
    s_waitcnt vmcnt(2)
    s_cmpk_ge_u32 s8, 1706
    s_cbranch_scc1 .ap_219
    s_waitcnt vmcnt(1)
.ap_219:
    s_add_u32 s63, s69, 286720
    buffer_load_dwordx4 v[236:239], v2, s[44:47], s63 offen nt
    s_memrealtime s[8:9]
    s_waitcnt vmcnt(8)
    s_waitcnt lgkmcnt(0)
    s_sub_u32 s8, s8, s30
    s_cmpk_ge_u32 s8, 1877
    s_cbranch_scc1 .ap_220
    s_waitcnt vmcnt(5)
    s_cmpk_ge_u32 s8, 1812
    s_cbranch_scc1 .ap_220
    s_waitcnt vmcnt(3)
    s_bitcmp1_b64 s[14:15], 52
    s_cbranch_scc0 1
    s_waitcnt vmcnt(2)
    s_cmpk_ge_u32 s8, 1737
    s_cbranch_scc1 .ap_220
    s_waitcnt vmcnt(1)
.ap_220:
    s_add_u32 s63, s69, 294912
    buffer_load_dwordx4 v[240:243], v2, s[44:47], s63 offen nt
    s_memrealtime s[8:9]
    s_waitcnt vmcnt(8)
    s_waitcnt lgkmcnt(0)
    s_sub_u32 s8, s8, s30
    s_cmpk_ge_u32 s8, 1908
    s_cbranch_scc1 .ap_221
    s_waitcnt vmcnt(5)
    s_cmpk_ge_u32 s8, 1843
    s_cbranch_scc1 .ap_221
    s_waitcnt vmcnt(3)
    s_bitcmp1_b64 s[14:15], 53
    s_cbranch_scc0 1
    s_waitcnt vmcnt(2)
    s_cmpk_ge_u32 s8, 1768
    s_cbranch_scc1 .ap_221
    s_waitcnt vmcnt(1)
.ap_221:
    s_add_u32 s63, s69, 303104
    buffer_load_dwordx4 v[244:247], v2, s[44:47], s63 offen nt
    s_and_b32 s0, s0, 0xffffff80
    s_sub_u32 s0, s0, 1024
    buffer_load_dword v28, v4, s[36:39], s0 offen sc1
    buffer_load_dwordx4 v[24:27], v9, s[36:39], s59 offen offset:0 sc1
    s_memrealtime s[8:9]
    s_waitcnt vmcnt(9)
    s_waitcnt lgkmcnt(0)
    s_sub_u32 s8, s8, s30
    s_cmpk_ge_u32 s8, 1939
    s_cbranch_scc1 .ap_222
    s_waitcnt vmcnt(6)
    s_cmpk_ge_u32 s8, 1874
    s_cbranch_scc1 .ap_222
    s_waitcnt vmcnt(4)
    s_bitcmp1_b64 s[14:15], 54
    s_cbranch_scc0 1
    s_waitcnt vmcnt(3)
    s_cmpk_ge_u32 s8, 1799
    s_cbranch_scc1 .ap_222
    s_waitcnt vmcnt(2)
.ap_222:
    s_add_u32 s63, s69, 311296
    buffer_load_dwordx4 v[248:251], v2, s[44:47], s63 offen nt
    s_sub_u32 s56, s65, 27
    s_lshl3_add_u32 s56, s56, s3
    s_cmp_ge_u32 s56, 11
    s_cbranch_scc1 .cpf_223
    s_getpc_b64 s[8:9]
.Lcpf_pc:
    s_cmp_ge_u32 s56, 6
    s_mov_b32 s57, .Lcpf_pc-.Ltail_ar
    s_cselect_b32 s57, .Lcpf_pc-.Ltail_bc+6144, s57
    s_lshl_b32 s56, s56, 10
    s_sub_u32 s56, s57, s56
    s_sub_u32 s8, s8, s56
    s_subb_u32 s9, s9, 0
    v_mov_b32 v41, s9
    v_add_co_u32 v40, vcc, s8, v2
    s_nop 1
    v_addc_co_u32 v41, vcc, 0, v41, vcc
    global_load_dwordx4 v[32:35], v[40:41], off
.cpf_223:
    s_memrealtime s[8:9]
    s_waitcnt vmcnt(9)
    s_waitcnt lgkmcnt(0)
    s_sub_u32 s8, s8, s30
    s_cmpk_ge_u32 s8, 1970
    s_cbranch_scc1 .ap_224
    s_waitcnt vmcnt(6)
    s_cmpk_ge_u32 s8, 1905
    s_cbranch_scc1 .ap_224
    s_waitcnt vmcnt(4)
    s_bitcmp1_b64 s[14:15], 55
    s_cbranch_scc0 1
    s_waitcnt vmcnt(3)
    s_cmpk_ge_u32 s8, 1830
    s_cbranch_scc1 .ap_224
    s_waitcnt vmcnt(1)
.ap_224:
    s_add_u32 s63, s69, 319488
    buffer_load_dwordx4 v[252:255], v2, s[44:47], s63 offen nt
    s_memrealtime s[8:9]
    s_waitcnt vmcnt(9)
    s_waitcnt lgkmcnt(0)
    s_sub_u32 s8, s8, s30
    s_cmpk_ge_u32 s8, 2001
    s_cbranch_scc1 .ap_225
    s_waitcnt vmcnt(6)
    s_cmpk_ge_u32 s8, 1936
    s_cbranch_scc1 .ap_225
    s_waitcnt vmcnt(4)
    s_bitcmp1_b64 s[14:15], 56
    s_cbranch_scc0 1
    s_waitcnt vmcnt(2)
    s_cmpk_ge_u32 s8, 1861
    s_cbranch_scc1 .ap_225
    s_waitcnt vmcnt(1)
.ap_225:
    s_add_u32 s63, s69, 393216
    buffer_load_dwordx4 v[36:39], v2, s[44:47], s63 offen nt
    s_memrealtime s[8:9]
    s_waitcnt vmcnt(9)
    s_waitcnt lgkmcnt(0)
    s_sub_u32 s8, s8, s30
    s_cmpk_ge_u32 s8, 2032
    s_cbranch_scc1 .ap_226
    s_waitcnt vmcnt(6)
    s_cmpk_ge_u32 s8, 1967
    s_cbranch_scc1 .ap_226
    s_waitcnt vmcnt(3)
    s_bitcmp1_b64 s[14:15], 57
    s_cbranch_scc0 1
    s_waitcnt vmcnt(2)
    s_cmpk_ge_u32 s8, 1892
    s_cbranch_scc1 .ap_226
    s_waitcnt vmcnt(1)
.ap_226:
    s_add_u32 s63, s69, 401408
    buffer_load_dwordx4 v[44:47], v2, s[44:47], s63 offen nt
    s_memrealtime s[8:9]
    s_waitcnt vmcnt(9)
    s_waitcnt lgkmcnt(0)
    s_sub_u32 s8, s8, s30
    s_cmpk_ge_u32 s8, 2063
    s_cbranch_scc1 .ap_227
    s_waitcnt vmcnt(6)
    s_cmpk_ge_u32 s8, 1998
    s_cbranch_scc1 .ap_227
    s_waitcnt vmcnt(3)
    s_bitcmp1_b64 s[14:15], 58
    s_cbranch_scc0 1
    s_waitcnt vmcnt(2)
    s_cmpk_ge_u32 s8, 1923
    s_cbranch_scc1 .ap_227
    s_waitcnt vmcnt(1)
.ap_227:
    s_add_u32 s63, s69, 409600
    buffer_load_dwordx4 v[52:55], v2, s[44:47], s63 offen nt
    s_waitcnt vmcnt(5)
    s_branch .gpc_229
.gp_228:
    buffer_load_dwordx4 v[24:27], v9, s[36:39], s59 offen offset:0 sc1
    s_waitcnt vmcnt(0)
.gpc_229:
    v_cmp_eq_u32 vcc, s34, v26
    s_cmp_eq_u64 vcc, exec
    s_nop 3
    s_cbranch_scc1 .gpd_230
    s_sub_u32 s35, s35, 1
    s_cbranch_scc1 .Lexit
    s_sleep 1
    s_branch .gp_228
.gpd_230:
    v_cmp_eq_u32 vcc, s1, v28
    s_cmp_eq_u64 vcc, -1
    s_cselect_b32 s0, 0xac000, 0
    v_mov_b32 v16, v24
    s_nop 1
    v_max_f32_dpp v16, v16, v16 row_ror:8 row_mask:0xf bank_mask:0xf
    s_nop 1
    v_max_f32_dpp v16, v16, v16 row_ror:4 row_mask:0xf bank_mask:0xf
    v_mov_b32 v17, v16
    s_nop 1
    v_permlane16_swap_b32 v17, v16
    v_max_f32 v16, v17, v16
    v_mov_b32 v17, v16
    s_nop 1
    v_permlane32_swap_b32 v17, v16
    v_max_f32 v16, v17, v16
    v_sub_f32 v17, v24, v16
    v_sub_f32 v18, v14, v16
    v_mul_f32 v17, 0x3fb8aa3b, v17
    v_mul_f32 v18, 0x3fb8aa3b, v18
    v_exp_f32 v17, v17
    v_exp_f32 v18, v18
    v_mul_f32 v17, v17, v25
    s_nop 1
    v_add_f32_dpp v17, v17, v17 row_ror:8 row_mask:0xf bank_mask:0xf
    s_nop 1
    v_add_f32_dpp v17, v17, v17 row_ror:4 row_mask:0xf bank_mask:0xf
    v_mov_b32 v19, v17
    s_nop 1
    v_permlane16_swap_b32 v19, v17
    v_add_f32 v17, v19, v17
    v_mov_b32 v19, v17
    s_nop 1
    v_permlane32_swap_b32 v19, v17
    v_add_f32 v17, v19, v17
    v_rcp_f32 v19, v17
    s_nop 0
    v_fma_f32 v15, -v17, v19, 1.0
    v_fma_f32 v19, v15, v19, v19
    v_mul_f32 v18, v18, v19
    v_mul_f32 v10, v10, v18
    v_mul_f32 v11, v11, v18
    v_mul_f32 v12, v12, v18
    v_mul_f32 v13, v13, v18
    v_mov_b32_dpp v112, v10 quad_perm:[2,3,0,1] row_mask:0xf bank_mask:0xf
    v_mov_b32_dpp v113, v11 quad_perm:[2,3,0,1] row_mask:0xf bank_mask:0xf
    v_mov_b32_dpp v114, v12 quad_perm:[2,3,0,1] row_mask:0xf bank_mask:0xf
    v_mov_b32_dpp v115, v13 quad_perm:[2,3,0,1] row_mask:0xf bank_mask:0xf
    v_cvt_pk_bf16_f32 v96, v10, v112
    v_cvt_pk_bf16_f32 v100, v11, v113
    v_cvt_pk_bf16_f32 v104, v12, v114
    v_cvt_pk_bf16_f32 v108, v13, v115
    v_mov_b32_dpp v97, v96 row_ror:12 row_mask:0xf bank_mask:0xf
    v_mov_b32_dpp v101, v100 row_ror:12 row_mask:0xf bank_mask:0xf
    v_mov_b32_dpp v105, v104 row_ror:12 row_mask:0xf bank_mask:0xf
    v_mov_b32_dpp v109, v108 row_ror:12 row_mask:0xf bank_mask:0xf
    v_mov_b32_dpp v98, v96 row_ror:8 row_mask:0xf bank_mask:0xf
    v_mov_b32_dpp v102, v100 row_ror:8 row_mask:0xf bank_mask:0xf
    v_mov_b32_dpp v106, v104 row_ror:8 row_mask:0xf bank_mask:0xf
    v_mov_b32_dpp v110, v108 row_ror:8 row_mask:0xf bank_mask:0xf
    v_mov_b32_dpp v99, v96 row_ror:4 row_mask:0xf bank_mask:0xf
    v_mov_b32_dpp v103, v100 row_ror:4 row_mask:0xf bank_mask:0xf
    v_mov_b32_dpp v107, v104 row_ror:4 row_mask:0xf bank_mask:0xf
    v_mov_b32_dpp v111, v108 row_ror:4 row_mask:0xf bank_mask:0xf
    s_memrealtime s[8:9]
    s_waitcnt lgkmcnt(0)
    s_sub_u32 s8, s8, s30
    s_cmpk_ge_u32 s8, 2094
    s_cbranch_scc1 .ap_231
    s_waitcnt vmcnt(5)
    s_cmpk_ge_u32 s8, 2029
    s_cbranch_scc1 .ap_231
    s_waitcnt vmcnt(3)
    s_bitcmp1_b64 s[14:15], 59
    s_cbranch_scc0 1
    s_waitcnt vmcnt(2)
    s_cmpk_ge_u32 s8, 1954
    s_cbranch_scc1 .ap_231
    s_waitcnt vmcnt(1)
.ap_231:
    s_add_u32 s63, s69, 417792
    buffer_load_dwordx4 v[60:63], v2, s[44:47], s63 offen nt
    s_lshl_b32 s60, s3, 10
    s_add_u32 s60, s60, 132096
    v_lshlrev_b32 v10, 5, v0
    v_add_u32 v10, s60, v10
    v_lshrrev_b32 v11, 5, v0
    v_lshlrev_b32 v11, 13, v11
    v_and_b32 v12, 31, v0
    v_lshl_add_u32 v11, v12, 4, v11
    v_add_u32 v9, 132096, v2
    v_mov_b32 v15, s34
    s_memrealtime s[8:9]
    s_waitcnt lgkmcnt(0)
    s_sub_u32 s8, s8, s30
    s_cmpk_ge_u32 s8, 2125
    s_cbranch_scc1 .ap_232
    s_waitcnt vmcnt(5)
    s_cmpk_ge_u32 s8, 2060
    s_cbranch_scc1 .ap_232
    s_waitcnt vmcnt(3)
    s_bitcmp1_b64 s[14:15], 60
    s_cbranch_scc0 1
    s_waitcnt vmcnt(2)
    s_cmpk_ge_u32 s8, 1985
    s_cbranch_scc1 .ap_232
    s_waitcnt vmcnt(1)
.ap_232:
    s_add_u32 s63, s69, 425984
    buffer_load_dwordx4 v[68:71], v2, s[44:47], s63 offen nt
    v_perm_b32 v112, v164, v160, s94
    v_perm_b32 v113, v172, v168, s94
    v_perm_b32 v114, v180, v176, s94
    v_perm_b32 v115, v188, v184, s94
    s_nop 1
    v_mfma_f32_16x16x32_bf16 v[128:131], v[96:99], v[112:115], 0
    v_perm_b32 v116, v164, v160, s95
    v_perm_b32 v117, v172, v168, s95
    v_perm_b32 v118, v180, v176, s95
    v_perm_b32 v119, v188, v184, s95
    s_nop 1
    v_mfma_f32_16x16x32_bf16 v[132:135], v[96:99], v[116:119], 0
    v_perm_b32 v120, v165, v161, s94
    v_perm_b32 v121, v173, v169, s94
    v_perm_b32 v122, v181, v177, s94
    v_perm_b32 v123, v189, v185, s94
    s_nop 1
    v_mfma_f32_16x16x32_bf16 v[136:139], v[96:99], v[120:123], 0
    v_perm_b32 v124, v165, v161, s95
    v_perm_b32 v125, v173, v169, s95
    v_perm_b32 v126, v181, v177, s95
    v_perm_b32 v127, v189, v185, s95
    s_nop 1
    v_mfma_f32_16x16x32_bf16 v[140:143], v[96:99], v[124:127], 0
    v_perm_b32 v112, v166, v162, s94
    v_perm_b32 v113, v174, v170, s94
    v_perm_b32 v114, v182, v178, s94
    v_perm_b32 v115, v190, v186, s94
    s_nop 1
    v_mfma_f32_16x16x32_bf16 v[144:147], v[96:99], v[112:115], 0
    v_perm_b32 v116, v166, v162, s95
    v_perm_b32 v117, v174, v170, s95
    v_perm_b32 v118, v182, v178, s95
    v_perm_b32 v119, v190, v186, s95
    s_nop 1
    v_mfma_f32_16x16x32_bf16 v[148:151], v[96:99], v[116:119], 0
    v_perm_b32 v120, v167, v163, s94
    v_perm_b32 v121, v175, v171, s94
    v_perm_b32 v122, v183, v179, s94
    v_perm_b32 v123, v191, v187, s94
    s_nop 1
    v_mfma_f32_16x16x32_bf16 v[152:155], v[96:99], v[120:123], 0
    v_perm_b32 v124, v167, v163, s95
    v_perm_b32 v125, v175, v171, s95
    v_perm_b32 v126, v183, v179, s95
    v_perm_b32 v127, v191, v187, s95
    s_nop 1
    v_mfma_f32_16x16x32_bf16 v[156:159], v[96:99], v[124:127], 0
    s_memrealtime s[8:9]
    s_waitcnt lgkmcnt(0)
    s_sub_u32 s8, s8, s30
    s_cmpk_ge_u32 s8, 2156
    s_nop 3
    s_cbranch_scc1 .ap_233
    s_waitcnt vmcnt(5)
    s_cmpk_ge_u32 s8, 2091
    s_cbranch_scc1 .ap_233
    s_waitcnt vmcnt(3)
    s_bitcmp1_b64 s[14:15], 61
    s_cbranch_scc0 1
    s_waitcnt vmcnt(2)
    s_cmpk_ge_u32 s8, 2016
    s_cbranch_scc1 .ap_233
    s_waitcnt vmcnt(1)
.ap_233:
    s_add_u32 s63, s69, 434176
    buffer_load_dwordx4 v[76:79], v2, s[44:47], s63 offen nt
    v_perm_b32 v112, v196, v192, s94
    v_perm_b32 v113, v204, v200, s94
    v_perm_b32 v114, v212, v208, s94
    v_perm_b32 v115, v220, v216, s94
    s_nop 1
    v_mfma_f32_16x16x32_bf16 v[128:131], v[100:103], v[112:115], v[128:131]
    v_perm_b32 v116, v196, v192, s95
    v_perm_b32 v117, v204, v200, s95
    v_perm_b32 v118, v212, v208, s95
    v_perm_b32 v119, v220, v216, s95
    s_nop 1
    v_mfma_f32_16x16x32_bf16 v[132:135], v[100:103], v[116:119], v[132:135]
    v_perm_b32 v120, v197, v193, s94
    v_perm_b32 v121, v205, v201, s94
    v_perm_b32 v122, v213, v209, s94
    v_perm_b32 v123, v221, v217, s94
    s_nop 1
    v_mfma_f32_16x16x32_bf16 v[136:139], v[100:103], v[120:123], v[136:139]
    v_perm_b32 v124, v197, v193, s95
    v_perm_b32 v125, v205, v201, s95
    v_perm_b32 v126, v213, v209, s95
    v_perm_b32 v127, v221, v217, s95
    s_nop 1
    v_mfma_f32_16x16x32_bf16 v[140:143], v[100:103], v[124:127], v[140:143]
    v_perm_b32 v112, v198, v194, s94
    v_perm_b32 v113, v206, v202, s94
    v_perm_b32 v114, v214, v210, s94
    v_perm_b32 v115, v222, v218, s94
    s_nop 1
    v_mfma_f32_16x16x32_bf16 v[144:147], v[100:103], v[112:115], v[144:147]
    v_perm_b32 v116, v198, v194, s95
    v_perm_b32 v117, v206, v202, s95
    v_perm_b32 v118, v214, v210, s95
    v_perm_b32 v119, v222, v218, s95
    s_nop 1
    v_mfma_f32_16x16x32_bf16 v[148:151], v[100:103], v[116:119], v[148:151]
    v_perm_b32 v120, v199, v195, s94
    v_perm_b32 v121, v207, v203, s94
    v_perm_b32 v122, v215, v211, s94
    v_perm_b32 v123, v223, v219, s94
    s_nop 1
    v_mfma_f32_16x16x32_bf16 v[152:155], v[100:103], v[120:123], v[152:155]
    v_perm_b32 v124, v199, v195, s95
    v_perm_b32 v125, v207, v203, s95
    v_perm_b32 v126, v215, v211, s95
    v_perm_b32 v127, v223, v219, s95
    s_nop 1
    v_mfma_f32_16x16x32_bf16 v[156:159], v[100:103], v[124:127], v[156:159]
    s_memrealtime s[8:9]
    s_waitcnt lgkmcnt(0)
    s_sub_u32 s8, s8, s30
    s_cmpk_ge_u32 s8, 2187
    s_nop 3
    s_cbranch_scc1 .ap_234
    s_waitcnt vmcnt(5)
    s_cmpk_ge_u32 s8, 2122
    s_cbranch_scc1 .ap_234
    s_waitcnt vmcnt(3)
    s_bitcmp1_b64 s[14:15], 62
    s_cbranch_scc0 1
    s_waitcnt vmcnt(2)
    s_cmpk_ge_u32 s8, 2047
    s_cbranch_scc1 .ap_234
    s_waitcnt vmcnt(1)
.ap_234:
    s_add_u32 s63, s69, 442368
    buffer_load_dwordx4 v[84:87], v2, s[44:47], s63 offen nt
    s_waitcnt vmcnt(7)
    v_perm_b32 v112, v228, v224, s94
    v_perm_b32 v113, v236, v232, s94
    v_perm_b32 v114, v244, v240, s94
    v_perm_b32 v115, v252, v248, s94
    s_nop 1
    v_mfma_f32_16x16x32_bf16 v[128:131], v[104:107], v[112:115], v[128:131]
    v_perm_b32 v116, v228, v224, s95
    v_perm_b32 v117, v236, v232, s95
    v_perm_b32 v118, v244, v240, s95
    v_perm_b32 v119, v252, v248, s95
    s_nop 1
    v_mfma_f32_16x16x32_bf16 v[132:135], v[104:107], v[116:119], v[132:135]
    v_perm_b32 v120, v229, v225, s94
    v_perm_b32 v121, v237, v233, s94
    v_perm_b32 v122, v245, v241, s94
    v_perm_b32 v123, v253, v249, s94
    s_nop 1
    v_mfma_f32_16x16x32_bf16 v[136:139], v[104:107], v[120:123], v[136:139]
    v_perm_b32 v124, v229, v225, s95
    v_perm_b32 v125, v237, v233, s95
    v_perm_b32 v126, v245, v241, s95
    v_perm_b32 v127, v253, v249, s95
    s_nop 1
    v_mfma_f32_16x16x32_bf16 v[140:143], v[104:107], v[124:127], v[140:143]
    v_perm_b32 v112, v230, v226, s94
    v_perm_b32 v113, v238, v234, s94
    v_perm_b32 v114, v246, v242, s94
    v_perm_b32 v115, v254, v250, s94
    s_nop 1
    v_mfma_f32_16x16x32_bf16 v[144:147], v[104:107], v[112:115], v[144:147]
    v_perm_b32 v116, v230, v226, s95
    v_perm_b32 v117, v238, v234, s95
    v_perm_b32 v118, v246, v242, s95
    v_perm_b32 v119, v254, v250, s95
    s_nop 1
    v_mfma_f32_16x16x32_bf16 v[148:151], v[104:107], v[116:119], v[148:151]
    v_perm_b32 v120, v231, v227, s94
    v_perm_b32 v121, v239, v235, s94
    v_perm_b32 v122, v247, v243, s94
    v_perm_b32 v123, v255, v251, s94
    s_nop 1
    v_mfma_f32_16x16x32_bf16 v[152:155], v[104:107], v[120:123], v[152:155]
    v_perm_b32 v124, v231, v227, s95
    v_perm_b32 v125, v239, v235, s95
    v_perm_b32 v126, v247, v243, s95
    v_perm_b32 v127, v255, v251, s95
    s_nop 1
    v_mfma_f32_16x16x32_bf16 v[156:159], v[104:107], v[124:127], v[156:159]
    s_memrealtime s[8:9]
    s_waitcnt lgkmcnt(0)
    s_sub_u32 s8, s8, s30
    s_cmpk_ge_u32 s8, 2218
    s_nop 3
    s_cbranch_scc1 .ap_235
    s_waitcnt vmcnt(5)
    s_cmpk_ge_u32 s8, 2153
    s_cbranch_scc1 .ap_235
    s_waitcnt vmcnt(3)
    s_bitcmp1_b64 s[14:15], 63
    s_cbranch_scc0 1
    s_waitcnt vmcnt(2)
    s_cmpk_ge_u32 s8, 2078
    s_cbranch_scc1 .ap_235
    s_waitcnt vmcnt(1)
.ap_235:
    s_add_u32 s63, s69, 450560
    buffer_load_dwordx4 v[92:95], v2, s[44:47], s63 offen nt
    s_setprio 0
    s_waitcnt vmcnt(6)
    v_perm_b32 v160, v44, v36, s94
    v_perm_b32 v164, v44, v36, s95
    v_perm_b32 v168, v45, v37, s94
    v_perm_b32 v172, v45, v37, s95
    v_perm_b32 v176, v46, v38, s94
    v_perm_b32 v180, v46, v38, s95
    v_perm_b32 v184, v47, v39, s94
    v_perm_b32 v188, v47, v39, s95
    s_waitcnt vmcnt(4)
    v_perm_b32 v161, v60, v52, s94
    v_perm_b32 v165, v60, v52, s95
    v_perm_b32 v169, v61, v53, s94
    v_perm_b32 v173, v61, v53, s95
    v_perm_b32 v177, v62, v54, s94
    v_perm_b32 v181, v62, v54, s95
    v_perm_b32 v185, v63, v55, s94
    v_perm_b32 v189, v63, v55, s95
    s_waitcnt vmcnt(2)
    v_perm_b32 v162, v76, v68, s94
    v_perm_b32 v166, v76, v68, s95
    v_perm_b32 v170, v77, v69, s94
    v_perm_b32 v174, v77, v69, s95
    v_perm_b32 v178, v78, v70, s94
    v_perm_b32 v182, v78, v70, s95
    v_perm_b32 v186, v79, v71, s94
    v_perm_b32 v190, v79, v71, s95
.Ltail_n:
    s_waitcnt vmcnt(0)
    v_perm_b32 v163, v92, v84, s94
    v_perm_b32 v167, v92, v84, s95
    v_perm_b32 v171, v93, v85, s94
    v_perm_b32 v175, v93, v85, s95
    v_perm_b32 v179, v94, v86, s94
    v_perm_b32 v183, v94, v86, s95
    v_perm_b32 v187, v95, v87, s94
    v_perm_b32 v191, v95, v87, s95
    v_mfma_f32_16x16x32_bf16 v[128:131], v[108:111], v[160:163], v[128:131]
    v_mfma_f32_16x16x32_bf16 v[132:135], v[108:111], v[164:167], v[132:135]
    v_mfma_f32_16x16x32_bf16 v[136:139], v[108:111], v[168:171], v[136:139]
    v_mfma_f32_16x16x32_bf16 v[140:143], v[108:111], v[172:175], v[140:143]
    v_mfma_f32_16x16x32_bf16 v[144:147], v[108:111], v[176:179], v[144:147]
    v_mfma_f32_16x16x32_bf16 v[148:151], v[108:111], v[180:183], v[148:151]
    v_mfma_f32_16x16x32_bf16 v[152:155], v[108:111], v[184:187], v[152:155]
    v_mfma_f32_16x16x32_bf16 v[156:159], v[108:111], v[188:191], v[156:159]
    s_lshl4_add_u32 s56, s67, s66
    s_lshl1_add_u32 s56, s56, s68
    s_lshl_b32 s56, s56, 9
    s_add_u32 s56, s56, 0x210000
    s_mov_b32 s60, 0x07060503
    s_mov_b32 s61, 0x07060502
    s_mov_b32 s62, 0x07060501
    s_mov_b64 exec, 0xffff
    ds_write2_b32 v10, v128, v129 offset0:0 offset1:128
    ds_write2_b32 v10, v132, v133 offset0:1 offset1:129
    ds_write2_b32 v10, v136, v137 offset0:2 offset1:130
    ds_write2_b32 v10, v140, v141 offset0:3 offset1:131
    ds_write2_b32 v10, v144, v145 offset0:4 offset1:132
    ds_write2_b32 v10, v148, v149 offset0:5 offset1:133
    ds_write2_b32 v10, v152, v153 offset0:6 offset1:134
    ds_write2_b32 v10, v156, v157 offset0:7 offset1:135
    s_mov_b64 exec, -1
    s_waitcnt lgkmcnt(0)
    s_barrier
    s_cmp_lg_u32 s3, 7
    s_cbranch_scc1 .opub_236
    ds_read_b128 v[196:199], v9 offset:0
    ds_read_b128 v[200:203], v9 offset:1024
    ds_read_b128 v[204:207], v9 offset:2048
    ds_read_b128 v[208:211], v9 offset:3072
    ds_read_b128 v[212:215], v9 offset:4096
    ds_read_b128 v[216:219], v9 offset:5120
    ds_read_b128 v[220:223], v9 offset:6144
    ds_read_b128 v[224:227], v9 offset:7168
    s_waitcnt lgkmcnt(6)
    v_pk_add_f32 v[196:197], v[196:197], v[200:201]
    v_pk_add_f32 v[198:199], v[198:199], v[202:203]
    s_waitcnt lgkmcnt(4)
    v_pk_add_f32 v[204:205], v[204:205], v[208:209]
    v_pk_add_f32 v[206:207], v[206:207], v[210:211]
    v_pk_add_f32 v[196:197], v[196:197], v[204:205]
    v_pk_add_f32 v[198:199], v[198:199], v[206:207]
    s_waitcnt lgkmcnt(2)
    v_pk_add_f32 v[212:213], v[212:213], v[216:217]
    v_pk_add_f32 v[214:215], v[214:215], v[218:219]
    s_waitcnt lgkmcnt(0)
    v_pk_add_f32 v[220:221], v[220:221], v[224:225]
    v_pk_add_f32 v[222:223], v[222:223], v[226:227]
    v_pk_add_f32 v[212:213], v[212:213], v[220:221]
    v_pk_add_f32 v[214:215], v[214:215], v[222:223]
    v_pk_add_f32 v[196:197], v[196:197], v[212:213]
    v_pk_add_f32 v[198:199], v[198:199], v[214:215]
    v_perm_b32 v12, v196, v199, s60
    v_perm_b32 v13, v197, v199, s61
    v_perm_b32 v14, v198, v199, s62
    s_add_u32 s57, s56, 0xac000
    buffer_store_dwordx4 v[12:15], v11, s[36:39], s57 offen
    buffer_store_dwordx4 v[12:15], v11, s[36:39], s56 offen sc1
.opub_236:
.Lexit:
.Lend:
s_endpgm
.section .rodata,"a"
.p2align 6
.amdhsa_kernel adaLN_cond__sliding_block_cached__moe_arch_mod__decode_kernel
  .amdhsa_next_free_vgpr 256
  .amdhsa_next_free_sgpr 102
  .amdhsa_accum_offset 256
  .amdhsa_group_segment_fixed_size 0
  .amdhsa_kernarg_size 120
  .amdhsa_user_sgpr_count 2
  .amdhsa_user_sgpr_kernarg_segment_ptr 1
  .amdhsa_system_sgpr_workgroup_id_x 1
.end_amdhsa_kernel
```

```asm
; @launch grid=(256,1,1) block=(512,1,1) lds=159360
.amdgcn_target "amdgcn-amd-amdhsa--gfx950"
.text
.globl adaLN_cond__sliding_block_cached__moe_arch_mod__decode_kernel
.p2align 8
.type adaLN_cond__sliding_block_cached__moe_arch_mod__decode_kernel,@function
adaLN_cond__sliding_block_cached__moe_arch_mod__decode_kernel:
    s_cmp_ge_u32 s2, 256
    s_cbranch_scc1 .Lend
    s_load_dwordx16 s[4:19], s[0:1], 0
    s_load_dwordx8 s[20:27], s[0:1], 64
    s_load_dwordx4 s[28:31], s[0:1], 96
    s_load_dwordx2 s[32:33], s[0:1], 112
    s_memrealtime s[70:71]
    v_lshrrev_b32 v1, 6, v0
    v_and_b32 v0, 63, v0
    v_readfirstlane_b32 s3, v1
    s_mov_b32 s35, 0x3ffff
    s_mov_b32 s98, 0xbfb8aa3b
    s_mov_b32 s94, 0x05040100
    s_mov_b32 s95, 0x07060302
    s_mov_b32 s96, 0xaaaaaaaa
    s_mov_b32 s97, 0xaaaaaaaa
    s_and_b32 s64, s2, 7
    s_lshr_b32 s65, s2, 3
    s_and_b32 s66, s65, 7
    s_lshr_b32 s67, s2, 7
    s_lshl1_add_u32 s67, s64, s67
    s_bfe_u32 s68, s2, 0x10006
    s_lshl4_add_u32 s69, s66, s67
    s_lshl_b32 s69, s69, 21
    s_lshl_b32 s56, s68, 16
    s_add_u32 s69, s69, s56
    s_lshl_b32 s56, s3, 10
    s_add_u32 s69, s69, s56
    s_add_u32 s69, s69, 0x180000
    v_bfe_u32 v1, v0, 2, 2
    v_lshrrev_b32 v2, 4, v0
    v_lshl_add_u32 v1, v1, 2, v2
    v_and_b32 v2, 3, v0
    v_lshl_add_u32 v1, v1, 2, v2
    v_lshlrev_b32 v1, 4, v1
    v_lshlrev_b32 v2, 4, v0
    v_lshlrev_b32 v3, 3, v0
    v_and_b32 v4, 31, v0
    v_lshlrev_b32 v4, 2, v4
    v_add_u32 v4, 1024, v4
    v_lshlrev_b32 v5, 1, v4
    s_waitcnt lgkmcnt(0)
    s_load_dword s34, s[32:33], 0
    s_sub_u32 s99, s2, 216
    s_cmp_ge_u32 s99, 18
    s_cbranch_scc1 .Lmcf_no
    s_mul_i32 s58, s3, 1152
    s_mov_b32 s52, s24
    s_and_b32 s53, s25, 0xffff
    s_mov_b32 s54, 0x2400
    s_mov_b32 s55, 0x00020000
    buffer_load_dwordx2 v[246:247], v3, s[52:55], s58 offen
    buffer_load_dwordx2 v[248:249], v3, s[52:55], s58 offen offset:512
    buffer_load_dword v250, v4, s[52:55], s58 offen
    s_mov_b32 s48, s26
    s_and_b32 s49, s27, 0xffff
    s_mov_b32 s50, 0x3cc000
    s_mov_b32 s51, 0x00020000
    v_bfe_u32 v12, v0, 4, 1
    s_and_b32 s56, s3, 3
    s_lshl_b32 s56, s56, 1
    v_or_b32 v12, s56, v12
    v_and_b32 v19, 7, v0
    v_xor_b32 v12, v12, v19
    v_lshrrev_b32 v19, 3, v0
    v_mul_u32_u24 v19, 6912, v19
    v_lshl_add_u32 v19, v12, 4, v19
    s_mul_i32 s57, s3, 55296
    s_lshl_b32 s59, s99, 7
    s_add_u32 s57, s57, s59
    s_lshl_b32 s100, s3, 10
    s_add_u32 m0, s100, 0
    s_add_u32 s56, s57, 0
    buffer_load_dwordx4 v19, s[48:51], s56 offen nt lds
    s_add_u32 m0, s100, 8192
    s_add_u32 s56, s57, 442368
    buffer_load_dwordx4 v19, s[48:51], s56 offen nt lds
    s_add_u32 m0, s100, 16384
    s_add_u32 s56, s57, 884736
    buffer_load_dwordx4 v19, s[48:51], s56 offen nt lds
    s_add_u32 m0, s100, 24576
    s_add_u32 s56, s57, 1327104
    buffer_load_dwordx4 v19, s[48:51], s56 offen nt lds
    s_add_u32 m0, s100, 32768
    s_add_u32 s56, s57, 1769472
    buffer_load_dwordx4 v19, s[48:51], s56 offen nt lds
    s_add_u32 m0, s100, 40960
    s_add_u32 s56, s57, 2211840
    buffer_load_dwordx4 v19, s[48:51], s56 offen nt lds
    s_add_u32 m0, s100, 49152
    s_add_u32 s56, s57, 2654208
    buffer_load_dwordx4 v19, s[48:51], s56 offen nt lds
    s_add_u32 m0, s100, 57344
    s_add_u32 s56, s57, 3096576
    buffer_load_dwordx4 v19, s[48:51], s56 offen nt lds
    s_add_u32 m0, s100, 65536
    s_add_u32 s56, s57, 3538944
    buffer_load_dwordx4 v19, s[48:51], s56 offen nt lds
.Lmcf_no:
    s_mov_b32 s40, s6
    s_and_b32 s41, s7, 0xffff
    s_mov_b32 s42, 0x10000000
    s_mov_b32 s43, 0x00020000
    s_add_u32 s63, s69, 0
    buffer_load_dwordx4 v[32:35], v1, s[40:43], s63 offen nt
    s_add_u32 s63, s69, 8192
    buffer_load_dwordx4 v[36:39], v1, s[40:43], s63 offen nt
    s_add_u32 s63, s69, 16384
    buffer_load_dwordx4 v[64:67], v1, s[40:43], s63 offen nt
    s_add_u32 s63, s69, 24576
    buffer_load_dwordx4 v[68:71], v1, s[40:43], s63 offen nt
    s_mov_b32 s44, s8
    s_and_b32 s45, s9, 0xffff
    s_mov_b32 s46, 0x10000000
    s_mov_b32 s47, 0x00020000
    s_mov_b32 s36, s32
    s_and_b32 s37, s33, 0xffff
    s_mov_b32 s38, 0x40000000
    s_mov_b32 s39, 0x00020000
    s_lshl3_add_u32 s56, s3, s2
    s_cmp_lt_u32 s56, 8
    s_cbranch_scc0 .Let_no
    s_lshl_b32 s56, s2, 7
    s_add_u32 s56, s56, 0x400
    v_mov_b32 v7, s70
    s_mov_b64 exec, 1
    buffer_store_dword v7, v2, s[36:39], s56 offen sc1
    s_mov_b64 exec, -1
.Let_no:
    s_mov_b32 s52, s30
    s_and_b32 s53, s31, 0xffff
    s_mov_b32 s54, 0x100
    s_mov_b32 s55, 0x00020000
    s_mov_b64 s[6:7], s[30:31]
    s_getreg_b32 s1, hwreg(HW_REG_XCC_ID)
    s_and_b32 s1, s1, 7
    s_lshl_b32 s1, s1, 3
    s_lshl_b32 s0, s64, 5
    s_cmp_lg_u32 s3, 0
    s_cbranch_scc1 .Lxa_no
    s_lshl_b64 s[56:57], 1, s1
    v_mov_b32 v8, s56
    v_mov_b32 v9, s57
    s_mov_b64 exec, 1
    buffer_atomic_add_x2 v[8:9], v2, s[52:55], s0 offen sc1
    v_mov_b32 v8, 0
    v_mov_b32 v9, 159232
    ds_write_b32 v9, v8
    s_waitcnt lgkmcnt(0)
    s_mov_b64 exec, -1
.Lxa_no:
    s_barrier
    s_cmp_lt_u32 s3, 4
    s_cbranch_scc1 1
    s_setprio 1
.Lresume:
    s_cmp_lt_u32 s65, 9
    s_cbranch_scc1 .Le_a
    s_sub_u32 s56, 3, s64
    s_and_b32 s56, s56, 7
    s_lshl1_add_u32 s56, s56, 9
    s_sub_u32 s56, s65, s56
    s_cselect_b32 s57, 18, 0
    s_add_u32 s56, s56, s57
    s_sub_u32 s101, s56, 2
    s_cmp_ge_u32 s56, 5
    s_addc_u32 s101, s101, 0
    s_sub_u32 s99, s56, 5
    s_min_u32 s99, s99, 7
    s_cmp_lt_u32 s65, 27
    s_cbranch_scc1 .Lrole_bc
    s_mov_b32 s101, 3
    s_sub_u32 s99, s65, 27
    s_cmp_ge_u32 s65, 31
    s_cselect_b32 s56, 2, 9
.Lrole_bc:
    s_lshl3_add_u32 s99, s99, s64
    s_sub_u32 s56, s56, 2
    s_cmp_lt_u32 s56, 7
    s_cbranch_scc1 .Le_q
    s_cmp_lt_u32 s99, 18
    s_cbranch_scc1 .Le_mc
    s_cmp_lt_u32 s99, 54
    s_mov_b32 s14, 0xfdff7fdf
    s_cselect_b32 s14, 0x6b5ad6b5, s14
    s_mov_b32 s15, 0xff7fdff7
    s_cselect_b32 s15, 0x5ad6b5ad, s15
    s_cselect_b32 s30, -30, 0
    s_add_u32 s30, s30, 0
    s_add_u32 s30, s30, s70
    s_sub_u32 s56, s65, 9
    s_lshr_b32 s56, s56, 1
    s_add_u32 s56, s56, s64
    s_and_b32 s56, s56, 7
    s_cmp_eq_u32 s56, 3
    s_cselect_b32 s56, -30, 0
    s_cmp_lt_u32 s99, 54
    s_cselect_b32 s56, 0, s56
    s_add_u32 s30, s30, s56
    s_waitcnt vmcnt(3)
    s_bitcmp1_b64 s[14:15], 4
    s_cbranch_scc0 1
    s_waitcnt vmcnt(2)
    s_add_u32 s63, s69, 32768
    buffer_load_dwordx4 v[96:99], v1, s[40:43], s63 offen nt
    s_memrealtime s[8:9]
    s_waitcnt lgkmcnt(0)
    s_sub_u32 s8, s8, s30
    s_cmpk_ge_u32 s8, 290
    s_cbranch_scc1 .ap_1
    s_waitcnt vmcnt(4)
    s_cmpk_ge_u32 s8, 225
    s_cbranch_scc1 .ap_1
    s_waitcnt vmcnt(3)
    s_bitcmp1_b64 s[14:15], 5
    s_cbranch_scc0 1
    s_waitcnt vmcnt(2)
    s_cmpk_ge_u32 s8, 150
    s_cbranch_scc1 .ap_1
    s_waitcnt vmcnt(1)
.ap_1:
    s_add_u32 s63, s69, 40960
    buffer_load_dwordx4 v[100:103], v1, s[40:43], s63 offen nt
    s_memrealtime s[8:9]
    s_waitcnt lgkmcnt(0)
    s_sub_u32 s8, s8, s30
    s_cmpk_ge_u32 s8, 315
    s_cbranch_scc1 .ap_2
    s_waitcnt vmcnt(5)
    s_cmpk_ge_u32 s8, 250
    s_cbranch_scc1 .ap_2
    s_waitcnt vmcnt(3)
    s_bitcmp1_b64 s[14:15], 6
    s_cbranch_scc0 1
    s_waitcnt vmcnt(2)
    s_cmpk_ge_u32 s8, 175
    s_cbranch_scc1 .ap_2
    s_waitcnt vmcnt(1)
.ap_2:
    s_add_u32 s63, s69, 49152
    buffer_load_dwordx4 v[128:131], v1, s[40:43], s63 offen nt
    s_memrealtime s[8:9]
    s_waitcnt lgkmcnt(0)
    s_sub_u32 s8, s8, s30
    s_cmpk_ge_u32 s8, 340
    s_cbranch_scc1 .ap_3
    s_waitcnt vmcnt(5)
    s_cmpk_ge_u32 s8, 275
    s_cbranch_scc1 .ap_3
    s_waitcnt vmcnt(3)
    s_bitcmp1_b64 s[14:15], 7
    s_cbranch_scc0 1
    s_waitcnt vmcnt(2)
    s_cmpk_ge_u32 s8, 200
    s_cbranch_scc1 .ap_3
    s_waitcnt vmcnt(1)
.ap_3:
    s_add_u32 s63, s69, 57344
    buffer_load_dwordx4 v[132:135], v1, s[40:43], s63 offen nt
    s_memrealtime s[8:9]
    s_waitcnt lgkmcnt(0)
    s_sub_u32 s8, s8, s30
    s_cmpk_ge_u32 s8, 365
    s_cbranch_scc1 .ap_4
    s_waitcnt vmcnt(5)
    s_cmpk_ge_u32 s8, 300
    s_cbranch_scc1 .ap_4
    s_waitcnt vmcnt(3)
    s_bitcmp1_b64 s[14:15], 8
    s_cbranch_scc0 1
    s_waitcnt vmcnt(2)
    s_cmpk_ge_u32 s8, 225
    s_cbranch_scc1 .ap_4
    s_waitcnt vmcnt(1)
.ap_4:
    s_add_u32 s63, s69, 131072
    buffer_load_dwordx4 v[40:43], v1, s[40:43], s63 offen nt
    s_memrealtime s[8:9]
    s_waitcnt lgkmcnt(0)
    s_sub_u32 s8, s8, s30
    s_cmpk_ge_u32 s8, 390
    s_cbranch_scc1 .ap_5
    s_waitcnt vmcnt(5)
    s_cmpk_ge_u32 s8, 325
    s_cbranch_scc1 .ap_5
    s_waitcnt vmcnt(3)
    s_bitcmp1_b64 s[14:15], 9
    s_cbranch_scc0 1
    s_waitcnt vmcnt(2)
    s_cmpk_ge_u32 s8, 250
    s_cbranch_scc1 .ap_5
    s_waitcnt vmcnt(1)
.ap_5:
    s_add_u32 s63, s69, 139264
    buffer_load_dwordx4 v[44:47], v1, s[40:43], s63 offen nt
    s_waitcnt lgkmcnt(0)
    s_add_u32 s34, s34, 1
    s_cmp_lt_u32 s99, 54
    s_cbranch_scc1 .Le_mr
    s_sub_u32 s57, s65, 9
    s_bitcmp1_b32 s57, 0
    s_cselect_b32 s48, s20, s18
    s_cselect_b32 s49, s21, s19
    s_cselect_b32 s33, 36, 0
    s_and_b32 s49, s49, 0xffff
    s_mov_b32 s50, 0x510000
    s_mov_b32 s51, 0x00020000
    s_mov_b32 s52, s22
    s_and_b32 s53, s23, 0xffff
    s_mov_b32 s54, 0x510000
    s_mov_b32 s55, 0x00020000
    s_lshr_b32 s57, s57, 1
    s_lshl_b32 s57, s57, 7
    s_mul_i32 s101, s64, 1152
    s_add_u32 s101, s101, s57
    s_mul_i32 s56, s3, 73728
    s_add_u32 s101, s101, s56
    s_mul_i32 s56, s64, 72
    s_add_u32 s33, s33, s56
    s_add_u32 s33, s33, s3
    s_mul_i32 s33, s33, 9216
    s_add_u32 s33, s33, s57
    s_bfe_u32 s56, s101, 0x30007
    s_cmp_eq_u32 s56, 3
    s_cselect_b32 s100, 1, 0
    v_bfe_u32 v12, v0, 4, 1
    s_and_b32 s56, s3, 3
    s_lshl_b32 s56, s56, 1
    v_or_b32 v12, s56, v12
    v_and_b32 v6, 7, v0
    v_xor_b32 v12, v12, v6
    v_lshrrev_b32 v6, 3, v0
    v_mul_u32_u24 v6, 9216, v6
    v_lshl_add_u32 v6, v12, 4, v6
    v_bfe_u32 v12, v0, 4, 1
    s_and_b32 s56, s3, 1
    s_lshl_b32 s56, s56, 2
    v_lshl_or_b32 v12, v12, 1, s56
    v_and_b32 v13, 7, v0
    v_xor_b32 v12, v12, v13
    v_lshrrev_b32 v13, 3, v0
    v_mul_u32_u24 v13, 1152, v13
    v_lshl_add_u32 v31, v12, 4, v13
    s_lshl_b32 s32, s3, 10
    s_memrealtime s[8:9]
    s_waitcnt vmcnt(8)
    s_waitcnt lgkmcnt(0)
    s_sub_u32 s8, s8, s30
    s_cmpk_ge_u32 s8, 436
    s_cbranch_scc1 .ap_6
    s_waitcnt vmcnt(5)
    s_cmpk_ge_u32 s8, 371
    s_cbranch_scc1 .ap_6
    s_waitcnt vmcnt(3)
    s_bitcmp1_b64 s[14:15], 10
    s_cbranch_scc0 1
    s_waitcnt vmcnt(2)
    s_cmpk_ge_u32 s8, 296
    s_cbranch_scc1 .ap_6
    s_waitcnt vmcnt(1)
.ap_6:
    s_add_u32 s63, s69, 147456
    buffer_load_dwordx4 v[72:75], v1, s[40:43], s63 offen nt
    s_cmp_eq_u32 s100, 0
    s_cbranch_scc1 .ls_7
    s_add_u32 m0, s32, 0
    s_add_u32 s56, s101, 0
    buffer_load_dwordx4 v6, s[48:51], s56 offen nt lds
.ls_7:
    s_memrealtime s[8:9]
    s_waitcnt vmcnt(8)
    s_waitcnt lgkmcnt(0)
    s_sub_u32 s8, s8, s30
    s_cmpk_ge_u32 s8, 482
    s_cbranch_scc1 .ap_8
    s_waitcnt vmcnt(5)
    s_cmpk_ge_u32 s8, 417
    s_cbranch_scc1 .ap_8
    s_waitcnt vmcnt(3)
    s_bitcmp1_b64 s[14:15], 11
    s_cbranch_scc0 1
    s_waitcnt vmcnt(2)
    s_cmpk_ge_u32 s8, 342
    s_cbranch_scc1 .ap_8
    s_waitcnt vmcnt(1)
.ap_8:
    s_add_u32 s63, s69, 155648
    buffer_load_dwordx4 v[76:79], v1, s[40:43], s63 offen nt
    s_memrealtime s[8:9]
    s_waitcnt vmcnt(8)
    s_waitcnt lgkmcnt(0)
    s_sub_u32 s8, s8, s30
    s_cmpk_ge_u32 s8, 528
    s_cbranch_scc1 .ap_9
    s_waitcnt vmcnt(5)
    s_cmpk_ge_u32 s8, 463
    s_cbranch_scc1 .ap_9
    s_waitcnt vmcnt(3)
    s_bitcmp1_b64 s[14:15], 12
    s_cbranch_scc0 1
    s_waitcnt vmcnt(2)
    s_cmpk_ge_u32 s8, 388
    s_cbranch_scc1 .ap_9
    s_waitcnt vmcnt(1)
.ap_9:
    s_add_u32 s63, s69, 163840
    buffer_load_dwordx4 v[104:107], v1, s[40:43], s63 offen nt
    s_memrealtime s[8:9]
    s_waitcnt vmcnt(8)
    s_waitcnt lgkmcnt(0)
    s_sub_u32 s8, s8, s30
    s_cmpk_ge_u32 s8, 574
    s_cbranch_scc1 .ap_10
    s_waitcnt vmcnt(5)
    s_cmpk_ge_u32 s8, 509
    s_cbranch_scc1 .ap_10
    s_waitcnt vmcnt(3)
    s_bitcmp1_b64 s[14:15], 13
    s_cbranch_scc0 1
    s_waitcnt vmcnt(2)
    s_cmpk_ge_u32 s8, 434
    s_cbranch_scc1 .ap_10
    s_waitcnt vmcnt(1)
.ap_10:
    s_add_u32 s63, s69, 172032
    buffer_load_dwordx4 v[108:111], v1, s[40:43], s63 offen nt
    s_cmp_eq_u32 s100, 0
    s_cbranch_scc1 .ls_11
    s_add_u32 m0, s32, 8192
    s_add_u32 s56, s101, 589824
    buffer_load_dwordx4 v6, s[48:51], s56 offen nt lds
.ls_11:
    s_memrealtime s[8:9]
    s_waitcnt vmcnt(8)
    s_waitcnt lgkmcnt(0)
    s_sub_u32 s8, s8, s30
    s_cmpk_ge_u32 s8, 620
    s_cbranch_scc1 .ap_12
    s_waitcnt vmcnt(5)
    s_cmpk_ge_u32 s8, 555
    s_cbranch_scc1 .ap_12
    s_waitcnt vmcnt(3)
    s_bitcmp1_b64 s[14:15], 14
    s_cbranch_scc0 1
    s_waitcnt vmcnt(2)
    s_cmpk_ge_u32 s8, 480
    s_cbranch_scc1 .ap_12
    s_waitcnt vmcnt(1)
.ap_12:
    s_add_u32 s63, s69, 180224
    buffer_load_dwordx4 v[136:139], v1, s[40:43], s63 offen nt
    s_memrealtime s[8:9]
    s_waitcnt vmcnt(8)
    s_waitcnt lgkmcnt(0)
    s_sub_u32 s8, s8, s30
    s_cmpk_ge_u32 s8, 666
    s_cbranch_scc1 .ap_13
    s_waitcnt vmcnt(5)
    s_cmpk_ge_u32 s8, 601
    s_cbranch_scc1 .ap_13
    s_waitcnt vmcnt(3)
    s_bitcmp1_b64 s[14:15], 15
    s_cbranch_scc0 1
    s_waitcnt vmcnt(2)
    s_cmpk_ge_u32 s8, 526
    s_cbranch_scc1 .ap_13
    s_waitcnt vmcnt(1)
.ap_13:
    s_add_u32 s63, s69, 188416
    buffer_load_dwordx4 v[140:143], v1, s[40:43], s63 offen nt
    s_memrealtime s[8:9]
    s_waitcnt vmcnt(8)
    s_waitcnt lgkmcnt(0)
    s_sub_u32 s8, s8, s30
    s_cmpk_ge_u32 s8, 712
    s_cbranch_scc1 .ap_14
    s_waitcnt vmcnt(5)
    s_cmpk_ge_u32 s8, 647
    s_cbranch_scc1 .ap_14
    s_waitcnt vmcnt(3)
    s_bitcmp1_b64 s[14:15], 16
    s_cbranch_scc0 1
    s_waitcnt vmcnt(2)
    s_cmpk_ge_u32 s8, 572
    s_cbranch_scc1 .ap_14
    s_waitcnt vmcnt(1)
.ap_14:
    s_add_u32 s63, s69, 262144
    buffer_load_dwordx4 v[48:51], v1, s[40:43], s63 offen nt
    s_cmp_eq_u32 s100, 0
    s_cbranch_scc1 .ls_15
    s_add_u32 m0, s32, 16384
    s_add_u32 s56, s101, 1179648
    buffer_load_dwordx4 v6, s[48:51], s56 offen nt lds
.ls_15:
    s_memrealtime s[8:9]
    s_waitcnt vmcnt(8)
    s_waitcnt lgkmcnt(0)
    s_sub_u32 s8, s8, s30
    s_cmpk_ge_u32 s8, 758
    s_cbranch_scc1 .ap_16
    s_waitcnt vmcnt(5)
    s_cmpk_ge_u32 s8, 693
    s_cbranch_scc1 .ap_16
    s_waitcnt vmcnt(3)
    s_bitcmp1_b64 s[14:15], 17
    s_cbranch_scc0 1
    s_waitcnt vmcnt(2)
    s_cmpk_ge_u32 s8, 618
    s_cbranch_scc1 .ap_16
    s_waitcnt vmcnt(1)
.ap_16:
    s_add_u32 s63, s69, 270336
    buffer_load_dwordx4 v[52:55], v1, s[40:43], s63 offen nt
    s_memrealtime s[8:9]
    s_waitcnt vmcnt(8)
    s_waitcnt lgkmcnt(0)
    s_sub_u32 s8, s8, s30
    s_cmpk_ge_u32 s8, 804
    s_cbranch_scc1 .ap_17
    s_waitcnt vmcnt(5)
    s_cmpk_ge_u32 s8, 739
    s_cbranch_scc1 .ap_17
    s_waitcnt vmcnt(3)
    s_bitcmp1_b64 s[14:15], 18
    s_cbranch_scc0 1
    s_waitcnt vmcnt(2)
    s_cmpk_ge_u32 s8, 664
    s_cbranch_scc1 .ap_17
    s_waitcnt vmcnt(1)
.ap_17:
    s_add_u32 s63, s69, 278528
    buffer_load_dwordx4 v[80:83], v1, s[40:43], s63 offen nt
    v_and_b32 v157, 7, v0
    v_lshlrev_b32 v157, 7, v157
    s_mov_b32 s63, 0x400
    buffer_load_dword v156, v157, s[36:39], s63 offen
    s_memrealtime s[8:9]
    s_waitcnt vmcnt(9)
    s_waitcnt lgkmcnt(0)
    s_sub_u32 s8, s8, s30
    s_cmpk_ge_u32 s8, 850
    s_cbranch_scc1 .ap_18
    s_waitcnt vmcnt(6)
    s_cmpk_ge_u32 s8, 785
    s_cbranch_scc1 .ap_18
    s_waitcnt vmcnt(4)
    s_bitcmp1_b64 s[14:15], 19
    s_cbranch_scc0 1
    s_waitcnt vmcnt(3)
    s_cmpk_ge_u32 s8, 710
    s_cbranch_scc1 .ap_18
    s_waitcnt vmcnt(2)
.ap_18:
    s_add_u32 s63, s69, 286720
    buffer_load_dwordx4 v[84:87], v1, s[40:43], s63 offen nt
    s_cmp_eq_u32 s100, 0
    s_cbranch_scc1 .ls_19
    s_add_u32 m0, s32, 24576
    s_add_u32 s56, s101, 1769472
    buffer_load_dwordx4 v6, s[48:51], s56 offen nt lds
.ls_19:
    s_memrealtime s[8:9]
    s_waitcnt vmcnt(9)
    s_waitcnt lgkmcnt(0)
    s_sub_u32 s8, s8, s30
    s_cmpk_ge_u32 s8, 895
    s_cbranch_scc1 .ap_20
    s_waitcnt vmcnt(6)
    s_cmpk_ge_u32 s8, 830
    s_cbranch_scc1 .ap_20
    s_waitcnt vmcnt(4)
    s_bitcmp1_b64 s[14:15], 20
    s_cbranch_scc0 1
    s_waitcnt vmcnt(3)
    s_cmpk_ge_u32 s8, 755
    s_cbranch_scc1 .ap_20
    s_waitcnt vmcnt(2)
.ap_20:
    s_add_u32 s63, s69, 294912
    buffer_load_dwordx4 v[112:115], v1, s[40:43], s63 offen nt
    s_memrealtime s[8:9]
    s_waitcnt vmcnt(9)
    s_waitcnt lgkmcnt(0)
    s_sub_u32 s8, s8, s30
    s_cmpk_ge_u32 s8, 940
    s_cbranch_scc1 .ap_21
    s_waitcnt vmcnt(6)
    s_cmpk_ge_u32 s8, 875
    s_cbranch_scc1 .ap_21
    s_waitcnt vmcnt(4)
    s_bitcmp1_b64 s[14:15], 21
    s_cbranch_scc0 1
    s_waitcnt vmcnt(3)
    s_cmpk_ge_u32 s8, 800
    s_cbranch_scc1 .ap_21
    s_waitcnt vmcnt(1)
.ap_21:
    s_add_u32 s63, s69, 303104
    buffer_load_dwordx4 v[116:119], v1, s[40:43], s63 offen nt
    s_memrealtime s[8:9]
    s_waitcnt vmcnt(9)
    s_waitcnt lgkmcnt(0)
    s_sub_u32 s8, s8, s30
    s_cmpk_ge_u32 s8, 985
    s_cbranch_scc1 .ap_22
    s_waitcnt vmcnt(6)
    s_cmpk_ge_u32 s8, 920
    s_cbranch_scc1 .ap_22
    s_waitcnt vmcnt(4)
    s_bitcmp1_b64 s[14:15], 22
    s_cbranch_scc0 1
    s_waitcnt vmcnt(2)
    s_cmpk_ge_u32 s8, 845
    s_cbranch_scc1 .ap_22
    s_waitcnt vmcnt(1)
.ap_22:
    s_add_u32 s63, s69, 311296
    buffer_load_dwordx4 v[144:147], v1, s[40:43], s63 offen nt
    s_waitcnt vmcnt(4)
    s_sub_u32 s63, s70, 300
    v_subrev_u32 v156, s63, v156
    v_mov_b32 v157, 600
    v_cmp_lt_u32 s[8:9], v156, v157
    v_add_u32_dpp v156, v156, v156 quad_perm:[1,0,3,2] row_mask:0xf bank_mask:0xf
    s_nop 1
    v_add_u32_dpp v156, v156, v156 quad_perm:[2,3,0,1] row_mask:0xf bank_mask:0xf
    s_nop 1
    v_add_u32_dpp v156, v156, v156 row_ror:4 row_mask:0xf bank_mask:0xf
    s_nop 0
    v_readfirstlane_b32 s63, v156
    s_cmp_eq_u64 s[8:9], -1
    s_nop 3
    s_cbranch_scc0 .et_23
    s_lshr_b32 s63, s63, 3
    s_sub_u32 s63, s63, 300
    s_add_u32 s30, s30, s63
.et_23:
    s_cmp_eq_u32 s100, 0
    s_cbranch_scc1 .ls_24
    s_add_u32 m0, s32, 32768
    s_add_u32 s56, s101, 2359296
    buffer_load_dwordx4 v6, s[48:51], s56 offen nt lds
.ls_24:
    s_memrealtime s[8:9]
    s_waitcnt lgkmcnt(0)
    s_sub_u32 s8, s8, s30
    s_cmpk_ge_u32 s8, 1030
    s_cbranch_scc1 .ap_25
    s_waitcnt vmcnt(4)
    s_cmpk_ge_u32 s8, 965
    s_cbranch_scc1 .ap_25
    s_waitcnt vmcnt(3)
    s_bitcmp1_b64 s[14:15], 23
    s_cbranch_scc0 1
    s_waitcnt vmcnt(2)
    s_cmpk_ge_u32 s8, 890
    s_cbranch_scc1 .ap_25
    s_waitcnt vmcnt(1)
.ap_25:
    s_add_u32 s63, s69, 319488
    buffer_load_dwordx4 v[148:151], v1, s[40:43], s63 offen nt
    s_memrealtime s[8:9]
    s_waitcnt lgkmcnt(0)
    s_sub_u32 s8, s8, s30
    s_cmpk_ge_u32 s8, 1075
    s_cbranch_scc1 .ap_26
    s_waitcnt vmcnt(5)
    s_cmpk_ge_u32 s8, 1010
    s_cbranch_scc1 .ap_26
    s_waitcnt vmcnt(3)
    s_bitcmp1_b64 s[14:15], 24
    s_cbranch_scc0 1
    s_waitcnt vmcnt(2)
    s_cmpk_ge_u32 s8, 935
    s_cbranch_scc1 .ap_26
    s_waitcnt vmcnt(1)
.ap_26:
    s_add_u32 s63, s69, 393216
    buffer_load_dwordx4 v[56:59], v1, s[40:43], s63 offen nt
    s_memrealtime s[8:9]
    s_waitcnt lgkmcnt(0)
    s_sub_u32 s8, s8, s30
    s_cmpk_ge_u32 s8, 1120
    s_cbranch_scc1 .ap_27
    s_waitcnt vmcnt(5)
    s_cmpk_ge_u32 s8, 1055
    s_cbranch_scc1 .ap_27
    s_waitcnt vmcnt(3)
    s_bitcmp1_b64 s[14:15], 25
    s_cbranch_scc0 1
    s_waitcnt vmcnt(2)
    s_cmpk_ge_u32 s8, 980
    s_cbranch_scc1 .ap_27
    s_waitcnt vmcnt(1)
.ap_27:
    s_add_u32 s63, s69, 401408
    buffer_load_dwordx4 v[60:63], v1, s[40:43], s63 offen nt
    s_branch .Latt_bc
.Le_mr:
    s_mul_i32 s58, s3, 1152
    s_mov_b32 s52, s24
    s_and_b32 s53, s25, 0xffff
    s_mov_b32 s54, 0x2400
    s_mov_b32 s55, 0x00020000
    buffer_load_dwordx2 v[246:247], v3, s[52:55], s58 offen
    buffer_load_dwordx2 v[248:249], v3, s[52:55], s58 offen offset:512
    buffer_load_dword v250, v4, s[52:55], s58 offen
    s_mov_b32 s48, s26
    s_and_b32 s49, s27, 0xffff
    s_mov_b32 s50, 0x3cc000
    s_mov_b32 s51, 0x00020000
    v_bfe_u32 v12, v0, 4, 1
    s_and_b32 s56, s3, 3
    s_lshl_b32 s56, s56, 1
    v_or_b32 v12, s56, v12
    v_and_b32 v19, 7, v0
    v_xor_b32 v12, v12, v19
    v_lshrrev_b32 v19, 3, v0
    v_mul_u32_u24 v19, 6912, v19
    v_lshl_add_u32 v19, v12, 4, v19
    s_mul_i32 s57, s3, 55296
    s_lshl_b32 s59, s99, 7
    s_add_u32 s57, s57, s59
    s_lshl_b32 s100, s3, 10
    s_add_u32 m0, s100, 0
    s_add_u32 s56, s57, 0
    buffer_load_dwordx4 v19, s[48:51], s56 offen nt lds
    s_add_u32 m0, s100, 8192
    s_add_u32 s56, s57, 442368
    buffer_load_dwordx4 v19, s[48:51], s56 offen nt lds
    s_add_u32 m0, s100, 16384
    s_add_u32 s56, s57, 884736
    buffer_load_dwordx4 v19, s[48:51], s56 offen nt lds
    s_add_u32 m0, s100, 24576
    s_add_u32 s56, s57, 1327104
    buffer_load_dwordx4 v19, s[48:51], s56 offen nt lds
    s_add_u32 m0, s100, 32768
    s_add_u32 s56, s57, 1769472
    buffer_load_dwordx4 v19, s[48:51], s56 offen nt lds
    s_add_u32 m0, s100, 40960
    s_add_u32 s56, s57, 2211840
    buffer_load_dwordx4 v19, s[48:51], s56 offen nt lds
    s_add_u32 m0, s100, 49152
    s_add_u32 s56, s57, 2654208
    buffer_load_dwordx4 v19, s[48:51], s56 offen nt lds
    s_add_u32 m0, s100, 57344
    s_add_u32 s56, s57, 3096576
    buffer_load_dwordx4 v19, s[48:51], s56 offen nt lds
    s_add_u32 m0, s100, 65536
    s_add_u32 s56, s57, 3538944
    buffer_load_dwordx4 v19, s[48:51], s56 offen nt lds
    v_bfe_u32 v16, v0, 1, 3
    v_mul_u32_u24 v16, 1312, v16
    v_lshrrev_b32 v12, 4, v0
    v_lshl_add_u32 v16, v12, 5, v16
    v_and_b32 v12, 1, v0
    v_lshl_add_u32 v16, v12, 4, v16
    v_add_u32 v16, 147456, v16
    s_mul_i32 s56, s3, 1312
    s_add_u32 s56, s56, 147456
    v_add_u32 v17, s56, v3
    v_add_u32 v18, s56, v4
    v_lshrrev_b32 v12, 4, v0
    v_bfe_u32 v13, v0, 1, 1
    v_lshl_add_u32 v12, v12, 1, v13
    v_bfe_u32 v13, v0, 2, 2
    v_lshl_add_u32 v20, v12, 3, v13
    v_lshlrev_b32 v20, 7, v20
    v_and_b32 v12, 3, v12
    v_lshrrev_b32 v13, 1, v13
    v_lshl_add_u32 v12, v12, 1, v13
    v_xor_b32 v12, s3, v12
    v_lshl_add_u32 v20, v12, 4, v20
    v_and_b32 v12, 1, v0
    v_lshl_add_u32 v20, v12, 3, v20
    v_bfe_u32 v23, v0, 1, 3
    v_mul_u32_u24 v23, 144, v23
    v_bfe_u32 v12, v0, 4, 1
    v_lshl_add_u32 v23, v12, 3, v23
    v_lshrrev_b32 v12, 5, v0
    v_lshl_add_u32 v23, v12, 2, v23
    v_and_b32 v12, 1, v0
    v_lshl_add_u32 v23, v12, 1, v23
    s_lshl_b32 s56, s3, 4
    s_add_u32 s56, s56, 157952
    v_add_u32 v23, s56, v23
    v_and_b32 v24, 15, v0
    v_lshlrev_b32 v24, 3, v24
    s_mul_i32 s56, s3, 144
    s_add_u32 s56, s56, 157952
    v_add_u32 v24, s56, v24
    v_add_u32 v21, 32768, v20
    s_lshl_b32 s100, s3, 10
    v_lshrrev_b32 v12, 4, v0
    v_mul_u32_u24 v12, 18432, v12
    v_and_b32 v13, 15, v0
    v_lshl_add_u32 v22, v13, 4, v12
    s_mul_i32 s57, s99, 57
    s_lshr_b32 s57, s57, 9
    s_mul_i32 s58, s57, 9
    s_sub_u32 s58, s99, s58
    s_mul_i32 s59, s57, 36864
    s_lshl_b32 s58, s58, 8
    s_add_u32 s59, s59, s58
    s_mul_i32 s58, s3, 2304
    s_add_u32 s59, s59, s58
    s_add_u32 s59, s59, 0x3000
    s_mov_b32 s58, 0
    s_cmp_eq_u32 s57, 1
    s_cselect_b32 s58, 1.0, s58
    s_cmp_eq_u32 s57, 4
    s_cselect_b32 s58, 1.0, s58
    s_waitcnt vmcnt(9)
    v_lshlrev_b32 v236, 16, v246
    v_and_b32 v237, 0xffff0000, v246
    v_max_f32 v236, 0xc2ae0000, v236
    v_min_f32 v242, 0x43000000, v236
    v_mul_f32 v238, 0xbfb8aa3b, v242
    v_fma_f32 v240, v242, s98, -v238
    v_fmac_f32 v240, 0xb2a57060, v242
    v_exp_f32 v238, v238
    v_mul_f32 v240, 0x3f317218, v240
    v_fmac_f32 v238, v238, v240
    v_add_f32 v238, 1.0, v238
    v_rcp_f32 v240, v238
    s_nop 0
    v_mul_f32 v242, v236, v240
    v_fma_f32 v238, -v242, v238, v236
    v_fma_f32 v236, v238, v240, v242
    v_max_f32 v237, 0xc2ae0000, v237
    v_min_f32 v243, 0x43000000, v237
    v_mul_f32 v239, 0xbfb8aa3b, v243
    v_fma_f32 v241, v243, s98, -v239
    v_fmac_f32 v241, 0xb2a57060, v243
    v_exp_f32 v239, v239
    v_mul_f32 v241, 0x3f317218, v241
    v_fmac_f32 v239, v239, v241
    v_add_f32 v239, 1.0, v239
    v_rcp_f32 v241, v239
    s_nop 0
    v_mul_f32 v243, v237, v241
    v_fma_f32 v239, -v243, v239, v237
    v_fma_f32 v237, v239, v241, v243
    v_cvt_pk_bf16_f32 v246, v236, v237
    v_lshlrev_b32 v236, 16, v247
    v_and_b32 v237, 0xffff0000, v247
    v_max_f32 v236, 0xc2ae0000, v236
    v_min_f32 v242, 0x43000000, v236
    v_mul_f32 v238, 0xbfb8aa3b, v242
    v_fma_f32 v240, v242, s98, -v238
    v_fmac_f32 v240, 0xb2a57060, v242
    v_exp_f32 v238, v238
    v_mul_f32 v240, 0x3f317218, v240
    v_fmac_f32 v238, v238, v240
    v_add_f32 v238, 1.0, v238
    v_rcp_f32 v240, v238
    s_nop 0
    v_mul_f32 v242, v236, v240
    v_fma_f32 v238, -v242, v238, v236
    v_fma_f32 v236, v238, v240, v242
    v_max_f32 v237, 0xc2ae0000, v237
    v_min_f32 v243, 0x43000000, v237
    v_mul_f32 v239, 0xbfb8aa3b, v243
    v_fma_f32 v241, v243, s98, -v239
    v_fmac_f32 v241, 0xb2a57060, v243
    v_exp_f32 v239, v239
    v_mul_f32 v241, 0x3f317218, v241
    v_fmac_f32 v239, v239, v241
    v_add_f32 v239, 1.0, v239
    v_rcp_f32 v241, v239
    s_nop 0
    v_mul_f32 v243, v237, v241
    v_fma_f32 v239, -v243, v239, v237
    v_fma_f32 v237, v239, v241, v243
    v_cvt_pk_bf16_f32 v247, v236, v237
    v_lshlrev_b32 v236, 16, v248
    v_and_b32 v237, 0xffff0000, v248
    v_max_f32 v236, 0xc2ae0000, v236
    v_min_f32 v242, 0x43000000, v236
    v_mul_f32 v238, 0xbfb8aa3b, v242
    v_fma_f32 v240, v242, s98, -v238
    v_fmac_f32 v240, 0xb2a57060, v242
    v_exp_f32 v238, v238
    v_mul_f32 v240, 0x3f317218, v240
    v_fmac_f32 v238, v238, v240
    v_add_f32 v238, 1.0, v238
    v_rcp_f32 v240, v238
    s_nop 0
    v_mul_f32 v242, v236, v240
    v_fma_f32 v238, -v242, v238, v236
    v_fma_f32 v236, v238, v240, v242
    v_max_f32 v237, 0xc2ae0000, v237
    v_min_f32 v243, 0x43000000, v237
    v_mul_f32 v239, 0xbfb8aa3b, v243
    v_fma_f32 v241, v243, s98, -v239
    v_fmac_f32 v241, 0xb2a57060, v243
    v_exp_f32 v239, v239
    v_mul_f32 v241, 0x3f317218, v241
    v_fmac_f32 v239, v239, v241
    v_add_f32 v239, 1.0, v239
    v_rcp_f32 v241, v239
    s_nop 0
    v_mul_f32 v243, v237, v241
    v_fma_f32 v239, -v243, v239, v237
    v_fma_f32 v237, v239, v241, v243
    v_cvt_pk_bf16_f32 v248, v236, v237
    v_lshlrev_b32 v236, 16, v249
    v_and_b32 v237, 0xffff0000, v249
    v_max_f32 v236, 0xc2ae0000, v236
    v_min_f32 v242, 0x43000000, v236
    v_mul_f32 v238, 0xbfb8aa3b, v242
    v_fma_f32 v240, v242, s98, -v238
    v_fmac_f32 v240, 0xb2a57060, v242
    v_exp_f32 v238, v238
    v_mul_f32 v240, 0x3f317218, v240
    v_fmac_f32 v238, v238, v240
    v_add_f32 v238, 1.0, v238
    v_rcp_f32 v240, v238
    s_nop 0
    v_mul_f32 v242, v236, v240
    v_fma_f32 v238, -v242, v238, v236
    v_fma_f32 v236, v238, v240, v242
    v_max_f32 v237, 0xc2ae0000, v237
    v_min_f32 v243, 0x43000000, v237
    v_mul_f32 v239, 0xbfb8aa3b, v243
    v_fma_f32 v241, v243, s98, -v239
    v_fmac_f32 v241, 0xb2a57060, v243
    v_exp_f32 v239, v239
    v_mul_f32 v241, 0x3f317218, v241
    v_fmac_f32 v239, v239, v241
    v_add_f32 v239, 1.0, v239
    v_rcp_f32 v241, v239
    s_nop 0
    v_mul_f32 v243, v237, v241
    v_fma_f32 v239, -v243, v239, v237
    v_fma_f32 v237, v239, v241, v243
    v_cvt_pk_bf16_f32 v249, v236, v237
    v_lshlrev_b32 v236, 16, v250
    v_and_b32 v237, 0xffff0000, v250
    v_max_f32 v236, 0xc2ae0000, v236
    v_min_f32 v242, 0x43000000, v236
    v_mul_f32 v238, 0xbfb8aa3b, v242
    v_fma_f32 v240, v242, s98, -v238
    v_fmac_f32 v240, 0xb2a57060, v242
    v_exp_f32 v238, v238
    v_mul_f32 v240, 0x3f317218, v240
    v_fmac_f32 v238, v238, v240
    v_add_f32 v238, 1.0, v238
    v_rcp_f32 v240, v238
    s_nop 0
    v_mul_f32 v242, v236, v240
    v_fma_f32 v238, -v242, v238, v236
    v_fma_f32 v236, v238, v240, v242
    v_max_f32 v237, 0xc2ae0000, v237
    v_min_f32 v243, 0x43000000, v237
    v_mul_f32 v239, 0xbfb8aa3b, v243
    v_fma_f32 v241, v243, s98, -v239
    v_fmac_f32 v241, 0xb2a57060, v243
    v_exp_f32 v239, v239
    v_mul_f32 v241, 0x3f317218, v241
    v_fmac_f32 v239, v239, v241
    v_add_f32 v239, 1.0, v239
    v_rcp_f32 v241, v239
    s_nop 0
    v_mul_f32 v243, v237, v241
    v_fma_f32 v239, -v243, v239, v237
    v_fma_f32 v237, v239, v241, v243
    v_cvt_pk_bf16_f32 v250, v236, v237
    ds_write_b64 v17, v[246:247]
    ds_write_b64 v17, v[248:249] offset:512
    ds_write_b32 v18, v250
    s_waitcnt vmcnt(3)
    s_add_u32 s63, s69, 147456
    buffer_load_dwordx4 v[72:75], v1, s[40:43], s63 offen nt
    s_waitcnt vmcnt(3)
    s_add_u32 s63, s69, 155648
    buffer_load_dwordx4 v[76:79], v1, s[40:43], s63 offen nt
    s_waitcnt vmcnt(3)
    s_add_u32 s63, s69, 163840
    buffer_load_dwordx4 v[104:107], v1, s[40:43], s63 offen nt
    s_waitcnt vmcnt(3)
    s_add_u32 s63, s69, 172032
    buffer_load_dwordx4 v[108:111], v1, s[40:43], s63 offen nt
    s_waitcnt vmcnt(3)
    s_add_u32 s63, s69, 180224
    buffer_load_dwordx4 v[136:139], v1, s[40:43], s63 offen nt
    s_waitcnt vmcnt(3)
    s_add_u32 s63, s69, 188416
    buffer_load_dwordx4 v[140:143], v1, s[40:43], s63 offen nt
    s_waitcnt vmcnt(3)
    s_add_u32 s63, s69, 262144
    buffer_load_dwordx4 v[48:51], v1, s[40:43], s63 offen nt
    s_waitcnt vmcnt(3)
    s_add_u32 s63, s69, 270336
    buffer_load_dwordx4 v[52:55], v1, s[40:43], s63 offen nt
    s_waitcnt lgkmcnt(0)
    s_barrier
    ds_read_b64_tr_b16 v[160:161], v20 offset:0
    ds_read_b64_tr_b16 v[162:163], v20 offset:512
    ds_read_b64_tr_b16 v[164:165], v20 offset:8192
    ds_read_b64_tr_b16 v[166:167], v20 offset:8704
    ds_read_b64_tr_b16 v[168:169], v20 offset:16384
    ds_read_b64_tr_b16 v[170:171], v20 offset:16896
    ds_read_b64_tr_b16 v[172:173], v20 offset:24576
    ds_read_b64_tr_b16 v[174:175], v20 offset:25088
    ds_read_b64_tr_b16 v[176:177], v21 offset:0
    ds_read_b64_tr_b16 v[178:179], v21 offset:512
    ds_read_b64_tr_b16 v[180:181], v21 offset:8192
    ds_read_b64_tr_b16 v[182:183], v21 offset:8704
    ds_read_b64_tr_b16 v[184:185], v21 offset:16384
    ds_read_b64_tr_b16 v[186:187], v21 offset:16896
    ds_read_b64_tr_b16 v[188:189], v21 offset:24576
    ds_read_b64_tr_b16 v[190:191], v21 offset:25088
    ds_read_b64_tr_b16 v[192:193], v21 offset:32768
    ds_read_b64_tr_b16 v[194:195], v21 offset:33280
    ds_read_b128 v[196:199], v16 offset:0
    ds_read_b128 v[200:203], v16 offset:128
    ds_read_b128 v[204:207], v16 offset:256
    ds_read_b128 v[208:211], v16 offset:384
    ds_read_b128 v[212:215], v16 offset:512
    ds_read_b128 v[216:219], v16 offset:640
    ds_read_b128 v[220:223], v16 offset:768
    ds_read_b128 v[224:227], v16 offset:896
    ds_read_b128 v[228:231], v16 offset:1024
    s_waitcnt lgkmcnt(8)
    v_mfma_f32_16x16x32_bf16 v[232:235], v[160:163], v[196:199], 0
    s_waitcnt lgkmcnt(7)
    v_mfma_f32_16x16x32_bf16 v[232:235], v[164:167], v[200:203], v[232:235]
    s_waitcnt lgkmcnt(6)
    v_mfma_f32_16x16x32_bf16 v[232:235], v[168:171], v[204:207], v[232:235]
    s_waitcnt lgkmcnt(5)
    v_mfma_f32_16x16x32_bf16 v[232:235], v[172:175], v[208:211], v[232:235]
    s_waitcnt lgkmcnt(4)
    v_mfma_f32_16x16x32_bf16 v[232:235], v[176:179], v[212:215], v[232:235]
    s_waitcnt lgkmcnt(3)
    v_mfma_f32_16x16x32_bf16 v[232:235], v[180:183], v[216:219], v[232:235]
    s_waitcnt lgkmcnt(2)
    v_mfma_f32_16x16x32_bf16 v[232:235], v[184:187], v[220:223], v[232:235]
    s_waitcnt lgkmcnt(1)
    v_mfma_f32_16x16x32_bf16 v[232:235], v[188:191], v[224:227], v[232:235]
    s_waitcnt lgkmcnt(0)
    v_mfma_f32_16x16x32_bf16 v[232:235], v[192:195], v[228:231], v[232:235]
    s_nop 7
    v_permlane32_swap_b32 v232, v234
    v_permlane32_swap_b32 v233, v235
    v_cndmask_b32 v233, v233, v234, s[96:97]
    v_cndmask_b32 v232, v232, v235, s[96:97]
    s_nop 1
    v_add_f32_dpp v236, v233, v232 quad_perm:[1,0,3,2] row_mask:0xf bank_mask:0xf
    v_cvt_pk_bf16_f32 v236, v236, v236
    v_lshlrev_b32 v236, 16, v236
    v_add_f32 v236, s58, v236
    v_cvt_pk_bf16_f32 v236, v236, v236
    ds_write_b16 v23, v236
    v_mov_b32 v243, s34
    s_waitcnt lgkmcnt(0)
    s_barrier
    ds_read2_b32 v[244:245], v24 offset1:1
    v_mov_b32 v241, s34
    s_waitcnt lgkmcnt(0)
    v_mov_b32 v240, v244
    v_mov_b32 v242, v245
    s_mov_b64 exec, 0xffff
    buffer_store_dwordx4 v[240:243], v22, s[36:39], s59 offen sc1
    s_mov_b64 exec, -1
    s_nop 0
    s_branch .Le_m2
.Le_mc:
    v_bfe_u32 v16, v0, 1, 3
    v_mul_u32_u24 v16, 1312, v16
    v_lshrrev_b32 v12, 4, v0
    v_lshl_add_u32 v16, v12, 5, v16
    v_and_b32 v12, 1, v0
    v_lshl_add_u32 v16, v12, 4, v16
    v_add_u32 v16, 147456, v16
    s_mul_i32 s56, s3, 1312
    s_add_u32 s56, s56, 147456
    v_add_u32 v17, s56, v3
    v_add_u32 v18, s56, v4
    v_lshrrev_b32 v12, 4, v0
    v_bfe_u32 v13, v0, 1, 1
    v_lshl_add_u32 v12, v12, 1, v13
    v_bfe_u32 v13, v0, 2, 2
    v_lshl_add_u32 v20, v12, 3, v13
    v_lshlrev_b32 v20, 7, v20
    v_and_b32 v12, 3, v12
    v_lshrrev_b32 v13, 1, v13
    v_lshl_add_u32 v12, v12, 1, v13
    v_xor_b32 v12, s3, v12
    v_lshl_add_u32 v20, v12, 4, v20
    v_and_b32 v12, 1, v0
    v_lshl_add_u32 v20, v12, 3, v20
    v_bfe_u32 v23, v0, 1, 3
    v_mul_u32_u24 v23, 144, v23
    v_bfe_u32 v12, v0, 4, 1
    v_lshl_add_u32 v23, v12, 3, v23
    v_lshrrev_b32 v12, 5, v0
    v_lshl_add_u32 v23, v12, 2, v23
    v_and_b32 v12, 1, v0
    v_lshl_add_u32 v23, v12, 1, v23
    s_lshl_b32 s56, s3, 4
    s_add_u32 s56, s56, 157952
    v_add_u32 v23, s56, v23
    v_and_b32 v24, 15, v0
    v_lshlrev_b32 v24, 3, v24
    s_mul_i32 s56, s3, 144
    s_add_u32 s56, s56, 157952
    v_add_u32 v24, s56, v24
    v_add_u32 v21, 32768, v20
    s_lshl_b32 s100, s3, 10
    s_waitcnt lgkmcnt(0)
    s_add_u32 s34, s34, 1
    v_lshrrev_b32 v12, 4, v0
    v_mul_u32_u24 v12, 18432, v12
    v_and_b32 v13, 15, v0
    v_lshl_add_u32 v22, v13, 4, v12
    s_mul_i32 s57, s99, 57
    s_lshr_b32 s57, s57, 9
    s_mul_i32 s58, s57, 9
    s_sub_u32 s58, s99, s58
    s_mul_i32 s59, s57, 36864
    s_lshl_b32 s58, s58, 8
    s_add_u32 s59, s59, s58
    s_mul_i32 s58, s3, 2304
    s_add_u32 s59, s59, s58
    s_add_u32 s59, s59, 0x3000
    s_mov_b32 s58, 0
    s_cmp_eq_u32 s57, 1
    s_cselect_b32 s58, 1.0, s58
    s_cmp_eq_u32 s57, 4
    s_cselect_b32 s58, 1.0, s58
    s_waitcnt vmcnt(13)
    v_lshlrev_b32 v236, 16, v246
    v_and_b32 v237, 0xffff0000, v246
    v_max_f32 v236, 0xc2ae0000, v236
    v_min_f32 v242, 0x43000000, v236
    v_mul_f32 v238, 0xbfb8aa3b, v242
    v_fma_f32 v240, v242, s98, -v238
    v_fmac_f32 v240, 0xb2a57060, v242
    v_exp_f32 v238, v238
    v_mul_f32 v240, 0x3f317218, v240
    v_fmac_f32 v238, v238, v240
    v_add_f32 v238, 1.0, v238
    v_rcp_f32 v240, v238
    s_nop 0
    v_mul_f32 v242, v236, v240
    v_fma_f32 v238, -v242, v238, v236
    v_fma_f32 v236, v238, v240, v242
    v_max_f32 v237, 0xc2ae0000, v237
    v_min_f32 v243, 0x43000000, v237
    v_mul_f32 v239, 0xbfb8aa3b, v243
    v_fma_f32 v241, v243, s98, -v239
    v_fmac_f32 v241, 0xb2a57060, v243
    v_exp_f32 v239, v239
    v_mul_f32 v241, 0x3f317218, v241
    v_fmac_f32 v239, v239, v241
    v_add_f32 v239, 1.0, v239
    v_rcp_f32 v241, v239
    s_nop 0
    v_mul_f32 v243, v237, v241
    v_fma_f32 v239, -v243, v239, v237
    v_fma_f32 v237, v239, v241, v243
    v_cvt_pk_bf16_f32 v246, v236, v237
    v_lshlrev_b32 v236, 16, v247
    v_and_b32 v237, 0xffff0000, v247
    v_max_f32 v236, 0xc2ae0000, v236
    v_min_f32 v242, 0x43000000, v236
    v_mul_f32 v238, 0xbfb8aa3b, v242
    v_fma_f32 v240, v242, s98, -v238
    v_fmac_f32 v240, 0xb2a57060, v242
    v_exp_f32 v238, v238
    v_mul_f32 v240, 0x3f317218, v240
    v_fmac_f32 v238, v238, v240
    v_add_f32 v238, 1.0, v238
    v_rcp_f32 v240, v238
    s_nop 0
    v_mul_f32 v242, v236, v240
    v_fma_f32 v238, -v242, v238, v236
    v_fma_f32 v236, v238, v240, v242
    v_max_f32 v237, 0xc2ae0000, v237
    v_min_f32 v243, 0x43000000, v237
    v_mul_f32 v239, 0xbfb8aa3b, v243
    v_fma_f32 v241, v243, s98, -v239
    v_fmac_f32 v241, 0xb2a57060, v243
    v_exp_f32 v239, v239
    v_mul_f32 v241, 0x3f317218, v241
    v_fmac_f32 v239, v239, v241
    v_add_f32 v239, 1.0, v239
    v_rcp_f32 v241, v239
    s_nop 0
    v_mul_f32 v243, v237, v241
    v_fma_f32 v239, -v243, v239, v237
    v_fma_f32 v237, v239, v241, v243
    v_cvt_pk_bf16_f32 v247, v236, v237
    v_lshlrev_b32 v236, 16, v248
    v_and_b32 v237, 0xffff0000, v248
    v_max_f32 v236, 0xc2ae0000, v236
    v_min_f32 v242, 0x43000000, v236
    v_mul_f32 v238, 0xbfb8aa3b, v242
    v_fma_f32 v240, v242, s98, -v238
    v_fmac_f32 v240, 0xb2a57060, v242
    v_exp_f32 v238, v238
    v_mul_f32 v240, 0x3f317218, v240
    v_fmac_f32 v238, v238, v240
    v_add_f32 v238, 1.0, v238
    v_rcp_f32 v240, v238
    s_nop 0
    v_mul_f32 v242, v236, v240
    v_fma_f32 v238, -v242, v238, v236
    v_fma_f32 v236, v238, v240, v242
    v_max_f32 v237, 0xc2ae0000, v237
    v_min_f32 v243, 0x43000000, v237
    v_mul_f32 v239, 0xbfb8aa3b, v243
    v_fma_f32 v241, v243, s98, -v239
    v_fmac_f32 v241, 0xb2a57060, v243
    v_exp_f32 v239, v239
    v_mul_f32 v241, 0x3f317218, v241
    v_fmac_f32 v239, v239, v241
    v_add_f32 v239, 1.0, v239
    v_rcp_f32 v241, v239
    s_nop 0
    v_mul_f32 v243, v237, v241
    v_fma_f32 v239, -v243, v239, v237
    v_fma_f32 v237, v239, v241, v243
    v_cvt_pk_bf16_f32 v248, v236, v237
    v_lshlrev_b32 v236, 16, v249
    v_and_b32 v237, 0xffff0000, v249
    v_max_f32 v236, 0xc2ae0000, v236
    v_min_f32 v242, 0x43000000, v236
    v_mul_f32 v238, 0xbfb8aa3b, v242
    v_fma_f32 v240, v242, s98, -v238
    v_fmac_f32 v240, 0xb2a57060, v242
    v_exp_f32 v238, v238
    v_mul_f32 v240, 0x3f317218, v240
    v_fmac_f32 v238, v238, v240
    v_add_f32 v238, 1.0, v238
    v_rcp_f32 v240, v238
    s_nop 0
    v_mul_f32 v242, v236, v240
    v_fma_f32 v238, -v242, v238, v236
    v_fma_f32 v236, v238, v240, v242
    v_max_f32 v237, 0xc2ae0000, v237
    v_min_f32 v243, 0x43000000, v237
    v_mul_f32 v239, 0xbfb8aa3b, v243
    v_fma_f32 v241, v243, s98, -v239
    v_fmac_f32 v241, 0xb2a57060, v243
    v_exp_f32 v239, v239
    v_mul_f32 v241, 0x3f317218, v241
    v_fmac_f32 v239, v239, v241
    v_add_f32 v239, 1.0, v239
    v_rcp_f32 v241, v239
    s_nop 0
    v_mul_f32 v243, v237, v241
    v_fma_f32 v239, -v243, v239, v237
    v_fma_f32 v237, v239, v241, v243
    v_cvt_pk_bf16_f32 v249, v236, v237
    v_lshlrev_b32 v236, 16, v250
    v_and_b32 v237, 0xffff0000, v250
    v_max_f32 v236, 0xc2ae0000, v236
    v_min_f32 v242, 0x43000000, v236
    v_mul_f32 v238, 0xbfb8aa3b, v242
    v_fma_f32 v240, v242, s98, -v238
    v_fmac_f32 v240, 0xb2a57060, v242
    v_exp_f32 v238, v238
    v_mul_f32 v240, 0x3f317218, v240
    v_fmac_f32 v238, v238, v240
    v_add_f32 v238, 1.0, v238
    v_rcp_f32 v240, v238
    s_nop 0
    v_mul_f32 v242, v236, v240
    v_fma_f32 v238, -v242, v238, v236
    v_fma_f32 v236, v238, v240, v242
    v_max_f32 v237, 0xc2ae0000, v237
    v_min_f32 v243, 0x43000000, v237
    v_mul_f32 v239, 0xbfb8aa3b, v243
    v_fma_f32 v241, v243, s98, -v239
    v_fmac_f32 v241, 0xb2a57060, v243
    v_exp_f32 v239, v239
    v_mul_f32 v241, 0x3f317218, v241
    v_fmac_f32 v239, v239, v241
    v_add_f32 v239, 1.0, v239
    v_rcp_f32 v241, v239
    s_nop 0
    v_mul_f32 v243, v237, v241
    v_fma_f32 v239, -v243, v239, v237
    v_fma_f32 v237, v239, v241, v243
    v_cvt_pk_bf16_f32 v250, v236, v237
    ds_write_b64 v17, v[246:247]
    ds_write_b64 v17, v[248:249] offset:512
    ds_write_b32 v18, v250
    s_waitcnt vmcnt(4)
    s_waitcnt lgkmcnt(0)
    s_barrier
    ds_read_b64_tr_b16 v[160:161], v20 offset:0
    ds_read_b64_tr_b16 v[162:163], v20 offset:512
    ds_read_b64_tr_b16 v[164:165], v20 offset:8192
    ds_read_b64_tr_b16 v[166:167], v20 offset:8704
    ds_read_b64_tr_b16 v[168:169], v20 offset:16384
    ds_read_b64_tr_b16 v[170:171], v20 offset:16896
    ds_read_b64_tr_b16 v[172:173], v20 offset:24576
    ds_read_b64_tr_b16 v[174:175], v20 offset:25088
    ds_read_b64_tr_b16 v[176:177], v21 offset:0
    ds_read_b64_tr_b16 v[178:179], v21 offset:512
    ds_read_b64_tr_b16 v[180:181], v21 offset:8192
    ds_read_b64_tr_b16 v[182:183], v21 offset:8704
    ds_read_b64_tr_b16 v[184:185], v21 offset:16384
    ds_read_b64_tr_b16 v[186:187], v21 offset:16896
    ds_read_b64_tr_b16 v[188:189], v21 offset:24576
    ds_read_b64_tr_b16 v[190:191], v21 offset:25088
    ds_read_b64_tr_b16 v[192:193], v21 offset:32768
    ds_read_b64_tr_b16 v[194:195], v21 offset:33280
    ds_read_b128 v[196:199], v16 offset:0
    ds_read_b128 v[200:203], v16 offset:128
    ds_read_b128 v[204:207], v16 offset:256
    ds_read_b128 v[208:211], v16 offset:384
    ds_read_b128 v[212:215], v16 offset:512
    ds_read_b128 v[216:219], v16 offset:640
    ds_read_b128 v[220:223], v16 offset:768
    ds_read_b128 v[224:227], v16 offset:896
    ds_read_b128 v[228:231], v16 offset:1024
    s_waitcnt lgkmcnt(8)
    v_mfma_f32_16x16x32_bf16 v[232:235], v[160:163], v[196:199], 0
    s_waitcnt lgkmcnt(7)
    v_mfma_f32_16x16x32_bf16 v[232:235], v[164:167], v[200:203], v[232:235]
    s_waitcnt lgkmcnt(6)
    v_mfma_f32_16x16x32_bf16 v[232:235], v[168:171], v[204:207], v[232:235]
    s_waitcnt lgkmcnt(5)
    v_mfma_f32_16x16x32_bf16 v[232:235], v[172:175], v[208:211], v[232:235]
    s_waitcnt lgkmcnt(4)
    v_mfma_f32_16x16x32_bf16 v[232:235], v[176:179], v[212:215], v[232:235]
    s_waitcnt lgkmcnt(3)
    v_mfma_f32_16x16x32_bf16 v[232:235], v[180:183], v[216:219], v[232:235]
    s_waitcnt lgkmcnt(2)
    v_mfma_f32_16x16x32_bf16 v[232:235], v[184:187], v[220:223], v[232:235]
    s_waitcnt lgkmcnt(1)
    v_mfma_f32_16x16x32_bf16 v[232:235], v[188:191], v[224:227], v[232:235]
    s_waitcnt lgkmcnt(0)
    v_mfma_f32_16x16x32_bf16 v[232:235], v[192:195], v[228:231], v[232:235]
    s_nop 7
    v_permlane32_swap_b32 v232, v234
    v_permlane32_swap_b32 v233, v235
    v_cndmask_b32 v233, v233, v234, s[96:97]
    v_cndmask_b32 v232, v232, v235, s[96:97]
    s_nop 1
    v_add_f32_dpp v236, v233, v232 quad_perm:[1,0,3,2] row_mask:0xf bank_mask:0xf
    v_cvt_pk_bf16_f32 v236, v236, v236
    v_lshlrev_b32 v236, 16, v236
    v_add_f32 v236, s58, v236
    v_cvt_pk_bf16_f32 v236, v236, v236
    ds_write_b16 v23, v236
    v_mov_b32 v243, s34
    s_waitcnt lgkmcnt(0)
    s_barrier
    ds_read2_b32 v[244:245], v24 offset1:1
    v_mov_b32 v241, s34
    s_waitcnt lgkmcnt(0)
    v_mov_b32 v240, v244
    v_mov_b32 v242, v245
    s_mov_b64 exec, 0xffffffff
    buffer_store_dwordx4 v[240:243], v22, s[36:39], s59 offen sc1
    s_mov_b64 exec, -1
    s_mov_b32 s14, 0x6b5ad6b5
    s_mov_b32 s15, 0x5ad6b5ad
    s_add_u32 s30, s70, -30
    s_waitcnt vmcnt(3)
    s_add_u32 s63, s69, 32768
    buffer_load_dwordx4 v[96:99], v1, s[40:43], s63 offen nt
    s_waitcnt vmcnt(3)
    s_add_u32 s63, s69, 40960
    buffer_load_dwordx4 v[100:103], v1, s[40:43], s63 offen nt
    s_waitcnt vmcnt(3)
    s_add_u32 s63, s69, 49152
    buffer_load_dwordx4 v[128:131], v1, s[40:43], s63 offen nt
    s_waitcnt vmcnt(3)
    s_add_u32 s63, s69, 57344
    buffer_load_dwordx4 v[132:135], v1, s[40:43], s63 offen nt
    s_waitcnt vmcnt(3)
    s_add_u32 s63, s69, 131072
    buffer_load_dwordx4 v[40:43], v1, s[40:43], s63 offen nt
    s_waitcnt vmcnt(3)
    s_add_u32 s63, s69, 139264
    buffer_load_dwordx4 v[44:47], v1, s[40:43], s63 offen nt
    s_waitcnt vmcnt(3)
    s_add_u32 s63, s69, 147456
    buffer_load_dwordx4 v[72:75], v1, s[40:43], s63 offen nt
    s_waitcnt vmcnt(3)
    s_add_u32 s63, s69, 155648
    buffer_load_dwordx4 v[76:79], v1, s[40:43], s63 offen nt
    s_waitcnt vmcnt(3)
    s_add_u32 s63, s69, 163840
    buffer_load_dwordx4 v[104:107], v1, s[40:43], s63 offen nt
    s_waitcnt vmcnt(3)
    s_add_u32 s63, s69, 172032
    buffer_load_dwordx4 v[108:111], v1, s[40:43], s63 offen nt
    s_waitcnt vmcnt(3)
    s_add_u32 s63, s69, 180224
    buffer_load_dwordx4 v[136:139], v1, s[40:43], s63 offen nt
    s_waitcnt vmcnt(3)
    s_add_u32 s63, s69, 188416
    buffer_load_dwordx4 v[140:143], v1, s[40:43], s63 offen nt
    s_waitcnt vmcnt(3)
    s_add_u32 s63, s69, 262144
    buffer_load_dwordx4 v[48:51], v1, s[40:43], s63 offen nt
    s_waitcnt vmcnt(3)
    s_add_u32 s63, s69, 270336
    buffer_load_dwordx4 v[52:55], v1, s[40:43], s63 offen nt
.Le_m2:
    s_waitcnt vmcnt(3)
    s_bitcmp1_b64 s[14:15], 18
    s_cbranch_scc0 1
    s_waitcnt vmcnt(2)
    s_add_u32 s63, s69, 278528
    buffer_load_dwordx4 v[80:83], v1, s[40:43], s63 offen nt
    v_and_b32 v157, 7, v0
    v_lshlrev_b32 v157, 7, v157
    s_mov_b32 s63, 0x400
    buffer_load_dword v156, v157, s[36:39], s63 offen
    s_memrealtime s[8:9]
    s_waitcnt lgkmcnt(0)
    s_sub_u32 s8, s8, s30
    s_cmpk_ge_u32 s8, 850
    s_cbranch_scc1 .ap_28
    s_waitcnt vmcnt(5)
    s_cmpk_ge_u32 s8, 785
    s_cbranch_scc1 .ap_28
    s_waitcnt vmcnt(4)
    s_bitcmp1_b64 s[14:15], 19
    s_cbranch_scc0 1
    s_waitcnt vmcnt(3)
    s_cmpk_ge_u32 s8, 710
    s_cbranch_scc1 .ap_28
    s_waitcnt vmcnt(2)
.ap_28:
    s_add_u32 s63, s69, 286720
    buffer_load_dwordx4 v[84:87], v1, s[40:43], s63 offen nt
    s_memrealtime s[8:9]
    s_waitcnt lgkmcnt(0)
    s_sub_u32 s8, s8, s30
    s_cmpk_ge_u32 s8, 895
    s_cbranch_scc1 .ap_29
    s_waitcnt vmcnt(6)
    s_cmpk_ge_u32 s8, 830
    s_cbranch_scc1 .ap_29
    s_waitcnt vmcnt(4)
    s_bitcmp1_b64 s[14:15], 20
    s_cbranch_scc0 1
    s_waitcnt vmcnt(3)
    s_cmpk_ge_u32 s8, 755
    s_cbranch_scc1 .ap_29
    s_waitcnt vmcnt(2)
.ap_29:
    s_add_u32 s63, s69, 294912
    buffer_load_dwordx4 v[112:115], v1, s[40:43], s63 offen nt
    s_memrealtime s[8:9]
    s_waitcnt lgkmcnt(0)
    s_sub_u32 s8, s8, s30
    s_cmpk_ge_u32 s8, 940
    s_cbranch_scc1 .ap_30
    s_waitcnt vmcnt(6)
    s_cmpk_ge_u32 s8, 875
    s_cbranch_scc1 .ap_30
    s_waitcnt vmcnt(4)
    s_bitcmp1_b64 s[14:15], 21
    s_cbranch_scc0 1
    s_waitcnt vmcnt(3)
    s_cmpk_ge_u32 s8, 800
    s_cbranch_scc1 .ap_30
    s_waitcnt vmcnt(1)
.ap_30:
    s_add_u32 s63, s69, 303104
    buffer_load_dwordx4 v[116:119], v1, s[40:43], s63 offen nt
    s_memrealtime s[8:9]
    s_waitcnt lgkmcnt(0)
    s_sub_u32 s8, s8, s30
    s_cmpk_ge_u32 s8, 985
    s_cbranch_scc1 .ap_31
    s_waitcnt vmcnt(6)
    s_cmpk_ge_u32 s8, 920
    s_cbranch_scc1 .ap_31
    s_waitcnt vmcnt(4)
    s_bitcmp1_b64 s[14:15], 22
    s_cbranch_scc0 1
    s_waitcnt vmcnt(2)
    s_cmpk_ge_u32 s8, 845
    s_cbranch_scc1 .ap_31
    s_waitcnt vmcnt(1)
.ap_31:
    s_add_u32 s63, s69, 311296
    buffer_load_dwordx4 v[144:147], v1, s[40:43], s63 offen nt
    s_waitcnt vmcnt(4)
    s_sub_u32 s63, s70, 300
    v_subrev_u32 v156, s63, v156
    v_mov_b32 v157, 600
    v_cmp_lt_u32 s[8:9], v156, v157
    v_add_u32_dpp v156, v156, v156 quad_perm:[1,0,3,2] row_mask:0xf bank_mask:0xf
    s_nop 1
    v_add_u32_dpp v156, v156, v156 quad_perm:[2,3,0,1] row_mask:0xf bank_mask:0xf
    s_nop 1
    v_add_u32_dpp v156, v156, v156 row_ror:4 row_mask:0xf bank_mask:0xf
    s_nop 0
    v_readfirstlane_b32 s63, v156
    s_cmp_eq_u64 s[8:9], -1
    s_nop 3
    s_cbranch_scc0 .et_32
    s_lshr_b32 s63, s63, 3
    s_sub_u32 s63, s63, 300
    s_add_u32 s30, s30, s63
.et_32:
    s_memrealtime s[8:9]
    s_waitcnt lgkmcnt(0)
    s_sub_u32 s8, s8, s30
    s_cmpk_ge_u32 s8, 1030
    s_cbranch_scc1 .ap_33
    s_waitcnt vmcnt(4)
    s_cmpk_ge_u32 s8, 965
    s_cbranch_scc1 .ap_33
    s_waitcnt vmcnt(3)
    s_bitcmp1_b64 s[14:15], 23
    s_cbranch_scc0 1
    s_waitcnt vmcnt(2)
    s_cmpk_ge_u32 s8, 890
    s_cbranch_scc1 .ap_33
    s_waitcnt vmcnt(1)
.ap_33:
    s_add_u32 s63, s69, 319488
    buffer_load_dwordx4 v[148:151], v1, s[40:43], s63 offen nt
    s_memrealtime s[8:9]
    s_waitcnt lgkmcnt(0)
    s_sub_u32 s8, s8, s30
    s_cmpk_ge_u32 s8, 1075
    s_cbranch_scc1 .ap_34
    s_waitcnt vmcnt(5)
    s_cmpk_ge_u32 s8, 1010
    s_cbranch_scc1 .ap_34
    s_waitcnt vmcnt(3)
    s_bitcmp1_b64 s[14:15], 24
    s_cbranch_scc0 1
    s_waitcnt vmcnt(2)
    s_cmpk_ge_u32 s8, 935
    s_cbranch_scc1 .ap_34
    s_waitcnt vmcnt(1)
.ap_34:
    s_add_u32 s63, s69, 393216
    buffer_load_dwordx4 v[56:59], v1, s[40:43], s63 offen nt
    s_memrealtime s[8:9]
    s_waitcnt lgkmcnt(0)
    s_sub_u32 s8, s8, s30
    s_cmpk_ge_u32 s8, 1120
    s_cbranch_scc1 .ap_35
    s_waitcnt vmcnt(5)
    s_cmpk_ge_u32 s8, 1055
    s_cbranch_scc1 .ap_35
    s_waitcnt vmcnt(3)
    s_bitcmp1_b64 s[14:15], 25
    s_cbranch_scc0 1
    s_waitcnt vmcnt(2)
    s_cmpk_ge_u32 s8, 980
    s_cbranch_scc1 .ap_35
    s_waitcnt vmcnt(1)
.ap_35:
    s_add_u32 s63, s69, 401408
    buffer_load_dwordx4 v[60:63], v1, s[40:43], s63 offen nt
    s_cmp_lt_u32 s2, 216
    s_cbranch_scc1 .Latt_bc
    s_branch .Latt_n
.Le_q:
    s_cmp_ge_u32 s65, 27
    s_mov_b32 s14, 0x94a5294a
    s_cselect_b32 s14, 0x0, s14
    s_mov_b32 s15, 0xa5294a52
    s_cselect_b32 s15, 0x0, s15
    s_cselect_b32 s30, -30, 0
    s_add_u32 s30, s30, 0
    s_add_u32 s30, s30, s70
    s_mul_i32 s58, s3, 1152
    s_mov_b32 s52, s4
    s_and_b32 s53, s5, 0xffff
    s_mov_b32 s54, 0x2400
    s_mov_b32 s55, 0x00020000
    buffer_load_dwordx2 v[246:247], v3, s[52:55], s58 offen
    buffer_load_dwordx2 v[248:249], v3, s[52:55], s58 offen offset:512
    buffer_load_dword v250, v4, s[52:55], s58 offen
    s_mov_b32 s48, s10
    s_and_b32 s49, s11, 0xffff
    s_mov_b32 s50, 0x480000
    s_mov_b32 s51, 0x00020000
    v_bfe_u32 v12, v0, 4, 1
    s_and_b32 s56, s3, 3
    s_lshl_b32 s56, s56, 1
    v_or_b32 v12, s56, v12
    v_and_b32 v19, 7, v0
    v_xor_b32 v12, v12, v19
    v_lshrrev_b32 v19, 3, v0
    v_mul_u32_u24 v19, 8192, v19
    v_lshl_add_u32 v19, v12, 4, v19
    s_lshl3_add_u32 s101, s64, s101
    s_lshl_b32 s99, s3, 16
    s_lshl_b32 s59, s101, 7
    s_add_u32 s99, s99, s59
    s_lshl_b32 s100, s3, 10
    s_add_u32 m0, s100, 0
    s_add_u32 s56, s99, 0
    buffer_load_dwordx4 v19, s[48:51], s56 offen nt lds
    s_add_u32 s63, s69, 32768
    buffer_load_dwordx4 v[96:99], v1, s[40:43], s63 offen nt
    v_bfe_u32 v16, v0, 1, 3
    v_mul_u32_u24 v16, 1312, v16
    v_lshrrev_b32 v12, 4, v0
    v_lshl_add_u32 v16, v12, 5, v16
    v_and_b32 v12, 1, v0
    v_lshl_add_u32 v16, v12, 4, v16
    v_add_u32 v16, 147456, v16
    s_mul_i32 s56, s3, 1312
    s_add_u32 s56, s56, 147456
    v_add_u32 v17, s56, v3
    v_add_u32 v18, s56, v4
    v_lshrrev_b32 v12, 4, v0
    v_bfe_u32 v13, v0, 1, 1
    v_lshl_add_u32 v12, v12, 1, v13
    v_bfe_u32 v13, v0, 2, 2
    v_lshl_add_u32 v20, v12, 3, v13
    v_lshlrev_b32 v20, 7, v20
    v_and_b32 v12, 3, v12
    v_lshrrev_b32 v13, 1, v13
    v_lshl_add_u32 v12, v12, 1, v13
    v_xor_b32 v12, s3, v12
    v_lshl_add_u32 v20, v12, 4, v20
    v_and_b32 v12, 1, v0
    v_lshl_add_u32 v20, v12, 3, v20
    v_bfe_u32 v23, v0, 1, 3
    v_mul_u32_u24 v23, 144, v23
    v_bfe_u32 v12, v0, 4, 1
    v_lshl_add_u32 v23, v12, 3, v23
    v_lshrrev_b32 v12, 5, v0
    v_lshl_add_u32 v23, v12, 2, v23
    v_and_b32 v12, 1, v0
    v_lshl_add_u32 v23, v12, 1, v23
    s_lshl_b32 s56, s3, 4
    s_add_u32 s56, s56, 157952
    v_add_u32 v23, s56, v23
    v_and_b32 v24, 15, v0
    v_lshlrev_b32 v24, 3, v24
    s_mul_i32 s56, s3, 144
    s_add_u32 s56, s56, 157952
    v_add_u32 v24, s56, v24
    v_add_u32 v21, 32768, v20
    s_lshl_b32 s100, s3, 10
    s_waitcnt lgkmcnt(0)
    s_add_u32 s34, s34, 1
    s_lshl_b32 s101, s101, 8
    s_lshl_b32 s58, s3, 14
    s_add_u32 s101, s101, s58
    s_add_u32 s101, s101, 0x40000
    s_and_b32 s58, s64, 1
    s_mul_i32 s58, s58, 18432
    s_mul_i32 s59, s3, 2304
    s_add_u32 s58, s58, s59
    s_add_u32 s58, s58, 0x3000
    s_add_u32 s59, s58, 36864
    s_waitcnt vmcnt(5)
    s_add_u32 m0, s100, 8192
    s_add_u32 s56, s99, 524288
    buffer_load_dwordx4 v19, s[48:51], s56 offen nt lds
    s_waitcnt vmcnt(5)
    s_add_u32 s63, s69, 40960
    buffer_load_dwordx4 v[100:103], v1, s[40:43], s63 offen nt
    s_waitcnt vmcnt(5)
    s_add_u32 m0, s100, 16384
    s_add_u32 s56, s99, 1048576
    buffer_load_dwordx4 v19, s[48:51], s56 offen nt lds
    s_waitcnt vmcnt(5)
    s_add_u32 s63, s69, 49152
    buffer_load_dwordx4 v[128:131], v1, s[40:43], s63 offen nt
    v_lshlrev_b32 v236, 16, v246
    v_and_b32 v237, 0xffff0000, v246
    v_lshlrev_b32 v238, 16, v247
    v_and_b32 v239, 0xffff0000, v247
    v_lshlrev_b32 v240, 16, v248
    v_and_b32 v241, 0xffff0000, v248
    v_lshlrev_b32 v242, 16, v249
    v_and_b32 v243, 0xffff0000, v249
    v_lshlrev_b32 v244, 16, v250
    v_and_b32 v245, 0xffff0000, v250
    s_mov_b32 s56, 0x3f803f80
    v_dot2_f32_bf16 v10, v246, s56, 0
    v_dot2_f32_bf16 v11, v246, v246, 0
    v_dot2_f32_bf16 v10, v247, s56, v10
    v_dot2_f32_bf16 v11, v247, v247, v11
    v_dot2_f32_bf16 v10, v248, s56, v10
    v_dot2_f32_bf16 v11, v248, v248, v11
    v_dot2_f32_bf16 v10, v249, s56, v10
    v_dot2_f32_bf16 v11, v249, v249, v11
    s_mov_b64 exec, 0xffffffff
    v_dot2_f32_bf16 v10, v250, s56, v10
    v_dot2_f32_bf16 v11, v250, v250, v11
    s_mov_b64 exec, -1
    s_nop 1
    v_permlane32_swap_b32 v10, v11
    v_add_f32 v10, v10, v11
    v_mov_b32 v12, v10
    s_nop 1
    v_permlane16_swap_b32 v12, v10
    v_add_f32 v10, v12, v10
    s_nop 1
    v_add_f32_dpp v10, v10, v10 row_ror:8 row_mask:0xf bank_mask:0xf
    s_nop 1
    v_add_f32_dpp v10, v10, v10 row_ror:4 row_mask:0xf bank_mask:0xf
    s_nop 1
    v_add_f32_dpp v10, v10, v10 quad_perm:[2,3,0,1] row_mask:0xf bank_mask:0xf
    s_nop 1
    v_add_f32_dpp v10, v10, v10 quad_perm:[1,0,3,2] row_mask:0xf bank_mask:0xf
    v_mul_f32 v10, 0x3ae38e39, v10
    s_nop 0
    v_readlane_b32 s56, v10, 0
    v_readlane_b32 s57, v10, 32
    s_nop 0
    v_mov_b32 v10, s56
    v_fma_f32 v11, -v10, v10, s57
    v_max_f32 v11, 0, v11
    v_cvt_pk_bf16_f32 v12, -v10, v11
    v_and_b32 v13, 0xffff0000, v12
    v_add_f32 v13, 0x3727c5ac, v13
    v_lshlrev_b32 v10, 16, v12
    v_cvt_pk_bf16_f32 v13, v13, v13
    v_lshlrev_b32 v13, 16, v13
    v_sqrt_f32 v13, v13
    v_mov_b32 v11, v10
    v_cvt_pk_bf16_f32 v13, v13, v13
    v_lshlrev_b32 v13, 16, v13
    v_rcp_f32 v12, v13
    v_rcp_f32 v13, v13
    v_pk_add_f32 v[236:237], v[236:237], v[10:11]
    v_pk_add_f32 v[238:239], v[238:239], v[10:11]
    v_pk_add_f32 v[240:241], v[240:241], v[10:11]
    v_pk_add_f32 v[242:243], v[242:243], v[10:11]
    v_pk_add_f32 v[244:245], v[244:245], v[10:11]
    v_cvt_pk_bf16_f32 v236, v236, v237
    v_and_b32 v237, 0xffff0000, v236
    v_lshlrev_b32 v236, 16, v236
    v_cvt_pk_bf16_f32 v238, v238, v239
    v_and_b32 v239, 0xffff0000, v238
    v_lshlrev_b32 v238, 16, v238
    v_cvt_pk_bf16_f32 v240, v240, v241
    v_and_b32 v241, 0xffff0000, v240
    v_lshlrev_b32 v240, 16, v240
    v_cvt_pk_bf16_f32 v242, v242, v243
    v_and_b32 v243, 0xffff0000, v242
    v_lshlrev_b32 v242, 16, v242
    v_cvt_pk_bf16_f32 v244, v244, v245
    v_and_b32 v245, 0xffff0000, v244
    v_lshlrev_b32 v244, 16, v244
    v_pk_mul_f32 v[236:237], v[236:237], v[12:13]
    v_pk_mul_f32 v[238:239], v[238:239], v[12:13]
    v_pk_mul_f32 v[240:241], v[240:241], v[12:13]
    v_pk_mul_f32 v[242:243], v[242:243], v[12:13]
    v_pk_mul_f32 v[244:245], v[244:245], v[12:13]
    v_cvt_pk_bf16_f32 v236, v236, v237
    v_and_b32 v237, 0xffff0000, v236
    v_lshlrev_b32 v236, 16, v236
    v_cvt_pk_bf16_f32 v238, v238, v239
    v_and_b32 v239, 0xffff0000, v238
    v_lshlrev_b32 v238, 16, v238
    v_cvt_pk_bf16_f32 v240, v240, v241
    v_and_b32 v241, 0xffff0000, v240
    v_lshlrev_b32 v240, 16, v240
    v_cvt_pk_bf16_f32 v242, v242, v243
    v_and_b32 v243, 0xffff0000, v242
    v_lshlrev_b32 v242, 16, v242
    v_cvt_pk_bf16_f32 v244, v244, v245
    v_and_b32 v245, 0xffff0000, v244
    v_lshlrev_b32 v244, 16, v244
    s_waitcnt vmcnt(5)
    s_add_u32 m0, s100, 24576
    s_add_u32 s56, s99, 1572864
    buffer_load_dwordx4 v19, s[48:51], s56 offen nt lds
    s_waitcnt vmcnt(5)
    s_add_u32 s63, s69, 57344
    buffer_load_dwordx4 v[132:135], v1, s[40:43], s63 offen nt
    s_waitcnt vmcnt(5)
    s_add_u32 m0, s100, 32768
    s_add_u32 s56, s99, 2097152
    buffer_load_dwordx4 v19, s[48:51], s56 offen nt lds
    s_waitcnt vmcnt(5)
    s_add_u32 s63, s69, 131072
    buffer_load_dwordx4 v[40:43], v1, s[40:43], s63 offen nt
    s_waitcnt vmcnt(5)
    s_add_u32 m0, s100, 40960
    s_add_u32 s56, s99, 2621440
    buffer_load_dwordx4 v19, s[48:51], s56 offen nt lds
    s_waitcnt vmcnt(5)
    s_add_u32 s63, s69, 139264
    buffer_load_dwordx4 v[44:47], v1, s[40:43], s63 offen nt
    s_waitcnt vmcnt(5)
    s_add_u32 m0, s100, 49152
    s_add_u32 s56, s99, 3145728
    buffer_load_dwordx4 v19, s[48:51], s56 offen nt lds
    s_waitcnt vmcnt(5)
    s_add_u32 s63, s69, 147456
    buffer_load_dwordx4 v[72:75], v1, s[40:43], s63 offen nt
    s_waitcnt vmcnt(5)
    s_add_u32 m0, s100, 57344
    s_add_u32 s56, s99, 3670016
    buffer_load_dwordx4 v19, s[48:51], s56 offen nt lds
    s_waitcnt vmcnt(5)
    s_add_u32 s63, s69, 155648
    buffer_load_dwordx4 v[76:79], v1, s[40:43], s63 offen nt
    s_waitcnt vmcnt(5)
    s_add_u32 m0, s100, 65536
    s_add_u32 s56, s99, 4194304
    buffer_load_dwordx4 v19, s[48:51], s56 offen nt lds
    s_waitcnt vmcnt(5)
    s_add_u32 s63, s69, 163840
    buffer_load_dwordx4 v[104:107], v1, s[40:43], s63 offen nt
    s_waitcnt vmcnt(5)
    s_add_u32 s63, s69, 172032
    buffer_load_dwordx4 v[108:111], v1, s[40:43], s63 offen nt
    buffer_load_dwordx4 v[196:199], v2, s[36:39], s58 offen offset:0 sc1
    buffer_load_dwordx4 v[200:203], v2, s[36:39], s58 offen offset:1024 sc1
    buffer_load_dwordx2 v[204:205], v5, s[36:39], s58 offen offset:0 sc1
    buffer_load_dwordx4 v[206:209], v2, s[36:39], s59 offen offset:0 sc1
    buffer_load_dwordx4 v[210:213], v2, s[36:39], s59 offen offset:1024 sc1
    buffer_load_dwordx2 v[214:215], v5, s[36:39], s59 offen offset:0 sc1
    s_add_u32 s63, s69, 180224
    buffer_load_dwordx4 v[136:139], v1, s[40:43], s63 offen nt
    s_add_u32 s63, s69, 188416
    buffer_load_dwordx4 v[140:143], v1, s[40:43], s63 offen nt
    s_add_u32 s63, s69, 262144
    buffer_load_dwordx4 v[48:51], v1, s[40:43], s63 offen nt
    s_add_u32 s63, s69, 270336
    buffer_load_dwordx4 v[52:55], v1, s[40:43], s63 offen nt
    s_waitcnt vmcnt(12)
    s_barrier
    ds_read_b64_tr_b16 v[160:161], v20 offset:0
    ds_read_b64_tr_b16 v[162:163], v20 offset:512
    ds_read_b64_tr_b16 v[164:165], v20 offset:8192
    ds_read_b64_tr_b16 v[166:167], v20 offset:8704
    ds_read_b64_tr_b16 v[168:169], v20 offset:16384
    ds_read_b64_tr_b16 v[170:171], v20 offset:16896
    ds_read_b64_tr_b16 v[172:173], v20 offset:24576
    ds_read_b64_tr_b16 v[174:175], v20 offset:25088
    ds_read_b64_tr_b16 v[176:177], v21 offset:0
    ds_read_b64_tr_b16 v[178:179], v21 offset:512
    ds_read_b64_tr_b16 v[180:181], v21 offset:8192
    ds_read_b64_tr_b16 v[182:183], v21 offset:8704
    ds_read_b64_tr_b16 v[184:185], v21 offset:16384
    ds_read_b64_tr_b16 v[186:187], v21 offset:16896
    ds_read_b64_tr_b16 v[188:189], v21 offset:24576
    ds_read_b64_tr_b16 v[190:191], v21 offset:25088
    ds_read_b64_tr_b16 v[192:193], v21 offset:32768
    ds_read_b64_tr_b16 v[194:195], v21 offset:33280
    s_waitcnt vmcnt(4)
    s_branch .gpc_37
.gp_36:
    buffer_load_dwordx4 v[196:199], v2, s[36:39], s58 offen offset:0 sc1
    buffer_load_dwordx4 v[200:203], v2, s[36:39], s58 offen offset:1024 sc1
    buffer_load_dwordx2 v[204:205], v5, s[36:39], s58 offen offset:0 sc1
    buffer_load_dwordx4 v[206:209], v2, s[36:39], s59 offen offset:0 sc1
    buffer_load_dwordx4 v[210:213], v2, s[36:39], s59 offen offset:1024 sc1
    buffer_load_dwordx2 v[214:215], v5, s[36:39], s59 offen offset:0 sc1
    s_waitcnt vmcnt(0)
.gpc_37:
    v_min_u32 v10, v197, v199
    v_max_u32 v11, v197, v199
    v_min3_u32 v10, v10, v201, v203
    v_max3_u32 v11, v11, v201, v203
    v_min3_u32 v10, v10, v205, v207
    v_max3_u32 v11, v11, v205, v207
    v_min3_u32 v10, v10, v209, v211
    v_max3_u32 v11, v11, v209, v211
    v_min3_u32 v10, v10, v213, v215
    v_max3_u32 v11, v11, v213, v215
    v_cmp_eq_u32 vcc, s34, v10
    v_cmp_eq_u32 s[56:57], s34, v11
    s_and_b64 vcc, vcc, s[56:57]
    s_cmp_eq_u64 vcc, exec
    s_nop 2
    s_cbranch_scc1 .gpd_38
    s_sub_u32 s35, s35, 1
    s_cbranch_scc1 .Lexit
    s_branch .gp_36
.gpd_38:
    v_and_b32 v207, 0xffff0000, v206
    v_lshlrev_b32 v206, 16, v206
    v_and_b32 v209, 0xffff0000, v208
    v_lshlrev_b32 v208, 16, v208
    v_and_b32 v211, 0xffff0000, v210
    v_lshlrev_b32 v210, 16, v210
    v_and_b32 v213, 0xffff0000, v212
    v_lshlrev_b32 v212, 16, v212
    v_and_b32 v215, 0xffff0000, v214
    v_lshlrev_b32 v214, 16, v214
    v_and_b32 v197, 0xffff0000, v196
    v_lshlrev_b32 v196, 16, v196
    v_and_b32 v199, 0xffff0000, v198
    v_lshlrev_b32 v198, 16, v198
    v_and_b32 v201, 0xffff0000, v200
    v_lshlrev_b32 v200, 16, v200
    v_and_b32 v203, 0xffff0000, v202
    v_lshlrev_b32 v202, 16, v202
    v_and_b32 v205, 0xffff0000, v204
    v_lshlrev_b32 v204, 16, v204
    v_pk_mul_f32 v[236:237], v[236:237], v[206:207]
    v_pk_mul_f32 v[238:239], v[238:239], v[208:209]
    v_pk_mul_f32 v[240:241], v[240:241], v[210:211]
    v_pk_mul_f32 v[242:243], v[242:243], v[212:213]
    v_pk_mul_f32 v[244:245], v[244:245], v[214:215]
    v_cvt_pk_bf16_f32 v236, v236, v237
    v_and_b32 v237, 0xffff0000, v236
    v_lshlrev_b32 v236, 16, v236
    v_cvt_pk_bf16_f32 v238, v238, v239
    v_and_b32 v239, 0xffff0000, v238
    v_lshlrev_b32 v238, 16, v238
    v_cvt_pk_bf16_f32 v240, v240, v241
    v_and_b32 v241, 0xffff0000, v240
    v_lshlrev_b32 v240, 16, v240
    v_cvt_pk_bf16_f32 v242, v242, v243
    v_and_b32 v243, 0xffff0000, v242
    v_lshlrev_b32 v242, 16, v242
    v_cvt_pk_bf16_f32 v244, v244, v245
    v_and_b32 v245, 0xffff0000, v244
    v_lshlrev_b32 v244, 16, v244
    v_pk_add_f32 v[236:237], v[236:237], v[196:197]
    v_pk_add_f32 v[238:239], v[238:239], v[198:199]
    v_pk_add_f32 v[240:241], v[240:241], v[200:201]
    v_pk_add_f32 v[242:243], v[242:243], v[202:203]
    v_pk_add_f32 v[244:245], v[244:245], v[204:205]
    v_cvt_pk_bf16_f32 v246, v236, v237
    v_cvt_pk_bf16_f32 v247, v238, v239
    v_cvt_pk_bf16_f32 v248, v240, v241
    v_cvt_pk_bf16_f32 v249, v242, v243
    v_cvt_pk_bf16_f32 v250, v244, v245
    ds_write_b64 v17, v[246:247]
    ds_write_b64 v17, v[248:249] offset:512
    ds_write_b32 v18, v250
    s_waitcnt lgkmcnt(0)
    s_barrier
    ds_read_b128 v[196:199], v16 offset:0
    ds_read_b128 v[200:203], v16 offset:128
    ds_read_b128 v[204:207], v16 offset:256
    ds_read_b128 v[208:211], v16 offset:384
    ds_read_b128 v[212:215], v16 offset:512
    ds_read_b128 v[216:219], v16 offset:640
    ds_read_b128 v[220:223], v16 offset:768
    ds_read_b128 v[224:227], v16 offset:896
    ds_read_b128 v[228:231], v16 offset:1024
    s_waitcnt lgkmcnt(8)
    v_mfma_f32_16x16x32_bf16 v[232:235], v[160:163], v[196:199], 0
    s_waitcnt lgkmcnt(7)
    v_mfma_f32_16x16x32_bf16 v[232:235], v[164:167], v[200:203], v[232:235]
    s_waitcnt lgkmcnt(6)
    v_mfma_f32_16x16x32_bf16 v[232:235], v[168:171], v[204:207], v[232:235]
    s_waitcnt lgkmcnt(5)
    v_mfma_f32_16x16x32_bf16 v[232:235], v[172:175], v[208:211], v[232:235]
    s_waitcnt lgkmcnt(4)
    v_mfma_f32_16x16x32_bf16 v[232:235], v[176:179], v[212:215], v[232:235]
    s_waitcnt lgkmcnt(3)
    v_mfma_f32_16x16x32_bf16 v[232:235], v[180:183], v[216:219], v[232:235]
    s_waitcnt lgkmcnt(2)
    v_mfma_f32_16x16x32_bf16 v[232:235], v[184:187], v[220:223], v[232:235]
    s_waitcnt lgkmcnt(1)
    v_mfma_f32_16x16x32_bf16 v[232:235], v[188:191], v[224:227], v[232:235]
    s_waitcnt lgkmcnt(0)
    v_mfma_f32_16x16x32_bf16 v[232:235], v[192:195], v[228:231], v[232:235]
    s_nop 7
    v_permlane32_swap_b32 v232, v234
    v_permlane32_swap_b32 v233, v235
    v_cndmask_b32 v233, v233, v234, s[96:97]
    v_cndmask_b32 v232, v232, v235, s[96:97]
    s_nop 1
    v_add_f32_dpp v236, v233, v232 quad_perm:[1,0,3,2] row_mask:0xf bank_mask:0xf
    v_cvt_pk_bf16_f32 v236, v236, v236
    ds_write_b16 v23, v236
    v_mov_b32 v243, s34
    s_waitcnt lgkmcnt(0)
    s_barrier
    ds_read2_b32 v[244:245], v24 offset1:1
    v_mov_b32 v241, s34
    s_waitcnt lgkmcnt(0)
    v_mov_b32 v240, v244
    v_mov_b32 v242, v245
    s_mov_b64 exec, 0xffff
    buffer_store_dwordx4 v[240:243], v2, s[36:39], s101 offen sc1
    s_mov_b64 exec, -1
.Lq_done:
    s_waitcnt vmcnt(3)
    s_bitcmp1_b64 s[14:15], 18
    s_cbranch_scc0 1
    s_waitcnt vmcnt(2)
    s_add_u32 s63, s69, 278528
    buffer_load_dwordx4 v[80:83], v1, s[40:43], s63 offen nt
    v_and_b32 v157, 7, v0
    v_lshlrev_b32 v157, 7, v157
    s_mov_b32 s63, 0x400
    buffer_load_dword v156, v157, s[36:39], s63 offen
    s_memrealtime s[8:9]
    s_waitcnt lgkmcnt(0)
    s_sub_u32 s8, s8, s30
    s_cmpk_ge_u32 s8, 850
    s_cbranch_scc1 .ap_39
    s_waitcnt vmcnt(5)
    s_cmpk_ge_u32 s8, 785
    s_cbranch_scc1 .ap_39
    s_waitcnt vmcnt(4)
    s_bitcmp1_b64 s[14:15], 19
    s_cbranch_scc0 1
    s_waitcnt vmcnt(3)
    s_cmpk_ge_u32 s8, 710
    s_cbranch_scc1 .ap_39
    s_waitcnt vmcnt(2)
.ap_39:
    s_add_u32 s63, s69, 286720
    buffer_load_dwordx4 v[84:87], v1, s[40:43], s63 offen nt
    s_memrealtime s[8:9]
    s_waitcnt lgkmcnt(0)
    s_sub_u32 s8, s8, s30
    s_cmpk_ge_u32 s8, 895
    s_cbranch_scc1 .ap_40
    s_waitcnt vmcnt(6)
    s_cmpk_ge_u32 s8, 830
    s_cbranch_scc1 .ap_40
    s_waitcnt vmcnt(4)
    s_bitcmp1_b64 s[14:15], 20
    s_cbranch_scc0 1
    s_waitcnt vmcnt(3)
    s_cmpk_ge_u32 s8, 755
    s_cbranch_scc1 .ap_40
    s_waitcnt vmcnt(2)
.ap_40:
    s_add_u32 s63, s69, 294912
    buffer_load_dwordx4 v[112:115], v1, s[40:43], s63 offen nt
    s_memrealtime s[8:9]
    s_waitcnt lgkmcnt(0)
    s_sub_u32 s8, s8, s30
    s_cmpk_ge_u32 s8, 940
    s_cbranch_scc1 .ap_41
    s_waitcnt vmcnt(6)
    s_cmpk_ge_u32 s8, 875
    s_cbranch_scc1 .ap_41
    s_waitcnt vmcnt(4)
    s_bitcmp1_b64 s[14:15], 21
    s_cbranch_scc0 1
    s_waitcnt vmcnt(3)
    s_cmpk_ge_u32 s8, 800
    s_cbranch_scc1 .ap_41
    s_waitcnt vmcnt(1)
.ap_41:
    s_add_u32 s63, s69, 303104
    buffer_load_dwordx4 v[116:119], v1, s[40:43], s63 offen nt
    s_memrealtime s[8:9]
    s_waitcnt lgkmcnt(0)
    s_sub_u32 s8, s8, s30
    s_cmpk_ge_u32 s8, 985
    s_cbranch_scc1 .ap_42
    s_waitcnt vmcnt(6)
    s_cmpk_ge_u32 s8, 920
    s_cbranch_scc1 .ap_42
    s_waitcnt vmcnt(4)
    s_bitcmp1_b64 s[14:15], 22
    s_cbranch_scc0 1
    s_waitcnt vmcnt(2)
    s_cmpk_ge_u32 s8, 845
    s_cbranch_scc1 .ap_42
    s_waitcnt vmcnt(1)
.ap_42:
    s_add_u32 s63, s69, 311296
    buffer_load_dwordx4 v[144:147], v1, s[40:43], s63 offen nt
    s_waitcnt vmcnt(4)
    s_sub_u32 s63, s70, 300
    v_subrev_u32 v156, s63, v156
    v_mov_b32 v157, 600
    v_cmp_lt_u32 s[8:9], v156, v157
    v_add_u32_dpp v156, v156, v156 quad_perm:[1,0,3,2] row_mask:0xf bank_mask:0xf
    s_nop 1
    v_add_u32_dpp v156, v156, v156 quad_perm:[2,3,0,1] row_mask:0xf bank_mask:0xf
    s_nop 1
    v_add_u32_dpp v156, v156, v156 row_ror:4 row_mask:0xf bank_mask:0xf
    s_nop 0
    v_readfirstlane_b32 s63, v156
    s_cmp_eq_u64 s[8:9], -1
    s_nop 3
    s_cbranch_scc0 .et_43
    s_lshr_b32 s63, s63, 3
    s_sub_u32 s63, s63, 300
    s_add_u32 s30, s30, s63
.et_43:
    s_memrealtime s[8:9]
    s_waitcnt lgkmcnt(0)
    s_sub_u32 s8, s8, s30
    s_cmpk_ge_u32 s8, 1030
    s_cbranch_scc1 .ap_44
    s_waitcnt vmcnt(4)
    s_cmpk_ge_u32 s8, 965
    s_cbranch_scc1 .ap_44
    s_waitcnt vmcnt(3)
    s_bitcmp1_b64 s[14:15], 23
    s_cbranch_scc0 1
    s_waitcnt vmcnt(2)
    s_cmpk_ge_u32 s8, 890
    s_cbranch_scc1 .ap_44
    s_waitcnt vmcnt(1)
.ap_44:
    s_add_u32 s63, s69, 319488
    buffer_load_dwordx4 v[148:151], v1, s[40:43], s63 offen nt
    s_memrealtime s[8:9]
    s_waitcnt lgkmcnt(0)
    s_sub_u32 s8, s8, s30
    s_cmpk_ge_u32 s8, 1075
    s_cbranch_scc1 .ap_45
    s_waitcnt vmcnt(5)
    s_cmpk_ge_u32 s8, 1010
    s_cbranch_scc1 .ap_45
    s_waitcnt vmcnt(3)
    s_bitcmp1_b64 s[14:15], 24
    s_cbranch_scc0 1
    s_waitcnt vmcnt(2)
    s_cmpk_ge_u32 s8, 935
    s_cbranch_scc1 .ap_45
    s_waitcnt vmcnt(1)
.ap_45:
    s_add_u32 s63, s69, 393216
    buffer_load_dwordx4 v[56:59], v1, s[40:43], s63 offen nt
    s_memrealtime s[8:9]
    s_waitcnt lgkmcnt(0)
    s_sub_u32 s8, s8, s30
    s_cmpk_ge_u32 s8, 1120
    s_cbranch_scc1 .ap_46
    s_waitcnt vmcnt(5)
    s_cmpk_ge_u32 s8, 1055
    s_cbranch_scc1 .ap_46
    s_waitcnt vmcnt(3)
    s_bitcmp1_b64 s[14:15], 25
    s_cbranch_scc0 1
    s_waitcnt vmcnt(2)
    s_cmpk_ge_u32 s8, 980
    s_cbranch_scc1 .ap_46
    s_waitcnt vmcnt(1)
.ap_46:
    s_add_u32 s63, s69, 401408
    buffer_load_dwordx4 v[60:63], v1, s[40:43], s63 offen nt
    s_cmp_lt_u32 s2, 216
    s_cbranch_scc1 .Latt_bc
    s_branch .Latt_n
.Le_a:
    s_mov_b32 s14, 0x6ddb76dd
    s_mov_b32 s15, 0xdb76ddb7
    s_add_u32 s30, s70, -60
    s_mov_b32 s48, s12
    s_and_b32 s49, s13, 0xffff
    s_mov_b32 s50, 0x480000
    s_mov_b32 s51, 0x00020000
    v_bfe_u32 v12, v0, 4, 1
    s_and_b32 s56, s3, 1
    s_lshl_b32 s56, s56, 2
    v_lshl_or_b32 v12, v12, 1, s56
    v_and_b32 v13, 7, v0
    v_xor_b32 v12, v12, v13
    v_lshrrev_b32 v13, 3, v0
    v_mul_u32_u24 v13, 1152, v13
    v_lshl_add_u32 v6, v12, 4, v13
    s_lshl_b32 s101, s64, 6
    s_add_u32 s101, s101, s3
    s_mul_i32 s101, s101, 9216
    s_lshl_b32 s56, s65, 7
    s_add_u32 s101, s101, s56
    s_lshl_b32 s100, s3, 10
    s_waitcnt vmcnt(3)
    s_add_u32 m0, s100, 0
    s_add_u32 s56, s101, 0
    buffer_load_dwordx4 v6, s[48:51], s56 offen nt lds
    s_waitcnt vmcnt(3)
    s_bitcmp1_b64 s[14:15], 4
    s_cbranch_scc0 1
    s_waitcnt vmcnt(2)
    s_add_u32 s63, s69, 32768
    buffer_load_dwordx4 v[96:99], v1, s[40:43], s63 offen nt
    s_waitcnt vmcnt(3)
    s_add_u32 m0, s100, 8192
    s_add_u32 s56, s101, 73728
    buffer_load_dwordx4 v6, s[48:51], s56 offen nt lds
    s_waitcnt vmcnt(3)
    s_bitcmp1_b64 s[14:15], 5
    s_cbranch_scc0 1
    s_waitcnt vmcnt(2)
    s_add_u32 s63, s69, 40960
    buffer_load_dwordx4 v[100:103], v1, s[40:43], s63 offen nt
    s_waitcnt vmcnt(3)
    s_bitcmp1_b64 s[14:15], 6
    s_cbranch_scc0 1
    s_waitcnt vmcnt(2)
    s_add_u32 s63, s69, 49152
    buffer_load_dwordx4 v[128:131], v1, s[40:43], s63 offen nt
    s_waitcnt vmcnt(3)
    s_bitcmp1_b64 s[14:15], 7
    s_cbranch_scc0 1
    s_waitcnt vmcnt(2)
    s_add_u32 s63, s69, 57344
    buffer_load_dwordx4 v[132:135], v1, s[40:43], s63 offen nt
    s_waitcnt vmcnt(3)
    s_add_u32 m0, s100, 16384
    s_add_u32 s56, s101, 147456
    buffer_load_dwordx4 v6, s[48:51], s56 offen nt lds
    s_waitcnt vmcnt(3)
    s_bitcmp1_b64 s[14:15], 8
    s_cbranch_scc0 1
    s_waitcnt vmcnt(2)
    s_add_u32 s63, s69, 131072
    buffer_load_dwordx4 v[40:43], v1, s[40:43], s63 offen nt
    s_waitcnt vmcnt(3)
    s_bitcmp1_b64 s[14:15], 9
    s_cbranch_scc0 1
    s_waitcnt vmcnt(2)
    s_add_u32 s63, s69, 139264
    buffer_load_dwordx4 v[44:47], v1, s[40:43], s63 offen nt
    s_memrealtime s[8:9]
    s_waitcnt lgkmcnt(0)
    s_sub_u32 s8, s8, s30
    s_cmpk_ge_u32 s8, 436
    s_cbranch_scc1 .ap_47
    s_waitcnt vmcnt(4)
    s_cmpk_ge_u32 s8, 371
    s_cbranch_scc1 .ap_47
    s_waitcnt vmcnt(3)
    s_bitcmp1_b64 s[14:15], 10
    s_cbranch_scc0 1
    s_waitcnt vmcnt(2)
    s_cmpk_ge_u32 s8, 296
    s_cbranch_scc1 .ap_47
    s_waitcnt vmcnt(1)
.ap_47:
    s_add_u32 s63, s69, 147456
    buffer_load_dwordx4 v[72:75], v1, s[40:43], s63 offen nt
    s_waitcnt vmcnt(3)
    s_add_u32 m0, s100, 24576
    s_add_u32 s56, s101, 221184
    buffer_load_dwordx4 v6, s[48:51], s56 offen nt lds
    s_memrealtime s[8:9]
    s_waitcnt lgkmcnt(0)
    s_sub_u32 s8, s8, s30
    s_cmpk_ge_u32 s8, 482
    s_cbranch_scc1 .ap_48
    s_waitcnt vmcnt(4)
    s_cmpk_ge_u32 s8, 417
    s_cbranch_scc1 .ap_48
    s_waitcnt vmcnt(3)
    s_bitcmp1_b64 s[14:15], 11
    s_cbranch_scc0 1
    s_waitcnt vmcnt(2)
    s_cmpk_ge_u32 s8, 342
    s_cbranch_scc1 .ap_48
    s_waitcnt vmcnt(1)
.ap_48:
    s_add_u32 s63, s69, 155648
    buffer_load_dwordx4 v[76:79], v1, s[40:43], s63 offen nt
    s_waitcnt lgkmcnt(0)
    s_add_u32 s34, s34, 1
    s_memrealtime s[8:9]
    s_waitcnt lgkmcnt(0)
    s_sub_u32 s8, s8, s30
    s_cmpk_ge_u32 s8, 528
    s_cbranch_scc1 .ap_49
    s_waitcnt vmcnt(5)
    s_cmpk_ge_u32 s8, 463
    s_cbranch_scc1 .ap_49
    s_waitcnt vmcnt(3)
    s_bitcmp1_b64 s[14:15], 12
    s_cbranch_scc0 1
    s_waitcnt vmcnt(2)
    s_cmpk_ge_u32 s8, 388
    s_cbranch_scc1 .ap_49
    s_waitcnt vmcnt(1)
.ap_49:
    s_add_u32 s63, s69, 163840
    buffer_load_dwordx4 v[104:107], v1, s[40:43], s63 offen nt
    s_memrealtime s[8:9]
    s_waitcnt lgkmcnt(0)
    s_sub_u32 s8, s8, s30
    s_cmpk_ge_u32 s8, 574
    s_cbranch_scc1 .ap_50
    s_waitcnt vmcnt(5)
    s_cmpk_ge_u32 s8, 509
    s_cbranch_scc1 .ap_50
    s_waitcnt vmcnt(3)
    s_bitcmp1_b64 s[14:15], 13
    s_cbranch_scc0 1
    s_waitcnt vmcnt(2)
    s_cmpk_ge_u32 s8, 434
    s_cbranch_scc1 .ap_50
    s_waitcnt vmcnt(1)
.ap_50:
    s_add_u32 s63, s69, 172032
    buffer_load_dwordx4 v[108:111], v1, s[40:43], s63 offen nt
    s_waitcnt vmcnt(3)
    s_add_u32 m0, s100, 32768
    s_add_u32 s56, s101, 294912
    buffer_load_dwordx4 v6, s[48:51], s56 offen nt lds
    s_memrealtime s[8:9]
    s_waitcnt lgkmcnt(0)
    s_sub_u32 s8, s8, s30
    s_cmpk_ge_u32 s8, 620
    s_cbranch_scc1 .ap_51
    s_waitcnt vmcnt(4)
    s_cmpk_ge_u32 s8, 555
    s_cbranch_scc1 .ap_51
    s_waitcnt vmcnt(3)
    s_bitcmp1_b64 s[14:15], 14
    s_cbranch_scc0 1
    s_waitcnt vmcnt(2)
    s_cmpk_ge_u32 s8, 480
    s_cbranch_scc1 .ap_51
    s_waitcnt vmcnt(1)
.ap_51:
    s_add_u32 s63, s69, 180224
    buffer_load_dwordx4 v[136:139], v1, s[40:43], s63 offen nt
    s_memrealtime s[8:9]
    s_waitcnt lgkmcnt(0)
    s_sub_u32 s8, s8, s30
    s_cmpk_ge_u32 s8, 666
    s_cbranch_scc1 .ap_52
    s_waitcnt vmcnt(5)
    s_cmpk_ge_u32 s8, 601
    s_cbranch_scc1 .ap_52
    s_waitcnt vmcnt(3)
    s_bitcmp1_b64 s[14:15], 15
    s_cbranch_scc0 1
    s_waitcnt vmcnt(2)
    s_cmpk_ge_u32 s8, 526
    s_cbranch_scc1 .ap_52
    s_waitcnt vmcnt(1)
.ap_52:
    s_add_u32 s63, s69, 188416
    buffer_load_dwordx4 v[140:143], v1, s[40:43], s63 offen nt
    s_memrealtime s[8:9]
    s_waitcnt lgkmcnt(0)
    s_sub_u32 s8, s8, s30
    s_cmpk_ge_u32 s8, 712
    s_cbranch_scc1 .ap_53
    s_waitcnt vmcnt(5)
    s_cmpk_ge_u32 s8, 647
    s_cbranch_scc1 .ap_53
    s_waitcnt vmcnt(3)
    s_bitcmp1_b64 s[14:15], 16
    s_cbranch_scc0 1
    s_waitcnt vmcnt(2)
    s_cmpk_ge_u32 s8, 572
    s_cbranch_scc1 .ap_53
    s_waitcnt vmcnt(1)
.ap_53:
    s_add_u32 s63, s69, 262144
    buffer_load_dwordx4 v[48:51], v1, s[40:43], s63 offen nt
    s_waitcnt vmcnt(3)
    s_add_u32 m0, s100, 40960
    s_add_u32 s56, s101, 368640
    buffer_load_dwordx4 v6, s[48:51], s56 offen nt lds
    s_memrealtime s[8:9]
    s_waitcnt lgkmcnt(0)
    s_sub_u32 s8, s8, s30
    s_cmpk_ge_u32 s8, 758
    s_cbranch_scc1 .ap_54
    s_waitcnt vmcnt(4)
    s_cmpk_ge_u32 s8, 693
    s_cbranch_scc1 .ap_54
    s_waitcnt vmcnt(3)
    s_bitcmp1_b64 s[14:15], 17
    s_cbranch_scc0 1
    s_waitcnt vmcnt(2)
    s_cmpk_ge_u32 s8, 618
    s_cbranch_scc1 .ap_54
    s_waitcnt vmcnt(1)
.ap_54:
    s_add_u32 s63, s69, 270336
    buffer_load_dwordx4 v[52:55], v1, s[40:43], s63 offen nt
    s_memrealtime s[8:9]
    s_waitcnt lgkmcnt(0)
    s_sub_u32 s8, s8, s30
    s_cmpk_ge_u32 s8, 804
    s_cbranch_scc1 .ap_55
    s_waitcnt vmcnt(5)
    s_cmpk_ge_u32 s8, 739
    s_cbranch_scc1 .ap_55
    s_waitcnt vmcnt(3)
    s_bitcmp1_b64 s[14:15], 18
    s_cbranch_scc0 1
    s_waitcnt vmcnt(2)
    s_cmpk_ge_u32 s8, 664
    s_cbranch_scc1 .ap_55
    s_waitcnt vmcnt(1)
.ap_55:
    s_add_u32 s63, s69, 278528
    buffer_load_dwordx4 v[80:83], v1, s[40:43], s63 offen nt
    v_and_b32 v157, 7, v0
    v_lshlrev_b32 v157, 7, v157
    s_mov_b32 s63, 0x400
    buffer_load_dword v156, v157, s[36:39], s63 offen
    s_memrealtime s[8:9]
    s_waitcnt lgkmcnt(0)
    s_sub_u32 s8, s8, s30
    s_cmpk_ge_u32 s8, 850
    s_cbranch_scc1 .ap_56
    s_waitcnt vmcnt(6)
    s_cmpk_ge_u32 s8, 785
    s_cbranch_scc1 .ap_56
    s_waitcnt vmcnt(4)
    s_bitcmp1_b64 s[14:15], 19
    s_cbranch_scc0 1
    s_waitcnt vmcnt(3)
    s_cmpk_ge_u32 s8, 710
    s_cbranch_scc1 .ap_56
    s_waitcnt vmcnt(2)
.ap_56:
    s_add_u32 s63, s69, 286720
    buffer_load_dwordx4 v[84:87], v1, s[40:43], s63 offen nt
    s_waitcnt vmcnt(4)
    s_add_u32 m0, s100, 49152
    s_add_u32 s56, s101, 442368
    buffer_load_dwordx4 v6, s[48:51], s56 offen nt lds
    s_memrealtime s[8:9]
    s_waitcnt lgkmcnt(0)
    s_sub_u32 s8, s8, s30
    s_cmpk_ge_u32 s8, 895
    s_cbranch_scc1 .ap_57
    s_waitcnt vmcnt(5)
    s_cmpk_ge_u32 s8, 830
    s_cbranch_scc1 .ap_57
    s_waitcnt vmcnt(4)
    s_bitcmp1_b64 s[14:15], 20
    s_cbranch_scc0 1
    s_waitcnt vmcnt(3)
    s_cmpk_ge_u32 s8, 755
    s_cbranch_scc1 .ap_57
    s_waitcnt vmcnt(1)
.ap_57:
    s_add_u32 s63, s69, 294912
    buffer_load_dwordx4 v[112:115], v1, s[40:43], s63 offen nt
    s_memrealtime s[8:9]
    s_waitcnt lgkmcnt(0)
    s_sub_u32 s8, s8, s30
    s_cmpk_ge_u32 s8, 940
    s_cbranch_scc1 .ap_58
    s_waitcnt vmcnt(6)
    s_cmpk_ge_u32 s8, 875
    s_cbranch_scc1 .ap_58
    s_waitcnt vmcnt(4)
    s_bitcmp1_b64 s[14:15], 21
    s_cbranch_scc0 1
    s_waitcnt vmcnt(2)
    s_cmpk_ge_u32 s8, 800
    s_cbranch_scc1 .ap_58
    s_waitcnt vmcnt(1)
.ap_58:
    s_add_u32 s63, s69, 303104
    buffer_load_dwordx4 v[116:119], v1, s[40:43], s63 offen nt
    s_memrealtime s[8:9]
    s_waitcnt lgkmcnt(0)
    s_sub_u32 s8, s8, s30
    s_cmpk_ge_u32 s8, 985
    s_cbranch_scc1 .ap_59
    s_waitcnt vmcnt(6)
    s_cmpk_ge_u32 s8, 920
    s_cbranch_scc1 .ap_59
    s_waitcnt vmcnt(3)
    s_bitcmp1_b64 s[14:15], 22
    s_cbranch_scc0 1
    s_waitcnt vmcnt(2)
    s_cmpk_ge_u32 s8, 845
    s_cbranch_scc1 .ap_59
    s_waitcnt vmcnt(1)
.ap_59:
    s_add_u32 s63, s69, 311296
    buffer_load_dwordx4 v[144:147], v1, s[40:43], s63 offen nt
    s_waitcnt vmcnt(5)
    s_sub_u32 s63, s70, 300
    v_subrev_u32 v156, s63, v156
    v_mov_b32 v157, 600
    v_cmp_lt_u32 s[8:9], v156, v157
    v_add_u32_dpp v156, v156, v156 quad_perm:[1,0,3,2] row_mask:0xf bank_mask:0xf
    s_nop 1
    v_add_u32_dpp v156, v156, v156 quad_perm:[2,3,0,1] row_mask:0xf bank_mask:0xf
    s_nop 1
    v_add_u32_dpp v156, v156, v156 row_ror:4 row_mask:0xf bank_mask:0xf
    s_nop 0
    v_readfirstlane_b32 s63, v156
    s_cmp_eq_u64 s[8:9], -1
    s_nop 3
    s_cbranch_scc0 .et_60
    s_lshr_b32 s63, s63, 3
    s_sub_u32 s63, s63, 300
    s_add_u32 s30, s30, s63
.et_60:
    s_waitcnt vmcnt(3)
    s_add_u32 m0, s100, 57344
    s_add_u32 s56, s101, 516096
    buffer_load_dwordx4 v6, s[48:51], s56 offen nt lds
    s_memrealtime s[8:9]
    s_waitcnt lgkmcnt(0)
    s_sub_u32 s8, s8, s30
    s_cmpk_ge_u32 s8, 1030
    s_cbranch_scc1 .ap_61
    s_waitcnt vmcnt(4)
    s_cmpk_ge_u32 s8, 965
    s_cbranch_scc1 .ap_61
    s_waitcnt vmcnt(3)
    s_bitcmp1_b64 s[14:15], 23
    s_cbranch_scc0 1
    s_waitcnt vmcnt(2)
    s_cmpk_ge_u32 s8, 890
    s_cbranch_scc1 .ap_61
    s_waitcnt vmcnt(1)
.ap_61:
    s_add_u32 s63, s69, 319488
    buffer_load_dwordx4 v[148:151], v1, s[40:43], s63 offen nt
    s_memrealtime s[8:9]
    s_waitcnt lgkmcnt(0)
    s_sub_u32 s8, s8, s30
    s_cmpk_ge_u32 s8, 1075
    s_cbranch_scc1 .ap_62
    s_waitcnt vmcnt(5)
    s_cmpk_ge_u32 s8, 1010
    s_cbranch_scc1 .ap_62
    s_waitcnt vmcnt(3)
    s_bitcmp1_b64 s[14:15], 24
    s_cbranch_scc0 1
    s_waitcnt vmcnt(2)
    s_cmpk_ge_u32 s8, 935
    s_cbranch_scc1 .ap_62
    s_waitcnt vmcnt(1)
.ap_62:
    s_add_u32 s63, s69, 393216
    buffer_load_dwordx4 v[56:59], v1, s[40:43], s63 offen nt
    s_memrealtime s[8:9]
    s_waitcnt lgkmcnt(0)
    s_sub_u32 s8, s8, s30
    s_cmpk_ge_u32 s8, 1120
    s_cbranch_scc1 .ap_63
    s_waitcnt vmcnt(5)
    s_cmpk_ge_u32 s8, 1055
    s_cbranch_scc1 .ap_63
    s_waitcnt vmcnt(3)
    s_bitcmp1_b64 s[14:15], 25
    s_cbranch_scc0 1
    s_waitcnt vmcnt(2)
    s_cmpk_ge_u32 s8, 980
    s_cbranch_scc1 .ap_63
    s_waitcnt vmcnt(1)
.ap_63:
    s_add_u32 s63, s69, 401408
    buffer_load_dwordx4 v[60:63], v1, s[40:43], s63 offen nt
.Latt_ar:
    v_and_b32 v8, 1, v0
    v_lshlrev_b32 v8, 8, v8
    v_and_b32 v9, 0x3c, v0
    v_lshl_add_u32 v9, v9, 2, v8
    v_lshlrev_b32 v7, 1, v9
    v_and_b32 v9, 0x3c, v0
    v_lshrrev_b32 v8, 4, v8
    v_and_b32 v9, 2, v0
    v_lshl_add_u32 v9, v9, 6, v8
    s_lshl_b32 s58, s66, 14
    s_lshl_b32 s59, s67, 10
    s_add_u32 s58, s58, s59
    s_add_u32 s58, s58, 0x40000
    s_lshl4_add_u32 s59, s66, s67
    s_lshl_b32 s59, s59, 8
    s_add_u32 s59, s59, 0x200000
    s_memrealtime s[8:9]
    s_waitcnt vmcnt(8)
    s_waitcnt lgkmcnt(0)
    s_sub_u32 s8, s8, s30
    s_cmpk_ge_u32 s8, 1147
    s_cbranch_scc1 .ap_64
    s_waitcnt vmcnt(5)
    s_cmpk_ge_u32 s8, 1082
    s_cbranch_scc1 .ap_64
    s_waitcnt vmcnt(3)
    s_bitcmp1_b64 s[14:15], 26
    s_cbranch_scc0 1
    s_waitcnt vmcnt(2)
    s_cmpk_ge_u32 s8, 1007
    s_cbranch_scc1 .ap_64
    s_waitcnt vmcnt(1)
.ap_64:
    s_add_u32 s63, s69, 409600
    buffer_load_dwordx4 v[88:91], v1, s[40:43], s63 offen nt
    s_memrealtime s[8:9]
    s_waitcnt vmcnt(8)
    s_waitcnt lgkmcnt(0)
    s_sub_u32 s8, s8, s30
    s_cmpk_ge_u32 s8, 1174
    s_cbranch_scc1 .ap_65
    s_waitcnt vmcnt(5)
    s_cmpk_ge_u32 s8, 1109
    s_cbranch_scc1 .ap_65
    s_waitcnt vmcnt(3)
    s_bitcmp1_b64 s[14:15], 27
    s_cbranch_scc0 1
    s_waitcnt vmcnt(2)
    s_cmpk_ge_u32 s8, 1034
    s_cbranch_scc1 .ap_65
    s_waitcnt vmcnt(1)
.ap_65:
    s_add_u32 s63, s69, 417792
    buffer_load_dwordx4 v[92:95], v1, s[40:43], s63 offen nt
    s_memrealtime s[8:9]
    s_waitcnt vmcnt(8)
    s_waitcnt lgkmcnt(0)
    s_sub_u32 s8, s8, s30
    s_cmpk_ge_u32 s8, 1201
    s_cbranch_scc1 .ap_66
    s_waitcnt vmcnt(5)
    s_cmpk_ge_u32 s8, 1136
    s_cbranch_scc1 .ap_66
    s_waitcnt vmcnt(3)
    s_bitcmp1_b64 s[14:15], 28
    s_cbranch_scc0 1
    s_waitcnt vmcnt(2)
    s_cmpk_ge_u32 s8, 1061
    s_cbranch_scc1 .ap_66
    s_waitcnt vmcnt(1)
.ap_66:
    s_add_u32 s63, s69, 425984
    buffer_load_dwordx4 v[120:123], v1, s[40:43], s63 offen nt
    s_memrealtime s[8:9]
    s_waitcnt vmcnt(8)
    s_waitcnt lgkmcnt(0)
    s_sub_u32 s8, s8, s30
    s_cmpk_ge_u32 s8, 1228
    s_cbranch_scc1 .ap_67
    s_waitcnt vmcnt(5)
    s_cmpk_ge_u32 s8, 1163
    s_cbranch_scc1 .ap_67
    s_waitcnt vmcnt(3)
    s_bitcmp1_b64 s[14:15], 29
    s_cbranch_scc0 1
    s_waitcnt vmcnt(2)
    s_cmpk_ge_u32 s8, 1088
    s_cbranch_scc1 .ap_67
    s_waitcnt vmcnt(1)
.ap_67:
    s_add_u32 s63, s69, 434176
    buffer_load_dwordx4 v[124:127], v1, s[40:43], s63 offen nt
    s_memrealtime s[8:9]
    s_waitcnt vmcnt(8)
    s_waitcnt lgkmcnt(0)
    s_sub_u32 s8, s8, s30
    s_cmpk_ge_u32 s8, 1255
    s_cbranch_scc1 .ap_68
    s_waitcnt vmcnt(5)
    s_cmpk_ge_u32 s8, 1190
    s_cbranch_scc1 .ap_68
    s_waitcnt vmcnt(3)
    s_bitcmp1_b64 s[14:15], 30
    s_cbranch_scc0 1
    s_waitcnt vmcnt(2)
    s_cmpk_ge_u32 s8, 1115
    s_cbranch_scc1 .ap_68
    s_waitcnt vmcnt(1)
.ap_68:
    s_add_u32 s63, s69, 442368
    buffer_load_dwordx4 v[152:155], v1, s[40:43], s63 offen nt
    s_memrealtime s[8:9]
    s_waitcnt vmcnt(8)
    s_waitcnt lgkmcnt(0)
    s_sub_u32 s8, s8, s30
    s_cmpk_ge_u32 s8, 1282
    s_cbranch_scc1 .ap_69
    s_waitcnt vmcnt(5)
    s_cmpk_ge_u32 s8, 1217
    s_cbranch_scc1 .ap_69
    s_waitcnt vmcnt(3)
    s_bitcmp1_b64 s[14:15], 31
    s_cbranch_scc0 1
    s_waitcnt vmcnt(2)
    s_cmpk_ge_u32 s8, 1142
    s_cbranch_scc1 .ap_69
    s_waitcnt vmcnt(1)
.ap_69:
    s_add_u32 s63, s69, 450560
    buffer_load_dwordx4 v[156:159], v1, s[40:43], s63 offen nt
    buffer_load_dwordx4 v[16:19], v7, s[36:39], s58 offen offset:0 sc1
    buffer_load_dwordx4 v[20:23], v7, s[36:39], s58 offen offset:16 sc1
    s_memrealtime s[8:9]
    s_waitcnt vmcnt(8)
    s_waitcnt lgkmcnt(0)
    s_sub_u32 s8, s8, s30
    s_cmpk_ge_u32 s8, 1309
    s_cbranch_scc1 .ap_70
    s_waitcnt vmcnt(5)
    s_cmpk_ge_u32 s8, 1244
    s_cbranch_scc1 .ap_70
    s_waitcnt vmcnt(3)
    s_bitcmp1_b64 s[14:15], 32
    s_cbranch_scc0 1
    s_waitcnt vmcnt(2)
    s_cmpk_ge_u32 s8, 1169
    s_cbranch_scc1 .ap_70
    s_waitcnt vmcnt(1)
.ap_70:
    s_add_u32 s63, s69, 0
    buffer_load_dwordx4 v[160:163], v2, s[44:47], s63 offen nt
    s_memrealtime s[8:9]
    s_waitcnt vmcnt(8)
    s_waitcnt lgkmcnt(0)
    s_sub_u32 s8, s8, s30
    s_cmpk_ge_u32 s8, 1336
    s_cbranch_scc1 .ap_71
    s_waitcnt vmcnt(5)
    s_cmpk_ge_u32 s8, 1271
    s_cbranch_scc1 .ap_71
    s_waitcnt vmcnt(3)
    s_bitcmp1_b64 s[14:15], 33
    s_cbranch_scc0 1
    s_waitcnt vmcnt(2)
    s_cmpk_ge_u32 s8, 1196
    s_cbranch_scc1 .ap_71
    s_waitcnt vmcnt(1)
.ap_71:
    s_add_u32 s63, s69, 8192
    buffer_load_dwordx4 v[164:167], v2, s[44:47], s63 offen nt
    s_memrealtime s[8:9]
    s_waitcnt vmcnt(8)
    s_waitcnt lgkmcnt(0)
    s_sub_u32 s8, s8, s30
    s_cmpk_ge_u32 s8, 1363
    s_cbranch_scc1 .ap_72
    s_waitcnt vmcnt(5)
    s_cmpk_ge_u32 s8, 1298
    s_cbranch_scc1 .ap_72
    s_waitcnt vmcnt(3)
    s_bitcmp1_b64 s[14:15], 34
    s_cbranch_scc0 1
    s_waitcnt vmcnt(2)
    s_cmpk_ge_u32 s8, 1223
    s_cbranch_scc1 .ap_72
    s_waitcnt vmcnt(1)
.ap_72:
    s_add_u32 s63, s69, 16384
    buffer_load_dwordx4 v[168:171], v2, s[44:47], s63 offen nt
    s_waitcnt vmcnt(3)
    s_branch .gpc_74
.gp_73:
    buffer_load_dwordx4 v[16:19], v7, s[36:39], s58 offen offset:0 sc1
    buffer_load_dwordx4 v[20:23], v7, s[36:39], s58 offen offset:16 sc1
    s_waitcnt vmcnt(0)
.gpc_74:
    v_min_u32 v10, v17, v19
    v_max_u32 v11, v17, v19
    v_min3_u32 v10, v10, v21, v23
    v_max3_u32 v11, v11, v21, v23
    v_cmp_eq_u32 vcc, s34, v10
    v_cmp_eq_u32 s[56:57], s34, v11
    s_and_b64 vcc, vcc, s[56:57]
    s_cmp_eq_u64 vcc, exec
    s_nop 2
    s_cbranch_scc1 .gpd_75
    s_sub_u32 s35, s35, 1
    s_cbranch_scc1 .Lexit
    s_sleep 1
    s_branch .gp_73
.gpd_75:
    s_mov_b32 vcc_lo, 0xcccccccc
    s_mov_b32 vcc_hi, 0xcccccccc
    v_cndmask_b32_e64 v24, v16, 0, vcc
    v_cndmask_b32_e64 v25, v18, 0, vcc
    v_cndmask_b32_e64 v26, v20, 0, vcc
    v_cndmask_b32_e64 v27, v22, 0, vcc
    v_cndmask_b32_e32 v28, 0, v16, vcc
    v_cndmask_b32_e32 v29, 0, v18, vcc
    v_cndmask_b32_e32 v30, 0, v20, vcc
    v_cndmask_b32_e32 v31, 0, v22, vcc
    v_mfma_f32_16x16x32_bf16 v[16:19], v[32:35], v[24:27], 0
    v_mfma_f32_16x16x32_bf16 v[32:35], v[40:43], v[24:27], 0
    v_mfma_f32_16x16x32_bf16 v[16:19], v[36:39], v[28:31], v[16:19]
    v_mfma_f32_16x16x32_bf16 v[40:43], v[48:51], v[24:27], 0
    v_mfma_f32_16x16x32_bf16 v[32:35], v[44:47], v[28:31], v[32:35]
    v_mfma_f32_16x16x32_bf16 v[48:51], v[56:59], v[24:27], 0
    v_mfma_f32_16x16x32_bf16 v[40:43], v[52:55], v[28:31], v[40:43]
    v_mfma_f32_16x16x32_bf16 v[56:59], v[64:67], v[24:27], 0
    v_mfma_f32_16x16x32_bf16 v[48:51], v[60:63], v[28:31], v[48:51]
    s_nop 1
    v_add_f32_dpp v10, v17, v16 row_ror:12 row_mask:0xf bank_mask:0x1
    s_memrealtime s[8:9]
    s_waitcnt lgkmcnt(0)
    s_sub_u32 s8, s8, s30
    s_cmpk_ge_u32 s8, 1390
    s_nop 0
    s_cbranch_scc1 .ap_76
    s_waitcnt vmcnt(3)
    s_cmpk_ge_u32 s8, 1325
    s_cbranch_scc1 .ap_76
    s_waitcnt vmcnt(3)
    s_bitcmp1_b64 s[14:15], 35
    s_cbranch_scc0 1
    s_waitcnt vmcnt(2)
    s_cmpk_ge_u32 s8, 1250
    s_cbranch_scc1 .ap_76
    s_waitcnt vmcnt(1)
.ap_76:
    s_add_u32 s63, s69, 24576
    buffer_load_dwordx4 v[172:175], v2, s[44:47], s63 offen nt
    v_mfma_f32_16x16x32_bf16 v[64:67], v[72:75], v[24:27], 0
    v_mfma_f32_16x16x32_bf16 v[56:59], v[68:71], v[28:31], v[56:59]
    v_add_f32_dpp v11, v33, v32 row_ror:12 row_mask:0xf bank_mask:0x1
    v_add_f32_dpp v10, v18, v10 row_ror:8 row_mask:0xf bank_mask:0x1
    v_mfma_f32_16x16x32_bf16 v[72:75], v[80:83], v[24:27], 0
    v_mfma_f32_16x16x32_bf16 v[64:67], v[76:79], v[28:31], v[64:67]
    v_add_f32_dpp v12, v41, v40 row_ror:12 row_mask:0xf bank_mask:0x1
    v_add_f32_dpp v11, v34, v11 row_ror:8 row_mask:0xf bank_mask:0x1
    v_add_f32_dpp v10, v19, v10 row_ror:4 row_mask:0xf bank_mask:0x1
    v_mfma_f32_16x16x32_bf16 v[80:83], v[88:91], v[24:27], 0
    v_mfma_f32_16x16x32_bf16 v[72:75], v[84:87], v[28:31], v[72:75]
    v_add_f32_dpp v13, v49, v48 row_ror:12 row_mask:0xf bank_mask:0x1
    v_add_f32_dpp v12, v42, v12 row_ror:8 row_mask:0xf bank_mask:0x1
    v_add_f32_dpp v11, v35, v11 row_ror:4 row_mask:0xf bank_mask:0x1
    v_mfma_f32_16x16x32_bf16 v[88:91], v[96:99], v[24:27], 0
    v_mfma_f32_16x16x32_bf16 v[80:83], v[92:95], v[28:31], v[80:83]
    v_add_f32_dpp v10, v58, v57 row_ror:12 row_mask:0xf bank_mask:0x2
    v_add_f32_dpp v13, v50, v13 row_ror:8 row_mask:0xf bank_mask:0x1
    v_add_f32_dpp v12, v43, v12 row_ror:4 row_mask:0xf bank_mask:0x1
    s_memrealtime s[8:9]
    s_waitcnt lgkmcnt(0)
    s_sub_u32 s8, s8, s30
    s_cmpk_ge_u32 s8, 1417
    s_nop 0
    s_cbranch_scc1 .ap_77
    s_waitcnt vmcnt(4)
    s_cmpk_ge_u32 s8, 1352
    s_cbranch_scc1 .ap_77
    s_waitcnt vmcnt(3)
    s_bitcmp1_b64 s[14:15], 36
    s_cbranch_scc0 1
    s_waitcnt vmcnt(2)
    s_cmpk_ge_u32 s8, 1277
    s_cbranch_scc1 .ap_77
    s_waitcnt vmcnt(1)
.ap_77:
    s_add_u32 s63, s69, 32768
    buffer_load_dwordx4 v[176:179], v2, s[44:47], s63 offen nt
    v_mfma_f32_16x16x32_bf16 v[96:99], v[104:107], v[24:27], 0
    v_mfma_f32_16x16x32_bf16 v[88:91], v[100:103], v[28:31], v[88:91]
    v_add_f32_dpp v11, v66, v65 row_ror:12 row_mask:0xf bank_mask:0x2
    v_add_f32_dpp v10, v59, v10 row_ror:8 row_mask:0xf bank_mask:0x2
    v_add_f32_dpp v13, v51, v13 row_ror:4 row_mask:0xf bank_mask:0x1
    v_mfma_f32_16x16x32_bf16 v[104:107], v[112:115], v[24:27], 0
    v_mfma_f32_16x16x32_bf16 v[96:99], v[108:111], v[28:31], v[96:99]
    v_add_f32_dpp v12, v74, v73 row_ror:12 row_mask:0xf bank_mask:0x2
    v_add_f32_dpp v11, v67, v11 row_ror:8 row_mask:0xf bank_mask:0x2
    v_add_f32_dpp v10, v56, v10 row_ror:4 row_mask:0xf bank_mask:0x2
    v_mfma_f32_16x16x32_bf16 v[112:115], v[120:123], v[24:27], 0
    v_mfma_f32_16x16x32_bf16 v[104:107], v[116:119], v[28:31], v[104:107]
    v_add_f32_dpp v13, v82, v81 row_ror:12 row_mask:0xf bank_mask:0x2
    v_add_f32_dpp v12, v75, v12 row_ror:8 row_mask:0xf bank_mask:0x2
    v_add_f32_dpp v11, v64, v11 row_ror:4 row_mask:0xf bank_mask:0x2
    v_mfma_f32_16x16x32_bf16 v[120:123], v[128:131], v[24:27], 0
    v_mfma_f32_16x16x32_bf16 v[112:115], v[124:127], v[28:31], v[112:115]
    v_add_f32_dpp v10, v91, v90 row_ror:12 row_mask:0xf bank_mask:0x4
    v_add_f32_dpp v13, v83, v13 row_ror:8 row_mask:0xf bank_mask:0x2
    v_add_f32_dpp v12, v72, v12 row_ror:4 row_mask:0xf bank_mask:0x2
    s_memrealtime s[8:9]
    s_waitcnt lgkmcnt(0)
    s_sub_u32 s8, s8, s30
    s_cmpk_ge_u32 s8, 1444
    s_nop 0
    s_cbranch_scc1 .ap_78
    s_waitcnt vmcnt(5)
    s_cmpk_ge_u32 s8, 1379
    s_cbranch_scc1 .ap_78
    s_waitcnt vmcnt(3)
    s_bitcmp1_b64 s[14:15], 37
    s_cbranch_scc0 1
    s_waitcnt vmcnt(2)
    s_cmpk_ge_u32 s8, 1304
    s_cbranch_scc1 .ap_78
    s_waitcnt vmcnt(1)
.ap_78:
    s_add_u32 s63, s69, 40960
    buffer_load_dwordx4 v[180:183], v2, s[44:47], s63 offen nt
    v_mfma_f32_16x16x32_bf16 v[128:131], v[136:139], v[24:27], 0
    v_mfma_f32_16x16x32_bf16 v[120:123], v[132:135], v[28:31], v[120:123]
    v_add_f32_dpp v11, v99, v98 row_ror:12 row_mask:0xf bank_mask:0x4
    v_add_f32_dpp v10, v88, v10 row_ror:8 row_mask:0xf bank_mask:0x4
    v_add_f32_dpp v13, v80, v13 row_ror:4 row_mask:0xf bank_mask:0x2
    v_mfma_f32_16x16x32_bf16 v[136:139], v[144:147], v[24:27], 0
    v_mfma_f32_16x16x32_bf16 v[128:131], v[140:143], v[28:31], v[128:131]
    v_add_f32_dpp v12, v107, v106 row_ror:12 row_mask:0xf bank_mask:0x4
    v_add_f32_dpp v11, v96, v11 row_ror:8 row_mask:0xf bank_mask:0x4
    v_add_f32_dpp v10, v89, v10 row_ror:4 row_mask:0xf bank_mask:0x4
    v_mfma_f32_16x16x32_bf16 v[144:147], v[152:155], v[24:27], 0
    v_mfma_f32_16x16x32_bf16 v[136:139], v[148:151], v[28:31], v[136:139]
    v_add_f32_dpp v13, v115, v114 row_ror:12 row_mask:0xf bank_mask:0x4
    v_add_f32_dpp v12, v104, v12 row_ror:8 row_mask:0xf bank_mask:0x4
    v_add_f32_dpp v11, v97, v11 row_ror:4 row_mask:0xf bank_mask:0x4
    v_mfma_f32_16x16x32_bf16 v[144:147], v[156:159], v[28:31], v[144:147]
    v_add_f32_dpp v10, v120, v123 row_ror:12 row_mask:0xf bank_mask:0x8
    v_add_f32_dpp v13, v112, v13 row_ror:8 row_mask:0xf bank_mask:0x4
    v_add_f32_dpp v12, v105, v12 row_ror:4 row_mask:0xf bank_mask:0x4
    s_memrealtime s[8:9]
    s_waitcnt lgkmcnt(0)
    s_sub_u32 s8, s8, s30
    s_cmpk_ge_u32 s8, 1471
    s_nop 0
    s_cbranch_scc1 .ap_79
    s_waitcnt vmcnt(5)
    s_cmpk_ge_u32 s8, 1406
    s_cbranch_scc1 .ap_79
    s_waitcnt vmcnt(3)
    s_bitcmp1_b64 s[14:15], 38
    s_cbranch_scc0 1
    s_waitcnt vmcnt(2)
    s_cmpk_ge_u32 s8, 1331
    s_cbranch_scc1 .ap_79
    s_waitcnt vmcnt(1)
.ap_79:
    s_add_u32 s63, s69, 49152
    buffer_load_dwordx4 v[184:187], v2, s[44:47], s63 offen nt
    v_add_f32_dpp v11, v128, v131 row_ror:12 row_mask:0xf bank_mask:0x8
    v_add_f32_dpp v10, v121, v10 row_ror:8 row_mask:0xf bank_mask:0x8
    v_add_f32_dpp v13, v113, v13 row_ror:4 row_mask:0xf bank_mask:0x4
    v_add_f32_dpp v12, v136, v139 row_ror:12 row_mask:0xf bank_mask:0x8
    v_add_f32_dpp v11, v129, v11 row_ror:8 row_mask:0xf bank_mask:0x8
    v_add_f32_dpp v10, v122, v10 row_ror:4 row_mask:0xf bank_mask:0x8
    v_add_f32_dpp v13, v144, v147 row_ror:12 row_mask:0xf bank_mask:0x8
    v_add_f32_dpp v12, v137, v12 row_ror:8 row_mask:0xf bank_mask:0x8
    v_add_f32_dpp v11, v130, v11 row_ror:4 row_mask:0xf bank_mask:0x8
    v_add_f32_dpp v13, v145, v13 row_ror:8 row_mask:0xf bank_mask:0x8
    v_add_f32_dpp v12, v138, v12 row_ror:4 row_mask:0xf bank_mask:0x8
    s_memrealtime s[8:9]
    s_waitcnt lgkmcnt(0)
    s_sub_u32 s8, s8, s30
    s_cmpk_ge_u32 s8, 1498
    s_cbranch_scc1 .ap_80
    s_waitcnt vmcnt(5)
    s_cmpk_ge_u32 s8, 1433
    s_cbranch_scc1 .ap_80
    s_waitcnt vmcnt(3)
    s_bitcmp1_b64 s[14:15], 39
    s_cbranch_scc0 1
    s_waitcnt vmcnt(2)
    s_cmpk_ge_u32 s8, 1358
    s_cbranch_scc1 .ap_80
    s_waitcnt vmcnt(1)
.ap_80:
    s_add_u32 s63, s69, 57344
    buffer_load_dwordx4 v[188:191], v2, s[44:47], s63 offen nt
    v_add_f32_dpp v13, v146, v13 row_ror:4 row_mask:0xf bank_mask:0x8
    s_mov_b32 s60, 0x3db504f3
    s_mov_b32 s61, 0x3db504f3
    v_cvt_pk_bf16_f32 v10, v10, v11
    v_and_b32 v11, 0xffff0000, v10
    v_lshlrev_b32 v10, 16, v10
    v_cvt_pk_bf16_f32 v12, v12, v13
    v_and_b32 v13, 0xffff0000, v12
    v_lshlrev_b32 v12, 16, v12
    v_pk_mul_f32 v[10:11], v[10:11], s[60:61]
    v_pk_mul_f32 v[12:13], v[12:13], s[60:61]
    v_cvt_pk_bf16_f32 v10, v10, v11
    v_and_b32 v11, 0xffff0000, v10
    v_lshlrev_b32 v10, 16, v10
    v_cvt_pk_bf16_f32 v12, v12, v13
    v_and_b32 v13, 0xffff0000, v12
    v_lshlrev_b32 v12, 16, v12
    v_max_f32 v14, v10, v11
    v_max3_f32 v14, v14, v12, v13
    s_mov_b32 s60, 0x3fb8aa3b
    v_mov_b32 v22, s34
    v_mov_b32 v23, s34
    v_max_f32_dpp v14, v14, v14 quad_perm:[2,3,0,1] row_mask:0xf bank_mask:0xf
    s_nop 1
    v_max_f32_dpp v14, v14, v14 row_ror:4 row_mask:0xf bank_mask:0xf
    s_nop 1
    v_max_f32_dpp v14, v14, v14 row_ror:8 row_mask:0xf bank_mask:0xf
    v_mov_b32 v15, v14
    s_nop 1
    v_permlane16_swap_b32 v15, v14
    v_max_f32 v14, v15, v14
    v_mov_b32 v15, v14
    s_nop 1
    v_permlane32_swap_b32 v15, v14
    v_max_f32 v14, v15, v14
    v_mul_f32 v15, 0xbfb8aa3b, v14
    v_fma_f32 v10, v10, s60, v15
    v_fma_f32 v11, v11, s60, v15
    v_fma_f32 v12, v12, s60, v15
    v_fma_f32 v13, v13, s60, v15
    v_exp_f32 v10, v10
    v_exp_f32 v11, v11
    v_exp_f32 v12, v12
    v_exp_f32 v13, v13
    v_mov_b32 v20, v14
    v_pk_add_f32 v[16:17], v[10:11], v[12:13]
    v_add_f32 v21, v16, v17
    s_lshl3_add_u32 s60, s68, s3
    s_lshl_b32 s60, s60, 5
    s_add_u32 s60, s60, s59
    v_add_f32_dpp v21, v21, v21 quad_perm:[2,3,0,1] row_mask:0xf bank_mask:0xf
    s_nop 1
    v_add_f32_dpp v21, v21, v21 row_ror:4 row_mask:0xf bank_mask:0xf
    s_nop 1
    v_add_f32_dpp v21, v21, v21 row_ror:8 row_mask:0xf bank_mask:0xf
    v_mov_b32 v15, v21
    s_nop 1
    v_permlane16_swap_b32 v15, v21
    v_add_f32 v21, v15, v21
    v_mov_b32 v15, v21
    s_nop 1
    v_permlane32_swap_b32 v15, v21
    v_add_f32 v21, v15, v21
    s_lshl_b32 s60, s3, 4
    s_add_u32 s60, s60, 159104
    v_add_u32 v16, s60, v3
    v_mov_b32 v17, 159232
    v_mov_b32 v18, 1
    s_mov_b64 exec, 3
    ds_write_b64 v16, v[20:21]
    s_mov_b64 exec, 1
    s_waitcnt lgkmcnt(0)
    ds_add_rtn_u32 v18, v17, v18
    s_mov_b64 exec, -1
    v_and_b32 v16, 0x78, v3
    v_add_u32 v16, 159104, v16
    s_waitcnt lgkmcnt(0)
    v_readfirstlane_b32 s60, v18
    s_cmp_lg_u32 s60, 7
    s_nop 3
    s_cbranch_scc1 .ml_81
    ds_read_b64 v[18:19], v16
    s_lshl_b32 s60, s68, 7
    s_add_u32 s60, s60, s59
    s_waitcnt lgkmcnt(0)
    v_mov_b32 v20, v18
    s_nop 1
    v_max_f32_dpp v20, v20, v20 quad_perm:[2,3,0,1] row_mask:0xf bank_mask:0xf
    s_nop 1
    v_max_f32_dpp v20, v20, v20 row_ror:4 row_mask:0xf bank_mask:0xf
    s_nop 1
    v_max_f32_dpp v20, v20, v20 row_ror:8 row_mask:0xf bank_mask:0xf
    v_sub_f32 v18, v18, v20
    v_mul_f32 v18, 0x3fb8aa3b, v18
    v_exp_f32 v18, v18
    s_nop 0
    v_mul_f32 v21, v18, v19
    s_nop 1
    v_add_f32_dpp v21, v21, v21 quad_perm:[2,3,0,1] row_mask:0xf bank_mask:0xf
    s_nop 1
    v_add_f32_dpp v21, v21, v21 row_ror:4 row_mask:0xf bank_mask:0xf
    s_nop 1
    v_add_f32_dpp v21, v21, v21 row_ror:8 row_mask:0xf bank_mask:0xf
    s_mov_b64 exec, 0xff
    buffer_store_dwordx4 v[20:23], v2, s[36:39], s60 offen sc1
    s_mov_b64 exec, -1
.ml_81:
    s_memrealtime s[8:9]
    s_waitcnt lgkmcnt(0)
    s_sub_u32 s8, s8, s30
    s_cmpk_ge_u32 s8, 1525
    s_cbranch_scc1 .ap_82
    s_waitcnt vmcnt(5)
    s_cmpk_ge_u32 s8, 1460
    s_cbranch_scc1 .ap_82
    s_waitcnt vmcnt(3)
    s_bitcmp1_b64 s[14:15], 40
    s_cbranch_scc0 1
    s_waitcnt vmcnt(2)
    s_cmpk_ge_u32 s8, 1385
    s_cbranch_scc1 .ap_82
    s_waitcnt vmcnt(1)
.ap_82:
    s_add_u32 s63, s69, 131072
    buffer_load_dwordx4 v[192:195], v2, s[44:47], s63 offen nt
    s_memrealtime s[8:9]
    s_waitcnt vmcnt(8)
    s_waitcnt lgkmcnt(0)
    s_sub_u32 s8, s8, s30
    s_cmpk_ge_u32 s8, 1552
    s_cbranch_scc1 .ap_83
    s_waitcnt vmcnt(5)
    s_cmpk_ge_u32 s8, 1487
    s_cbranch_scc1 .ap_83
    s_waitcnt vmcnt(3)
    s_bitcmp1_b64 s[14:15], 41
    s_cbranch_scc0 1
    s_waitcnt vmcnt(2)
    s_cmpk_ge_u32 s8, 1412
    s_cbranch_scc1 .ap_83
    s_waitcnt vmcnt(1)
.ap_83:
    s_add_u32 s63, s69, 139264
    buffer_load_dwordx4 v[196:199], v2, s[44:47], s63 offen nt
    s_memrealtime s[8:9]
    s_waitcnt vmcnt(8)
    s_waitcnt lgkmcnt(0)
    s_sub_u32 s8, s8, s30
    s_cmpk_ge_u32 s8, 1579
    s_cbranch_scc1 .ap_84
    s_waitcnt vmcnt(5)
    s_cmpk_ge_u32 s8, 1514
    s_cbranch_scc1 .ap_84
    s_waitcnt vmcnt(3)
    s_bitcmp1_b64 s[14:15], 42
    s_cbranch_scc0 1
    s_waitcnt vmcnt(2)
    s_cmpk_ge_u32 s8, 1439
    s_cbranch_scc1 .ap_84
    s_waitcnt vmcnt(1)
.ap_84:
    s_add_u32 s63, s69, 147456
    buffer_load_dwordx4 v[200:203], v2, s[44:47], s63 offen nt
    s_memrealtime s[8:9]
    s_waitcnt vmcnt(8)
    s_waitcnt lgkmcnt(0)
    s_sub_u32 s8, s8, s30
    s_cmpk_ge_u32 s8, 1606
    s_cbranch_scc1 .ap_85
    s_waitcnt vmcnt(5)
    s_cmpk_ge_u32 s8, 1541
    s_cbranch_scc1 .ap_85
    s_waitcnt vmcnt(3)
    s_bitcmp1_b64 s[14:15], 43
    s_cbranch_scc0 1
    s_waitcnt vmcnt(2)
    s_cmpk_ge_u32 s8, 1466
    s_cbranch_scc1 .ap_85
    s_waitcnt vmcnt(1)
.ap_85:
    s_add_u32 s63, s69, 155648
    buffer_load_dwordx4 v[204:207], v2, s[44:47], s63 offen nt
    s_memrealtime s[8:9]
    s_waitcnt vmcnt(8)
    s_waitcnt lgkmcnt(0)
    s_sub_u32 s8, s8, s30
    s_cmpk_ge_u32 s8, 1633
    s_cbranch_scc1 .ap_86
    s_waitcnt vmcnt(5)
    s_cmpk_ge_u32 s8, 1568
    s_cbranch_scc1 .ap_86
    s_waitcnt vmcnt(3)
    s_bitcmp1_b64 s[14:15], 44
    s_cbranch_scc0 1
    s_waitcnt vmcnt(2)
    s_cmpk_ge_u32 s8, 1493
    s_cbranch_scc1 .ap_86
    s_waitcnt vmcnt(1)
.ap_86:
    s_add_u32 s63, s69, 163840
    buffer_load_dwordx4 v[208:211], v2, s[44:47], s63 offen nt
    v_and_b32 v16, 15, v0
    v_lshrrev_b32 v17, 4, v0
    v_lshl_add_u32 v16, v16, 2, v17
    v_lshlrev_b32 v31, 1, v16
    s_lshl_b32 s56, s65, 7
    v_add_u32 v31, s56, v31
    v_and_b32 v6, -4, v31
    v_lshlrev_b32 v6, 1, v6
    s_mul_i32 s56, s3, 1152
    s_mov_b32 s52, s4
    s_and_b32 s53, s5, 0xffff
    s_mov_b32 s54, 0x2400
    s_mov_b32 s55, 0x00020000
    buffer_load_ushort v29, v31, s[52:55], s56 offen
    s_mul_i32 s101, s3, 2304
    s_add_u32 s101, s101, 0x15000
    s_add_u32 s99, s101, 36864
    s_add_u32 s100, s101, 73728
    s_add_u32 s33, s101, 110592
    buffer_load_dwordx2 v[72:73], v6, s[36:39], s101 offen offset:0
    s_cmp_lg_u32 s3, s64
    s_cbranch_scc1 .rin_87
    buffer_load_dwordx4 v[32:35], v2, s[36:39], s99 offen offset:0
    buffer_load_dwordx4 v[40:43], v2, s[36:39], s99 offen offset:1024
    buffer_load_dwordx2 v[48:49], v5, s[36:39], s99 offen offset:0
    buffer_load_dwordx4 v[56:59], v2, s[36:39], s100 offen offset:0
    buffer_load_dwordx4 v[64:67], v2, s[36:39], s100 offen offset:1024
    buffer_load_dwordx2 v[50:51], v5, s[36:39], s100 offen offset:0
    buffer_load_dwordx2 v[74:75], v6, s[36:39], s99 offen offset:0
    buffer_load_dwordx2 v[80:81], v6, s[36:39], s100 offen offset:0
    buffer_load_dwordx2 v[82:83], v6, s[36:39], s33 offen offset:0
    s_mov_b32 s48, s16
    s_and_b32 s49, s17, 0xffff
    s_mov_b32 s50, 0x480
    s_mov_b32 s51, 0x00020000
    buffer_load_dwordx2 v[88:89], v3, s[48:51], 0 offen
    buffer_load_dwordx2 v[90:91], v3, s[48:51], 0 offen offset:512
    buffer_load_dword v30, v4, s[48:51], 0 offen
    s_mov_b32 s48, s28
    s_and_b32 s49, s29, 0xffff
    s_mov_b32 s50, 0x2400
    s_mov_b32 s51, 0x00020000
    buffer_load_ushort v17, v31, s[48:51], s56 offen nt
.rin_87:
    s_memrealtime s[8:9]
    s_waitcnt vmcnt(10)
    s_waitcnt lgkmcnt(0)
    s_sub_u32 s8, s8, s30
    s_cmpk_ge_u32 s8, 1660
    s_cbranch_scc1 .ap_88
    s_waitcnt vmcnt(7)
    s_cmpk_ge_u32 s8, 1595
    s_cbranch_scc1 .ap_88
    s_waitcnt vmcnt(5)
    s_bitcmp1_b64 s[14:15], 45
    s_cbranch_scc0 1
    s_waitcnt vmcnt(4)
    s_cmpk_ge_u32 s8, 1520
    s_cbranch_scc1 .ap_88
    s_waitcnt vmcnt(3)
.ap_88:
    s_add_u32 s63, s69, 172032
    buffer_load_dwordx4 v[212:215], v2, s[44:47], s63 offen nt
    s_memrealtime s[8:9]
    s_waitcnt vmcnt(10)
    s_waitcnt lgkmcnt(0)
    s_sub_u32 s8, s8, s30
    s_cmpk_ge_u32 s8, 1691
    s_cbranch_scc1 .ap_89
    s_waitcnt vmcnt(7)
    s_cmpk_ge_u32 s8, 1626
    s_cbranch_scc1 .ap_89
    s_waitcnt vmcnt(5)
    s_bitcmp1_b64 s[14:15], 46
    s_cbranch_scc0 1
    s_waitcnt vmcnt(4)
    s_cmpk_ge_u32 s8, 1551
    s_cbranch_scc1 .ap_89
    s_waitcnt vmcnt(3)
.ap_89:
    s_add_u32 s63, s69, 180224
    buffer_load_dwordx4 v[216:219], v2, s[44:47], s63 offen nt
    s_memrealtime s[8:9]
    s_waitcnt vmcnt(10)
    s_waitcnt lgkmcnt(0)
    s_sub_u32 s8, s8, s30
    s_cmpk_ge_u32 s8, 1722
    s_cbranch_scc1 .ap_90
    s_waitcnt vmcnt(7)
    s_cmpk_ge_u32 s8, 1657
    s_cbranch_scc1 .ap_90
    s_waitcnt vmcnt(5)
    s_bitcmp1_b64 s[14:15], 47
    s_cbranch_scc0 1
    s_waitcnt vmcnt(4)
    s_cmpk_ge_u32 s8, 1582
    s_cbranch_scc1 .ap_90
    s_waitcnt vmcnt(1)
.ap_90:
    s_add_u32 s63, s69, 188416
    buffer_load_dwordx4 v[220:223], v2, s[44:47], s63 offen nt
    s_memrealtime s[8:9]
    s_waitcnt vmcnt(10)
    s_waitcnt lgkmcnt(0)
    s_sub_u32 s8, s8, s30
    s_cmpk_ge_u32 s8, 1753
    s_cbranch_scc1 .ap_91
    s_waitcnt vmcnt(7)
    s_cmpk_ge_u32 s8, 1688
    s_cbranch_scc1 .ap_91
    s_waitcnt vmcnt(5)
    s_bitcmp1_b64 s[14:15], 48
    s_cbranch_scc0 1
    s_waitcnt vmcnt(2)
    s_cmpk_ge_u32 s8, 1613
    s_cbranch_scc1 .ap_91
    s_waitcnt vmcnt(1)
.ap_91:
    s_add_u32 s63, s69, 262144
    buffer_load_dwordx4 v[224:227], v2, s[44:47], s63 offen nt
    s_memrealtime s[8:9]
    s_waitcnt vmcnt(10)
    s_waitcnt lgkmcnt(0)
    s_sub_u32 s8, s8, s30
    s_cmpk_ge_u32 s8, 1784
    s_cbranch_scc1 .ap_92
    s_waitcnt vmcnt(7)
    s_cmpk_ge_u32 s8, 1719
    s_cbranch_scc1 .ap_92
    s_waitcnt vmcnt(3)
    s_bitcmp1_b64 s[14:15], 49
    s_cbranch_scc0 1
    s_waitcnt vmcnt(2)
    s_cmpk_ge_u32 s8, 1644
    s_cbranch_scc1 .ap_92
    s_waitcnt vmcnt(1)
.ap_92:
    s_add_u32 s63, s69, 270336
    buffer_load_dwordx4 v[228:231], v2, s[44:47], s63 offen nt
    s_memrealtime s[8:9]
    s_waitcnt vmcnt(10)
    s_waitcnt lgkmcnt(0)
    s_sub_u32 s8, s8, s30
    s_cmpk_ge_u32 s8, 1815
    s_cbranch_scc1 .ap_93
    s_waitcnt vmcnt(7)
    s_cmpk_ge_u32 s8, 1750
    s_cbranch_scc1 .ap_93
    s_waitcnt vmcnt(3)
    s_bitcmp1_b64 s[14:15], 50
    s_cbranch_scc0 1
    s_waitcnt vmcnt(2)
    s_cmpk_ge_u32 s8, 1675
    s_cbranch_scc1 .ap_93
    s_waitcnt vmcnt(1)
.ap_93:
    s_add_u32 s63, s69, 278528
    buffer_load_dwordx4 v[232:235], v2, s[44:47], s63 offen nt
    s_memrealtime s[8:9]
    s_waitcnt vmcnt(10)
    s_waitcnt lgkmcnt(0)
    s_sub_u32 s8, s8, s30
    s_cmpk_ge_u32 s8, 1846
    s_cbranch_scc1 .ap_94
    s_waitcnt vmcnt(5)
    s_cmpk_ge_u32 s8, 1781
    s_cbranch_scc1 .ap_94
    s_waitcnt vmcnt(3)
    s_bitcmp1_b64 s[14:15], 51
    s_cbranch_scc0 1
    s_waitcnt vmcnt(2)
    s_cmpk_ge_u32 s8, 1706
    s_cbranch_scc1 .ap_94
    s_waitcnt vmcnt(1)
.ap_94:
    s_add_u32 s63, s69, 286720
    buffer_load_dwordx4 v[236:239], v2, s[44:47], s63 offen nt
    s_memrealtime s[8:9]
    s_waitcnt vmcnt(10)
    s_waitcnt lgkmcnt(0)
    s_sub_u32 s8, s8, s30
    s_cmpk_ge_u32 s8, 1877
    s_cbranch_scc1 .ap_95
    s_waitcnt vmcnt(5)
    s_cmpk_ge_u32 s8, 1812
    s_cbranch_scc1 .ap_95
    s_waitcnt vmcnt(3)
    s_bitcmp1_b64 s[14:15], 52
    s_cbranch_scc0 1
    s_waitcnt vmcnt(2)
    s_cmpk_ge_u32 s8, 1737
    s_cbranch_scc1 .ap_95
    s_waitcnt vmcnt(1)
.ap_95:
    s_add_u32 s63, s69, 294912
    buffer_load_dwordx4 v[240:243], v2, s[44:47], s63 offen nt
    s_memrealtime s[8:9]
    s_waitcnt vmcnt(10)
    s_waitcnt lgkmcnt(0)
    s_sub_u32 s8, s8, s30
    s_cmpk_ge_u32 s8, 1908
    s_cbranch_scc1 .ap_96
    s_waitcnt vmcnt(5)
    s_cmpk_ge_u32 s8, 1843
    s_cbranch_scc1 .ap_96
    s_waitcnt vmcnt(3)
    s_bitcmp1_b64 s[14:15], 53
    s_cbranch_scc0 1
    s_waitcnt vmcnt(2)
    s_cmpk_ge_u32 s8, 1768
    s_cbranch_scc1 .ap_96
    s_waitcnt vmcnt(1)
.ap_96:
    s_add_u32 s63, s69, 303104
    buffer_load_dwordx4 v[244:247], v2, s[44:47], s63 offen nt
    s_load_dwordx2 s[88:89], s[6:7], s0
    buffer_load_dwordx4 v[24:27], v9, s[36:39], s59 offen offset:0 sc1
    s_memrealtime s[8:9]
    s_waitcnt vmcnt(8)
    s_waitcnt lgkmcnt(0)
    s_sub_u32 s8, s8, s30
    s_cmpk_ge_u32 s8, 1939
    s_cbranch_scc1 .ap_97
    s_waitcnt vmcnt(5)
    s_cmpk_ge_u32 s8, 1874
    s_cbranch_scc1 .ap_97
    s_waitcnt vmcnt(3)
    s_bitcmp1_b64 s[14:15], 54
    s_cbranch_scc0 1
    s_waitcnt vmcnt(2)
    s_cmpk_ge_u32 s8, 1799
    s_cbranch_scc1 .ap_97
    s_waitcnt vmcnt(1)
.ap_97:
    s_add_u32 s63, s69, 311296
    buffer_load_dwordx4 v[248:251], v2, s[44:47], s63 offen nt
    s_memrealtime s[8:9]
    s_waitcnt vmcnt(8)
    s_waitcnt lgkmcnt(0)
    s_sub_u32 s8, s8, s30
    s_cmpk_ge_u32 s8, 1970
    s_cbranch_scc1 .ap_98
    s_waitcnt vmcnt(5)
    s_cmpk_ge_u32 s8, 1905
    s_cbranch_scc1 .ap_98
    s_waitcnt vmcnt(3)
    s_bitcmp1_b64 s[14:15], 55
    s_cbranch_scc0 1
    s_waitcnt vmcnt(2)
    s_cmpk_ge_u32 s8, 1830
    s_cbranch_scc1 .ap_98
    s_waitcnt vmcnt(1)
.ap_98:
    s_add_u32 s63, s69, 319488
    buffer_load_dwordx4 v[252:255], v2, s[44:47], s63 offen nt
    s_memrealtime s[8:9]
    s_waitcnt vmcnt(8)
    s_waitcnt lgkmcnt(0)
    s_sub_u32 s8, s8, s30
    s_cmpk_ge_u32 s8, 2001
    s_cbranch_scc1 .ap_99
    s_waitcnt vmcnt(5)
    s_cmpk_ge_u32 s8, 1936
    s_cbranch_scc1 .ap_99
    s_waitcnt vmcnt(3)
    s_bitcmp1_b64 s[14:15], 56
    s_cbranch_scc0 1
    s_waitcnt vmcnt(2)
    s_cmpk_ge_u32 s8, 1861
    s_cbranch_scc1 .ap_99
    s_waitcnt vmcnt(1)
.ap_99:
    s_add_u32 s63, s69, 393216
    buffer_load_dwordx4 v[36:39], v2, s[44:47], s63 offen nt
    s_memrealtime s[8:9]
    s_waitcnt vmcnt(8)
    s_waitcnt lgkmcnt(0)
    s_sub_u32 s8, s8, s30
    s_cmpk_ge_u32 s8, 2032
    s_cbranch_scc1 .ap_100
    s_waitcnt vmcnt(5)
    s_cmpk_ge_u32 s8, 1967
    s_cbranch_scc1 .ap_100
    s_waitcnt vmcnt(3)
    s_bitcmp1_b64 s[14:15], 57
    s_cbranch_scc0 1
    s_waitcnt vmcnt(2)
    s_cmpk_ge_u32 s8, 1892
    s_cbranch_scc1 .ap_100
    s_waitcnt vmcnt(1)
.ap_100:
    s_add_u32 s63, s69, 401408
    buffer_load_dwordx4 v[44:47], v2, s[44:47], s63 offen nt
    s_memrealtime s[8:9]
    s_waitcnt vmcnt(8)
    s_waitcnt lgkmcnt(0)
    s_sub_u32 s8, s8, s30
    s_cmpk_ge_u32 s8, 2063
    s_cbranch_scc1 .ap_101
    s_waitcnt vmcnt(5)
    s_cmpk_ge_u32 s8, 1998
    s_cbranch_scc1 .ap_101
    s_waitcnt vmcnt(3)
    s_bitcmp1_b64 s[14:15], 58
    s_cbranch_scc0 1
    s_waitcnt vmcnt(2)
    s_cmpk_ge_u32 s8, 1923
    s_cbranch_scc1 .ap_101
    s_waitcnt vmcnt(1)
.ap_101:
    s_add_u32 s63, s69, 409600
    buffer_load_dwordx4 v[52:55], v2, s[44:47], s63 offen nt
    s_waitcnt vmcnt(5)
    s_branch .gpc_103
.gp_102:
    buffer_load_dwordx4 v[24:27], v9, s[36:39], s59 offen offset:0 sc1
    s_waitcnt vmcnt(0)
.gpc_103:
    v_cmp_eq_u32 vcc, s34, v26
    s_cmp_eq_u64 vcc, exec
    s_nop 3
    s_cbranch_scc1 .gpd_104
    s_sub_u32 s35, s35, 1
    s_cbranch_scc1 .Lexit
    s_sleep 1
    s_branch .gp_102
.gpd_104:
    s_lshr_b64 s[88:89], s[88:89], s1
    s_and_b32 s88, s88, 0xff
    s_cmp_eq_u32 s88, 32
    s_cselect_b32 s0, 0xac000, 0
    v_mov_b32 v16, v24
    s_nop 1
    v_max_f32_dpp v16, v16, v16 quad_perm:[2,3,0,1] row_mask:0xf bank_mask:0xf
    v_sub_f32 v17, v24, v16
    v_sub_f32 v18, v14, v16
    v_mul_f32 v17, 0x3fb8aa3b, v17
    v_mul_f32 v18, 0x3fb8aa3b, v18
    v_exp_f32 v17, v17
    v_exp_f32 v18, v18
    v_mul_f32 v17, v17, v25
    s_nop 1
    v_add_f32_dpp v17, v17, v17 quad_perm:[2,3,0,1] row_mask:0xf bank_mask:0xf
    v_rcp_f32 v19, v17
    s_nop 0
    v_fma_f32 v15, -v17, v19, 1.0
    v_fma_f32 v19, v15, v19, v19
    v_mul_f32 v18, v18, v19
    v_mul_f32 v10, v10, v18
    v_mul_f32 v11, v11, v18
    v_mul_f32 v12, v12, v18
    v_mul_f32 v13, v13, v18
    v_mov_b32_dpp v112, v10 quad_perm:[2,3,0,1] row_mask:0xf bank_mask:0xf
    v_mov_b32_dpp v113, v11 quad_perm:[2,3,0,1] row_mask:0xf bank_mask:0xf
    v_mov_b32_dpp v114, v12 quad_perm:[2,3,0,1] row_mask:0xf bank_mask:0xf
    v_mov_b32_dpp v115, v13 quad_perm:[2,3,0,1] row_mask:0xf bank_mask:0xf
    v_cvt_pk_bf16_f32 v96, v10, v112
    v_cvt_pk_bf16_f32 v100, v11, v113
    v_cvt_pk_bf16_f32 v104, v12, v114
    v_cvt_pk_bf16_f32 v108, v13, v115
    v_mov_b32_dpp v97, v96 row_ror:12 row_mask:0xf bank_mask:0xf
    v_mov_b32_dpp v101, v100 row_ror:12 row_mask:0xf bank_mask:0xf
    v_mov_b32_dpp v105, v104 row_ror:12 row_mask:0xf bank_mask:0xf
    v_mov_b32_dpp v109, v108 row_ror:12 row_mask:0xf bank_mask:0xf
    v_mov_b32_dpp v98, v96 row_ror:8 row_mask:0xf bank_mask:0xf
    v_mov_b32_dpp v102, v100 row_ror:8 row_mask:0xf bank_mask:0xf
    v_mov_b32_dpp v106, v104 row_ror:8 row_mask:0xf bank_mask:0xf
    v_mov_b32_dpp v110, v108 row_ror:8 row_mask:0xf bank_mask:0xf
    v_mov_b32_dpp v99, v96 row_ror:4 row_mask:0xf bank_mask:0xf
    v_mov_b32_dpp v103, v100 row_ror:4 row_mask:0xf bank_mask:0xf
    v_mov_b32_dpp v107, v104 row_ror:4 row_mask:0xf bank_mask:0xf
    v_mov_b32_dpp v111, v108 row_ror:4 row_mask:0xf bank_mask:0xf
    s_memrealtime s[8:9]
    s_waitcnt lgkmcnt(0)
    s_sub_u32 s8, s8, s30
    s_cmpk_ge_u32 s8, 2094
    s_cbranch_scc1 .ap_105
    s_waitcnt vmcnt(5)
    s_cmpk_ge_u32 s8, 2029
    s_cbranch_scc1 .ap_105
    s_waitcnt vmcnt(3)
    s_bitcmp1_b64 s[14:15], 59
    s_cbranch_scc0 1
    s_waitcnt vmcnt(2)
    s_cmpk_ge_u32 s8, 1954
    s_cbranch_scc1 .ap_105
    s_waitcnt vmcnt(1)
.ap_105:
    s_add_u32 s63, s69, 417792
    buffer_load_dwordx4 v[60:63], v2, s[44:47], s63 offen nt
    s_lshl_b32 s60, s3, 10
    s_add_u32 s60, s60, 132096
    v_lshlrev_b32 v10, 5, v0
    v_add_u32 v10, s60, v10
    v_lshrrev_b32 v11, 5, v0
    v_lshlrev_b32 v11, 13, v11
    v_and_b32 v12, 31, v0
    v_lshl_add_u32 v11, v12, 4, v11
    v_add_u32 v9, 132096, v2
    v_mov_b32 v15, s34
    v_lshrrev_b32 v25, 4, v0
    v_bfe_u32 v26, v0, 2, 2
    v_lshl_add_u32 v16, v25, 3, v26
    v_lshlrev_b32 v16, 7, v16
    v_and_b32 v25, 1, v25
    v_lshrrev_b32 v26, 1, v26
    v_lshl_add_u32 v25, v25, 1, v26
    s_and_b32 s56, s3, 1
    s_lshl_b32 s56, s56, 1
    v_xor_b32 v25, s56, v25
    v_and_b32 v26, 3, v0
    v_lshl_add_u32 v16, v26, 3, v16
    s_lshr_b32 s56, s3, 1
    s_mul_i32 s56, s56, 16384
    v_add_u32 v16, s56, v16
    v_xor_b32 v26, 1, v25
    v_lshl_add_u32 v17, v26, 5, v16
    v_lshl_add_u32 v16, v25, 5, v16
    v_bfe_u32 v25, v0, 1, 3
    v_mul_u32_u24 v19, 1312, v25
    v_mul_u32_u24 v20, 272, v25
    v_and_b32 v25, 48, v0
    s_lshr_b32 s56, s3, 1
    s_mul_i32 s57, s56, 256
    s_add_u32 s57, s57, 147456
    v_add3_u32 v19, v19, v25, s57
    s_mul_i32 s56, s56, 2176
    s_and_b32 s57, s3, 1
    s_lshl_b32 s57, s57, 7
    s_add_u32 s56, s56, s57
    s_add_u32 s56, s56, 122880
    v_add3_u32 v20, v20, v25, s56
    v_and_b32 v25, 1, v0
    v_lshl_add_u32 v20, v25, 6, v20
    v_and_b32 v25, 15, v0
    s_mul_i32 s56, s3, 272
    s_add_u32 s56, s56, 122880
    v_lshl_add_u32 v21, v25, 4, s56
    v_and_b32 v18, 31, v0
    v_lshlrev_b32 v18, 3, v18
    v_lshrrev_b32 v25, 5, v0
    v_lshl_add_u32 v18, v25, 2, v18
    s_mul_i32 s56, s3, 1312
    s_add_u32 s56, s56, 147456
    v_add_u32 v18, s56, v18
    v_add_u32 v7, 8192, v2
    v_add_u32 v8, 16384, v2
    v_add_u32 v22, 24576, v2
    s_nop 1
    s_branch .gpc_107
.gp_106:
    buffer_load_dwordx2 v[72:73], v6, s[36:39], s101 offen offset:0 sc1
    s_waitcnt vmcnt(0)
.gpc_107:
    v_cmp_eq_u32 vcc, s34, v73
    s_cmp_eq_u64 vcc, exec
    s_nop 3
    s_cbranch_scc1 .gpd_108
    s_sub_u32 s35, s35, 1
    s_cbranch_scc1 .Lexit
    s_sleep 2
    s_branch .gp_106
.gpd_108:
    v_lshlrev_b32 v23, 16, v72
    v_and_b32 v72, 0xffff0000, v72
    s_mov_b32 vcc_lo, 0xffff0000
    s_mov_b32 vcc_hi, 0xffff0000
    v_cndmask_b32 v23, v23, v72, vcc
    v_lshlrev_b32 v29, 16, v29
    s_memrealtime s[8:9]
    s_waitcnt lgkmcnt(0)
    s_sub_u32 s8, s8, s30
    s_cmpk_ge_u32 s8, 2125
    s_cbranch_scc1 .ap_109
    s_waitcnt vmcnt(5)
    s_cmpk_ge_u32 s8, 2060
    s_cbranch_scc1 .ap_109
    s_waitcnt vmcnt(3)
    s_bitcmp1_b64 s[14:15], 60
    s_cbranch_scc0 1
    s_waitcnt vmcnt(2)
    s_cmpk_ge_u32 s8, 1985
    s_cbranch_scc1 .ap_109
    s_waitcnt vmcnt(1)
.ap_109:
    s_add_u32 s63, s69, 425984
    buffer_load_dwordx4 v[68:71], v2, s[44:47], s63 offen nt
    v_perm_b32 v112, v164, v160, s94
    v_perm_b32 v113, v172, v168, s94
    v_perm_b32 v114, v180, v176, s94
    v_perm_b32 v115, v188, v184, s94
    s_nop 1
    v_mfma_f32_16x16x32_bf16 v[128:131], v[96:99], v[112:115], 0
    v_perm_b32 v116, v164, v160, s95
    v_perm_b32 v117, v172, v168, s95
    v_perm_b32 v118, v180, v176, s95
    v_perm_b32 v119, v188, v184, s95
    s_nop 1
    v_mfma_f32_16x16x32_bf16 v[132:135], v[96:99], v[116:119], 0
    v_perm_b32 v120, v165, v161, s94
    v_perm_b32 v121, v173, v169, s94
    v_perm_b32 v122, v181, v177, s94
    v_perm_b32 v123, v189, v185, s94
    s_nop 1
    v_mfma_f32_16x16x32_bf16 v[136:139], v[96:99], v[120:123], 0
    v_perm_b32 v124, v165, v161, s95
    v_perm_b32 v125, v173, v169, s95
    v_perm_b32 v126, v181, v177, s95
    v_perm_b32 v127, v189, v185, s95
    s_nop 1
    v_mfma_f32_16x16x32_bf16 v[140:143], v[96:99], v[124:127], 0
    v_perm_b32 v112, v166, v162, s94
    v_perm_b32 v113, v174, v170, s94
    v_perm_b32 v114, v182, v178, s94
    v_perm_b32 v115, v190, v186, s94
    s_nop 1
    v_mfma_f32_16x16x32_bf16 v[144:147], v[96:99], v[112:115], 0
    v_perm_b32 v116, v166, v162, s95
    v_perm_b32 v117, v174, v170, s95
    v_perm_b32 v118, v182, v178, s95
    v_perm_b32 v119, v190, v186, s95
    s_nop 1
    v_mfma_f32_16x16x32_bf16 v[148:151], v[96:99], v[116:119], 0
    v_perm_b32 v120, v167, v163, s94
    v_perm_b32 v121, v175, v171, s94
    v_perm_b32 v122, v183, v179, s94
    v_perm_b32 v123, v191, v187, s94
    s_nop 1
    v_mfma_f32_16x16x32_bf16 v[152:155], v[96:99], v[120:123], 0
    v_perm_b32 v124, v167, v163, s95
    v_perm_b32 v125, v175, v171, s95
    v_perm_b32 v126, v183, v179, s95
    v_perm_b32 v127, v191, v187, s95
    s_nop 1
    v_mfma_f32_16x16x32_bf16 v[156:159], v[96:99], v[124:127], 0
    s_memrealtime s[8:9]
    s_waitcnt lgkmcnt(0)
    s_sub_u32 s8, s8, s30
    s_cmpk_ge_u32 s8, 2156
    s_nop 3
    s_cbranch_scc1 .ap_110
    s_waitcnt vmcnt(5)
    s_cmpk_ge_u32 s8, 2091
    s_cbranch_scc1 .ap_110
    s_waitcnt vmcnt(3)
    s_bitcmp1_b64 s[14:15], 61
    s_cbranch_scc0 1
    s_waitcnt vmcnt(2)
    s_cmpk_ge_u32 s8, 2016
    s_cbranch_scc1 .ap_110
    s_waitcnt vmcnt(1)
.ap_110:
    s_add_u32 s63, s69, 434176
    buffer_load_dwordx4 v[76:79], v2, s[44:47], s63 offen nt
    v_perm_b32 v112, v196, v192, s94
    v_perm_b32 v113, v204, v200, s94
    v_perm_b32 v114, v212, v208, s94
    v_perm_b32 v115, v220, v216, s94
    s_nop 1
    v_mfma_f32_16x16x32_bf16 v[128:131], v[100:103], v[112:115], v[128:131]
    v_perm_b32 v116, v196, v192, s95
    v_perm_b32 v117, v204, v200, s95
    v_perm_b32 v118, v212, v208, s95
    v_perm_b32 v119, v220, v216, s95
    s_nop 1
    v_mfma_f32_16x16x32_bf16 v[132:135], v[100:103], v[116:119], v[132:135]
    v_perm_b32 v120, v197, v193, s94
    v_perm_b32 v121, v205, v201, s94
    v_perm_b32 v122, v213, v209, s94
    v_perm_b32 v123, v221, v217, s94
    s_nop 1
    v_mfma_f32_16x16x32_bf16 v[136:139], v[100:103], v[120:123], v[136:139]
    v_perm_b32 v124, v197, v193, s95
    v_perm_b32 v125, v205, v201, s95
    v_perm_b32 v126, v213, v209, s95
    v_perm_b32 v127, v221, v217, s95
    s_nop 1
    v_mfma_f32_16x16x32_bf16 v[140:143], v[100:103], v[124:127], v[140:143]
    v_perm_b32 v112, v198, v194, s94
    v_perm_b32 v113, v206, v202, s94
    v_perm_b32 v114, v214, v210, s94
    v_perm_b32 v115, v222, v218, s94
    s_nop 1
    v_mfma_f32_16x16x32_bf16 v[144:147], v[100:103], v[112:115], v[144:147]
    v_perm_b32 v116, v198, v194, s95
    v_perm_b32 v117, v206, v202, s95
    v_perm_b32 v118, v214, v210, s95
    v_perm_b32 v119, v222, v218, s95
    s_nop 1
    v_mfma_f32_16x16x32_bf16 v[148:151], v[100:103], v[116:119], v[148:151]
    v_perm_b32 v120, v199, v195, s94
    v_perm_b32 v121, v207, v203, s94
    v_perm_b32 v122, v215, v211, s94
    v_perm_b32 v123, v223, v219, s94
    s_nop 1
    v_mfma_f32_16x16x32_bf16 v[152:155], v[100:103], v[120:123], v[152:155]
    v_perm_b32 v124, v199, v195, s95
    v_perm_b32 v125, v207, v203, s95
    v_perm_b32 v126, v215, v211, s95
    v_perm_b32 v127, v223, v219, s95
    s_nop 1
    v_mfma_f32_16x16x32_bf16 v[156:159], v[100:103], v[124:127], v[156:159]
    s_memrealtime s[8:9]
    s_waitcnt lgkmcnt(0)
    s_sub_u32 s8, s8, s30
    s_cmpk_ge_u32 s8, 2187
    s_nop 3
    s_cbranch_scc1 .ap_111
    s_waitcnt vmcnt(5)
    s_cmpk_ge_u32 s8, 2122
    s_cbranch_scc1 .ap_111
    s_waitcnt vmcnt(3)
    s_bitcmp1_b64 s[14:15], 62
    s_cbranch_scc0 1
    s_waitcnt vmcnt(2)
    s_cmpk_ge_u32 s8, 2047
    s_cbranch_scc1 .ap_111
    s_waitcnt vmcnt(1)
.ap_111:
    s_add_u32 s63, s69, 442368
    buffer_load_dwordx4 v[84:87], v2, s[44:47], s63 offen nt
    s_waitcnt vmcnt(7)
    v_perm_b32 v112, v228, v224, s94
    v_perm_b32 v113, v236, v232, s94
    v_perm_b32 v114, v244, v240, s94
    v_perm_b32 v115, v252, v248, s94
    s_nop 1
    v_mfma_f32_16x16x32_bf16 v[128:131], v[104:107], v[112:115], v[128:131]
    v_perm_b32 v116, v228, v224, s95
    v_perm_b32 v117, v236, v232, s95
    v_perm_b32 v118, v244, v240, s95
    v_perm_b32 v119, v252, v248, s95
    s_nop 1
    v_mfma_f32_16x16x32_bf16 v[132:135], v[104:107], v[116:119], v[132:135]
    v_perm_b32 v120, v229, v225, s94
    v_perm_b32 v121, v237, v233, s94
    v_perm_b32 v122, v245, v241, s94
    v_perm_b32 v123, v253, v249, s94
    s_nop 1
    v_mfma_f32_16x16x32_bf16 v[136:139], v[104:107], v[120:123], v[136:139]
    v_perm_b32 v124, v229, v225, s95
    v_perm_b32 v125, v237, v233, s95
    v_perm_b32 v126, v245, v241, s95
    v_perm_b32 v127, v253, v249, s95
    s_nop 1
    v_mfma_f32_16x16x32_bf16 v[140:143], v[104:107], v[124:127], v[140:143]
    v_perm_b32 v112, v230, v226, s94
    v_perm_b32 v113, v238, v234, s94
    v_perm_b32 v114, v246, v242, s94
    v_perm_b32 v115, v254, v250, s94
    s_nop 1
    v_mfma_f32_16x16x32_bf16 v[144:147], v[104:107], v[112:115], v[144:147]
    v_perm_b32 v116, v230, v226, s95
    v_perm_b32 v117, v238, v234, s95
    v_perm_b32 v118, v246, v242, s95
    v_perm_b32 v119, v254, v250, s95
    s_nop 1
    v_mfma_f32_16x16x32_bf16 v[148:151], v[104:107], v[116:119], v[148:151]
    v_perm_b32 v120, v231, v227, s94
    v_perm_b32 v121, v239, v235, s94
    v_perm_b32 v122, v247, v243, s94
    v_perm_b32 v123, v255, v251, s94
    s_nop 1
    v_mfma_f32_16x16x32_bf16 v[152:155], v[104:107], v[120:123], v[152:155]
    v_perm_b32 v124, v231, v227, s95
    v_perm_b32 v125, v239, v235, s95
    v_perm_b32 v126, v247, v243, s95
    v_perm_b32 v127, v255, v251, s95
    s_nop 1
    v_mfma_f32_16x16x32_bf16 v[156:159], v[104:107], v[124:127], v[156:159]
    s_memrealtime s[8:9]
    s_waitcnt lgkmcnt(0)
    s_sub_u32 s8, s8, s30
    s_cmpk_ge_u32 s8, 2218
    s_nop 3
    s_cbranch_scc1 .ap_112
    s_waitcnt vmcnt(5)
    s_cmpk_ge_u32 s8, 2153
    s_cbranch_scc1 .ap_112
    s_waitcnt vmcnt(3)
    s_bitcmp1_b64 s[14:15], 63
    s_cbranch_scc0 1
    s_waitcnt vmcnt(2)
    s_cmpk_ge_u32 s8, 2078
    s_cbranch_scc1 .ap_112
    s_waitcnt vmcnt(1)
.ap_112:
    s_add_u32 s63, s69, 450560
    buffer_load_dwordx4 v[92:95], v2, s[44:47], s63 offen nt
    s_setprio 0
    s_waitcnt vmcnt(6)
    v_perm_b32 v160, v44, v36, s94
    v_perm_b32 v164, v44, v36, s95
    v_perm_b32 v168, v45, v37, s94
    v_perm_b32 v172, v45, v37, s95
    v_perm_b32 v176, v46, v38, s94
    v_perm_b32 v180, v46, v38, s95
    v_perm_b32 v184, v47, v39, s94
    v_perm_b32 v188, v47, v39, s95
    s_waitcnt vmcnt(4)
    v_perm_b32 v161, v60, v52, s94
    v_perm_b32 v165, v60, v52, s95
    v_perm_b32 v169, v61, v53, s94
    v_perm_b32 v173, v61, v53, s95
    v_perm_b32 v177, v62, v54, s94
    v_perm_b32 v181, v62, v54, s95
    v_perm_b32 v185, v63, v55, s94
    v_perm_b32 v189, v63, v55, s95
    s_waitcnt vmcnt(2)
    v_perm_b32 v162, v76, v68, s94
    v_perm_b32 v166, v76, v68, s95
    v_perm_b32 v170, v77, v69, s94
    v_perm_b32 v174, v77, v69, s95
    v_perm_b32 v178, v78, v70, s94
    v_perm_b32 v182, v78, v70, s95
    v_perm_b32 v186, v79, v71, s94
    v_perm_b32 v190, v79, v71, s95
.Ltail_ar:
    s_waitcnt vmcnt(0)
    v_perm_b32 v163, v92, v84, s94
    v_perm_b32 v167, v92, v84, s95
    v_perm_b32 v171, v93, v85, s94
    v_perm_b32 v175, v93, v85, s95
    v_perm_b32 v179, v94, v86, s94
    v_perm_b32 v183, v94, v86, s95
    v_perm_b32 v187, v95, v87, s94
    v_perm_b32 v191, v95, v87, s95
    v_mfma_f32_16x16x32_bf16 v[128:131], v[108:111], v[160:163], v[128:131]
    v_mfma_f32_16x16x32_bf16 v[132:135], v[108:111], v[164:167], v[132:135]
    v_mfma_f32_16x16x32_bf16 v[136:139], v[108:111], v[168:171], v[136:139]
    v_mfma_f32_16x16x32_bf16 v[140:143], v[108:111], v[172:175], v[140:143]
    v_mfma_f32_16x16x32_bf16 v[144:147], v[108:111], v[176:179], v[144:147]
    v_mfma_f32_16x16x32_bf16 v[148:151], v[108:111], v[180:183], v[148:151]
    v_mfma_f32_16x16x32_bf16 v[152:155], v[108:111], v[184:187], v[152:155]
    v_mfma_f32_16x16x32_bf16 v[156:159], v[108:111], v[188:191], v[156:159]
    s_lshl4_add_u32 s56, s67, s66
    s_lshl1_add_u32 s56, s56, s68
    s_lshl_b32 s56, s56, 9
    s_add_u32 s56, s56, 0x210000
    s_mov_b32 s60, 0x07060503
    s_mov_b32 s61, 0x07060502
    s_mov_b32 s62, 0x07060501
    s_mov_b64 exec, 0xffff
    ds_write2_b32 v10, v128, v129 offset0:0 offset1:128
    ds_write2_b32 v10, v132, v133 offset0:1 offset1:129
    ds_write2_b32 v10, v136, v137 offset0:2 offset1:130
    ds_write2_b32 v10, v140, v141 offset0:3 offset1:131
    ds_write2_b32 v10, v144, v145 offset0:4 offset1:132
    ds_write2_b32 v10, v148, v149 offset0:5 offset1:133
    ds_write2_b32 v10, v152, v153 offset0:6 offset1:134
    ds_write2_b32 v10, v156, v157 offset0:7 offset1:135
    s_mov_b64 exec, -1
    s_waitcnt lgkmcnt(0)
    s_barrier
    s_cmp_lg_u32 s3, 7
    s_cbranch_scc1 .opub_113
    ds_read_b128 v[196:199], v9 offset:0
    ds_read_b128 v[200:203], v9 offset:1024
    ds_read_b128 v[204:207], v9 offset:2048
    ds_read_b128 v[208:211], v9 offset:3072
    ds_read_b128 v[212:215], v9 offset:4096
    ds_read_b128 v[216:219], v9 offset:5120
    ds_read_b128 v[220:223], v9 offset:6144
    ds_read_b128 v[224:227], v9 offset:7168
    s_waitcnt lgkmcnt(6)
    v_pk_add_f32 v[196:197], v[196:197], v[200:201]
    v_pk_add_f32 v[198:199], v[198:199], v[202:203]
    s_waitcnt lgkmcnt(4)
    v_pk_add_f32 v[204:205], v[204:205], v[208:209]
    v_pk_add_f32 v[206:207], v[206:207], v[210:211]
    v_pk_add_f32 v[196:197], v[196:197], v[204:205]
    v_pk_add_f32 v[198:199], v[198:199], v[206:207]
    s_waitcnt lgkmcnt(2)
    v_pk_add_f32 v[212:213], v[212:213], v[216:217]
    v_pk_add_f32 v[214:215], v[214:215], v[218:219]
    s_waitcnt lgkmcnt(0)
    v_pk_add_f32 v[220:221], v[220:221], v[224:225]
    v_pk_add_f32 v[222:223], v[222:223], v[226:227]
    v_pk_add_f32 v[212:213], v[212:213], v[220:221]
    v_pk_add_f32 v[214:215], v[214:215], v[222:223]
    v_pk_add_f32 v[196:197], v[196:197], v[212:213]
    v_pk_add_f32 v[198:199], v[198:199], v[214:215]
    v_perm_b32 v12, v196, v199, s60
    v_perm_b32 v13, v197, v199, s61
    v_perm_b32 v14, v198, v199, s62
    s_add_u32 s57, s56, 0xac000
    buffer_store_dwordx4 v[12:15], v11, s[36:39], s57 offen
    buffer_store_dwordx4 v[12:15], v11, s[36:39], s56 offen sc1
.opub_113:
    ds_read_b64_tr_b16 v[160:161], v16 offset:0
    ds_read_b64_tr_b16 v[162:163], v16 offset:512
    ds_read_b64_tr_b16 v[176:177], v17 offset:0
    ds_read_b64_tr_b16 v[178:179], v17 offset:512
    ds_read_b64_tr_b16 v[164:165], v16 offset:4096
    ds_read_b64_tr_b16 v[166:167], v16 offset:4608
    ds_read_b64_tr_b16 v[180:181], v17 offset:4096
    ds_read_b64_tr_b16 v[182:183], v17 offset:4608
    ds_read_b64_tr_b16 v[168:169], v16 offset:8192
    ds_read_b64_tr_b16 v[170:171], v16 offset:8704
    ds_read_b64_tr_b16 v[184:185], v17 offset:8192
    ds_read_b64_tr_b16 v[186:187], v17 offset:8704
    ds_read_b64_tr_b16 v[172:173], v16 offset:12288
    ds_read_b64_tr_b16 v[174:175], v16 offset:12800
    ds_read_b64_tr_b16 v[188:189], v17 offset:12288
    ds_read_b64_tr_b16 v[190:191], v17 offset:12800
    s_lshl_b32 s59, s64, 5
    s_add_u32 s59, s59, s3
    s_lshl_b32 s59, s59, 10
    s_add_u32 s59, s59, 0x210000
    s_mov_b32 s60, 0x04000c0c
    s_mov_b32 s61, 0x0706000c
    v_mov_b32 v143, s34
    s_add_u32 s58, s59, s0
    s_mov_b32 s32, 0
    s_mov_b64 s[88:89], exec
    s_mov_b64 s[90:91], exec
    s_mov_b64 s[92:93], exec
    s_mov_b64 s[56:57], exec
.mp_114:
    s_mov_b64 exec, s[88:89]
    buffer_load_dwordx4 v[192:195], v2, s[36:39], s58 offen offset:0 sc1
    s_mov_b64 exec, s[90:91]
    buffer_load_dwordx4 v[196:199], v7, s[36:39], s58 offen offset:0 sc1
    s_mov_b64 exec, s[92:93]
    buffer_load_dwordx4 v[200:203], v8, s[36:39], s58 offen offset:0 sc1
    s_mov_b64 exec, s[56:57]
    buffer_load_dwordx4 v[204:207], v22, s[36:39], s58 offen offset:0 sc1
    s_mov_b64 exec, -1
    s_sub_u32 s35, s35, 1
    s_cbranch_scc1 .Lexit
    s_add_u32 s32, s32, 1
    s_cmp_eq_u32 s32, 64
    s_cselect_b32 s58, s59, s58
    s_waitcnt vmcnt(0)
.mpj_115:
    v_cmp_ne_u32 s[88:89], s34, v195
    v_cmp_ne_u32 s[90:91], s34, v199
    v_cmp_ne_u32 s[92:93], s34, v203
    v_cmp_ne_u32 s[56:57], s34, v207
    s_or_b64 vcc, s[88:89], s[90:91]
    s_or_b64 vcc, vcc, s[92:93]
    s_or_b64 vcc, vcc, s[56:57]
    s_nop 1
    s_cbranch_scc1 .mp_114
    v_perm_b32 v195, v192, v193, s60
    v_perm_b32 v199, v196, v197, s60
    v_perm_b32 v203, v200, v201, s60
    v_perm_b32 v207, v204, v205, s60
    v_perm_b32 v195, v195, v194, s61
    v_perm_b32 v199, v199, v198, s61
    v_perm_b32 v203, v203, v202, s61
    v_perm_b32 v207, v207, v206, s61
    v_permlane32_swap_b32 v192, v194
    v_permlane32_swap_b32 v193, v195
    v_permlane32_swap_b32 v196, v198
    v_permlane32_swap_b32 v197, v199
    v_permlane32_swap_b32 v200, v202
    v_permlane32_swap_b32 v201, v203
    v_permlane32_swap_b32 v204, v206
    v_permlane32_swap_b32 v205, v207
    v_pk_add_f32 v[192:193], v[192:193], v[194:195]
    v_pk_add_f32 v[196:197], v[196:197], v[198:199]
    v_pk_add_f32 v[200:201], v[200:201], v[202:203]
    v_pk_add_f32 v[204:205], v[204:205], v[206:207]
    v_cvt_pk_bf16_f32 v192, v192, v193
    v_cvt_pk_bf16_f32 v196, v196, v197
    v_cvt_pk_bf16_f32 v200, v200, v201
    v_cvt_pk_bf16_f32 v204, v204, v205
    ds_write2_b32 v18, v192, v196 offset1:64
    ds_write2_b32 v18, v200, v204 offset0:128 offset1:192
    s_mul_i32 s59, s3, 9
    s_add_u32 s59, s59, s65
    s_lshl_b32 s59, s59, 11
    s_add_u32 s58, s59, 0x368000
    s_lshl_b32 s63, s64, 8
    s_add_u32 s63, s63, s58
    s_waitcnt lgkmcnt(0)
    s_barrier
    ds_read_b128 v[224:227], v19 offset:0
    ds_read_b128 v[228:231], v19 offset:64
    ds_read_b128 v[232:235], v19 offset:128
    ds_read_b128 v[236:239], v19 offset:192
    s_waitcnt lgkmcnt(3)
    v_mfma_f32_16x16x32_bf16 v[132:135], v[160:163], v[224:227], 0
    v_mfma_f32_16x16x32_bf16 v[136:139], v[176:179], v[224:227], 0
    s_waitcnt lgkmcnt(2)
    v_mfma_f32_16x16x32_bf16 v[132:135], v[164:167], v[228:231], v[132:135]
    v_mfma_f32_16x16x32_bf16 v[136:139], v[180:183], v[228:231], v[136:139]
    s_waitcnt lgkmcnt(1)
    v_mfma_f32_16x16x32_bf16 v[132:135], v[168:171], v[232:235], v[132:135]
    v_mfma_f32_16x16x32_bf16 v[136:139], v[184:187], v[232:235], v[136:139]
    s_waitcnt lgkmcnt(0)
    v_mfma_f32_16x16x32_bf16 v[132:135], v[172:175], v[236:239], v[132:135]
    v_mfma_f32_16x16x32_bf16 v[136:139], v[188:191], v[236:239], v[136:139]
    s_nop 7
    v_cndmask_b32 v132, v132, v136, s[96:97]
    v_cndmask_b32 v133, v133, v137, s[96:97]
    v_cndmask_b32 v134, v134, v138, s[96:97]
    v_cndmask_b32 v135, v135, v139, s[96:97]
    ds_write_b128 v20, v[132:135]
    s_waitcnt lgkmcnt(0)
    s_barrier
    ds_read_b128 v[224:227], v21 offset:0
    ds_read_b128 v[228:231], v21 offset:2176
    ds_read_b128 v[232:235], v21 offset:4352
    ds_read_b128 v[236:239], v21 offset:6528
    s_mov_b32 s60, 0x07060503
    s_mov_b32 s61, 0x07060502
    s_mov_b32 s62, 0x07060501
    s_waitcnt lgkmcnt(2)
    v_pk_add_f32 v[224:225], v[224:225], v[228:229]
    v_pk_add_f32 v[226:227], v[226:227], v[230:231]
    s_waitcnt lgkmcnt(0)
    v_pk_add_f32 v[232:233], v[232:233], v[236:237]
    v_pk_add_f32 v[234:235], v[234:235], v[238:239]
    v_pk_add_f32 v[224:225], v[224:225], v[232:233]
    v_pk_add_f32 v[226:227], v[226:227], v[234:235]
    v_perm_b32 v140, v224, v227, s60
    v_perm_b32 v141, v225, v227, s61
    v_perm_b32 v142, v226, v227, s62
    s_mov_b64 exec, 0xffff
    buffer_store_dwordx4 v[140:143], v2, s[36:39], s63 offen sc1
    s_mov_b64 exec, -1
    s_barrier
    s_mov_b32 s60, 0x04000c0c
    s_mov_b32 s61, 0x0706000c
    s_mul_i32 s101, s64, 18432
    s_mul_i32 s56, s3, 2304
    s_add_u32 s101, s101, s56
    s_add_u32 s101, s101, 0x250000
    s_lshl_b32 s63, s65, 8
    s_add_u32 s63, s63, s101
    v_mov_b32 v253, s34
    v_mov_b32 v255, s34
    s_mov_b64 s[88:89], exec
    s_mov_b64 s[90:91], exec
.mp_118:
    s_mov_b64 exec, s[88:89]
    buffer_load_dwordx4 v[108:111], v2, s[36:39], s58 offen offset:0 sc1
    s_mov_b64 exec, s[90:91]
    buffer_load_dwordx4 v[112:115], v2, s[36:39], s58 offen offset:1024 sc1
    s_mov_b64 exec, -1
    s_sub_u32 s35, s35, 1
    s_cbranch_scc1 .Lexit
    s_waitcnt vmcnt(0)
.mpj_119:
    v_cmp_ne_u32 s[88:89], s34, v111
    v_cmp_ne_u32 s[90:91], s34, v115
    s_or_b64 vcc, s[88:89], s[90:91]
    s_nop 3
    s_cbranch_scc1 .mp_118
    v_perm_b32 v111, v108, v109, s60
    v_perm_b32 v115, v112, v113, s60
    v_perm_b32 v111, v111, v110, s61
    v_perm_b32 v115, v115, v114, s61
    v_pk_add_f32 v[248:249], v[108:109], v[112:113]
    v_pk_add_f32 v[250:251], v[110:111], v[114:115]
    s_nop 1
    v_permlane32_swap_b32 v248, v250
    v_permlane32_swap_b32 v249, v251
    v_pk_add_f32 v[248:249], v[248:249], v[250:251]
    s_nop 1
    v_permlane16_swap_b32 v248, v249
    v_add_f32 v248, v248, v249
    v_cvt_pk_bf16_f32 v248, v248, v248
    v_lshlrev_b32 v248, 16, v248
    v_mul_f32 v248, v248, v23
    v_cvt_pk_bf16_f32 v248, v248, v248
    v_lshlrev_b32 v248, 16, v248
    v_add_f32 v249, v248, v29
    v_add_f32 v248, v248, v29
    v_mov_b32 v24, v248
    s_nop 0
    v_permlane16_swap_b32 v248, v249
    v_cvt_pk_bf16_f32 v252, v248, v249
    v_cvt_pk_bf16_f32 v254, v248, v249
    s_nop 1
    v_permlane32_swap_b32 v252, v254
    s_mov_b64 exec, 0xffff
    s_add_u32 s57, s63, 0xac000
    buffer_store_dwordx4 v[252:255], v2, s[36:39], s57 offen
    buffer_store_dwordx4 v[252:255], v2, s[36:39], s63 offen sc1
    s_mov_b64 exec, -1
    s_cmp_eq_u32 s3, s64
    s_cbranch_scc1 .r2_122
    s_branch .Lexit
.r2_122:
    v_cvt_pk_bf16_f32 v24, v24, v24
    v_lshlrev_b32 v24, 16, v24
    s_nop 1
    s_branch .gpc_124
.gp_123:
    buffer_load_dwordx4 v[32:35], v2, s[36:39], s99 offen offset:0 sc1
    buffer_load_dwordx4 v[40:43], v2, s[36:39], s99 offen offset:1024 sc1
    buffer_load_dwordx2 v[48:49], v5, s[36:39], s99 offen offset:0 sc1
    buffer_load_dwordx4 v[56:59], v2, s[36:39], s100 offen offset:0 sc1
    buffer_load_dwordx4 v[64:67], v2, s[36:39], s100 offen offset:1024 sc1
    buffer_load_dwordx2 v[50:51], v5, s[36:39], s100 offen offset:0 sc1
    buffer_load_dwordx2 v[74:75], v6, s[36:39], s99 offen offset:0 sc1
    buffer_load_dwordx2 v[80:81], v6, s[36:39], s100 offen offset:0 sc1
    buffer_load_dwordx2 v[82:83], v6, s[36:39], s33 offen offset:0 sc1
    s_waitcnt vmcnt(0)
.gpc_124:
    v_min3_u32 v25, v33, v35, v41
    v_max3_u32 v26, v33, v35, v41
    v_min3_u32 v25, v25, v43, v49
    v_max3_u32 v26, v26, v43, v49
    v_min3_u32 v25, v25, v57, v59
    v_max3_u32 v26, v26, v57, v59
    v_min3_u32 v25, v25, v65, v67
    v_max3_u32 v26, v26, v65, v67
    v_min3_u32 v25, v25, v51, v75
    v_max3_u32 v26, v26, v51, v75
    v_min3_u32 v25, v25, v81, v83
    v_max3_u32 v26, v26, v81, v83
    v_cmp_eq_u32 vcc, s34, v25
    v_cmp_eq_u32 s[56:57], s34, v26
    s_and_b64 vcc, vcc, s[56:57]
    s_cmp_eq_u64 vcc, exec
    s_nop 2
    s_cbranch_scc1 .gpd_125
    s_sub_u32 s35, s35, 1
    s_cbranch_scc1 .Lexit
    s_sleep 2
    s_branch .gp_123
.gpd_125:
    v_lshlrev_b32 v160, 16, v32
    v_and_b32 v161, 0xffff0000, v32
    v_lshlrev_b32 v170, 16, v56
    v_and_b32 v171, 0xffff0000, v56
    v_lshlrev_b32 v162, 16, v34
    v_and_b32 v163, 0xffff0000, v34
    v_lshlrev_b32 v172, 16, v58
    v_and_b32 v173, 0xffff0000, v58
    v_lshlrev_b32 v164, 16, v40
    v_and_b32 v165, 0xffff0000, v40
    v_lshlrev_b32 v174, 16, v64
    v_and_b32 v175, 0xffff0000, v64
    v_lshlrev_b32 v166, 16, v42
    v_and_b32 v167, 0xffff0000, v42
    v_lshlrev_b32 v176, 16, v66
    v_and_b32 v177, 0xffff0000, v66
    v_lshlrev_b32 v168, 16, v48
    v_and_b32 v169, 0xffff0000, v48
    v_lshlrev_b32 v178, 16, v50
    v_and_b32 v179, 0xffff0000, v50
    v_lshlrev_b32 v75, 16, v74
    v_and_b32 v74, 0xffff0000, v74
    s_mov_b32 vcc_lo, 0xffff0000
    s_mov_b32 vcc_hi, 0xffff0000
    v_cndmask_b32 v75, v75, v74, vcc
    v_lshlrev_b32 v81, 16, v80
    v_and_b32 v80, 0xffff0000, v80
    s_mov_b32 vcc_lo, 0xffff0000
    s_mov_b32 vcc_hi, 0xffff0000
    v_cndmask_b32 v81, v81, v80, vcc
    v_lshlrev_b32 v83, 16, v82
    v_and_b32 v82, 0xffff0000, v82
    s_mov_b32 vcc_lo, 0xffff0000
    s_mov_b32 vcc_hi, 0xffff0000
    v_cndmask_b32 v83, v83, v82, vcc
    s_waitcnt vmcnt(0)
    s_add_u32 s58, s101, s0
    s_mov_b32 s32, 0
    s_mov_b64 s[88:89], exec
    s_mov_b64 s[90:91], exec
    s_mov_b64 s[92:93], exec
.mp_126:
    s_mov_b64 exec, s[88:89]
    buffer_load_dwordx4 v[180:183], v2, s[36:39], s58 offen offset:0 sc1
    s_mov_b64 exec, s[90:91]
    buffer_load_dwordx4 v[184:187], v2, s[36:39], s58 offen offset:1024 sc1
    s_mov_b64 exec, s[92:93]
    buffer_load_dwordx2 v[188:189], v5, s[36:39], s58 offen offset:0 sc1
    s_mov_b64 exec, -1
    s_sub_u32 s35, s35, 1
    s_cbranch_scc1 .Lexit
    s_add_u32 s32, s32, 1
    s_cmp_eq_u32 s32, 64
    s_cselect_b32 s58, s101, s58
    s_waitcnt vmcnt(0)
.mpj_127:
    v_cmp_ne_u32 s[88:89], s34, v181
    v_cmp_ne_u32 vcc, s34, v183
    s_or_b64 s[88:89], s[88:89], vcc
    v_cmp_ne_u32 s[90:91], s34, v185
    v_cmp_ne_u32 vcc, s34, v187
    s_or_b64 s[90:91], s[90:91], vcc
    v_cmp_ne_u32 s[92:93], s34, v189
    s_or_b64 vcc, s[88:89], s[90:91]
    s_or_b64 vcc, vcc, s[92:93]
    s_nop 2
    s_cbranch_scc1 .mp_126
    s_mov_b32 s56, 0x3f803f80
    v_dot2_f32_bf16 v200, v180, s56, 0
    v_dot2_f32_bf16 v201, v180, v180, 0
    v_dot2_f32_bf16 v200, v182, s56, v200
    v_dot2_f32_bf16 v201, v182, v182, v201
    v_dot2_f32_bf16 v200, v184, s56, v200
    v_dot2_f32_bf16 v201, v184, v184, v201
    v_dot2_f32_bf16 v200, v186, s56, v200
    v_dot2_f32_bf16 v201, v186, v186, v201
    s_mov_b64 exec, 0xffffffff
    v_dot2_f32_bf16 v200, v188, s56, v200
    v_dot2_f32_bf16 v201, v188, v188, v201
    s_mov_b64 exec, -1
    s_nop 1
    v_permlane32_swap_b32 v200, v201
    v_add_f32 v200, v200, v201
    v_mov_b32 v202, v200
    s_nop 1
    v_permlane16_swap_b32 v202, v200
    v_add_f32 v200, v202, v200
    v_lshlrev_b32 v190, 16, v180
    v_and_b32 v191, 0xffff0000, v180
    v_add_f32_dpp v200, v200, v200 row_ror:8 row_mask:0xf bank_mask:0xf
    v_lshlrev_b32 v192, 16, v182
    v_and_b32 v193, 0xffff0000, v182
    v_add_f32_dpp v200, v200, v200 row_ror:4 row_mask:0xf bank_mask:0xf
    v_lshlrev_b32 v194, 16, v184
    v_and_b32 v195, 0xffff0000, v184
    v_add_f32_dpp v200, v200, v200 quad_perm:[2,3,0,1] row_mask:0xf bank_mask:0xf
    v_lshlrev_b32 v196, 16, v186
    v_and_b32 v197, 0xffff0000, v186
    v_add_f32_dpp v200, v200, v200 quad_perm:[1,0,3,2] row_mask:0xf bank_mask:0xf
    v_mul_f32 v200, 0x3ae38e39, v200
    v_lshlrev_b32 v198, 16, v188
    v_and_b32 v199, 0xffff0000, v188
    v_readlane_b32 s56, v200, 0
    v_readlane_b32 s57, v200, 32
    s_nop 0
    v_mov_b32 v200, s56
    v_fma_f32 v201, -v200, v200, s57
    v_max_f32 v201, 0, v201
    v_cvt_pk_bf16_f32 v202, -v200, v201
    v_and_b32 v203, 0xffff0000, v202
    v_add_f32 v203, 0x3727c5ac, v203
    v_lshlrev_b32 v200, 16, v202
    v_cvt_pk_bf16_f32 v203, v203, v203
    v_lshlrev_b32 v203, 16, v203
    v_sqrt_f32 v203, v203
    v_mov_b32 v201, v200
    v_cvt_pk_bf16_f32 v203, v203, v203
    v_lshlrev_b32 v203, 16, v203
    v_rcp_f32 v202, v203
    v_rcp_f32 v203, v203
    v_pk_add_f32 v[190:191], v[190:191], v[200:201]
    v_pk_add_f32 v[192:193], v[192:193], v[200:201]
    v_pk_add_f32 v[194:195], v[194:195], v[200:201]
    v_pk_add_f32 v[196:197], v[196:197], v[200:201]
    v_pk_add_f32 v[198:199], v[198:199], v[200:201]
    v_cvt_pk_bf16_f32 v190, v190, v191
    v_and_b32 v191, 0xffff0000, v190
    v_lshlrev_b32 v190, 16, v190
    v_cvt_pk_bf16_f32 v192, v192, v193
    v_and_b32 v193, 0xffff0000, v192
    v_lshlrev_b32 v192, 16, v192
    v_cvt_pk_bf16_f32 v194, v194, v195
    v_and_b32 v195, 0xffff0000, v194
    v_lshlrev_b32 v194, 16, v194
    v_cvt_pk_bf16_f32 v196, v196, v197
    v_and_b32 v197, 0xffff0000, v196
    v_lshlrev_b32 v196, 16, v196
    v_cvt_pk_bf16_f32 v198, v198, v199
    v_and_b32 v199, 0xffff0000, v198
    v_lshlrev_b32 v198, 16, v198
    v_pk_mul_f32 v[190:191], v[190:191], v[202:203]
    v_pk_mul_f32 v[192:193], v[192:193], v[202:203]
    v_pk_mul_f32 v[194:195], v[194:195], v[202:203]
    v_pk_mul_f32 v[196:197], v[196:197], v[202:203]
    v_pk_mul_f32 v[198:199], v[198:199], v[202:203]
    v_cvt_pk_bf16_f32 v190, v190, v191
    v_and_b32 v191, 0xffff0000, v190
    v_lshlrev_b32 v190, 16, v190
    v_cvt_pk_bf16_f32 v192, v192, v193
    v_and_b32 v193, 0xffff0000, v192
    v_lshlrev_b32 v192, 16, v192
    v_cvt_pk_bf16_f32 v194, v194, v195
    v_and_b32 v195, 0xffff0000, v194
    v_lshlrev_b32 v194, 16, v194
    v_cvt_pk_bf16_f32 v196, v196, v197
    v_and_b32 v197, 0xffff0000, v196
    v_lshlrev_b32 v196, 16, v196
    v_cvt_pk_bf16_f32 v198, v198, v199
    v_and_b32 v199, 0xffff0000, v198
    v_lshlrev_b32 v198, 16, v198
    v_pk_mul_f32 v[190:191], v[190:191], v[170:171]
    v_pk_mul_f32 v[192:193], v[192:193], v[172:173]
    v_pk_mul_f32 v[194:195], v[194:195], v[174:175]
    v_pk_mul_f32 v[196:197], v[196:197], v[176:177]
    v_pk_mul_f32 v[198:199], v[198:199], v[178:179]
    v_cvt_pk_bf16_f32 v190, v190, v191
    v_and_b32 v191, 0xffff0000, v190
    v_lshlrev_b32 v190, 16, v190
    v_cvt_pk_bf16_f32 v192, v192, v193
    v_and_b32 v193, 0xffff0000, v192
    v_lshlrev_b32 v192, 16, v192
    v_cvt_pk_bf16_f32 v194, v194, v195
    v_and_b32 v195, 0xffff0000, v194
    v_lshlrev_b32 v194, 16, v194
    v_cvt_pk_bf16_f32 v196, v196, v197
    v_and_b32 v197, 0xffff0000, v196
    v_lshlrev_b32 v196, 16, v196
    v_cvt_pk_bf16_f32 v198, v198, v199
    v_and_b32 v199, 0xffff0000, v198
    v_lshlrev_b32 v198, 16, v198
    v_pk_add_f32 v[190:191], v[190:191], v[160:161]
    v_pk_add_f32 v[192:193], v[192:193], v[162:163]
    v_pk_add_f32 v[194:195], v[194:195], v[164:165]
    v_pk_add_f32 v[196:197], v[196:197], v[166:167]
    v_pk_add_f32 v[198:199], v[198:199], v[168:169]
    v_cvt_pk_bf16_f32 v206, v190, v191
    v_cvt_pk_bf16_f32 v207, v192, v193
    v_cvt_pk_bf16_f32 v208, v194, v195
    v_cvt_pk_bf16_f32 v209, v196, v197
    v_cvt_pk_bf16_f32 v210, v198, v199
    v_dot2_f32_bf16 v14, v206, v88, 0
    v_dot2_f32_bf16 v14, v207, v89, v14
    v_dot2_f32_bf16 v14, v208, v90, v14
    v_dot2_f32_bf16 v14, v209, v91, v14
    s_mov_b64 exec, 0xffffffff
    v_dot2_f32_bf16 v14, v210, v30, v14
    s_mov_b64 exec, -1
    s_nop 1
    v_mov_b32 v15, v14
    s_nop 1
    v_permlane32_swap_b32 v15, v14
    v_add_f32 v14, v15, v14
    v_mov_b32 v15, v14
    s_nop 1
    v_permlane16_swap_b32 v15, v14
    v_add_f32 v14, v15, v14
    s_nop 1
    v_add_f32_dpp v14, v14, v14 row_ror:8 row_mask:0xf bank_mask:0xf
    s_nop 1
    v_add_f32_dpp v14, v14, v14 row_ror:4 row_mask:0xf bank_mask:0xf
    s_nop 1
    v_add_f32_dpp v14, v14, v14 quad_perm:[2,3,0,1] row_mask:0xf bank_mask:0xf
    s_nop 1
    v_add_f32_dpp v14, v14, v14 quad_perm:[1,0,3,2] row_mask:0xf bank_mask:0xf
    v_cvt_pk_bf16_f32 v14, v14, v14
    v_lshlrev_b32 v14, 16, v14
    v_max_f32 v14, 0xc2ae0000, v14
    v_min_f32 v14, 0x43000000, v14
    v_mul_f32 v15, 0xbfb8aa3b, v14
    v_fma_f32 v16, v14, s98, -v15
    v_fmac_f32 v16, 0xb2a57060, v14
    v_exp_f32 v15, v15
    v_mul_f32 v16, 0x3f317218, v16
    v_fmac_f32 v15, v15, v16
    v_add_f32 v15, 1.0, v15
    v_rcp_f32 v16, v15
    s_nop 0
    v_fma_f32 v15, -v15, v16, 1.0
    v_fma_f32 v14, v15, v16, v16
    v_cvt_pk_bf16_f32 v14, v14, v14
    v_lshlrev_b32 v14, 16, v14
    v_add_f32 v17, v24, v200
    v_cvt_pk_bf16_f32 v17, v17, v17
    v_lshlrev_b32 v17, 16, v17
    v_mul_f32 v17, v17, v202
    v_cvt_pk_bf16_f32 v17, v17, v17
    v_lshlrev_b32 v17, 16, v17
    v_mul_f32 v17, v17, v81
    v_cvt_pk_bf16_f32 v17, v17, v17
    v_lshlrev_b32 v17, 16, v17
    v_add_f32 v17, v17, v75
    v_cvt_pk_bf16_f32 v17, v17, v17
    v_lshlrev_b32 v17, 16, v17
    s_lshl_b32 s59, s59, 1
    s_add_u32 s58, s59, 0x38c000
    s_mov_b32 s60, 0x04000c0c
    s_mov_b32 s61, 0x0706000c
    s_mov_b32 s48, s28
    s_and_b32 s49, s29, 0xffff
    s_mov_b32 s50, 0x2400
    s_mov_b32 s51, 0x00020000
    s_mul_i32 s63, s3, 1152
    s_mov_b64 s[88:89], exec
    s_mov_b64 s[90:91], exec
    s_mov_b64 s[92:93], exec
    s_mov_b64 s[56:57], exec
.mp_130:
    s_mov_b64 exec, s[88:89]
    buffer_load_dwordx4 v[96:99], v2, s[36:39], s58 offen offset:0 sc1
    s_mov_b64 exec, s[90:91]
    buffer_load_dwordx4 v[100:103], v2, s[36:39], s58 offen offset:1024 sc1
    s_mov_b64 exec, s[92:93]
    buffer_load_dwordx4 v[104:107], v2, s[36:39], s58 offen offset:2048 sc1
    s_mov_b64 exec, s[56:57]
    buffer_load_dwordx4 v[108:111], v2, s[36:39], s58 offen offset:3072 sc1
    s_mov_b64 exec, -1
    s_sub_u32 s35, s35, 1
    s_cbranch_scc1 .Lexit
    s_waitcnt vmcnt(0)
.mpj_131:
    v_cmp_ne_u32 s[88:89], s34, v99
    v_cmp_ne_u32 s[90:91], s34, v103
    v_cmp_ne_u32 s[92:93], s34, v107
    v_cmp_ne_u32 s[56:57], s34, v111
    s_or_b64 vcc, s[88:89], s[90:91]
    s_or_b64 vcc, vcc, s[92:93]
    s_or_b64 vcc, vcc, s[56:57]
    s_nop 1
    s_cbranch_scc1 .mp_130
    v_perm_b32 v99, v96, v97, s60
    v_perm_b32 v103, v100, v101, s60
    v_perm_b32 v107, v104, v105, s60
    v_perm_b32 v111, v108, v109, s60
    v_perm_b32 v99, v99, v98, s61
    v_perm_b32 v103, v103, v102, s61
    v_perm_b32 v107, v107, v106, s61
    v_perm_b32 v111, v111, v110, s61
    v_pk_add_f32 v[96:97], v[96:97], v[100:101]
    v_pk_add_f32 v[98:99], v[98:99], v[102:103]
    v_pk_add_f32 v[248:249], v[104:105], v[108:109]
    v_pk_add_f32 v[250:251], v[106:107], v[110:111]
    v_pk_add_f32 v[248:249], v[248:249], v[96:97]
    v_pk_add_f32 v[250:251], v[250:251], v[98:99]
    s_nop 1
    v_permlane32_swap_b32 v248, v250
    v_permlane32_swap_b32 v249, v251
    v_pk_add_f32 v[248:249], v[248:249], v[250:251]
    s_nop 1
    v_permlane16_swap_b32 v248, v249
    v_add_f32 v248, v248, v249
    v_cvt_pk_bf16_f32 v248, v248, v248
    v_lshlrev_b32 v248, 16, v248
    v_mul_f32 v248, v248, v14
    v_cvt_pk_bf16_f32 v248, v248, v248
    v_lshlrev_b32 v248, 16, v248
    v_add_f32 v248, v248, v17
    v_cvt_pk_bf16_f32 v248, v248, v248
    v_lshlrev_b32 v248, 16, v248
    v_mul_f32 v248, v248, v83
    v_cvt_pk_bf16_f32 v248, v248, v248
    v_lshlrev_b32 v248, 16, v248
    v_add_f32 v248, v248, v24
    v_cvt_pk_bf16_f32 v248, v248, v248
    buffer_store_short v248, v31, s[48:51], s63 offen
    s_cmp_lg_u32 s2, 0
    s_cbranch_scc1 .Lexit
    v_mov_b32 v13, s34
    s_mov_b64 exec, 1
    buffer_store_dword v13, v2, s[36:39], 0 offen
    s_mov_b64 exec, -1
    s_branch .Lexit
.Latt_bc:
    v_and_b32 v8, 1, v0
    v_lshlrev_b32 v8, 8, v8
    v_and_b32 v9, 0x3c, v0
    v_lshl_add_u32 v9, v9, 2, v8
    v_lshlrev_b32 v7, 1, v9
    v_and_b32 v9, 0x3c, v0
    v_lshrrev_b32 v8, 4, v8
    v_and_b32 v9, 2, v0
    v_lshl_add_u32 v9, v9, 6, v8
    s_lshl_b32 s58, s66, 14
    s_lshl_b32 s59, s67, 10
    s_add_u32 s58, s58, s59
    s_add_u32 s58, s58, 0x40000
    s_lshl4_add_u32 s59, s66, s67
    s_lshl_b32 s59, s59, 8
    s_add_u32 s59, s59, 0x200000
    s_memrealtime s[8:9]
    s_waitcnt vmcnt(8)
    s_waitcnt lgkmcnt(0)
    s_sub_u32 s8, s8, s30
    s_cmpk_ge_u32 s8, 1147
    s_cbranch_scc1 .ap_134
    s_waitcnt vmcnt(5)
    s_cmpk_ge_u32 s8, 1082
    s_cbranch_scc1 .ap_134
    s_waitcnt vmcnt(3)
    s_bitcmp1_b64 s[14:15], 26
    s_cbranch_scc0 1
    s_waitcnt vmcnt(2)
    s_cmpk_ge_u32 s8, 1007
    s_cbranch_scc1 .ap_134
    s_waitcnt vmcnt(1)
.ap_134:
    s_add_u32 s63, s69, 409600
    buffer_load_dwordx4 v[88:91], v1, s[40:43], s63 offen nt
    s_memrealtime s[8:9]
    s_waitcnt vmcnt(8)
    s_waitcnt lgkmcnt(0)
    s_sub_u32 s8, s8, s30
    s_cmpk_ge_u32 s8, 1174
    s_cbranch_scc1 .ap_135
    s_waitcnt vmcnt(5)
    s_cmpk_ge_u32 s8, 1109
    s_cbranch_scc1 .ap_135
    s_waitcnt vmcnt(3)
    s_bitcmp1_b64 s[14:15], 27
    s_cbranch_scc0 1
    s_waitcnt vmcnt(2)
    s_cmpk_ge_u32 s8, 1034
    s_cbranch_scc1 .ap_135
    s_waitcnt vmcnt(1)
.ap_135:
    s_add_u32 s63, s69, 417792
    buffer_load_dwordx4 v[92:95], v1, s[40:43], s63 offen nt
    s_memrealtime s[8:9]
    s_waitcnt vmcnt(8)
    s_waitcnt lgkmcnt(0)
    s_sub_u32 s8, s8, s30
    s_cmpk_ge_u32 s8, 1201
    s_cbranch_scc1 .ap_136
    s_waitcnt vmcnt(5)
    s_cmpk_ge_u32 s8, 1136
    s_cbranch_scc1 .ap_136
    s_waitcnt vmcnt(3)
    s_bitcmp1_b64 s[14:15], 28
    s_cbranch_scc0 1
    s_waitcnt vmcnt(2)
    s_cmpk_ge_u32 s8, 1061
    s_cbranch_scc1 .ap_136
    s_waitcnt vmcnt(1)
.ap_136:
    s_add_u32 s63, s69, 425984
    buffer_load_dwordx4 v[120:123], v1, s[40:43], s63 offen nt
    s_memrealtime s[8:9]
    s_waitcnt vmcnt(8)
    s_waitcnt lgkmcnt(0)
    s_sub_u32 s8, s8, s30
    s_cmpk_ge_u32 s8, 1228
    s_cbranch_scc1 .ap_137
    s_waitcnt vmcnt(5)
    s_cmpk_ge_u32 s8, 1163
    s_cbranch_scc1 .ap_137
    s_waitcnt vmcnt(3)
    s_bitcmp1_b64 s[14:15], 29
    s_cbranch_scc0 1
    s_waitcnt vmcnt(2)
    s_cmpk_ge_u32 s8, 1088
    s_cbranch_scc1 .ap_137
    s_waitcnt vmcnt(1)
.ap_137:
    s_add_u32 s63, s69, 434176
    buffer_load_dwordx4 v[124:127], v1, s[40:43], s63 offen nt
    s_memrealtime s[8:9]
    s_waitcnt vmcnt(8)
    s_waitcnt lgkmcnt(0)
    s_sub_u32 s8, s8, s30
    s_cmpk_ge_u32 s8, 1255
    s_cbranch_scc1 .ap_138
    s_waitcnt vmcnt(5)
    s_cmpk_ge_u32 s8, 1190
    s_cbranch_scc1 .ap_138
    s_waitcnt vmcnt(3)
    s_bitcmp1_b64 s[14:15], 30
    s_cbranch_scc0 1
    s_waitcnt vmcnt(2)
    s_cmpk_ge_u32 s8, 1115
    s_cbranch_scc1 .ap_138
    s_waitcnt vmcnt(1)
.ap_138:
    s_add_u32 s63, s69, 442368
    buffer_load_dwordx4 v[152:155], v1, s[40:43], s63 offen nt
    s_memrealtime s[8:9]
    s_waitcnt vmcnt(8)
    s_waitcnt lgkmcnt(0)
    s_sub_u32 s8, s8, s30
    s_cmpk_ge_u32 s8, 1282
    s_cbranch_scc1 .ap_139
    s_waitcnt vmcnt(5)
    s_cmpk_ge_u32 s8, 1217
    s_cbranch_scc1 .ap_139
    s_waitcnt vmcnt(3)
    s_bitcmp1_b64 s[14:15], 31
    s_cbranch_scc0 1
    s_waitcnt vmcnt(2)
    s_cmpk_ge_u32 s8, 1142
    s_cbranch_scc1 .ap_139
    s_waitcnt vmcnt(1)
.ap_139:
    s_add_u32 s63, s69, 450560
    buffer_load_dwordx4 v[156:159], v1, s[40:43], s63 offen nt
    buffer_load_dwordx4 v[16:19], v7, s[36:39], s58 offen offset:0 sc1
    buffer_load_dwordx4 v[20:23], v7, s[36:39], s58 offen offset:16 sc1
    s_memrealtime s[8:9]
    s_waitcnt vmcnt(8)
    s_waitcnt lgkmcnt(0)
    s_sub_u32 s8, s8, s30
    s_cmpk_ge_u32 s8, 1309
    s_cbranch_scc1 .ap_140
    s_waitcnt vmcnt(5)
    s_cmpk_ge_u32 s8, 1244
    s_cbranch_scc1 .ap_140
    s_waitcnt vmcnt(3)
    s_bitcmp1_b64 s[14:15], 32
    s_cbranch_scc0 1
    s_waitcnt vmcnt(2)
    s_cmpk_ge_u32 s8, 1169
    s_cbranch_scc1 .ap_140
    s_waitcnt vmcnt(1)
.ap_140:
    s_add_u32 s63, s69, 0
    buffer_load_dwordx4 v[160:163], v2, s[44:47], s63 offen nt
    s_memrealtime s[8:9]
    s_waitcnt vmcnt(8)
    s_waitcnt lgkmcnt(0)
    s_sub_u32 s8, s8, s30
    s_cmpk_ge_u32 s8, 1336
    s_cbranch_scc1 .ap_141
    s_waitcnt vmcnt(5)
    s_cmpk_ge_u32 s8, 1271
    s_cbranch_scc1 .ap_141
    s_waitcnt vmcnt(3)
    s_bitcmp1_b64 s[14:15], 33
    s_cbranch_scc0 1
    s_waitcnt vmcnt(2)
    s_cmpk_ge_u32 s8, 1196
    s_cbranch_scc1 .ap_141
    s_waitcnt vmcnt(1)
.ap_141:
    s_add_u32 s63, s69, 8192
    buffer_load_dwordx4 v[164:167], v2, s[44:47], s63 offen nt
    s_memrealtime s[8:9]
    s_waitcnt vmcnt(8)
    s_waitcnt lgkmcnt(0)
    s_sub_u32 s8, s8, s30
    s_cmpk_ge_u32 s8, 1363
    s_cbranch_scc1 .ap_142
    s_waitcnt vmcnt(5)
    s_cmpk_ge_u32 s8, 1298
    s_cbranch_scc1 .ap_142
    s_waitcnt vmcnt(3)
    s_bitcmp1_b64 s[14:15], 34
    s_cbranch_scc0 1
    s_waitcnt vmcnt(2)
    s_cmpk_ge_u32 s8, 1223
    s_cbranch_scc1 .ap_142
    s_waitcnt vmcnt(1)
.ap_142:
    s_add_u32 s63, s69, 16384
    buffer_load_dwordx4 v[168:171], v2, s[44:47], s63 offen nt
    s_waitcnt vmcnt(3)
    s_branch .gpc_144
.gp_143:
    buffer_load_dwordx4 v[16:19], v7, s[36:39], s58 offen offset:0 sc1
    buffer_load_dwordx4 v[20:23], v7, s[36:39], s58 offen offset:16 sc1
    s_waitcnt vmcnt(0)
.gpc_144:
    v_min_u32 v10, v17, v19
    v_max_u32 v11, v17, v19
    v_min3_u32 v10, v10, v21, v23
    v_max3_u32 v11, v11, v21, v23
    v_cmp_eq_u32 vcc, s34, v10
    v_cmp_eq_u32 s[56:57], s34, v11
    s_and_b64 vcc, vcc, s[56:57]
    s_cmp_eq_u64 vcc, exec
    s_nop 2
    s_cbranch_scc1 .gpd_145
    s_sub_u32 s35, s35, 1
    s_cbranch_scc1 .Lexit
    s_sleep 1
    s_branch .gp_143
.gpd_145:
    s_mov_b32 vcc_lo, 0xcccccccc
    s_mov_b32 vcc_hi, 0xcccccccc
    v_cndmask_b32_e64 v24, v16, 0, vcc
    v_cndmask_b32_e64 v25, v18, 0, vcc
    v_cndmask_b32_e64 v26, v20, 0, vcc
    v_cndmask_b32_e64 v27, v22, 0, vcc
    v_cndmask_b32_e32 v28, 0, v16, vcc
    v_cndmask_b32_e32 v29, 0, v18, vcc
    v_cndmask_b32_e32 v30, 0, v20, vcc
    v_cndmask_b32_e32 v31, 0, v22, vcc
    v_mfma_f32_16x16x32_bf16 v[16:19], v[32:35], v[24:27], 0
    v_mfma_f32_16x16x32_bf16 v[32:35], v[40:43], v[24:27], 0
    v_mfma_f32_16x16x32_bf16 v[16:19], v[36:39], v[28:31], v[16:19]
    v_mfma_f32_16x16x32_bf16 v[40:43], v[48:51], v[24:27], 0
    v_mfma_f32_16x16x32_bf16 v[32:35], v[44:47], v[28:31], v[32:35]
    v_mfma_f32_16x16x32_bf16 v[48:51], v[56:59], v[24:27], 0
    v_mfma_f32_16x16x32_bf16 v[40:43], v[52:55], v[28:31], v[40:43]
    v_mfma_f32_16x16x32_bf16 v[56:59], v[64:67], v[24:27], 0
    v_mfma_f32_16x16x32_bf16 v[48:51], v[60:63], v[28:31], v[48:51]
    s_nop 1
    v_add_f32_dpp v10, v17, v16 row_ror:12 row_mask:0xf bank_mask:0x1
    s_memrealtime s[8:9]
    s_waitcnt lgkmcnt(0)
    s_sub_u32 s8, s8, s30
    s_cmpk_ge_u32 s8, 1390
    s_nop 0
    s_cbranch_scc1 .ap_146
    s_waitcnt vmcnt(3)
    s_cmpk_ge_u32 s8, 1325
    s_cbranch_scc1 .ap_146
    s_waitcnt vmcnt(3)
    s_bitcmp1_b64 s[14:15], 35
    s_cbranch_scc0 1
    s_waitcnt vmcnt(2)
    s_cmpk_ge_u32 s8, 1250
    s_cbranch_scc1 .ap_146
    s_waitcnt vmcnt(1)
.ap_146:
    s_add_u32 s63, s69, 24576
    buffer_load_dwordx4 v[172:175], v2, s[44:47], s63 offen nt
    v_mfma_f32_16x16x32_bf16 v[64:67], v[72:75], v[24:27], 0
    v_mfma_f32_16x16x32_bf16 v[56:59], v[68:71], v[28:31], v[56:59]
    v_add_f32_dpp v11, v33, v32 row_ror:12 row_mask:0xf bank_mask:0x1
    v_add_f32_dpp v10, v18, v10 row_ror:8 row_mask:0xf bank_mask:0x1
    v_mfma_f32_16x16x32_bf16 v[72:75], v[80:83], v[24:27], 0
    v_mfma_f32_16x16x32_bf16 v[64:67], v[76:79], v[28:31], v[64:67]
    v_add_f32_dpp v12, v41, v40 row_ror:12 row_mask:0xf bank_mask:0x1
    v_add_f32_dpp v11, v34, v11 row_ror:8 row_mask:0xf bank_mask:0x1
    v_add_f32_dpp v10, v19, v10 row_ror:4 row_mask:0xf bank_mask:0x1
    v_mfma_f32_16x16x32_bf16 v[80:83], v[88:91], v[24:27], 0
    v_mfma_f32_16x16x32_bf16 v[72:75], v[84:87], v[28:31], v[72:75]
    v_add_f32_dpp v13, v49, v48 row_ror:12 row_mask:0xf bank_mask:0x1
    v_add_f32_dpp v12, v42, v12 row_ror:8 row_mask:0xf bank_mask:0x1
    v_add_f32_dpp v11, v35, v11 row_ror:4 row_mask:0xf bank_mask:0x1
    v_mfma_f32_16x16x32_bf16 v[88:91], v[96:99], v[24:27], 0
    v_mfma_f32_16x16x32_bf16 v[80:83], v[92:95], v[28:31], v[80:83]
    v_add_f32_dpp v10, v58, v57 row_ror:12 row_mask:0xf bank_mask:0x2
    v_add_f32_dpp v13, v50, v13 row_ror:8 row_mask:0xf bank_mask:0x1
    v_add_f32_dpp v12, v43, v12 row_ror:4 row_mask:0xf bank_mask:0x1
    s_memrealtime s[8:9]
    s_waitcnt lgkmcnt(0)
    s_sub_u32 s8, s8, s30
    s_cmpk_ge_u32 s8, 1417
    s_nop 0
    s_cbranch_scc1 .ap_147
    s_waitcnt vmcnt(4)
    s_cmpk_ge_u32 s8, 1352
    s_cbranch_scc1 .ap_147
    s_waitcnt vmcnt(3)
    s_bitcmp1_b64 s[14:15], 36
    s_cbranch_scc0 1
    s_waitcnt vmcnt(2)
    s_cmpk_ge_u32 s8, 1277
    s_cbranch_scc1 .ap_147
    s_waitcnt vmcnt(1)
.ap_147:
    s_add_u32 s63, s69, 32768
    buffer_load_dwordx4 v[176:179], v2, s[44:47], s63 offen nt
    v_mfma_f32_16x16x32_bf16 v[96:99], v[104:107], v[24:27], 0
    v_mfma_f32_16x16x32_bf16 v[88:91], v[100:103], v[28:31], v[88:91]
    v_add_f32_dpp v11, v66, v65 row_ror:12 row_mask:0xf bank_mask:0x2
    v_add_f32_dpp v10, v59, v10 row_ror:8 row_mask:0xf bank_mask:0x2
    v_add_f32_dpp v13, v51, v13 row_ror:4 row_mask:0xf bank_mask:0x1
    v_mfma_f32_16x16x32_bf16 v[104:107], v[112:115], v[24:27], 0
    v_mfma_f32_16x16x32_bf16 v[96:99], v[108:111], v[28:31], v[96:99]
    v_add_f32_dpp v12, v74, v73 row_ror:12 row_mask:0xf bank_mask:0x2
    v_add_f32_dpp v11, v67, v11 row_ror:8 row_mask:0xf bank_mask:0x2
    v_add_f32_dpp v10, v56, v10 row_ror:4 row_mask:0xf bank_mask:0x2
    v_mfma_f32_16x16x32_bf16 v[112:115], v[120:123], v[24:27], 0
    v_mfma_f32_16x16x32_bf16 v[104:107], v[116:119], v[28:31], v[104:107]
    v_add_f32_dpp v13, v82, v81 row_ror:12 row_mask:0xf bank_mask:0x2
    v_add_f32_dpp v12, v75, v12 row_ror:8 row_mask:0xf bank_mask:0x2
    v_add_f32_dpp v11, v64, v11 row_ror:4 row_mask:0xf bank_mask:0x2
    v_mfma_f32_16x16x32_bf16 v[120:123], v[128:131], v[24:27], 0
    v_mfma_f32_16x16x32_bf16 v[112:115], v[124:127], v[28:31], v[112:115]
    v_add_f32_dpp v10, v91, v90 row_ror:12 row_mask:0xf bank_mask:0x4
    v_add_f32_dpp v13, v83, v13 row_ror:8 row_mask:0xf bank_mask:0x2
    v_add_f32_dpp v12, v72, v12 row_ror:4 row_mask:0xf bank_mask:0x2
    s_memrealtime s[8:9]
    s_waitcnt lgkmcnt(0)
    s_sub_u32 s8, s8, s30
    s_cmpk_ge_u32 s8, 1444
    s_nop 0
    s_cbranch_scc1 .ap_148
    s_waitcnt vmcnt(5)
    s_cmpk_ge_u32 s8, 1379
    s_cbranch_scc1 .ap_148
    s_waitcnt vmcnt(3)
    s_bitcmp1_b64 s[14:15], 37
    s_cbranch_scc0 1
    s_waitcnt vmcnt(2)
    s_cmpk_ge_u32 s8, 1304
    s_cbranch_scc1 .ap_148
    s_waitcnt vmcnt(1)
.ap_148:
    s_add_u32 s63, s69, 40960
    buffer_load_dwordx4 v[180:183], v2, s[44:47], s63 offen nt
    v_mfma_f32_16x16x32_bf16 v[128:131], v[136:139], v[24:27], 0
    v_mfma_f32_16x16x32_bf16 v[120:123], v[132:135], v[28:31], v[120:123]
    v_add_f32_dpp v11, v99, v98 row_ror:12 row_mask:0xf bank_mask:0x4
    v_add_f32_dpp v10, v88, v10 row_ror:8 row_mask:0xf bank_mask:0x4
    v_add_f32_dpp v13, v80, v13 row_ror:4 row_mask:0xf bank_mask:0x2
    v_mfma_f32_16x16x32_bf16 v[136:139], v[144:147], v[24:27], 0
    v_mfma_f32_16x16x32_bf16 v[128:131], v[140:143], v[28:31], v[128:131]
    v_add_f32_dpp v12, v107, v106 row_ror:12 row_mask:0xf bank_mask:0x4
    v_add_f32_dpp v11, v96, v11 row_ror:8 row_mask:0xf bank_mask:0x4
    v_add_f32_dpp v10, v89, v10 row_ror:4 row_mask:0xf bank_mask:0x4
    v_mfma_f32_16x16x32_bf16 v[144:147], v[152:155], v[24:27], 0
    v_mfma_f32_16x16x32_bf16 v[136:139], v[148:151], v[28:31], v[136:139]
    v_add_f32_dpp v13, v115, v114 row_ror:12 row_mask:0xf bank_mask:0x4
    v_add_f32_dpp v12, v104, v12 row_ror:8 row_mask:0xf bank_mask:0x4
    v_add_f32_dpp v11, v97, v11 row_ror:4 row_mask:0xf bank_mask:0x4
    v_mfma_f32_16x16x32_bf16 v[144:147], v[156:159], v[28:31], v[144:147]
    v_add_f32_dpp v10, v120, v123 row_ror:12 row_mask:0xf bank_mask:0x8
    v_add_f32_dpp v13, v112, v13 row_ror:8 row_mask:0xf bank_mask:0x4
    v_add_f32_dpp v12, v105, v12 row_ror:4 row_mask:0xf bank_mask:0x4
    s_memrealtime s[8:9]
    s_waitcnt lgkmcnt(0)
    s_sub_u32 s8, s8, s30
    s_cmpk_ge_u32 s8, 1471
    s_nop 0
    s_cbranch_scc1 .ap_149
    s_waitcnt vmcnt(5)
    s_cmpk_ge_u32 s8, 1406
    s_cbranch_scc1 .ap_149
    s_waitcnt vmcnt(3)
    s_bitcmp1_b64 s[14:15], 38
    s_cbranch_scc0 1
    s_waitcnt vmcnt(2)
    s_cmpk_ge_u32 s8, 1331
    s_cbranch_scc1 .ap_149
    s_waitcnt vmcnt(1)
.ap_149:
    s_add_u32 s63, s69, 49152
    buffer_load_dwordx4 v[184:187], v2, s[44:47], s63 offen nt
    v_add_f32_dpp v11, v128, v131 row_ror:12 row_mask:0xf bank_mask:0x8
    v_add_f32_dpp v10, v121, v10 row_ror:8 row_mask:0xf bank_mask:0x8
    v_add_f32_dpp v13, v113, v13 row_ror:4 row_mask:0xf bank_mask:0x4
    v_add_f32_dpp v12, v136, v139 row_ror:12 row_mask:0xf bank_mask:0x8
    v_add_f32_dpp v11, v129, v11 row_ror:8 row_mask:0xf bank_mask:0x8
    v_add_f32_dpp v10, v122, v10 row_ror:4 row_mask:0xf bank_mask:0x8
    v_add_f32_dpp v13, v144, v147 row_ror:12 row_mask:0xf bank_mask:0x8
    v_add_f32_dpp v12, v137, v12 row_ror:8 row_mask:0xf bank_mask:0x8
    v_add_f32_dpp v11, v130, v11 row_ror:4 row_mask:0xf bank_mask:0x8
    v_add_f32_dpp v13, v145, v13 row_ror:8 row_mask:0xf bank_mask:0x8
    v_add_f32_dpp v12, v138, v12 row_ror:4 row_mask:0xf bank_mask:0x8
    s_memrealtime s[8:9]
    s_waitcnt lgkmcnt(0)
    s_sub_u32 s8, s8, s30
    s_cmpk_ge_u32 s8, 1498
    s_cbranch_scc1 .ap_150
    s_waitcnt vmcnt(5)
    s_cmpk_ge_u32 s8, 1433
    s_cbranch_scc1 .ap_150
    s_waitcnt vmcnt(3)
    s_bitcmp1_b64 s[14:15], 39
    s_cbranch_scc0 1
    s_waitcnt vmcnt(2)
    s_cmpk_ge_u32 s8, 1358
    s_cbranch_scc1 .ap_150
    s_waitcnt vmcnt(1)
.ap_150:
    s_add_u32 s63, s69, 57344
    buffer_load_dwordx4 v[188:191], v2, s[44:47], s63 offen nt
    v_add_f32_dpp v13, v146, v13 row_ror:4 row_mask:0xf bank_mask:0x8
    s_mov_b32 s60, 0x3db504f3
    s_mov_b32 s61, 0x3db504f3
    v_cvt_pk_bf16_f32 v10, v10, v11
    v_and_b32 v11, 0xffff0000, v10
    v_lshlrev_b32 v10, 16, v10
    v_cvt_pk_bf16_f32 v12, v12, v13
    v_and_b32 v13, 0xffff0000, v12
    v_lshlrev_b32 v12, 16, v12
    v_pk_mul_f32 v[10:11], v[10:11], s[60:61]
    v_pk_mul_f32 v[12:13], v[12:13], s[60:61]
    v_cvt_pk_bf16_f32 v10, v10, v11
    v_and_b32 v11, 0xffff0000, v10
    v_lshlrev_b32 v10, 16, v10
    v_cvt_pk_bf16_f32 v12, v12, v13
    v_and_b32 v13, 0xffff0000, v12
    v_lshlrev_b32 v12, 16, v12
    v_max_f32 v14, v10, v11
    v_max3_f32 v14, v14, v12, v13
    s_mov_b32 s60, 0x3fb8aa3b
    v_mov_b32 v22, s34
    v_mov_b32 v23, s34
    v_max_f32_dpp v14, v14, v14 quad_perm:[2,3,0,1] row_mask:0xf bank_mask:0xf
    s_nop 1
    v_max_f32_dpp v14, v14, v14 row_ror:4 row_mask:0xf bank_mask:0xf
    s_nop 1
    v_max_f32_dpp v14, v14, v14 row_ror:8 row_mask:0xf bank_mask:0xf
    v_mov_b32 v15, v14
    s_nop 1
    v_permlane16_swap_b32 v15, v14
    v_max_f32 v14, v15, v14
    v_mov_b32 v15, v14
    s_nop 1
    v_permlane32_swap_b32 v15, v14
    v_max_f32 v14, v15, v14
    v_mul_f32 v15, 0xbfb8aa3b, v14
    v_fma_f32 v10, v10, s60, v15
    v_fma_f32 v11, v11, s60, v15
    v_fma_f32 v12, v12, s60, v15
    v_fma_f32 v13, v13, s60, v15
    v_exp_f32 v10, v10
    v_exp_f32 v11, v11
    v_exp_f32 v12, v12
    v_exp_f32 v13, v13
    v_mov_b32 v20, v14
    v_pk_add_f32 v[16:17], v[10:11], v[12:13]
    v_add_f32 v21, v16, v17
    s_lshl3_add_u32 s60, s68, s3
    s_lshl_b32 s60, s60, 5
    s_add_u32 s60, s60, s59
    v_add_f32_dpp v21, v21, v21 quad_perm:[2,3,0,1] row_mask:0xf bank_mask:0xf
    s_nop 1
    v_add_f32_dpp v21, v21, v21 row_ror:4 row_mask:0xf bank_mask:0xf
    s_nop 1
    v_add_f32_dpp v21, v21, v21 row_ror:8 row_mask:0xf bank_mask:0xf
    v_mov_b32 v15, v21
    s_nop 1
    v_permlane16_swap_b32 v15, v21
    v_add_f32 v21, v15, v21
    v_mov_b32 v15, v21
    s_nop 1
    v_permlane32_swap_b32 v15, v21
    v_add_f32 v21, v15, v21
    s_lshl_b32 s60, s3, 4
    s_add_u32 s60, s60, 159104
    v_add_u32 v16, s60, v3
    v_mov_b32 v17, 159232
    v_mov_b32 v18, 1
    s_mov_b64 exec, 3
    ds_write_b64 v16, v[20:21]
    s_mov_b64 exec, 1
    s_waitcnt lgkmcnt(0)
    ds_add_rtn_u32 v18, v17, v18
    s_mov_b64 exec, -1
    v_and_b32 v16, 0x78, v3
    v_add_u32 v16, 159104, v16
    s_waitcnt lgkmcnt(0)
    v_readfirstlane_b32 s60, v18
    s_cmp_lg_u32 s60, 7
    s_nop 3
    s_cbranch_scc1 .ml_151
    ds_read_b64 v[18:19], v16
    s_lshl_b32 s60, s68, 7
    s_add_u32 s60, s60, s59
    s_waitcnt lgkmcnt(0)
    v_mov_b32 v20, v18
    s_nop 1
    v_max_f32_dpp v20, v20, v20 quad_perm:[2,3,0,1] row_mask:0xf bank_mask:0xf
    s_nop 1
    v_max_f32_dpp v20, v20, v20 row_ror:4 row_mask:0xf bank_mask:0xf
    s_nop 1
    v_max_f32_dpp v20, v20, v20 row_ror:8 row_mask:0xf bank_mask:0xf
    v_sub_f32 v18, v18, v20
    v_mul_f32 v18, 0x3fb8aa3b, v18
    v_exp_f32 v18, v18
    s_nop 0
    v_mul_f32 v21, v18, v19
    s_nop 1
    v_add_f32_dpp v21, v21, v21 quad_perm:[2,3,0,1] row_mask:0xf bank_mask:0xf
    s_nop 1
    v_add_f32_dpp v21, v21, v21 row_ror:4 row_mask:0xf bank_mask:0xf
    s_nop 1
    v_add_f32_dpp v21, v21, v21 row_ror:8 row_mask:0xf bank_mask:0xf
    s_mov_b64 exec, 0xff
    buffer_store_dwordx4 v[20:23], v2, s[36:39], s60 offen sc1
    s_mov_b64 exec, -1
.ml_151:
    s_memrealtime s[8:9]
    s_waitcnt lgkmcnt(0)
    s_sub_u32 s8, s8, s30
    s_cmpk_ge_u32 s8, 1525
    s_cbranch_scc1 .ap_152
    s_waitcnt vmcnt(5)
    s_cmpk_ge_u32 s8, 1460
    s_cbranch_scc1 .ap_152
    s_waitcnt vmcnt(3)
    s_bitcmp1_b64 s[14:15], 40
    s_cbranch_scc0 1
    s_waitcnt vmcnt(2)
    s_cmpk_ge_u32 s8, 1385
    s_cbranch_scc1 .ap_152
    s_waitcnt vmcnt(1)
.ap_152:
    s_add_u32 s63, s69, 131072
    buffer_load_dwordx4 v[192:195], v2, s[44:47], s63 offen nt
    s_sub_u32 s57, s65, 9
    s_bitcmp1_b32 s57, 0
    s_cselect_b32 s48, s20, s18
    s_cselect_b32 s49, s21, s19
    s_cselect_b32 s33, 36, 0
    s_and_b32 s49, s49, 0xffff
    s_mov_b32 s50, 0x510000
    s_mov_b32 s51, 0x00020000
    s_mov_b32 s52, s22
    s_and_b32 s53, s23, 0xffff
    s_mov_b32 s54, 0x510000
    s_mov_b32 s55, 0x00020000
    s_lshr_b32 s57, s57, 1
    s_lshl_b32 s57, s57, 7
    s_mul_i32 s101, s64, 1152
    s_add_u32 s101, s101, s57
    s_mul_i32 s56, s3, 73728
    s_add_u32 s101, s101, s56
    s_mul_i32 s56, s64, 72
    s_add_u32 s33, s33, s56
    s_add_u32 s33, s33, s3
    s_mul_i32 s33, s33, 9216
    s_add_u32 s33, s33, s57
    s_bfe_u32 s56, s101, 0x30007
    s_cmp_eq_u32 s56, 3
    s_cselect_b32 s43, 1, 0
    v_bfe_u32 v16, v0, 4, 1
    s_and_b32 s56, s3, 3
    s_lshl_b32 s56, s56, 1
    v_or_b32 v16, s56, v16
    v_and_b32 v6, 7, v0
    v_xor_b32 v16, v16, v6
    v_lshrrev_b32 v6, 3, v0
    v_mul_u32_u24 v6, 9216, v6
    v_lshl_add_u32 v6, v16, 4, v6
    v_bfe_u32 v16, v0, 4, 1
    s_and_b32 s56, s3, 1
    s_lshl_b32 s56, s56, 2
    v_lshl_or_b32 v16, v16, 1, s56
    v_and_b32 v17, 7, v0
    v_xor_b32 v16, v16, v17
    v_lshrrev_b32 v17, 3, v0
    v_mul_u32_u24 v17, 1152, v17
    v_lshl_add_u32 v31, v16, 4, v17
    s_memrealtime s[8:9]
    s_waitcnt vmcnt(8)
    s_waitcnt lgkmcnt(0)
    s_sub_u32 s8, s8, s30
    s_cmpk_ge_u32 s8, 1552
    s_cbranch_scc1 .ap_153
    s_waitcnt vmcnt(5)
    s_cmpk_ge_u32 s8, 1487
    s_cbranch_scc1 .ap_153
    s_waitcnt vmcnt(3)
    s_bitcmp1_b64 s[14:15], 41
    s_cbranch_scc0 1
    s_waitcnt vmcnt(2)
    s_cmpk_ge_u32 s8, 1412
    s_cbranch_scc1 .ap_153
    s_waitcnt vmcnt(1)
.ap_153:
    s_add_u32 s63, s69, 139264
    buffer_load_dwordx4 v[196:199], v2, s[44:47], s63 offen nt
    s_memrealtime s[8:9]
    s_waitcnt vmcnt(8)
    s_waitcnt lgkmcnt(0)
    s_sub_u32 s8, s8, s30
    s_cmpk_ge_u32 s8, 1579
    s_cbranch_scc1 .ap_154
    s_waitcnt vmcnt(5)
    s_cmpk_ge_u32 s8, 1514
    s_cbranch_scc1 .ap_154
    s_waitcnt vmcnt(3)
    s_bitcmp1_b64 s[14:15], 42
    s_cbranch_scc0 1
    s_waitcnt vmcnt(2)
    s_cmpk_ge_u32 s8, 1439
    s_cbranch_scc1 .ap_154
    s_waitcnt vmcnt(1)
.ap_154:
    s_add_u32 s63, s69, 147456
    buffer_load_dwordx4 v[200:203], v2, s[44:47], s63 offen nt
    s_memrealtime s[8:9]
    s_waitcnt vmcnt(8)
    s_waitcnt lgkmcnt(0)
    s_sub_u32 s8, s8, s30
    s_cmpk_ge_u32 s8, 1606
    s_cbranch_scc1 .ap_155
    s_waitcnt vmcnt(5)
    s_cmpk_ge_u32 s8, 1541
    s_cbranch_scc1 .ap_155
    s_waitcnt vmcnt(3)
    s_bitcmp1_b64 s[14:15], 43
    s_cbranch_scc0 1
    s_waitcnt vmcnt(2)
    s_cmpk_ge_u32 s8, 1466
    s_cbranch_scc1 .ap_155
    s_waitcnt vmcnt(1)
.ap_155:
    s_add_u32 s63, s69, 155648
    buffer_load_dwordx4 v[204:207], v2, s[44:47], s63 offen nt
    s_memrealtime s[8:9]
    s_waitcnt vmcnt(8)
    s_waitcnt lgkmcnt(0)
    s_sub_u32 s8, s8, s30
    s_cmpk_ge_u32 s8, 1633
    s_cbranch_scc1 .ap_156
    s_waitcnt vmcnt(5)
    s_cmpk_ge_u32 s8, 1568
    s_cbranch_scc1 .ap_156
    s_waitcnt vmcnt(3)
    s_bitcmp1_b64 s[14:15], 44
    s_cbranch_scc0 1
    s_waitcnt vmcnt(2)
    s_cmpk_ge_u32 s8, 1493
    s_cbranch_scc1 .ap_156
    s_waitcnt vmcnt(1)
.ap_156:
    s_add_u32 s63, s69, 163840
    buffer_load_dwordx4 v[208:211], v2, s[44:47], s63 offen nt
    s_memrealtime s[8:9]
    s_waitcnt vmcnt(8)
    s_waitcnt lgkmcnt(0)
    s_sub_u32 s8, s8, s30
    s_cmpk_ge_u32 s8, 1660
    s_cbranch_scc1 .ap_157
    s_waitcnt vmcnt(5)
    s_cmpk_ge_u32 s8, 1595
    s_cbranch_scc1 .ap_157
    s_waitcnt vmcnt(3)
    s_bitcmp1_b64 s[14:15], 45
    s_cbranch_scc0 1
    s_waitcnt vmcnt(2)
    s_cmpk_ge_u32 s8, 1520
    s_cbranch_scc1 .ap_157
    s_waitcnt vmcnt(1)
.ap_157:
    s_add_u32 s63, s69, 172032
    buffer_load_dwordx4 v[212:215], v2, s[44:47], s63 offen nt
    s_memrealtime s[8:9]
    s_waitcnt vmcnt(8)
    s_waitcnt lgkmcnt(0)
    s_sub_u32 s8, s8, s30
    s_cmpk_ge_u32 s8, 1691
    s_cbranch_scc1 .ap_158
    s_waitcnt vmcnt(5)
    s_cmpk_ge_u32 s8, 1626
    s_cbranch_scc1 .ap_158
    s_waitcnt vmcnt(3)
    s_bitcmp1_b64 s[14:15], 46
    s_cbranch_scc0 1
    s_waitcnt vmcnt(2)
    s_cmpk_ge_u32 s8, 1551
    s_cbranch_scc1 .ap_158
    s_waitcnt vmcnt(1)
.ap_158:
    s_add_u32 s63, s69, 180224
    buffer_load_dwordx4 v[216:219], v2, s[44:47], s63 offen nt
    s_memrealtime s[8:9]
    s_waitcnt vmcnt(8)
    s_waitcnt lgkmcnt(0)
    s_sub_u32 s8, s8, s30
    s_cmpk_ge_u32 s8, 1722
    s_cbranch_scc1 .ap_159
    s_waitcnt vmcnt(5)
    s_cmpk_ge_u32 s8, 1657
    s_cbranch_scc1 .ap_159
    s_waitcnt vmcnt(3)
    s_bitcmp1_b64 s[14:15], 47
    s_cbranch_scc0 1
    s_waitcnt vmcnt(2)
    s_cmpk_ge_u32 s8, 1582
    s_cbranch_scc1 .ap_159
    s_waitcnt vmcnt(1)
.ap_159:
    s_add_u32 s63, s69, 188416
    buffer_load_dwordx4 v[220:223], v2, s[44:47], s63 offen nt
    s_mul_i32 s99, s3, 2304
    s_add_u32 s99, s99, 0x1e000
    buffer_load_dwordx4 v[32:35], v2, s[36:39], s99 offen offset:0
    buffer_load_dwordx4 v[40:43], v2, s[36:39], s99 offen offset:1024
    buffer_load_dwordx2 v[48:49], v5, s[36:39], s99 offen offset:0
    s_memrealtime s[8:9]
    s_waitcnt vmcnt(11)
    s_waitcnt lgkmcnt(0)
    s_sub_u32 s8, s8, s30
    s_cmpk_ge_u32 s8, 1753
    s_cbranch_scc1 .ap_160
    s_waitcnt vmcnt(8)
    s_cmpk_ge_u32 s8, 1688
    s_cbranch_scc1 .ap_160
    s_waitcnt vmcnt(6)
    s_bitcmp1_b64 s[14:15], 48
    s_cbranch_scc0 1
    s_waitcnt vmcnt(5)
    s_cmpk_ge_u32 s8, 1613
    s_cbranch_scc1 .ap_160
    s_waitcnt vmcnt(4)
.ap_160:
    s_add_u32 s63, s69, 262144
    buffer_load_dwordx4 v[224:227], v2, s[44:47], s63 offen nt
    s_memrealtime s[8:9]
    s_waitcnt vmcnt(11)
    s_waitcnt lgkmcnt(0)
    s_sub_u32 s8, s8, s30
    s_cmpk_ge_u32 s8, 1784
    s_cbranch_scc1 .ap_161
    s_waitcnt vmcnt(8)
    s_cmpk_ge_u32 s8, 1719
    s_cbranch_scc1 .ap_161
    s_waitcnt vmcnt(6)
    s_bitcmp1_b64 s[14:15], 49
    s_cbranch_scc0 1
    s_waitcnt vmcnt(5)
    s_cmpk_ge_u32 s8, 1644
    s_cbranch_scc1 .ap_161
    s_waitcnt vmcnt(4)
.ap_161:
    s_add_u32 s63, s69, 270336
    buffer_load_dwordx4 v[228:231], v2, s[44:47], s63 offen nt
    s_mul_i32 s100, s3, 2304
    s_add_u32 s100, s100, 0x27000
    buffer_load_dwordx4 v[56:59], v2, s[36:39], s100 offen offset:0
    buffer_load_dwordx4 v[64:67], v2, s[36:39], s100 offen offset:1024
    buffer_load_dwordx2 v[50:51], v5, s[36:39], s100 offen offset:0
    s_memrealtime s[8:9]
    s_waitcnt vmcnt(14)
    s_waitcnt lgkmcnt(0)
    s_sub_u32 s8, s8, s30
    s_cmpk_ge_u32 s8, 1815
    s_cbranch_scc1 .ap_162
    s_waitcnt vmcnt(11)
    s_cmpk_ge_u32 s8, 1750
    s_cbranch_scc1 .ap_162
    s_waitcnt vmcnt(9)
    s_bitcmp1_b64 s[14:15], 50
    s_cbranch_scc0 1
    s_waitcnt vmcnt(8)
    s_cmpk_ge_u32 s8, 1675
    s_cbranch_scc1 .ap_162
    s_waitcnt vmcnt(4)
.ap_162:
    s_add_u32 s63, s69, 278528
    buffer_load_dwordx4 v[232:235], v2, s[44:47], s63 offen nt
    s_memrealtime s[8:9]
    s_waitcnt vmcnt(14)
    s_waitcnt lgkmcnt(0)
    s_sub_u32 s8, s8, s30
    s_cmpk_ge_u32 s8, 1846
    s_cbranch_scc1 .ap_163
    s_waitcnt vmcnt(11)
    s_cmpk_ge_u32 s8, 1781
    s_cbranch_scc1 .ap_163
    s_waitcnt vmcnt(9)
    s_bitcmp1_b64 s[14:15], 51
    s_cbranch_scc0 1
    s_waitcnt vmcnt(5)
    s_cmpk_ge_u32 s8, 1706
    s_cbranch_scc1 .ap_163
    s_waitcnt vmcnt(4)
.ap_163:
    s_add_u32 s63, s69, 286720
    buffer_load_dwordx4 v[236:239], v2, s[44:47], s63 offen nt
    s_memrealtime s[8:9]
    s_waitcnt vmcnt(14)
    s_waitcnt lgkmcnt(0)
    s_sub_u32 s8, s8, s30
    s_cmpk_ge_u32 s8, 1877
    s_cbranch_scc1 .ap_164
    s_waitcnt vmcnt(11)
    s_cmpk_ge_u32 s8, 1812
    s_cbranch_scc1 .ap_164
    s_waitcnt vmcnt(6)
    s_bitcmp1_b64 s[14:15], 52
    s_cbranch_scc0 1
    s_waitcnt vmcnt(5)
    s_cmpk_ge_u32 s8, 1737
    s_cbranch_scc1 .ap_164
    s_waitcnt vmcnt(1)
.ap_164:
    s_add_u32 s63, s69, 294912
    buffer_load_dwordx4 v[240:243], v2, s[44:47], s63 offen nt
    s_memrealtime s[8:9]
    s_waitcnt vmcnt(14)
    s_waitcnt lgkmcnt(0)
    s_sub_u32 s8, s8, s30
    s_cmpk_ge_u32 s8, 1908
    s_cbranch_scc1 .ap_165
    s_waitcnt vmcnt(11)
    s_cmpk_ge_u32 s8, 1843
    s_cbranch_scc1 .ap_165
    s_waitcnt vmcnt(6)
    s_bitcmp1_b64 s[14:15], 53
    s_cbranch_scc0 1
    s_waitcnt vmcnt(2)
    s_cmpk_ge_u32 s8, 1768
    s_cbranch_scc1 .ap_165
    s_waitcnt vmcnt(1)
.ap_165:
    s_add_u32 s63, s69, 303104
    buffer_load_dwordx4 v[244:247], v2, s[44:47], s63 offen nt
    s_load_dwordx2 s[88:89], s[6:7], s0
    buffer_load_dwordx4 v[24:27], v9, s[36:39], s59 offen offset:0 sc1
    s_memrealtime s[8:9]
    s_waitcnt vmcnt(14)
    s_waitcnt lgkmcnt(0)
    s_sub_u32 s8, s8, s30
    s_cmpk_ge_u32 s8, 1939
    s_cbranch_scc1 .ap_166
    s_waitcnt vmcnt(8)
    s_cmpk_ge_u32 s8, 1874
    s_cbranch_scc1 .ap_166
    s_waitcnt vmcnt(3)
    s_bitcmp1_b64 s[14:15], 54
    s_cbranch_scc0 1
    s_waitcnt vmcnt(2)
    s_cmpk_ge_u32 s8, 1799
    s_cbranch_scc1 .ap_166
    s_waitcnt vmcnt(1)
.ap_166:
    s_add_u32 s63, s69, 311296
    buffer_load_dwordx4 v[248:251], v2, s[44:47], s63 offen nt
    s_memrealtime s[8:9]
    s_waitcnt vmcnt(14)
    s_waitcnt lgkmcnt(0)
    s_sub_u32 s8, s8, s30
    s_cmpk_ge_u32 s8, 1970
    s_cbranch_scc1 .ap_167
    s_waitcnt vmcnt(5)
    s_cmpk_ge_u32 s8, 1905
    s_cbranch_scc1 .ap_167
    s_waitcnt vmcnt(3)
    s_bitcmp1_b64 s[14:15], 55
    s_cbranch_scc0 1
    s_waitcnt vmcnt(2)
    s_cmpk_ge_u32 s8, 1830
    s_cbranch_scc1 .ap_167
    s_waitcnt vmcnt(1)
.ap_167:
    s_add_u32 s63, s69, 319488
    buffer_load_dwordx4 v[252:255], v2, s[44:47], s63 offen nt
    s_memrealtime s[8:9]
    s_waitcnt vmcnt(11)
    s_waitcnt lgkmcnt(0)
    s_sub_u32 s8, s8, s30
    s_cmpk_ge_u32 s8, 2001
    s_cbranch_scc1 .ap_168
    s_waitcnt vmcnt(5)
    s_cmpk_ge_u32 s8, 1936
    s_cbranch_scc1 .ap_168
    s_waitcnt vmcnt(3)
    s_bitcmp1_b64 s[14:15], 56
    s_cbranch_scc0 1
    s_waitcnt vmcnt(2)
    s_cmpk_ge_u32 s8, 1861
    s_cbranch_scc1 .ap_168
    s_waitcnt vmcnt(1)
.ap_168:
    s_add_u32 s63, s69, 393216
    buffer_load_dwordx4 v[36:39], v2, s[44:47], s63 offen nt
    s_memrealtime s[8:9]
    s_waitcnt vmcnt(11)
    s_waitcnt lgkmcnt(0)
    s_sub_u32 s8, s8, s30
    s_cmpk_ge_u32 s8, 2032
    s_cbranch_scc1 .ap_169
    s_waitcnt vmcnt(5)
    s_cmpk_ge_u32 s8, 1967
    s_cbranch_scc1 .ap_169
    s_waitcnt vmcnt(3)
    s_bitcmp1_b64 s[14:15], 57
    s_cbranch_scc0 1
    s_waitcnt vmcnt(2)
    s_cmpk_ge_u32 s8, 1892
    s_cbranch_scc1 .ap_169
    s_waitcnt vmcnt(1)
.ap_169:
    s_add_u32 s63, s69, 401408
    buffer_load_dwordx4 v[44:47], v2, s[44:47], s63 offen nt
    s_memrealtime s[8:9]
    s_waitcnt vmcnt(8)
    s_waitcnt lgkmcnt(0)
    s_sub_u32 s8, s8, s30
    s_cmpk_ge_u32 s8, 2063
    s_cbranch_scc1 .ap_170
    s_waitcnt vmcnt(5)
    s_cmpk_ge_u32 s8, 1998
    s_cbranch_scc1 .ap_170
    s_waitcnt vmcnt(3)
    s_bitcmp1_b64 s[14:15], 58
    s_cbranch_scc0 1
    s_waitcnt vmcnt(2)
    s_cmpk_ge_u32 s8, 1923
    s_cbranch_scc1 .ap_170
    s_waitcnt vmcnt(1)
.ap_170:
    s_add_u32 s63, s69, 409600
    buffer_load_dwordx4 v[52:55], v2, s[44:47], s63 offen nt
    s_waitcnt vmcnt(5)
    s_branch .gpc_172
.gp_171:
    buffer_load_dwordx4 v[24:27], v9, s[36:39], s59 offen offset:0 sc1
    s_waitcnt vmcnt(0)
.gpc_172:
    v_cmp_eq_u32 vcc, s34, v26
    s_cmp_eq_u64 vcc, exec
    s_nop 3
    s_cbranch_scc1 .gpd_173
    s_sub_u32 s35, s35, 1
    s_cbranch_scc1 .Lexit
    s_sleep 1
    s_branch .gp_171
.gpd_173:
    s_lshr_b64 s[88:89], s[88:89], s1
    s_and_b32 s88, s88, 0xff
    s_cmp_eq_u32 s88, 32
    s_cselect_b32 s0, 0xac000, 0
    v_mov_b32 v16, v24
    s_nop 1
    v_max_f32_dpp v16, v16, v16 quad_perm:[2,3,0,1] row_mask:0xf bank_mask:0xf
    v_sub_f32 v17, v24, v16
    v_sub_f32 v18, v14, v16
    v_mul_f32 v17, 0x3fb8aa3b, v17
    v_mul_f32 v18, 0x3fb8aa3b, v18
    v_exp_f32 v17, v17
    v_exp_f32 v18, v18
    v_mul_f32 v17, v17, v25
    s_nop 1
    v_add_f32_dpp v17, v17, v17 quad_perm:[2,3,0,1] row_mask:0xf bank_mask:0xf
    v_rcp_f32 v19, v17
    s_nop 0
    v_fma_f32 v15, -v17, v19, 1.0
    v_fma_f32 v19, v15, v19, v19
    v_mul_f32 v18, v18, v19
    v_mul_f32 v10, v10, v18
    v_mul_f32 v11, v11, v18
    v_mul_f32 v12, v12, v18
    v_mul_f32 v13, v13, v18
    v_mov_b32_dpp v112, v10 quad_perm:[2,3,0,1] row_mask:0xf bank_mask:0xf
    v_mov_b32_dpp v113, v11 quad_perm:[2,3,0,1] row_mask:0xf bank_mask:0xf
    v_mov_b32_dpp v114, v12 quad_perm:[2,3,0,1] row_mask:0xf bank_mask:0xf
    v_mov_b32_dpp v115, v13 quad_perm:[2,3,0,1] row_mask:0xf bank_mask:0xf
    v_cvt_pk_bf16_f32 v96, v10, v112
    v_cvt_pk_bf16_f32 v100, v11, v113
    v_cvt_pk_bf16_f32 v104, v12, v114
    v_cvt_pk_bf16_f32 v108, v13, v115
    v_mov_b32_dpp v97, v96 row_ror:12 row_mask:0xf bank_mask:0xf
    v_mov_b32_dpp v101, v100 row_ror:12 row_mask:0xf bank_mask:0xf
    v_mov_b32_dpp v105, v104 row_ror:12 row_mask:0xf bank_mask:0xf
    v_mov_b32_dpp v109, v108 row_ror:12 row_mask:0xf bank_mask:0xf
    v_mov_b32_dpp v98, v96 row_ror:8 row_mask:0xf bank_mask:0xf
    v_mov_b32_dpp v102, v100 row_ror:8 row_mask:0xf bank_mask:0xf
    v_mov_b32_dpp v106, v104 row_ror:8 row_mask:0xf bank_mask:0xf
    v_mov_b32_dpp v110, v108 row_ror:8 row_mask:0xf bank_mask:0xf
    v_mov_b32_dpp v99, v96 row_ror:4 row_mask:0xf bank_mask:0xf
    v_mov_b32_dpp v103, v100 row_ror:4 row_mask:0xf bank_mask:0xf
    v_mov_b32_dpp v107, v104 row_ror:4 row_mask:0xf bank_mask:0xf
    v_mov_b32_dpp v111, v108 row_ror:4 row_mask:0xf bank_mask:0xf
    s_memrealtime s[8:9]
    s_waitcnt lgkmcnt(0)
    s_sub_u32 s8, s8, s30
    s_cmpk_ge_u32 s8, 2094
    s_cbranch_scc1 .ap_174
    s_waitcnt vmcnt(5)
    s_cmpk_ge_u32 s8, 2029
    s_cbranch_scc1 .ap_174
    s_waitcnt vmcnt(3)
    s_bitcmp1_b64 s[14:15], 59
    s_cbranch_scc0 1
    s_waitcnt vmcnt(2)
    s_cmpk_ge_u32 s8, 1954
    s_cbranch_scc1 .ap_174
    s_waitcnt vmcnt(1)
.ap_174:
    s_add_u32 s63, s69, 417792
    buffer_load_dwordx4 v[60:63], v2, s[44:47], s63 offen nt
    s_lshl_b32 s60, s3, 10
    s_add_u32 s60, s60, 132096
    v_lshlrev_b32 v10, 5, v0
    v_add_u32 v10, s60, v10
    v_lshrrev_b32 v11, 5, v0
    v_lshlrev_b32 v11, 13, v11
    v_and_b32 v12, 31, v0
    v_lshl_add_u32 v11, v12, 4, v11
    v_add_u32 v9, 132096, v2
    v_mov_b32 v15, s34
    v_mov_b32 v13, 110592
    s_mov_b32 s1, s43
    v_bfe_u32 v16, v0, 1, 3
    v_mul_u32_u24 v16, 1312, v16
    v_lshrrev_b32 v7, 4, v0
    v_lshl_add_u32 v16, v7, 5, v16
    v_and_b32 v7, 1, v0
    v_lshl_add_u32 v16, v7, 4, v16
    v_add_u32 v16, 147456, v16
    s_mul_i32 s56, s3, 1312
    s_add_u32 s56, s56, 147456
    v_add_u32 v17, s56, v3
    v_add_u32 v18, s56, v4
    v_lshrrev_b32 v7, 4, v0
    v_bfe_u32 v8, v0, 1, 1
    v_lshl_add_u32 v7, v7, 1, v8
    v_bfe_u32 v8, v0, 2, 2
    v_lshl_add_u32 v19, v7, 3, v8
    v_lshlrev_b32 v19, 7, v19
    v_and_b32 v7, 3, v7
    v_lshrrev_b32 v8, 1, v8
    v_lshl_add_u32 v7, v7, 1, v8
    v_xor_b32 v7, s3, v7
    v_lshl_add_u32 v19, v7, 4, v19
    v_and_b32 v7, 1, v0
    v_lshl_add_u32 v19, v7, 3, v19
    v_add_u32 v20, 32768, v19
    v_lshrrev_b32 v7, 4, v0
    v_bfe_u32 v8, v0, 2, 2
    v_lshl_add_u32 v21, v7, 3, v8
    v_lshlrev_b32 v21, 7, v21
    v_and_b32 v7, 1, v7
    v_lshrrev_b32 v8, 1, v8
    v_lshl_add_u32 v7, v7, 1, v8
    s_and_b32 s56, s3, 1
    s_lshl_b32 s56, s56, 1
    v_xor_b32 v7, s56, v7
    v_and_b32 v8, 3, v0
    v_lshl_add_u32 v21, v8, 3, v21
    s_lshr_b32 s56, s3, 1
    s_mul_i32 s56, s56, 12288
    s_add_u32 s56, s56, 73728
    v_add_u32 v21, s56, v21
    v_xor_b32 v8, 1, v7
    v_lshl_add_u32 v22, v8, 5, v21
    v_lshl_add_u32 v21, v7, 5, v21
    v_bfe_u32 v7, v0, 1, 3
    v_mul_u32_u24 v23, 1312, v7
    v_mul_u32_u24 v24, 272, v7
    v_and_b32 v7, 48, v0
    s_lshr_b32 s56, s3, 1
    s_mul_i32 s57, s56, 192
    s_add_u32 s57, s57, 110592
    v_add3_u32 v23, v23, v7, s57
    s_mul_i32 s56, s56, 2176
    s_and_b32 s57, s3, 1
    s_lshl_b32 s57, s57, 7
    s_add_u32 s56, s56, s57
    s_add_u32 s56, s56, 122880
    v_add3_u32 v24, v24, v7, s56
    v_and_b32 v7, 1, v0
    v_lshl_add_u32 v24, v7, 6, v24
    v_and_b32 v7, 15, v0
    s_mul_i32 s56, s3, 272
    s_add_u32 s56, s56, 122880
    v_lshl_add_u32 v25, v7, 4, s56
    v_bfe_u32 v26, v0, 1, 4
    v_lshlrev_b32 v26, 4, v26
    s_mul_i32 s56, s3, 72
    v_add_u32 v7, s56, v0
    v_lshrrev_b32 v8, 4, v7
    v_lshlrev_b32 v27, 9, v8
    v_and_b32 v29, 15, v7
    v_lshl_add_u32 v27, v29, 4, v27
    v_and_b32 v29, 7, v7
    v_mul_u32_u24 v29, 1312, v29
    v_and_b32 v7, -8, v7
    v_add3_u32 v29, v29, v7, v13
    v_and_b32 v7, 7, v0
    v_add3_u32 v7, v7, s56, 64
    v_lshrrev_b32 v8, 4, v7
    v_lshlrev_b32 v28, 9, v8
    v_and_b32 v30, 15, v7
    v_lshl_add_u32 v28, v30, 4, v28
    v_and_b32 v30, 7, v7
    v_mul_u32_u24 v30, 1312, v30
    v_and_b32 v7, -8, v7
    v_add3_u32 v30, v30, v7, v13
    s_memrealtime s[8:9]
    s_waitcnt lgkmcnt(0)
    s_sub_u32 s8, s8, s30
    s_cmpk_ge_u32 s8, 2125
    s_cbranch_scc1 .ap_175
    s_waitcnt vmcnt(5)
    s_cmpk_ge_u32 s8, 2060
    s_cbranch_scc1 .ap_175
    s_waitcnt vmcnt(3)
    s_bitcmp1_b64 s[14:15], 60
    s_cbranch_scc0 1
    s_waitcnt vmcnt(2)
    s_cmpk_ge_u32 s8, 1985
    s_cbranch_scc1 .ap_175
    s_waitcnt vmcnt(1)
.ap_175:
    s_add_u32 s63, s69, 425984
    buffer_load_dwordx4 v[68:71], v2, s[44:47], s63 offen nt
    v_perm_b32 v112, v164, v160, s94
    v_perm_b32 v113, v172, v168, s94
    v_perm_b32 v114, v180, v176, s94
    v_perm_b32 v115, v188, v184, s94
    s_nop 1
    v_mfma_f32_16x16x32_bf16 v[128:131], v[96:99], v[112:115], 0
    v_perm_b32 v116, v164, v160, s95
    v_perm_b32 v117, v172, v168, s95
    v_perm_b32 v118, v180, v176, s95
    v_perm_b32 v119, v188, v184, s95
    s_nop 1
    v_mfma_f32_16x16x32_bf16 v[132:135], v[96:99], v[116:119], 0
    v_perm_b32 v120, v165, v161, s94
    v_perm_b32 v121, v173, v169, s94
    v_perm_b32 v122, v181, v177, s94
    v_perm_b32 v123, v189, v185, s94
    s_nop 1
    v_mfma_f32_16x16x32_bf16 v[136:139], v[96:99], v[120:123], 0
    v_perm_b32 v124, v165, v161, s95
    v_perm_b32 v125, v173, v169, s95
    v_perm_b32 v126, v181, v177, s95
    v_perm_b32 v127, v189, v185, s95
    s_nop 1
    v_mfma_f32_16x16x32_bf16 v[140:143], v[96:99], v[124:127], 0
    v_perm_b32 v112, v166, v162, s94
    v_perm_b32 v113, v174, v170, s94
    v_perm_b32 v114, v182, v178, s94
    v_perm_b32 v115, v190, v186, s94
    s_nop 1
    v_mfma_f32_16x16x32_bf16 v[144:147], v[96:99], v[112:115], 0
    v_perm_b32 v116, v166, v162, s95
    v_perm_b32 v117, v174, v170, s95
    v_perm_b32 v118, v182, v178, s95
    v_perm_b32 v119, v190, v186, s95
    s_nop 1
    v_mfma_f32_16x16x32_bf16 v[148:151], v[96:99], v[116:119], 0
    v_perm_b32 v120, v167, v163, s94
    v_perm_b32 v121, v175, v171, s94
    v_perm_b32 v122, v183, v179, s94
    v_perm_b32 v123, v191, v187, s94
    s_nop 1
    v_mfma_f32_16x16x32_bf16 v[152:155], v[96:99], v[120:123], 0
    v_perm_b32 v124, v167, v163, s95
    v_perm_b32 v125, v175, v171, s95
    v_perm_b32 v126, v183, v179, s95
    v_perm_b32 v127, v191, v187, s95
    s_nop 1
    v_mfma_f32_16x16x32_bf16 v[156:159], v[96:99], v[124:127], 0
    s_memrealtime s[8:9]
    s_waitcnt lgkmcnt(0)
    s_sub_u32 s8, s8, s30
    s_cmpk_ge_u32 s8, 2156
    s_nop 3
    s_cbranch_scc1 .ap_176
    s_waitcnt vmcnt(5)
    s_cmpk_ge_u32 s8, 2091
    s_cbranch_scc1 .ap_176
    s_waitcnt vmcnt(3)
    s_bitcmp1_b64 s[14:15], 61
    s_cbranch_scc0 1
    s_waitcnt vmcnt(2)
    s_cmpk_ge_u32 s8, 2016
    s_cbranch_scc1 .ap_176
    s_waitcnt vmcnt(1)
.ap_176:
    s_add_u32 s63, s69, 434176
    buffer_load_dwordx4 v[76:79], v2, s[44:47], s63 offen nt
    v_perm_b32 v112, v196, v192, s94
    v_perm_b32 v113, v204, v200, s94
    v_perm_b32 v114, v212, v208, s94
    v_perm_b32 v115, v220, v216, s94
    s_nop 1
    v_mfma_f32_16x16x32_bf16 v[128:131], v[100:103], v[112:115], v[128:131]
    v_perm_b32 v116, v196, v192, s95
    v_perm_b32 v117, v204, v200, s95
    v_perm_b32 v118, v212, v208, s95
    v_perm_b32 v119, v220, v216, s95
    s_nop 1
    v_mfma_f32_16x16x32_bf16 v[132:135], v[100:103], v[116:119], v[132:135]
    v_perm_b32 v120, v197, v193, s94
    v_perm_b32 v121, v205, v201, s94
    v_perm_b32 v122, v213, v209, s94
    v_perm_b32 v123, v221, v217, s94
    s_nop 1
    v_mfma_f32_16x16x32_bf16 v[136:139], v[100:103], v[120:123], v[136:139]
    v_perm_b32 v124, v197, v193, s95
    v_perm_b32 v125, v205, v201, s95
    v_perm_b32 v126, v213, v209, s95
    v_perm_b32 v127, v221, v217, s95
    s_nop 1
    v_mfma_f32_16x16x32_bf16 v[140:143], v[100:103], v[124:127], v[140:143]
    v_perm_b32 v112, v198, v194, s94
    v_perm_b32 v113, v206, v202, s94
    v_perm_b32 v114, v214, v210, s94
    v_perm_b32 v115, v222, v218, s94
    s_nop 1
    v_mfma_f32_16x16x32_bf16 v[144:147], v[100:103], v[112:115], v[144:147]
    v_perm_b32 v116, v198, v194, s95
    v_perm_b32 v117, v206, v202, s95
    v_perm_b32 v118, v214, v210, s95
    v_perm_b32 v119, v222, v218, s95
    s_nop 1
    v_mfma_f32_16x16x32_bf16 v[148:151], v[100:103], v[116:119], v[148:151]
    v_perm_b32 v120, v199, v195, s94
    v_perm_b32 v121, v207, v203, s94
    v_perm_b32 v122, v215, v211, s94
    v_perm_b32 v123, v223, v219, s94
    s_nop 1
    v_mfma_f32_16x16x32_bf16 v[152:155], v[100:103], v[120:123], v[152:155]
    v_perm_b32 v124, v199, v195, s95
    v_perm_b32 v125, v207, v203, s95
    v_perm_b32 v126, v215, v211, s95
    v_perm_b32 v127, v223, v219, s95
    s_nop 1
    v_mfma_f32_16x16x32_bf16 v[156:159], v[100:103], v[124:127], v[156:159]
    s_memrealtime s[8:9]
    s_waitcnt lgkmcnt(0)
    s_sub_u32 s8, s8, s30
    s_cmpk_ge_u32 s8, 2187
    s_nop 3
    s_cbranch_scc1 .ap_177
    s_waitcnt vmcnt(5)
    s_cmpk_ge_u32 s8, 2122
    s_cbranch_scc1 .ap_177
    s_waitcnt vmcnt(3)
    s_bitcmp1_b64 s[14:15], 62
    s_cbranch_scc0 1
    s_waitcnt vmcnt(2)
    s_cmpk_ge_u32 s8, 2047
    s_cbranch_scc1 .ap_177
    s_waitcnt vmcnt(1)
.ap_177:
    s_add_u32 s63, s69, 442368
    buffer_load_dwordx4 v[84:87], v2, s[44:47], s63 offen nt
    s_waitcnt vmcnt(7)
    v_perm_b32 v112, v228, v224, s94
    v_perm_b32 v113, v236, v232, s94
    v_perm_b32 v114, v244, v240, s94
    v_perm_b32 v115, v252, v248, s94
    s_nop 1
    v_mfma_f32_16x16x32_bf16 v[128:131], v[104:107], v[112:115], v[128:131]
    v_perm_b32 v116, v228, v224, s95
    v_perm_b32 v117, v236, v232, s95
    v_perm_b32 v118, v244, v240, s95
    v_perm_b32 v119, v252, v248, s95
    s_nop 1
    v_mfma_f32_16x16x32_bf16 v[132:135], v[104:107], v[116:119], v[132:135]
    v_perm_b32 v120, v229, v225, s94
    v_perm_b32 v121, v237, v233, s94
    v_perm_b32 v122, v245, v241, s94
    v_perm_b32 v123, v253, v249, s94
    s_nop 1
    v_mfma_f32_16x16x32_bf16 v[136:139], v[104:107], v[120:123], v[136:139]
    v_perm_b32 v124, v229, v225, s95
    v_perm_b32 v125, v237, v233, s95
    v_perm_b32 v126, v245, v241, s95
    v_perm_b32 v127, v253, v249, s95
    s_nop 1
    v_mfma_f32_16x16x32_bf16 v[140:143], v[104:107], v[124:127], v[140:143]
    v_perm_b32 v112, v230, v226, s94
    v_perm_b32 v113, v238, v234, s94
    v_perm_b32 v114, v246, v242, s94
    v_perm_b32 v115, v254, v250, s94
    s_nop 1
    v_mfma_f32_16x16x32_bf16 v[144:147], v[104:107], v[112:115], v[144:147]
    v_perm_b32 v116, v230, v226, s95
    v_perm_b32 v117, v238, v234, s95
    v_perm_b32 v118, v246, v242, s95
    v_perm_b32 v119, v254, v250, s95
    s_nop 1
    v_mfma_f32_16x16x32_bf16 v[148:151], v[104:107], v[116:119], v[148:151]
    v_perm_b32 v120, v231, v227, s94
    v_perm_b32 v121, v239, v235, s94
    v_perm_b32 v122, v247, v243, s94
    v_perm_b32 v123, v255, v251, s94
    s_nop 1
    v_mfma_f32_16x16x32_bf16 v[152:155], v[104:107], v[120:123], v[152:155]
    v_perm_b32 v124, v231, v227, s95
    v_perm_b32 v125, v239, v235, s95
    v_perm_b32 v126, v247, v243, s95
    v_perm_b32 v127, v255, v251, s95
    s_nop 1
    v_mfma_f32_16x16x32_bf16 v[156:159], v[104:107], v[124:127], v[156:159]
    s_memrealtime s[8:9]
    s_waitcnt lgkmcnt(0)
    s_sub_u32 s8, s8, s30
    s_cmpk_ge_u32 s8, 2218
    s_nop 3
    s_cbranch_scc1 .ap_178
    s_waitcnt vmcnt(5)
    s_cmpk_ge_u32 s8, 2153
    s_cbranch_scc1 .ap_178
    s_waitcnt vmcnt(3)
    s_bitcmp1_b64 s[14:15], 63
    s_cbranch_scc0 1
    s_waitcnt vmcnt(2)
    s_cmpk_ge_u32 s8, 2078
    s_cbranch_scc1 .ap_178
    s_waitcnt vmcnt(1)
.ap_178:
    s_add_u32 s63, s69, 450560
    buffer_load_dwordx4 v[92:95], v2, s[44:47], s63 offen nt
    s_setprio 0
    s_waitcnt vmcnt(6)
    v_perm_b32 v160, v44, v36, s94
    v_perm_b32 v164, v44, v36, s95
    v_perm_b32 v168, v45, v37, s94
    v_perm_b32 v172, v45, v37, s95
    v_perm_b32 v176, v46, v38, s94
    v_perm_b32 v180, v46, v38, s95
    v_perm_b32 v184, v47, v39, s94
    v_perm_b32 v188, v47, v39, s95
    s_waitcnt vmcnt(4)
    v_perm_b32 v161, v60, v52, s94
    v_perm_b32 v165, v60, v52, s95
    v_perm_b32 v169, v61, v53, s94
    v_perm_b32 v173, v61, v53, s95
    v_perm_b32 v177, v62, v54, s94
    v_perm_b32 v181, v62, v54, s95
    v_perm_b32 v185, v63, v55, s94
    v_perm_b32 v189, v63, v55, s95
    s_waitcnt vmcnt(2)
    v_perm_b32 v162, v76, v68, s94
    v_perm_b32 v166, v76, v68, s95
    v_perm_b32 v170, v77, v69, s94
    v_perm_b32 v174, v77, v69, s95
    v_perm_b32 v178, v78, v70, s94
    v_perm_b32 v182, v78, v70, s95
    v_perm_b32 v186, v79, v71, s94
    v_perm_b32 v190, v79, v71, s95
.Ltail_bc:
    s_waitcnt vmcnt(0)
    v_perm_b32 v163, v92, v84, s94
    v_perm_b32 v167, v92, v84, s95
    v_perm_b32 v171, v93, v85, s94
    v_perm_b32 v175, v93, v85, s95
    v_perm_b32 v179, v94, v86, s94
    v_perm_b32 v183, v94, v86, s95
    v_perm_b32 v187, v95, v87, s94
    v_perm_b32 v191, v95, v87, s95
    v_mfma_f32_16x16x32_bf16 v[128:131], v[108:111], v[160:163], v[128:131]
    v_mfma_f32_16x16x32_bf16 v[132:135], v[108:111], v[164:167], v[132:135]
    v_mfma_f32_16x16x32_bf16 v[136:139], v[108:111], v[168:171], v[136:139]
    v_mfma_f32_16x16x32_bf16 v[140:143], v[108:111], v[172:175], v[140:143]
    v_mfma_f32_16x16x32_bf16 v[144:147], v[108:111], v[176:179], v[144:147]
    v_mfma_f32_16x16x32_bf16 v[148:151], v[108:111], v[180:183], v[148:151]
    v_mfma_f32_16x16x32_bf16 v[152:155], v[108:111], v[184:187], v[152:155]
    v_mfma_f32_16x16x32_bf16 v[156:159], v[108:111], v[188:191], v[156:159]
    s_lshl_b32 s32, s3, 10
    s_add_u32 m0, s32, 40960
    s_add_u32 s56, s101, 2949120
    buffer_load_dwordx4 v6, s[48:51], s56 offen nt lds
    s_add_u32 m0, s32, 49152
    s_add_u32 s56, s101, 3538944
    buffer_load_dwordx4 v6, s[48:51], s56 offen nt lds
    s_add_u32 m0, s32, 57344
    s_add_u32 s56, s101, 4128768
    buffer_load_dwordx4 v6, s[48:51], s56 offen nt lds
    s_lshl4_add_u32 s56, s67, s66
    s_lshl1_add_u32 s56, s56, s68
    s_lshl_b32 s56, s56, 9
    s_add_u32 s56, s56, 0x210000
    s_mov_b32 s60, 0x07060503
    s_mov_b32 s61, 0x07060502
    s_mov_b32 s62, 0x07060501
    s_mov_b64 exec, 0xffff
    ds_write2_b32 v10, v128, v129 offset0:0 offset1:128
    ds_write2_b32 v10, v132, v133 offset0:1 offset1:129
    ds_write2_b32 v10, v136, v137 offset0:2 offset1:130
    ds_write2_b32 v10, v140, v141 offset0:3 offset1:131
    ds_write2_b32 v10, v144, v145 offset0:4 offset1:132
    ds_write2_b32 v10, v148, v149 offset0:5 offset1:133
    ds_write2_b32 v10, v152, v153 offset0:6 offset1:134
    ds_write2_b32 v10, v156, v157 offset0:7 offset1:135
    s_mov_b64 exec, -1
    s_waitcnt lgkmcnt(0)
    s_barrier
    s_cmp_lg_u32 s3, 7
    s_cbranch_scc1 .opub_179
    ds_read_b128 v[196:199], v9 offset:0
    ds_read_b128 v[200:203], v9 offset:1024
    ds_read_b128 v[204:207], v9 offset:2048
    ds_read_b128 v[208:211], v9 offset:3072
    ds_read_b128 v[212:215], v9 offset:4096
    ds_read_b128 v[216:219], v9 offset:5120
    ds_read_b128 v[220:223], v9 offset:6144
    ds_read_b128 v[224:227], v9 offset:7168
    s_waitcnt lgkmcnt(6)
    v_pk_add_f32 v[196:197], v[196:197], v[200:201]
    v_pk_add_f32 v[198:199], v[198:199], v[202:203]
    s_waitcnt lgkmcnt(4)
    v_pk_add_f32 v[204:205], v[204:205], v[208:209]
    v_pk_add_f32 v[206:207], v[206:207], v[210:211]
    v_pk_add_f32 v[196:197], v[196:197], v[204:205]
    v_pk_add_f32 v[198:199], v[198:199], v[206:207]
    s_waitcnt lgkmcnt(2)
    v_pk_add_f32 v[212:213], v[212:213], v[216:217]
    v_pk_add_f32 v[214:215], v[214:215], v[218:219]
    s_waitcnt lgkmcnt(0)
    v_pk_add_f32 v[220:221], v[220:221], v[224:225]
    v_pk_add_f32 v[222:223], v[222:223], v[226:227]
    v_pk_add_f32 v[212:213], v[212:213], v[220:221]
    v_pk_add_f32 v[214:215], v[214:215], v[222:223]
    v_pk_add_f32 v[196:197], v[196:197], v[212:213]
    v_pk_add_f32 v[198:199], v[198:199], v[214:215]
    v_perm_b32 v12, v196, v199, s60
    v_perm_b32 v13, v197, v199, s61
    v_perm_b32 v14, v198, v199, s62
    s_add_u32 s57, s56, 0xac000
    buffer_store_dwordx4 v[12:15], v11, s[36:39], s57 offen
    buffer_store_dwordx4 v[12:15], v11, s[36:39], s56 offen sc1
.opub_179:
    s_barrier
    s_bitcmp1_b32 s1, 0
    s_cbranch_scc1 .lt_180
    s_lshl_b32 s32, s3, 10
    s_add_u32 m0, s32, 0
    s_add_u32 s56, s101, 0
    buffer_load_dwordx4 v6, s[48:51], s56 offen nt lds
    s_add_u32 m0, s32, 8192
    s_add_u32 s56, s101, 589824
    buffer_load_dwordx4 v6, s[48:51], s56 offen nt lds
    s_add_u32 m0, s32, 16384
    s_add_u32 s56, s101, 1179648
    buffer_load_dwordx4 v6, s[48:51], s56 offen nt lds
    s_add_u32 m0, s32, 24576
    s_add_u32 s56, s101, 1769472
    buffer_load_dwordx4 v6, s[48:51], s56 offen nt lds
    s_add_u32 m0, s32, 32768
    s_add_u32 s56, s101, 2359296
    buffer_load_dwordx4 v6, s[48:51], s56 offen nt lds
.lt_180:
    s_lshl_b32 s32, s3, 10
    s_add_u32 m0, s32, 65536
    s_add_u32 s56, s101, 4718592
    buffer_load_dwordx4 v6, s[48:51], s56 offen nt lds
    s_add_u32 m0, s32, 73728
    s_add_u32 s56, s33, 0
    buffer_load_dwordx4 v31, s[52:55], s56 offen nt lds
    s_add_u32 m0, s32, 81920
    s_add_u32 s56, s33, 73728
    buffer_load_dwordx4 v31, s[52:55], s56 offen nt lds
    s_add_u32 m0, s32, 90112
    s_add_u32 s56, s33, 147456
    buffer_load_dwordx4 v31, s[52:55], s56 offen nt lds
    s_add_u32 m0, s32, 98304
    s_add_u32 s56, s33, 221184
    buffer_load_dwordx4 v31, s[52:55], s56 offen nt lds
    s_cmp_ge_u32 s3, 4
    s_cbranch_scc1 .nod_181
    s_add_u32 m0, s32, 106496
    s_add_u32 s56, s33, 294912
    buffer_load_dwordx4 v31, s[52:55], s56 offen nt lds
.nod_181:
    s_branch .gpc_183
.gp_182:
    buffer_load_dwordx4 v[32:35], v2, s[36:39], s99 offen offset:0 sc1
    buffer_load_dwordx4 v[40:43], v2, s[36:39], s99 offen offset:1024 sc1
    buffer_load_dwordx2 v[48:49], v5, s[36:39], s99 offen offset:0 sc1
    buffer_load_dwordx4 v[56:59], v2, s[36:39], s100 offen offset:0 sc1
    buffer_load_dwordx4 v[64:67], v2, s[36:39], s100 offen offset:1024 sc1
    buffer_load_dwordx2 v[50:51], v5, s[36:39], s100 offen offset:0 sc1
    s_waitcnt vmcnt(0)
.gpc_183:
    v_min_u32 v7, v33, v35
    v_max_u32 v8, v33, v35
    v_min3_u32 v7, v7, v41, v43
    v_max3_u32 v8, v8, v41, v43
    v_min3_u32 v7, v7, v49, v57
    v_max3_u32 v8, v8, v49, v57
    v_min3_u32 v7, v7, v59, v65
    v_max3_u32 v8, v8, v59, v65
    v_min3_u32 v7, v7, v67, v51
    v_max3_u32 v8, v8, v67, v51
    v_cmp_eq_u32 vcc, s34, v7
    v_cmp_eq_u32 s[56:57], s34, v8
    s_and_b64 vcc, vcc, s[56:57]
    s_cmp_eq_u64 vcc, exec
    s_nop 2
    s_cbranch_scc1 .gpd_184
    s_sub_u32 s35, s35, 1
    s_cbranch_scc1 .Lexit
    s_sleep 2
    s_branch .gp_182
.gpd_184:
    v_lshlrev_b32 v230, 16, v32
    v_and_b32 v231, 0xffff0000, v32
    v_lshlrev_b32 v240, 16, v56
    v_and_b32 v241, 0xffff0000, v56
    v_lshlrev_b32 v232, 16, v34
    v_and_b32 v233, 0xffff0000, v34
    v_lshlrev_b32 v242, 16, v58
    v_and_b32 v243, 0xffff0000, v58
    v_lshlrev_b32 v234, 16, v40
    v_and_b32 v235, 0xffff0000, v40
    v_lshlrev_b32 v244, 16, v64
    v_and_b32 v245, 0xffff0000, v64
    v_lshlrev_b32 v236, 16, v42
    v_and_b32 v237, 0xffff0000, v42
    v_lshlrev_b32 v246, 16, v66
    v_and_b32 v247, 0xffff0000, v66
    v_lshlrev_b32 v238, 16, v48
    v_and_b32 v239, 0xffff0000, v48
    v_lshlrev_b32 v248, 16, v50
    v_and_b32 v249, 0xffff0000, v50
    s_sub_u32 s63, s65, 9
    s_mul_i32 s42, s64, 18432
    s_mul_i32 s56, s3, 2304
    s_add_u32 s42, s42, s56
    s_add_u32 s42, s42, 0x250000
    s_mul_i32 s41, s64, 36864
    s_add_u32 s41, s41, 0x274000
    s_lshr_b32 s57, s63, 1
    s_lshl3_add_u32 s40, s57, s3
    s_and_b32 s63, s63, 1
    s_lshl1_add_u32 s40, s40, s63
    s_lshl_b32 s40, s40, 8
    s_add_u32 s40, s40, s41
    s_mul_i32 s56, s63, 18432
    s_add_u32 s41, s41, s56
    s_mul_i32 s43, s3, 9
    s_add_u32 s43, s43, s57
    s_lshl3_add_u32 s43, s43, s64
    s_lshl1_add_u32 s43, s43, s63
    s_lshl_b32 s43, s43, 8
    s_add_u32 s43, s43, 0x38c000
    v_mov_b32 v143, s34
    s_add_u32 s57, s40, 0xac000
    s_mov_b64 exec, 0xffff
    buffer_load_dwordx4 v[80:83], v2, s[36:39], s57 offen offset:0
    s_mov_b64 exec, -1
    s_waitcnt vmcnt(5)
    s_barrier
    ds_read_b64_tr_b16 v[160:161], v19 offset:0
    ds_read_b64_tr_b16 v[162:163], v19 offset:512
    ds_read_b64_tr_b16 v[164:165], v19 offset:8192
    ds_read_b64_tr_b16 v[166:167], v19 offset:8704
    ds_read_b64_tr_b16 v[168:169], v19 offset:16384
    ds_read_b64_tr_b16 v[170:171], v19 offset:16896
    ds_read_b64_tr_b16 v[172:173], v19 offset:24576
    ds_read_b64_tr_b16 v[174:175], v19 offset:25088
    ds_read_b64_tr_b16 v[176:177], v20 offset:0
    ds_read_b64_tr_b16 v[178:179], v20 offset:512
    ds_read_b64_tr_b16 v[180:181], v20 offset:8192
    ds_read_b64_tr_b16 v[182:183], v20 offset:8704
    ds_read_b64_tr_b16 v[184:185], v20 offset:16384
    ds_read_b64_tr_b16 v[186:187], v20 offset:16896
    ds_read_b64_tr_b16 v[188:189], v20 offset:24576
    ds_read_b64_tr_b16 v[190:191], v20 offset:25088
    ds_read_b64_tr_b16 v[192:193], v20 offset:32768
    ds_read_b64_tr_b16 v[194:195], v20 offset:33280
.Lbc_x:
    s_add_u32 s58, s42, s0
    s_mov_b32 s32, 0
    s_mov_b64 s[88:89], exec
    s_mov_b64 s[90:91], exec
    s_mov_b64 s[92:93], exec
.mp_185:
    s_mov_b64 exec, s[88:89]
    buffer_load_dwordx4 v[144:147], v2, s[36:39], s58 offen offset:0 sc1
    s_mov_b64 exec, s[90:91]
    buffer_load_dwordx4 v[148:151], v2, s[36:39], s58 offen offset:1024 sc1
    s_mov_b64 exec, s[92:93]
    buffer_load_dwordx2 v[152:153], v5, s[36:39], s58 offen offset:0 sc1
    s_mov_b64 exec, -1
    s_sub_u32 s35, s35, 1
    s_cbranch_scc1 .Lexit
    s_add_u32 s32, s32, 1
    s_cmp_eq_u32 s32, 64
    s_cselect_b32 s58, s42, s58
    s_waitcnt vmcnt(0)
.mpj_186:
    v_cmp_ne_u32 s[88:89], s34, v145
    v_cmp_ne_u32 vcc, s34, v147
    s_or_b64 s[88:89], s[88:89], vcc
    v_cmp_ne_u32 s[90:91], s34, v149
    v_cmp_ne_u32 vcc, s34, v151
    s_or_b64 s[90:91], s[90:91], vcc
    v_cmp_ne_u32 s[92:93], s34, v153
    s_or_b64 vcc, s[88:89], s[90:91]
    s_or_b64 vcc, vcc, s[92:93]
    s_nop 2
    s_cbranch_scc1 .mp_185
    s_mov_b32 s56, 0x3f803f80
    v_dot2_f32_bf16 v250, v144, s56, 0
    v_dot2_f32_bf16 v251, v144, v144, 0
    v_dot2_f32_bf16 v250, v146, s56, v250
    v_dot2_f32_bf16 v251, v146, v146, v251
    v_dot2_f32_bf16 v250, v148, s56, v250
    v_dot2_f32_bf16 v251, v148, v148, v251
    v_dot2_f32_bf16 v250, v150, s56, v250
    v_dot2_f32_bf16 v251, v150, v150, v251
    s_mov_b64 exec, 0xffffffff
    v_dot2_f32_bf16 v250, v152, s56, v250
    v_dot2_f32_bf16 v251, v152, v152, v251
    s_mov_b64 exec, -1
    s_nop 1
    v_permlane32_swap_b32 v250, v251
    v_add_f32 v250, v250, v251
    v_mov_b32 v252, v250
    s_nop 1
    v_permlane16_swap_b32 v252, v250
    v_add_f32 v250, v252, v250
    v_lshlrev_b32 v220, 16, v144
    v_and_b32 v221, 0xffff0000, v144
    v_add_f32_dpp v250, v250, v250 row_ror:8 row_mask:0xf bank_mask:0xf
    v_lshlrev_b32 v222, 16, v146
    v_and_b32 v223, 0xffff0000, v146
    v_add_f32_dpp v250, v250, v250 row_ror:4 row_mask:0xf bank_mask:0xf
    v_lshlrev_b32 v224, 16, v148
    v_and_b32 v225, 0xffff0000, v148
    v_add_f32_dpp v250, v250, v250 quad_perm:[2,3,0,1] row_mask:0xf bank_mask:0xf
    v_lshlrev_b32 v226, 16, v150
    v_and_b32 v227, 0xffff0000, v150
    v_add_f32_dpp v250, v250, v250 quad_perm:[1,0,3,2] row_mask:0xf bank_mask:0xf
    v_mul_f32 v250, 0x3ae38e39, v250
    v_lshlrev_b32 v228, 16, v152
    v_and_b32 v229, 0xffff0000, v152
    v_readlane_b32 s56, v250, 0
    v_readlane_b32 s57, v250, 32
    s_nop 0
    v_mov_b32 v250, s56
    v_fma_f32 v251, -v250, v250, s57
    v_max_f32 v251, 0, v251
    v_cvt_pk_bf16_f32 v252, -v250, v251
    v_and_b32 v253, 0xffff0000, v252
    v_add_f32 v253, 0x3727c5ac, v253
    v_lshlrev_b32 v250, 16, v252
    v_cvt_pk_bf16_f32 v253, v253, v253
    v_lshlrev_b32 v253, 16, v253
    v_sqrt_f32 v253, v253
    v_mov_b32 v251, v250
    v_cvt_pk_bf16_f32 v253, v253, v253
    v_lshlrev_b32 v253, 16, v253
    v_rcp_f32 v252, v253
    v_rcp_f32 v253, v253
    v_pk_add_f32 v[220:221], v[220:221], v[250:251]
    v_pk_add_f32 v[222:223], v[222:223], v[250:251]
    v_pk_add_f32 v[224:225], v[224:225], v[250:251]
    v_pk_add_f32 v[226:227], v[226:227], v[250:251]
    v_pk_add_f32 v[228:229], v[228:229], v[250:251]
    v_cvt_pk_bf16_f32 v220, v220, v221
    v_and_b32 v221, 0xffff0000, v220
    v_lshlrev_b32 v220, 16, v220
    v_cvt_pk_bf16_f32 v222, v222, v223
    v_and_b32 v223, 0xffff0000, v222
    v_lshlrev_b32 v222, 16, v222
    v_cvt_pk_bf16_f32 v224, v224, v225
    v_and_b32 v225, 0xffff0000, v224
    v_lshlrev_b32 v224, 16, v224
    v_cvt_pk_bf16_f32 v226, v226, v227
    v_and_b32 v227, 0xffff0000, v226
    v_lshlrev_b32 v226, 16, v226
    v_cvt_pk_bf16_f32 v228, v228, v229
    v_and_b32 v229, 0xffff0000, v228
    v_lshlrev_b32 v228, 16, v228
    v_pk_mul_f32 v[220:221], v[220:221], v[252:253]
    v_pk_mul_f32 v[222:223], v[222:223], v[252:253]
    v_pk_mul_f32 v[224:225], v[224:225], v[252:253]
    v_pk_mul_f32 v[226:227], v[226:227], v[252:253]
    v_pk_mul_f32 v[228:229], v[228:229], v[252:253]
    v_cvt_pk_bf16_f32 v220, v220, v221
    v_and_b32 v221, 0xffff0000, v220
    v_lshlrev_b32 v220, 16, v220
    v_cvt_pk_bf16_f32 v222, v222, v223
    v_and_b32 v223, 0xffff0000, v222
    v_lshlrev_b32 v222, 16, v222
    v_cvt_pk_bf16_f32 v224, v224, v225
    v_and_b32 v225, 0xffff0000, v224
    v_lshlrev_b32 v224, 16, v224
    v_cvt_pk_bf16_f32 v226, v226, v227
    v_and_b32 v227, 0xffff0000, v226
    v_lshlrev_b32 v226, 16, v226
    v_cvt_pk_bf16_f32 v228, v228, v229
    v_and_b32 v229, 0xffff0000, v228
    v_lshlrev_b32 v228, 16, v228
    v_pk_mul_f32 v[220:221], v[220:221], v[240:241]
    v_pk_mul_f32 v[222:223], v[222:223], v[242:243]
    v_pk_mul_f32 v[224:225], v[224:225], v[244:245]
    v_pk_mul_f32 v[226:227], v[226:227], v[246:247]
    v_pk_mul_f32 v[228:229], v[228:229], v[248:249]
    v_cvt_pk_bf16_f32 v220, v220, v221
    v_and_b32 v221, 0xffff0000, v220
    v_lshlrev_b32 v220, 16, v220
    v_cvt_pk_bf16_f32 v222, v222, v223
    v_and_b32 v223, 0xffff0000, v222
    v_lshlrev_b32 v222, 16, v222
    v_cvt_pk_bf16_f32 v224, v224, v225
    v_and_b32 v225, 0xffff0000, v224
    v_lshlrev_b32 v224, 16, v224
    v_cvt_pk_bf16_f32 v226, v226, v227
    v_and_b32 v227, 0xffff0000, v226
    v_lshlrev_b32 v226, 16, v226
    v_cvt_pk_bf16_f32 v228, v228, v229
    v_and_b32 v229, 0xffff0000, v228
    v_lshlrev_b32 v228, 16, v228
    v_pk_add_f32 v[220:221], v[220:221], v[230:231]
    v_pk_add_f32 v[222:223], v[222:223], v[232:233]
    v_pk_add_f32 v[224:225], v[224:225], v[234:235]
    v_pk_add_f32 v[226:227], v[226:227], v[236:237]
    v_pk_add_f32 v[228:229], v[228:229], v[238:239]
    v_cvt_pk_bf16_f32 v154, v220, v221
    v_cvt_pk_bf16_f32 v155, v222, v223
    v_cvt_pk_bf16_f32 v156, v224, v225
    v_cvt_pk_bf16_f32 v157, v226, v227
    v_cvt_pk_bf16_f32 v158, v228, v229
    ds_write_b64 v17, v[154:155]
    ds_write_b64 v17, v[156:157] offset:512
    ds_write_b32 v18, v158
    s_waitcnt lgkmcnt(0)
    s_barrier
    ds_read_b128 v[96:99], v16 offset:0
    ds_read_b128 v[100:103], v16 offset:128
    ds_read_b128 v[104:107], v16 offset:256
    ds_read_b128 v[108:111], v16 offset:384
    ds_read_b128 v[112:115], v16 offset:512
    ds_read_b128 v[116:119], v16 offset:640
    ds_read_b128 v[120:123], v16 offset:768
    ds_read_b128 v[124:127], v16 offset:896
    ds_read_b128 v[128:131], v16 offset:1024
    s_waitcnt lgkmcnt(8)
    v_mfma_f32_16x16x32_bf16 v[132:135], v[160:163], v[96:99], 0
    s_waitcnt lgkmcnt(7)
    v_mfma_f32_16x16x32_bf16 v[132:135], v[164:167], v[100:103], v[132:135]
    s_waitcnt lgkmcnt(6)
    v_mfma_f32_16x16x32_bf16 v[132:135], v[168:171], v[104:107], v[132:135]
    s_waitcnt lgkmcnt(5)
    v_mfma_f32_16x16x32_bf16 v[132:135], v[172:175], v[108:111], v[132:135]
    s_waitcnt lgkmcnt(4)
    v_mfma_f32_16x16x32_bf16 v[132:135], v[176:179], v[112:115], v[132:135]
    s_waitcnt lgkmcnt(3)
    v_mfma_f32_16x16x32_bf16 v[132:135], v[180:183], v[116:119], v[132:135]
    s_waitcnt lgkmcnt(2)
    v_mfma_f32_16x16x32_bf16 v[132:135], v[184:187], v[120:123], v[132:135]
    s_waitcnt lgkmcnt(1)
    v_mfma_f32_16x16x32_bf16 v[132:135], v[188:191], v[124:127], v[132:135]
    s_waitcnt lgkmcnt(0)
    v_mfma_f32_16x16x32_bf16 v[132:135], v[192:195], v[128:131], v[132:135]
    s_nop 7
    v_permlane32_swap_b32 v132, v134
    v_permlane32_swap_b32 v133, v135
    v_cndmask_b32 v133, v133, v134, s[96:97]
    v_cndmask_b32 v132, v132, v135, s[96:97]
    s_nop 1
    v_add_f32_dpp v12, v133, v132 quad_perm:[1,0,3,2] row_mask:0xf bank_mask:0xf
    v_cvt_pk_bf16_f32 v12, v12, v12
    v_lshlrev_b32 v12, 16, v12
    s_cmp_lg_u32 s63, 0
    s_nop 0
    s_cbranch_scc1 .up_189
    v_max_f32 v12, 0xc2ae0000, v12
    v_min_f32 v9, 0x43000000, v12
    v_mul_f32 v7, 0xbfb8aa3b, v9
    v_fma_f32 v8, v9, s98, -v7
    v_fmac_f32 v8, 0xb2a57060, v9
    v_exp_f32 v7, v7
    v_mul_f32 v8, 0x3f317218, v8
    v_fmac_f32 v7, v7, v8
    v_add_f32 v7, 1.0, v7
    v_rcp_f32 v8, v7
    s_nop 0
    v_mul_f32 v9, v12, v8
    v_fma_f32 v7, -v9, v7, v12
    v_fma_f32 v12, v7, v8, v9
.up_189:
    s_nop 1
    v_mov_b32_dpp v137, v12 quad_perm:[0,0,2,2] row_mask:0xf bank_mask:0xf
    v_mov_b32_dpp v139, v12 quad_perm:[1,1,3,3] row_mask:0xf bank_mask:0xf
    v_cvt_pk_bf16_f32 v136, v137, v139
    v_cvt_pk_bf16_f32 v138, v137, v139
    v_mov_b32 v137, s34
    v_mov_b32 v139, s34
    v_permlane32_swap_b32 v136, v138
    s_mov_b64 exec, 0x55555555
    s_add_u32 s57, s40, 0xac000
    buffer_store_dwordx4 v[136:139], v26, s[36:39], s57 offen
    s_cmp_lg_u32 s0, 0
    s_cbranch_scc1 2
    buffer_store_dwordx4 v[136:139], v26, s[36:39], s40 offen sc1
    s_mov_b64 exec, -1
    s_barrier
    ds_read_b64_tr_b16 v[196:197], v21 offset:0
    ds_read_b64_tr_b16 v[198:199], v21 offset:512
    ds_read_b64_tr_b16 v[208:209], v22 offset:0
    ds_read_b64_tr_b16 v[210:211], v22 offset:512
    ds_read_b64_tr_b16 v[200:201], v21 offset:4096
    ds_read_b64_tr_b16 v[202:203], v21 offset:4608
    ds_read_b64_tr_b16 v[212:213], v22 offset:4096
    ds_read_b64_tr_b16 v[214:215], v22 offset:4608
    ds_read_b64_tr_b16 v[204:205], v21 offset:8192
    ds_read_b64_tr_b16 v[206:207], v21 offset:8704
    ds_read_b64_tr_b16 v[216:217], v22 offset:8192
    ds_read_b64_tr_b16 v[218:219], v22 offset:8704
    s_add_u32 s58, s41, s0
    s_mov_b32 s32, 0
    s_mov_b64 s[88:89], exec
    s_mov_b64 s[90:91], exec
    s_and_b64 s[92:93], exec, 0xff
    s_and_b64 s[56:57], exec, 0xff
.mp_190:
    s_mov_b64 exec, s[88:89]
    buffer_load_dwordx4 v[160:163], v27, s[36:39], s58 offen offset:0 sc1
    s_mov_b64 exec, s[90:91]
    buffer_load_dwordx4 v[164:167], v27, s[36:39], s58 offen offset:256 sc1
    s_mov_b64 exec, s[92:93]
    buffer_load_dwordx4 v[168:171], v28, s[36:39], s58 offen offset:0 sc1
    s_mov_b64 exec, s[56:57]
    buffer_load_dwordx4 v[172:175], v28, s[36:39], s58 offen offset:256 sc1
    s_mov_b64 exec, -1
    s_sub_u32 s35, s35, 1
    s_cbranch_scc1 .Lexit
    s_add_u32 s32, s32, 1
    s_cmp_eq_u32 s32, 64
    s_cselect_b32 s58, s41, s58
    s_cbranch_scc0 .mpi_192
    s_mov_b64 exec, 0x55555555
    buffer_store_dwordx4 v[136:139], v26, s[36:39], s40 offen sc1
    s_mov_b64 exec, -1
.mpi_192:
    s_waitcnt vmcnt(0)
.mpj_191:
    v_cmp_ne_u32 s[88:89], s34, v161
    v_cmp_ne_u32 vcc, s34, v163
    s_or_b64 s[88:89], s[88:89], vcc
    v_cmp_ne_u32 s[90:91], s34, v165
    v_cmp_ne_u32 vcc, s34, v167
    s_or_b64 s[90:91], s[90:91], vcc
    v_cmp_ne_u32 s[92:93], s34, v169
    v_cmp_ne_u32 vcc, s34, v171
    s_or_b64 s[92:93], s[92:93], vcc
    s_and_b64 s[92:93], s[92:93], 0xff
    v_cmp_ne_u32 s[56:57], s34, v173
    v_cmp_ne_u32 vcc, s34, v175
    s_or_b64 s[56:57], s[56:57], vcc
    s_and_b64 s[56:57], s[56:57], 0xff
    s_or_b64 vcc, s[88:89], s[90:91]
    s_or_b64 vcc, vcc, s[92:93]
    s_or_b64 vcc, vcc, s[56:57]
    s_cbranch_scc1 .mp_190
    v_and_b32 v161, 0xffff0000, v160
    v_lshlrev_b32 v160, 16, v160
    v_and_b32 v163, 0xffff0000, v162
    v_lshlrev_b32 v162, 16, v162
    v_and_b32 v165, 0xffff0000, v164
    v_lshlrev_b32 v164, 16, v164
    v_and_b32 v167, 0xffff0000, v166
    v_lshlrev_b32 v166, 16, v166
    v_and_b32 v169, 0xffff0000, v168
    v_lshlrev_b32 v168, 16, v168
    v_and_b32 v171, 0xffff0000, v170
    v_lshlrev_b32 v170, 16, v170
    v_and_b32 v173, 0xffff0000, v172
    v_lshlrev_b32 v172, 16, v172
    v_and_b32 v175, 0xffff0000, v174
    v_lshlrev_b32 v174, 16, v174
    v_pk_mul_f32 v[160:161], v[160:161], v[164:165]
    v_pk_mul_f32 v[162:163], v[162:163], v[166:167]
    v_pk_mul_f32 v[168:169], v[168:169], v[172:173]
    v_pk_mul_f32 v[170:171], v[170:171], v[174:175]
    v_cvt_pk_bf16_f32 v160, v160, v161
    v_cvt_pk_bf16_f32 v161, v162, v163
    v_cvt_pk_bf16_f32 v168, v168, v169
    v_cvt_pk_bf16_f32 v169, v170, v171
    ds_write_b64 v29, v[160:161]
    s_mov_b64 exec, 0xff
    ds_write_b64 v30, v[168:169]
    s_mov_b64 exec, -1
    s_mov_b64 exec, 0x55555555
    buffer_store_dwordx4 v[136:139], v26, s[36:39], s40 offen sc1
    s_mov_b64 exec, -1
    s_waitcnt lgkmcnt(0)
    s_barrier
    s_cmp_ge_u32 s3, 6
    s_cbranch_scc1 .tg_194
    ds_read_b128 v[96:99], v23 offset:0
    ds_read_b128 v[100:103], v23 offset:64
    ds_read_b128 v[104:107], v23 offset:128
    s_waitcnt lgkmcnt(2)
    v_mfma_f32_16x16x32_bf16 v[132:135], v[196:199], v[96:99], 0
    v_mfma_f32_16x16x32_bf16 v[136:139], v[208:211], v[96:99], 0
    s_waitcnt lgkmcnt(1)
    v_mfma_f32_16x16x32_bf16 v[132:135], v[200:203], v[100:103], v[132:135]
    v_mfma_f32_16x16x32_bf16 v[136:139], v[212:215], v[100:103], v[136:139]
    s_waitcnt lgkmcnt(0)
    v_mfma_f32_16x16x32_bf16 v[132:135], v[204:207], v[104:107], v[132:135]
    v_mfma_f32_16x16x32_bf16 v[136:139], v[216:219], v[104:107], v[136:139]
    s_nop 7
    v_cndmask_b32 v132, v132, v136, s[96:97]
    v_cndmask_b32 v133, v133, v137, s[96:97]
    v_cndmask_b32 v134, v134, v138, s[96:97]
    v_cndmask_b32 v135, v135, v139, s[96:97]
    ds_write_b128 v24, v[132:135]
    s_waitcnt lgkmcnt(0)
.tg_194:
    s_barrier
    ds_read_b128 v[112:115], v25 offset:0
    ds_read_b128 v[116:119], v25 offset:2176
    ds_read_b128 v[120:123], v25 offset:4352
    s_mov_b32 s60, 0x07060503
    s_mov_b32 s61, 0x07060502
    s_mov_b32 s62, 0x07060501
    s_waitcnt lgkmcnt(1)
    v_pk_add_f32 v[112:113], v[112:113], v[116:117]
    v_pk_add_f32 v[114:115], v[114:115], v[118:119]
    s_waitcnt lgkmcnt(0)
    v_pk_add_f32 v[112:113], v[112:113], v[120:121]
    v_pk_add_f32 v[114:115], v[114:115], v[122:123]
    v_perm_b32 v140, v112, v115, s60
    v_perm_b32 v141, v113, v115, s61
    v_perm_b32 v142, v114, v115, s62
    s_mov_b64 exec, 0xffff
    buffer_store_dwordx4 v[140:143], v2, s[36:39], s43 offen sc1
    s_mov_b64 exec, -1
    s_nop 0
    s_branch .Lexit
.Latt_n:
    v_and_b32 v8, 1, v0
    v_lshlrev_b32 v8, 8, v8
    v_and_b32 v9, 0x3c, v0
    v_lshl_add_u32 v9, v9, 2, v8
    v_lshlrev_b32 v7, 1, v9
    v_and_b32 v9, 0x3c, v0
    v_lshrrev_b32 v8, 4, v8
    v_and_b32 v9, 2, v0
    v_lshl_add_u32 v9, v9, 6, v8
    s_lshl_b32 s58, s66, 14
    s_lshl_b32 s59, s67, 10
    s_add_u32 s58, s58, s59
    s_add_u32 s58, s58, 0x40000
    s_lshl4_add_u32 s59, s66, s67
    s_lshl_b32 s59, s59, 8
    s_add_u32 s59, s59, 0x200000
    s_memrealtime s[8:9]
    s_waitcnt vmcnt(8)
    s_waitcnt lgkmcnt(0)
    s_sub_u32 s8, s8, s30
    s_cmpk_ge_u32 s8, 1147
    s_cbranch_scc1 .ap_195
    s_waitcnt vmcnt(5)
    s_cmpk_ge_u32 s8, 1082
    s_cbranch_scc1 .ap_195
    s_waitcnt vmcnt(3)
    s_bitcmp1_b64 s[14:15], 26
    s_cbranch_scc0 1
    s_waitcnt vmcnt(2)
    s_cmpk_ge_u32 s8, 1007
    s_cbranch_scc1 .ap_195
    s_waitcnt vmcnt(1)
.ap_195:
    s_add_u32 s63, s69, 409600
    buffer_load_dwordx4 v[88:91], v1, s[40:43], s63 offen nt
    s_memrealtime s[8:9]
    s_waitcnt vmcnt(8)
    s_waitcnt lgkmcnt(0)
    s_sub_u32 s8, s8, s30
    s_cmpk_ge_u32 s8, 1174
    s_cbranch_scc1 .ap_196
    s_waitcnt vmcnt(5)
    s_cmpk_ge_u32 s8, 1109
    s_cbranch_scc1 .ap_196
    s_waitcnt vmcnt(3)
    s_bitcmp1_b64 s[14:15], 27
    s_cbranch_scc0 1
    s_waitcnt vmcnt(2)
    s_cmpk_ge_u32 s8, 1034
    s_cbranch_scc1 .ap_196
    s_waitcnt vmcnt(1)
.ap_196:
    s_add_u32 s63, s69, 417792
    buffer_load_dwordx4 v[92:95], v1, s[40:43], s63 offen nt
    s_memrealtime s[8:9]
    s_waitcnt vmcnt(8)
    s_waitcnt lgkmcnt(0)
    s_sub_u32 s8, s8, s30
    s_cmpk_ge_u32 s8, 1201
    s_cbranch_scc1 .ap_197
    s_waitcnt vmcnt(5)
    s_cmpk_ge_u32 s8, 1136
    s_cbranch_scc1 .ap_197
    s_waitcnt vmcnt(3)
    s_bitcmp1_b64 s[14:15], 28
    s_cbranch_scc0 1
    s_waitcnt vmcnt(2)
    s_cmpk_ge_u32 s8, 1061
    s_cbranch_scc1 .ap_197
    s_waitcnt vmcnt(1)
.ap_197:
    s_add_u32 s63, s69, 425984
    buffer_load_dwordx4 v[120:123], v1, s[40:43], s63 offen nt
    s_memrealtime s[8:9]
    s_waitcnt vmcnt(8)
    s_waitcnt lgkmcnt(0)
    s_sub_u32 s8, s8, s30
    s_cmpk_ge_u32 s8, 1228
    s_cbranch_scc1 .ap_198
    s_waitcnt vmcnt(5)
    s_cmpk_ge_u32 s8, 1163
    s_cbranch_scc1 .ap_198
    s_waitcnt vmcnt(3)
    s_bitcmp1_b64 s[14:15], 29
    s_cbranch_scc0 1
    s_waitcnt vmcnt(2)
    s_cmpk_ge_u32 s8, 1088
    s_cbranch_scc1 .ap_198
    s_waitcnt vmcnt(1)
.ap_198:
    s_add_u32 s63, s69, 434176
    buffer_load_dwordx4 v[124:127], v1, s[40:43], s63 offen nt
    s_memrealtime s[8:9]
    s_waitcnt vmcnt(8)
    s_waitcnt lgkmcnt(0)
    s_sub_u32 s8, s8, s30
    s_cmpk_ge_u32 s8, 1255
    s_cbranch_scc1 .ap_199
    s_waitcnt vmcnt(5)
    s_cmpk_ge_u32 s8, 1190
    s_cbranch_scc1 .ap_199
    s_waitcnt vmcnt(3)
    s_bitcmp1_b64 s[14:15], 30
    s_cbranch_scc0 1
    s_waitcnt vmcnt(2)
    s_cmpk_ge_u32 s8, 1115
    s_cbranch_scc1 .ap_199
    s_waitcnt vmcnt(1)
.ap_199:
    s_add_u32 s63, s69, 442368
    buffer_load_dwordx4 v[152:155], v1, s[40:43], s63 offen nt
    s_memrealtime s[8:9]
    s_waitcnt vmcnt(8)
    s_waitcnt lgkmcnt(0)
    s_sub_u32 s8, s8, s30
    s_cmpk_ge_u32 s8, 1282
    s_cbranch_scc1 .ap_200
    s_waitcnt vmcnt(5)
    s_cmpk_ge_u32 s8, 1217
    s_cbranch_scc1 .ap_200
    s_waitcnt vmcnt(3)
    s_bitcmp1_b64 s[14:15], 31
    s_cbranch_scc0 1
    s_waitcnt vmcnt(2)
    s_cmpk_ge_u32 s8, 1142
    s_cbranch_scc1 .ap_200
    s_waitcnt vmcnt(1)
.ap_200:
    s_add_u32 s63, s69, 450560
    buffer_load_dwordx4 v[156:159], v1, s[40:43], s63 offen nt
    buffer_load_dwordx4 v[16:19], v7, s[36:39], s58 offen offset:0 sc1
    buffer_load_dwordx4 v[20:23], v7, s[36:39], s58 offen offset:16 sc1
    s_memrealtime s[8:9]
    s_waitcnt vmcnt(8)
    s_waitcnt lgkmcnt(0)
    s_sub_u32 s8, s8, s30
    s_cmpk_ge_u32 s8, 1309
    s_cbranch_scc1 .ap_201
    s_waitcnt vmcnt(5)
    s_cmpk_ge_u32 s8, 1244
    s_cbranch_scc1 .ap_201
    s_waitcnt vmcnt(3)
    s_bitcmp1_b64 s[14:15], 32
    s_cbranch_scc0 1
    s_waitcnt vmcnt(2)
    s_cmpk_ge_u32 s8, 1169
    s_cbranch_scc1 .ap_201
    s_waitcnt vmcnt(1)
.ap_201:
    s_add_u32 s63, s69, 0
    buffer_load_dwordx4 v[160:163], v2, s[44:47], s63 offen nt
    s_memrealtime s[8:9]
    s_waitcnt vmcnt(8)
    s_waitcnt lgkmcnt(0)
    s_sub_u32 s8, s8, s30
    s_cmpk_ge_u32 s8, 1336
    s_cbranch_scc1 .ap_202
    s_waitcnt vmcnt(5)
    s_cmpk_ge_u32 s8, 1271
    s_cbranch_scc1 .ap_202
    s_waitcnt vmcnt(3)
    s_bitcmp1_b64 s[14:15], 33
    s_cbranch_scc0 1
    s_waitcnt vmcnt(2)
    s_cmpk_ge_u32 s8, 1196
    s_cbranch_scc1 .ap_202
    s_waitcnt vmcnt(1)
.ap_202:
    s_add_u32 s63, s69, 8192
    buffer_load_dwordx4 v[164:167], v2, s[44:47], s63 offen nt
    s_memrealtime s[8:9]
    s_waitcnt vmcnt(8)
    s_waitcnt lgkmcnt(0)
    s_sub_u32 s8, s8, s30
    s_cmpk_ge_u32 s8, 1363
    s_cbranch_scc1 .ap_203
    s_waitcnt vmcnt(5)
    s_cmpk_ge_u32 s8, 1298
    s_cbranch_scc1 .ap_203
    s_waitcnt vmcnt(3)
    s_bitcmp1_b64 s[14:15], 34
    s_cbranch_scc0 1
    s_waitcnt vmcnt(2)
    s_cmpk_ge_u32 s8, 1223
    s_cbranch_scc1 .ap_203
    s_waitcnt vmcnt(1)
.ap_203:
    s_add_u32 s63, s69, 16384
    buffer_load_dwordx4 v[168:171], v2, s[44:47], s63 offen nt
    s_waitcnt vmcnt(3)
    s_branch .gpc_205
.gp_204:
    buffer_load_dwordx4 v[16:19], v7, s[36:39], s58 offen offset:0 sc1
    buffer_load_dwordx4 v[20:23], v7, s[36:39], s58 offen offset:16 sc1
    s_waitcnt vmcnt(0)
.gpc_205:
    v_min_u32 v10, v17, v19
    v_max_u32 v11, v17, v19
    v_min3_u32 v10, v10, v21, v23
    v_max3_u32 v11, v11, v21, v23
    v_cmp_eq_u32 vcc, s34, v10
    v_cmp_eq_u32 s[56:57], s34, v11
    s_and_b64 vcc, vcc, s[56:57]
    s_cmp_eq_u64 vcc, exec
    s_nop 2
    s_cbranch_scc1 .gpd_206
    s_sub_u32 s35, s35, 1
    s_cbranch_scc1 .Lexit
    s_sleep 1
    s_branch .gp_204
.gpd_206:
    s_mov_b32 vcc_lo, 0xcccccccc
    s_mov_b32 vcc_hi, 0xcccccccc
    v_cndmask_b32_e64 v24, v16, 0, vcc
    v_cndmask_b32_e64 v25, v18, 0, vcc
    v_cndmask_b32_e64 v26, v20, 0, vcc
    v_cndmask_b32_e64 v27, v22, 0, vcc
    v_cndmask_b32_e32 v28, 0, v16, vcc
    v_cndmask_b32_e32 v29, 0, v18, vcc
    v_cndmask_b32_e32 v30, 0, v20, vcc
    v_cndmask_b32_e32 v31, 0, v22, vcc
    v_mfma_f32_16x16x32_bf16 v[16:19], v[32:35], v[24:27], 0
    v_mfma_f32_16x16x32_bf16 v[32:35], v[40:43], v[24:27], 0
    v_mfma_f32_16x16x32_bf16 v[16:19], v[36:39], v[28:31], v[16:19]
    v_mfma_f32_16x16x32_bf16 v[40:43], v[48:51], v[24:27], 0
    v_mfma_f32_16x16x32_bf16 v[32:35], v[44:47], v[28:31], v[32:35]
    v_mfma_f32_16x16x32_bf16 v[48:51], v[56:59], v[24:27], 0
    v_mfma_f32_16x16x32_bf16 v[40:43], v[52:55], v[28:31], v[40:43]
    v_mfma_f32_16x16x32_bf16 v[56:59], v[64:67], v[24:27], 0
    v_mfma_f32_16x16x32_bf16 v[48:51], v[60:63], v[28:31], v[48:51]
    s_nop 1
    v_add_f32_dpp v10, v17, v16 row_ror:12 row_mask:0xf bank_mask:0x1
    s_memrealtime s[8:9]
    s_waitcnt lgkmcnt(0)
    s_sub_u32 s8, s8, s30
    s_cmpk_ge_u32 s8, 1390
    s_nop 0
    s_cbranch_scc1 .ap_207
    s_waitcnt vmcnt(3)
    s_cmpk_ge_u32 s8, 1325
    s_cbranch_scc1 .ap_207
    s_waitcnt vmcnt(3)
    s_bitcmp1_b64 s[14:15], 35
    s_cbranch_scc0 1
    s_waitcnt vmcnt(2)
    s_cmpk_ge_u32 s8, 1250
    s_cbranch_scc1 .ap_207
    s_waitcnt vmcnt(1)
.ap_207:
    s_add_u32 s63, s69, 24576
    buffer_load_dwordx4 v[172:175], v2, s[44:47], s63 offen nt
    v_mfma_f32_16x16x32_bf16 v[64:67], v[72:75], v[24:27], 0
    v_mfma_f32_16x16x32_bf16 v[56:59], v[68:71], v[28:31], v[56:59]
    v_add_f32_dpp v11, v33, v32 row_ror:12 row_mask:0xf bank_mask:0x1
    v_add_f32_dpp v10, v18, v10 row_ror:8 row_mask:0xf bank_mask:0x1
    v_mfma_f32_16x16x32_bf16 v[72:75], v[80:83], v[24:27], 0
    v_mfma_f32_16x16x32_bf16 v[64:67], v[76:79], v[28:31], v[64:67]
    v_add_f32_dpp v12, v41, v40 row_ror:12 row_mask:0xf bank_mask:0x1
    v_add_f32_dpp v11, v34, v11 row_ror:8 row_mask:0xf bank_mask:0x1
    v_add_f32_dpp v10, v19, v10 row_ror:4 row_mask:0xf bank_mask:0x1
    v_mfma_f32_16x16x32_bf16 v[80:83], v[88:91], v[24:27], 0
    v_mfma_f32_16x16x32_bf16 v[72:75], v[84:87], v[28:31], v[72:75]
    v_add_f32_dpp v13, v49, v48 row_ror:12 row_mask:0xf bank_mask:0x1
    v_add_f32_dpp v12, v42, v12 row_ror:8 row_mask:0xf bank_mask:0x1
    v_add_f32_dpp v11, v35, v11 row_ror:4 row_mask:0xf bank_mask:0x1
    v_mfma_f32_16x16x32_bf16 v[88:91], v[96:99], v[24:27], 0
    v_mfma_f32_16x16x32_bf16 v[80:83], v[92:95], v[28:31], v[80:83]
    v_add_f32_dpp v10, v58, v57 row_ror:12 row_mask:0xf bank_mask:0x2
    v_add_f32_dpp v13, v50, v13 row_ror:8 row_mask:0xf bank_mask:0x1
    v_add_f32_dpp v12, v43, v12 row_ror:4 row_mask:0xf bank_mask:0x1
    s_memrealtime s[8:9]
    s_waitcnt lgkmcnt(0)
    s_sub_u32 s8, s8, s30
    s_cmpk_ge_u32 s8, 1417
    s_nop 0
    s_cbranch_scc1 .ap_208
    s_waitcnt vmcnt(4)
    s_cmpk_ge_u32 s8, 1352
    s_cbranch_scc1 .ap_208
    s_waitcnt vmcnt(3)
    s_bitcmp1_b64 s[14:15], 36
    s_cbranch_scc0 1
    s_waitcnt vmcnt(2)
    s_cmpk_ge_u32 s8, 1277
    s_cbranch_scc1 .ap_208
    s_waitcnt vmcnt(1)
.ap_208:
    s_add_u32 s63, s69, 32768
    buffer_load_dwordx4 v[176:179], v2, s[44:47], s63 offen nt
    v_mfma_f32_16x16x32_bf16 v[96:99], v[104:107], v[24:27], 0
    v_mfma_f32_16x16x32_bf16 v[88:91], v[100:103], v[28:31], v[88:91]
    v_add_f32_dpp v11, v66, v65 row_ror:12 row_mask:0xf bank_mask:0x2
    v_add_f32_dpp v10, v59, v10 row_ror:8 row_mask:0xf bank_mask:0x2
    v_add_f32_dpp v13, v51, v13 row_ror:4 row_mask:0xf bank_mask:0x1
    v_mfma_f32_16x16x32_bf16 v[104:107], v[112:115], v[24:27], 0
    v_mfma_f32_16x16x32_bf16 v[96:99], v[108:111], v[28:31], v[96:99]
    v_add_f32_dpp v12, v74, v73 row_ror:12 row_mask:0xf bank_mask:0x2
    v_add_f32_dpp v11, v67, v11 row_ror:8 row_mask:0xf bank_mask:0x2
    v_add_f32_dpp v10, v56, v10 row_ror:4 row_mask:0xf bank_mask:0x2
    v_mfma_f32_16x16x32_bf16 v[112:115], v[120:123], v[24:27], 0
    v_mfma_f32_16x16x32_bf16 v[104:107], v[116:119], v[28:31], v[104:107]
    v_add_f32_dpp v13, v82, v81 row_ror:12 row_mask:0xf bank_mask:0x2
    v_add_f32_dpp v12, v75, v12 row_ror:8 row_mask:0xf bank_mask:0x2
    v_add_f32_dpp v11, v64, v11 row_ror:4 row_mask:0xf bank_mask:0x2
    v_mfma_f32_16x16x32_bf16 v[120:123], v[128:131], v[24:27], 0
    v_mfma_f32_16x16x32_bf16 v[112:115], v[124:127], v[28:31], v[112:115]
    v_add_f32_dpp v10, v91, v90 row_ror:12 row_mask:0xf bank_mask:0x4
    v_add_f32_dpp v13, v83, v13 row_ror:8 row_mask:0xf bank_mask:0x2
    v_add_f32_dpp v12, v72, v12 row_ror:4 row_mask:0xf bank_mask:0x2
    s_memrealtime s[8:9]
    s_waitcnt lgkmcnt(0)
    s_sub_u32 s8, s8, s30
    s_cmpk_ge_u32 s8, 1444
    s_nop 0
    s_cbranch_scc1 .ap_209
    s_waitcnt vmcnt(5)
    s_cmpk_ge_u32 s8, 1379
    s_cbranch_scc1 .ap_209
    s_waitcnt vmcnt(3)
    s_bitcmp1_b64 s[14:15], 37
    s_cbranch_scc0 1
    s_waitcnt vmcnt(2)
    s_cmpk_ge_u32 s8, 1304
    s_cbranch_scc1 .ap_209
    s_waitcnt vmcnt(1)
.ap_209:
    s_add_u32 s63, s69, 40960
    buffer_load_dwordx4 v[180:183], v2, s[44:47], s63 offen nt
    v_mfma_f32_16x16x32_bf16 v[128:131], v[136:139], v[24:27], 0
    v_mfma_f32_16x16x32_bf16 v[120:123], v[132:135], v[28:31], v[120:123]
    v_add_f32_dpp v11, v99, v98 row_ror:12 row_mask:0xf bank_mask:0x4
    v_add_f32_dpp v10, v88, v10 row_ror:8 row_mask:0xf bank_mask:0x4
    v_add_f32_dpp v13, v80, v13 row_ror:4 row_mask:0xf bank_mask:0x2
    v_mfma_f32_16x16x32_bf16 v[136:139], v[144:147], v[24:27], 0
    v_mfma_f32_16x16x32_bf16 v[128:131], v[140:143], v[28:31], v[128:131]
    v_add_f32_dpp v12, v107, v106 row_ror:12 row_mask:0xf bank_mask:0x4
    v_add_f32_dpp v11, v96, v11 row_ror:8 row_mask:0xf bank_mask:0x4
    v_add_f32_dpp v10, v89, v10 row_ror:4 row_mask:0xf bank_mask:0x4
    v_mfma_f32_16x16x32_bf16 v[144:147], v[152:155], v[24:27], 0
    v_mfma_f32_16x16x32_bf16 v[136:139], v[148:151], v[28:31], v[136:139]
    v_add_f32_dpp v13, v115, v114 row_ror:12 row_mask:0xf bank_mask:0x4
    v_add_f32_dpp v12, v104, v12 row_ror:8 row_mask:0xf bank_mask:0x4
    v_add_f32_dpp v11, v97, v11 row_ror:4 row_mask:0xf bank_mask:0x4
    v_mfma_f32_16x16x32_bf16 v[144:147], v[156:159], v[28:31], v[144:147]
    v_add_f32_dpp v10, v120, v123 row_ror:12 row_mask:0xf bank_mask:0x8
    v_add_f32_dpp v13, v112, v13 row_ror:8 row_mask:0xf bank_mask:0x4
    v_add_f32_dpp v12, v105, v12 row_ror:4 row_mask:0xf bank_mask:0x4
    s_memrealtime s[8:9]
    s_waitcnt lgkmcnt(0)
    s_sub_u32 s8, s8, s30
    s_cmpk_ge_u32 s8, 1471
    s_nop 0
    s_cbranch_scc1 .ap_210
    s_waitcnt vmcnt(5)
    s_cmpk_ge_u32 s8, 1406
    s_cbranch_scc1 .ap_210
    s_waitcnt vmcnt(3)
    s_bitcmp1_b64 s[14:15], 38
    s_cbranch_scc0 1
    s_waitcnt vmcnt(2)
    s_cmpk_ge_u32 s8, 1331
    s_cbranch_scc1 .ap_210
    s_waitcnt vmcnt(1)
.ap_210:
    s_add_u32 s63, s69, 49152
    buffer_load_dwordx4 v[184:187], v2, s[44:47], s63 offen nt
    v_add_f32_dpp v11, v128, v131 row_ror:12 row_mask:0xf bank_mask:0x8
    v_add_f32_dpp v10, v121, v10 row_ror:8 row_mask:0xf bank_mask:0x8
    v_add_f32_dpp v13, v113, v13 row_ror:4 row_mask:0xf bank_mask:0x4
    v_add_f32_dpp v12, v136, v139 row_ror:12 row_mask:0xf bank_mask:0x8
    v_add_f32_dpp v11, v129, v11 row_ror:8 row_mask:0xf bank_mask:0x8
    v_add_f32_dpp v10, v122, v10 row_ror:4 row_mask:0xf bank_mask:0x8
    v_add_f32_dpp v13, v144, v147 row_ror:12 row_mask:0xf bank_mask:0x8
    v_add_f32_dpp v12, v137, v12 row_ror:8 row_mask:0xf bank_mask:0x8
    v_add_f32_dpp v11, v130, v11 row_ror:4 row_mask:0xf bank_mask:0x8
    v_add_f32_dpp v13, v145, v13 row_ror:8 row_mask:0xf bank_mask:0x8
    v_add_f32_dpp v12, v138, v12 row_ror:4 row_mask:0xf bank_mask:0x8
    s_memrealtime s[8:9]
    s_waitcnt lgkmcnt(0)
    s_sub_u32 s8, s8, s30
    s_cmpk_ge_u32 s8, 1498
    s_cbranch_scc1 .ap_211
    s_waitcnt vmcnt(5)
    s_cmpk_ge_u32 s8, 1433
    s_cbranch_scc1 .ap_211
    s_waitcnt vmcnt(3)
    s_bitcmp1_b64 s[14:15], 39
    s_cbranch_scc0 1
    s_waitcnt vmcnt(2)
    s_cmpk_ge_u32 s8, 1358
    s_cbranch_scc1 .ap_211
    s_waitcnt vmcnt(1)
.ap_211:
    s_add_u32 s63, s69, 57344
    buffer_load_dwordx4 v[188:191], v2, s[44:47], s63 offen nt
    v_add_f32_dpp v13, v146, v13 row_ror:4 row_mask:0xf bank_mask:0x8
    s_mov_b32 s60, 0x3db504f3
    s_mov_b32 s61, 0x3db504f3
    v_cvt_pk_bf16_f32 v10, v10, v11
    v_and_b32 v11, 0xffff0000, v10
    v_lshlrev_b32 v10, 16, v10
    v_cvt_pk_bf16_f32 v12, v12, v13
    v_and_b32 v13, 0xffff0000, v12
    v_lshlrev_b32 v12, 16, v12
    v_pk_mul_f32 v[10:11], v[10:11], s[60:61]
    v_pk_mul_f32 v[12:13], v[12:13], s[60:61]
    v_cvt_pk_bf16_f32 v10, v10, v11
    v_and_b32 v11, 0xffff0000, v10
    v_lshlrev_b32 v10, 16, v10
    v_cvt_pk_bf16_f32 v12, v12, v13
    v_and_b32 v13, 0xffff0000, v12
    v_lshlrev_b32 v12, 16, v12
    v_max_f32 v14, v10, v11
    v_max3_f32 v14, v14, v12, v13
    s_mov_b32 s60, 0x3fb8aa3b
    v_mov_b32 v22, s34
    v_mov_b32 v23, s34
    v_max_f32_dpp v14, v14, v14 quad_perm:[2,3,0,1] row_mask:0xf bank_mask:0xf
    s_nop 1
    v_max_f32_dpp v14, v14, v14 row_ror:4 row_mask:0xf bank_mask:0xf
    s_nop 1
    v_max_f32_dpp v14, v14, v14 row_ror:8 row_mask:0xf bank_mask:0xf
    v_mov_b32 v15, v14
    s_nop 1
    v_permlane16_swap_b32 v15, v14
    v_max_f32 v14, v15, v14
    v_mov_b32 v15, v14
    s_nop 1
    v_permlane32_swap_b32 v15, v14
    v_max_f32 v14, v15, v14
    v_mul_f32 v15, 0xbfb8aa3b, v14
    v_fma_f32 v10, v10, s60, v15
    v_fma_f32 v11, v11, s60, v15
    v_fma_f32 v12, v12, s60, v15
    v_fma_f32 v13, v13, s60, v15
    v_exp_f32 v10, v10
    v_exp_f32 v11, v11
    v_exp_f32 v12, v12
    v_exp_f32 v13, v13
    v_mov_b32 v20, v14
    v_pk_add_f32 v[16:17], v[10:11], v[12:13]
    v_add_f32 v21, v16, v17
    s_lshl3_add_u32 s60, s68, s3
    s_lshl_b32 s60, s60, 5
    s_add_u32 s60, s60, s59
    v_add_f32_dpp v21, v21, v21 quad_perm:[2,3,0,1] row_mask:0xf bank_mask:0xf
    s_nop 1
    v_add_f32_dpp v21, v21, v21 row_ror:4 row_mask:0xf bank_mask:0xf
    s_nop 1
    v_add_f32_dpp v21, v21, v21 row_ror:8 row_mask:0xf bank_mask:0xf
    v_mov_b32 v15, v21
    s_nop 1
    v_permlane16_swap_b32 v15, v21
    v_add_f32 v21, v15, v21
    v_mov_b32 v15, v21
    s_nop 1
    v_permlane32_swap_b32 v15, v21
    v_add_f32 v21, v15, v21
    s_lshl_b32 s60, s3, 4
    s_add_u32 s60, s60, 159104
    v_add_u32 v16, s60, v3
    v_mov_b32 v17, 159232
    v_mov_b32 v18, 1
    s_mov_b64 exec, 3
    ds_write_b64 v16, v[20:21]
    s_mov_b64 exec, 1
    s_waitcnt lgkmcnt(0)
    ds_add_rtn_u32 v18, v17, v18
    s_mov_b64 exec, -1
    v_and_b32 v16, 0x78, v3
    v_add_u32 v16, 159104, v16
    s_waitcnt lgkmcnt(0)
    v_readfirstlane_b32 s60, v18
    s_cmp_lg_u32 s60, 7
    s_nop 3
    s_cbranch_scc1 .ml_212
    ds_read_b64 v[18:19], v16
    s_lshl_b32 s60, s68, 7
    s_add_u32 s60, s60, s59
    s_waitcnt lgkmcnt(0)
    v_mov_b32 v20, v18
    s_nop 1
    v_max_f32_dpp v20, v20, v20 quad_perm:[2,3,0,1] row_mask:0xf bank_mask:0xf
    s_nop 1
    v_max_f32_dpp v20, v20, v20 row_ror:4 row_mask:0xf bank_mask:0xf
    s_nop 1
    v_max_f32_dpp v20, v20, v20 row_ror:8 row_mask:0xf bank_mask:0xf
    v_sub_f32 v18, v18, v20
    v_mul_f32 v18, 0x3fb8aa3b, v18
    v_exp_f32 v18, v18
    s_nop 0
    v_mul_f32 v21, v18, v19
    s_nop 1
    v_add_f32_dpp v21, v21, v21 quad_perm:[2,3,0,1] row_mask:0xf bank_mask:0xf
    s_nop 1
    v_add_f32_dpp v21, v21, v21 row_ror:4 row_mask:0xf bank_mask:0xf
    s_nop 1
    v_add_f32_dpp v21, v21, v21 row_ror:8 row_mask:0xf bank_mask:0xf
    s_mov_b64 exec, 0xff
    buffer_store_dwordx4 v[20:23], v2, s[36:39], s60 offen sc1
    s_mov_b64 exec, -1
.ml_212:
    s_memrealtime s[8:9]
    s_waitcnt lgkmcnt(0)
    s_sub_u32 s8, s8, s30
    s_cmpk_ge_u32 s8, 1525
    s_cbranch_scc1 .ap_213
    s_waitcnt vmcnt(5)
    s_cmpk_ge_u32 s8, 1460
    s_cbranch_scc1 .ap_213
    s_waitcnt vmcnt(3)
    s_bitcmp1_b64 s[14:15], 40
    s_cbranch_scc0 1
    s_waitcnt vmcnt(2)
    s_cmpk_ge_u32 s8, 1385
    s_cbranch_scc1 .ap_213
    s_waitcnt vmcnt(1)
.ap_213:
    s_add_u32 s63, s69, 131072
    buffer_load_dwordx4 v[192:195], v2, s[44:47], s63 offen nt
    s_memrealtime s[8:9]
    s_waitcnt vmcnt(8)
    s_waitcnt lgkmcnt(0)
    s_sub_u32 s8, s8, s30
    s_cmpk_ge_u32 s8, 1552
    s_cbranch_scc1 .ap_214
    s_waitcnt vmcnt(5)
    s_cmpk_ge_u32 s8, 1487
    s_cbranch_scc1 .ap_214
    s_waitcnt vmcnt(3)
    s_bitcmp1_b64 s[14:15], 41
    s_cbranch_scc0 1
    s_waitcnt vmcnt(2)
    s_cmpk_ge_u32 s8, 1412
    s_cbranch_scc1 .ap_214
    s_waitcnt vmcnt(1)
.ap_214:
    s_add_u32 s63, s69, 139264
    buffer_load_dwordx4 v[196:199], v2, s[44:47], s63 offen nt
    s_memrealtime s[8:9]
    s_waitcnt vmcnt(8)
    s_waitcnt lgkmcnt(0)
    s_sub_u32 s8, s8, s30
    s_cmpk_ge_u32 s8, 1579
    s_cbranch_scc1 .ap_215
    s_waitcnt vmcnt(5)
    s_cmpk_ge_u32 s8, 1514
    s_cbranch_scc1 .ap_215
    s_waitcnt vmcnt(3)
    s_bitcmp1_b64 s[14:15], 42
    s_cbranch_scc0 1
    s_waitcnt vmcnt(2)
    s_cmpk_ge_u32 s8, 1439
    s_cbranch_scc1 .ap_215
    s_waitcnt vmcnt(1)
.ap_215:
    s_add_u32 s63, s69, 147456
    buffer_load_dwordx4 v[200:203], v2, s[44:47], s63 offen nt
    s_memrealtime s[8:9]
    s_waitcnt vmcnt(8)
    s_waitcnt lgkmcnt(0)
    s_sub_u32 s8, s8, s30
    s_cmpk_ge_u32 s8, 1606
    s_cbranch_scc1 .ap_216
    s_waitcnt vmcnt(5)
    s_cmpk_ge_u32 s8, 1541
    s_cbranch_scc1 .ap_216
    s_waitcnt vmcnt(3)
    s_bitcmp1_b64 s[14:15], 43
    s_cbranch_scc0 1
    s_waitcnt vmcnt(2)
    s_cmpk_ge_u32 s8, 1466
    s_cbranch_scc1 .ap_216
    s_waitcnt vmcnt(1)
.ap_216:
    s_add_u32 s63, s69, 155648
    buffer_load_dwordx4 v[204:207], v2, s[44:47], s63 offen nt
    s_memrealtime s[8:9]
    s_waitcnt vmcnt(8)
    s_waitcnt lgkmcnt(0)
    s_sub_u32 s8, s8, s30
    s_cmpk_ge_u32 s8, 1633
    s_cbranch_scc1 .ap_217
    s_waitcnt vmcnt(5)
    s_cmpk_ge_u32 s8, 1568
    s_cbranch_scc1 .ap_217
    s_waitcnt vmcnt(3)
    s_bitcmp1_b64 s[14:15], 44
    s_cbranch_scc0 1
    s_waitcnt vmcnt(2)
    s_cmpk_ge_u32 s8, 1493
    s_cbranch_scc1 .ap_217
    s_waitcnt vmcnt(1)
.ap_217:
    s_add_u32 s63, s69, 163840
    buffer_load_dwordx4 v[208:211], v2, s[44:47], s63 offen nt
    s_memrealtime s[8:9]
    s_waitcnt vmcnt(8)
    s_waitcnt lgkmcnt(0)
    s_sub_u32 s8, s8, s30
    s_cmpk_ge_u32 s8, 1660
    s_cbranch_scc1 .ap_218
    s_waitcnt vmcnt(5)
    s_cmpk_ge_u32 s8, 1595
    s_cbranch_scc1 .ap_218
    s_waitcnt vmcnt(3)
    s_bitcmp1_b64 s[14:15], 45
    s_cbranch_scc0 1
    s_waitcnt vmcnt(2)
    s_cmpk_ge_u32 s8, 1520
    s_cbranch_scc1 .ap_218
    s_waitcnt vmcnt(1)
.ap_218:
    s_add_u32 s63, s69, 172032
    buffer_load_dwordx4 v[212:215], v2, s[44:47], s63 offen nt
    s_memrealtime s[8:9]
    s_waitcnt vmcnt(8)
    s_waitcnt lgkmcnt(0)
    s_sub_u32 s8, s8, s30
    s_cmpk_ge_u32 s8, 1691
    s_cbranch_scc1 .ap_219
    s_waitcnt vmcnt(5)
    s_cmpk_ge_u32 s8, 1626
    s_cbranch_scc1 .ap_219
    s_waitcnt vmcnt(3)
    s_bitcmp1_b64 s[14:15], 46
    s_cbranch_scc0 1
    s_waitcnt vmcnt(2)
    s_cmpk_ge_u32 s8, 1551
    s_cbranch_scc1 .ap_219
    s_waitcnt vmcnt(1)
.ap_219:
    s_add_u32 s63, s69, 180224
    buffer_load_dwordx4 v[216:219], v2, s[44:47], s63 offen nt
    s_memrealtime s[8:9]
    s_waitcnt vmcnt(8)
    s_waitcnt lgkmcnt(0)
    s_sub_u32 s8, s8, s30
    s_cmpk_ge_u32 s8, 1722
    s_cbranch_scc1 .ap_220
    s_waitcnt vmcnt(5)
    s_cmpk_ge_u32 s8, 1657
    s_cbranch_scc1 .ap_220
    s_waitcnt vmcnt(3)
    s_bitcmp1_b64 s[14:15], 47
    s_cbranch_scc0 1
    s_waitcnt vmcnt(2)
    s_cmpk_ge_u32 s8, 1582
    s_cbranch_scc1 .ap_220
    s_waitcnt vmcnt(1)
.ap_220:
    s_add_u32 s63, s69, 188416
    buffer_load_dwordx4 v[220:223], v2, s[44:47], s63 offen nt
    s_memrealtime s[8:9]
    s_waitcnt vmcnt(8)
    s_waitcnt lgkmcnt(0)
    s_sub_u32 s8, s8, s30
    s_cmpk_ge_u32 s8, 1753
    s_cbranch_scc1 .ap_221
    s_waitcnt vmcnt(5)
    s_cmpk_ge_u32 s8, 1688
    s_cbranch_scc1 .ap_221
    s_waitcnt vmcnt(3)
    s_bitcmp1_b64 s[14:15], 48
    s_cbranch_scc0 1
    s_waitcnt vmcnt(2)
    s_cmpk_ge_u32 s8, 1613
    s_cbranch_scc1 .ap_221
    s_waitcnt vmcnt(1)
.ap_221:
    s_add_u32 s63, s69, 262144
    buffer_load_dwordx4 v[224:227], v2, s[44:47], s63 offen nt
    s_memrealtime s[8:9]
    s_waitcnt vmcnt(8)
    s_waitcnt lgkmcnt(0)
    s_sub_u32 s8, s8, s30
    s_cmpk_ge_u32 s8, 1784
    s_cbranch_scc1 .ap_222
    s_waitcnt vmcnt(5)
    s_cmpk_ge_u32 s8, 1719
    s_cbranch_scc1 .ap_222
    s_waitcnt vmcnt(3)
    s_bitcmp1_b64 s[14:15], 49
    s_cbranch_scc0 1
    s_waitcnt vmcnt(2)
    s_cmpk_ge_u32 s8, 1644
    s_cbranch_scc1 .ap_222
    s_waitcnt vmcnt(1)
.ap_222:
    s_add_u32 s63, s69, 270336
    buffer_load_dwordx4 v[228:231], v2, s[44:47], s63 offen nt
    s_memrealtime s[8:9]
    s_waitcnt vmcnt(8)
    s_waitcnt lgkmcnt(0)
    s_sub_u32 s8, s8, s30
    s_cmpk_ge_u32 s8, 1815
    s_cbranch_scc1 .ap_223
    s_waitcnt vmcnt(5)
    s_cmpk_ge_u32 s8, 1750
    s_cbranch_scc1 .ap_223
    s_waitcnt vmcnt(3)
    s_bitcmp1_b64 s[14:15], 50
    s_cbranch_scc0 1
    s_waitcnt vmcnt(2)
    s_cmpk_ge_u32 s8, 1675
    s_cbranch_scc1 .ap_223
    s_waitcnt vmcnt(1)
.ap_223:
    s_add_u32 s63, s69, 278528
    buffer_load_dwordx4 v[232:235], v2, s[44:47], s63 offen nt
    s_memrealtime s[8:9]
    s_waitcnt vmcnt(8)
    s_waitcnt lgkmcnt(0)
    s_sub_u32 s8, s8, s30
    s_cmpk_ge_u32 s8, 1846
    s_cbranch_scc1 .ap_224
    s_waitcnt vmcnt(5)
    s_cmpk_ge_u32 s8, 1781
    s_cbranch_scc1 .ap_224
    s_waitcnt vmcnt(3)
    s_bitcmp1_b64 s[14:15], 51
    s_cbranch_scc0 1
    s_waitcnt vmcnt(2)
    s_cmpk_ge_u32 s8, 1706
    s_cbranch_scc1 .ap_224
    s_waitcnt vmcnt(1)
.ap_224:
    s_add_u32 s63, s69, 286720
    buffer_load_dwordx4 v[236:239], v2, s[44:47], s63 offen nt
    s_memrealtime s[8:9]
    s_waitcnt vmcnt(8)
    s_waitcnt lgkmcnt(0)
    s_sub_u32 s8, s8, s30
    s_cmpk_ge_u32 s8, 1877
    s_cbranch_scc1 .ap_225
    s_waitcnt vmcnt(5)
    s_cmpk_ge_u32 s8, 1812
    s_cbranch_scc1 .ap_225
    s_waitcnt vmcnt(3)
    s_bitcmp1_b64 s[14:15], 52
    s_cbranch_scc0 1
    s_waitcnt vmcnt(2)
    s_cmpk_ge_u32 s8, 1737
    s_cbranch_scc1 .ap_225
    s_waitcnt vmcnt(1)
.ap_225:
    s_add_u32 s63, s69, 294912
    buffer_load_dwordx4 v[240:243], v2, s[44:47], s63 offen nt
    s_memrealtime s[8:9]
    s_waitcnt vmcnt(8)
    s_waitcnt lgkmcnt(0)
    s_sub_u32 s8, s8, s30
    s_cmpk_ge_u32 s8, 1908
    s_cbranch_scc1 .ap_226
    s_waitcnt vmcnt(5)
    s_cmpk_ge_u32 s8, 1843
    s_cbranch_scc1 .ap_226
    s_waitcnt vmcnt(3)
    s_bitcmp1_b64 s[14:15], 53
    s_cbranch_scc0 1
    s_waitcnt vmcnt(2)
    s_cmpk_ge_u32 s8, 1768
    s_cbranch_scc1 .ap_226
    s_waitcnt vmcnt(1)
.ap_226:
    s_add_u32 s63, s69, 303104
    buffer_load_dwordx4 v[244:247], v2, s[44:47], s63 offen nt
    s_load_dwordx2 s[88:89], s[6:7], s0
    buffer_load_dwordx4 v[24:27], v9, s[36:39], s59 offen offset:0 sc1
    s_memrealtime s[8:9]
    s_waitcnt vmcnt(8)
    s_waitcnt lgkmcnt(0)
    s_sub_u32 s8, s8, s30
    s_cmpk_ge_u32 s8, 1939
    s_cbranch_scc1 .ap_227
    s_waitcnt vmcnt(5)
    s_cmpk_ge_u32 s8, 1874
    s_cbranch_scc1 .ap_227
    s_waitcnt vmcnt(3)
    s_bitcmp1_b64 s[14:15], 54
    s_cbranch_scc0 1
    s_waitcnt vmcnt(2)
    s_cmpk_ge_u32 s8, 1799
    s_cbranch_scc1 .ap_227
    s_waitcnt vmcnt(1)
.ap_227:
    s_add_u32 s63, s69, 311296
    buffer_load_dwordx4 v[248:251], v2, s[44:47], s63 offen nt
    s_sub_u32 s56, s65, 27
    s_lshl3_add_u32 s56, s56, s3
    s_cmp_ge_u32 s56, 11
    s_cbranch_scc1 .cpf_228
    s_getpc_b64 s[8:9]
.Lcpf_pc:
    s_cmp_ge_u32 s56, 6
    s_mov_b32 s57, .Lcpf_pc-.Ltail_ar
    s_cselect_b32 s57, .Lcpf_pc-.Ltail_bc+6144, s57
    s_lshl_b32 s56, s56, 10
    s_sub_u32 s56, s57, s56
    s_sub_u32 s8, s8, s56
    s_subb_u32 s9, s9, 0
    v_mov_b32 v41, s9
    v_add_co_u32 v40, vcc, s8, v2
    s_nop 1
    v_addc_co_u32 v41, vcc, 0, v41, vcc
    global_load_dwordx4 v[32:35], v[40:41], off
.cpf_228:
    s_memrealtime s[8:9]
    s_waitcnt vmcnt(8)
    s_waitcnt lgkmcnt(0)
    s_sub_u32 s8, s8, s30
    s_cmpk_ge_u32 s8, 1970
    s_cbranch_scc1 .ap_229
    s_waitcnt vmcnt(5)
    s_cmpk_ge_u32 s8, 1905
    s_cbranch_scc1 .ap_229
    s_waitcnt vmcnt(3)
    s_bitcmp1_b64 s[14:15], 55
    s_cbranch_scc0 1
    s_waitcnt vmcnt(2)
    s_cmpk_ge_u32 s8, 1830
    s_cbranch_scc1 .ap_229
    s_waitcnt vmcnt(1)
.ap_229:
    s_add_u32 s63, s69, 319488
    buffer_load_dwordx4 v[252:255], v2, s[44:47], s63 offen nt
    s_memrealtime s[8:9]
    s_waitcnt vmcnt(8)
    s_waitcnt lgkmcnt(0)
    s_sub_u32 s8, s8, s30
    s_cmpk_ge_u32 s8, 2001
    s_cbranch_scc1 .ap_230
    s_waitcnt vmcnt(5)
    s_cmpk_ge_u32 s8, 1936
    s_cbranch_scc1 .ap_230
    s_waitcnt vmcnt(3)
    s_bitcmp1_b64 s[14:15], 56
    s_cbranch_scc0 1
    s_waitcnt vmcnt(2)
    s_cmpk_ge_u32 s8, 1861
    s_cbranch_scc1 .ap_230
    s_waitcnt vmcnt(1)
.ap_230:
    s_add_u32 s63, s69, 393216
    buffer_load_dwordx4 v[36:39], v2, s[44:47], s63 offen nt
    s_memrealtime s[8:9]
    s_waitcnt vmcnt(8)
    s_waitcnt lgkmcnt(0)
    s_sub_u32 s8, s8, s30
    s_cmpk_ge_u32 s8, 2032
    s_cbranch_scc1 .ap_231
    s_waitcnt vmcnt(5)
    s_cmpk_ge_u32 s8, 1967
    s_cbranch_scc1 .ap_231
    s_waitcnt vmcnt(3)
    s_bitcmp1_b64 s[14:15], 57
    s_cbranch_scc0 1
    s_waitcnt vmcnt(2)
    s_cmpk_ge_u32 s8, 1892
    s_cbranch_scc1 .ap_231
    s_waitcnt vmcnt(1)
.ap_231:
    s_add_u32 s63, s69, 401408
    buffer_load_dwordx4 v[44:47], v2, s[44:47], s63 offen nt
    s_memrealtime s[8:9]
    s_waitcnt vmcnt(8)
    s_waitcnt lgkmcnt(0)
    s_sub_u32 s8, s8, s30
    s_cmpk_ge_u32 s8, 2063
    s_cbranch_scc1 .ap_232
    s_waitcnt vmcnt(5)
    s_cmpk_ge_u32 s8, 1998
    s_cbranch_scc1 .ap_232
    s_waitcnt vmcnt(3)
    s_bitcmp1_b64 s[14:15], 58
    s_cbranch_scc0 1
    s_waitcnt vmcnt(2)
    s_cmpk_ge_u32 s8, 1923
    s_cbranch_scc1 .ap_232
    s_waitcnt vmcnt(1)
.ap_232:
    s_add_u32 s63, s69, 409600
    buffer_load_dwordx4 v[52:55], v2, s[44:47], s63 offen nt
    s_waitcnt vmcnt(5)
    s_branch .gpc_234
.gp_233:
    buffer_load_dwordx4 v[24:27], v9, s[36:39], s59 offen offset:0 sc1
    s_waitcnt vmcnt(0)
.gpc_234:
    v_cmp_eq_u32 vcc, s34, v26
    s_cmp_eq_u64 vcc, exec
    s_nop 3
    s_cbranch_scc1 .gpd_235
    s_sub_u32 s35, s35, 1
    s_cbranch_scc1 .Lexit
    s_sleep 1
    s_branch .gp_233
.gpd_235:
    s_lshr_b64 s[88:89], s[88:89], s1
    s_and_b32 s88, s88, 0xff
    s_cmp_eq_u32 s88, 32
    s_cselect_b32 s0, 0xac000, 0
    v_mov_b32 v16, v24
    s_nop 1
    v_max_f32_dpp v16, v16, v16 quad_perm:[2,3,0,1] row_mask:0xf bank_mask:0xf
    v_sub_f32 v17, v24, v16
    v_sub_f32 v18, v14, v16
    v_mul_f32 v17, 0x3fb8aa3b, v17
    v_mul_f32 v18, 0x3fb8aa3b, v18
    v_exp_f32 v17, v17
    v_exp_f32 v18, v18
    v_mul_f32 v17, v17, v25
    s_nop 1
    v_add_f32_dpp v17, v17, v17 quad_perm:[2,3,0,1] row_mask:0xf bank_mask:0xf
    v_rcp_f32 v19, v17
    s_nop 0
    v_fma_f32 v15, -v17, v19, 1.0
    v_fma_f32 v19, v15, v19, v19
    v_mul_f32 v18, v18, v19
    v_mul_f32 v10, v10, v18
    v_mul_f32 v11, v11, v18
    v_mul_f32 v12, v12, v18
    v_mul_f32 v13, v13, v18
    v_mov_b32_dpp v112, v10 quad_perm:[2,3,0,1] row_mask:0xf bank_mask:0xf
    v_mov_b32_dpp v113, v11 quad_perm:[2,3,0,1] row_mask:0xf bank_mask:0xf
    v_mov_b32_dpp v114, v12 quad_perm:[2,3,0,1] row_mask:0xf bank_mask:0xf
    v_mov_b32_dpp v115, v13 quad_perm:[2,3,0,1] row_mask:0xf bank_mask:0xf
    v_cvt_pk_bf16_f32 v96, v10, v112
    v_cvt_pk_bf16_f32 v100, v11, v113
    v_cvt_pk_bf16_f32 v104, v12, v114
    v_cvt_pk_bf16_f32 v108, v13, v115
    v_mov_b32_dpp v97, v96 row_ror:12 row_mask:0xf bank_mask:0xf
    v_mov_b32_dpp v101, v100 row_ror:12 row_mask:0xf bank_mask:0xf
    v_mov_b32_dpp v105, v104 row_ror:12 row_mask:0xf bank_mask:0xf
    v_mov_b32_dpp v109, v108 row_ror:12 row_mask:0xf bank_mask:0xf
    v_mov_b32_dpp v98, v96 row_ror:8 row_mask:0xf bank_mask:0xf
    v_mov_b32_dpp v102, v100 row_ror:8 row_mask:0xf bank_mask:0xf
    v_mov_b32_dpp v106, v104 row_ror:8 row_mask:0xf bank_mask:0xf
    v_mov_b32_dpp v110, v108 row_ror:8 row_mask:0xf bank_mask:0xf
    v_mov_b32_dpp v99, v96 row_ror:4 row_mask:0xf bank_mask:0xf
    v_mov_b32_dpp v103, v100 row_ror:4 row_mask:0xf bank_mask:0xf
    v_mov_b32_dpp v107, v104 row_ror:4 row_mask:0xf bank_mask:0xf
    v_mov_b32_dpp v111, v108 row_ror:4 row_mask:0xf bank_mask:0xf
    s_memrealtime s[8:9]
    s_waitcnt lgkmcnt(0)
    s_sub_u32 s8, s8, s30
    s_cmpk_ge_u32 s8, 2094
    s_cbranch_scc1 .ap_236
    s_waitcnt vmcnt(5)
    s_cmpk_ge_u32 s8, 2029
    s_cbranch_scc1 .ap_236
    s_waitcnt vmcnt(3)
    s_bitcmp1_b64 s[14:15], 59
    s_cbranch_scc0 1
    s_waitcnt vmcnt(2)
    s_cmpk_ge_u32 s8, 1954
    s_cbranch_scc1 .ap_236
    s_waitcnt vmcnt(1)
.ap_236:
    s_add_u32 s63, s69, 417792
    buffer_load_dwordx4 v[60:63], v2, s[44:47], s63 offen nt
    s_lshl_b32 s60, s3, 10
    s_add_u32 s60, s60, 132096
    v_lshlrev_b32 v10, 5, v0
    v_add_u32 v10, s60, v10
    v_lshrrev_b32 v11, 5, v0
    v_lshlrev_b32 v11, 13, v11
    v_and_b32 v12, 31, v0
    v_lshl_add_u32 v11, v12, 4, v11
    v_add_u32 v9, 132096, v2
    v_mov_b32 v15, s34
    s_memrealtime s[8:9]
    s_waitcnt lgkmcnt(0)
    s_sub_u32 s8, s8, s30
    s_cmpk_ge_u32 s8, 2125
    s_cbranch_scc1 .ap_237
    s_waitcnt vmcnt(5)
    s_cmpk_ge_u32 s8, 2060
    s_cbranch_scc1 .ap_237
    s_waitcnt vmcnt(3)
    s_bitcmp1_b64 s[14:15], 60
    s_cbranch_scc0 1
    s_waitcnt vmcnt(2)
    s_cmpk_ge_u32 s8, 1985
    s_cbranch_scc1 .ap_237
    s_waitcnt vmcnt(1)
.ap_237:
    s_add_u32 s63, s69, 425984
    buffer_load_dwordx4 v[68:71], v2, s[44:47], s63 offen nt
    v_perm_b32 v112, v164, v160, s94
    v_perm_b32 v113, v172, v168, s94
    v_perm_b32 v114, v180, v176, s94
    v_perm_b32 v115, v188, v184, s94
    s_nop 1
    v_mfma_f32_16x16x32_bf16 v[128:131], v[96:99], v[112:115], 0
    v_perm_b32 v116, v164, v160, s95
    v_perm_b32 v117, v172, v168, s95
    v_perm_b32 v118, v180, v176, s95
    v_perm_b32 v119, v188, v184, s95
    s_nop 1
    v_mfma_f32_16x16x32_bf16 v[132:135], v[96:99], v[116:119], 0
    v_perm_b32 v120, v165, v161, s94
    v_perm_b32 v121, v173, v169, s94
    v_perm_b32 v122, v181, v177, s94
    v_perm_b32 v123, v189, v185, s94
    s_nop 1
    v_mfma_f32_16x16x32_bf16 v[136:139], v[96:99], v[120:123], 0
    v_perm_b32 v124, v165, v161, s95
    v_perm_b32 v125, v173, v169, s95
    v_perm_b32 v126, v181, v177, s95
    v_perm_b32 v127, v189, v185, s95
    s_nop 1
    v_mfma_f32_16x16x32_bf16 v[140:143], v[96:99], v[124:127], 0
    v_perm_b32 v112, v166, v162, s94
    v_perm_b32 v113, v174, v170, s94
    v_perm_b32 v114, v182, v178, s94
    v_perm_b32 v115, v190, v186, s94
    s_nop 1
    v_mfma_f32_16x16x32_bf16 v[144:147], v[96:99], v[112:115], 0
    v_perm_b32 v116, v166, v162, s95
    v_perm_b32 v117, v174, v170, s95
    v_perm_b32 v118, v182, v178, s95
    v_perm_b32 v119, v190, v186, s95
    s_nop 1
    v_mfma_f32_16x16x32_bf16 v[148:151], v[96:99], v[116:119], 0
    v_perm_b32 v120, v167, v163, s94
    v_perm_b32 v121, v175, v171, s94
    v_perm_b32 v122, v183, v179, s94
    v_perm_b32 v123, v191, v187, s94
    s_nop 1
    v_mfma_f32_16x16x32_bf16 v[152:155], v[96:99], v[120:123], 0
    v_perm_b32 v124, v167, v163, s95
    v_perm_b32 v125, v175, v171, s95
    v_perm_b32 v126, v183, v179, s95
    v_perm_b32 v127, v191, v187, s95
    s_nop 1
    v_mfma_f32_16x16x32_bf16 v[156:159], v[96:99], v[124:127], 0
    s_memrealtime s[8:9]
    s_waitcnt lgkmcnt(0)
    s_sub_u32 s8, s8, s30
    s_cmpk_ge_u32 s8, 2156
    s_nop 3
    s_cbranch_scc1 .ap_238
    s_waitcnt vmcnt(5)
    s_cmpk_ge_u32 s8, 2091
    s_cbranch_scc1 .ap_238
    s_waitcnt vmcnt(3)
    s_bitcmp1_b64 s[14:15], 61
    s_cbranch_scc0 1
    s_waitcnt vmcnt(2)
    s_cmpk_ge_u32 s8, 2016
    s_cbranch_scc1 .ap_238
    s_waitcnt vmcnt(1)
.ap_238:
    s_add_u32 s63, s69, 434176
    buffer_load_dwordx4 v[76:79], v2, s[44:47], s63 offen nt
    v_perm_b32 v112, v196, v192, s94
    v_perm_b32 v113, v204, v200, s94
    v_perm_b32 v114, v212, v208, s94
    v_perm_b32 v115, v220, v216, s94
    s_nop 1
    v_mfma_f32_16x16x32_bf16 v[128:131], v[100:103], v[112:115], v[128:131]
    v_perm_b32 v116, v196, v192, s95
    v_perm_b32 v117, v204, v200, s95
    v_perm_b32 v118, v212, v208, s95
    v_perm_b32 v119, v220, v216, s95
    s_nop 1
    v_mfma_f32_16x16x32_bf16 v[132:135], v[100:103], v[116:119], v[132:135]
    v_perm_b32 v120, v197, v193, s94
    v_perm_b32 v121, v205, v201, s94
    v_perm_b32 v122, v213, v209, s94
    v_perm_b32 v123, v221, v217, s94
    s_nop 1
    v_mfma_f32_16x16x32_bf16 v[136:139], v[100:103], v[120:123], v[136:139]
    v_perm_b32 v124, v197, v193, s95
    v_perm_b32 v125, v205, v201, s95
    v_perm_b32 v126, v213, v209, s95
    v_perm_b32 v127, v221, v217, s95
    s_nop 1
    v_mfma_f32_16x16x32_bf16 v[140:143], v[100:103], v[124:127], v[140:143]
    v_perm_b32 v112, v198, v194, s94
    v_perm_b32 v113, v206, v202, s94
    v_perm_b32 v114, v214, v210, s94
    v_perm_b32 v115, v222, v218, s94
    s_nop 1
    v_mfma_f32_16x16x32_bf16 v[144:147], v[100:103], v[112:115], v[144:147]
    v_perm_b32 v116, v198, v194, s95
    v_perm_b32 v117, v206, v202, s95
    v_perm_b32 v118, v214, v210, s95
    v_perm_b32 v119, v222, v218, s95
    s_nop 1
    v_mfma_f32_16x16x32_bf16 v[148:151], v[100:103], v[116:119], v[148:151]
    v_perm_b32 v120, v199, v195, s94
    v_perm_b32 v121, v207, v203, s94
    v_perm_b32 v122, v215, v211, s94
    v_perm_b32 v123, v223, v219, s94
    s_nop 1
    v_mfma_f32_16x16x32_bf16 v[152:155], v[100:103], v[120:123], v[152:155]
    v_perm_b32 v124, v199, v195, s95
    v_perm_b32 v125, v207, v203, s95
    v_perm_b32 v126, v215, v211, s95
    v_perm_b32 v127, v223, v219, s95
    s_nop 1
    v_mfma_f32_16x16x32_bf16 v[156:159], v[100:103], v[124:127], v[156:159]
    s_memrealtime s[8:9]
    s_waitcnt lgkmcnt(0)
    s_sub_u32 s8, s8, s30
    s_cmpk_ge_u32 s8, 2187
    s_nop 3
    s_cbranch_scc1 .ap_239
    s_waitcnt vmcnt(5)
    s_cmpk_ge_u32 s8, 2122
    s_cbranch_scc1 .ap_239
    s_waitcnt vmcnt(3)
    s_bitcmp1_b64 s[14:15], 62
    s_cbranch_scc0 1
    s_waitcnt vmcnt(2)
    s_cmpk_ge_u32 s8, 2047
    s_cbranch_scc1 .ap_239
    s_waitcnt vmcnt(1)
.ap_239:
    s_add_u32 s63, s69, 442368
    buffer_load_dwordx4 v[84:87], v2, s[44:47], s63 offen nt
    s_waitcnt vmcnt(7)
    v_perm_b32 v112, v228, v224, s94
    v_perm_b32 v113, v236, v232, s94
    v_perm_b32 v114, v244, v240, s94
    v_perm_b32 v115, v252, v248, s94
    s_nop 1
    v_mfma_f32_16x16x32_bf16 v[128:131], v[104:107], v[112:115], v[128:131]
    v_perm_b32 v116, v228, v224, s95
    v_perm_b32 v117, v236, v232, s95
    v_perm_b32 v118, v244, v240, s95
    v_perm_b32 v119, v252, v248, s95
    s_nop 1
    v_mfma_f32_16x16x32_bf16 v[132:135], v[104:107], v[116:119], v[132:135]
    v_perm_b32 v120, v229, v225, s94
    v_perm_b32 v121, v237, v233, s94
    v_perm_b32 v122, v245, v241, s94
    v_perm_b32 v123, v253, v249, s94
    s_nop 1
    v_mfma_f32_16x16x32_bf16 v[136:139], v[104:107], v[120:123], v[136:139]
    v_perm_b32 v124, v229, v225, s95
    v_perm_b32 v125, v237, v233, s95
    v_perm_b32 v126, v245, v241, s95
    v_perm_b32 v127, v253, v249, s95
    s_nop 1
    v_mfma_f32_16x16x32_bf16 v[140:143], v[104:107], v[124:127], v[140:143]
    v_perm_b32 v112, v230, v226, s94
    v_perm_b32 v113, v238, v234, s94
    v_perm_b32 v114, v246, v242, s94
    v_perm_b32 v115, v254, v250, s94
    s_nop 1
    v_mfma_f32_16x16x32_bf16 v[144:147], v[104:107], v[112:115], v[144:147]
    v_perm_b32 v116, v230, v226, s95
    v_perm_b32 v117, v238, v234, s95
    v_perm_b32 v118, v246, v242, s95
    v_perm_b32 v119, v254, v250, s95
    s_nop 1
    v_mfma_f32_16x16x32_bf16 v[148:151], v[104:107], v[116:119], v[148:151]
    v_perm_b32 v120, v231, v227, s94
    v_perm_b32 v121, v239, v235, s94
    v_perm_b32 v122, v247, v243, s94
    v_perm_b32 v123, v255, v251, s94
    s_nop 1
    v_mfma_f32_16x16x32_bf16 v[152:155], v[104:107], v[120:123], v[152:155]
    v_perm_b32 v124, v231, v227, s95
    v_perm_b32 v125, v239, v235, s95
    v_perm_b32 v126, v247, v243, s95
    v_perm_b32 v127, v255, v251, s95
    s_nop 1
    v_mfma_f32_16x16x32_bf16 v[156:159], v[104:107], v[124:127], v[156:159]
    s_memrealtime s[8:9]
    s_waitcnt lgkmcnt(0)
    s_sub_u32 s8, s8, s30
    s_cmpk_ge_u32 s8, 2218
    s_nop 3
    s_cbranch_scc1 .ap_240
    s_waitcnt vmcnt(5)
    s_cmpk_ge_u32 s8, 2153
    s_cbranch_scc1 .ap_240
    s_waitcnt vmcnt(3)
    s_bitcmp1_b64 s[14:15], 63
    s_cbranch_scc0 1
    s_waitcnt vmcnt(2)
    s_cmpk_ge_u32 s8, 2078
    s_cbranch_scc1 .ap_240
    s_waitcnt vmcnt(1)
.ap_240:
    s_add_u32 s63, s69, 450560
    buffer_load_dwordx4 v[92:95], v2, s[44:47], s63 offen nt
    s_setprio 0
    s_waitcnt vmcnt(6)
    v_perm_b32 v160, v44, v36, s94
    v_perm_b32 v164, v44, v36, s95
    v_perm_b32 v168, v45, v37, s94
    v_perm_b32 v172, v45, v37, s95
    v_perm_b32 v176, v46, v38, s94
    v_perm_b32 v180, v46, v38, s95
    v_perm_b32 v184, v47, v39, s94
    v_perm_b32 v188, v47, v39, s95
    s_waitcnt vmcnt(4)
    v_perm_b32 v161, v60, v52, s94
    v_perm_b32 v165, v60, v52, s95
    v_perm_b32 v169, v61, v53, s94
    v_perm_b32 v173, v61, v53, s95
    v_perm_b32 v177, v62, v54, s94
    v_perm_b32 v181, v62, v54, s95
    v_perm_b32 v185, v63, v55, s94
    v_perm_b32 v189, v63, v55, s95
    s_waitcnt vmcnt(2)
    v_perm_b32 v162, v76, v68, s94
    v_perm_b32 v166, v76, v68, s95
    v_perm_b32 v170, v77, v69, s94
    v_perm_b32 v174, v77, v69, s95
    v_perm_b32 v178, v78, v70, s94
    v_perm_b32 v182, v78, v70, s95
    v_perm_b32 v186, v79, v71, s94
    v_perm_b32 v190, v79, v71, s95
.Ltail_n:
    s_waitcnt vmcnt(0)
    v_perm_b32 v163, v92, v84, s94
    v_perm_b32 v167, v92, v84, s95
    v_perm_b32 v171, v93, v85, s94
    v_perm_b32 v175, v93, v85, s95
    v_perm_b32 v179, v94, v86, s94
    v_perm_b32 v183, v94, v86, s95
    v_perm_b32 v187, v95, v87, s94
    v_perm_b32 v191, v95, v87, s95
    v_mfma_f32_16x16x32_bf16 v[128:131], v[108:111], v[160:163], v[128:131]
    v_mfma_f32_16x16x32_bf16 v[132:135], v[108:111], v[164:167], v[132:135]
    v_mfma_f32_16x16x32_bf16 v[136:139], v[108:111], v[168:171], v[136:139]
    v_mfma_f32_16x16x32_bf16 v[140:143], v[108:111], v[172:175], v[140:143]
    v_mfma_f32_16x16x32_bf16 v[144:147], v[108:111], v[176:179], v[144:147]
    v_mfma_f32_16x16x32_bf16 v[148:151], v[108:111], v[180:183], v[148:151]
    v_mfma_f32_16x16x32_bf16 v[152:155], v[108:111], v[184:187], v[152:155]
    v_mfma_f32_16x16x32_bf16 v[156:159], v[108:111], v[188:191], v[156:159]
    s_lshl4_add_u32 s56, s67, s66
    s_lshl1_add_u32 s56, s56, s68
    s_lshl_b32 s56, s56, 9
    s_add_u32 s56, s56, 0x210000
    s_mov_b32 s60, 0x07060503
    s_mov_b32 s61, 0x07060502
    s_mov_b32 s62, 0x07060501
    s_mov_b64 exec, 0xffff
    ds_write2_b32 v10, v128, v129 offset0:0 offset1:128
    ds_write2_b32 v10, v132, v133 offset0:1 offset1:129
    ds_write2_b32 v10, v136, v137 offset0:2 offset1:130
    ds_write2_b32 v10, v140, v141 offset0:3 offset1:131
    ds_write2_b32 v10, v144, v145 offset0:4 offset1:132
    ds_write2_b32 v10, v148, v149 offset0:5 offset1:133
    ds_write2_b32 v10, v152, v153 offset0:6 offset1:134
    ds_write2_b32 v10, v156, v157 offset0:7 offset1:135
    s_mov_b64 exec, -1
    s_waitcnt lgkmcnt(0)
    s_barrier
    s_cmp_lg_u32 s3, 7
    s_cbranch_scc1 .opub_241
    ds_read_b128 v[196:199], v9 offset:0
    ds_read_b128 v[200:203], v9 offset:1024
    ds_read_b128 v[204:207], v9 offset:2048
    ds_read_b128 v[208:211], v9 offset:3072
    ds_read_b128 v[212:215], v9 offset:4096
    ds_read_b128 v[216:219], v9 offset:5120
    ds_read_b128 v[220:223], v9 offset:6144
    ds_read_b128 v[224:227], v9 offset:7168
    s_waitcnt lgkmcnt(6)
    v_pk_add_f32 v[196:197], v[196:197], v[200:201]
    v_pk_add_f32 v[198:199], v[198:199], v[202:203]
    s_waitcnt lgkmcnt(4)
    v_pk_add_f32 v[204:205], v[204:205], v[208:209]
    v_pk_add_f32 v[206:207], v[206:207], v[210:211]
    v_pk_add_f32 v[196:197], v[196:197], v[204:205]
    v_pk_add_f32 v[198:199], v[198:199], v[206:207]
    s_waitcnt lgkmcnt(2)
    v_pk_add_f32 v[212:213], v[212:213], v[216:217]
    v_pk_add_f32 v[214:215], v[214:215], v[218:219]
    s_waitcnt lgkmcnt(0)
    v_pk_add_f32 v[220:221], v[220:221], v[224:225]
    v_pk_add_f32 v[222:223], v[222:223], v[226:227]
    v_pk_add_f32 v[212:213], v[212:213], v[220:221]
    v_pk_add_f32 v[214:215], v[214:215], v[222:223]
    v_pk_add_f32 v[196:197], v[196:197], v[212:213]
    v_pk_add_f32 v[198:199], v[198:199], v[214:215]
    v_perm_b32 v12, v196, v199, s60
    v_perm_b32 v13, v197, v199, s61
    v_perm_b32 v14, v198, v199, s62
    s_add_u32 s57, s56, 0xac000
    buffer_store_dwordx4 v[12:15], v11, s[36:39], s57 offen
    buffer_store_dwordx4 v[12:15], v11, s[36:39], s56 offen sc1
.opub_241:
.Lexit:
.Lend:
s_endpgm
.section .rodata,"a"
.p2align 6
.amdhsa_kernel adaLN_cond__sliding_block_cached__moe_arch_mod__decode_kernel
  .amdhsa_next_free_vgpr 256
  .amdhsa_next_free_sgpr 102
  .amdhsa_accum_offset 256
  .amdhsa_group_segment_fixed_size 0
  .amdhsa_kernarg_size 120
  .amdhsa_user_sgpr_count 2
  .amdhsa_user_sgpr_kernarg_segment_ptr 1
  .amdhsa_system_sgpr_workgroup_id_x 1
.end_amdhsa_kernel
```

```asm
; @launch grid=(256,1,1) block=(512,1,1) lds=159360
.amdgcn_target "amdgcn-amd-amdhsa--gfx950"
.text
.globl adaLN_cond__sliding_block_cached__moe_arch_mod__decode_kernel
.p2align 8
.type adaLN_cond__sliding_block_cached__moe_arch_mod__decode_kernel,@function
adaLN_cond__sliding_block_cached__moe_arch_mod__decode_kernel:
    s_cmp_ge_u32 s2, 256
    s_cbranch_scc1 .Lend
    s_load_dwordx16 s[4:19], s[0:1], 0
    s_load_dwordx8 s[20:27], s[0:1], 64
    s_load_dwordx4 s[28:31], s[0:1], 96
    s_load_dwordx2 s[32:33], s[0:1], 112
    s_memrealtime s[70:71]
    v_lshrrev_b32 v1, 6, v0
    v_and_b32 v0, 63, v0
    v_readfirstlane_b32 s3, v1
    s_mov_b32 s35, 0x3ffff
    s_mov_b32 s98, 0xbfb8aa3b
    s_mov_b32 s94, 0x05040100
    s_mov_b32 s95, 0x07060302
    s_mov_b32 s96, 0xaaaaaaaa
    s_mov_b32 s97, 0xaaaaaaaa
    s_and_b32 s64, s2, 7
    s_lshr_b32 s65, s2, 3
    s_and_b32 s66, s65, 7
    s_lshr_b32 s67, s2, 7
    s_lshl1_add_u32 s67, s64, s67
    s_bfe_u32 s68, s2, 0x10006
    s_lshl4_add_u32 s69, s66, s67
    s_lshl_b32 s69, s69, 21
    s_lshl_b32 s56, s68, 16
    s_add_u32 s69, s69, s56
    s_lshl_b32 s56, s3, 10
    s_add_u32 s69, s69, s56
    s_add_u32 s69, s69, 0x180000
    v_bfe_u32 v1, v0, 2, 2
    v_lshrrev_b32 v2, 4, v0
    v_lshl_add_u32 v1, v1, 2, v2
    v_and_b32 v2, 3, v0
    v_lshl_add_u32 v1, v1, 2, v2
    v_lshlrev_b32 v1, 4, v1
    v_lshlrev_b32 v2, 4, v0
    v_lshlrev_b32 v3, 3, v0
    v_and_b32 v4, 31, v0
    v_lshlrev_b32 v4, 2, v4
    v_add_u32 v4, 1024, v4
    v_lshlrev_b32 v5, 1, v4
    s_waitcnt lgkmcnt(0)
    s_load_dword s34, s[32:33], 0
    s_sub_u32 s99, s2, 216
    s_cmp_ge_u32 s99, 18
    s_cbranch_scc1 .Lmcf_no
    s_mul_i32 s58, s3, 1152
    s_mov_b32 s52, s24
    s_and_b32 s53, s25, 0xffff
    s_mov_b32 s54, 0x2400
    s_mov_b32 s55, 0x00020000
    buffer_load_dwordx2 v[246:247], v3, s[52:55], s58 offen
    buffer_load_dwordx2 v[248:249], v3, s[52:55], s58 offen offset:512
    buffer_load_dword v250, v4, s[52:55], s58 offen
    s_mov_b32 s48, s26
    s_and_b32 s49, s27, 0xffff
    s_mov_b32 s50, 0x3cc000
    s_mov_b32 s51, 0x00020000
    v_bfe_u32 v12, v0, 4, 1
    s_and_b32 s56, s3, 3
    s_lshl_b32 s56, s56, 1
    v_or_b32 v12, s56, v12
    v_and_b32 v19, 7, v0
    v_xor_b32 v12, v12, v19
    v_lshrrev_b32 v19, 3, v0
    v_mul_u32_u24 v19, 6912, v19
    v_lshl_add_u32 v19, v12, 4, v19
    s_mul_i32 s57, s3, 55296
    s_lshl_b32 s59, s99, 7
    s_add_u32 s57, s57, s59
    s_lshl_b32 s100, s3, 10
    s_add_u32 m0, s100, 0
    s_add_u32 s56, s57, 0
    buffer_load_dwordx4 v19, s[48:51], s56 offen nt lds
    s_add_u32 m0, s100, 8192
    s_add_u32 s56, s57, 442368
    buffer_load_dwordx4 v19, s[48:51], s56 offen nt lds
    s_add_u32 m0, s100, 16384
    s_add_u32 s56, s57, 884736
    buffer_load_dwordx4 v19, s[48:51], s56 offen nt lds
    s_add_u32 m0, s100, 24576
    s_add_u32 s56, s57, 1327104
    buffer_load_dwordx4 v19, s[48:51], s56 offen nt lds
    s_add_u32 m0, s100, 32768
    s_add_u32 s56, s57, 1769472
    buffer_load_dwordx4 v19, s[48:51], s56 offen nt lds
    s_add_u32 m0, s100, 40960
    s_add_u32 s56, s57, 2211840
    buffer_load_dwordx4 v19, s[48:51], s56 offen nt lds
    s_add_u32 m0, s100, 49152
    s_add_u32 s56, s57, 2654208
    buffer_load_dwordx4 v19, s[48:51], s56 offen nt lds
    s_add_u32 m0, s100, 57344
    s_add_u32 s56, s57, 3096576
    buffer_load_dwordx4 v19, s[48:51], s56 offen nt lds
    s_add_u32 m0, s100, 65536
    s_add_u32 s56, s57, 3538944
    buffer_load_dwordx4 v19, s[48:51], s56 offen nt lds
.Lmcf_no:
    s_mov_b32 s40, s6
    s_and_b32 s41, s7, 0xffff
    s_mov_b32 s42, 0x10000000
    s_mov_b32 s43, 0x00020000
    s_add_u32 s63, s69, 0
    buffer_load_dwordx4 v[32:35], v1, s[40:43], s63 offen nt
    s_add_u32 s63, s69, 8192
    buffer_load_dwordx4 v[36:39], v1, s[40:43], s63 offen nt
    s_add_u32 s63, s69, 16384
    buffer_load_dwordx4 v[64:67], v1, s[40:43], s63 offen nt
    s_add_u32 s63, s69, 24576
    buffer_load_dwordx4 v[68:71], v1, s[40:43], s63 offen nt
    s_mov_b32 s44, s8
    s_and_b32 s45, s9, 0xffff
    s_mov_b32 s46, 0x10000000
    s_mov_b32 s47, 0x00020000
    s_mov_b32 s36, s32
    s_and_b32 s37, s33, 0xffff
    s_mov_b32 s38, 0x40000000
    s_mov_b32 s39, 0x00020000
    s_lshl3_add_u32 s56, s3, s2
    s_cmp_lt_u32 s56, 8
    s_cbranch_scc0 .Let_no
    s_lshl_b32 s56, s2, 7
    s_add_u32 s56, s56, 0x400
    v_mov_b32 v7, s70
    s_mov_b64 exec, 1
    buffer_store_dword v7, v2, s[36:39], s56 offen sc1
    s_mov_b64 exec, -1
.Let_no:
    s_mov_b32 s52, s30
    s_and_b32 s53, s31, 0xffff
    s_mov_b32 s54, 0x100
    s_mov_b32 s55, 0x00020000
    s_mov_b64 s[6:7], s[30:31]
    s_getreg_b32 s1, hwreg(HW_REG_XCC_ID)
    s_and_b32 s1, s1, 7
    s_lshl_b32 s1, s1, 3
    s_lshl_b32 s0, s64, 5
    s_cmp_lg_u32 s3, 0
    s_cbranch_scc1 .Lxa_no
    s_lshl_b64 s[56:57], 1, s1
    v_mov_b32 v8, s56
    v_mov_b32 v9, s57
    s_mov_b64 exec, 1
    buffer_atomic_add_x2 v[8:9], v2, s[52:55], s0 offen sc1
    v_mov_b32 v8, 0
    v_mov_b32 v9, 159232
    ds_write_b32 v9, v8
    s_waitcnt lgkmcnt(0)
    s_mov_b64 exec, -1
.Lxa_no:
    s_barrier
    s_cmp_lt_u32 s3, 4
    s_cbranch_scc1 1
    s_setprio 1
.Lresume:
    s_cmp_lt_u32 s65, 9
    s_cbranch_scc1 .Le_a
    s_sub_u32 s56, 3, s64
    s_and_b32 s56, s56, 7
    s_lshl1_add_u32 s56, s56, 9
    s_sub_u32 s56, s65, s56
    s_cselect_b32 s57, 18, 0
    s_add_u32 s56, s56, s57
    s_sub_u32 s101, s56, 2
    s_cmp_ge_u32 s56, 5
    s_addc_u32 s101, s101, 0
    s_sub_u32 s99, s56, 5
    s_min_u32 s99, s99, 7
    s_cmp_lt_u32 s65, 27
    s_cbranch_scc1 .Lrole_bc
    s_mov_b32 s101, 3
    s_sub_u32 s99, s65, 27
    s_cmp_ge_u32 s65, 31
    s_cselect_b32 s56, 2, 9
.Lrole_bc:
    s_lshl3_add_u32 s99, s99, s64
    s_sub_u32 s56, s56, 2
    s_cmp_lt_u32 s56, 7
    s_cbranch_scc1 .Le_q
    s_cmp_lt_u32 s99, 18
    s_cbranch_scc1 .Le_mc
    s_cmp_lt_u32 s99, 54
    s_mov_b32 s14, 0xfdff7fdf
    s_cselect_b32 s14, 0x6b5ad6b5, s14
    s_mov_b32 s15, 0xff7fdff7
    s_cselect_b32 s15, 0x5ad6b5ad, s15
    s_cselect_b32 s30, -30, 0
    s_add_u32 s30, s30, 0
    s_add_u32 s30, s30, s70
    s_sub_u32 s56, s65, 9
    s_lshr_b32 s56, s56, 1
    s_add_u32 s56, s56, s64
    s_and_b32 s56, s56, 7
    s_cmp_eq_u32 s56, 3
    s_cselect_b32 s56, -30, 0
    s_cmp_lt_u32 s99, 54
    s_cselect_b32 s56, 0, s56
    s_add_u32 s30, s30, s56
    s_waitcnt vmcnt(3)
    s_bitcmp1_b64 s[14:15], 4
    s_cbranch_scc0 1
    s_waitcnt vmcnt(2)
    s_add_u32 s63, s69, 32768
    buffer_load_dwordx4 v[96:99], v1, s[40:43], s63 offen nt
    s_memrealtime s[8:9]
    s_waitcnt lgkmcnt(0)
    s_sub_u32 s8, s8, s30
    s_cmpk_ge_u32 s8, 290
    s_cbranch_scc1 .ap_1
    s_waitcnt vmcnt(4)
    s_cmpk_ge_u32 s8, 225
    s_cbranch_scc1 .ap_1
    s_waitcnt vmcnt(3)
    s_bitcmp1_b64 s[14:15], 5
    s_cbranch_scc0 1
    s_waitcnt vmcnt(2)
    s_cmpk_ge_u32 s8, 150
    s_cbranch_scc1 .ap_1
    s_waitcnt vmcnt(1)
.ap_1:
    s_add_u32 s63, s69, 40960
    buffer_load_dwordx4 v[100:103], v1, s[40:43], s63 offen nt
    s_memrealtime s[8:9]
    s_waitcnt lgkmcnt(0)
    s_sub_u32 s8, s8, s30
    s_cmpk_ge_u32 s8, 315
    s_cbranch_scc1 .ap_2
    s_waitcnt vmcnt(5)
    s_cmpk_ge_u32 s8, 250
    s_cbranch_scc1 .ap_2
    s_waitcnt vmcnt(3)
    s_bitcmp1_b64 s[14:15], 6
    s_cbranch_scc0 1
    s_waitcnt vmcnt(2)
    s_cmpk_ge_u32 s8, 175
    s_cbranch_scc1 .ap_2
    s_waitcnt vmcnt(1)
.ap_2:
    s_add_u32 s63, s69, 49152
    buffer_load_dwordx4 v[128:131], v1, s[40:43], s63 offen nt
    s_memrealtime s[8:9]
    s_waitcnt lgkmcnt(0)
    s_sub_u32 s8, s8, s30
    s_cmpk_ge_u32 s8, 340
    s_cbranch_scc1 .ap_3
    s_waitcnt vmcnt(5)
    s_cmpk_ge_u32 s8, 275
    s_cbranch_scc1 .ap_3
    s_waitcnt vmcnt(3)
    s_bitcmp1_b64 s[14:15], 7
    s_cbranch_scc0 1
    s_waitcnt vmcnt(2)
    s_cmpk_ge_u32 s8, 200
    s_cbranch_scc1 .ap_3
    s_waitcnt vmcnt(1)
.ap_3:
    s_add_u32 s63, s69, 57344
    buffer_load_dwordx4 v[132:135], v1, s[40:43], s63 offen nt
    s_memrealtime s[8:9]
    s_waitcnt lgkmcnt(0)
    s_sub_u32 s8, s8, s30
    s_cmpk_ge_u32 s8, 365
    s_cbranch_scc1 .ap_4
    s_waitcnt vmcnt(5)
    s_cmpk_ge_u32 s8, 300
    s_cbranch_scc1 .ap_4
    s_waitcnt vmcnt(3)
    s_bitcmp1_b64 s[14:15], 8
    s_cbranch_scc0 1
    s_waitcnt vmcnt(2)
    s_cmpk_ge_u32 s8, 225
    s_cbranch_scc1 .ap_4
    s_waitcnt vmcnt(1)
.ap_4:
    s_add_u32 s63, s69, 131072
    buffer_load_dwordx4 v[40:43], v1, s[40:43], s63 offen nt
    s_memrealtime s[8:9]
    s_waitcnt lgkmcnt(0)
    s_sub_u32 s8, s8, s30
    s_cmpk_ge_u32 s8, 390
    s_cbranch_scc1 .ap_5
    s_waitcnt vmcnt(5)
    s_cmpk_ge_u32 s8, 325
    s_cbranch_scc1 .ap_5
    s_waitcnt vmcnt(3)
    s_bitcmp1_b64 s[14:15], 9
    s_cbranch_scc0 1
    s_waitcnt vmcnt(2)
    s_cmpk_ge_u32 s8, 250
    s_cbranch_scc1 .ap_5
    s_waitcnt vmcnt(1)
.ap_5:
    s_add_u32 s63, s69, 139264
    buffer_load_dwordx4 v[44:47], v1, s[40:43], s63 offen nt
    s_waitcnt lgkmcnt(0)
    s_add_u32 s34, s34, 1
    s_cmp_lt_u32 s99, 54
    s_cbranch_scc1 .Le_mr
    s_sub_u32 s57, s65, 9
    s_bitcmp1_b32 s57, 0
    s_cselect_b32 s48, s20, s18
    s_cselect_b32 s49, s21, s19
    s_cselect_b32 s33, 36, 0
    s_and_b32 s49, s49, 0xffff
    s_mov_b32 s50, 0x510000
    s_mov_b32 s51, 0x00020000
    s_mov_b32 s52, s22
    s_and_b32 s53, s23, 0xffff
    s_mov_b32 s54, 0x510000
    s_mov_b32 s55, 0x00020000
    s_lshr_b32 s57, s57, 1
    s_lshl_b32 s57, s57, 7
    s_mul_i32 s101, s64, 1152
    s_add_u32 s101, s101, s57
    s_mul_i32 s56, s3, 73728
    s_add_u32 s101, s101, s56
    s_mul_i32 s56, s64, 72
    s_add_u32 s33, s33, s56
    s_add_u32 s33, s33, s3
    s_mul_i32 s33, s33, 9216
    s_add_u32 s33, s33, s57
    s_bfe_u32 s56, s101, 0x30007
    s_cmp_eq_u32 s56, 3
    s_cselect_b32 s100, 1, 0
    v_bfe_u32 v12, v0, 4, 1
    s_and_b32 s56, s3, 3
    s_lshl_b32 s56, s56, 1
    v_or_b32 v12, s56, v12
    v_and_b32 v6, 7, v0
    v_xor_b32 v12, v12, v6
    v_lshrrev_b32 v6, 3, v0
    v_mul_u32_u24 v6, 9216, v6
    v_lshl_add_u32 v6, v12, 4, v6
    v_bfe_u32 v12, v0, 4, 1
    s_and_b32 s56, s3, 1
    s_lshl_b32 s56, s56, 2
    v_lshl_or_b32 v12, v12, 1, s56
    v_and_b32 v13, 7, v0
    v_xor_b32 v12, v12, v13
    v_lshrrev_b32 v13, 3, v0
    v_mul_u32_u24 v13, 1152, v13
    v_lshl_add_u32 v31, v12, 4, v13
    s_lshl_b32 s32, s3, 10
    s_memrealtime s[8:9]
    s_waitcnt vmcnt(8)
    s_waitcnt lgkmcnt(0)
    s_sub_u32 s8, s8, s30
    s_cmpk_ge_u32 s8, 436
    s_cbranch_scc1 .ap_6
    s_waitcnt vmcnt(5)
    s_cmpk_ge_u32 s8, 371
    s_cbranch_scc1 .ap_6
    s_waitcnt vmcnt(3)
    s_bitcmp1_b64 s[14:15], 10
    s_cbranch_scc0 1
    s_waitcnt vmcnt(2)
    s_cmpk_ge_u32 s8, 296
    s_cbranch_scc1 .ap_6
    s_waitcnt vmcnt(1)
.ap_6:
    s_add_u32 s63, s69, 147456
    buffer_load_dwordx4 v[72:75], v1, s[40:43], s63 offen nt
    s_cmp_eq_u32 s100, 0
    s_cbranch_scc1 .ls_7
    s_add_u32 m0, s32, 0
    s_add_u32 s56, s101, 0
    buffer_load_dwordx4 v6, s[48:51], s56 offen nt lds
.ls_7:
    s_memrealtime s[8:9]
    s_waitcnt vmcnt(8)
    s_waitcnt lgkmcnt(0)
    s_sub_u32 s8, s8, s30
    s_cmpk_ge_u32 s8, 482
    s_cbranch_scc1 .ap_8
    s_waitcnt vmcnt(5)
    s_cmpk_ge_u32 s8, 417
    s_cbranch_scc1 .ap_8
    s_waitcnt vmcnt(3)
    s_bitcmp1_b64 s[14:15], 11
    s_cbranch_scc0 1
    s_waitcnt vmcnt(2)
    s_cmpk_ge_u32 s8, 342
    s_cbranch_scc1 .ap_8
    s_waitcnt vmcnt(1)
.ap_8:
    s_add_u32 s63, s69, 155648
    buffer_load_dwordx4 v[76:79], v1, s[40:43], s63 offen nt
    s_memrealtime s[8:9]
    s_waitcnt vmcnt(8)
    s_waitcnt lgkmcnt(0)
    s_sub_u32 s8, s8, s30
    s_cmpk_ge_u32 s8, 528
    s_cbranch_scc1 .ap_9
    s_waitcnt vmcnt(5)
    s_cmpk_ge_u32 s8, 463
    s_cbranch_scc1 .ap_9
    s_waitcnt vmcnt(3)
    s_bitcmp1_b64 s[14:15], 12
    s_cbranch_scc0 1
    s_waitcnt vmcnt(2)
    s_cmpk_ge_u32 s8, 388
    s_cbranch_scc1 .ap_9
    s_waitcnt vmcnt(1)
.ap_9:
    s_add_u32 s63, s69, 163840
    buffer_load_dwordx4 v[104:107], v1, s[40:43], s63 offen nt
    s_memrealtime s[8:9]
    s_waitcnt vmcnt(8)
    s_waitcnt lgkmcnt(0)
    s_sub_u32 s8, s8, s30
    s_cmpk_ge_u32 s8, 574
    s_cbranch_scc1 .ap_10
    s_waitcnt vmcnt(5)
    s_cmpk_ge_u32 s8, 509
    s_cbranch_scc1 .ap_10
    s_waitcnt vmcnt(3)
    s_bitcmp1_b64 s[14:15], 13
    s_cbranch_scc0 1
    s_waitcnt vmcnt(2)
    s_cmpk_ge_u32 s8, 434
    s_cbranch_scc1 .ap_10
    s_waitcnt vmcnt(1)
.ap_10:
    s_add_u32 s63, s69, 172032
    buffer_load_dwordx4 v[108:111], v1, s[40:43], s63 offen nt
    s_cmp_eq_u32 s100, 0
    s_cbranch_scc1 .ls_11
    s_add_u32 m0, s32, 8192
    s_add_u32 s56, s101, 589824
    buffer_load_dwordx4 v6, s[48:51], s56 offen nt lds
.ls_11:
    s_memrealtime s[8:9]
    s_waitcnt vmcnt(8)
    s_waitcnt lgkmcnt(0)
    s_sub_u32 s8, s8, s30
    s_cmpk_ge_u32 s8, 620
    s_cbranch_scc1 .ap_12
    s_waitcnt vmcnt(5)
    s_cmpk_ge_u32 s8, 555
    s_cbranch_scc1 .ap_12
    s_waitcnt vmcnt(3)
    s_bitcmp1_b64 s[14:15], 14
    s_cbranch_scc0 1
    s_waitcnt vmcnt(2)
    s_cmpk_ge_u32 s8, 480
    s_cbranch_scc1 .ap_12
    s_waitcnt vmcnt(1)
.ap_12:
    s_add_u32 s63, s69, 180224
    buffer_load_dwordx4 v[136:139], v1, s[40:43], s63 offen nt
    s_memrealtime s[8:9]
    s_waitcnt vmcnt(8)
    s_waitcnt lgkmcnt(0)
    s_sub_u32 s8, s8, s30
    s_cmpk_ge_u32 s8, 666
    s_cbranch_scc1 .ap_13
    s_waitcnt vmcnt(5)
    s_cmpk_ge_u32 s8, 601
    s_cbranch_scc1 .ap_13
    s_waitcnt vmcnt(3)
    s_bitcmp1_b64 s[14:15], 15
    s_cbranch_scc0 1
    s_waitcnt vmcnt(2)
    s_cmpk_ge_u32 s8, 526
    s_cbranch_scc1 .ap_13
    s_waitcnt vmcnt(1)
.ap_13:
    s_add_u32 s63, s69, 188416
    buffer_load_dwordx4 v[140:143], v1, s[40:43], s63 offen nt
    s_memrealtime s[8:9]
    s_waitcnt vmcnt(8)
    s_waitcnt lgkmcnt(0)
    s_sub_u32 s8, s8, s30
    s_cmpk_ge_u32 s8, 712
    s_cbranch_scc1 .ap_14
    s_waitcnt vmcnt(5)
    s_cmpk_ge_u32 s8, 647
    s_cbranch_scc1 .ap_14
    s_waitcnt vmcnt(3)
    s_bitcmp1_b64 s[14:15], 16
    s_cbranch_scc0 1
    s_waitcnt vmcnt(2)
    s_cmpk_ge_u32 s8, 572
    s_cbranch_scc1 .ap_14
    s_waitcnt vmcnt(1)
.ap_14:
    s_add_u32 s63, s69, 262144
    buffer_load_dwordx4 v[48:51], v1, s[40:43], s63 offen nt
    s_cmp_eq_u32 s100, 0
    s_cbranch_scc1 .ls_15
    s_add_u32 m0, s32, 16384
    s_add_u32 s56, s101, 1179648
    buffer_load_dwordx4 v6, s[48:51], s56 offen nt lds
.ls_15:
    s_memrealtime s[8:9]
    s_waitcnt vmcnt(8)
    s_waitcnt lgkmcnt(0)
    s_sub_u32 s8, s8, s30
    s_cmpk_ge_u32 s8, 758
    s_cbranch_scc1 .ap_16
    s_waitcnt vmcnt(5)
    s_cmpk_ge_u32 s8, 693
    s_cbranch_scc1 .ap_16
    s_waitcnt vmcnt(3)
    s_bitcmp1_b64 s[14:15], 17
    s_cbranch_scc0 1
    s_waitcnt vmcnt(2)
    s_cmpk_ge_u32 s8, 618
    s_cbranch_scc1 .ap_16
    s_waitcnt vmcnt(1)
.ap_16:
    s_add_u32 s63, s69, 270336
    buffer_load_dwordx4 v[52:55], v1, s[40:43], s63 offen nt
    s_memrealtime s[8:9]
    s_waitcnt vmcnt(8)
    s_waitcnt lgkmcnt(0)
    s_sub_u32 s8, s8, s30
    s_cmpk_ge_u32 s8, 804
    s_cbranch_scc1 .ap_17
    s_waitcnt vmcnt(5)
    s_cmpk_ge_u32 s8, 739
    s_cbranch_scc1 .ap_17
    s_waitcnt vmcnt(3)
    s_bitcmp1_b64 s[14:15], 18
    s_cbranch_scc0 1
    s_waitcnt vmcnt(2)
    s_cmpk_ge_u32 s8, 664
    s_cbranch_scc1 .ap_17
    s_waitcnt vmcnt(1)
.ap_17:
    s_add_u32 s63, s69, 278528
    buffer_load_dwordx4 v[80:83], v1, s[40:43], s63 offen nt
    v_and_b32 v157, 7, v0
    v_lshlrev_b32 v157, 7, v157
    s_mov_b32 s63, 0x400
    buffer_load_dword v156, v157, s[36:39], s63 offen
    s_memrealtime s[8:9]
    s_waitcnt vmcnt(9)
    s_waitcnt lgkmcnt(0)
    s_sub_u32 s8, s8, s30
    s_cmpk_ge_u32 s8, 850
    s_cbranch_scc1 .ap_18
    s_waitcnt vmcnt(6)
    s_cmpk_ge_u32 s8, 785
    s_cbranch_scc1 .ap_18
    s_waitcnt vmcnt(4)
    s_bitcmp1_b64 s[14:15], 19
    s_cbranch_scc0 1
    s_waitcnt vmcnt(3)
    s_cmpk_ge_u32 s8, 710
    s_cbranch_scc1 .ap_18
    s_waitcnt vmcnt(2)
.ap_18:
    s_add_u32 s63, s69, 286720
    buffer_load_dwordx4 v[84:87], v1, s[40:43], s63 offen nt
    s_cmp_eq_u32 s100, 0
    s_cbranch_scc1 .ls_19
    s_add_u32 m0, s32, 24576
    s_add_u32 s56, s101, 1769472
    buffer_load_dwordx4 v6, s[48:51], s56 offen nt lds
.ls_19:
    s_memrealtime s[8:9]
    s_waitcnt vmcnt(9)
    s_waitcnt lgkmcnt(0)
    s_sub_u32 s8, s8, s30
    s_cmpk_ge_u32 s8, 895
    s_cbranch_scc1 .ap_20
    s_waitcnt vmcnt(6)
    s_cmpk_ge_u32 s8, 830
    s_cbranch_scc1 .ap_20
    s_waitcnt vmcnt(4)
    s_bitcmp1_b64 s[14:15], 20
    s_cbranch_scc0 1
    s_waitcnt vmcnt(3)
    s_cmpk_ge_u32 s8, 755
    s_cbranch_scc1 .ap_20
    s_waitcnt vmcnt(2)
.ap_20:
    s_add_u32 s63, s69, 294912
    buffer_load_dwordx4 v[112:115], v1, s[40:43], s63 offen nt
    s_memrealtime s[8:9]
    s_waitcnt vmcnt(9)
    s_waitcnt lgkmcnt(0)
    s_sub_u32 s8, s8, s30
    s_cmpk_ge_u32 s8, 940
    s_cbranch_scc1 .ap_21
    s_waitcnt vmcnt(6)
    s_cmpk_ge_u32 s8, 875
    s_cbranch_scc1 .ap_21
    s_waitcnt vmcnt(4)
    s_bitcmp1_b64 s[14:15], 21
    s_cbranch_scc0 1
    s_waitcnt vmcnt(3)
    s_cmpk_ge_u32 s8, 800
    s_cbranch_scc1 .ap_21
    s_waitcnt vmcnt(1)
.ap_21:
    s_add_u32 s63, s69, 303104
    buffer_load_dwordx4 v[116:119], v1, s[40:43], s63 offen nt
    s_memrealtime s[8:9]
    s_waitcnt vmcnt(9)
    s_waitcnt lgkmcnt(0)
    s_sub_u32 s8, s8, s30
    s_cmpk_ge_u32 s8, 985
    s_cbranch_scc1 .ap_22
    s_waitcnt vmcnt(6)
    s_cmpk_ge_u32 s8, 920
    s_cbranch_scc1 .ap_22
    s_waitcnt vmcnt(4)
    s_bitcmp1_b64 s[14:15], 22
    s_cbranch_scc0 1
    s_waitcnt vmcnt(2)
    s_cmpk_ge_u32 s8, 845
    s_cbranch_scc1 .ap_22
    s_waitcnt vmcnt(1)
.ap_22:
    s_add_u32 s63, s69, 311296
    buffer_load_dwordx4 v[144:147], v1, s[40:43], s63 offen nt
    s_waitcnt vmcnt(4)
    s_sub_u32 s63, s70, 300
    v_subrev_u32 v156, s63, v156
    v_mov_b32 v157, 600
    v_cmp_lt_u32 s[8:9], v156, v157
    v_add_u32_dpp v156, v156, v156 quad_perm:[1,0,3,2] row_mask:0xf bank_mask:0xf
    s_nop 1
    v_add_u32_dpp v156, v156, v156 quad_perm:[2,3,0,1] row_mask:0xf bank_mask:0xf
    s_nop 1
    v_add_u32_dpp v156, v156, v156 row_ror:4 row_mask:0xf bank_mask:0xf
    s_nop 0
    v_readfirstlane_b32 s63, v156
    s_cmp_eq_u64 s[8:9], -1
    s_nop 3
    s_cbranch_scc0 .et_23
    s_lshr_b32 s63, s63, 3
    s_sub_u32 s63, s63, 300
    s_add_u32 s30, s30, s63
.et_23:
    s_cmp_eq_u32 s100, 0
    s_cbranch_scc1 .ls_24
    s_add_u32 m0, s32, 32768
    s_add_u32 s56, s101, 2359296
    buffer_load_dwordx4 v6, s[48:51], s56 offen nt lds
.ls_24:
    s_memrealtime s[8:9]
    s_waitcnt lgkmcnt(0)
    s_sub_u32 s8, s8, s30
    s_cmpk_ge_u32 s8, 1030
    s_cbranch_scc1 .ap_25
    s_waitcnt vmcnt(4)
    s_cmpk_ge_u32 s8, 965
    s_cbranch_scc1 .ap_25
    s_waitcnt vmcnt(3)
    s_bitcmp1_b64 s[14:15], 23
    s_cbranch_scc0 1
    s_waitcnt vmcnt(2)
    s_cmpk_ge_u32 s8, 890
    s_cbranch_scc1 .ap_25
    s_waitcnt vmcnt(1)
.ap_25:
    s_add_u32 s63, s69, 319488
    buffer_load_dwordx4 v[148:151], v1, s[40:43], s63 offen nt
    s_memrealtime s[8:9]
    s_waitcnt lgkmcnt(0)
    s_sub_u32 s8, s8, s30
    s_cmpk_ge_u32 s8, 1075
    s_cbranch_scc1 .ap_26
    s_waitcnt vmcnt(5)
    s_cmpk_ge_u32 s8, 1010
    s_cbranch_scc1 .ap_26
    s_waitcnt vmcnt(3)
    s_bitcmp1_b64 s[14:15], 24
    s_cbranch_scc0 1
    s_waitcnt vmcnt(2)
    s_cmpk_ge_u32 s8, 935
    s_cbranch_scc1 .ap_26
    s_waitcnt vmcnt(1)
.ap_26:
    s_add_u32 s63, s69, 393216
    buffer_load_dwordx4 v[56:59], v1, s[40:43], s63 offen nt
    s_memrealtime s[8:9]
    s_waitcnt lgkmcnt(0)
    s_sub_u32 s8, s8, s30
    s_cmpk_ge_u32 s8, 1120
    s_cbranch_scc1 .ap_27
    s_waitcnt vmcnt(5)
    s_cmpk_ge_u32 s8, 1055
    s_cbranch_scc1 .ap_27
    s_waitcnt vmcnt(3)
    s_bitcmp1_b64 s[14:15], 25
    s_cbranch_scc0 1
    s_waitcnt vmcnt(2)
    s_cmpk_ge_u32 s8, 980
    s_cbranch_scc1 .ap_27
    s_waitcnt vmcnt(1)
.ap_27:
    s_add_u32 s63, s69, 401408
    buffer_load_dwordx4 v[60:63], v1, s[40:43], s63 offen nt
    s_branch .Latt_bc
.Le_mr:
    s_mul_i32 s58, s3, 1152
    s_mov_b32 s52, s24
    s_and_b32 s53, s25, 0xffff
    s_mov_b32 s54, 0x2400
    s_mov_b32 s55, 0x00020000
    buffer_load_dwordx2 v[246:247], v3, s[52:55], s58 offen
    buffer_load_dwordx2 v[248:249], v3, s[52:55], s58 offen offset:512
    buffer_load_dword v250, v4, s[52:55], s58 offen
    s_mov_b32 s48, s26
    s_and_b32 s49, s27, 0xffff
    s_mov_b32 s50, 0x3cc000
    s_mov_b32 s51, 0x00020000
    v_bfe_u32 v12, v0, 4, 1
    s_and_b32 s56, s3, 3
    s_lshl_b32 s56, s56, 1
    v_or_b32 v12, s56, v12
    v_and_b32 v19, 7, v0
    v_xor_b32 v12, v12, v19
    v_lshrrev_b32 v19, 3, v0
    v_mul_u32_u24 v19, 6912, v19
    v_lshl_add_u32 v19, v12, 4, v19
    s_mul_i32 s57, s3, 55296
    s_lshl_b32 s59, s99, 7
    s_add_u32 s57, s57, s59
    s_lshl_b32 s100, s3, 10
    s_add_u32 m0, s100, 0
    s_add_u32 s56, s57, 0
    buffer_load_dwordx4 v19, s[48:51], s56 offen nt lds
    s_add_u32 m0, s100, 8192
    s_add_u32 s56, s57, 442368
    buffer_load_dwordx4 v19, s[48:51], s56 offen nt lds
    s_add_u32 m0, s100, 16384
    s_add_u32 s56, s57, 884736
    buffer_load_dwordx4 v19, s[48:51], s56 offen nt lds
    s_add_u32 m0, s100, 24576
    s_add_u32 s56, s57, 1327104
    buffer_load_dwordx4 v19, s[48:51], s56 offen nt lds
    s_add_u32 m0, s100, 32768
    s_add_u32 s56, s57, 1769472
    buffer_load_dwordx4 v19, s[48:51], s56 offen nt lds
    s_add_u32 m0, s100, 40960
    s_add_u32 s56, s57, 2211840
    buffer_load_dwordx4 v19, s[48:51], s56 offen nt lds
    s_add_u32 m0, s100, 49152
    s_add_u32 s56, s57, 2654208
    buffer_load_dwordx4 v19, s[48:51], s56 offen nt lds
    s_add_u32 m0, s100, 57344
    s_add_u32 s56, s57, 3096576
    buffer_load_dwordx4 v19, s[48:51], s56 offen nt lds
    s_add_u32 m0, s100, 65536
    s_add_u32 s56, s57, 3538944
    buffer_load_dwordx4 v19, s[48:51], s56 offen nt lds
    v_bfe_u32 v16, v0, 1, 3
    v_mul_u32_u24 v16, 1312, v16
    v_lshrrev_b32 v12, 4, v0
    v_lshl_add_u32 v16, v12, 5, v16
    v_and_b32 v12, 1, v0
    v_lshl_add_u32 v16, v12, 4, v16
    v_add_u32 v16, 147456, v16
    s_mul_i32 s56, s3, 1312
    s_add_u32 s56, s56, 147456
    v_add_u32 v17, s56, v3
    v_add_u32 v18, s56, v4
    v_lshrrev_b32 v12, 4, v0
    v_bfe_u32 v13, v0, 1, 1
    v_lshl_add_u32 v12, v12, 1, v13
    v_bfe_u32 v13, v0, 2, 2
    v_lshl_add_u32 v20, v12, 3, v13
    v_lshlrev_b32 v20, 7, v20
    v_and_b32 v12, 3, v12
    v_lshrrev_b32 v13, 1, v13
    v_lshl_add_u32 v12, v12, 1, v13
    v_xor_b32 v12, s3, v12
    v_lshl_add_u32 v20, v12, 4, v20
    v_and_b32 v12, 1, v0
    v_lshl_add_u32 v20, v12, 3, v20
    v_bfe_u32 v23, v0, 1, 3
    v_mul_u32_u24 v23, 144, v23
    v_bfe_u32 v12, v0, 4, 1
    v_lshl_add_u32 v23, v12, 3, v23
    v_lshrrev_b32 v12, 5, v0
    v_lshl_add_u32 v23, v12, 2, v23
    v_and_b32 v12, 1, v0
    v_lshl_add_u32 v23, v12, 1, v23
    s_lshl_b32 s56, s3, 4
    s_add_u32 s56, s56, 157952
    v_add_u32 v23, s56, v23
    v_and_b32 v24, 15, v0
    v_lshlrev_b32 v24, 3, v24
    s_mul_i32 s56, s3, 144
    s_add_u32 s56, s56, 157952
    v_add_u32 v24, s56, v24
    v_add_u32 v21, 32768, v20
    s_lshl_b32 s100, s3, 10
    v_lshrrev_b32 v12, 4, v0
    v_mul_u32_u24 v12, 18432, v12
    v_and_b32 v13, 15, v0
    v_lshl_add_u32 v22, v13, 4, v12
    s_mul_i32 s57, s99, 57
    s_lshr_b32 s57, s57, 9
    s_mul_i32 s58, s57, 9
    s_sub_u32 s58, s99, s58
    s_mul_i32 s59, s57, 36864
    s_lshl_b32 s58, s58, 8
    s_add_u32 s59, s59, s58
    s_mul_i32 s58, s3, 2304
    s_add_u32 s59, s59, s58
    s_add_u32 s59, s59, 0x3000
    s_mov_b32 s58, 0
    s_cmp_eq_u32 s57, 1
    s_cselect_b32 s58, 1.0, s58
    s_cmp_eq_u32 s57, 4
    s_cselect_b32 s58, 1.0, s58
    s_waitcnt vmcnt(9)
    v_lshlrev_b32 v236, 16, v246
    v_and_b32 v237, 0xffff0000, v246
    v_max_f32 v236, 0xc2ae0000, v236
    v_min_f32 v242, 0x43000000, v236
    v_mul_f32 v238, 0xbfb8aa3b, v242
    v_fma_f32 v240, v242, s98, -v238
    v_fmac_f32 v240, 0xb2a57060, v242
    v_exp_f32 v238, v238
    v_mul_f32 v240, 0x3f317218, v240
    v_fmac_f32 v238, v238, v240
    v_add_f32 v238, 1.0, v238
    v_rcp_f32 v240, v238
    s_nop 0
    v_mul_f32 v242, v236, v240
    v_fma_f32 v238, -v242, v238, v236
    v_fma_f32 v236, v238, v240, v242
    v_max_f32 v237, 0xc2ae0000, v237
    v_min_f32 v243, 0x43000000, v237
    v_mul_f32 v239, 0xbfb8aa3b, v243
    v_fma_f32 v241, v243, s98, -v239
    v_fmac_f32 v241, 0xb2a57060, v243
    v_exp_f32 v239, v239
    v_mul_f32 v241, 0x3f317218, v241
    v_fmac_f32 v239, v239, v241
    v_add_f32 v239, 1.0, v239
    v_rcp_f32 v241, v239
    s_nop 0
    v_mul_f32 v243, v237, v241
    v_fma_f32 v239, -v243, v239, v237
    v_fma_f32 v237, v239, v241, v243
    v_cvt_pk_bf16_f32 v246, v236, v237
    v_lshlrev_b32 v236, 16, v247
    v_and_b32 v237, 0xffff0000, v247
    v_max_f32 v236, 0xc2ae0000, v236
    v_min_f32 v242, 0x43000000, v236
    v_mul_f32 v238, 0xbfb8aa3b, v242
    v_fma_f32 v240, v242, s98, -v238
    v_fmac_f32 v240, 0xb2a57060, v242
    v_exp_f32 v238, v238
    v_mul_f32 v240, 0x3f317218, v240
    v_fmac_f32 v238, v238, v240
    v_add_f32 v238, 1.0, v238
    v_rcp_f32 v240, v238
    s_nop 0
    v_mul_f32 v242, v236, v240
    v_fma_f32 v238, -v242, v238, v236
    v_fma_f32 v236, v238, v240, v242
    v_max_f32 v237, 0xc2ae0000, v237
    v_min_f32 v243, 0x43000000, v237
    v_mul_f32 v239, 0xbfb8aa3b, v243
    v_fma_f32 v241, v243, s98, -v239
    v_fmac_f32 v241, 0xb2a57060, v243
    v_exp_f32 v239, v239
    v_mul_f32 v241, 0x3f317218, v241
    v_fmac_f32 v239, v239, v241
    v_add_f32 v239, 1.0, v239
    v_rcp_f32 v241, v239
    s_nop 0
    v_mul_f32 v243, v237, v241
    v_fma_f32 v239, -v243, v239, v237
    v_fma_f32 v237, v239, v241, v243
    v_cvt_pk_bf16_f32 v247, v236, v237
    v_lshlrev_b32 v236, 16, v248
    v_and_b32 v237, 0xffff0000, v248
    v_max_f32 v236, 0xc2ae0000, v236
    v_min_f32 v242, 0x43000000, v236
    v_mul_f32 v238, 0xbfb8aa3b, v242
    v_fma_f32 v240, v242, s98, -v238
    v_fmac_f32 v240, 0xb2a57060, v242
    v_exp_f32 v238, v238
    v_mul_f32 v240, 0x3f317218, v240
    v_fmac_f32 v238, v238, v240
    v_add_f32 v238, 1.0, v238
    v_rcp_f32 v240, v238
    s_nop 0
    v_mul_f32 v242, v236, v240
    v_fma_f32 v238, -v242, v238, v236
    v_fma_f32 v236, v238, v240, v242
    v_max_f32 v237, 0xc2ae0000, v237
    v_min_f32 v243, 0x43000000, v237
    v_mul_f32 v239, 0xbfb8aa3b, v243
    v_fma_f32 v241, v243, s98, -v239
    v_fmac_f32 v241, 0xb2a57060, v243
    v_exp_f32 v239, v239
    v_mul_f32 v241, 0x3f317218, v241
    v_fmac_f32 v239, v239, v241
    v_add_f32 v239, 1.0, v239
    v_rcp_f32 v241, v239
    s_nop 0
    v_mul_f32 v243, v237, v241
    v_fma_f32 v239, -v243, v239, v237
    v_fma_f32 v237, v239, v241, v243
    v_cvt_pk_bf16_f32 v248, v236, v237
    v_lshlrev_b32 v236, 16, v249
    v_and_b32 v237, 0xffff0000, v249
    v_max_f32 v236, 0xc2ae0000, v236
    v_min_f32 v242, 0x43000000, v236
    v_mul_f32 v238, 0xbfb8aa3b, v242
    v_fma_f32 v240, v242, s98, -v238
    v_fmac_f32 v240, 0xb2a57060, v242
    v_exp_f32 v238, v238
    v_mul_f32 v240, 0x3f317218, v240
    v_fmac_f32 v238, v238, v240
    v_add_f32 v238, 1.0, v238
    v_rcp_f32 v240, v238
    s_nop 0
    v_mul_f32 v242, v236, v240
    v_fma_f32 v238, -v242, v238, v236
    v_fma_f32 v236, v238, v240, v242
    v_max_f32 v237, 0xc2ae0000, v237
    v_min_f32 v243, 0x43000000, v237
    v_mul_f32 v239, 0xbfb8aa3b, v243
    v_fma_f32 v241, v243, s98, -v239
    v_fmac_f32 v241, 0xb2a57060, v243
    v_exp_f32 v239, v239
    v_mul_f32 v241, 0x3f317218, v241
    v_fmac_f32 v239, v239, v241
    v_add_f32 v239, 1.0, v239
    v_rcp_f32 v241, v239
    s_nop 0
    v_mul_f32 v243, v237, v241
    v_fma_f32 v239, -v243, v239, v237
    v_fma_f32 v237, v239, v241, v243
    v_cvt_pk_bf16_f32 v249, v236, v237
    v_lshlrev_b32 v236, 16, v250
    v_and_b32 v237, 0xffff0000, v250
    v_max_f32 v236, 0xc2ae0000, v236
    v_min_f32 v242, 0x43000000, v236
    v_mul_f32 v238, 0xbfb8aa3b, v242
    v_fma_f32 v240, v242, s98, -v238
    v_fmac_f32 v240, 0xb2a57060, v242
    v_exp_f32 v238, v238
    v_mul_f32 v240, 0x3f317218, v240
    v_fmac_f32 v238, v238, v240
    v_add_f32 v238, 1.0, v238
    v_rcp_f32 v240, v238
    s_nop 0
    v_mul_f32 v242, v236, v240
    v_fma_f32 v238, -v242, v238, v236
    v_fma_f32 v236, v238, v240, v242
    v_max_f32 v237, 0xc2ae0000, v237
    v_min_f32 v243, 0x43000000, v237
    v_mul_f32 v239, 0xbfb8aa3b, v243
    v_fma_f32 v241, v243, s98, -v239
    v_fmac_f32 v241, 0xb2a57060, v243
    v_exp_f32 v239, v239
    v_mul_f32 v241, 0x3f317218, v241
    v_fmac_f32 v239, v239, v241
    v_add_f32 v239, 1.0, v239
    v_rcp_f32 v241, v239
    s_nop 0
    v_mul_f32 v243, v237, v241
    v_fma_f32 v239, -v243, v239, v237
    v_fma_f32 v237, v239, v241, v243
    v_cvt_pk_bf16_f32 v250, v236, v237
    ds_write_b64 v17, v[246:247]
    ds_write_b64 v17, v[248:249] offset:512
    ds_write_b32 v18, v250
    s_waitcnt vmcnt(3)
    s_add_u32 s63, s69, 147456
    buffer_load_dwordx4 v[72:75], v1, s[40:43], s63 offen nt
    s_waitcnt vmcnt(3)
    s_add_u32 s63, s69, 155648
    buffer_load_dwordx4 v[76:79], v1, s[40:43], s63 offen nt
    s_waitcnt vmcnt(3)
    s_add_u32 s63, s69, 163840
    buffer_load_dwordx4 v[104:107], v1, s[40:43], s63 offen nt
    s_waitcnt vmcnt(3)
    s_add_u32 s63, s69, 172032
    buffer_load_dwordx4 v[108:111], v1, s[40:43], s63 offen nt
    s_waitcnt vmcnt(3)
    s_add_u32 s63, s69, 180224
    buffer_load_dwordx4 v[136:139], v1, s[40:43], s63 offen nt
    s_waitcnt vmcnt(3)
    s_add_u32 s63, s69, 188416
    buffer_load_dwordx4 v[140:143], v1, s[40:43], s63 offen nt
    s_waitcnt vmcnt(3)
    s_add_u32 s63, s69, 262144
    buffer_load_dwordx4 v[48:51], v1, s[40:43], s63 offen nt
    s_waitcnt vmcnt(3)
    s_add_u32 s63, s69, 270336
    buffer_load_dwordx4 v[52:55], v1, s[40:43], s63 offen nt
    s_waitcnt lgkmcnt(0)
    s_barrier
    ds_read_b64_tr_b16 v[160:161], v20 offset:0
    ds_read_b64_tr_b16 v[162:163], v20 offset:512
    ds_read_b64_tr_b16 v[164:165], v20 offset:8192
    ds_read_b64_tr_b16 v[166:167], v20 offset:8704
    ds_read_b64_tr_b16 v[168:169], v20 offset:16384
    ds_read_b64_tr_b16 v[170:171], v20 offset:16896
    ds_read_b64_tr_b16 v[172:173], v20 offset:24576
    ds_read_b64_tr_b16 v[174:175], v20 offset:25088
    ds_read_b64_tr_b16 v[176:177], v21 offset:0
    ds_read_b64_tr_b16 v[178:179], v21 offset:512
    ds_read_b64_tr_b16 v[180:181], v21 offset:8192
    ds_read_b64_tr_b16 v[182:183], v21 offset:8704
    ds_read_b64_tr_b16 v[184:185], v21 offset:16384
    ds_read_b64_tr_b16 v[186:187], v21 offset:16896
    ds_read_b64_tr_b16 v[188:189], v21 offset:24576
    ds_read_b64_tr_b16 v[190:191], v21 offset:25088
    ds_read_b64_tr_b16 v[192:193], v21 offset:32768
    ds_read_b64_tr_b16 v[194:195], v21 offset:33280
    ds_read_b128 v[196:199], v16 offset:0
    ds_read_b128 v[200:203], v16 offset:128
    ds_read_b128 v[204:207], v16 offset:256
    ds_read_b128 v[208:211], v16 offset:384
    ds_read_b128 v[212:215], v16 offset:512
    ds_read_b128 v[216:219], v16 offset:640
    ds_read_b128 v[220:223], v16 offset:768
    ds_read_b128 v[224:227], v16 offset:896
    ds_read_b128 v[228:231], v16 offset:1024
    s_waitcnt lgkmcnt(8)
    v_mfma_f32_16x16x32_bf16 v[232:235], v[160:163], v[196:199], 0
    s_waitcnt lgkmcnt(7)
    v_mfma_f32_16x16x32_bf16 v[232:235], v[164:167], v[200:203], v[232:235]
    s_waitcnt lgkmcnt(6)
    v_mfma_f32_16x16x32_bf16 v[232:235], v[168:171], v[204:207], v[232:235]
    s_waitcnt lgkmcnt(5)
    v_mfma_f32_16x16x32_bf16 v[232:235], v[172:175], v[208:211], v[232:235]
    s_waitcnt lgkmcnt(4)
    v_mfma_f32_16x16x32_bf16 v[232:235], v[176:179], v[212:215], v[232:235]
    s_waitcnt lgkmcnt(3)
    v_mfma_f32_16x16x32_bf16 v[232:235], v[180:183], v[216:219], v[232:235]
    s_waitcnt lgkmcnt(2)
    v_mfma_f32_16x16x32_bf16 v[232:235], v[184:187], v[220:223], v[232:235]
    s_waitcnt lgkmcnt(1)
    v_mfma_f32_16x16x32_bf16 v[232:235], v[188:191], v[224:227], v[232:235]
    s_waitcnt lgkmcnt(0)
    v_mfma_f32_16x16x32_bf16 v[232:235], v[192:195], v[228:231], v[232:235]
    s_nop 7
    v_permlane32_swap_b32 v232, v234
    v_permlane32_swap_b32 v233, v235
    v_cndmask_b32 v233, v233, v234, s[96:97]
    v_cndmask_b32 v232, v232, v235, s[96:97]
    s_nop 1
    v_add_f32_dpp v236, v233, v232 quad_perm:[1,0,3,2] row_mask:0xf bank_mask:0xf
    v_cvt_pk_bf16_f32 v236, 0, v236
    v_add_f32 v236, s58, v236
    v_cvt_pk_bf16_f32 v236, v236, v236
    ds_write_b16 v23, v236
    v_mov_b32 v243, s34
    s_waitcnt lgkmcnt(0)
    s_barrier
    ds_read2_b32 v[244:245], v24 offset1:1
    v_mov_b32 v241, s34
    s_waitcnt lgkmcnt(0)
    v_mov_b32 v240, v244
    v_mov_b32 v242, v245
    s_mov_b64 exec, 0xffff
    buffer_store_dwordx4 v[240:243], v22, s[36:39], s59 offen sc1
    s_mov_b64 exec, -1
    s_nop 0
    s_branch .Le_m2
.Le_mc:
    v_bfe_u32 v16, v0, 1, 3
    v_mul_u32_u24 v16, 1312, v16
    v_lshrrev_b32 v12, 4, v0
    v_lshl_add_u32 v16, v12, 5, v16
    v_and_b32 v12, 1, v0
    v_lshl_add_u32 v16, v12, 4, v16
    v_add_u32 v16, 147456, v16
    s_mul_i32 s56, s3, 1312
    s_add_u32 s56, s56, 147456
    v_add_u32 v17, s56, v3
    v_add_u32 v18, s56, v4
    v_lshrrev_b32 v12, 4, v0
    v_bfe_u32 v13, v0, 1, 1
    v_lshl_add_u32 v12, v12, 1, v13
    v_bfe_u32 v13, v0, 2, 2
    v_lshl_add_u32 v20, v12, 3, v13
    v_lshlrev_b32 v20, 7, v20
    v_and_b32 v12, 3, v12
    v_lshrrev_b32 v13, 1, v13
    v_lshl_add_u32 v12, v12, 1, v13
    v_xor_b32 v12, s3, v12
    v_lshl_add_u32 v20, v12, 4, v20
    v_and_b32 v12, 1, v0
    v_lshl_add_u32 v20, v12, 3, v20
    v_bfe_u32 v23, v0, 1, 3
    v_mul_u32_u24 v23, 144, v23
    v_bfe_u32 v12, v0, 4, 1
    v_lshl_add_u32 v23, v12, 3, v23
    v_lshrrev_b32 v12, 5, v0
    v_lshl_add_u32 v23, v12, 2, v23
    v_and_b32 v12, 1, v0
    v_lshl_add_u32 v23, v12, 1, v23
    s_lshl_b32 s56, s3, 4
    s_add_u32 s56, s56, 157952
    v_add_u32 v23, s56, v23
    v_and_b32 v24, 15, v0
    v_lshlrev_b32 v24, 3, v24
    s_mul_i32 s56, s3, 144
    s_add_u32 s56, s56, 157952
    v_add_u32 v24, s56, v24
    v_add_u32 v21, 32768, v20
    s_lshl_b32 s100, s3, 10
    s_waitcnt lgkmcnt(0)
    s_add_u32 s34, s34, 1
    v_lshrrev_b32 v12, 4, v0
    v_mul_u32_u24 v12, 18432, v12
    v_and_b32 v13, 15, v0
    v_lshl_add_u32 v22, v13, 4, v12
    s_mul_i32 s57, s99, 57
    s_lshr_b32 s57, s57, 9
    s_mul_i32 s58, s57, 9
    s_sub_u32 s58, s99, s58
    s_mul_i32 s59, s57, 36864
    s_lshl_b32 s58, s58, 8
    s_add_u32 s59, s59, s58
    s_mul_i32 s58, s3, 2304
    s_add_u32 s59, s59, s58
    s_add_u32 s59, s59, 0x3000
    s_mov_b32 s58, 0
    s_cmp_eq_u32 s57, 1
    s_cselect_b32 s58, 1.0, s58
    s_cmp_eq_u32 s57, 4
    s_cselect_b32 s58, 1.0, s58
    s_waitcnt vmcnt(13)
    v_lshlrev_b32 v236, 16, v246
    v_and_b32 v237, 0xffff0000, v246
    v_max_f32 v236, 0xc2ae0000, v236
    v_min_f32 v242, 0x43000000, v236
    v_mul_f32 v238, 0xbfb8aa3b, v242
    v_fma_f32 v240, v242, s98, -v238
    v_fmac_f32 v240, 0xb2a57060, v242
    v_exp_f32 v238, v238
    v_mul_f32 v240, 0x3f317218, v240
    v_fmac_f32 v238, v238, v240
    v_add_f32 v238, 1.0, v238
    v_rcp_f32 v240, v238
    s_nop 0
    v_mul_f32 v242, v236, v240
    v_fma_f32 v238, -v242, v238, v236
    v_fma_f32 v236, v238, v240, v242
    v_max_f32 v237, 0xc2ae0000, v237
    v_min_f32 v243, 0x43000000, v237
    v_mul_f32 v239, 0xbfb8aa3b, v243
    v_fma_f32 v241, v243, s98, -v239
    v_fmac_f32 v241, 0xb2a57060, v243
    v_exp_f32 v239, v239
    v_mul_f32 v241, 0x3f317218, v241
    v_fmac_f32 v239, v239, v241
    v_add_f32 v239, 1.0, v239
    v_rcp_f32 v241, v239
    s_nop 0
    v_mul_f32 v243, v237, v241
    v_fma_f32 v239, -v243, v239, v237
    v_fma_f32 v237, v239, v241, v243
    v_cvt_pk_bf16_f32 v246, v236, v237
    v_lshlrev_b32 v236, 16, v247
    v_and_b32 v237, 0xffff0000, v247
    v_max_f32 v236, 0xc2ae0000, v236
    v_min_f32 v242, 0x43000000, v236
    v_mul_f32 v238, 0xbfb8aa3b, v242
    v_fma_f32 v240, v242, s98, -v238
    v_fmac_f32 v240, 0xb2a57060, v242
    v_exp_f32 v238, v238
    v_mul_f32 v240, 0x3f317218, v240
    v_fmac_f32 v238, v238, v240
    v_add_f32 v238, 1.0, v238
    v_rcp_f32 v240, v238
    s_nop 0
    v_mul_f32 v242, v236, v240
    v_fma_f32 v238, -v242, v238, v236
    v_fma_f32 v236, v238, v240, v242
    v_max_f32 v237, 0xc2ae0000, v237
    v_min_f32 v243, 0x43000000, v237
    v_mul_f32 v239, 0xbfb8aa3b, v243
    v_fma_f32 v241, v243, s98, -v239
    v_fmac_f32 v241, 0xb2a57060, v243
    v_exp_f32 v239, v239
    v_mul_f32 v241, 0x3f317218, v241
    v_fmac_f32 v239, v239, v241
    v_add_f32 v239, 1.0, v239
    v_rcp_f32 v241, v239
    s_nop 0
    v_mul_f32 v243, v237, v241
    v_fma_f32 v239, -v243, v239, v237
    v_fma_f32 v237, v239, v241, v243
    v_cvt_pk_bf16_f32 v247, v236, v237
    v_lshlrev_b32 v236, 16, v248
    v_and_b32 v237, 0xffff0000, v248
    v_max_f32 v236, 0xc2ae0000, v236
    v_min_f32 v242, 0x43000000, v236
    v_mul_f32 v238, 0xbfb8aa3b, v242
    v_fma_f32 v240, v242, s98, -v238
    v_fmac_f32 v240, 0xb2a57060, v242
    v_exp_f32 v238, v238
    v_mul_f32 v240, 0x3f317218, v240
    v_fmac_f32 v238, v238, v240
    v_add_f32 v238, 1.0, v238
    v_rcp_f32 v240, v238
    s_nop 0
    v_mul_f32 v242, v236, v240
    v_fma_f32 v238, -v242, v238, v236
    v_fma_f32 v236, v238, v240, v242
    v_max_f32 v237, 0xc2ae0000, v237
    v_min_f32 v243, 0x43000000, v237
    v_mul_f32 v239, 0xbfb8aa3b, v243
    v_fma_f32 v241, v243, s98, -v239
    v_fmac_f32 v241, 0xb2a57060, v243
    v_exp_f32 v239, v239
    v_mul_f32 v241, 0x3f317218, v241
    v_fmac_f32 v239, v239, v241
    v_add_f32 v239, 1.0, v239
    v_rcp_f32 v241, v239
    s_nop 0
    v_mul_f32 v243, v237, v241
    v_fma_f32 v239, -v243, v239, v237
    v_fma_f32 v237, v239, v241, v243
    v_cvt_pk_bf16_f32 v248, v236, v237
    v_lshlrev_b32 v236, 16, v249
    v_and_b32 v237, 0xffff0000, v249
    v_max_f32 v236, 0xc2ae0000, v236
    v_min_f32 v242, 0x43000000, v236
    v_mul_f32 v238, 0xbfb8aa3b, v242
    v_fma_f32 v240, v242, s98, -v238
    v_fmac_f32 v240, 0xb2a57060, v242
    v_exp_f32 v238, v238
    v_mul_f32 v240, 0x3f317218, v240
    v_fmac_f32 v238, v238, v240
    v_add_f32 v238, 1.0, v238
    v_rcp_f32 v240, v238
    s_nop 0
    v_mul_f32 v242, v236, v240
    v_fma_f32 v238, -v242, v238, v236
    v_fma_f32 v236, v238, v240, v242
    v_max_f32 v237, 0xc2ae0000, v237
    v_min_f32 v243, 0x43000000, v237
    v_mul_f32 v239, 0xbfb8aa3b, v243
    v_fma_f32 v241, v243, s98, -v239
    v_fmac_f32 v241, 0xb2a57060, v243
    v_exp_f32 v239, v239
    v_mul_f32 v241, 0x3f317218, v241
    v_fmac_f32 v239, v239, v241
    v_add_f32 v239, 1.0, v239
    v_rcp_f32 v241, v239
    s_nop 0
    v_mul_f32 v243, v237, v241
    v_fma_f32 v239, -v243, v239, v237
    v_fma_f32 v237, v239, v241, v243
    v_cvt_pk_bf16_f32 v249, v236, v237
    v_lshlrev_b32 v236, 16, v250
    v_and_b32 v237, 0xffff0000, v250
    v_max_f32 v236, 0xc2ae0000, v236
    v_min_f32 v242, 0x43000000, v236
    v_mul_f32 v238, 0xbfb8aa3b, v242
    v_fma_f32 v240, v242, s98, -v238
    v_fmac_f32 v240, 0xb2a57060, v242
    v_exp_f32 v238, v238
    v_mul_f32 v240, 0x3f317218, v240
    v_fmac_f32 v238, v238, v240
    v_add_f32 v238, 1.0, v238
    v_rcp_f32 v240, v238
    s_nop 0
    v_mul_f32 v242, v236, v240
    v_fma_f32 v238, -v242, v238, v236
    v_fma_f32 v236, v238, v240, v242
    v_max_f32 v237, 0xc2ae0000, v237
    v_min_f32 v243, 0x43000000, v237
    v_mul_f32 v239, 0xbfb8aa3b, v243
    v_fma_f32 v241, v243, s98, -v239
    v_fmac_f32 v241, 0xb2a57060, v243
    v_exp_f32 v239, v239
    v_mul_f32 v241, 0x3f317218, v241
    v_fmac_f32 v239, v239, v241
    v_add_f32 v239, 1.0, v239
    v_rcp_f32 v241, v239
    s_nop 0
    v_mul_f32 v243, v237, v241
    v_fma_f32 v239, -v243, v239, v237
    v_fma_f32 v237, v239, v241, v243
    v_cvt_pk_bf16_f32 v250, v236, v237
    ds_write_b64 v17, v[246:247]
    ds_write_b64 v17, v[248:249] offset:512
    ds_write_b32 v18, v250
    s_waitcnt vmcnt(4)
    s_waitcnt lgkmcnt(0)
    s_barrier
    ds_read_b64_tr_b16 v[160:161], v20 offset:0
    ds_read_b64_tr_b16 v[162:163], v20 offset:512
    ds_read_b64_tr_b16 v[164:165], v20 offset:8192
    ds_read_b64_tr_b16 v[166:167], v20 offset:8704
    ds_read_b64_tr_b16 v[168:169], v20 offset:16384
    ds_read_b64_tr_b16 v[170:171], v20 offset:16896
    ds_read_b64_tr_b16 v[172:173], v20 offset:24576
    ds_read_b64_tr_b16 v[174:175], v20 offset:25088
    ds_read_b64_tr_b16 v[176:177], v21 offset:0
    ds_read_b64_tr_b16 v[178:179], v21 offset:512
    ds_read_b64_tr_b16 v[180:181], v21 offset:8192
    ds_read_b64_tr_b16 v[182:183], v21 offset:8704
    ds_read_b64_tr_b16 v[184:185], v21 offset:16384
    ds_read_b64_tr_b16 v[186:187], v21 offset:16896
    ds_read_b64_tr_b16 v[188:189], v21 offset:24576
    ds_read_b64_tr_b16 v[190:191], v21 offset:25088
    ds_read_b64_tr_b16 v[192:193], v21 offset:32768
    ds_read_b64_tr_b16 v[194:195], v21 offset:33280
    ds_read_b128 v[196:199], v16 offset:0
    ds_read_b128 v[200:203], v16 offset:128
    ds_read_b128 v[204:207], v16 offset:256
    ds_read_b128 v[208:211], v16 offset:384
    ds_read_b128 v[212:215], v16 offset:512
    ds_read_b128 v[216:219], v16 offset:640
    ds_read_b128 v[220:223], v16 offset:768
    ds_read_b128 v[224:227], v16 offset:896
    ds_read_b128 v[228:231], v16 offset:1024
    s_waitcnt lgkmcnt(8)
    v_mfma_f32_16x16x32_bf16 v[232:235], v[160:163], v[196:199], 0
    s_waitcnt lgkmcnt(7)
    v_mfma_f32_16x16x32_bf16 v[232:235], v[164:167], v[200:203], v[232:235]
    s_waitcnt lgkmcnt(6)
    v_mfma_f32_16x16x32_bf16 v[232:235], v[168:171], v[204:207], v[232:235]
    s_waitcnt lgkmcnt(5)
    v_mfma_f32_16x16x32_bf16 v[232:235], v[172:175], v[208:211], v[232:235]
    s_waitcnt lgkmcnt(4)
    v_mfma_f32_16x16x32_bf16 v[232:235], v[176:179], v[212:215], v[232:235]
    s_waitcnt lgkmcnt(3)
    v_mfma_f32_16x16x32_bf16 v[232:235], v[180:183], v[216:219], v[232:235]
    s_waitcnt lgkmcnt(2)
    v_mfma_f32_16x16x32_bf16 v[232:235], v[184:187], v[220:223], v[232:235]
    s_waitcnt lgkmcnt(1)
    v_mfma_f32_16x16x32_bf16 v[232:235], v[188:191], v[224:227], v[232:235]
    s_waitcnt lgkmcnt(0)
    v_mfma_f32_16x16x32_bf16 v[232:235], v[192:195], v[228:231], v[232:235]
    s_nop 7
    v_permlane32_swap_b32 v232, v234
    v_permlane32_swap_b32 v233, v235
    v_cndmask_b32 v233, v233, v234, s[96:97]
    v_cndmask_b32 v232, v232, v235, s[96:97]
    s_nop 1
    v_add_f32_dpp v236, v233, v232 quad_perm:[1,0,3,2] row_mask:0xf bank_mask:0xf
    v_cvt_pk_bf16_f32 v236, 0, v236
    v_add_f32 v236, s58, v236
    v_cvt_pk_bf16_f32 v236, v236, v236
    ds_write_b16 v23, v236
    v_mov_b32 v243, s34
    s_waitcnt lgkmcnt(0)
    s_barrier
    ds_read2_b32 v[244:245], v24 offset1:1
    v_mov_b32 v241, s34
    s_waitcnt lgkmcnt(0)
    v_mov_b32 v240, v244
    v_mov_b32 v242, v245
    s_mov_b64 exec, 0xffffffff
    buffer_store_dwordx4 v[240:243], v22, s[36:39], s59 offen sc1
    s_mov_b64 exec, -1
    s_mov_b32 s14, 0x6b5ad6b5
    s_mov_b32 s15, 0x5ad6b5ad
    s_add_u32 s30, s70, -30
    s_waitcnt vmcnt(3)
    s_add_u32 s63, s69, 32768
    buffer_load_dwordx4 v[96:99], v1, s[40:43], s63 offen nt
    s_waitcnt vmcnt(3)
    s_add_u32 s63, s69, 40960
    buffer_load_dwordx4 v[100:103], v1, s[40:43], s63 offen nt
    s_waitcnt vmcnt(3)
    s_add_u32 s63, s69, 49152
    buffer_load_dwordx4 v[128:131], v1, s[40:43], s63 offen nt
    s_waitcnt vmcnt(3)
    s_add_u32 s63, s69, 57344
    buffer_load_dwordx4 v[132:135], v1, s[40:43], s63 offen nt
    s_waitcnt vmcnt(3)
    s_add_u32 s63, s69, 131072
    buffer_load_dwordx4 v[40:43], v1, s[40:43], s63 offen nt
    s_waitcnt vmcnt(3)
    s_add_u32 s63, s69, 139264
    buffer_load_dwordx4 v[44:47], v1, s[40:43], s63 offen nt
    s_waitcnt vmcnt(3)
    s_add_u32 s63, s69, 147456
    buffer_load_dwordx4 v[72:75], v1, s[40:43], s63 offen nt
    s_waitcnt vmcnt(3)
    s_add_u32 s63, s69, 155648
    buffer_load_dwordx4 v[76:79], v1, s[40:43], s63 offen nt
    s_waitcnt vmcnt(3)
    s_add_u32 s63, s69, 163840
    buffer_load_dwordx4 v[104:107], v1, s[40:43], s63 offen nt
    s_waitcnt vmcnt(3)
    s_add_u32 s63, s69, 172032
    buffer_load_dwordx4 v[108:111], v1, s[40:43], s63 offen nt
    s_waitcnt vmcnt(3)
    s_add_u32 s63, s69, 180224
    buffer_load_dwordx4 v[136:139], v1, s[40:43], s63 offen nt
    s_waitcnt vmcnt(3)
    s_add_u32 s63, s69, 188416
    buffer_load_dwordx4 v[140:143], v1, s[40:43], s63 offen nt
    s_waitcnt vmcnt(3)
    s_add_u32 s63, s69, 262144
    buffer_load_dwordx4 v[48:51], v1, s[40:43], s63 offen nt
    s_waitcnt vmcnt(3)
    s_add_u32 s63, s69, 270336
    buffer_load_dwordx4 v[52:55], v1, s[40:43], s63 offen nt
.Le_m2:
    s_waitcnt vmcnt(3)
    s_bitcmp1_b64 s[14:15], 18
    s_cbranch_scc0 1
    s_waitcnt vmcnt(2)
    s_add_u32 s63, s69, 278528
    buffer_load_dwordx4 v[80:83], v1, s[40:43], s63 offen nt
    v_and_b32 v157, 7, v0
    v_lshlrev_b32 v157, 7, v157
    s_mov_b32 s63, 0x400
    buffer_load_dword v156, v157, s[36:39], s63 offen
    s_memrealtime s[8:9]
    s_waitcnt lgkmcnt(0)
    s_sub_u32 s8, s8, s30
    s_cmpk_ge_u32 s8, 850
    s_cbranch_scc1 .ap_28
    s_waitcnt vmcnt(5)
    s_cmpk_ge_u32 s8, 785
    s_cbranch_scc1 .ap_28
    s_waitcnt vmcnt(4)
    s_bitcmp1_b64 s[14:15], 19
    s_cbranch_scc0 1
    s_waitcnt vmcnt(3)
    s_cmpk_ge_u32 s8, 710
    s_cbranch_scc1 .ap_28
    s_waitcnt vmcnt(2)
.ap_28:
    s_add_u32 s63, s69, 286720
    buffer_load_dwordx4 v[84:87], v1, s[40:43], s63 offen nt
    s_memrealtime s[8:9]
    s_waitcnt lgkmcnt(0)
    s_sub_u32 s8, s8, s30
    s_cmpk_ge_u32 s8, 895
    s_cbranch_scc1 .ap_29
    s_waitcnt vmcnt(6)
    s_cmpk_ge_u32 s8, 830
    s_cbranch_scc1 .ap_29
    s_waitcnt vmcnt(4)
    s_bitcmp1_b64 s[14:15], 20
    s_cbranch_scc0 1
    s_waitcnt vmcnt(3)
    s_cmpk_ge_u32 s8, 755
    s_cbranch_scc1 .ap_29
    s_waitcnt vmcnt(2)
.ap_29:
    s_add_u32 s63, s69, 294912
    buffer_load_dwordx4 v[112:115], v1, s[40:43], s63 offen nt
    s_memrealtime s[8:9]
    s_waitcnt lgkmcnt(0)
    s_sub_u32 s8, s8, s30
    s_cmpk_ge_u32 s8, 940
    s_cbranch_scc1 .ap_30
    s_waitcnt vmcnt(6)
    s_cmpk_ge_u32 s8, 875
    s_cbranch_scc1 .ap_30
    s_waitcnt vmcnt(4)
    s_bitcmp1_b64 s[14:15], 21
    s_cbranch_scc0 1
    s_waitcnt vmcnt(3)
    s_cmpk_ge_u32 s8, 800
    s_cbranch_scc1 .ap_30
    s_waitcnt vmcnt(1)
.ap_30:
    s_add_u32 s63, s69, 303104
    buffer_load_dwordx4 v[116:119], v1, s[40:43], s63 offen nt
    s_memrealtime s[8:9]
    s_waitcnt lgkmcnt(0)
    s_sub_u32 s8, s8, s30
    s_cmpk_ge_u32 s8, 985
    s_cbranch_scc1 .ap_31
    s_waitcnt vmcnt(6)
    s_cmpk_ge_u32 s8, 920
    s_cbranch_scc1 .ap_31
    s_waitcnt vmcnt(4)
    s_bitcmp1_b64 s[14:15], 22
    s_cbranch_scc0 1
    s_waitcnt vmcnt(2)
    s_cmpk_ge_u32 s8, 845
    s_cbranch_scc1 .ap_31
    s_waitcnt vmcnt(1)
.ap_31:
    s_add_u32 s63, s69, 311296
    buffer_load_dwordx4 v[144:147], v1, s[40:43], s63 offen nt
    s_waitcnt vmcnt(4)
    s_sub_u32 s63, s70, 300
    v_subrev_u32 v156, s63, v156
    v_mov_b32 v157, 600
    v_cmp_lt_u32 s[8:9], v156, v157
    v_add_u32_dpp v156, v156, v156 quad_perm:[1,0,3,2] row_mask:0xf bank_mask:0xf
    s_nop 1
    v_add_u32_dpp v156, v156, v156 quad_perm:[2,3,0,1] row_mask:0xf bank_mask:0xf
    s_nop 1
    v_add_u32_dpp v156, v156, v156 row_ror:4 row_mask:0xf bank_mask:0xf
    s_nop 0
    v_readfirstlane_b32 s63, v156
    s_cmp_eq_u64 s[8:9], -1
    s_nop 3
    s_cbranch_scc0 .et_32
    s_lshr_b32 s63, s63, 3
    s_sub_u32 s63, s63, 300
    s_add_u32 s30, s30, s63
.et_32:
    s_memrealtime s[8:9]
    s_waitcnt lgkmcnt(0)
    s_sub_u32 s8, s8, s30
    s_cmpk_ge_u32 s8, 1030
    s_cbranch_scc1 .ap_33
    s_waitcnt vmcnt(4)
    s_cmpk_ge_u32 s8, 965
    s_cbranch_scc1 .ap_33
    s_waitcnt vmcnt(3)
    s_bitcmp1_b64 s[14:15], 23
    s_cbranch_scc0 1
    s_waitcnt vmcnt(2)
    s_cmpk_ge_u32 s8, 890
    s_cbranch_scc1 .ap_33
    s_waitcnt vmcnt(1)
.ap_33:
    s_add_u32 s63, s69, 319488
    buffer_load_dwordx4 v[148:151], v1, s[40:43], s63 offen nt
    s_memrealtime s[8:9]
    s_waitcnt lgkmcnt(0)
    s_sub_u32 s8, s8, s30
    s_cmpk_ge_u32 s8, 1075
    s_cbranch_scc1 .ap_34
    s_waitcnt vmcnt(5)
    s_cmpk_ge_u32 s8, 1010
    s_cbranch_scc1 .ap_34
    s_waitcnt vmcnt(3)
    s_bitcmp1_b64 s[14:15], 24
    s_cbranch_scc0 1
    s_waitcnt vmcnt(2)
    s_cmpk_ge_u32 s8, 935
    s_cbranch_scc1 .ap_34
    s_waitcnt vmcnt(1)
.ap_34:
    s_add_u32 s63, s69, 393216
    buffer_load_dwordx4 v[56:59], v1, s[40:43], s63 offen nt
    s_memrealtime s[8:9]
    s_waitcnt lgkmcnt(0)
    s_sub_u32 s8, s8, s30
    s_cmpk_ge_u32 s8, 1120
    s_cbranch_scc1 .ap_35
    s_waitcnt vmcnt(5)
    s_cmpk_ge_u32 s8, 1055
    s_cbranch_scc1 .ap_35
    s_waitcnt vmcnt(3)
    s_bitcmp1_b64 s[14:15], 25
    s_cbranch_scc0 1
    s_waitcnt vmcnt(2)
    s_cmpk_ge_u32 s8, 980
    s_cbranch_scc1 .ap_35
    s_waitcnt vmcnt(1)
.ap_35:
    s_add_u32 s63, s69, 401408
    buffer_load_dwordx4 v[60:63], v1, s[40:43], s63 offen nt
    s_cmp_lt_u32 s2, 216
    s_cbranch_scc1 .Latt_bc
    s_branch .Latt_n
.Le_q:
    s_cmp_ge_u32 s65, 27
    s_mov_b32 s14, 0x94a5294a
    s_cselect_b32 s14, 0x0, s14
    s_mov_b32 s15, 0xa5294a52
    s_cselect_b32 s15, 0x0, s15
    s_cselect_b32 s30, -30, 0
    s_add_u32 s30, s30, 0
    s_add_u32 s30, s30, s70
    s_mul_i32 s58, s3, 1152
    s_mov_b32 s52, s4
    s_and_b32 s53, s5, 0xffff
    s_mov_b32 s54, 0x2400
    s_mov_b32 s55, 0x00020000
    buffer_load_dwordx2 v[246:247], v3, s[52:55], s58 offen
    buffer_load_dwordx2 v[248:249], v3, s[52:55], s58 offen offset:512
    buffer_load_dword v250, v4, s[52:55], s58 offen
    s_mov_b32 s48, s10
    s_and_b32 s49, s11, 0xffff
    s_mov_b32 s50, 0x480000
    s_mov_b32 s51, 0x00020000
    v_bfe_u32 v12, v0, 4, 1
    s_and_b32 s56, s3, 3
    s_lshl_b32 s56, s56, 1
    v_or_b32 v12, s56, v12
    v_and_b32 v19, 7, v0
    v_xor_b32 v12, v12, v19
    v_lshrrev_b32 v19, 3, v0
    v_mul_u32_u24 v19, 8192, v19
    v_lshl_add_u32 v19, v12, 4, v19
    s_lshl3_add_u32 s101, s64, s101
    s_lshl_b32 s99, s3, 16
    s_lshl_b32 s59, s101, 7
    s_add_u32 s99, s99, s59
    s_lshl_b32 s100, s3, 10
    s_add_u32 m0, s100, 0
    s_add_u32 s56, s99, 0
    buffer_load_dwordx4 v19, s[48:51], s56 offen nt lds
    s_add_u32 s63, s69, 32768
    buffer_load_dwordx4 v[96:99], v1, s[40:43], s63 offen nt
    v_bfe_u32 v16, v0, 1, 3
    v_mul_u32_u24 v16, 1312, v16
    v_lshrrev_b32 v12, 4, v0
    v_lshl_add_u32 v16, v12, 5, v16
    v_and_b32 v12, 1, v0
    v_lshl_add_u32 v16, v12, 4, v16
    v_add_u32 v16, 147456, v16
    s_mul_i32 s56, s3, 1312
    s_add_u32 s56, s56, 147456
    v_add_u32 v17, s56, v3
    v_add_u32 v18, s56, v4
    v_lshrrev_b32 v12, 4, v0
    v_bfe_u32 v13, v0, 1, 1
    v_lshl_add_u32 v12, v12, 1, v13
    v_bfe_u32 v13, v0, 2, 2
    v_lshl_add_u32 v20, v12, 3, v13
    v_lshlrev_b32 v20, 7, v20
    v_and_b32 v12, 3, v12
    v_lshrrev_b32 v13, 1, v13
    v_lshl_add_u32 v12, v12, 1, v13
    v_xor_b32 v12, s3, v12
    v_lshl_add_u32 v20, v12, 4, v20
    v_and_b32 v12, 1, v0
    v_lshl_add_u32 v20, v12, 3, v20
    v_bfe_u32 v23, v0, 1, 3
    v_mul_u32_u24 v23, 144, v23
    v_bfe_u32 v12, v0, 4, 1
    v_lshl_add_u32 v23, v12, 3, v23
    v_lshrrev_b32 v12, 5, v0
    v_lshl_add_u32 v23, v12, 2, v23
    v_and_b32 v12, 1, v0
    v_lshl_add_u32 v23, v12, 1, v23
    s_lshl_b32 s56, s3, 4
    s_add_u32 s56, s56, 157952
    v_add_u32 v23, s56, v23
    v_and_b32 v24, 15, v0
    v_lshlrev_b32 v24, 3, v24
    s_mul_i32 s56, s3, 144
    s_add_u32 s56, s56, 157952
    v_add_u32 v24, s56, v24
    v_add_u32 v21, 32768, v20
    s_lshl_b32 s100, s3, 10
    s_waitcnt lgkmcnt(0)
    s_add_u32 s34, s34, 1
    s_lshl_b32 s101, s101, 8
    s_lshl_b32 s58, s3, 14
    s_add_u32 s101, s101, s58
    s_add_u32 s101, s101, 0x40000
    s_and_b32 s58, s64, 1
    s_mul_i32 s58, s58, 18432
    s_mul_i32 s59, s3, 2304
    s_add_u32 s58, s58, s59
    s_add_u32 s58, s58, 0x3000
    s_add_u32 s59, s58, 36864
    s_waitcnt vmcnt(5)
    s_add_u32 m0, s100, 8192
    s_add_u32 s56, s99, 524288
    buffer_load_dwordx4 v19, s[48:51], s56 offen nt lds
    s_waitcnt vmcnt(5)
    s_add_u32 s63, s69, 40960
    buffer_load_dwordx4 v[100:103], v1, s[40:43], s63 offen nt
    s_waitcnt vmcnt(5)
    s_add_u32 m0, s100, 16384
    s_add_u32 s56, s99, 1048576
    buffer_load_dwordx4 v19, s[48:51], s56 offen nt lds
    s_waitcnt vmcnt(5)
    s_add_u32 s63, s69, 49152
    buffer_load_dwordx4 v[128:131], v1, s[40:43], s63 offen nt
    v_lshlrev_b32 v236, 16, v246
    v_and_b32 v237, 0xffff0000, v246
    v_lshlrev_b32 v238, 16, v247
    v_and_b32 v239, 0xffff0000, v247
    v_lshlrev_b32 v240, 16, v248
    v_and_b32 v241, 0xffff0000, v248
    v_lshlrev_b32 v242, 16, v249
    v_and_b32 v243, 0xffff0000, v249
    v_lshlrev_b32 v244, 16, v250
    v_and_b32 v245, 0xffff0000, v250
    s_mov_b32 s56, 0x3f803f80
    v_dot2_f32_bf16 v10, v246, s56, 0
    v_dot2_f32_bf16 v11, v246, v246, 0
    v_dot2_f32_bf16 v10, v247, s56, v10
    v_dot2_f32_bf16 v11, v247, v247, v11
    v_dot2_f32_bf16 v10, v248, s56, v10
    v_dot2_f32_bf16 v11, v248, v248, v11
    v_dot2_f32_bf16 v10, v249, s56, v10
    v_dot2_f32_bf16 v11, v249, v249, v11
    s_mov_b64 exec, 0xffffffff
    v_dot2_f32_bf16 v10, v250, s56, v10
    v_dot2_f32_bf16 v11, v250, v250, v11
    s_mov_b64 exec, -1
    s_nop 1
    v_permlane32_swap_b32 v10, v11
    v_add_f32 v10, v10, v11
    v_mov_b32 v12, v10
    s_nop 1
    v_permlane16_swap_b32 v12, v10
    v_add_f32 v10, v12, v10
    s_nop 1
    v_add_f32_dpp v10, v10, v10 row_ror:8 row_mask:0xf bank_mask:0xf
    s_nop 1
    v_add_f32_dpp v10, v10, v10 row_ror:4 row_mask:0xf bank_mask:0xf
    s_nop 1
    v_add_f32_dpp v10, v10, v10 quad_perm:[2,3,0,1] row_mask:0xf bank_mask:0xf
    s_nop 1
    v_add_f32_dpp v10, v10, v10 quad_perm:[1,0,3,2] row_mask:0xf bank_mask:0xf
    v_mul_f32 v10, 0x3ae38e39, v10
    s_nop 0
    v_readlane_b32 s56, v10, 0
    v_readlane_b32 s57, v10, 32
    s_nop 0
    v_mov_b32 v10, s56
    v_fma_f32 v11, -v10, v10, s57
    v_max_f32 v11, 0, v11
    v_cvt_pk_bf16_f32 v13, 0, v11
    v_cvt_pk_bf16_f32 v11, 0, -v10
    v_cvt_pk_bf16_f32 v10, 0, -v10
    v_add_f32 v13, 0x3727c5ac, v13
    v_pk_add_f32 v[236:237], v[236:237], v[10:11]
    v_pk_add_f32 v[238:239], v[238:239], v[10:11]
    v_pk_add_f32 v[240:241], v[240:241], v[10:11]
    v_cvt_pk_bf16_f32 v13, 0, v13
    v_pk_add_f32 v[242:243], v[242:243], v[10:11]
    v_pk_add_f32 v[244:245], v[244:245], v[10:11]
    v_cvt_pk_bf16_f32 v236, 0, v236
    v_sqrt_f32 v13, v13
    v_cvt_pk_bf16_f32 v237, 0, v237
    v_cvt_pk_bf16_f32 v238, 0, v238
    v_cvt_pk_bf16_f32 v239, 0, v239
    v_cvt_pk_bf16_f32 v13, 0, v13
    v_cvt_pk_bf16_f32 v240, 0, v240
    v_cvt_pk_bf16_f32 v241, 0, v241
    v_cvt_pk_bf16_f32 v242, 0, v242
    v_rcp_f32 v12, v13
    v_cvt_pk_bf16_f32 v243, 0, v243
    v_cvt_pk_bf16_f32 v244, 0, v244
    v_cvt_pk_bf16_f32 v245, 0, v245
    v_mov_b32 v13, v12
    v_pk_mul_f32 v[236:237], v[236:237], v[12:13]
    v_pk_mul_f32 v[238:239], v[238:239], v[12:13]
    v_pk_mul_f32 v[240:241], v[240:241], v[12:13]
    v_pk_mul_f32 v[242:243], v[242:243], v[12:13]
    v_pk_mul_f32 v[244:245], v[244:245], v[12:13]
    v_cvt_pk_bf16_f32 v236, 0, v236
    v_cvt_pk_bf16_f32 v237, 0, v237
    v_cvt_pk_bf16_f32 v238, 0, v238
    v_cvt_pk_bf16_f32 v239, 0, v239
    v_cvt_pk_bf16_f32 v240, 0, v240
    v_cvt_pk_bf16_f32 v241, 0, v241
    v_cvt_pk_bf16_f32 v242, 0, v242
    v_cvt_pk_bf16_f32 v243, 0, v243
    v_cvt_pk_bf16_f32 v244, 0, v244
    v_cvt_pk_bf16_f32 v245, 0, v245
    s_waitcnt vmcnt(5)
    s_add_u32 m0, s100, 24576
    s_add_u32 s56, s99, 1572864
    buffer_load_dwordx4 v19, s[48:51], s56 offen nt lds
    s_waitcnt vmcnt(5)
    s_add_u32 s63, s69, 57344
    buffer_load_dwordx4 v[132:135], v1, s[40:43], s63 offen nt
    s_waitcnt vmcnt(5)
    s_add_u32 m0, s100, 32768
    s_add_u32 s56, s99, 2097152
    buffer_load_dwordx4 v19, s[48:51], s56 offen nt lds
    s_waitcnt vmcnt(5)
    s_add_u32 s63, s69, 131072
    buffer_load_dwordx4 v[40:43], v1, s[40:43], s63 offen nt
    s_waitcnt vmcnt(5)
    s_add_u32 m0, s100, 40960
    s_add_u32 s56, s99, 2621440
    buffer_load_dwordx4 v19, s[48:51], s56 offen nt lds
    s_waitcnt vmcnt(5)
    s_add_u32 s63, s69, 139264
    buffer_load_dwordx4 v[44:47], v1, s[40:43], s63 offen nt
    s_waitcnt vmcnt(5)
    s_add_u32 m0, s100, 49152
    s_add_u32 s56, s99, 3145728
    buffer_load_dwordx4 v19, s[48:51], s56 offen nt lds
    s_waitcnt vmcnt(5)
    s_add_u32 s63, s69, 147456
    buffer_load_dwordx4 v[72:75], v1, s[40:43], s63 offen nt
    s_waitcnt vmcnt(5)
    s_add_u32 m0, s100, 57344
    s_add_u32 s56, s99, 3670016
    buffer_load_dwordx4 v19, s[48:51], s56 offen nt lds
    s_waitcnt vmcnt(5)
    s_add_u32 s63, s69, 155648
    buffer_load_dwordx4 v[76:79], v1, s[40:43], s63 offen nt
    s_waitcnt vmcnt(5)
    s_add_u32 m0, s100, 65536
    s_add_u32 s56, s99, 4194304
    buffer_load_dwordx4 v19, s[48:51], s56 offen nt lds
    s_waitcnt vmcnt(5)
    s_add_u32 s63, s69, 163840
    buffer_load_dwordx4 v[104:107], v1, s[40:43], s63 offen nt
    s_waitcnt vmcnt(5)
    s_add_u32 s63, s69, 172032
    buffer_load_dwordx4 v[108:111], v1, s[40:43], s63 offen nt
    buffer_load_dwordx4 v[196:199], v2, s[36:39], s58 offen offset:0 sc1
    buffer_load_dwordx4 v[200:203], v2, s[36:39], s58 offen offset:1024 sc1
    buffer_load_dwordx2 v[204:205], v5, s[36:39], s58 offen offset:0 sc1
    buffer_load_dwordx4 v[206:209], v2, s[36:39], s59 offen offset:0 sc1
    buffer_load_dwordx4 v[210:213], v2, s[36:39], s59 offen offset:1024 sc1
    buffer_load_dwordx2 v[214:215], v5, s[36:39], s59 offen offset:0 sc1
    s_add_u32 s63, s69, 180224
    buffer_load_dwordx4 v[136:139], v1, s[40:43], s63 offen nt
    s_add_u32 s63, s69, 188416
    buffer_load_dwordx4 v[140:143], v1, s[40:43], s63 offen nt
    s_add_u32 s63, s69, 262144
    buffer_load_dwordx4 v[48:51], v1, s[40:43], s63 offen nt
    s_add_u32 s63, s69, 270336
    buffer_load_dwordx4 v[52:55], v1, s[40:43], s63 offen nt
    s_waitcnt vmcnt(12)
    s_barrier
    ds_read_b64_tr_b16 v[160:161], v20 offset:0
    ds_read_b64_tr_b16 v[162:163], v20 offset:512
    ds_read_b64_tr_b16 v[164:165], v20 offset:8192
    ds_read_b64_tr_b16 v[166:167], v20 offset:8704
    ds_read_b64_tr_b16 v[168:169], v20 offset:16384
    ds_read_b64_tr_b16 v[170:171], v20 offset:16896
    ds_read_b64_tr_b16 v[172:173], v20 offset:24576
    ds_read_b64_tr_b16 v[174:175], v20 offset:25088
    ds_read_b64_tr_b16 v[176:177], v21 offset:0
    ds_read_b64_tr_b16 v[178:179], v21 offset:512
    ds_read_b64_tr_b16 v[180:181], v21 offset:8192
    ds_read_b64_tr_b16 v[182:183], v21 offset:8704
    ds_read_b64_tr_b16 v[184:185], v21 offset:16384
    ds_read_b64_tr_b16 v[186:187], v21 offset:16896
    ds_read_b64_tr_b16 v[188:189], v21 offset:24576
    ds_read_b64_tr_b16 v[190:191], v21 offset:25088
    ds_read_b64_tr_b16 v[192:193], v21 offset:32768
    ds_read_b64_tr_b16 v[194:195], v21 offset:33280
    s_waitcnt vmcnt(4)
    s_branch .gpc_37
.gp_36:
    buffer_load_dwordx4 v[196:199], v2, s[36:39], s58 offen offset:0 sc1
    buffer_load_dwordx4 v[200:203], v2, s[36:39], s58 offen offset:1024 sc1
    buffer_load_dwordx2 v[204:205], v5, s[36:39], s58 offen offset:0 sc1
    buffer_load_dwordx4 v[206:209], v2, s[36:39], s59 offen offset:0 sc1
    buffer_load_dwordx4 v[210:213], v2, s[36:39], s59 offen offset:1024 sc1
    buffer_load_dwordx2 v[214:215], v5, s[36:39], s59 offen offset:0 sc1
    s_waitcnt vmcnt(0)
.gpc_37:
    v_min_u32 v10, v197, v199
    v_max_u32 v11, v197, v199
    v_min3_u32 v10, v10, v201, v203
    v_max3_u32 v11, v11, v201, v203
    v_min3_u32 v10, v10, v205, v207
    v_max3_u32 v11, v11, v205, v207
    v_min3_u32 v10, v10, v209, v211
    v_max3_u32 v11, v11, v209, v211
    v_min3_u32 v10, v10, v213, v215
    v_max3_u32 v11, v11, v213, v215
    v_cmp_eq_u32 vcc, s34, v10
    v_cmp_eq_u32 s[56:57], s34, v11
    s_and_b64 vcc, vcc, s[56:57]
    s_cmp_eq_u64 vcc, exec
    s_nop 2
    s_cbranch_scc1 .gpd_38
    s_sub_u32 s35, s35, 1
    s_cbranch_scc1 .Lexit
    s_branch .gp_36
.gpd_38:
    v_and_b32 v207, 0xffff0000, v206
    v_lshlrev_b32 v206, 16, v206
    v_and_b32 v209, 0xffff0000, v208
    v_lshlrev_b32 v208, 16, v208
    v_and_b32 v211, 0xffff0000, v210
    v_lshlrev_b32 v210, 16, v210
    v_and_b32 v213, 0xffff0000, v212
    v_lshlrev_b32 v212, 16, v212
    v_and_b32 v215, 0xffff0000, v214
    v_lshlrev_b32 v214, 16, v214
    v_and_b32 v197, 0xffff0000, v196
    v_lshlrev_b32 v196, 16, v196
    v_and_b32 v199, 0xffff0000, v198
    v_lshlrev_b32 v198, 16, v198
    v_and_b32 v201, 0xffff0000, v200
    v_lshlrev_b32 v200, 16, v200
    v_and_b32 v203, 0xffff0000, v202
    v_lshlrev_b32 v202, 16, v202
    v_and_b32 v205, 0xffff0000, v204
    v_lshlrev_b32 v204, 16, v204
    v_pk_mul_f32 v[236:237], v[236:237], v[206:207]
    v_pk_mul_f32 v[238:239], v[238:239], v[208:209]
    v_pk_mul_f32 v[240:241], v[240:241], v[210:211]
    v_pk_mul_f32 v[242:243], v[242:243], v[212:213]
    v_pk_mul_f32 v[244:245], v[244:245], v[214:215]
    v_cvt_pk_bf16_f32 v236, 0, v236
    v_cvt_pk_bf16_f32 v237, 0, v237
    v_cvt_pk_bf16_f32 v238, 0, v238
    v_cvt_pk_bf16_f32 v239, 0, v239
    v_cvt_pk_bf16_f32 v240, 0, v240
    v_cvt_pk_bf16_f32 v241, 0, v241
    v_cvt_pk_bf16_f32 v242, 0, v242
    v_cvt_pk_bf16_f32 v243, 0, v243
    v_cvt_pk_bf16_f32 v244, 0, v244
    v_cvt_pk_bf16_f32 v245, 0, v245
    v_pk_add_f32 v[236:237], v[236:237], v[196:197]
    v_pk_add_f32 v[238:239], v[238:239], v[198:199]
    v_pk_add_f32 v[240:241], v[240:241], v[200:201]
    v_pk_add_f32 v[242:243], v[242:243], v[202:203]
    v_pk_add_f32 v[244:245], v[244:245], v[204:205]
    v_cvt_pk_bf16_f32 v246, v236, v237
    v_cvt_pk_bf16_f32 v247, v238, v239
    v_cvt_pk_bf16_f32 v248, v240, v241
    v_cvt_pk_bf16_f32 v249, v242, v243
    v_cvt_pk_bf16_f32 v250, v244, v245
    ds_write_b64 v17, v[246:247]
    ds_write_b64 v17, v[248:249] offset:512
    ds_write_b32 v18, v250
    s_waitcnt lgkmcnt(0)
    s_barrier
    ds_read_b128 v[196:199], v16 offset:0
    ds_read_b128 v[200:203], v16 offset:128
    ds_read_b128 v[204:207], v16 offset:256
    ds_read_b128 v[208:211], v16 offset:384
    ds_read_b128 v[212:215], v16 offset:512
    ds_read_b128 v[216:219], v16 offset:640
    ds_read_b128 v[220:223], v16 offset:768
    ds_read_b128 v[224:227], v16 offset:896
    ds_read_b128 v[228:231], v16 offset:1024
    s_waitcnt lgkmcnt(8)
    v_mfma_f32_16x16x32_bf16 v[232:235], v[160:163], v[196:199], 0
    s_waitcnt lgkmcnt(7)
    v_mfma_f32_16x16x32_bf16 v[232:235], v[164:167], v[200:203], v[232:235]
    s_waitcnt lgkmcnt(6)
    v_mfma_f32_16x16x32_bf16 v[232:235], v[168:171], v[204:207], v[232:235]
    s_waitcnt lgkmcnt(5)
    v_mfma_f32_16x16x32_bf16 v[232:235], v[172:175], v[208:211], v[232:235]
    s_waitcnt lgkmcnt(4)
    v_mfma_f32_16x16x32_bf16 v[232:235], v[176:179], v[212:215], v[232:235]
    s_waitcnt lgkmcnt(3)
    v_mfma_f32_16x16x32_bf16 v[232:235], v[180:183], v[216:219], v[232:235]
    s_waitcnt lgkmcnt(2)
    v_mfma_f32_16x16x32_bf16 v[232:235], v[184:187], v[220:223], v[232:235]
    s_waitcnt lgkmcnt(1)
    v_mfma_f32_16x16x32_bf16 v[232:235], v[188:191], v[224:227], v[232:235]
    s_waitcnt lgkmcnt(0)
    v_mfma_f32_16x16x32_bf16 v[232:235], v[192:195], v[228:231], v[232:235]
    s_nop 7
    v_permlane32_swap_b32 v232, v234
    v_permlane32_swap_b32 v233, v235
    v_cndmask_b32 v233, v233, v234, s[96:97]
    v_cndmask_b32 v232, v232, v235, s[96:97]
    s_nop 1
    v_add_f32_dpp v236, v233, v232 quad_perm:[1,0,3,2] row_mask:0xf bank_mask:0xf
    v_cvt_pk_bf16_f32 v236, v236, v236
    ds_write_b16 v23, v236
    v_mov_b32 v243, s34
    s_waitcnt lgkmcnt(0)
    s_barrier
    ds_read2_b32 v[244:245], v24 offset1:1
    v_mov_b32 v241, s34
    s_waitcnt lgkmcnt(0)
    v_mov_b32 v240, v244
    v_mov_b32 v242, v245
    s_mov_b64 exec, 0xffff
    buffer_store_dwordx4 v[240:243], v2, s[36:39], s101 offen sc1
    s_mov_b64 exec, -1
.Lq_done:
    s_waitcnt vmcnt(3)
    s_bitcmp1_b64 s[14:15], 18
    s_cbranch_scc0 1
    s_waitcnt vmcnt(2)
    s_add_u32 s63, s69, 278528
    buffer_load_dwordx4 v[80:83], v1, s[40:43], s63 offen nt
    v_and_b32 v157, 7, v0
    v_lshlrev_b32 v157, 7, v157
    s_mov_b32 s63, 0x400
    buffer_load_dword v156, v157, s[36:39], s63 offen
    s_memrealtime s[8:9]
    s_waitcnt lgkmcnt(0)
    s_sub_u32 s8, s8, s30
    s_cmpk_ge_u32 s8, 850
    s_cbranch_scc1 .ap_39
    s_waitcnt vmcnt(5)
    s_cmpk_ge_u32 s8, 785
    s_cbranch_scc1 .ap_39
    s_waitcnt vmcnt(4)
    s_bitcmp1_b64 s[14:15], 19
    s_cbranch_scc0 1
    s_waitcnt vmcnt(3)
    s_cmpk_ge_u32 s8, 710
    s_cbranch_scc1 .ap_39
    s_waitcnt vmcnt(2)
.ap_39:
    s_add_u32 s63, s69, 286720
    buffer_load_dwordx4 v[84:87], v1, s[40:43], s63 offen nt
    s_memrealtime s[8:9]
    s_waitcnt lgkmcnt(0)
    s_sub_u32 s8, s8, s30
    s_cmpk_ge_u32 s8, 895
    s_cbranch_scc1 .ap_40
    s_waitcnt vmcnt(6)
    s_cmpk_ge_u32 s8, 830
    s_cbranch_scc1 .ap_40
    s_waitcnt vmcnt(4)
    s_bitcmp1_b64 s[14:15], 20
    s_cbranch_scc0 1
    s_waitcnt vmcnt(3)
    s_cmpk_ge_u32 s8, 755
    s_cbranch_scc1 .ap_40
    s_waitcnt vmcnt(2)
.ap_40:
    s_add_u32 s63, s69, 294912
    buffer_load_dwordx4 v[112:115], v1, s[40:43], s63 offen nt
    s_memrealtime s[8:9]
    s_waitcnt lgkmcnt(0)
    s_sub_u32 s8, s8, s30
    s_cmpk_ge_u32 s8, 940
    s_cbranch_scc1 .ap_41
    s_waitcnt vmcnt(6)
    s_cmpk_ge_u32 s8, 875
    s_cbranch_scc1 .ap_41
    s_waitcnt vmcnt(4)
    s_bitcmp1_b64 s[14:15], 21
    s_cbranch_scc0 1
    s_waitcnt vmcnt(3)
    s_cmpk_ge_u32 s8, 800
    s_cbranch_scc1 .ap_41
    s_waitcnt vmcnt(1)
.ap_41:
    s_add_u32 s63, s69, 303104
    buffer_load_dwordx4 v[116:119], v1, s[40:43], s63 offen nt
    s_memrealtime s[8:9]
    s_waitcnt lgkmcnt(0)
    s_sub_u32 s8, s8, s30
    s_cmpk_ge_u32 s8, 985
    s_cbranch_scc1 .ap_42
    s_waitcnt vmcnt(6)
    s_cmpk_ge_u32 s8, 920
    s_cbranch_scc1 .ap_42
    s_waitcnt vmcnt(4)
    s_bitcmp1_b64 s[14:15], 22
    s_cbranch_scc0 1
    s_waitcnt vmcnt(2)
    s_cmpk_ge_u32 s8, 845
    s_cbranch_scc1 .ap_42
    s_waitcnt vmcnt(1)
.ap_42:
    s_add_u32 s63, s69, 311296
    buffer_load_dwordx4 v[144:147], v1, s[40:43], s63 offen nt
    s_waitcnt vmcnt(4)
    s_sub_u32 s63, s70, 300
    v_subrev_u32 v156, s63, v156
    v_mov_b32 v157, 600
    v_cmp_lt_u32 s[8:9], v156, v157
    v_add_u32_dpp v156, v156, v156 quad_perm:[1,0,3,2] row_mask:0xf bank_mask:0xf
    s_nop 1
    v_add_u32_dpp v156, v156, v156 quad_perm:[2,3,0,1] row_mask:0xf bank_mask:0xf
    s_nop 1
    v_add_u32_dpp v156, v156, v156 row_ror:4 row_mask:0xf bank_mask:0xf
    s_nop 0
    v_readfirstlane_b32 s63, v156
    s_cmp_eq_u64 s[8:9], -1
    s_nop 3
    s_cbranch_scc0 .et_43
    s_lshr_b32 s63, s63, 3
    s_sub_u32 s63, s63, 300
    s_add_u32 s30, s30, s63
.et_43:
    s_memrealtime s[8:9]
    s_waitcnt lgkmcnt(0)
    s_sub_u32 s8, s8, s30
    s_cmpk_ge_u32 s8, 1030
    s_cbranch_scc1 .ap_44
    s_waitcnt vmcnt(4)
    s_cmpk_ge_u32 s8, 965
    s_cbranch_scc1 .ap_44
    s_waitcnt vmcnt(3)
    s_bitcmp1_b64 s[14:15], 23
    s_cbranch_scc0 1
    s_waitcnt vmcnt(2)
    s_cmpk_ge_u32 s8, 890
    s_cbranch_scc1 .ap_44
    s_waitcnt vmcnt(1)
.ap_44:
    s_add_u32 s63, s69, 319488
    buffer_load_dwordx4 v[148:151], v1, s[40:43], s63 offen nt
    s_memrealtime s[8:9]
    s_waitcnt lgkmcnt(0)
    s_sub_u32 s8, s8, s30
    s_cmpk_ge_u32 s8, 1075
    s_cbranch_scc1 .ap_45
    s_waitcnt vmcnt(5)
    s_cmpk_ge_u32 s8, 1010
    s_cbranch_scc1 .ap_45
    s_waitcnt vmcnt(3)
    s_bitcmp1_b64 s[14:15], 24
    s_cbranch_scc0 1
    s_waitcnt vmcnt(2)
    s_cmpk_ge_u32 s8, 935
    s_cbranch_scc1 .ap_45
    s_waitcnt vmcnt(1)
.ap_45:
    s_add_u32 s63, s69, 393216
    buffer_load_dwordx4 v[56:59], v1, s[40:43], s63 offen nt
    s_memrealtime s[8:9]
    s_waitcnt lgkmcnt(0)
    s_sub_u32 s8, s8, s30
    s_cmpk_ge_u32 s8, 1120
    s_cbranch_scc1 .ap_46
    s_waitcnt vmcnt(5)
    s_cmpk_ge_u32 s8, 1055
    s_cbranch_scc1 .ap_46
    s_waitcnt vmcnt(3)
    s_bitcmp1_b64 s[14:15], 25
    s_cbranch_scc0 1
    s_waitcnt vmcnt(2)
    s_cmpk_ge_u32 s8, 980
    s_cbranch_scc1 .ap_46
    s_waitcnt vmcnt(1)
.ap_46:
    s_add_u32 s63, s69, 401408
    buffer_load_dwordx4 v[60:63], v1, s[40:43], s63 offen nt
    s_cmp_lt_u32 s2, 216
    s_cbranch_scc1 .Latt_bc
    s_branch .Latt_n
.Le_a:
    s_mov_b32 s14, 0x6ddb76dd
    s_mov_b32 s15, 0xdb76ddb7
    s_add_u32 s30, s70, -60
    s_mov_b32 s48, s12
    s_and_b32 s49, s13, 0xffff
    s_mov_b32 s50, 0x480000
    s_mov_b32 s51, 0x00020000
    v_bfe_u32 v12, v0, 4, 1
    s_and_b32 s56, s3, 1
    s_lshl_b32 s56, s56, 2
    v_lshl_or_b32 v12, v12, 1, s56
    v_and_b32 v13, 7, v0
    v_xor_b32 v12, v12, v13
    v_lshrrev_b32 v13, 3, v0
    v_mul_u32_u24 v13, 1152, v13
    v_lshl_add_u32 v6, v12, 4, v13
    s_lshl_b32 s101, s64, 6
    s_add_u32 s101, s101, s3
    s_mul_i32 s101, s101, 9216
    s_lshl_b32 s56, s65, 7
    s_add_u32 s101, s101, s56
    s_lshl_b32 s100, s3, 10
    s_waitcnt vmcnt(3)
    s_add_u32 m0, s100, 0
    s_add_u32 s56, s101, 0
    buffer_load_dwordx4 v6, s[48:51], s56 offen nt lds
    s_waitcnt vmcnt(3)
    s_bitcmp1_b64 s[14:15], 4
    s_cbranch_scc0 1
    s_waitcnt vmcnt(2)
    s_add_u32 s63, s69, 32768
    buffer_load_dwordx4 v[96:99], v1, s[40:43], s63 offen nt
    s_waitcnt vmcnt(3)
    s_add_u32 m0, s100, 8192
    s_add_u32 s56, s101, 73728
    buffer_load_dwordx4 v6, s[48:51], s56 offen nt lds
    s_waitcnt vmcnt(3)
    s_bitcmp1_b64 s[14:15], 5
    s_cbranch_scc0 1
    s_waitcnt vmcnt(2)
    s_add_u32 s63, s69, 40960
    buffer_load_dwordx4 v[100:103], v1, s[40:43], s63 offen nt
    s_waitcnt vmcnt(3)
    s_bitcmp1_b64 s[14:15], 6
    s_cbranch_scc0 1
    s_waitcnt vmcnt(2)
    s_add_u32 s63, s69, 49152
    buffer_load_dwordx4 v[128:131], v1, s[40:43], s63 offen nt
    s_waitcnt vmcnt(3)
    s_bitcmp1_b64 s[14:15], 7
    s_cbranch_scc0 1
    s_waitcnt vmcnt(2)
    s_add_u32 s63, s69, 57344
    buffer_load_dwordx4 v[132:135], v1, s[40:43], s63 offen nt
    s_waitcnt vmcnt(3)
    s_add_u32 m0, s100, 16384
    s_add_u32 s56, s101, 147456
    buffer_load_dwordx4 v6, s[48:51], s56 offen nt lds
    s_waitcnt vmcnt(3)
    s_bitcmp1_b64 s[14:15], 8
    s_cbranch_scc0 1
    s_waitcnt vmcnt(2)
    s_add_u32 s63, s69, 131072
    buffer_load_dwordx4 v[40:43], v1, s[40:43], s63 offen nt
    s_waitcnt vmcnt(3)
    s_bitcmp1_b64 s[14:15], 9
    s_cbranch_scc0 1
    s_waitcnt vmcnt(2)
    s_add_u32 s63, s69, 139264
    buffer_load_dwordx4 v[44:47], v1, s[40:43], s63 offen nt
    s_memrealtime s[8:9]
    s_waitcnt lgkmcnt(0)
    s_sub_u32 s8, s8, s30
    s_cmpk_ge_u32 s8, 436
    s_cbranch_scc1 .ap_47
    s_waitcnt vmcnt(4)
    s_cmpk_ge_u32 s8, 371
    s_cbranch_scc1 .ap_47
    s_waitcnt vmcnt(3)
    s_bitcmp1_b64 s[14:15], 10
    s_cbranch_scc0 1
    s_waitcnt vmcnt(2)
    s_cmpk_ge_u32 s8, 296
    s_cbranch_scc1 .ap_47
    s_waitcnt vmcnt(1)
.ap_47:
    s_add_u32 s63, s69, 147456
    buffer_load_dwordx4 v[72:75], v1, s[40:43], s63 offen nt
    s_waitcnt vmcnt(3)
    s_add_u32 m0, s100, 24576
    s_add_u32 s56, s101, 221184
    buffer_load_dwordx4 v6, s[48:51], s56 offen nt lds
    s_memrealtime s[8:9]
    s_waitcnt lgkmcnt(0)
    s_sub_u32 s8, s8, s30
    s_cmpk_ge_u32 s8, 482
    s_cbranch_scc1 .ap_48
    s_waitcnt vmcnt(4)
    s_cmpk_ge_u32 s8, 417
    s_cbranch_scc1 .ap_48
    s_waitcnt vmcnt(3)
    s_bitcmp1_b64 s[14:15], 11
    s_cbranch_scc0 1
    s_waitcnt vmcnt(2)
    s_cmpk_ge_u32 s8, 342
    s_cbranch_scc1 .ap_48
    s_waitcnt vmcnt(1)
.ap_48:
    s_add_u32 s63, s69, 155648
    buffer_load_dwordx4 v[76:79], v1, s[40:43], s63 offen nt
    s_waitcnt lgkmcnt(0)
    s_add_u32 s34, s34, 1
    s_memrealtime s[8:9]
    s_waitcnt lgkmcnt(0)
    s_sub_u32 s8, s8, s30
    s_cmpk_ge_u32 s8, 528
    s_cbranch_scc1 .ap_49
    s_waitcnt vmcnt(5)
    s_cmpk_ge_u32 s8, 463
    s_cbranch_scc1 .ap_49
    s_waitcnt vmcnt(3)
    s_bitcmp1_b64 s[14:15], 12
    s_cbranch_scc0 1
    s_waitcnt vmcnt(2)
    s_cmpk_ge_u32 s8, 388
    s_cbranch_scc1 .ap_49
    s_waitcnt vmcnt(1)
.ap_49:
    s_add_u32 s63, s69, 163840
    buffer_load_dwordx4 v[104:107], v1, s[40:43], s63 offen nt
    s_memrealtime s[8:9]
    s_waitcnt lgkmcnt(0)
    s_sub_u32 s8, s8, s30
    s_cmpk_ge_u32 s8, 574
    s_cbranch_scc1 .ap_50
    s_waitcnt vmcnt(5)
    s_cmpk_ge_u32 s8, 509
    s_cbranch_scc1 .ap_50
    s_waitcnt vmcnt(3)
    s_bitcmp1_b64 s[14:15], 13
    s_cbranch_scc0 1
    s_waitcnt vmcnt(2)
    s_cmpk_ge_u32 s8, 434
    s_cbranch_scc1 .ap_50
    s_waitcnt vmcnt(1)
.ap_50:
    s_add_u32 s63, s69, 172032
    buffer_load_dwordx4 v[108:111], v1, s[40:43], s63 offen nt
    s_waitcnt vmcnt(3)
    s_add_u32 m0, s100, 32768
    s_add_u32 s56, s101, 294912
    buffer_load_dwordx4 v6, s[48:51], s56 offen nt lds
    s_memrealtime s[8:9]
    s_waitcnt lgkmcnt(0)
    s_sub_u32 s8, s8, s30
    s_cmpk_ge_u32 s8, 620
    s_cbranch_scc1 .ap_51
    s_waitcnt vmcnt(4)
    s_cmpk_ge_u32 s8, 555
    s_cbranch_scc1 .ap_51
    s_waitcnt vmcnt(3)
    s_bitcmp1_b64 s[14:15], 14
    s_cbranch_scc0 1
    s_waitcnt vmcnt(2)
    s_cmpk_ge_u32 s8, 480
    s_cbranch_scc1 .ap_51
    s_waitcnt vmcnt(1)
.ap_51:
    s_add_u32 s63, s69, 180224
    buffer_load_dwordx4 v[136:139], v1, s[40:43], s63 offen nt
    s_memrealtime s[8:9]
    s_waitcnt lgkmcnt(0)
    s_sub_u32 s8, s8, s30
    s_cmpk_ge_u32 s8, 666
    s_cbranch_scc1 .ap_52
    s_waitcnt vmcnt(5)
    s_cmpk_ge_u32 s8, 601
    s_cbranch_scc1 .ap_52
    s_waitcnt vmcnt(3)
    s_bitcmp1_b64 s[14:15], 15
    s_cbranch_scc0 1
    s_waitcnt vmcnt(2)
    s_cmpk_ge_u32 s8, 526
    s_cbranch_scc1 .ap_52
    s_waitcnt vmcnt(1)
.ap_52:
    s_add_u32 s63, s69, 188416
    buffer_load_dwordx4 v[140:143], v1, s[40:43], s63 offen nt
    s_memrealtime s[8:9]
    s_waitcnt lgkmcnt(0)
    s_sub_u32 s8, s8, s30
    s_cmpk_ge_u32 s8, 712
    s_cbranch_scc1 .ap_53
    s_waitcnt vmcnt(5)
    s_cmpk_ge_u32 s8, 647
    s_cbranch_scc1 .ap_53
    s_waitcnt vmcnt(3)
    s_bitcmp1_b64 s[14:15], 16
    s_cbranch_scc0 1
    s_waitcnt vmcnt(2)
    s_cmpk_ge_u32 s8, 572
    s_cbranch_scc1 .ap_53
    s_waitcnt vmcnt(1)
.ap_53:
    s_add_u32 s63, s69, 262144
    buffer_load_dwordx4 v[48:51], v1, s[40:43], s63 offen nt
    s_waitcnt vmcnt(3)
    s_add_u32 m0, s100, 40960
    s_add_u32 s56, s101, 368640
    buffer_load_dwordx4 v6, s[48:51], s56 offen nt lds
    s_memrealtime s[8:9]
    s_waitcnt lgkmcnt(0)
    s_sub_u32 s8, s8, s30
    s_cmpk_ge_u32 s8, 758
    s_cbranch_scc1 .ap_54
    s_waitcnt vmcnt(4)
    s_cmpk_ge_u32 s8, 693
    s_cbranch_scc1 .ap_54
    s_waitcnt vmcnt(3)
    s_bitcmp1_b64 s[14:15], 17
    s_cbranch_scc0 1
    s_waitcnt vmcnt(2)
    s_cmpk_ge_u32 s8, 618
    s_cbranch_scc1 .ap_54
    s_waitcnt vmcnt(1)
.ap_54:
    s_add_u32 s63, s69, 270336
    buffer_load_dwordx4 v[52:55], v1, s[40:43], s63 offen nt
    s_memrealtime s[8:9]
    s_waitcnt lgkmcnt(0)
    s_sub_u32 s8, s8, s30
    s_cmpk_ge_u32 s8, 804
    s_cbranch_scc1 .ap_55
    s_waitcnt vmcnt(5)
    s_cmpk_ge_u32 s8, 739
    s_cbranch_scc1 .ap_55
    s_waitcnt vmcnt(3)
    s_bitcmp1_b64 s[14:15], 18
    s_cbranch_scc0 1
    s_waitcnt vmcnt(2)
    s_cmpk_ge_u32 s8, 664
    s_cbranch_scc1 .ap_55
    s_waitcnt vmcnt(1)
.ap_55:
    s_add_u32 s63, s69, 278528
    buffer_load_dwordx4 v[80:83], v1, s[40:43], s63 offen nt
    v_and_b32 v157, 7, v0
    v_lshlrev_b32 v157, 7, v157
    s_mov_b32 s63, 0x400
    buffer_load_dword v156, v157, s[36:39], s63 offen
    s_memrealtime s[8:9]
    s_waitcnt lgkmcnt(0)
    s_sub_u32 s8, s8, s30
    s_cmpk_ge_u32 s8, 850
    s_cbranch_scc1 .ap_56
    s_waitcnt vmcnt(6)
    s_cmpk_ge_u32 s8, 785
    s_cbranch_scc1 .ap_56
    s_waitcnt vmcnt(4)
    s_bitcmp1_b64 s[14:15], 19
    s_cbranch_scc0 1
    s_waitcnt vmcnt(3)
    s_cmpk_ge_u32 s8, 710
    s_cbranch_scc1 .ap_56
    s_waitcnt vmcnt(2)
.ap_56:
    s_add_u32 s63, s69, 286720
    buffer_load_dwordx4 v[84:87], v1, s[40:43], s63 offen nt
    s_waitcnt vmcnt(4)
    s_add_u32 m0, s100, 49152
    s_add_u32 s56, s101, 442368
    buffer_load_dwordx4 v6, s[48:51], s56 offen nt lds
    s_memrealtime s[8:9]
    s_waitcnt lgkmcnt(0)
    s_sub_u32 s8, s8, s30
    s_cmpk_ge_u32 s8, 895
    s_cbranch_scc1 .ap_57
    s_waitcnt vmcnt(5)
    s_cmpk_ge_u32 s8, 830
    s_cbranch_scc1 .ap_57
    s_waitcnt vmcnt(4)
    s_bitcmp1_b64 s[14:15], 20
    s_cbranch_scc0 1
    s_waitcnt vmcnt(3)
    s_cmpk_ge_u32 s8, 755
    s_cbranch_scc1 .ap_57
    s_waitcnt vmcnt(1)
.ap_57:
    s_add_u32 s63, s69, 294912
    buffer_load_dwordx4 v[112:115], v1, s[40:43], s63 offen nt
    s_memrealtime s[8:9]
    s_waitcnt lgkmcnt(0)
    s_sub_u32 s8, s8, s30
    s_cmpk_ge_u32 s8, 940
    s_cbranch_scc1 .ap_58
    s_waitcnt vmcnt(6)
    s_cmpk_ge_u32 s8, 875
    s_cbranch_scc1 .ap_58
    s_waitcnt vmcnt(4)
    s_bitcmp1_b64 s[14:15], 21
    s_cbranch_scc0 1
    s_waitcnt vmcnt(2)
    s_cmpk_ge_u32 s8, 800
    s_cbranch_scc1 .ap_58
    s_waitcnt vmcnt(1)
.ap_58:
    s_add_u32 s63, s69, 303104
    buffer_load_dwordx4 v[116:119], v1, s[40:43], s63 offen nt
    s_memrealtime s[8:9]
    s_waitcnt lgkmcnt(0)
    s_sub_u32 s8, s8, s30
    s_cmpk_ge_u32 s8, 985
    s_cbranch_scc1 .ap_59
    s_waitcnt vmcnt(6)
    s_cmpk_ge_u32 s8, 920
    s_cbranch_scc1 .ap_59
    s_waitcnt vmcnt(3)
    s_bitcmp1_b64 s[14:15], 22
    s_cbranch_scc0 1
    s_waitcnt vmcnt(2)
    s_cmpk_ge_u32 s8, 845
    s_cbranch_scc1 .ap_59
    s_waitcnt vmcnt(1)
.ap_59:
    s_add_u32 s63, s69, 311296
    buffer_load_dwordx4 v[144:147], v1, s[40:43], s63 offen nt
    s_waitcnt vmcnt(5)
    s_sub_u32 s63, s70, 300
    v_subrev_u32 v156, s63, v156
    v_mov_b32 v157, 600
    v_cmp_lt_u32 s[8:9], v156, v157
    v_add_u32_dpp v156, v156, v156 quad_perm:[1,0,3,2] row_mask:0xf bank_mask:0xf
    s_nop 1
    v_add_u32_dpp v156, v156, v156 quad_perm:[2,3,0,1] row_mask:0xf bank_mask:0xf
    s_nop 1
    v_add_u32_dpp v156, v156, v156 row_ror:4 row_mask:0xf bank_mask:0xf
    s_nop 0
    v_readfirstlane_b32 s63, v156
    s_cmp_eq_u64 s[8:9], -1
    s_nop 3
    s_cbranch_scc0 .et_60
    s_lshr_b32 s63, s63, 3
    s_sub_u32 s63, s63, 300
    s_add_u32 s30, s30, s63
.et_60:
    s_waitcnt vmcnt(3)
    s_add_u32 m0, s100, 57344
    s_add_u32 s56, s101, 516096
    buffer_load_dwordx4 v6, s[48:51], s56 offen nt lds
    s_memrealtime s[8:9]
    s_waitcnt lgkmcnt(0)
    s_sub_u32 s8, s8, s30
    s_cmpk_ge_u32 s8, 1030
    s_cbranch_scc1 .ap_61
    s_waitcnt vmcnt(4)
    s_cmpk_ge_u32 s8, 965
    s_cbranch_scc1 .ap_61
    s_waitcnt vmcnt(3)
    s_bitcmp1_b64 s[14:15], 23
    s_cbranch_scc0 1
    s_waitcnt vmcnt(2)
    s_cmpk_ge_u32 s8, 890
    s_cbranch_scc1 .ap_61
    s_waitcnt vmcnt(1)
.ap_61:
    s_add_u32 s63, s69, 319488
    buffer_load_dwordx4 v[148:151], v1, s[40:43], s63 offen nt
    s_memrealtime s[8:9]
    s_waitcnt lgkmcnt(0)
    s_sub_u32 s8, s8, s30
    s_cmpk_ge_u32 s8, 1075
    s_cbranch_scc1 .ap_62
    s_waitcnt vmcnt(5)
    s_cmpk_ge_u32 s8, 1010
    s_cbranch_scc1 .ap_62
    s_waitcnt vmcnt(3)
    s_bitcmp1_b64 s[14:15], 24
    s_cbranch_scc0 1
    s_waitcnt vmcnt(2)
    s_cmpk_ge_u32 s8, 935
    s_cbranch_scc1 .ap_62
    s_waitcnt vmcnt(1)
.ap_62:
    s_add_u32 s63, s69, 393216
    buffer_load_dwordx4 v[56:59], v1, s[40:43], s63 offen nt
    s_memrealtime s[8:9]
    s_waitcnt lgkmcnt(0)
    s_sub_u32 s8, s8, s30
    s_cmpk_ge_u32 s8, 1120
    s_cbranch_scc1 .ap_63
    s_waitcnt vmcnt(5)
    s_cmpk_ge_u32 s8, 1055
    s_cbranch_scc1 .ap_63
    s_waitcnt vmcnt(3)
    s_bitcmp1_b64 s[14:15], 25
    s_cbranch_scc0 1
    s_waitcnt vmcnt(2)
    s_cmpk_ge_u32 s8, 980
    s_cbranch_scc1 .ap_63
    s_waitcnt vmcnt(1)
.ap_63:
    s_add_u32 s63, s69, 401408
    buffer_load_dwordx4 v[60:63], v1, s[40:43], s63 offen nt
.Latt_ar:
    v_and_b32 v8, 1, v0
    v_lshlrev_b32 v8, 8, v8
    v_and_b32 v9, 0x3c, v0
    v_lshl_add_u32 v9, v9, 2, v8
    v_lshlrev_b32 v7, 1, v9
    v_and_b32 v9, 0x3c, v0
    v_lshrrev_b32 v8, 4, v8
    v_and_b32 v9, 2, v0
    v_lshl_add_u32 v9, v9, 6, v8
    s_lshl_b32 s58, s66, 14
    s_lshl_b32 s59, s67, 10
    s_add_u32 s58, s58, s59
    s_add_u32 s58, s58, 0x40000
    s_lshl4_add_u32 s59, s66, s67
    s_lshl_b32 s59, s59, 8
    s_add_u32 s59, s59, 0x200000
    s_memrealtime s[8:9]
    s_waitcnt vmcnt(8)
    s_waitcnt lgkmcnt(0)
    s_sub_u32 s8, s8, s30
    s_cmpk_ge_u32 s8, 1147
    s_cbranch_scc1 .ap_64
    s_waitcnt vmcnt(5)
    s_cmpk_ge_u32 s8, 1082
    s_cbranch_scc1 .ap_64
    s_waitcnt vmcnt(3)
    s_bitcmp1_b64 s[14:15], 26
    s_cbranch_scc0 1
    s_waitcnt vmcnt(2)
    s_cmpk_ge_u32 s8, 1007
    s_cbranch_scc1 .ap_64
    s_waitcnt vmcnt(1)
.ap_64:
    s_add_u32 s63, s69, 409600
    buffer_load_dwordx4 v[88:91], v1, s[40:43], s63 offen nt
    s_memrealtime s[8:9]
    s_waitcnt vmcnt(8)
    s_waitcnt lgkmcnt(0)
    s_sub_u32 s8, s8, s30
    s_cmpk_ge_u32 s8, 1174
    s_cbranch_scc1 .ap_65
    s_waitcnt vmcnt(5)
    s_cmpk_ge_u32 s8, 1109
    s_cbranch_scc1 .ap_65
    s_waitcnt vmcnt(3)
    s_bitcmp1_b64 s[14:15], 27
    s_cbranch_scc0 1
    s_waitcnt vmcnt(2)
    s_cmpk_ge_u32 s8, 1034
    s_cbranch_scc1 .ap_65
    s_waitcnt vmcnt(1)
.ap_65:
    s_add_u32 s63, s69, 417792
    buffer_load_dwordx4 v[92:95], v1, s[40:43], s63 offen nt
    s_memrealtime s[8:9]
    s_waitcnt vmcnt(8)
    s_waitcnt lgkmcnt(0)
    s_sub_u32 s8, s8, s30
    s_cmpk_ge_u32 s8, 1201
    s_cbranch_scc1 .ap_66
    s_waitcnt vmcnt(5)
    s_cmpk_ge_u32 s8, 1136
    s_cbranch_scc1 .ap_66
    s_waitcnt vmcnt(3)
    s_bitcmp1_b64 s[14:15], 28
    s_cbranch_scc0 1
    s_waitcnt vmcnt(2)
    s_cmpk_ge_u32 s8, 1061
    s_cbranch_scc1 .ap_66
    s_waitcnt vmcnt(1)
.ap_66:
    s_add_u32 s63, s69, 425984
    buffer_load_dwordx4 v[120:123], v1, s[40:43], s63 offen nt
    s_memrealtime s[8:9]
    s_waitcnt vmcnt(8)
    s_waitcnt lgkmcnt(0)
    s_sub_u32 s8, s8, s30
    s_cmpk_ge_u32 s8, 1228
    s_cbranch_scc1 .ap_67
    s_waitcnt vmcnt(5)
    s_cmpk_ge_u32 s8, 1163
    s_cbranch_scc1 .ap_67
    s_waitcnt vmcnt(3)
    s_bitcmp1_b64 s[14:15], 29
    s_cbranch_scc0 1
    s_waitcnt vmcnt(2)
    s_cmpk_ge_u32 s8, 1088
    s_cbranch_scc1 .ap_67
    s_waitcnt vmcnt(1)
.ap_67:
    s_add_u32 s63, s69, 434176
    buffer_load_dwordx4 v[124:127], v1, s[40:43], s63 offen nt
    s_memrealtime s[8:9]
    s_waitcnt vmcnt(8)
    s_waitcnt lgkmcnt(0)
    s_sub_u32 s8, s8, s30
    s_cmpk_ge_u32 s8, 1255
    s_cbranch_scc1 .ap_68
    s_waitcnt vmcnt(5)
    s_cmpk_ge_u32 s8, 1190
    s_cbranch_scc1 .ap_68
    s_waitcnt vmcnt(3)
    s_bitcmp1_b64 s[14:15], 30
    s_cbranch_scc0 1
    s_waitcnt vmcnt(2)
    s_cmpk_ge_u32 s8, 1115
    s_cbranch_scc1 .ap_68
    s_waitcnt vmcnt(1)
.ap_68:
    s_add_u32 s63, s69, 442368
    buffer_load_dwordx4 v[152:155], v1, s[40:43], s63 offen nt
    s_memrealtime s[8:9]
    s_waitcnt vmcnt(8)
    s_waitcnt lgkmcnt(0)
    s_sub_u32 s8, s8, s30
    s_cmpk_ge_u32 s8, 1282
    s_cbranch_scc1 .ap_69
    s_waitcnt vmcnt(5)
    s_cmpk_ge_u32 s8, 1217
    s_cbranch_scc1 .ap_69
    s_waitcnt vmcnt(3)
    s_bitcmp1_b64 s[14:15], 31
    s_cbranch_scc0 1
    s_waitcnt vmcnt(2)
    s_cmpk_ge_u32 s8, 1142
    s_cbranch_scc1 .ap_69
    s_waitcnt vmcnt(1)
.ap_69:
    s_add_u32 s63, s69, 450560
    buffer_load_dwordx4 v[156:159], v1, s[40:43], s63 offen nt
    buffer_load_dwordx4 v[16:19], v7, s[36:39], s58 offen offset:0 sc1
    buffer_load_dwordx4 v[20:23], v7, s[36:39], s58 offen offset:16 sc1
    s_memrealtime s[8:9]
    s_waitcnt vmcnt(8)
    s_waitcnt lgkmcnt(0)
    s_sub_u32 s8, s8, s30
    s_cmpk_ge_u32 s8, 1309
    s_cbranch_scc1 .ap_70
    s_waitcnt vmcnt(5)
    s_cmpk_ge_u32 s8, 1244
    s_cbranch_scc1 .ap_70
    s_waitcnt vmcnt(3)
    s_bitcmp1_b64 s[14:15], 32
    s_cbranch_scc0 1
    s_waitcnt vmcnt(2)
    s_cmpk_ge_u32 s8, 1169
    s_cbranch_scc1 .ap_70
    s_waitcnt vmcnt(1)
.ap_70:
    s_add_u32 s63, s69, 0
    buffer_load_dwordx4 v[160:163], v2, s[44:47], s63 offen nt
    s_memrealtime s[8:9]
    s_waitcnt vmcnt(8)
    s_waitcnt lgkmcnt(0)
    s_sub_u32 s8, s8, s30
    s_cmpk_ge_u32 s8, 1336
    s_cbranch_scc1 .ap_71
    s_waitcnt vmcnt(5)
    s_cmpk_ge_u32 s8, 1271
    s_cbranch_scc1 .ap_71
    s_waitcnt vmcnt(3)
    s_bitcmp1_b64 s[14:15], 33
    s_cbranch_scc0 1
    s_waitcnt vmcnt(2)
    s_cmpk_ge_u32 s8, 1196
    s_cbranch_scc1 .ap_71
    s_waitcnt vmcnt(1)
.ap_71:
    s_add_u32 s63, s69, 8192
    buffer_load_dwordx4 v[164:167], v2, s[44:47], s63 offen nt
    s_memrealtime s[8:9]
    s_waitcnt vmcnt(8)
    s_waitcnt lgkmcnt(0)
    s_sub_u32 s8, s8, s30
    s_cmpk_ge_u32 s8, 1363
    s_cbranch_scc1 .ap_72
    s_waitcnt vmcnt(5)
    s_cmpk_ge_u32 s8, 1298
    s_cbranch_scc1 .ap_72
    s_waitcnt vmcnt(3)
    s_bitcmp1_b64 s[14:15], 34
    s_cbranch_scc0 1
    s_waitcnt vmcnt(2)
    s_cmpk_ge_u32 s8, 1223
    s_cbranch_scc1 .ap_72
    s_waitcnt vmcnt(1)
.ap_72:
    s_add_u32 s63, s69, 16384
    buffer_load_dwordx4 v[168:171], v2, s[44:47], s63 offen nt
    s_waitcnt vmcnt(3)
    s_branch .gpc_74
.gp_73:
    buffer_load_dwordx4 v[16:19], v7, s[36:39], s58 offen offset:0 sc1
    buffer_load_dwordx4 v[20:23], v7, s[36:39], s58 offen offset:16 sc1
    s_waitcnt vmcnt(0)
.gpc_74:
    v_min_u32 v10, v17, v19
    v_max_u32 v11, v17, v19
    v_min3_u32 v10, v10, v21, v23
    v_max3_u32 v11, v11, v21, v23
    v_cmp_eq_u32 vcc, s34, v10
    v_cmp_eq_u32 s[56:57], s34, v11
    s_and_b64 vcc, vcc, s[56:57]
    s_cmp_eq_u64 vcc, exec
    s_nop 2
    s_cbranch_scc1 .gpd_75
    s_sub_u32 s35, s35, 1
    s_cbranch_scc1 .Lexit
    s_sleep 1
    s_branch .gp_73
.gpd_75:
    s_mov_b32 vcc_lo, 0xcccccccc
    s_mov_b32 vcc_hi, 0xcccccccc
    v_cndmask_b32_e64 v24, v16, 0, vcc
    v_cndmask_b32_e64 v25, v18, 0, vcc
    v_cndmask_b32_e64 v26, v20, 0, vcc
    v_cndmask_b32_e64 v27, v22, 0, vcc
    v_cndmask_b32_e32 v28, 0, v16, vcc
    v_cndmask_b32_e32 v29, 0, v18, vcc
    v_cndmask_b32_e32 v30, 0, v20, vcc
    v_cndmask_b32_e32 v31, 0, v22, vcc
    v_mfma_f32_16x16x32_bf16 v[16:19], v[32:35], v[24:27], 0
    v_mfma_f32_16x16x32_bf16 v[32:35], v[40:43], v[24:27], 0
    v_mfma_f32_16x16x32_bf16 v[16:19], v[36:39], v[28:31], v[16:19]
    v_mfma_f32_16x16x32_bf16 v[40:43], v[48:51], v[24:27], 0
    v_mfma_f32_16x16x32_bf16 v[32:35], v[44:47], v[28:31], v[32:35]
    v_mfma_f32_16x16x32_bf16 v[48:51], v[56:59], v[24:27], 0
    v_mfma_f32_16x16x32_bf16 v[40:43], v[52:55], v[28:31], v[40:43]
    v_mfma_f32_16x16x32_bf16 v[56:59], v[64:67], v[24:27], 0
    v_mfma_f32_16x16x32_bf16 v[48:51], v[60:63], v[28:31], v[48:51]
    s_nop 1
    v_add_f32_dpp v10, v17, v16 row_ror:12 row_mask:0xf bank_mask:0x1
    s_memrealtime s[8:9]
    s_waitcnt lgkmcnt(0)
    s_sub_u32 s8, s8, s30
    s_cmpk_ge_u32 s8, 1390
    s_nop 0
    s_cbranch_scc1 .ap_76
    s_waitcnt vmcnt(3)
    s_cmpk_ge_u32 s8, 1325
    s_cbranch_scc1 .ap_76
    s_waitcnt vmcnt(3)
    s_bitcmp1_b64 s[14:15], 35
    s_cbranch_scc0 1
    s_waitcnt vmcnt(2)
    s_cmpk_ge_u32 s8, 1250
    s_cbranch_scc1 .ap_76
    s_waitcnt vmcnt(1)
.ap_76:
    s_add_u32 s63, s69, 24576
    buffer_load_dwordx4 v[172:175], v2, s[44:47], s63 offen nt
    v_mfma_f32_16x16x32_bf16 v[64:67], v[72:75], v[24:27], 0
    v_mfma_f32_16x16x32_bf16 v[56:59], v[68:71], v[28:31], v[56:59]
    v_add_f32_dpp v11, v33, v32 row_ror:12 row_mask:0xf bank_mask:0x1
    v_add_f32_dpp v10, v18, v10 row_ror:8 row_mask:0xf bank_mask:0x1
    v_mfma_f32_16x16x32_bf16 v[72:75], v[80:83], v[24:27], 0
    v_mfma_f32_16x16x32_bf16 v[64:67], v[76:79], v[28:31], v[64:67]
    v_add_f32_dpp v12, v41, v40 row_ror:12 row_mask:0xf bank_mask:0x1
    v_add_f32_dpp v11, v34, v11 row_ror:8 row_mask:0xf bank_mask:0x1
    v_add_f32_dpp v10, v19, v10 row_ror:4 row_mask:0xf bank_mask:0x1
    v_mfma_f32_16x16x32_bf16 v[80:83], v[88:91], v[24:27], 0
    v_mfma_f32_16x16x32_bf16 v[72:75], v[84:87], v[28:31], v[72:75]
    v_add_f32_dpp v13, v49, v48 row_ror:12 row_mask:0xf bank_mask:0x1
    v_add_f32_dpp v12, v42, v12 row_ror:8 row_mask:0xf bank_mask:0x1
    v_add_f32_dpp v11, v35, v11 row_ror:4 row_mask:0xf bank_mask:0x1
    v_mfma_f32_16x16x32_bf16 v[88:91], v[96:99], v[24:27], 0
    v_mfma_f32_16x16x32_bf16 v[80:83], v[92:95], v[28:31], v[80:83]
    v_add_f32_dpp v10, v58, v57 row_ror:12 row_mask:0xf bank_mask:0x2
    v_add_f32_dpp v13, v50, v13 row_ror:8 row_mask:0xf bank_mask:0x1
    v_add_f32_dpp v12, v43, v12 row_ror:4 row_mask:0xf bank_mask:0x1
    s_memrealtime s[8:9]
    s_waitcnt lgkmcnt(0)
    s_sub_u32 s8, s8, s30
    s_cmpk_ge_u32 s8, 1417
    s_nop 0
    s_cbranch_scc1 .ap_77
    s_waitcnt vmcnt(4)
    s_cmpk_ge_u32 s8, 1352
    s_cbranch_scc1 .ap_77
    s_waitcnt vmcnt(3)
    s_bitcmp1_b64 s[14:15], 36
    s_cbranch_scc0 1
    s_waitcnt vmcnt(2)
    s_cmpk_ge_u32 s8, 1277
    s_cbranch_scc1 .ap_77
    s_waitcnt vmcnt(1)
.ap_77:
    s_add_u32 s63, s69, 32768
    buffer_load_dwordx4 v[176:179], v2, s[44:47], s63 offen nt
    v_mfma_f32_16x16x32_bf16 v[96:99], v[104:107], v[24:27], 0
    v_mfma_f32_16x16x32_bf16 v[88:91], v[100:103], v[28:31], v[88:91]
    v_add_f32_dpp v11, v66, v65 row_ror:12 row_mask:0xf bank_mask:0x2
    v_add_f32_dpp v10, v59, v10 row_ror:8 row_mask:0xf bank_mask:0x2
    v_add_f32_dpp v13, v51, v13 row_ror:4 row_mask:0xf bank_mask:0x1
    v_mfma_f32_16x16x32_bf16 v[104:107], v[112:115], v[24:27], 0
    v_mfma_f32_16x16x32_bf16 v[96:99], v[108:111], v[28:31], v[96:99]
    v_add_f32_dpp v12, v74, v73 row_ror:12 row_mask:0xf bank_mask:0x2
    v_add_f32_dpp v11, v67, v11 row_ror:8 row_mask:0xf bank_mask:0x2
    v_add_f32_dpp v10, v56, v10 row_ror:4 row_mask:0xf bank_mask:0x2
    v_mfma_f32_16x16x32_bf16 v[112:115], v[120:123], v[24:27], 0
    v_mfma_f32_16x16x32_bf16 v[104:107], v[116:119], v[28:31], v[104:107]
    v_add_f32_dpp v13, v82, v81 row_ror:12 row_mask:0xf bank_mask:0x2
    v_add_f32_dpp v12, v75, v12 row_ror:8 row_mask:0xf bank_mask:0x2
    v_add_f32_dpp v11, v64, v11 row_ror:4 row_mask:0xf bank_mask:0x2
    v_mfma_f32_16x16x32_bf16 v[120:123], v[128:131], v[24:27], 0
    v_mfma_f32_16x16x32_bf16 v[112:115], v[124:127], v[28:31], v[112:115]
    v_add_f32_dpp v10, v91, v90 row_ror:12 row_mask:0xf bank_mask:0x4
    v_add_f32_dpp v13, v83, v13 row_ror:8 row_mask:0xf bank_mask:0x2
    v_add_f32_dpp v12, v72, v12 row_ror:4 row_mask:0xf bank_mask:0x2
    s_memrealtime s[8:9]
    s_waitcnt lgkmcnt(0)
    s_sub_u32 s8, s8, s30
    s_cmpk_ge_u32 s8, 1444
    s_nop 0
    s_cbranch_scc1 .ap_78
    s_waitcnt vmcnt(5)
    s_cmpk_ge_u32 s8, 1379
    s_cbranch_scc1 .ap_78
    s_waitcnt vmcnt(3)
    s_bitcmp1_b64 s[14:15], 37
    s_cbranch_scc0 1
    s_waitcnt vmcnt(2)
    s_cmpk_ge_u32 s8, 1304
    s_cbranch_scc1 .ap_78
    s_waitcnt vmcnt(1)
.ap_78:
    s_add_u32 s63, s69, 40960
    buffer_load_dwordx4 v[180:183], v2, s[44:47], s63 offen nt
    v_mfma_f32_16x16x32_bf16 v[128:131], v[136:139], v[24:27], 0
    v_mfma_f32_16x16x32_bf16 v[120:123], v[132:135], v[28:31], v[120:123]
    v_add_f32_dpp v11, v99, v98 row_ror:12 row_mask:0xf bank_mask:0x4
    v_add_f32_dpp v10, v88, v10 row_ror:8 row_mask:0xf bank_mask:0x4
    v_add_f32_dpp v13, v80, v13 row_ror:4 row_mask:0xf bank_mask:0x2
    v_mfma_f32_16x16x32_bf16 v[136:139], v[144:147], v[24:27], 0
    v_mfma_f32_16x16x32_bf16 v[128:131], v[140:143], v[28:31], v[128:131]
    v_add_f32_dpp v12, v107, v106 row_ror:12 row_mask:0xf bank_mask:0x4
    v_add_f32_dpp v11, v96, v11 row_ror:8 row_mask:0xf bank_mask:0x4
    v_add_f32_dpp v10, v89, v10 row_ror:4 row_mask:0xf bank_mask:0x4
    v_mfma_f32_16x16x32_bf16 v[144:147], v[152:155], v[24:27], 0
    v_mfma_f32_16x16x32_bf16 v[136:139], v[148:151], v[28:31], v[136:139]
    v_add_f32_dpp v13, v115, v114 row_ror:12 row_mask:0xf bank_mask:0x4
    v_add_f32_dpp v12, v104, v12 row_ror:8 row_mask:0xf bank_mask:0x4
    v_add_f32_dpp v11, v97, v11 row_ror:4 row_mask:0xf bank_mask:0x4
    v_mfma_f32_16x16x32_bf16 v[144:147], v[156:159], v[28:31], v[144:147]
    v_add_f32_dpp v10, v120, v123 row_ror:12 row_mask:0xf bank_mask:0x8
    v_add_f32_dpp v13, v112, v13 row_ror:8 row_mask:0xf bank_mask:0x4
    v_add_f32_dpp v12, v105, v12 row_ror:4 row_mask:0xf bank_mask:0x4
    s_memrealtime s[8:9]
    s_waitcnt lgkmcnt(0)
    s_sub_u32 s8, s8, s30
    s_cmpk_ge_u32 s8, 1471
    s_nop 0
    s_cbranch_scc1 .ap_79
    s_waitcnt vmcnt(5)
    s_cmpk_ge_u32 s8, 1406
    s_cbranch_scc1 .ap_79
    s_waitcnt vmcnt(3)
    s_bitcmp1_b64 s[14:15], 38
    s_cbranch_scc0 1
    s_waitcnt vmcnt(2)
    s_cmpk_ge_u32 s8, 1331
    s_cbranch_scc1 .ap_79
    s_waitcnt vmcnt(1)
.ap_79:
    s_add_u32 s63, s69, 49152
    buffer_load_dwordx4 v[184:187], v2, s[44:47], s63 offen nt
    v_add_f32_dpp v11, v128, v131 row_ror:12 row_mask:0xf bank_mask:0x8
    v_add_f32_dpp v10, v121, v10 row_ror:8 row_mask:0xf bank_mask:0x8
    v_add_f32_dpp v13, v113, v13 row_ror:4 row_mask:0xf bank_mask:0x4
    v_add_f32_dpp v12, v136, v139 row_ror:12 row_mask:0xf bank_mask:0x8
    v_add_f32_dpp v11, v129, v11 row_ror:8 row_mask:0xf bank_mask:0x8
    v_add_f32_dpp v10, v122, v10 row_ror:4 row_mask:0xf bank_mask:0x8
    v_add_f32_dpp v13, v144, v147 row_ror:12 row_mask:0xf bank_mask:0x8
    v_add_f32_dpp v12, v137, v12 row_ror:8 row_mask:0xf bank_mask:0x8
    v_add_f32_dpp v11, v130, v11 row_ror:4 row_mask:0xf bank_mask:0x8
    v_add_f32_dpp v13, v145, v13 row_ror:8 row_mask:0xf bank_mask:0x8
    v_add_f32_dpp v12, v138, v12 row_ror:4 row_mask:0xf bank_mask:0x8
    s_memrealtime s[8:9]
    s_waitcnt lgkmcnt(0)
    s_sub_u32 s8, s8, s30
    s_cmpk_ge_u32 s8, 1498
    s_cbranch_scc1 .ap_80
    s_waitcnt vmcnt(5)
    s_cmpk_ge_u32 s8, 1433
    s_cbranch_scc1 .ap_80
    s_waitcnt vmcnt(3)
    s_bitcmp1_b64 s[14:15], 39
    s_cbranch_scc0 1
    s_waitcnt vmcnt(2)
    s_cmpk_ge_u32 s8, 1358
    s_cbranch_scc1 .ap_80
    s_waitcnt vmcnt(1)
.ap_80:
    s_add_u32 s63, s69, 57344
    buffer_load_dwordx4 v[188:191], v2, s[44:47], s63 offen nt
    v_add_f32_dpp v13, v146, v13 row_ror:4 row_mask:0xf bank_mask:0x8
    s_mov_b32 s60, 0x3db504f3
    s_mov_b32 s61, 0x3db504f3
    v_cvt_pk_bf16_f32 v10, 0, v10
    v_cvt_pk_bf16_f32 v11, 0, v11
    v_cvt_pk_bf16_f32 v12, 0, v12
    v_cvt_pk_bf16_f32 v13, 0, v13
    v_pk_mul_f32 v[10:11], v[10:11], s[60:61]
    v_pk_mul_f32 v[12:13], v[12:13], s[60:61]
    v_cvt_pk_bf16_f32 v10, 0, v10
    v_cvt_pk_bf16_f32 v11, 0, v11
    v_cvt_pk_bf16_f32 v12, 0, v12
    v_cvt_pk_bf16_f32 v13, 0, v13
    v_max_f32 v14, v10, v11
    v_max3_f32 v14, v14, v12, v13
    s_mov_b32 s60, 0x3fb8aa3b
    v_mov_b32 v22, s34
    v_mov_b32 v23, s34
    v_max_f32_dpp v14, v14, v14 quad_perm:[2,3,0,1] row_mask:0xf bank_mask:0xf
    s_nop 1
    v_max_f32_dpp v14, v14, v14 row_ror:4 row_mask:0xf bank_mask:0xf
    s_nop 1
    v_max_f32_dpp v14, v14, v14 row_ror:8 row_mask:0xf bank_mask:0xf
    v_mov_b32 v15, v14
    s_nop 1
    v_permlane16_swap_b32 v15, v14
    v_max_f32 v14, v15, v14
    v_mov_b32 v15, v14
    s_nop 1
    v_permlane32_swap_b32 v15, v14
    v_max_f32 v14, v15, v14
    v_mul_f32 v15, 0xbfb8aa3b, v14
    v_fma_f32 v10, v10, s60, v15
    v_fma_f32 v11, v11, s60, v15
    v_fma_f32 v12, v12, s60, v15
    v_fma_f32 v13, v13, s60, v15
    v_exp_f32 v10, v10
    v_exp_f32 v11, v11
    v_exp_f32 v12, v12
    v_exp_f32 v13, v13
    v_mov_b32 v20, v14
    v_pk_add_f32 v[16:17], v[10:11], v[12:13]
    v_add_f32 v21, v16, v17
    s_lshl3_add_u32 s60, s68, s3
    s_lshl_b32 s60, s60, 5
    s_add_u32 s60, s60, s59
    v_add_f32_dpp v21, v21, v21 quad_perm:[2,3,0,1] row_mask:0xf bank_mask:0xf
    s_nop 1
    v_add_f32_dpp v21, v21, v21 row_ror:4 row_mask:0xf bank_mask:0xf
    s_nop 1
    v_add_f32_dpp v21, v21, v21 row_ror:8 row_mask:0xf bank_mask:0xf
    v_mov_b32 v15, v21
    s_nop 1
    v_permlane16_swap_b32 v15, v21
    v_add_f32 v21, v15, v21
    v_mov_b32 v15, v21
    s_nop 1
    v_permlane32_swap_b32 v15, v21
    v_add_f32 v21, v15, v21
    s_lshl_b32 s60, s3, 4
    s_add_u32 s60, s60, 159104
    v_add_u32 v16, s60, v3
    v_mov_b32 v17, 159232
    v_mov_b32 v18, 1
    s_mov_b64 exec, 3
    ds_write_b64 v16, v[20:21]
    s_mov_b64 exec, 1
    s_waitcnt lgkmcnt(0)
    ds_add_rtn_u32 v18, v17, v18
    s_mov_b64 exec, -1
    v_and_b32 v16, 0x78, v3
    v_add_u32 v16, 159104, v16
    s_waitcnt lgkmcnt(0)
    v_readfirstlane_b32 s60, v18
    s_cmp_lg_u32 s60, 7
    s_nop 3
    s_cbranch_scc1 .ml_81
    ds_read_b64 v[18:19], v16
    s_lshl_b32 s60, s68, 7
    s_add_u32 s60, s60, s59
    s_waitcnt lgkmcnt(0)
    v_mov_b32 v20, v18
    s_nop 1
    v_max_f32_dpp v20, v20, v20 quad_perm:[2,3,0,1] row_mask:0xf bank_mask:0xf
    s_nop 1
    v_max_f32_dpp v20, v20, v20 row_ror:4 row_mask:0xf bank_mask:0xf
    s_nop 1
    v_max_f32_dpp v20, v20, v20 row_ror:8 row_mask:0xf bank_mask:0xf
    v_sub_f32 v18, v18, v20
    v_mul_f32 v18, 0x3fb8aa3b, v18
    v_exp_f32 v18, v18
    s_nop 0
    v_mul_f32 v21, v18, v19
    s_nop 1
    v_add_f32_dpp v21, v21, v21 quad_perm:[2,3,0,1] row_mask:0xf bank_mask:0xf
    s_nop 1
    v_add_f32_dpp v21, v21, v21 row_ror:4 row_mask:0xf bank_mask:0xf
    s_nop 1
    v_add_f32_dpp v21, v21, v21 row_ror:8 row_mask:0xf bank_mask:0xf
    s_mov_b64 exec, 0xff
    buffer_store_dwordx4 v[20:23], v2, s[36:39], s60 offen sc1
    s_mov_b64 exec, -1
.ml_81:
    s_memrealtime s[8:9]
    s_waitcnt lgkmcnt(0)
    s_sub_u32 s8, s8, s30
    s_cmpk_ge_u32 s8, 1525
    s_cbranch_scc1 .ap_82
    s_waitcnt vmcnt(5)
    s_cmpk_ge_u32 s8, 1460
    s_cbranch_scc1 .ap_82
    s_waitcnt vmcnt(3)
    s_bitcmp1_b64 s[14:15], 40
    s_cbranch_scc0 1
    s_waitcnt vmcnt(2)
    s_cmpk_ge_u32 s8, 1385
    s_cbranch_scc1 .ap_82
    s_waitcnt vmcnt(1)
.ap_82:
    s_add_u32 s63, s69, 131072
    buffer_load_dwordx4 v[192:195], v2, s[44:47], s63 offen nt
    s_memrealtime s[8:9]
    s_waitcnt vmcnt(8)
    s_waitcnt lgkmcnt(0)
    s_sub_u32 s8, s8, s30
    s_cmpk_ge_u32 s8, 1552
    s_cbranch_scc1 .ap_83
    s_waitcnt vmcnt(5)
    s_cmpk_ge_u32 s8, 1487
    s_cbranch_scc1 .ap_83
    s_waitcnt vmcnt(3)
    s_bitcmp1_b64 s[14:15], 41
    s_cbranch_scc0 1
    s_waitcnt vmcnt(2)
    s_cmpk_ge_u32 s8, 1412
    s_cbranch_scc1 .ap_83
    s_waitcnt vmcnt(1)
.ap_83:
    s_add_u32 s63, s69, 139264
    buffer_load_dwordx4 v[196:199], v2, s[44:47], s63 offen nt
    s_memrealtime s[8:9]
    s_waitcnt vmcnt(8)
    s_waitcnt lgkmcnt(0)
    s_sub_u32 s8, s8, s30
    s_cmpk_ge_u32 s8, 1579
    s_cbranch_scc1 .ap_84
    s_waitcnt vmcnt(5)
    s_cmpk_ge_u32 s8, 1514
    s_cbranch_scc1 .ap_84
    s_waitcnt vmcnt(3)
    s_bitcmp1_b64 s[14:15], 42
    s_cbranch_scc0 1
    s_waitcnt vmcnt(2)
    s_cmpk_ge_u32 s8, 1439
    s_cbranch_scc1 .ap_84
    s_waitcnt vmcnt(1)
.ap_84:
    s_add_u32 s63, s69, 147456
    buffer_load_dwordx4 v[200:203], v2, s[44:47], s63 offen nt
    s_memrealtime s[8:9]
    s_waitcnt vmcnt(8)
    s_waitcnt lgkmcnt(0)
    s_sub_u32 s8, s8, s30
    s_cmpk_ge_u32 s8, 1606
    s_cbranch_scc1 .ap_85
    s_waitcnt vmcnt(5)
    s_cmpk_ge_u32 s8, 1541
    s_cbranch_scc1 .ap_85
    s_waitcnt vmcnt(3)
    s_bitcmp1_b64 s[14:15], 43
    s_cbranch_scc0 1
    s_waitcnt vmcnt(2)
    s_cmpk_ge_u32 s8, 1466
    s_cbranch_scc1 .ap_85
    s_waitcnt vmcnt(1)
.ap_85:
    s_add_u32 s63, s69, 155648
    buffer_load_dwordx4 v[204:207], v2, s[44:47], s63 offen nt
    s_memrealtime s[8:9]
    s_waitcnt vmcnt(8)
    s_waitcnt lgkmcnt(0)
    s_sub_u32 s8, s8, s30
    s_cmpk_ge_u32 s8, 1633
    s_cbranch_scc1 .ap_86
    s_waitcnt vmcnt(5)
    s_cmpk_ge_u32 s8, 1568
    s_cbranch_scc1 .ap_86
    s_waitcnt vmcnt(3)
    s_bitcmp1_b64 s[14:15], 44
    s_cbranch_scc0 1
    s_waitcnt vmcnt(2)
    s_cmpk_ge_u32 s8, 1493
    s_cbranch_scc1 .ap_86
    s_waitcnt vmcnt(1)
.ap_86:
    s_add_u32 s63, s69, 163840
    buffer_load_dwordx4 v[208:211], v2, s[44:47], s63 offen nt
    v_and_b32 v16, 15, v0
    v_lshrrev_b32 v17, 4, v0
    v_lshl_add_u32 v16, v16, 2, v17
    v_lshlrev_b32 v31, 1, v16
    s_lshl_b32 s56, s65, 7
    v_add_u32 v31, s56, v31
    v_and_b32 v6, -4, v31
    v_lshlrev_b32 v6, 1, v6
    s_mul_i32 s56, s3, 1152
    s_mov_b32 s52, s4
    s_and_b32 s53, s5, 0xffff
    s_mov_b32 s54, 0x2400
    s_mov_b32 s55, 0x00020000
    buffer_load_ushort v29, v31, s[52:55], s56 offen
    s_mul_i32 s101, s3, 2304
    s_add_u32 s101, s101, 0x15000
    s_add_u32 s99, s101, 36864
    s_add_u32 s100, s101, 73728
    s_add_u32 s33, s101, 110592
    buffer_load_dwordx2 v[72:73], v6, s[36:39], s101 offen offset:0
    s_cmp_lg_u32 s3, s64
    s_cbranch_scc1 .rin_87
    buffer_load_dwordx4 v[32:35], v2, s[36:39], s99 offen offset:0
    buffer_load_dwordx4 v[40:43], v2, s[36:39], s99 offen offset:1024
    buffer_load_dwordx2 v[48:49], v5, s[36:39], s99 offen offset:0
    buffer_load_dwordx4 v[56:59], v2, s[36:39], s100 offen offset:0
    buffer_load_dwordx4 v[64:67], v2, s[36:39], s100 offen offset:1024
    buffer_load_dwordx2 v[50:51], v5, s[36:39], s100 offen offset:0
    buffer_load_dwordx2 v[74:75], v6, s[36:39], s99 offen offset:0
    buffer_load_dwordx2 v[80:81], v6, s[36:39], s100 offen offset:0
    buffer_load_dwordx2 v[82:83], v6, s[36:39], s33 offen offset:0
    s_mov_b32 s48, s16
    s_and_b32 s49, s17, 0xffff
    s_mov_b32 s50, 0x480
    s_mov_b32 s51, 0x00020000
    buffer_load_dwordx2 v[88:89], v3, s[48:51], 0 offen
    buffer_load_dwordx2 v[90:91], v3, s[48:51], 0 offen offset:512
    buffer_load_dword v30, v4, s[48:51], 0 offen
    s_mov_b32 s48, s28
    s_and_b32 s49, s29, 0xffff
    s_mov_b32 s50, 0x2400
    s_mov_b32 s51, 0x00020000
    buffer_load_ushort v17, v31, s[48:51], s56 offen nt
.rin_87:
    s_memrealtime s[8:9]
    s_waitcnt vmcnt(10)
    s_waitcnt lgkmcnt(0)
    s_sub_u32 s8, s8, s30
    s_cmpk_ge_u32 s8, 1660
    s_cbranch_scc1 .ap_88
    s_waitcnt vmcnt(7)
    s_cmpk_ge_u32 s8, 1595
    s_cbranch_scc1 .ap_88
    s_waitcnt vmcnt(5)
    s_bitcmp1_b64 s[14:15], 45
    s_cbranch_scc0 1
    s_waitcnt vmcnt(4)
    s_cmpk_ge_u32 s8, 1520
    s_cbranch_scc1 .ap_88
    s_waitcnt vmcnt(3)
.ap_88:
    s_add_u32 s63, s69, 172032
    buffer_load_dwordx4 v[212:215], v2, s[44:47], s63 offen nt
    s_memrealtime s[8:9]
    s_waitcnt vmcnt(10)
    s_waitcnt lgkmcnt(0)
    s_sub_u32 s8, s8, s30
    s_cmpk_ge_u32 s8, 1691
    s_cbranch_scc1 .ap_89
    s_waitcnt vmcnt(7)
    s_cmpk_ge_u32 s8, 1626
    s_cbranch_scc1 .ap_89
    s_waitcnt vmcnt(5)
    s_bitcmp1_b64 s[14:15], 46
    s_cbranch_scc0 1
    s_waitcnt vmcnt(4)
    s_cmpk_ge_u32 s8, 1551
    s_cbranch_scc1 .ap_89
    s_waitcnt vmcnt(3)
.ap_89:
    s_add_u32 s63, s69, 180224
    buffer_load_dwordx4 v[216:219], v2, s[44:47], s63 offen nt
    s_memrealtime s[8:9]
    s_waitcnt vmcnt(10)
    s_waitcnt lgkmcnt(0)
    s_sub_u32 s8, s8, s30
    s_cmpk_ge_u32 s8, 1722
    s_cbranch_scc1 .ap_90
    s_waitcnt vmcnt(7)
    s_cmpk_ge_u32 s8, 1657
    s_cbranch_scc1 .ap_90
    s_waitcnt vmcnt(5)
    s_bitcmp1_b64 s[14:15], 47
    s_cbranch_scc0 1
    s_waitcnt vmcnt(4)
    s_cmpk_ge_u32 s8, 1582
    s_cbranch_scc1 .ap_90
    s_waitcnt vmcnt(1)
.ap_90:
    s_add_u32 s63, s69, 188416
    buffer_load_dwordx4 v[220:223], v2, s[44:47], s63 offen nt
    s_memrealtime s[8:9]
    s_waitcnt vmcnt(10)
    s_waitcnt lgkmcnt(0)
    s_sub_u32 s8, s8, s30
    s_cmpk_ge_u32 s8, 1753
    s_cbranch_scc1 .ap_91
    s_waitcnt vmcnt(7)
    s_cmpk_ge_u32 s8, 1688
    s_cbranch_scc1 .ap_91
    s_waitcnt vmcnt(5)
    s_bitcmp1_b64 s[14:15], 48
    s_cbranch_scc0 1
    s_waitcnt vmcnt(2)
    s_cmpk_ge_u32 s8, 1613
    s_cbranch_scc1 .ap_91
    s_waitcnt vmcnt(1)
.ap_91:
    s_add_u32 s63, s69, 262144
    buffer_load_dwordx4 v[224:227], v2, s[44:47], s63 offen nt
    s_memrealtime s[8:9]
    s_waitcnt vmcnt(10)
    s_waitcnt lgkmcnt(0)
    s_sub_u32 s8, s8, s30
    s_cmpk_ge_u32 s8, 1784
    s_cbranch_scc1 .ap_92
    s_waitcnt vmcnt(7)
    s_cmpk_ge_u32 s8, 1719
    s_cbranch_scc1 .ap_92
    s_waitcnt vmcnt(3)
    s_bitcmp1_b64 s[14:15], 49
    s_cbranch_scc0 1
    s_waitcnt vmcnt(2)
    s_cmpk_ge_u32 s8, 1644
    s_cbranch_scc1 .ap_92
    s_waitcnt vmcnt(1)
.ap_92:
    s_add_u32 s63, s69, 270336
    buffer_load_dwordx4 v[228:231], v2, s[44:47], s63 offen nt
    s_memrealtime s[8:9]
    s_waitcnt vmcnt(10)
    s_waitcnt lgkmcnt(0)
    s_sub_u32 s8, s8, s30
    s_cmpk_ge_u32 s8, 1815
    s_cbranch_scc1 .ap_93
    s_waitcnt vmcnt(7)
    s_cmpk_ge_u32 s8, 1750
    s_cbranch_scc1 .ap_93
    s_waitcnt vmcnt(3)
    s_bitcmp1_b64 s[14:15], 50
    s_cbranch_scc0 1
    s_waitcnt vmcnt(2)
    s_cmpk_ge_u32 s8, 1675
    s_cbranch_scc1 .ap_93
    s_waitcnt vmcnt(1)
.ap_93:
    s_add_u32 s63, s69, 278528
    buffer_load_dwordx4 v[232:235], v2, s[44:47], s63 offen nt
    s_memrealtime s[8:9]
    s_waitcnt vmcnt(10)
    s_waitcnt lgkmcnt(0)
    s_sub_u32 s8, s8, s30
    s_cmpk_ge_u32 s8, 1846
    s_cbranch_scc1 .ap_94
    s_waitcnt vmcnt(5)
    s_cmpk_ge_u32 s8, 1781
    s_cbranch_scc1 .ap_94
    s_waitcnt vmcnt(3)
    s_bitcmp1_b64 s[14:15], 51
    s_cbranch_scc0 1
    s_waitcnt vmcnt(2)
    s_cmpk_ge_u32 s8, 1706
    s_cbranch_scc1 .ap_94
    s_waitcnt vmcnt(1)
.ap_94:
    s_add_u32 s63, s69, 286720
    buffer_load_dwordx4 v[236:239], v2, s[44:47], s63 offen nt
    s_memrealtime s[8:9]
    s_waitcnt vmcnt(10)
    s_waitcnt lgkmcnt(0)
    s_sub_u32 s8, s8, s30
    s_cmpk_ge_u32 s8, 1877
    s_cbranch_scc1 .ap_95
    s_waitcnt vmcnt(5)
    s_cmpk_ge_u32 s8, 1812
    s_cbranch_scc1 .ap_95
    s_waitcnt vmcnt(3)
    s_bitcmp1_b64 s[14:15], 52
    s_cbranch_scc0 1
    s_waitcnt vmcnt(2)
    s_cmpk_ge_u32 s8, 1737
    s_cbranch_scc1 .ap_95
    s_waitcnt vmcnt(1)
.ap_95:
    s_add_u32 s63, s69, 294912
    buffer_load_dwordx4 v[240:243], v2, s[44:47], s63 offen nt
    s_memrealtime s[8:9]
    s_waitcnt vmcnt(10)
    s_waitcnt lgkmcnt(0)
    s_sub_u32 s8, s8, s30
    s_cmpk_ge_u32 s8, 1908
    s_cbranch_scc1 .ap_96
    s_waitcnt vmcnt(5)
    s_cmpk_ge_u32 s8, 1843
    s_cbranch_scc1 .ap_96
    s_waitcnt vmcnt(3)
    s_bitcmp1_b64 s[14:15], 53
    s_cbranch_scc0 1
    s_waitcnt vmcnt(2)
    s_cmpk_ge_u32 s8, 1768
    s_cbranch_scc1 .ap_96
    s_waitcnt vmcnt(1)
.ap_96:
    s_add_u32 s63, s69, 303104
    buffer_load_dwordx4 v[244:247], v2, s[44:47], s63 offen nt
    s_load_dwordx2 s[88:89], s[6:7], s0
    buffer_load_dwordx4 v[24:27], v9, s[36:39], s59 offen offset:0 sc1
    s_memrealtime s[8:9]
    s_waitcnt vmcnt(8)
    s_waitcnt lgkmcnt(0)
    s_sub_u32 s8, s8, s30
    s_cmpk_ge_u32 s8, 1939
    s_cbranch_scc1 .ap_97
    s_waitcnt vmcnt(5)
    s_cmpk_ge_u32 s8, 1874
    s_cbranch_scc1 .ap_97
    s_waitcnt vmcnt(3)
    s_bitcmp1_b64 s[14:15], 54
    s_cbranch_scc0 1
    s_waitcnt vmcnt(2)
    s_cmpk_ge_u32 s8, 1799
    s_cbranch_scc1 .ap_97
    s_waitcnt vmcnt(1)
.ap_97:
    s_add_u32 s63, s69, 311296
    buffer_load_dwordx4 v[248:251], v2, s[44:47], s63 offen nt
    s_memrealtime s[8:9]
    s_waitcnt vmcnt(8)
    s_waitcnt lgkmcnt(0)
    s_sub_u32 s8, s8, s30
    s_cmpk_ge_u32 s8, 1970
    s_cbranch_scc1 .ap_98
    s_waitcnt vmcnt(5)
    s_cmpk_ge_u32 s8, 1905
    s_cbranch_scc1 .ap_98
    s_waitcnt vmcnt(3)
    s_bitcmp1_b64 s[14:15], 55
    s_cbranch_scc0 1
    s_waitcnt vmcnt(2)
    s_cmpk_ge_u32 s8, 1830
    s_cbranch_scc1 .ap_98
    s_waitcnt vmcnt(1)
.ap_98:
    s_add_u32 s63, s69, 319488
    buffer_load_dwordx4 v[252:255], v2, s[44:47], s63 offen nt
    s_memrealtime s[8:9]
    s_waitcnt vmcnt(8)
    s_waitcnt lgkmcnt(0)
    s_sub_u32 s8, s8, s30
    s_cmpk_ge_u32 s8, 2001
    s_cbranch_scc1 .ap_99
    s_waitcnt vmcnt(5)
    s_cmpk_ge_u32 s8, 1936
    s_cbranch_scc1 .ap_99
    s_waitcnt vmcnt(3)
    s_bitcmp1_b64 s[14:15], 56
    s_cbranch_scc0 1
    s_waitcnt vmcnt(2)
    s_cmpk_ge_u32 s8, 1861
    s_cbranch_scc1 .ap_99
    s_waitcnt vmcnt(1)
.ap_99:
    s_add_u32 s63, s69, 393216
    buffer_load_dwordx4 v[36:39], v2, s[44:47], s63 offen nt
    s_memrealtime s[8:9]
    s_waitcnt vmcnt(8)
    s_waitcnt lgkmcnt(0)
    s_sub_u32 s8, s8, s30
    s_cmpk_ge_u32 s8, 2032
    s_cbranch_scc1 .ap_100
    s_waitcnt vmcnt(5)
    s_cmpk_ge_u32 s8, 1967
    s_cbranch_scc1 .ap_100
    s_waitcnt vmcnt(3)
    s_bitcmp1_b64 s[14:15], 57
    s_cbranch_scc0 1
    s_waitcnt vmcnt(2)
    s_cmpk_ge_u32 s8, 1892
    s_cbranch_scc1 .ap_100
    s_waitcnt vmcnt(1)
.ap_100:
    s_add_u32 s63, s69, 401408
    buffer_load_dwordx4 v[44:47], v2, s[44:47], s63 offen nt
    s_memrealtime s[8:9]
    s_waitcnt vmcnt(8)
    s_waitcnt lgkmcnt(0)
    s_sub_u32 s8, s8, s30
    s_cmpk_ge_u32 s8, 2063
    s_cbranch_scc1 .ap_101
    s_waitcnt vmcnt(5)
    s_cmpk_ge_u32 s8, 1998
    s_cbranch_scc1 .ap_101
    s_waitcnt vmcnt(3)
    s_bitcmp1_b64 s[14:15], 58
    s_cbranch_scc0 1
    s_waitcnt vmcnt(2)
    s_cmpk_ge_u32 s8, 1923
    s_cbranch_scc1 .ap_101
    s_waitcnt vmcnt(1)
.ap_101:
    s_add_u32 s63, s69, 409600
    buffer_load_dwordx4 v[52:55], v2, s[44:47], s63 offen nt
    s_waitcnt vmcnt(5)
    s_branch .gpc_103
.gp_102:
    buffer_load_dwordx4 v[24:27], v9, s[36:39], s59 offen offset:0 sc1
    s_waitcnt vmcnt(0)
.gpc_103:
    v_cmp_eq_u32 vcc, s34, v26
    s_cmp_eq_u64 vcc, exec
    s_nop 3
    s_cbranch_scc1 .gpd_104
    s_sub_u32 s35, s35, 1
    s_cbranch_scc1 .Lexit
    s_sleep 1
    s_branch .gp_102
.gpd_104:
    s_lshr_b64 s[88:89], s[88:89], s1
    s_and_b32 s88, s88, 0xff
    s_cmp_eq_u32 s88, 32
    s_cselect_b32 s0, 0xac000, 0
    v_mov_b32 v16, v24
    s_nop 1
    v_max_f32_dpp v16, v16, v16 quad_perm:[2,3,0,1] row_mask:0xf bank_mask:0xf
    v_sub_f32 v17, v24, v16
    v_sub_f32 v18, v14, v16
    v_mul_f32 v17, 0x3fb8aa3b, v17
    v_mul_f32 v18, 0x3fb8aa3b, v18
    v_exp_f32 v17, v17
    v_exp_f32 v18, v18
    v_mul_f32 v17, v17, v25
    s_nop 1
    v_add_f32_dpp v17, v17, v17 quad_perm:[2,3,0,1] row_mask:0xf bank_mask:0xf
    v_rcp_f32 v19, v17
    s_nop 0
    v_fma_f32 v15, -v17, v19, 1.0
    v_fma_f32 v19, v15, v19, v19
    v_mul_f32 v18, v18, v19
    v_mul_f32 v10, v10, v18
    v_mul_f32 v11, v11, v18
    v_mul_f32 v12, v12, v18
    v_mul_f32 v13, v13, v18
    v_mov_b32_dpp v112, v10 quad_perm:[2,3,0,1] row_mask:0xf bank_mask:0xf
    v_mov_b32_dpp v113, v11 quad_perm:[2,3,0,1] row_mask:0xf bank_mask:0xf
    v_mov_b32_dpp v114, v12 quad_perm:[2,3,0,1] row_mask:0xf bank_mask:0xf
    v_mov_b32_dpp v115, v13 quad_perm:[2,3,0,1] row_mask:0xf bank_mask:0xf
    v_cvt_pk_bf16_f32 v96, v10, v112
    v_cvt_pk_bf16_f32 v100, v11, v113
    v_cvt_pk_bf16_f32 v104, v12, v114
    v_cvt_pk_bf16_f32 v108, v13, v115
    v_mov_b32_dpp v97, v96 row_ror:12 row_mask:0xf bank_mask:0xf
    v_mov_b32_dpp v101, v100 row_ror:12 row_mask:0xf bank_mask:0xf
    v_mov_b32_dpp v105, v104 row_ror:12 row_mask:0xf bank_mask:0xf
    v_mov_b32_dpp v109, v108 row_ror:12 row_mask:0xf bank_mask:0xf
    v_mov_b32_dpp v98, v96 row_ror:8 row_mask:0xf bank_mask:0xf
    v_mov_b32_dpp v102, v100 row_ror:8 row_mask:0xf bank_mask:0xf
    v_mov_b32_dpp v106, v104 row_ror:8 row_mask:0xf bank_mask:0xf
    v_mov_b32_dpp v110, v108 row_ror:8 row_mask:0xf bank_mask:0xf
    v_mov_b32_dpp v99, v96 row_ror:4 row_mask:0xf bank_mask:0xf
    v_mov_b32_dpp v103, v100 row_ror:4 row_mask:0xf bank_mask:0xf
    v_mov_b32_dpp v107, v104 row_ror:4 row_mask:0xf bank_mask:0xf
    v_mov_b32_dpp v111, v108 row_ror:4 row_mask:0xf bank_mask:0xf
    v_mov_b32_dpp v96, v96 row_shr:3 row_mask:0xf bank_mask:0x2
    v_mov_b32_dpp v97, v97 row_shr:3 row_mask:0xf bank_mask:0x2
    v_mov_b32_dpp v98, v98 row_shr:3 row_mask:0xf bank_mask:0x2
    v_mov_b32_dpp v99, v99 row_shr:3 row_mask:0xf bank_mask:0x2
    v_mov_b32_dpp v100, v100 row_shr:3 row_mask:0xf bank_mask:0x2
    v_mov_b32_dpp v101, v101 row_shr:3 row_mask:0xf bank_mask:0x2
    v_mov_b32_dpp v102, v102 row_shr:3 row_mask:0xf bank_mask:0x2
    v_mov_b32_dpp v103, v103 row_shr:3 row_mask:0xf bank_mask:0x2
    v_mov_b32_dpp v104, v104 row_shr:3 row_mask:0xf bank_mask:0x2
    v_mov_b32_dpp v105, v105 row_shr:3 row_mask:0xf bank_mask:0x2
    v_mov_b32_dpp v106, v106 row_shr:3 row_mask:0xf bank_mask:0x2
    v_mov_b32_dpp v107, v107 row_shr:3 row_mask:0xf bank_mask:0x2
    v_mov_b32_dpp v108, v108 row_shr:3 row_mask:0xf bank_mask:0x2
    v_mov_b32_dpp v109, v109 row_shr:3 row_mask:0xf bank_mask:0x2
    v_mov_b32_dpp v110, v110 row_shr:3 row_mask:0xf bank_mask:0x2
    v_mov_b32_dpp v111, v111 row_shr:3 row_mask:0xf bank_mask:0x2
    s_memrealtime s[8:9]
    s_waitcnt lgkmcnt(0)
    s_sub_u32 s8, s8, s30
    s_cmpk_ge_u32 s8, 2094
    s_cbranch_scc1 .ap_105
    s_waitcnt vmcnt(5)
    s_cmpk_ge_u32 s8, 2029
    s_cbranch_scc1 .ap_105
    s_waitcnt vmcnt(3)
    s_bitcmp1_b64 s[14:15], 59
    s_cbranch_scc0 1
    s_waitcnt vmcnt(2)
    s_cmpk_ge_u32 s8, 1954
    s_cbranch_scc1 .ap_105
    s_waitcnt vmcnt(1)
.ap_105:
    s_add_u32 s63, s69, 417792
    buffer_load_dwordx4 v[60:63], v2, s[44:47], s63 offen nt
    s_lshl_b32 s60, s3, 10
    s_add_u32 s60, s60, 132096
    v_lshlrev_b32 v10, 5, v0
    v_add_u32 v10, s60, v10
    v_lshrrev_b32 v11, 5, v0
    v_lshlrev_b32 v11, 13, v11
    v_and_b32 v12, 31, v0
    v_lshl_add_u32 v11, v12, 4, v11
    v_add_u32 v9, 132096, v2
    v_mov_b32 v15, s34
    v_lshrrev_b32 v25, 4, v0
    v_bfe_u32 v26, v0, 2, 2
    v_lshl_add_u32 v16, v25, 3, v26
    v_lshlrev_b32 v16, 7, v16
    v_and_b32 v25, 1, v25
    v_lshrrev_b32 v26, 1, v26
    v_lshl_add_u32 v25, v25, 1, v26
    s_and_b32 s56, s3, 1
    s_lshl_b32 s56, s56, 1
    v_xor_b32 v25, s56, v25
    v_and_b32 v26, 3, v0
    v_lshl_add_u32 v16, v26, 3, v16
    s_lshr_b32 s56, s3, 1
    s_mul_i32 s56, s56, 16384
    v_add_u32 v16, s56, v16
    v_xor_b32 v26, 1, v25
    v_lshl_add_u32 v17, v26, 5, v16
    v_lshl_add_u32 v16, v25, 5, v16
    v_bfe_u32 v25, v0, 1, 3
    v_mul_u32_u24 v19, 1312, v25
    v_mul_u32_u24 v20, 272, v25
    v_and_b32 v25, 48, v0
    s_lshr_b32 s56, s3, 1
    s_mul_i32 s57, s56, 256
    s_add_u32 s57, s57, 147456
    v_add3_u32 v19, v19, v25, s57
    s_mul_i32 s56, s56, 2176
    s_and_b32 s57, s3, 1
    s_lshl_b32 s57, s57, 7
    s_add_u32 s56, s56, s57
    s_add_u32 s56, s56, 122880
    v_add3_u32 v20, v20, v25, s56
    v_and_b32 v25, 1, v0
    v_lshl_add_u32 v20, v25, 6, v20
    v_and_b32 v25, 15, v0
    s_mul_i32 s56, s3, 272
    s_add_u32 s56, s56, 122880
    v_lshl_add_u32 v21, v25, 4, s56
    s_mul_i32 s56, s3, 1312
    s_add_u32 s56, s56, 147456
    v_add_u32 v18, s56, v3
    v_add_u32 v7, 16384, v11
    s_nop 1
    s_branch .gpc_107
.gp_106:
    buffer_load_dwordx2 v[72:73], v6, s[36:39], s101 offen offset:0 sc1
    s_waitcnt vmcnt(0)
.gpc_107:
    v_cmp_eq_u32 vcc, s34, v73
    s_cmp_eq_u64 vcc, exec
    s_nop 3
    s_cbranch_scc1 .gpd_108
    s_sub_u32 s35, s35, 1
    s_cbranch_scc1 .Lexit
    s_sleep 2
    s_branch .gp_106
.gpd_108:
    v_lshlrev_b32 v23, 16, v72
    v_and_b32 v72, 0xffff0000, v72
    s_mov_b32 vcc_lo, 0xffff0000
    s_mov_b32 vcc_hi, 0xffff0000
    v_cndmask_b32 v23, v23, v72, vcc
    v_lshlrev_b32 v29, 16, v29
    s_memrealtime s[8:9]
    s_waitcnt lgkmcnt(0)
    s_sub_u32 s8, s8, s30
    s_cmpk_ge_u32 s8, 2125
    s_cbranch_scc1 .ap_109
    s_waitcnt vmcnt(5)
    s_cmpk_ge_u32 s8, 2060
    s_cbranch_scc1 .ap_109
    s_waitcnt vmcnt(3)
    s_bitcmp1_b64 s[14:15], 60
    s_cbranch_scc0 1
    s_waitcnt vmcnt(2)
    s_cmpk_ge_u32 s8, 1985
    s_cbranch_scc1 .ap_109
    s_waitcnt vmcnt(1)
.ap_109:
    s_add_u32 s63, s69, 425984
    buffer_load_dwordx4 v[68:71], v2, s[44:47], s63 offen nt
    v_perm_b32 v112, v164, v160, s94
    v_perm_b32 v113, v172, v168, s94
    v_perm_b32 v114, v180, v176, s94
    v_perm_b32 v115, v188, v184, s94
    s_nop 1
    v_mfma_f32_16x16x32_bf16 v[128:131], v[96:99], v[112:115], 0
    v_perm_b32 v116, v164, v160, s95
    v_perm_b32 v117, v172, v168, s95
    v_perm_b32 v118, v180, v176, s95
    v_perm_b32 v119, v188, v184, s95
    s_nop 1
    v_mfma_f32_16x16x32_bf16 v[132:135], v[96:99], v[116:119], 0
    v_perm_b32 v120, v165, v161, s94
    v_perm_b32 v121, v173, v169, s94
    v_perm_b32 v122, v181, v177, s94
    v_perm_b32 v123, v189, v185, s94
    s_nop 1
    v_mfma_f32_16x16x32_bf16 v[136:139], v[96:99], v[120:123], 0
    v_perm_b32 v124, v165, v161, s95
    v_perm_b32 v125, v173, v169, s95
    v_perm_b32 v126, v181, v177, s95
    v_perm_b32 v127, v189, v185, s95
    s_nop 1
    v_mfma_f32_16x16x32_bf16 v[140:143], v[96:99], v[124:127], 0
    v_perm_b32 v112, v166, v162, s94
    v_perm_b32 v113, v174, v170, s94
    v_perm_b32 v114, v182, v178, s94
    v_perm_b32 v115, v190, v186, s94
    s_nop 1
    v_mfma_f32_16x16x32_bf16 v[144:147], v[96:99], v[112:115], 0
    v_perm_b32 v116, v166, v162, s95
    v_perm_b32 v117, v174, v170, s95
    v_perm_b32 v118, v182, v178, s95
    v_perm_b32 v119, v190, v186, s95
    s_nop 1
    v_mfma_f32_16x16x32_bf16 v[148:151], v[96:99], v[116:119], 0
    v_perm_b32 v120, v167, v163, s94
    v_perm_b32 v121, v175, v171, s94
    v_perm_b32 v122, v183, v179, s94
    v_perm_b32 v123, v191, v187, s94
    s_nop 1
    v_mfma_f32_16x16x32_bf16 v[152:155], v[96:99], v[120:123], 0
    v_perm_b32 v124, v167, v163, s95
    v_perm_b32 v125, v175, v171, s95
    v_perm_b32 v126, v183, v179, s95
    v_perm_b32 v127, v191, v187, s95
    s_nop 1
    v_mfma_f32_16x16x32_bf16 v[156:159], v[96:99], v[124:127], 0
    s_memrealtime s[8:9]
    s_waitcnt lgkmcnt(0)
    s_sub_u32 s8, s8, s30
    s_cmpk_ge_u32 s8, 2156
    s_nop 3
    s_cbranch_scc1 .ap_110
    s_waitcnt vmcnt(5)
    s_cmpk_ge_u32 s8, 2091
    s_cbranch_scc1 .ap_110
    s_waitcnt vmcnt(3)
    s_bitcmp1_b64 s[14:15], 61
    s_cbranch_scc0 1
    s_waitcnt vmcnt(2)
    s_cmpk_ge_u32 s8, 2016
    s_cbranch_scc1 .ap_110
    s_waitcnt vmcnt(1)
.ap_110:
    s_add_u32 s63, s69, 434176
    buffer_load_dwordx4 v[76:79], v2, s[44:47], s63 offen nt
    v_perm_b32 v112, v196, v192, s94
    v_perm_b32 v113, v204, v200, s94
    v_perm_b32 v114, v212, v208, s94
    v_perm_b32 v115, v220, v216, s94
    s_nop 1
    v_mfma_f32_16x16x32_bf16 v[128:131], v[100:103], v[112:115], v[128:131]
    v_perm_b32 v116, v196, v192, s95
    v_perm_b32 v117, v204, v200, s95
    v_perm_b32 v118, v212, v208, s95
    v_perm_b32 v119, v220, v216, s95
    s_nop 1
    v_mfma_f32_16x16x32_bf16 v[132:135], v[100:103], v[116:119], v[132:135]
    v_perm_b32 v120, v197, v193, s94
    v_perm_b32 v121, v205, v201, s94
    v_perm_b32 v122, v213, v209, s94
    v_perm_b32 v123, v221, v217, s94
    s_nop 1
    v_mfma_f32_16x16x32_bf16 v[136:139], v[100:103], v[120:123], v[136:139]
    v_perm_b32 v124, v197, v193, s95
    v_perm_b32 v125, v205, v201, s95
    v_perm_b32 v126, v213, v209, s95
    v_perm_b32 v127, v221, v217, s95
    s_nop 1
    v_mfma_f32_16x16x32_bf16 v[140:143], v[100:103], v[124:127], v[140:143]
    v_perm_b32 v112, v198, v194, s94
    v_perm_b32 v113, v206, v202, s94
    v_perm_b32 v114, v214, v210, s94
    v_perm_b32 v115, v222, v218, s94
    s_nop 1
    v_mfma_f32_16x16x32_bf16 v[144:147], v[100:103], v[112:115], v[144:147]
    v_perm_b32 v116, v198, v194, s95
    v_perm_b32 v117, v206, v202, s95
    v_perm_b32 v118, v214, v210, s95
    v_perm_b32 v119, v222, v218, s95
    s_nop 1
    v_mfma_f32_16x16x32_bf16 v[148:151], v[100:103], v[116:119], v[148:151]
    v_perm_b32 v120, v199, v195, s94
    v_perm_b32 v121, v207, v203, s94
    v_perm_b32 v122, v215, v211, s94
    v_perm_b32 v123, v223, v219, s94
    s_nop 1
    v_mfma_f32_16x16x32_bf16 v[152:155], v[100:103], v[120:123], v[152:155]
    v_perm_b32 v124, v199, v195, s95
    v_perm_b32 v125, v207, v203, s95
    v_perm_b32 v126, v215, v211, s95
    v_perm_b32 v127, v223, v219, s95
    s_nop 1
    v_mfma_f32_16x16x32_bf16 v[156:159], v[100:103], v[124:127], v[156:159]
    s_memrealtime s[8:9]
    s_waitcnt lgkmcnt(0)
    s_sub_u32 s8, s8, s30
    s_cmpk_ge_u32 s8, 2187
    s_nop 3
    s_cbranch_scc1 .ap_111
    s_waitcnt vmcnt(5)
    s_cmpk_ge_u32 s8, 2122
    s_cbranch_scc1 .ap_111
    s_waitcnt vmcnt(3)
    s_bitcmp1_b64 s[14:15], 62
    s_cbranch_scc0 1
    s_waitcnt vmcnt(2)
    s_cmpk_ge_u32 s8, 2047
    s_cbranch_scc1 .ap_111
    s_waitcnt vmcnt(1)
.ap_111:
    s_add_u32 s63, s69, 442368
    buffer_load_dwordx4 v[84:87], v2, s[44:47], s63 offen nt
    s_waitcnt vmcnt(7)
    v_perm_b32 v112, v228, v224, s94
    v_perm_b32 v113, v236, v232, s94
    v_perm_b32 v114, v244, v240, s94
    v_perm_b32 v115, v252, v248, s94
    s_nop 1
    v_mfma_f32_16x16x32_bf16 v[128:131], v[104:107], v[112:115], v[128:131]
    v_perm_b32 v116, v228, v224, s95
    v_perm_b32 v117, v236, v232, s95
    v_perm_b32 v118, v244, v240, s95
    v_perm_b32 v119, v252, v248, s95
    s_nop 1
    v_mfma_f32_16x16x32_bf16 v[132:135], v[104:107], v[116:119], v[132:135]
    v_perm_b32 v120, v229, v225, s94
    v_perm_b32 v121, v237, v233, s94
    v_perm_b32 v122, v245, v241, s94
    v_perm_b32 v123, v253, v249, s94
    s_nop 1
    v_mfma_f32_16x16x32_bf16 v[136:139], v[104:107], v[120:123], v[136:139]
    v_perm_b32 v124, v229, v225, s95
    v_perm_b32 v125, v237, v233, s95
    v_perm_b32 v126, v245, v241, s95
    v_perm_b32 v127, v253, v249, s95
    s_nop 1
    v_mfma_f32_16x16x32_bf16 v[140:143], v[104:107], v[124:127], v[140:143]
    v_perm_b32 v112, v230, v226, s94
    v_perm_b32 v113, v238, v234, s94
    v_perm_b32 v114, v246, v242, s94
    v_perm_b32 v115, v254, v250, s94
    s_nop 1
    v_mfma_f32_16x16x32_bf16 v[144:147], v[104:107], v[112:115], v[144:147]
    v_perm_b32 v116, v230, v226, s95
    v_perm_b32 v117, v238, v234, s95
    v_perm_b32 v118, v246, v242, s95
    v_perm_b32 v119, v254, v250, s95
    s_nop 1
    v_mfma_f32_16x16x32_bf16 v[148:151], v[104:107], v[116:119], v[148:151]
    v_perm_b32 v120, v231, v227, s94
    v_perm_b32 v121, v239, v235, s94
    v_perm_b32 v122, v247, v243, s94
    v_perm_b32 v123, v255, v251, s94
    s_nop 1
    v_mfma_f32_16x16x32_bf16 v[152:155], v[104:107], v[120:123], v[152:155]
    v_perm_b32 v124, v231, v227, s95
    v_perm_b32 v125, v239, v235, s95
    v_perm_b32 v126, v247, v243, s95
    v_perm_b32 v127, v255, v251, s95
    s_nop 1
    v_mfma_f32_16x16x32_bf16 v[156:159], v[104:107], v[124:127], v[156:159]
    s_memrealtime s[8:9]
    s_waitcnt lgkmcnt(0)
    s_sub_u32 s8, s8, s30
    s_cmpk_ge_u32 s8, 2218
    s_nop 3
    s_cbranch_scc1 .ap_112
    s_waitcnt vmcnt(5)
    s_cmpk_ge_u32 s8, 2153
    s_cbranch_scc1 .ap_112
    s_waitcnt vmcnt(3)
    s_bitcmp1_b64 s[14:15], 63
    s_cbranch_scc0 1
    s_waitcnt vmcnt(2)
    s_cmpk_ge_u32 s8, 2078
    s_cbranch_scc1 .ap_112
    s_waitcnt vmcnt(1)
.ap_112:
    s_add_u32 s63, s69, 450560
    buffer_load_dwordx4 v[92:95], v2, s[44:47], s63 offen nt
    s_setprio 0
    s_waitcnt vmcnt(6)
    v_perm_b32 v160, v44, v36, s94
    v_perm_b32 v164, v44, v36, s95
    v_perm_b32 v168, v45, v37, s94
    v_perm_b32 v172, v45, v37, s95
    v_perm_b32 v176, v46, v38, s94
    v_perm_b32 v180, v46, v38, s95
    v_perm_b32 v184, v47, v39, s94
    v_perm_b32 v188, v47, v39, s95
    s_waitcnt vmcnt(4)
    v_perm_b32 v161, v60, v52, s94
    v_perm_b32 v165, v60, v52, s95
    v_perm_b32 v169, v61, v53, s94
    v_perm_b32 v173, v61, v53, s95
    v_perm_b32 v177, v62, v54, s94
    v_perm_b32 v181, v62, v54, s95
    v_perm_b32 v185, v63, v55, s94
    v_perm_b32 v189, v63, v55, s95
    v_mfma_f32_16x16x16_bf16 v[128:131], v[108:109], v[160:161], v[128:131]
    v_mfma_f32_16x16x16_bf16 v[132:135], v[108:109], v[164:165], v[132:135]
    v_mfma_f32_16x16x16_bf16 v[136:139], v[108:109], v[168:169], v[136:139]
    v_mfma_f32_16x16x16_bf16 v[140:143], v[108:109], v[172:173], v[140:143]
    v_mfma_f32_16x16x16_bf16 v[144:147], v[108:109], v[176:177], v[144:147]
    v_mfma_f32_16x16x16_bf16 v[148:151], v[108:109], v[180:181], v[148:151]
    v_mfma_f32_16x16x16_bf16 v[152:155], v[108:109], v[184:185], v[152:155]
    v_mfma_f32_16x16x16_bf16 v[156:159], v[108:109], v[188:189], v[156:159]
    s_waitcnt vmcnt(2)
    v_perm_b32 v162, v76, v68, s94
    v_perm_b32 v166, v76, v68, s95
    v_perm_b32 v170, v77, v69, s94
    v_perm_b32 v174, v77, v69, s95
    v_perm_b32 v178, v78, v70, s94
    v_perm_b32 v182, v78, v70, s95
    v_perm_b32 v186, v79, v71, s94
    v_perm_b32 v190, v79, v71, s95
    s_lshl4_add_u32 s59, s67, s66
    s_lshl1_add_u32 s59, s59, s68
    s_lshl_b32 s59, s59, 9
    s_add_u32 s59, s59, 0x210000
    s_mov_b32 s60, 0x07060503
    s_mov_b32 s61, 0x07060502
    s_mov_b32 s62, 0x07060501
.Ltail_ar:
    s_waitcnt vmcnt(0)
    v_perm_b32 v163, v92, v84, s94
    v_perm_b32 v167, v92, v84, s95
    v_perm_b32 v171, v93, v85, s94
    v_perm_b32 v175, v93, v85, s95
    v_perm_b32 v179, v94, v86, s94
    v_perm_b32 v183, v94, v86, s95
    v_perm_b32 v187, v95, v87, s94
    v_perm_b32 v191, v95, v87, s95
    v_mfma_f32_16x16x16_bf16 v[128:131], v[110:111], v[162:163], v[128:131]
    v_mfma_f32_16x16x16_bf16 v[132:135], v[110:111], v[166:167], v[132:135]
    v_mfma_f32_16x16x16_bf16 v[136:139], v[110:111], v[170:171], v[136:139]
    v_mfma_f32_16x16x16_bf16 v[140:143], v[110:111], v[174:175], v[140:143]
    v_mfma_f32_16x16x16_bf16 v[144:147], v[110:111], v[178:179], v[144:147]
    v_mfma_f32_16x16x16_bf16 v[148:151], v[110:111], v[182:183], v[148:151]
    v_mfma_f32_16x16x16_bf16 v[152:155], v[110:111], v[186:187], v[152:155]
    v_mfma_f32_16x16x16_bf16 v[156:159], v[110:111], v[190:191], v[156:159]
    s_mov_b64 exec, 0xffffffff
    s_nop 0
    ds_write2_b32 v10, v128, v132 offset0:0 offset1:1
    s_nop 0
    ds_write2_b32 v10, v136, v140 offset0:2 offset1:3
    s_nop 0
    ds_write2_b32 v10, v144, v148 offset0:4 offset1:5
    s_nop 0
    ds_write2_b32 v10, v152, v156 offset0:6 offset1:7
    s_mov_b64 exec, -1
    s_waitcnt lgkmcnt(0)
    s_barrier
    s_cmp_lg_u32 s3, 7
    s_cbranch_scc1 .opub_113
    ds_read_b128 v[196:199], v9 offset:0
    ds_read_b128 v[200:203], v9 offset:1024
    ds_read_b128 v[204:207], v9 offset:2048
    ds_read_b128 v[208:211], v9 offset:3072
    ds_read_b128 v[212:215], v9 offset:4096
    ds_read_b128 v[216:219], v9 offset:5120
    ds_read_b128 v[220:223], v9 offset:6144
    ds_read_b128 v[224:227], v9 offset:7168
    s_waitcnt lgkmcnt(6)
    v_pk_add_f32 v[196:197], v[196:197], v[200:201]
    v_pk_add_f32 v[198:199], v[198:199], v[202:203]
    s_waitcnt lgkmcnt(4)
    v_pk_add_f32 v[204:205], v[204:205], v[208:209]
    v_pk_add_f32 v[206:207], v[206:207], v[210:211]
    v_pk_add_f32 v[196:197], v[196:197], v[204:205]
    v_pk_add_f32 v[198:199], v[198:199], v[206:207]
    s_waitcnt lgkmcnt(2)
    v_pk_add_f32 v[212:213], v[212:213], v[216:217]
    v_pk_add_f32 v[214:215], v[214:215], v[218:219]
    s_waitcnt lgkmcnt(0)
    v_pk_add_f32 v[220:221], v[220:221], v[224:225]
    v_pk_add_f32 v[222:223], v[222:223], v[226:227]
    v_pk_add_f32 v[212:213], v[212:213], v[220:221]
    v_pk_add_f32 v[214:215], v[214:215], v[222:223]
    v_pk_add_f32 v[196:197], v[196:197], v[212:213]
    v_pk_add_f32 v[198:199], v[198:199], v[214:215]
    v_perm_b32 v12, v196, v199, s60
    v_perm_b32 v13, v197, v199, s61
    v_perm_b32 v14, v198, v199, s62
    s_add_u32 s57, s59, 0xac000
    buffer_store_dwordx4 v[12:15], v11, s[36:39], s57 offen
    buffer_store_dwordx4 v[12:15], v11, s[36:39], s59 offen sc1
.opub_113:
    ds_read_b64_tr_b16 v[160:161], v16 offset:0
    ds_read_b64_tr_b16 v[162:163], v16 offset:512
    ds_read_b64_tr_b16 v[176:177], v17 offset:0
    ds_read_b64_tr_b16 v[178:179], v17 offset:512
    ds_read_b64_tr_b16 v[164:165], v16 offset:4096
    ds_read_b64_tr_b16 v[166:167], v16 offset:4608
    ds_read_b64_tr_b16 v[180:181], v17 offset:4096
    ds_read_b64_tr_b16 v[182:183], v17 offset:4608
    ds_read_b64_tr_b16 v[168:169], v16 offset:8192
    ds_read_b64_tr_b16 v[170:171], v16 offset:8704
    ds_read_b64_tr_b16 v[184:185], v17 offset:8192
    ds_read_b64_tr_b16 v[186:187], v17 offset:8704
    ds_read_b64_tr_b16 v[172:173], v16 offset:12288
    ds_read_b64_tr_b16 v[174:175], v16 offset:12800
    ds_read_b64_tr_b16 v[188:189], v17 offset:12288
    ds_read_b64_tr_b16 v[190:191], v17 offset:12800
    s_lshl_b32 s59, s64, 5
    s_add_u32 s59, s59, s3
    s_lshl_b32 s59, s59, 10
    s_add_u32 s59, s59, 0x210000
    s_mov_b32 s60, 0x04000c0c
    s_mov_b32 s61, 0x0706000c
    v_mov_b32 v143, s34
    s_mul_i32 s40, s3, 9
    s_add_u32 s40, s40, s65
    s_lshl_b32 s40, s40, 11
    s_add_u32 s41, s40, 0x368000
    s_lshl_b32 s63, s64, 8
    s_add_u32 s63, s63, s41
    s_mul_i32 s101, s64, 18432
    s_mul_i32 s56, s3, 2304
    s_add_u32 s101, s101, s56
    s_add_u32 s101, s101, 0x250000
    s_lshl_b32 s42, s65, 8
    s_add_u32 s42, s42, s101
    v_mov_b32 v253, s34
    v_mov_b32 v255, s34
    s_add_u32 s58, s59, s0
    s_mov_b32 s32, 0
    s_mov_b64 s[88:89], exec
    s_mov_b64 s[90:91], exec
    s_mov_b64 s[92:93], exec
    s_mov_b64 s[56:57], exec
.mp_114:
    s_mov_b64 exec, s[88:89]
    buffer_load_dwordx4 v[192:195], v11, s[36:39], s58 offen offset:0 sc1
    s_mov_b64 exec, s[90:91]
    buffer_load_dwordx4 v[196:199], v11, s[36:39], s58 offen offset:512 sc1
    s_mov_b64 exec, s[92:93]
    buffer_load_dwordx4 v[200:203], v7, s[36:39], s58 offen offset:0 sc1
    s_mov_b64 exec, s[56:57]
    buffer_load_dwordx4 v[204:207], v7, s[36:39], s58 offen offset:512 sc1
    s_mov_b64 exec, -1
    s_sub_u32 s35, s35, 1
    s_cbranch_scc1 .Lexit
    s_add_u32 s32, s32, 1
    s_cmp_eq_u32 s32, 64
    s_cselect_b32 s58, s59, s58
    s_waitcnt vmcnt(0)
.mpj_115:
    v_cmp_ne_u32 s[88:89], s34, v195
    v_cmp_ne_u32 s[90:91], s34, v199
    v_cmp_ne_u32 s[92:93], s34, v203
    v_cmp_ne_u32 s[56:57], s34, v207
    s_or_b64 vcc, s[88:89], s[90:91]
    s_or_b64 vcc, vcc, s[92:93]
    s_or_b64 vcc, vcc, s[56:57]
    s_cbranch_scc1 .mp_114
    v_perm_b32 v195, v192, v193, s60
    v_perm_b32 v199, v196, v197, s60
    v_perm_b32 v203, v200, v201, s60
    v_perm_b32 v207, v204, v205, s60
    v_perm_b32 v195, v195, v194, s61
    v_perm_b32 v199, v199, v198, s61
    v_perm_b32 v203, v203, v202, s61
    v_perm_b32 v207, v207, v206, s61
    v_pk_add_f32 v[192:193], v[192:193], v[196:197]
    v_pk_add_f32 v[194:195], v[194:195], v[198:199]
    v_pk_add_f32 v[200:201], v[200:201], v[204:205]
    v_pk_add_f32 v[202:203], v[202:203], v[206:207]
    v_cvt_pk_bf16_f32 v192, v192, v193
    v_cvt_pk_bf16_f32 v193, v194, v195
    v_cvt_pk_bf16_f32 v200, v200, v201
    v_cvt_pk_bf16_f32 v201, v202, v203
    ds_write_b64 v18, v[192:193]
    ds_write_b64 v18, v[200:201] offset:512
    s_waitcnt lgkmcnt(0)
    s_barrier
    ds_read_b128 v[224:227], v19 offset:0
    ds_read_b128 v[228:231], v19 offset:64
    ds_read_b128 v[232:235], v19 offset:128
    ds_read_b128 v[236:239], v19 offset:192
    s_waitcnt lgkmcnt(3)
    v_mfma_f32_16x16x32_bf16 v[132:135], v[160:163], v[224:227], 0
    v_mfma_f32_16x16x32_bf16 v[136:139], v[176:179], v[224:227], 0
    s_waitcnt lgkmcnt(2)
    v_mfma_f32_16x16x32_bf16 v[132:135], v[164:167], v[228:231], v[132:135]
    v_mfma_f32_16x16x32_bf16 v[136:139], v[180:183], v[228:231], v[136:139]
    s_waitcnt lgkmcnt(1)
    v_mfma_f32_16x16x32_bf16 v[132:135], v[168:171], v[232:235], v[132:135]
    v_mfma_f32_16x16x32_bf16 v[136:139], v[184:187], v[232:235], v[136:139]
    s_waitcnt lgkmcnt(0)
    v_mfma_f32_16x16x32_bf16 v[132:135], v[172:175], v[236:239], v[132:135]
    v_mfma_f32_16x16x32_bf16 v[136:139], v[188:191], v[236:239], v[136:139]
    s_nop 7
    v_cndmask_b32 v132, v132, v136, s[96:97]
    v_cndmask_b32 v133, v133, v137, s[96:97]
    v_cndmask_b32 v134, v134, v138, s[96:97]
    v_cndmask_b32 v135, v135, v139, s[96:97]
    ds_write_b128 v20, v[132:135]
    s_waitcnt lgkmcnt(0)
    s_barrier
    ds_read_b128 v[224:227], v21 offset:0
    ds_read_b128 v[228:231], v21 offset:2176
    ds_read_b128 v[232:235], v21 offset:4352
    ds_read_b128 v[236:239], v21 offset:6528
    s_mov_b32 s60, 0x07060503
    s_mov_b32 s61, 0x07060502
    s_mov_b32 s62, 0x07060501
    s_waitcnt lgkmcnt(2)
    v_pk_add_f32 v[224:225], v[224:225], v[228:229]
    v_pk_add_f32 v[226:227], v[226:227], v[230:231]
    s_waitcnt lgkmcnt(0)
    v_pk_add_f32 v[232:233], v[232:233], v[236:237]
    v_pk_add_f32 v[234:235], v[234:235], v[238:239]
    v_pk_add_f32 v[224:225], v[224:225], v[232:233]
    v_pk_add_f32 v[226:227], v[226:227], v[234:235]
    v_perm_b32 v140, v224, v227, s60
    v_perm_b32 v141, v225, v227, s61
    v_perm_b32 v142, v226, v227, s62
    s_mov_b64 exec, 0xffff
    buffer_store_dwordx4 v[140:143], v2, s[36:39], s63 offen sc1
    s_mov_b64 exec, -1
    s_barrier
    s_mov_b32 s60, 0x04000c0c
    s_mov_b32 s61, 0x0706000c
    s_mov_b64 s[88:89], exec
    s_mov_b64 s[90:91], exec
.mp_118:
    s_mov_b64 exec, s[88:89]
    buffer_load_dwordx4 v[108:111], v2, s[36:39], s41 offen offset:0 sc1
    s_mov_b64 exec, s[90:91]
    buffer_load_dwordx4 v[112:115], v2, s[36:39], s41 offen offset:1024 sc1
    s_mov_b64 exec, -1
    s_sub_u32 s35, s35, 1
    s_cbranch_scc1 .Lexit
    s_waitcnt vmcnt(0)
.mpj_119:
    v_cmp_ne_u32 s[88:89], s34, v111
    v_cmp_ne_u32 s[90:91], s34, v115
    s_or_b64 vcc, s[88:89], s[90:91]
    s_cbranch_scc1 .mp_118
    v_perm_b32 v111, v108, v109, s60
    v_perm_b32 v115, v112, v113, s60
    v_perm_b32 v111, v111, v110, s61
    v_perm_b32 v115, v115, v114, s61
    v_pk_add_f32 v[248:249], v[108:109], v[112:113]
    v_pk_add_f32 v[250:251], v[110:111], v[114:115]
    s_nop 1
    v_permlane32_swap_b32 v248, v250
    v_permlane32_swap_b32 v249, v251
    v_pk_add_f32 v[248:249], v[248:249], v[250:251]
    s_nop 1
    v_permlane16_swap_b32 v248, v249
    v_add_f32 v248, v248, v249
    v_cvt_pk_bf16_f32 v248, 0, v248
    v_mul_f32 v248, v248, v23
    v_cvt_pk_bf16_f32 v248, 0, v248
    v_add_f32 v249, v248, v29
    v_add_f32 v248, v248, v29
    v_mov_b32 v24, v248
    s_nop 0
    v_permlane16_swap_b32 v248, v249
    v_cvt_pk_bf16_f32 v252, v248, v249
    v_cvt_pk_bf16_f32 v254, v248, v249
    s_nop 1
    v_permlane32_swap_b32 v252, v254
    s_mov_b64 exec, 0xffff
    s_add_u32 s57, s42, 0xac000
    buffer_store_dwordx4 v[252:255], v2, s[36:39], s57 offen
    buffer_store_dwordx4 v[252:255], v2, s[36:39], s42 offen sc1
    s_mov_b64 exec, -1
    s_cmp_eq_u32 s3, s64
    s_cbranch_scc1 .r2_122
    s_branch .Lexit
.r2_122:
    v_cvt_pk_bf16_f32 v24, 0, v24
    s_nop 1
    s_branch .gpc_124
.gp_123:
    buffer_load_dwordx4 v[32:35], v2, s[36:39], s99 offen offset:0 sc1
    buffer_load_dwordx4 v[40:43], v2, s[36:39], s99 offen offset:1024 sc1
    buffer_load_dwordx2 v[48:49], v5, s[36:39], s99 offen offset:0 sc1
    buffer_load_dwordx4 v[56:59], v2, s[36:39], s100 offen offset:0 sc1
    buffer_load_dwordx4 v[64:67], v2, s[36:39], s100 offen offset:1024 sc1
    buffer_load_dwordx2 v[50:51], v5, s[36:39], s100 offen offset:0 sc1
    buffer_load_dwordx2 v[74:75], v6, s[36:39], s99 offen offset:0 sc1
    buffer_load_dwordx2 v[80:81], v6, s[36:39], s100 offen offset:0 sc1
    buffer_load_dwordx2 v[82:83], v6, s[36:39], s33 offen offset:0 sc1
    s_waitcnt vmcnt(0)
.gpc_124:
    v_min3_u32 v25, v33, v35, v41
    v_max3_u32 v26, v33, v35, v41
    v_min3_u32 v25, v25, v43, v49
    v_max3_u32 v26, v26, v43, v49
    v_min3_u32 v25, v25, v57, v59
    v_max3_u32 v26, v26, v57, v59
    v_min3_u32 v25, v25, v65, v67
    v_max3_u32 v26, v26, v65, v67
    v_min3_u32 v25, v25, v51, v75
    v_max3_u32 v26, v26, v51, v75
    v_min3_u32 v25, v25, v81, v83
    v_max3_u32 v26, v26, v81, v83
    v_cmp_eq_u32 vcc, s34, v25
    v_cmp_eq_u32 s[56:57], s34, v26
    s_and_b64 vcc, vcc, s[56:57]
    s_cmp_eq_u64 vcc, exec
    s_nop 2
    s_cbranch_scc1 .gpd_125
    s_sub_u32 s35, s35, 1
    s_cbranch_scc1 .Lexit
    s_sleep 2
    s_branch .gp_123
.gpd_125:
    v_lshlrev_b32 v160, 16, v32
    v_and_b32 v161, 0xffff0000, v32
    v_lshlrev_b32 v170, 16, v56
    v_and_b32 v171, 0xffff0000, v56
    v_lshlrev_b32 v162, 16, v34
    v_and_b32 v163, 0xffff0000, v34
    v_lshlrev_b32 v172, 16, v58
    v_and_b32 v173, 0xffff0000, v58
    v_lshlrev_b32 v164, 16, v40
    v_and_b32 v165, 0xffff0000, v40
    v_lshlrev_b32 v174, 16, v64
    v_and_b32 v175, 0xffff0000, v64
    v_lshlrev_b32 v166, 16, v42
    v_and_b32 v167, 0xffff0000, v42
    v_lshlrev_b32 v176, 16, v66
    v_and_b32 v177, 0xffff0000, v66
    v_lshlrev_b32 v168, 16, v48
    v_and_b32 v169, 0xffff0000, v48
    v_lshlrev_b32 v178, 16, v50
    v_and_b32 v179, 0xffff0000, v50
    v_lshlrev_b32 v75, 16, v74
    v_and_b32 v74, 0xffff0000, v74
    s_mov_b32 vcc_lo, 0xffff0000
    s_mov_b32 vcc_hi, 0xffff0000
    v_cndmask_b32 v75, v75, v74, vcc
    v_lshlrev_b32 v81, 16, v80
    v_and_b32 v80, 0xffff0000, v80
    s_mov_b32 vcc_lo, 0xffff0000
    s_mov_b32 vcc_hi, 0xffff0000
    v_cndmask_b32 v81, v81, v80, vcc
    v_lshlrev_b32 v83, 16, v82
    v_and_b32 v82, 0xffff0000, v82
    s_mov_b32 vcc_lo, 0xffff0000
    s_mov_b32 vcc_hi, 0xffff0000
    v_cndmask_b32 v83, v83, v82, vcc
    s_waitcnt vmcnt(0)
    s_add_u32 s58, s101, s0
    s_mov_b32 s32, 0
    s_mov_b64 s[88:89], exec
    s_mov_b64 s[90:91], exec
    s_mov_b64 s[92:93], exec
.mp_126:
    s_mov_b64 exec, s[88:89]
    buffer_load_dwordx4 v[180:183], v2, s[36:39], s58 offen offset:0 sc1
    s_mov_b64 exec, s[90:91]
    buffer_load_dwordx4 v[184:187], v2, s[36:39], s58 offen offset:1024 sc1
    s_mov_b64 exec, s[92:93]
    buffer_load_dwordx2 v[188:189], v5, s[36:39], s58 offen offset:0 sc1
    s_mov_b64 exec, -1
    s_sub_u32 s35, s35, 1
    s_cbranch_scc1 .Lexit
    s_add_u32 s32, s32, 1
    s_cmp_eq_u32 s32, 64
    s_cselect_b32 s58, s101, s58
    s_waitcnt vmcnt(0)
.mpj_127:
    v_cmp_ne_u32 s[88:89], s34, v183
    v_cmp_ne_u32 s[90:91], s34, v187
    v_cmp_ne_u32 s[92:93], s34, v189
    s_or_b64 vcc, s[88:89], s[90:91]
    s_or_b64 vcc, vcc, s[92:93]
    s_cbranch_scc1 .mp_126
    s_mov_b32 s56, 0x3f803f80
    v_dot2_f32_bf16 v200, v180, s56, 0
    v_dot2_f32_bf16 v201, v180, v180, 0
    v_dot2_f32_bf16 v200, v182, s56, v200
    v_dot2_f32_bf16 v201, v182, v182, v201
    v_dot2_f32_bf16 v200, v184, s56, v200
    v_dot2_f32_bf16 v201, v184, v184, v201
    v_dot2_f32_bf16 v200, v186, s56, v200
    v_dot2_f32_bf16 v201, v186, v186, v201
    s_mov_b64 exec, 0xffffffff
    v_dot2_f32_bf16 v200, v188, s56, v200
    v_dot2_f32_bf16 v201, v188, v188, v201
    s_mov_b64 exec, -1
    s_nop 1
    v_permlane32_swap_b32 v200, v201
    v_add_f32 v200, v200, v201
    v_mov_b32 v202, v200
    s_nop 1
    v_permlane16_swap_b32 v202, v200
    v_add_f32 v200, v202, v200
    v_lshlrev_b32 v190, 16, v180
    v_and_b32 v191, 0xffff0000, v180
    v_add_f32_dpp v200, v200, v200 row_ror:8 row_mask:0xf bank_mask:0xf
    v_lshlrev_b32 v192, 16, v182
    v_and_b32 v193, 0xffff0000, v182
    v_add_f32_dpp v200, v200, v200 row_ror:4 row_mask:0xf bank_mask:0xf
    v_lshlrev_b32 v194, 16, v184
    v_and_b32 v195, 0xffff0000, v184
    v_add_f32_dpp v200, v200, v200 quad_perm:[2,3,0,1] row_mask:0xf bank_mask:0xf
    v_lshlrev_b32 v196, 16, v186
    v_and_b32 v197, 0xffff0000, v186
    v_add_f32_dpp v200, v200, v200 quad_perm:[1,0,3,2] row_mask:0xf bank_mask:0xf
    v_mul_f32 v200, 0x3ae38e39, v200
    v_lshlrev_b32 v198, 16, v188
    v_and_b32 v199, 0xffff0000, v188
    v_readlane_b32 s56, v200, 0
    v_readlane_b32 s57, v200, 32
    s_nop 0
    v_mov_b32 v200, s56
    v_fma_f32 v201, -v200, v200, s57
    v_max_f32 v201, 0, v201
    v_cvt_pk_bf16_f32 v203, 0, v201
    v_cvt_pk_bf16_f32 v201, 0, -v200
    v_cvt_pk_bf16_f32 v200, 0, -v200
    v_add_f32 v203, 0x3727c5ac, v203
    v_pk_add_f32 v[190:191], v[190:191], v[200:201]
    v_pk_add_f32 v[192:193], v[192:193], v[200:201]
    v_pk_add_f32 v[194:195], v[194:195], v[200:201]
    v_cvt_pk_bf16_f32 v203, 0, v203
    v_pk_add_f32 v[196:197], v[196:197], v[200:201]
    v_pk_add_f32 v[198:199], v[198:199], v[200:201]
    v_cvt_pk_bf16_f32 v190, 0, v190
    v_sqrt_f32 v203, v203
    v_cvt_pk_bf16_f32 v191, 0, v191
    v_cvt_pk_bf16_f32 v192, 0, v192
    v_cvt_pk_bf16_f32 v193, 0, v193
    v_cvt_pk_bf16_f32 v203, 0, v203
    v_cvt_pk_bf16_f32 v194, 0, v194
    v_cvt_pk_bf16_f32 v195, 0, v195
    v_cvt_pk_bf16_f32 v196, 0, v196
    v_rcp_f32 v202, v203
    v_cvt_pk_bf16_f32 v197, 0, v197
    v_cvt_pk_bf16_f32 v198, 0, v198
    v_cvt_pk_bf16_f32 v199, 0, v199
    v_mov_b32 v203, v202
    v_pk_mul_f32 v[190:191], v[190:191], v[202:203]
    v_pk_mul_f32 v[192:193], v[192:193], v[202:203]
    v_pk_mul_f32 v[194:195], v[194:195], v[202:203]
    v_pk_mul_f32 v[196:197], v[196:197], v[202:203]
    v_pk_mul_f32 v[198:199], v[198:199], v[202:203]
    v_cvt_pk_bf16_f32 v190, 0, v190
    v_cvt_pk_bf16_f32 v191, 0, v191
    v_cvt_pk_bf16_f32 v192, 0, v192
    v_cvt_pk_bf16_f32 v193, 0, v193
    v_cvt_pk_bf16_f32 v194, 0, v194
    v_cvt_pk_bf16_f32 v195, 0, v195
    v_cvt_pk_bf16_f32 v196, 0, v196
    v_cvt_pk_bf16_f32 v197, 0, v197
    v_cvt_pk_bf16_f32 v198, 0, v198
    v_cvt_pk_bf16_f32 v199, 0, v199
    v_pk_mul_f32 v[190:191], v[190:191], v[170:171]
    v_pk_mul_f32 v[192:193], v[192:193], v[172:173]
    v_pk_mul_f32 v[194:195], v[194:195], v[174:175]
    v_pk_mul_f32 v[196:197], v[196:197], v[176:177]
    v_pk_mul_f32 v[198:199], v[198:199], v[178:179]
    v_cvt_pk_bf16_f32 v190, 0, v190
    v_cvt_pk_bf16_f32 v191, 0, v191
    v_cvt_pk_bf16_f32 v192, 0, v192
    v_cvt_pk_bf16_f32 v193, 0, v193
    v_cvt_pk_bf16_f32 v194, 0, v194
    v_cvt_pk_bf16_f32 v195, 0, v195
    v_cvt_pk_bf16_f32 v196, 0, v196
    v_cvt_pk_bf16_f32 v197, 0, v197
    v_cvt_pk_bf16_f32 v198, 0, v198
    v_cvt_pk_bf16_f32 v199, 0, v199
    v_pk_add_f32 v[190:191], v[190:191], v[160:161]
    v_pk_add_f32 v[192:193], v[192:193], v[162:163]
    v_pk_add_f32 v[194:195], v[194:195], v[164:165]
    v_pk_add_f32 v[196:197], v[196:197], v[166:167]
    v_pk_add_f32 v[198:199], v[198:199], v[168:169]
    v_cvt_pk_bf16_f32 v206, v190, v191
    v_cvt_pk_bf16_f32 v207, v192, v193
    v_cvt_pk_bf16_f32 v208, v194, v195
    v_cvt_pk_bf16_f32 v209, v196, v197
    v_cvt_pk_bf16_f32 v210, v198, v199
    v_dot2_f32_bf16 v14, v206, v88, 0
    v_dot2_f32_bf16 v14, v207, v89, v14
    v_dot2_f32_bf16 v14, v208, v90, v14
    v_dot2_f32_bf16 v14, v209, v91, v14
    s_mov_b64 exec, 0xffffffff
    v_dot2_f32_bf16 v14, v210, v30, v14
    s_mov_b64 exec, -1
    s_nop 1
    v_mov_b32 v15, v14
    s_nop 1
    v_permlane32_swap_b32 v15, v14
    v_add_f32 v14, v15, v14
    v_mov_b32 v15, v14
    s_nop 1
    v_permlane16_swap_b32 v15, v14
    v_add_f32 v14, v15, v14
    s_nop 1
    v_add_f32_dpp v14, v14, v14 row_ror:8 row_mask:0xf bank_mask:0xf
    s_nop 1
    v_add_f32_dpp v14, v14, v14 row_ror:4 row_mask:0xf bank_mask:0xf
    s_nop 1
    v_add_f32_dpp v14, v14, v14 quad_perm:[2,3,0,1] row_mask:0xf bank_mask:0xf
    s_nop 1
    v_add_f32_dpp v14, v14, v14 quad_perm:[1,0,3,2] row_mask:0xf bank_mask:0xf
    v_cvt_pk_bf16_f32 v14, 0, v14
    v_max_f32 v14, 0xc2ae0000, v14
    v_min_f32 v14, 0x43000000, v14
    v_mul_f32 v15, 0xbfb8aa3b, v14
    v_fma_f32 v16, v14, s98, -v15
    v_fmac_f32 v16, 0xb2a57060, v14
    v_exp_f32 v15, v15
    v_mul_f32 v16, 0x3f317218, v16
    v_fmac_f32 v15, v15, v16
    v_add_f32 v15, 1.0, v15
    v_rcp_f32 v16, v15
    s_nop 0
    v_fma_f32 v15, -v15, v16, 1.0
    v_fma_f32 v14, v15, v16, v16
    v_cvt_pk_bf16_f32 v14, 0, v14
    v_add_f32 v17, v24, v200
    v_cvt_pk_bf16_f32 v17, 0, v17
    v_mul_f32 v17, v17, v202
    v_cvt_pk_bf16_f32 v17, 0, v17
    v_mul_f32 v17, v17, v81
    v_cvt_pk_bf16_f32 v17, 0, v17
    v_add_f32 v17, v17, v75
    v_cvt_pk_bf16_f32 v17, 0, v17
    s_lshl_b32 s59, s40, 1
    s_add_u32 s58, s59, 0x38c000
    s_mov_b32 s60, 0x04000c0c
    s_mov_b32 s61, 0x0706000c
    s_mov_b32 s48, s28
    s_and_b32 s49, s29, 0xffff
    s_mov_b32 s50, 0x2400
    s_mov_b32 s51, 0x00020000
    s_mul_i32 s63, s3, 1152
    s_mov_b64 s[88:89], exec
    s_mov_b64 s[90:91], exec
    s_mov_b64 s[92:93], exec
    s_mov_b64 s[56:57], exec
.mp_130:
    s_mov_b64 exec, s[88:89]
    buffer_load_dwordx4 v[96:99], v2, s[36:39], s58 offen offset:0 sc1
    s_mov_b64 exec, s[90:91]
    buffer_load_dwordx4 v[100:103], v2, s[36:39], s58 offen offset:1024 sc1
    s_mov_b64 exec, s[92:93]
    buffer_load_dwordx4 v[104:107], v2, s[36:39], s58 offen offset:2048 sc1
    s_mov_b64 exec, s[56:57]
    buffer_load_dwordx4 v[108:111], v2, s[36:39], s58 offen offset:3072 sc1
    s_mov_b64 exec, -1
    s_sub_u32 s35, s35, 1
    s_cbranch_scc1 .Lexit
    s_waitcnt vmcnt(0)
.mpj_131:
    v_cmp_ne_u32 s[88:89], s34, v99
    v_cmp_ne_u32 s[90:91], s34, v103
    v_cmp_ne_u32 s[92:93], s34, v107
    v_cmp_ne_u32 s[56:57], s34, v111
    s_or_b64 vcc, s[88:89], s[90:91]
    s_or_b64 vcc, vcc, s[92:93]
    s_or_b64 vcc, vcc, s[56:57]
    s_cbranch_scc1 .mp_130
    v_perm_b32 v99, v96, v97, s60
    v_perm_b32 v103, v100, v101, s60
    v_perm_b32 v107, v104, v105, s60
    v_perm_b32 v111, v108, v109, s60
    v_perm_b32 v99, v99, v98, s61
    v_perm_b32 v103, v103, v102, s61
    v_perm_b32 v107, v107, v106, s61
    v_perm_b32 v111, v111, v110, s61
    v_pk_add_f32 v[96:97], v[96:97], v[100:101]
    v_pk_add_f32 v[98:99], v[98:99], v[102:103]
    v_pk_add_f32 v[248:249], v[104:105], v[108:109]
    v_pk_add_f32 v[250:251], v[106:107], v[110:111]
    v_pk_add_f32 v[248:249], v[248:249], v[96:97]
    v_pk_add_f32 v[250:251], v[250:251], v[98:99]
    s_nop 1
    v_permlane32_swap_b32 v248, v250
    v_permlane32_swap_b32 v249, v251
    v_pk_add_f32 v[248:249], v[248:249], v[250:251]
    s_nop 1
    v_permlane16_swap_b32 v248, v249
    v_add_f32 v248, v248, v249
    v_cvt_pk_bf16_f32 v248, 0, v248
    v_mul_f32 v248, v248, v14
    v_cvt_pk_bf16_f32 v248, 0, v248
    v_add_f32 v248, v248, v17
    v_cvt_pk_bf16_f32 v248, 0, v248
    v_mul_f32 v248, v248, v83
    v_cvt_pk_bf16_f32 v248, 0, v248
    v_add_f32 v248, v248, v24
    v_cvt_pk_bf16_f32 v248, v248, v248
    buffer_store_short v248, v31, s[48:51], s63 offen
    s_cmp_lg_u32 s2, 0
    s_cbranch_scc1 .Lexit
    v_mov_b32 v13, s34
    s_mov_b64 exec, 1
    buffer_store_dword v13, v2, s[36:39], 0 offen
    s_mov_b64 exec, -1
    s_branch .Lexit
.Latt_bc:
    v_and_b32 v8, 1, v0
    v_lshlrev_b32 v8, 8, v8
    v_and_b32 v9, 0x3c, v0
    v_lshl_add_u32 v9, v9, 2, v8
    v_lshlrev_b32 v7, 1, v9
    v_and_b32 v9, 0x3c, v0
    v_lshrrev_b32 v8, 4, v8
    v_and_b32 v9, 2, v0
    v_lshl_add_u32 v9, v9, 6, v8
    s_lshl_b32 s58, s66, 14
    s_lshl_b32 s59, s67, 10
    s_add_u32 s58, s58, s59
    s_add_u32 s58, s58, 0x40000
    s_lshl4_add_u32 s59, s66, s67
    s_lshl_b32 s59, s59, 8
    s_add_u32 s59, s59, 0x200000
    s_memrealtime s[8:9]
    s_waitcnt vmcnt(8)
    s_waitcnt lgkmcnt(0)
    s_sub_u32 s8, s8, s30
    s_cmpk_ge_u32 s8, 1147
    s_cbranch_scc1 .ap_134
    s_waitcnt vmcnt(5)
    s_cmpk_ge_u32 s8, 1082
    s_cbranch_scc1 .ap_134
    s_waitcnt vmcnt(3)
    s_bitcmp1_b64 s[14:15], 26
    s_cbranch_scc0 1
    s_waitcnt vmcnt(2)
    s_cmpk_ge_u32 s8, 1007
    s_cbranch_scc1 .ap_134
    s_waitcnt vmcnt(1)
.ap_134:
    s_add_u32 s63, s69, 409600
    buffer_load_dwordx4 v[88:91], v1, s[40:43], s63 offen nt
    s_memrealtime s[8:9]
    s_waitcnt vmcnt(8)
    s_waitcnt lgkmcnt(0)
    s_sub_u32 s8, s8, s30
    s_cmpk_ge_u32 s8, 1174
    s_cbranch_scc1 .ap_135
    s_waitcnt vmcnt(5)
    s_cmpk_ge_u32 s8, 1109
    s_cbranch_scc1 .ap_135
    s_waitcnt vmcnt(3)
    s_bitcmp1_b64 s[14:15], 27
    s_cbranch_scc0 1
    s_waitcnt vmcnt(2)
    s_cmpk_ge_u32 s8, 1034
    s_cbranch_scc1 .ap_135
    s_waitcnt vmcnt(1)
.ap_135:
    s_add_u32 s63, s69, 417792
    buffer_load_dwordx4 v[92:95], v1, s[40:43], s63 offen nt
    s_memrealtime s[8:9]
    s_waitcnt vmcnt(8)
    s_waitcnt lgkmcnt(0)
    s_sub_u32 s8, s8, s30
    s_cmpk_ge_u32 s8, 1201
    s_cbranch_scc1 .ap_136
    s_waitcnt vmcnt(5)
    s_cmpk_ge_u32 s8, 1136
    s_cbranch_scc1 .ap_136
    s_waitcnt vmcnt(3)
    s_bitcmp1_b64 s[14:15], 28
    s_cbranch_scc0 1
    s_waitcnt vmcnt(2)
    s_cmpk_ge_u32 s8, 1061
    s_cbranch_scc1 .ap_136
    s_waitcnt vmcnt(1)
.ap_136:
    s_add_u32 s63, s69, 425984
    buffer_load_dwordx4 v[120:123], v1, s[40:43], s63 offen nt
    s_memrealtime s[8:9]
    s_waitcnt vmcnt(8)
    s_waitcnt lgkmcnt(0)
    s_sub_u32 s8, s8, s30
    s_cmpk_ge_u32 s8, 1228
    s_cbranch_scc1 .ap_137
    s_waitcnt vmcnt(5)
    s_cmpk_ge_u32 s8, 1163
    s_cbranch_scc1 .ap_137
    s_waitcnt vmcnt(3)
    s_bitcmp1_b64 s[14:15], 29
    s_cbranch_scc0 1
    s_waitcnt vmcnt(2)
    s_cmpk_ge_u32 s8, 1088
    s_cbranch_scc1 .ap_137
    s_waitcnt vmcnt(1)
.ap_137:
    s_add_u32 s63, s69, 434176
    buffer_load_dwordx4 v[124:127], v1, s[40:43], s63 offen nt
    s_memrealtime s[8:9]
    s_waitcnt vmcnt(8)
    s_waitcnt lgkmcnt(0)
    s_sub_u32 s8, s8, s30
    s_cmpk_ge_u32 s8, 1255
    s_cbranch_scc1 .ap_138
    s_waitcnt vmcnt(5)
    s_cmpk_ge_u32 s8, 1190
    s_cbranch_scc1 .ap_138
    s_waitcnt vmcnt(3)
    s_bitcmp1_b64 s[14:15], 30
    s_cbranch_scc0 1
    s_waitcnt vmcnt(2)
    s_cmpk_ge_u32 s8, 1115
    s_cbranch_scc1 .ap_138
    s_waitcnt vmcnt(1)
.ap_138:
    s_add_u32 s63, s69, 442368
    buffer_load_dwordx4 v[152:155], v1, s[40:43], s63 offen nt
    s_memrealtime s[8:9]
    s_waitcnt vmcnt(8)
    s_waitcnt lgkmcnt(0)
    s_sub_u32 s8, s8, s30
    s_cmpk_ge_u32 s8, 1282
    s_cbranch_scc1 .ap_139
    s_waitcnt vmcnt(5)
    s_cmpk_ge_u32 s8, 1217
    s_cbranch_scc1 .ap_139
    s_waitcnt vmcnt(3)
    s_bitcmp1_b64 s[14:15], 31
    s_cbranch_scc0 1
    s_waitcnt vmcnt(2)
    s_cmpk_ge_u32 s8, 1142
    s_cbranch_scc1 .ap_139
    s_waitcnt vmcnt(1)
.ap_139:
    s_add_u32 s63, s69, 450560
    buffer_load_dwordx4 v[156:159], v1, s[40:43], s63 offen nt
    buffer_load_dwordx4 v[16:19], v7, s[36:39], s58 offen offset:0 sc1
    buffer_load_dwordx4 v[20:23], v7, s[36:39], s58 offen offset:16 sc1
    s_memrealtime s[8:9]
    s_waitcnt vmcnt(8)
    s_waitcnt lgkmcnt(0)
    s_sub_u32 s8, s8, s30
    s_cmpk_ge_u32 s8, 1309
    s_cbranch_scc1 .ap_140
    s_waitcnt vmcnt(5)
    s_cmpk_ge_u32 s8, 1244
    s_cbranch_scc1 .ap_140
    s_waitcnt vmcnt(3)
    s_bitcmp1_b64 s[14:15], 32
    s_cbranch_scc0 1
    s_waitcnt vmcnt(2)
    s_cmpk_ge_u32 s8, 1169
    s_cbranch_scc1 .ap_140
    s_waitcnt vmcnt(1)
.ap_140:
    s_add_u32 s63, s69, 0
    buffer_load_dwordx4 v[160:163], v2, s[44:47], s63 offen nt
    s_memrealtime s[8:9]
    s_waitcnt vmcnt(8)
    s_waitcnt lgkmcnt(0)
    s_sub_u32 s8, s8, s30
    s_cmpk_ge_u32 s8, 1336
    s_cbranch_scc1 .ap_141
    s_waitcnt vmcnt(5)
    s_cmpk_ge_u32 s8, 1271
    s_cbranch_scc1 .ap_141
    s_waitcnt vmcnt(3)
    s_bitcmp1_b64 s[14:15], 33
    s_cbranch_scc0 1
    s_waitcnt vmcnt(2)
    s_cmpk_ge_u32 s8, 1196
    s_cbranch_scc1 .ap_141
    s_waitcnt vmcnt(1)
.ap_141:
    s_add_u32 s63, s69, 8192
    buffer_load_dwordx4 v[164:167], v2, s[44:47], s63 offen nt
    s_memrealtime s[8:9]
    s_waitcnt vmcnt(8)
    s_waitcnt lgkmcnt(0)
    s_sub_u32 s8, s8, s30
    s_cmpk_ge_u32 s8, 1363
    s_cbranch_scc1 .ap_142
    s_waitcnt vmcnt(5)
    s_cmpk_ge_u32 s8, 1298
    s_cbranch_scc1 .ap_142
    s_waitcnt vmcnt(3)
    s_bitcmp1_b64 s[14:15], 34
    s_cbranch_scc0 1
    s_waitcnt vmcnt(2)
    s_cmpk_ge_u32 s8, 1223
    s_cbranch_scc1 .ap_142
    s_waitcnt vmcnt(1)
.ap_142:
    s_add_u32 s63, s69, 16384
    buffer_load_dwordx4 v[168:171], v2, s[44:47], s63 offen nt
    s_waitcnt vmcnt(3)
    s_branch .gpc_144
.gp_143:
    buffer_load_dwordx4 v[16:19], v7, s[36:39], s58 offen offset:0 sc1
    buffer_load_dwordx4 v[20:23], v7, s[36:39], s58 offen offset:16 sc1
    s_waitcnt vmcnt(0)
.gpc_144:
    v_min_u32 v10, v17, v19
    v_max_u32 v11, v17, v19
    v_min3_u32 v10, v10, v21, v23
    v_max3_u32 v11, v11, v21, v23
    v_cmp_eq_u32 vcc, s34, v10
    v_cmp_eq_u32 s[56:57], s34, v11
    s_and_b64 vcc, vcc, s[56:57]
    s_cmp_eq_u64 vcc, exec
    s_nop 2
    s_cbranch_scc1 .gpd_145
    s_sub_u32 s35, s35, 1
    s_cbranch_scc1 .Lexit
    s_sleep 1
    s_branch .gp_143
.gpd_145:
    s_mov_b32 vcc_lo, 0xcccccccc
    s_mov_b32 vcc_hi, 0xcccccccc
    v_cndmask_b32_e64 v24, v16, 0, vcc
    v_cndmask_b32_e64 v25, v18, 0, vcc
    v_cndmask_b32_e64 v26, v20, 0, vcc
    v_cndmask_b32_e64 v27, v22, 0, vcc
    v_cndmask_b32_e32 v28, 0, v16, vcc
    v_cndmask_b32_e32 v29, 0, v18, vcc
    v_cndmask_b32_e32 v30, 0, v20, vcc
    v_cndmask_b32_e32 v31, 0, v22, vcc
    v_mfma_f32_16x16x32_bf16 v[16:19], v[32:35], v[24:27], 0
    v_mfma_f32_16x16x32_bf16 v[32:35], v[40:43], v[24:27], 0
    v_mfma_f32_16x16x32_bf16 v[16:19], v[36:39], v[28:31], v[16:19]
    v_mfma_f32_16x16x32_bf16 v[40:43], v[48:51], v[24:27], 0
    v_mfma_f32_16x16x32_bf16 v[32:35], v[44:47], v[28:31], v[32:35]
    v_mfma_f32_16x16x32_bf16 v[48:51], v[56:59], v[24:27], 0
    v_mfma_f32_16x16x32_bf16 v[40:43], v[52:55], v[28:31], v[40:43]
    v_mfma_f32_16x16x32_bf16 v[56:59], v[64:67], v[24:27], 0
    v_mfma_f32_16x16x32_bf16 v[48:51], v[60:63], v[28:31], v[48:51]
    s_nop 1
    v_add_f32_dpp v10, v17, v16 row_ror:12 row_mask:0xf bank_mask:0x1
    s_memrealtime s[8:9]
    s_waitcnt lgkmcnt(0)
    s_sub_u32 s8, s8, s30
    s_cmpk_ge_u32 s8, 1390
    s_nop 0
    s_cbranch_scc1 .ap_146
    s_waitcnt vmcnt(3)
    s_cmpk_ge_u32 s8, 1325
    s_cbranch_scc1 .ap_146
    s_waitcnt vmcnt(3)
    s_bitcmp1_b64 s[14:15], 35
    s_cbranch_scc0 1
    s_waitcnt vmcnt(2)
    s_cmpk_ge_u32 s8, 1250
    s_cbranch_scc1 .ap_146
    s_waitcnt vmcnt(1)
.ap_146:
    s_add_u32 s63, s69, 24576
    buffer_load_dwordx4 v[172:175], v2, s[44:47], s63 offen nt
    v_mfma_f32_16x16x32_bf16 v[64:67], v[72:75], v[24:27], 0
    v_mfma_f32_16x16x32_bf16 v[56:59], v[68:71], v[28:31], v[56:59]
    v_add_f32_dpp v11, v33, v32 row_ror:12 row_mask:0xf bank_mask:0x1
    v_add_f32_dpp v10, v18, v10 row_ror:8 row_mask:0xf bank_mask:0x1
    v_mfma_f32_16x16x32_bf16 v[72:75], v[80:83], v[24:27], 0
    v_mfma_f32_16x16x32_bf16 v[64:67], v[76:79], v[28:31], v[64:67]
    v_add_f32_dpp v12, v41, v40 row_ror:12 row_mask:0xf bank_mask:0x1
    v_add_f32_dpp v11, v34, v11 row_ror:8 row_mask:0xf bank_mask:0x1
    v_add_f32_dpp v10, v19, v10 row_ror:4 row_mask:0xf bank_mask:0x1
    v_mfma_f32_16x16x32_bf16 v[80:83], v[88:91], v[24:27], 0
    v_mfma_f32_16x16x32_bf16 v[72:75], v[84:87], v[28:31], v[72:75]
    v_add_f32_dpp v13, v49, v48 row_ror:12 row_mask:0xf bank_mask:0x1
    v_add_f32_dpp v12, v42, v12 row_ror:8 row_mask:0xf bank_mask:0x1
    v_add_f32_dpp v11, v35, v11 row_ror:4 row_mask:0xf bank_mask:0x1
    v_mfma_f32_16x16x32_bf16 v[88:91], v[96:99], v[24:27], 0
    v_mfma_f32_16x16x32_bf16 v[80:83], v[92:95], v[28:31], v[80:83]
    v_add_f32_dpp v10, v58, v57 row_ror:12 row_mask:0xf bank_mask:0x2
    v_add_f32_dpp v13, v50, v13 row_ror:8 row_mask:0xf bank_mask:0x1
    v_add_f32_dpp v12, v43, v12 row_ror:4 row_mask:0xf bank_mask:0x1
    s_memrealtime s[8:9]
    s_waitcnt lgkmcnt(0)
    s_sub_u32 s8, s8, s30
    s_cmpk_ge_u32 s8, 1417
    s_nop 0
    s_cbranch_scc1 .ap_147
    s_waitcnt vmcnt(4)
    s_cmpk_ge_u32 s8, 1352
    s_cbranch_scc1 .ap_147
    s_waitcnt vmcnt(3)
    s_bitcmp1_b64 s[14:15], 36
    s_cbranch_scc0 1
    s_waitcnt vmcnt(2)
    s_cmpk_ge_u32 s8, 1277
    s_cbranch_scc1 .ap_147
    s_waitcnt vmcnt(1)
.ap_147:
    s_add_u32 s63, s69, 32768
    buffer_load_dwordx4 v[176:179], v2, s[44:47], s63 offen nt
    v_mfma_f32_16x16x32_bf16 v[96:99], v[104:107], v[24:27], 0
    v_mfma_f32_16x16x32_bf16 v[88:91], v[100:103], v[28:31], v[88:91]
    v_add_f32_dpp v11, v66, v65 row_ror:12 row_mask:0xf bank_mask:0x2
    v_add_f32_dpp v10, v59, v10 row_ror:8 row_mask:0xf bank_mask:0x2
    v_add_f32_dpp v13, v51, v13 row_ror:4 row_mask:0xf bank_mask:0x1
    v_mfma_f32_16x16x32_bf16 v[104:107], v[112:115], v[24:27], 0
    v_mfma_f32_16x16x32_bf16 v[96:99], v[108:111], v[28:31], v[96:99]
    v_add_f32_dpp v12, v74, v73 row_ror:12 row_mask:0xf bank_mask:0x2
    v_add_f32_dpp v11, v67, v11 row_ror:8 row_mask:0xf bank_mask:0x2
    v_add_f32_dpp v10, v56, v10 row_ror:4 row_mask:0xf bank_mask:0x2
    v_mfma_f32_16x16x32_bf16 v[112:115], v[120:123], v[24:27], 0
    v_mfma_f32_16x16x32_bf16 v[104:107], v[116:119], v[28:31], v[104:107]
    v_add_f32_dpp v13, v82, v81 row_ror:12 row_mask:0xf bank_mask:0x2
    v_add_f32_dpp v12, v75, v12 row_ror:8 row_mask:0xf bank_mask:0x2
    v_add_f32_dpp v11, v64, v11 row_ror:4 row_mask:0xf bank_mask:0x2
    v_mfma_f32_16x16x32_bf16 v[120:123], v[128:131], v[24:27], 0
    v_mfma_f32_16x16x32_bf16 v[112:115], v[124:127], v[28:31], v[112:115]
    v_add_f32_dpp v10, v91, v90 row_ror:12 row_mask:0xf bank_mask:0x4
    v_add_f32_dpp v13, v83, v13 row_ror:8 row_mask:0xf bank_mask:0x2
    v_add_f32_dpp v12, v72, v12 row_ror:4 row_mask:0xf bank_mask:0x2
    s_memrealtime s[8:9]
    s_waitcnt lgkmcnt(0)
    s_sub_u32 s8, s8, s30
    s_cmpk_ge_u32 s8, 1444
    s_nop 0
    s_cbranch_scc1 .ap_148
    s_waitcnt vmcnt(5)
    s_cmpk_ge_u32 s8, 1379
    s_cbranch_scc1 .ap_148
    s_waitcnt vmcnt(3)
    s_bitcmp1_b64 s[14:15], 37
    s_cbranch_scc0 1
    s_waitcnt vmcnt(2)
    s_cmpk_ge_u32 s8, 1304
    s_cbranch_scc1 .ap_148
    s_waitcnt vmcnt(1)
.ap_148:
    s_add_u32 s63, s69, 40960
    buffer_load_dwordx4 v[180:183], v2, s[44:47], s63 offen nt
    v_mfma_f32_16x16x32_bf16 v[128:131], v[136:139], v[24:27], 0
    v_mfma_f32_16x16x32_bf16 v[120:123], v[132:135], v[28:31], v[120:123]
    v_add_f32_dpp v11, v99, v98 row_ror:12 row_mask:0xf bank_mask:0x4
    v_add_f32_dpp v10, v88, v10 row_ror:8 row_mask:0xf bank_mask:0x4
    v_add_f32_dpp v13, v80, v13 row_ror:4 row_mask:0xf bank_mask:0x2
    v_mfma_f32_16x16x32_bf16 v[136:139], v[144:147], v[24:27], 0
    v_mfma_f32_16x16x32_bf16 v[128:131], v[140:143], v[28:31], v[128:131]
    v_add_f32_dpp v12, v107, v106 row_ror:12 row_mask:0xf bank_mask:0x4
    v_add_f32_dpp v11, v96, v11 row_ror:8 row_mask:0xf bank_mask:0x4
    v_add_f32_dpp v10, v89, v10 row_ror:4 row_mask:0xf bank_mask:0x4
    v_mfma_f32_16x16x32_bf16 v[144:147], v[152:155], v[24:27], 0
    v_mfma_f32_16x16x32_bf16 v[136:139], v[148:151], v[28:31], v[136:139]
    v_add_f32_dpp v13, v115, v114 row_ror:12 row_mask:0xf bank_mask:0x4
    v_add_f32_dpp v12, v104, v12 row_ror:8 row_mask:0xf bank_mask:0x4
    v_add_f32_dpp v11, v97, v11 row_ror:4 row_mask:0xf bank_mask:0x4
    v_mfma_f32_16x16x32_bf16 v[144:147], v[156:159], v[28:31], v[144:147]
    v_add_f32_dpp v10, v120, v123 row_ror:12 row_mask:0xf bank_mask:0x8
    v_add_f32_dpp v13, v112, v13 row_ror:8 row_mask:0xf bank_mask:0x4
    v_add_f32_dpp v12, v105, v12 row_ror:4 row_mask:0xf bank_mask:0x4
    s_memrealtime s[8:9]
    s_waitcnt lgkmcnt(0)
    s_sub_u32 s8, s8, s30
    s_cmpk_ge_u32 s8, 1471
    s_nop 0
    s_cbranch_scc1 .ap_149
    s_waitcnt vmcnt(5)
    s_cmpk_ge_u32 s8, 1406
    s_cbranch_scc1 .ap_149
    s_waitcnt vmcnt(3)
    s_bitcmp1_b64 s[14:15], 38
    s_cbranch_scc0 1
    s_waitcnt vmcnt(2)
    s_cmpk_ge_u32 s8, 1331
    s_cbranch_scc1 .ap_149
    s_waitcnt vmcnt(1)
.ap_149:
    s_add_u32 s63, s69, 49152
    buffer_load_dwordx4 v[184:187], v2, s[44:47], s63 offen nt
    v_add_f32_dpp v11, v128, v131 row_ror:12 row_mask:0xf bank_mask:0x8
    v_add_f32_dpp v10, v121, v10 row_ror:8 row_mask:0xf bank_mask:0x8
    v_add_f32_dpp v13, v113, v13 row_ror:4 row_mask:0xf bank_mask:0x4
    v_add_f32_dpp v12, v136, v139 row_ror:12 row_mask:0xf bank_mask:0x8
    v_add_f32_dpp v11, v129, v11 row_ror:8 row_mask:0xf bank_mask:0x8
    v_add_f32_dpp v10, v122, v10 row_ror:4 row_mask:0xf bank_mask:0x8
    v_add_f32_dpp v13, v144, v147 row_ror:12 row_mask:0xf bank_mask:0x8
    v_add_f32_dpp v12, v137, v12 row_ror:8 row_mask:0xf bank_mask:0x8
    v_add_f32_dpp v11, v130, v11 row_ror:4 row_mask:0xf bank_mask:0x8
    v_add_f32_dpp v13, v145, v13 row_ror:8 row_mask:0xf bank_mask:0x8
    v_add_f32_dpp v12, v138, v12 row_ror:4 row_mask:0xf bank_mask:0x8
    s_memrealtime s[8:9]
    s_waitcnt lgkmcnt(0)
    s_sub_u32 s8, s8, s30
    s_cmpk_ge_u32 s8, 1498
    s_cbranch_scc1 .ap_150
    s_waitcnt vmcnt(5)
    s_cmpk_ge_u32 s8, 1433
    s_cbranch_scc1 .ap_150
    s_waitcnt vmcnt(3)
    s_bitcmp1_b64 s[14:15], 39
    s_cbranch_scc0 1
    s_waitcnt vmcnt(2)
    s_cmpk_ge_u32 s8, 1358
    s_cbranch_scc1 .ap_150
    s_waitcnt vmcnt(1)
.ap_150:
    s_add_u32 s63, s69, 57344
    buffer_load_dwordx4 v[188:191], v2, s[44:47], s63 offen nt
    v_add_f32_dpp v13, v146, v13 row_ror:4 row_mask:0xf bank_mask:0x8
    s_mov_b32 s60, 0x3db504f3
    s_mov_b32 s61, 0x3db504f3
    v_cvt_pk_bf16_f32 v10, 0, v10
    v_cvt_pk_bf16_f32 v11, 0, v11
    v_cvt_pk_bf16_f32 v12, 0, v12
    v_cvt_pk_bf16_f32 v13, 0, v13
    v_pk_mul_f32 v[10:11], v[10:11], s[60:61]
    v_pk_mul_f32 v[12:13], v[12:13], s[60:61]
    v_cvt_pk_bf16_f32 v10, 0, v10
    v_cvt_pk_bf16_f32 v11, 0, v11
    v_cvt_pk_bf16_f32 v12, 0, v12
    v_cvt_pk_bf16_f32 v13, 0, v13
    v_max_f32 v14, v10, v11
    v_max3_f32 v14, v14, v12, v13
    s_mov_b32 s60, 0x3fb8aa3b
    v_mov_b32 v22, s34
    v_mov_b32 v23, s34
    v_max_f32_dpp v14, v14, v14 quad_perm:[2,3,0,1] row_mask:0xf bank_mask:0xf
    s_nop 1
    v_max_f32_dpp v14, v14, v14 row_ror:4 row_mask:0xf bank_mask:0xf
    s_nop 1
    v_max_f32_dpp v14, v14, v14 row_ror:8 row_mask:0xf bank_mask:0xf
    v_mov_b32 v15, v14
    s_nop 1
    v_permlane16_swap_b32 v15, v14
    v_max_f32 v14, v15, v14
    v_mov_b32 v15, v14
    s_nop 1
    v_permlane32_swap_b32 v15, v14
    v_max_f32 v14, v15, v14
    v_mul_f32 v15, 0xbfb8aa3b, v14
    v_fma_f32 v10, v10, s60, v15
    v_fma_f32 v11, v11, s60, v15
    v_fma_f32 v12, v12, s60, v15
    v_fma_f32 v13, v13, s60, v15
    v_exp_f32 v10, v10
    v_exp_f32 v11, v11
    v_exp_f32 v12, v12
    v_exp_f32 v13, v13
    v_mov_b32 v20, v14
    v_pk_add_f32 v[16:17], v[10:11], v[12:13]
    v_add_f32 v21, v16, v17
    s_lshl3_add_u32 s60, s68, s3
    s_lshl_b32 s60, s60, 5
    s_add_u32 s60, s60, s59
    v_add_f32_dpp v21, v21, v21 quad_perm:[2,3,0,1] row_mask:0xf bank_mask:0xf
    s_nop 1
    v_add_f32_dpp v21, v21, v21 row_ror:4 row_mask:0xf bank_mask:0xf
    s_nop 1
    v_add_f32_dpp v21, v21, v21 row_ror:8 row_mask:0xf bank_mask:0xf
    v_mov_b32 v15, v21
    s_nop 1
    v_permlane16_swap_b32 v15, v21
    v_add_f32 v21, v15, v21
    v_mov_b32 v15, v21
    s_nop 1
    v_permlane32_swap_b32 v15, v21
    v_add_f32 v21, v15, v21
    s_lshl_b32 s60, s3, 4
    s_add_u32 s60, s60, 159104
    v_add_u32 v16, s60, v3
    v_mov_b32 v17, 159232
    v_mov_b32 v18, 1
    s_mov_b64 exec, 3
    ds_write_b64 v16, v[20:21]
    s_mov_b64 exec, 1
    s_waitcnt lgkmcnt(0)
    ds_add_rtn_u32 v18, v17, v18
    s_mov_b64 exec, -1
    v_and_b32 v16, 0x78, v3
    v_add_u32 v16, 159104, v16
    s_waitcnt lgkmcnt(0)
    v_readfirstlane_b32 s60, v18
    s_cmp_lg_u32 s60, 7
    s_nop 3
    s_cbranch_scc1 .ml_151
    ds_read_b64 v[18:19], v16
    s_lshl_b32 s60, s68, 7
    s_add_u32 s60, s60, s59
    s_waitcnt lgkmcnt(0)
    v_mov_b32 v20, v18
    s_nop 1
    v_max_f32_dpp v20, v20, v20 quad_perm:[2,3,0,1] row_mask:0xf bank_mask:0xf
    s_nop 1
    v_max_f32_dpp v20, v20, v20 row_ror:4 row_mask:0xf bank_mask:0xf
    s_nop 1
    v_max_f32_dpp v20, v20, v20 row_ror:8 row_mask:0xf bank_mask:0xf
    v_sub_f32 v18, v18, v20
    v_mul_f32 v18, 0x3fb8aa3b, v18
    v_exp_f32 v18, v18
    s_nop 0
    v_mul_f32 v21, v18, v19
    s_nop 1
    v_add_f32_dpp v21, v21, v21 quad_perm:[2,3,0,1] row_mask:0xf bank_mask:0xf
    s_nop 1
    v_add_f32_dpp v21, v21, v21 row_ror:4 row_mask:0xf bank_mask:0xf
    s_nop 1
    v_add_f32_dpp v21, v21, v21 row_ror:8 row_mask:0xf bank_mask:0xf
    s_mov_b64 exec, 0xff
    buffer_store_dwordx4 v[20:23], v2, s[36:39], s60 offen sc1
    s_mov_b64 exec, -1
.ml_151:
    s_memrealtime s[8:9]
    s_waitcnt lgkmcnt(0)
    s_sub_u32 s8, s8, s30
    s_cmpk_ge_u32 s8, 1525
    s_cbranch_scc1 .ap_152
    s_waitcnt vmcnt(5)
    s_cmpk_ge_u32 s8, 1460
    s_cbranch_scc1 .ap_152
    s_waitcnt vmcnt(3)
    s_bitcmp1_b64 s[14:15], 40
    s_cbranch_scc0 1
    s_waitcnt vmcnt(2)
    s_cmpk_ge_u32 s8, 1385
    s_cbranch_scc1 .ap_152
    s_waitcnt vmcnt(1)
.ap_152:
    s_add_u32 s63, s69, 131072
    buffer_load_dwordx4 v[192:195], v2, s[44:47], s63 offen nt
    s_sub_u32 s57, s65, 9
    s_bitcmp1_b32 s57, 0
    s_cselect_b32 s48, s20, s18
    s_cselect_b32 s49, s21, s19
    s_cselect_b32 s33, 36, 0
    s_and_b32 s49, s49, 0xffff
    s_mov_b32 s50, 0x510000
    s_mov_b32 s51, 0x00020000
    s_mov_b32 s52, s22
    s_and_b32 s53, s23, 0xffff
    s_mov_b32 s54, 0x510000
    s_mov_b32 s55, 0x00020000
    s_lshr_b32 s57, s57, 1
    s_lshl_b32 s57, s57, 7
    s_mul_i32 s101, s64, 1152
    s_add_u32 s101, s101, s57
    s_mul_i32 s56, s3, 73728
    s_add_u32 s101, s101, s56
    s_mul_i32 s56, s64, 72
    s_add_u32 s33, s33, s56
    s_add_u32 s33, s33, s3
    s_mul_i32 s33, s33, 9216
    s_add_u32 s33, s33, s57
    s_bfe_u32 s56, s101, 0x30007
    s_cmp_eq_u32 s56, 3
    s_cselect_b32 s43, 1, 0
    v_bfe_u32 v16, v0, 4, 1
    s_and_b32 s56, s3, 3
    s_lshl_b32 s56, s56, 1
    v_or_b32 v16, s56, v16
    v_and_b32 v6, 7, v0
    v_xor_b32 v16, v16, v6
    v_lshrrev_b32 v6, 3, v0
    v_mul_u32_u24 v6, 9216, v6
    v_lshl_add_u32 v6, v16, 4, v6
    v_bfe_u32 v16, v0, 4, 1
    s_and_b32 s56, s3, 1
    s_lshl_b32 s56, s56, 2
    v_lshl_or_b32 v16, v16, 1, s56
    v_and_b32 v17, 7, v0
    v_xor_b32 v16, v16, v17
    v_lshrrev_b32 v17, 3, v0
    v_mul_u32_u24 v17, 1152, v17
    v_lshl_add_u32 v31, v16, 4, v17
    s_memrealtime s[8:9]
    s_waitcnt vmcnt(8)
    s_waitcnt lgkmcnt(0)
    s_sub_u32 s8, s8, s30
    s_cmpk_ge_u32 s8, 1552
    s_cbranch_scc1 .ap_153
    s_waitcnt vmcnt(5)
    s_cmpk_ge_u32 s8, 1487
    s_cbranch_scc1 .ap_153
    s_waitcnt vmcnt(3)
    s_bitcmp1_b64 s[14:15], 41
    s_cbranch_scc0 1
    s_waitcnt vmcnt(2)
    s_cmpk_ge_u32 s8, 1412
    s_cbranch_scc1 .ap_153
    s_waitcnt vmcnt(1)
.ap_153:
    s_add_u32 s63, s69, 139264
    buffer_load_dwordx4 v[196:199], v2, s[44:47], s63 offen nt
    s_memrealtime s[8:9]
    s_waitcnt vmcnt(8)
    s_waitcnt lgkmcnt(0)
    s_sub_u32 s8, s8, s30
    s_cmpk_ge_u32 s8, 1579
    s_cbranch_scc1 .ap_154
    s_waitcnt vmcnt(5)
    s_cmpk_ge_u32 s8, 1514
    s_cbranch_scc1 .ap_154
    s_waitcnt vmcnt(3)
    s_bitcmp1_b64 s[14:15], 42
    s_cbranch_scc0 1
    s_waitcnt vmcnt(2)
    s_cmpk_ge_u32 s8, 1439
    s_cbranch_scc1 .ap_154
    s_waitcnt vmcnt(1)
.ap_154:
    s_add_u32 s63, s69, 147456
    buffer_load_dwordx4 v[200:203], v2, s[44:47], s63 offen nt
    s_memrealtime s[8:9]
    s_waitcnt vmcnt(8)
    s_waitcnt lgkmcnt(0)
    s_sub_u32 s8, s8, s30
    s_cmpk_ge_u32 s8, 1606
    s_cbranch_scc1 .ap_155
    s_waitcnt vmcnt(5)
    s_cmpk_ge_u32 s8, 1541
    s_cbranch_scc1 .ap_155
    s_waitcnt vmcnt(3)
    s_bitcmp1_b64 s[14:15], 43
    s_cbranch_scc0 1
    s_waitcnt vmcnt(2)
    s_cmpk_ge_u32 s8, 1466
    s_cbranch_scc1 .ap_155
    s_waitcnt vmcnt(1)
.ap_155:
    s_add_u32 s63, s69, 155648
    buffer_load_dwordx4 v[204:207], v2, s[44:47], s63 offen nt
    s_memrealtime s[8:9]
    s_waitcnt vmcnt(8)
    s_waitcnt lgkmcnt(0)
    s_sub_u32 s8, s8, s30
    s_cmpk_ge_u32 s8, 1633
    s_cbranch_scc1 .ap_156
    s_waitcnt vmcnt(5)
    s_cmpk_ge_u32 s8, 1568
    s_cbranch_scc1 .ap_156
    s_waitcnt vmcnt(3)
    s_bitcmp1_b64 s[14:15], 44
    s_cbranch_scc0 1
    s_waitcnt vmcnt(2)
    s_cmpk_ge_u32 s8, 1493
    s_cbranch_scc1 .ap_156
    s_waitcnt vmcnt(1)
.ap_156:
    s_add_u32 s63, s69, 163840
    buffer_load_dwordx4 v[208:211], v2, s[44:47], s63 offen nt
    s_memrealtime s[8:9]
    s_waitcnt vmcnt(8)
    s_waitcnt lgkmcnt(0)
    s_sub_u32 s8, s8, s30
    s_cmpk_ge_u32 s8, 1660
    s_cbranch_scc1 .ap_157
    s_waitcnt vmcnt(5)
    s_cmpk_ge_u32 s8, 1595
    s_cbranch_scc1 .ap_157
    s_waitcnt vmcnt(3)
    s_bitcmp1_b64 s[14:15], 45
    s_cbranch_scc0 1
    s_waitcnt vmcnt(2)
    s_cmpk_ge_u32 s8, 1520
    s_cbranch_scc1 .ap_157
    s_waitcnt vmcnt(1)
.ap_157:
    s_add_u32 s63, s69, 172032
    buffer_load_dwordx4 v[212:215], v2, s[44:47], s63 offen nt
    s_memrealtime s[8:9]
    s_waitcnt vmcnt(8)
    s_waitcnt lgkmcnt(0)
    s_sub_u32 s8, s8, s30
    s_cmpk_ge_u32 s8, 1691
    s_cbranch_scc1 .ap_158
    s_waitcnt vmcnt(5)
    s_cmpk_ge_u32 s8, 1626
    s_cbranch_scc1 .ap_158
    s_waitcnt vmcnt(3)
    s_bitcmp1_b64 s[14:15], 46
    s_cbranch_scc0 1
    s_waitcnt vmcnt(2)
    s_cmpk_ge_u32 s8, 1551
    s_cbranch_scc1 .ap_158
    s_waitcnt vmcnt(1)
.ap_158:
    s_add_u32 s63, s69, 180224
    buffer_load_dwordx4 v[216:219], v2, s[44:47], s63 offen nt
    s_memrealtime s[8:9]
    s_waitcnt vmcnt(8)
    s_waitcnt lgkmcnt(0)
    s_sub_u32 s8, s8, s30
    s_cmpk_ge_u32 s8, 1722
    s_cbranch_scc1 .ap_159
    s_waitcnt vmcnt(5)
    s_cmpk_ge_u32 s8, 1657
    s_cbranch_scc1 .ap_159
    s_waitcnt vmcnt(3)
    s_bitcmp1_b64 s[14:15], 47
    s_cbranch_scc0 1
    s_waitcnt vmcnt(2)
    s_cmpk_ge_u32 s8, 1582
    s_cbranch_scc1 .ap_159
    s_waitcnt vmcnt(1)
.ap_159:
    s_add_u32 s63, s69, 188416
    buffer_load_dwordx4 v[220:223], v2, s[44:47], s63 offen nt
    s_mul_i32 s99, s3, 2304
    s_add_u32 s99, s99, 0x1e000
    buffer_load_dwordx4 v[32:35], v2, s[36:39], s99 offen offset:0
    buffer_load_dwordx4 v[40:43], v2, s[36:39], s99 offen offset:1024
    buffer_load_dwordx2 v[48:49], v5, s[36:39], s99 offen offset:0
    s_memrealtime s[8:9]
    s_waitcnt vmcnt(11)
    s_waitcnt lgkmcnt(0)
    s_sub_u32 s8, s8, s30
    s_cmpk_ge_u32 s8, 1753
    s_cbranch_scc1 .ap_160
    s_waitcnt vmcnt(8)
    s_cmpk_ge_u32 s8, 1688
    s_cbranch_scc1 .ap_160
    s_waitcnt vmcnt(6)
    s_bitcmp1_b64 s[14:15], 48
    s_cbranch_scc0 1
    s_waitcnt vmcnt(5)
    s_cmpk_ge_u32 s8, 1613
    s_cbranch_scc1 .ap_160
    s_waitcnt vmcnt(4)
.ap_160:
    s_add_u32 s63, s69, 262144
    buffer_load_dwordx4 v[224:227], v2, s[44:47], s63 offen nt
    s_memrealtime s[8:9]
    s_waitcnt vmcnt(11)
    s_waitcnt lgkmcnt(0)
    s_sub_u32 s8, s8, s30
    s_cmpk_ge_u32 s8, 1784
    s_cbranch_scc1 .ap_161
    s_waitcnt vmcnt(8)
    s_cmpk_ge_u32 s8, 1719
    s_cbranch_scc1 .ap_161
    s_waitcnt vmcnt(6)
    s_bitcmp1_b64 s[14:15], 49
    s_cbranch_scc0 1
    s_waitcnt vmcnt(5)
    s_cmpk_ge_u32 s8, 1644
    s_cbranch_scc1 .ap_161
    s_waitcnt vmcnt(4)
.ap_161:
    s_add_u32 s63, s69, 270336
    buffer_load_dwordx4 v[228:231], v2, s[44:47], s63 offen nt
    s_mul_i32 s100, s3, 2304
    s_add_u32 s100, s100, 0x27000
    buffer_load_dwordx4 v[56:59], v2, s[36:39], s100 offen offset:0
    buffer_load_dwordx4 v[64:67], v2, s[36:39], s100 offen offset:1024
    buffer_load_dwordx2 v[50:51], v5, s[36:39], s100 offen offset:0
    s_memrealtime s[8:9]
    s_waitcnt vmcnt(14)
    s_waitcnt lgkmcnt(0)
    s_sub_u32 s8, s8, s30
    s_cmpk_ge_u32 s8, 1815
    s_cbranch_scc1 .ap_162
    s_waitcnt vmcnt(11)
    s_cmpk_ge_u32 s8, 1750
    s_cbranch_scc1 .ap_162
    s_waitcnt vmcnt(9)
    s_bitcmp1_b64 s[14:15], 50
    s_cbranch_scc0 1
    s_waitcnt vmcnt(8)
    s_cmpk_ge_u32 s8, 1675
    s_cbranch_scc1 .ap_162
    s_waitcnt vmcnt(4)
.ap_162:
    s_add_u32 s63, s69, 278528
    buffer_load_dwordx4 v[232:235], v2, s[44:47], s63 offen nt
    s_memrealtime s[8:9]
    s_waitcnt vmcnt(14)
    s_waitcnt lgkmcnt(0)
    s_sub_u32 s8, s8, s30
    s_cmpk_ge_u32 s8, 1846
    s_cbranch_scc1 .ap_163
    s_waitcnt vmcnt(11)
    s_cmpk_ge_u32 s8, 1781
    s_cbranch_scc1 .ap_163
    s_waitcnt vmcnt(9)
    s_bitcmp1_b64 s[14:15], 51
    s_cbranch_scc0 1
    s_waitcnt vmcnt(5)
    s_cmpk_ge_u32 s8, 1706
    s_cbranch_scc1 .ap_163
    s_waitcnt vmcnt(4)
.ap_163:
    s_add_u32 s63, s69, 286720
    buffer_load_dwordx4 v[236:239], v2, s[44:47], s63 offen nt
    s_memrealtime s[8:9]
    s_waitcnt vmcnt(14)
    s_waitcnt lgkmcnt(0)
    s_sub_u32 s8, s8, s30
    s_cmpk_ge_u32 s8, 1877
    s_cbranch_scc1 .ap_164
    s_waitcnt vmcnt(11)
    s_cmpk_ge_u32 s8, 1812
    s_cbranch_scc1 .ap_164
    s_waitcnt vmcnt(6)
    s_bitcmp1_b64 s[14:15], 52
    s_cbranch_scc0 1
    s_waitcnt vmcnt(5)
    s_cmpk_ge_u32 s8, 1737
    s_cbranch_scc1 .ap_164
    s_waitcnt vmcnt(1)
.ap_164:
    s_add_u32 s63, s69, 294912
    buffer_load_dwordx4 v[240:243], v2, s[44:47], s63 offen nt
    s_memrealtime s[8:9]
    s_waitcnt vmcnt(14)
    s_waitcnt lgkmcnt(0)
    s_sub_u32 s8, s8, s30
    s_cmpk_ge_u32 s8, 1908
    s_cbranch_scc1 .ap_165
    s_waitcnt vmcnt(11)
    s_cmpk_ge_u32 s8, 1843
    s_cbranch_scc1 .ap_165
    s_waitcnt vmcnt(6)
    s_bitcmp1_b64 s[14:15], 53
    s_cbranch_scc0 1
    s_waitcnt vmcnt(2)
    s_cmpk_ge_u32 s8, 1768
    s_cbranch_scc1 .ap_165
    s_waitcnt vmcnt(1)
.ap_165:
    s_add_u32 s63, s69, 303104
    buffer_load_dwordx4 v[244:247], v2, s[44:47], s63 offen nt
    s_load_dwordx2 s[88:89], s[6:7], s0
    buffer_load_dwordx4 v[24:27], v9, s[36:39], s59 offen offset:0 sc1
    s_memrealtime s[8:9]
    s_waitcnt vmcnt(14)
    s_waitcnt lgkmcnt(0)
    s_sub_u32 s8, s8, s30
    s_cmpk_ge_u32 s8, 1939
    s_cbranch_scc1 .ap_166
    s_waitcnt vmcnt(8)
    s_cmpk_ge_u32 s8, 1874
    s_cbranch_scc1 .ap_166
    s_waitcnt vmcnt(3)
    s_bitcmp1_b64 s[14:15], 54
    s_cbranch_scc0 1
    s_waitcnt vmcnt(2)
    s_cmpk_ge_u32 s8, 1799
    s_cbranch_scc1 .ap_166
    s_waitcnt vmcnt(1)
.ap_166:
    s_add_u32 s63, s69, 311296
    buffer_load_dwordx4 v[248:251], v2, s[44:47], s63 offen nt
    s_memrealtime s[8:9]
    s_waitcnt vmcnt(14)
    s_waitcnt lgkmcnt(0)
    s_sub_u32 s8, s8, s30
    s_cmpk_ge_u32 s8, 1970
    s_cbranch_scc1 .ap_167
    s_waitcnt vmcnt(5)
    s_cmpk_ge_u32 s8, 1905
    s_cbranch_scc1 .ap_167
    s_waitcnt vmcnt(3)
    s_bitcmp1_b64 s[14:15], 55
    s_cbranch_scc0 1
    s_waitcnt vmcnt(2)
    s_cmpk_ge_u32 s8, 1830
    s_cbranch_scc1 .ap_167
    s_waitcnt vmcnt(1)
.ap_167:
    s_add_u32 s63, s69, 319488
    buffer_load_dwordx4 v[252:255], v2, s[44:47], s63 offen nt
    s_memrealtime s[8:9]
    s_waitcnt vmcnt(11)
    s_waitcnt lgkmcnt(0)
    s_sub_u32 s8, s8, s30
    s_cmpk_ge_u32 s8, 2001
    s_cbranch_scc1 .ap_168
    s_waitcnt vmcnt(5)
    s_cmpk_ge_u32 s8, 1936
    s_cbranch_scc1 .ap_168
    s_waitcnt vmcnt(3)
    s_bitcmp1_b64 s[14:15], 56
    s_cbranch_scc0 1
    s_waitcnt vmcnt(2)
    s_cmpk_ge_u32 s8, 1861
    s_cbranch_scc1 .ap_168
    s_waitcnt vmcnt(1)
.ap_168:
    s_add_u32 s63, s69, 393216
    buffer_load_dwordx4 v[36:39], v2, s[44:47], s63 offen nt
    s_memrealtime s[8:9]
    s_waitcnt vmcnt(11)
    s_waitcnt lgkmcnt(0)
    s_sub_u32 s8, s8, s30
    s_cmpk_ge_u32 s8, 2032
    s_cbranch_scc1 .ap_169
    s_waitcnt vmcnt(5)
    s_cmpk_ge_u32 s8, 1967
    s_cbranch_scc1 .ap_169
    s_waitcnt vmcnt(3)
    s_bitcmp1_b64 s[14:15], 57
    s_cbranch_scc0 1
    s_waitcnt vmcnt(2)
    s_cmpk_ge_u32 s8, 1892
    s_cbranch_scc1 .ap_169
    s_waitcnt vmcnt(1)
.ap_169:
    s_add_u32 s63, s69, 401408
    buffer_load_dwordx4 v[44:47], v2, s[44:47], s63 offen nt
    s_memrealtime s[8:9]
    s_waitcnt vmcnt(8)
    s_waitcnt lgkmcnt(0)
    s_sub_u32 s8, s8, s30
    s_cmpk_ge_u32 s8, 2063
    s_cbranch_scc1 .ap_170
    s_waitcnt vmcnt(5)
    s_cmpk_ge_u32 s8, 1998
    s_cbranch_scc1 .ap_170
    s_waitcnt vmcnt(3)
    s_bitcmp1_b64 s[14:15], 58
    s_cbranch_scc0 1
    s_waitcnt vmcnt(2)
    s_cmpk_ge_u32 s8, 1923
    s_cbranch_scc1 .ap_170
    s_waitcnt vmcnt(1)
.ap_170:
    s_add_u32 s63, s69, 409600
    buffer_load_dwordx4 v[52:55], v2, s[44:47], s63 offen nt
    s_waitcnt vmcnt(5)
    s_branch .gpc_172
.gp_171:
    buffer_load_dwordx4 v[24:27], v9, s[36:39], s59 offen offset:0 sc1
    s_waitcnt vmcnt(0)
.gpc_172:
    v_cmp_eq_u32 vcc, s34, v26
    s_cmp_eq_u64 vcc, exec
    s_nop 3
    s_cbranch_scc1 .gpd_173
    s_sub_u32 s35, s35, 1
    s_cbranch_scc1 .Lexit
    s_sleep 1
    s_branch .gp_171
.gpd_173:
    s_lshr_b64 s[88:89], s[88:89], s1
    s_and_b32 s88, s88, 0xff
    s_cmp_eq_u32 s88, 32
    s_cselect_b32 s0, 0xac000, 0
    v_mov_b32 v16, v24
    s_nop 1
    v_max_f32_dpp v16, v16, v16 quad_perm:[2,3,0,1] row_mask:0xf bank_mask:0xf
    v_sub_f32 v17, v24, v16
    v_sub_f32 v18, v14, v16
    v_mul_f32 v17, 0x3fb8aa3b, v17
    v_mul_f32 v18, 0x3fb8aa3b, v18
    v_exp_f32 v17, v17
    v_exp_f32 v18, v18
    v_mul_f32 v17, v17, v25
    s_nop 1
    v_add_f32_dpp v17, v17, v17 quad_perm:[2,3,0,1] row_mask:0xf bank_mask:0xf
    v_rcp_f32 v19, v17
    s_nop 0
    v_fma_f32 v15, -v17, v19, 1.0
    v_fma_f32 v19, v15, v19, v19
    v_mul_f32 v18, v18, v19
    v_mul_f32 v10, v10, v18
    v_mul_f32 v11, v11, v18
    v_mul_f32 v12, v12, v18
    v_mul_f32 v13, v13, v18
    v_mov_b32_dpp v112, v10 quad_perm:[2,3,0,1] row_mask:0xf bank_mask:0xf
    v_mov_b32_dpp v113, v11 quad_perm:[2,3,0,1] row_mask:0xf bank_mask:0xf
    v_mov_b32_dpp v114, v12 quad_perm:[2,3,0,1] row_mask:0xf bank_mask:0xf
    v_mov_b32_dpp v115, v13 quad_perm:[2,3,0,1] row_mask:0xf bank_mask:0xf
    v_cvt_pk_bf16_f32 v96, v10, v112
    v_cvt_pk_bf16_f32 v100, v11, v113
    v_cvt_pk_bf16_f32 v104, v12, v114
    v_cvt_pk_bf16_f32 v108, v13, v115
    v_mov_b32_dpp v97, v96 row_ror:12 row_mask:0xf bank_mask:0xf
    v_mov_b32_dpp v101, v100 row_ror:12 row_mask:0xf bank_mask:0xf
    v_mov_b32_dpp v105, v104 row_ror:12 row_mask:0xf bank_mask:0xf
    v_mov_b32_dpp v109, v108 row_ror:12 row_mask:0xf bank_mask:0xf
    v_mov_b32_dpp v98, v96 row_ror:8 row_mask:0xf bank_mask:0xf
    v_mov_b32_dpp v102, v100 row_ror:8 row_mask:0xf bank_mask:0xf
    v_mov_b32_dpp v106, v104 row_ror:8 row_mask:0xf bank_mask:0xf
    v_mov_b32_dpp v110, v108 row_ror:8 row_mask:0xf bank_mask:0xf
    v_mov_b32_dpp v99, v96 row_ror:4 row_mask:0xf bank_mask:0xf
    v_mov_b32_dpp v103, v100 row_ror:4 row_mask:0xf bank_mask:0xf
    v_mov_b32_dpp v107, v104 row_ror:4 row_mask:0xf bank_mask:0xf
    v_mov_b32_dpp v111, v108 row_ror:4 row_mask:0xf bank_mask:0xf
    v_mov_b32_dpp v96, v96 row_shr:3 row_mask:0xf bank_mask:0x2
    v_mov_b32_dpp v97, v97 row_shr:3 row_mask:0xf bank_mask:0x2
    v_mov_b32_dpp v98, v98 row_shr:3 row_mask:0xf bank_mask:0x2
    v_mov_b32_dpp v99, v99 row_shr:3 row_mask:0xf bank_mask:0x2
    v_mov_b32_dpp v100, v100 row_shr:3 row_mask:0xf bank_mask:0x2
    v_mov_b32_dpp v101, v101 row_shr:3 row_mask:0xf bank_mask:0x2
    v_mov_b32_dpp v102, v102 row_shr:3 row_mask:0xf bank_mask:0x2
    v_mov_b32_dpp v103, v103 row_shr:3 row_mask:0xf bank_mask:0x2
    v_mov_b32_dpp v104, v104 row_shr:3 row_mask:0xf bank_mask:0x2
    v_mov_b32_dpp v105, v105 row_shr:3 row_mask:0xf bank_mask:0x2
    v_mov_b32_dpp v106, v106 row_shr:3 row_mask:0xf bank_mask:0x2
    v_mov_b32_dpp v107, v107 row_shr:3 row_mask:0xf bank_mask:0x2
    v_mov_b32_dpp v108, v108 row_shr:3 row_mask:0xf bank_mask:0x2
    v_mov_b32_dpp v109, v109 row_shr:3 row_mask:0xf bank_mask:0x2
    v_mov_b32_dpp v110, v110 row_shr:3 row_mask:0xf bank_mask:0x2
    v_mov_b32_dpp v111, v111 row_shr:3 row_mask:0xf bank_mask:0x2
    s_memrealtime s[8:9]
    s_waitcnt lgkmcnt(0)
    s_sub_u32 s8, s8, s30
    s_cmpk_ge_u32 s8, 2094
    s_cbranch_scc1 .ap_174
    s_waitcnt vmcnt(5)
    s_cmpk_ge_u32 s8, 2029
    s_cbranch_scc1 .ap_174
    s_waitcnt vmcnt(3)
    s_bitcmp1_b64 s[14:15], 59
    s_cbranch_scc0 1
    s_waitcnt vmcnt(2)
    s_cmpk_ge_u32 s8, 1954
    s_cbranch_scc1 .ap_174
    s_waitcnt vmcnt(1)
.ap_174:
    s_add_u32 s63, s69, 417792
    buffer_load_dwordx4 v[60:63], v2, s[44:47], s63 offen nt
    s_lshl_b32 s60, s3, 10
    s_add_u32 s60, s60, 132096
    v_lshlrev_b32 v10, 5, v0
    v_add_u32 v10, s60, v10
    v_lshrrev_b32 v11, 5, v0
    v_lshlrev_b32 v11, 13, v11
    v_and_b32 v12, 31, v0
    v_lshl_add_u32 v11, v12, 4, v11
    v_add_u32 v9, 132096, v2
    v_mov_b32 v15, s34
    v_mov_b32 v13, 110592
    s_mov_b32 s1, s43
    v_bfe_u32 v16, v0, 1, 3
    v_mul_u32_u24 v16, 1312, v16
    v_lshrrev_b32 v7, 4, v0
    v_lshl_add_u32 v16, v7, 5, v16
    v_and_b32 v7, 1, v0
    v_lshl_add_u32 v16, v7, 4, v16
    v_add_u32 v16, 147456, v16
    s_mul_i32 s56, s3, 1312
    s_add_u32 s56, s56, 147456
    v_add_u32 v17, s56, v3
    v_add_u32 v18, s56, v4
    v_lshrrev_b32 v7, 4, v0
    v_bfe_u32 v8, v0, 1, 1
    v_lshl_add_u32 v7, v7, 1, v8
    v_bfe_u32 v8, v0, 2, 2
    v_lshl_add_u32 v19, v7, 3, v8
    v_lshlrev_b32 v19, 7, v19
    v_and_b32 v7, 3, v7
    v_lshrrev_b32 v8, 1, v8
    v_lshl_add_u32 v7, v7, 1, v8
    v_xor_b32 v7, s3, v7
    v_lshl_add_u32 v19, v7, 4, v19
    v_and_b32 v7, 1, v0
    v_lshl_add_u32 v19, v7, 3, v19
    v_add_u32 v20, 32768, v19
    v_lshrrev_b32 v7, 4, v0
    v_bfe_u32 v8, v0, 2, 2
    v_lshl_add_u32 v21, v7, 3, v8
    v_lshlrev_b32 v21, 7, v21
    v_and_b32 v7, 1, v7
    v_lshrrev_b32 v8, 1, v8
    v_lshl_add_u32 v7, v7, 1, v8
    s_and_b32 s56, s3, 1
    s_lshl_b32 s56, s56, 1
    v_xor_b32 v7, s56, v7
    v_and_b32 v8, 3, v0
    v_lshl_add_u32 v21, v8, 3, v21
    s_lshr_b32 s56, s3, 1
    s_mul_i32 s56, s56, 12288
    s_add_u32 s56, s56, 73728
    v_add_u32 v21, s56, v21
    v_xor_b32 v8, 1, v7
    v_lshl_add_u32 v22, v8, 5, v21
    v_lshl_add_u32 v21, v7, 5, v21
    v_bfe_u32 v7, v0, 1, 3
    v_mul_u32_u24 v23, 1312, v7
    v_mul_u32_u24 v24, 272, v7
    v_and_b32 v7, 48, v0
    s_lshr_b32 s56, s3, 1
    s_mul_i32 s57, s56, 192
    s_add_u32 s57, s57, 110592
    v_add3_u32 v23, v23, v7, s57
    s_mul_i32 s56, s56, 2176
    s_and_b32 s57, s3, 1
    s_lshl_b32 s57, s57, 7
    s_add_u32 s56, s56, s57
    s_add_u32 s56, s56, 122880
    v_add3_u32 v24, v24, v7, s56
    v_and_b32 v7, 1, v0
    v_lshl_add_u32 v24, v7, 6, v24
    v_and_b32 v7, 15, v0
    s_mul_i32 s56, s3, 272
    s_add_u32 s56, s56, 122880
    v_lshl_add_u32 v25, v7, 4, s56
    v_bfe_u32 v26, v0, 1, 4
    v_lshlrev_b32 v26, 4, v26
    s_mul_i32 s56, s3, 72
    v_add_u32 v7, s56, v0
    v_lshrrev_b32 v8, 4, v7
    v_lshlrev_b32 v27, 9, v8
    v_and_b32 v29, 15, v7
    v_lshl_add_u32 v27, v29, 4, v27
    v_and_b32 v29, 7, v7
    v_mul_u32_u24 v29, 1312, v29
    v_and_b32 v7, -8, v7
    v_add3_u32 v29, v29, v7, v13
    v_and_b32 v7, 7, v0
    v_add3_u32 v7, v7, s56, 64
    v_lshrrev_b32 v8, 4, v7
    v_lshlrev_b32 v28, 9, v8
    v_and_b32 v30, 15, v7
    v_lshl_add_u32 v28, v30, 4, v28
    v_and_b32 v30, 7, v7
    v_mul_u32_u24 v30, 1312, v30
    v_and_b32 v7, -8, v7
    v_add3_u32 v30, v30, v7, v13
    s_memrealtime s[8:9]
    s_waitcnt lgkmcnt(0)
    s_sub_u32 s8, s8, s30
    s_cmpk_ge_u32 s8, 2125
    s_cbranch_scc1 .ap_175
    s_waitcnt vmcnt(5)
    s_cmpk_ge_u32 s8, 2060
    s_cbranch_scc1 .ap_175
    s_waitcnt vmcnt(3)
    s_bitcmp1_b64 s[14:15], 60
    s_cbranch_scc0 1
    s_waitcnt vmcnt(2)
    s_cmpk_ge_u32 s8, 1985
    s_cbranch_scc1 .ap_175
    s_waitcnt vmcnt(1)
.ap_175:
    s_add_u32 s63, s69, 425984
    buffer_load_dwordx4 v[68:71], v2, s[44:47], s63 offen nt
    v_perm_b32 v112, v164, v160, s94
    v_perm_b32 v113, v172, v168, s94
    v_perm_b32 v114, v180, v176, s94
    v_perm_b32 v115, v188, v184, s94
    s_nop 1
    v_mfma_f32_16x16x32_bf16 v[128:131], v[96:99], v[112:115], 0
    v_perm_b32 v116, v164, v160, s95
    v_perm_b32 v117, v172, v168, s95
    v_perm_b32 v118, v180, v176, s95
    v_perm_b32 v119, v188, v184, s95
    s_nop 1
    v_mfma_f32_16x16x32_bf16 v[132:135], v[96:99], v[116:119], 0
    v_perm_b32 v120, v165, v161, s94
    v_perm_b32 v121, v173, v169, s94
    v_perm_b32 v122, v181, v177, s94
    v_perm_b32 v123, v189, v185, s94
    s_nop 1
    v_mfma_f32_16x16x32_bf16 v[136:139], v[96:99], v[120:123], 0
    v_perm_b32 v124, v165, v161, s95
    v_perm_b32 v125, v173, v169, s95
    v_perm_b32 v126, v181, v177, s95
    v_perm_b32 v127, v189, v185, s95
    s_nop 1
    v_mfma_f32_16x16x32_bf16 v[140:143], v[96:99], v[124:127], 0
    v_perm_b32 v112, v166, v162, s94
    v_perm_b32 v113, v174, v170, s94
    v_perm_b32 v114, v182, v178, s94
    v_perm_b32 v115, v190, v186, s94
    s_nop 1
    v_mfma_f32_16x16x32_bf16 v[144:147], v[96:99], v[112:115], 0
    v_perm_b32 v116, v166, v162, s95
    v_perm_b32 v117, v174, v170, s95
    v_perm_b32 v118, v182, v178, s95
    v_perm_b32 v119, v190, v186, s95
    s_nop 1
    v_mfma_f32_16x16x32_bf16 v[148:151], v[96:99], v[116:119], 0
    v_perm_b32 v120, v167, v163, s94
    v_perm_b32 v121, v175, v171, s94
    v_perm_b32 v122, v183, v179, s94
    v_perm_b32 v123, v191, v187, s94
    s_nop 1
    v_mfma_f32_16x16x32_bf16 v[152:155], v[96:99], v[120:123], 0
    v_perm_b32 v124, v167, v163, s95
    v_perm_b32 v125, v175, v171, s95
    v_perm_b32 v126, v183, v179, s95
    v_perm_b32 v127, v191, v187, s95
    s_nop 1
    v_mfma_f32_16x16x32_bf16 v[156:159], v[96:99], v[124:127], 0
    s_memrealtime s[8:9]
    s_waitcnt lgkmcnt(0)
    s_sub_u32 s8, s8, s30
    s_cmpk_ge_u32 s8, 2156
    s_nop 3
    s_cbranch_scc1 .ap_176
    s_waitcnt vmcnt(5)
    s_cmpk_ge_u32 s8, 2091
    s_cbranch_scc1 .ap_176
    s_waitcnt vmcnt(3)
    s_bitcmp1_b64 s[14:15], 61
    s_cbranch_scc0 1
    s_waitcnt vmcnt(2)
    s_cmpk_ge_u32 s8, 2016
    s_cbranch_scc1 .ap_176
    s_waitcnt vmcnt(1)
.ap_176:
    s_add_u32 s63, s69, 434176
    buffer_load_dwordx4 v[76:79], v2, s[44:47], s63 offen nt
    v_perm_b32 v112, v196, v192, s94
    v_perm_b32 v113, v204, v200, s94
    v_perm_b32 v114, v212, v208, s94
    v_perm_b32 v115, v220, v216, s94
    s_nop 1
    v_mfma_f32_16x16x32_bf16 v[128:131], v[100:103], v[112:115], v[128:131]
    v_perm_b32 v116, v196, v192, s95
    v_perm_b32 v117, v204, v200, s95
    v_perm_b32 v118, v212, v208, s95
    v_perm_b32 v119, v220, v216, s95
    s_nop 1
    v_mfma_f32_16x16x32_bf16 v[132:135], v[100:103], v[116:119], v[132:135]
    v_perm_b32 v120, v197, v193, s94
    v_perm_b32 v121, v205, v201, s94
    v_perm_b32 v122, v213, v209, s94
    v_perm_b32 v123, v221, v217, s94
    s_nop 1
    v_mfma_f32_16x16x32_bf16 v[136:139], v[100:103], v[120:123], v[136:139]
    v_perm_b32 v124, v197, v193, s95
    v_perm_b32 v125, v205, v201, s95
    v_perm_b32 v126, v213, v209, s95
    v_perm_b32 v127, v221, v217, s95
    s_nop 1
    v_mfma_f32_16x16x32_bf16 v[140:143], v[100:103], v[124:127], v[140:143]
    v_perm_b32 v112, v198, v194, s94
    v_perm_b32 v113, v206, v202, s94
    v_perm_b32 v114, v214, v210, s94
    v_perm_b32 v115, v222, v218, s94
    s_nop 1
    v_mfma_f32_16x16x32_bf16 v[144:147], v[100:103], v[112:115], v[144:147]
    v_perm_b32 v116, v198, v194, s95
    v_perm_b32 v117, v206, v202, s95
    v_perm_b32 v118, v214, v210, s95
    v_perm_b32 v119, v222, v218, s95
    s_nop 1
    v_mfma_f32_16x16x32_bf16 v[148:151], v[100:103], v[116:119], v[148:151]
    v_perm_b32 v120, v199, v195, s94
    v_perm_b32 v121, v207, v203, s94
    v_perm_b32 v122, v215, v211, s94
    v_perm_b32 v123, v223, v219, s94
    s_nop 1
    v_mfma_f32_16x16x32_bf16 v[152:155], v[100:103], v[120:123], v[152:155]
    v_perm_b32 v124, v199, v195, s95
    v_perm_b32 v125, v207, v203, s95
    v_perm_b32 v126, v215, v211, s95
    v_perm_b32 v127, v223, v219, s95
    s_nop 1
    v_mfma_f32_16x16x32_bf16 v[156:159], v[100:103], v[124:127], v[156:159]
    s_memrealtime s[8:9]
    s_waitcnt lgkmcnt(0)
    s_sub_u32 s8, s8, s30
    s_cmpk_ge_u32 s8, 2187
    s_nop 3
    s_cbranch_scc1 .ap_177
    s_waitcnt vmcnt(5)
    s_cmpk_ge_u32 s8, 2122
    s_cbranch_scc1 .ap_177
    s_waitcnt vmcnt(3)
    s_bitcmp1_b64 s[14:15], 62
    s_cbranch_scc0 1
    s_waitcnt vmcnt(2)
    s_cmpk_ge_u32 s8, 2047
    s_cbranch_scc1 .ap_177
    s_waitcnt vmcnt(1)
.ap_177:
    s_add_u32 s63, s69, 442368
    buffer_load_dwordx4 v[84:87], v2, s[44:47], s63 offen nt
    s_waitcnt vmcnt(7)
    v_perm_b32 v112, v228, v224, s94
    v_perm_b32 v113, v236, v232, s94
    v_perm_b32 v114, v244, v240, s94
    v_perm_b32 v115, v252, v248, s94
    s_nop 1
    v_mfma_f32_16x16x32_bf16 v[128:131], v[104:107], v[112:115], v[128:131]
    v_perm_b32 v116, v228, v224, s95
    v_perm_b32 v117, v236, v232, s95
    v_perm_b32 v118, v244, v240, s95
    v_perm_b32 v119, v252, v248, s95
    s_nop 1
    v_mfma_f32_16x16x32_bf16 v[132:135], v[104:107], v[116:119], v[132:135]
    v_perm_b32 v120, v229, v225, s94
    v_perm_b32 v121, v237, v233, s94
    v_perm_b32 v122, v245, v241, s94
    v_perm_b32 v123, v253, v249, s94
    s_nop 1
    v_mfma_f32_16x16x32_bf16 v[136:139], v[104:107], v[120:123], v[136:139]
    v_perm_b32 v124, v229, v225, s95
    v_perm_b32 v125, v237, v233, s95
    v_perm_b32 v126, v245, v241, s95
    v_perm_b32 v127, v253, v249, s95
    s_nop 1
    v_mfma_f32_16x16x32_bf16 v[140:143], v[104:107], v[124:127], v[140:143]
    v_perm_b32 v112, v230, v226, s94
    v_perm_b32 v113, v238, v234, s94
    v_perm_b32 v114, v246, v242, s94
    v_perm_b32 v115, v254, v250, s94
    s_nop 1
    v_mfma_f32_16x16x32_bf16 v[144:147], v[104:107], v[112:115], v[144:147]
    v_perm_b32 v116, v230, v226, s95
    v_perm_b32 v117, v238, v234, s95
    v_perm_b32 v118, v246, v242, s95
    v_perm_b32 v119, v254, v250, s95
    s_nop 1
    v_mfma_f32_16x16x32_bf16 v[148:151], v[104:107], v[116:119], v[148:151]
    v_perm_b32 v120, v231, v227, s94
    v_perm_b32 v121, v239, v235, s94
    v_perm_b32 v122, v247, v243, s94
    v_perm_b32 v123, v255, v251, s94
    s_nop 1
    v_mfma_f32_16x16x32_bf16 v[152:155], v[104:107], v[120:123], v[152:155]
    v_perm_b32 v124, v231, v227, s95
    v_perm_b32 v125, v239, v235, s95
    v_perm_b32 v126, v247, v243, s95
    v_perm_b32 v127, v255, v251, s95
    s_nop 1
    v_mfma_f32_16x16x32_bf16 v[156:159], v[104:107], v[124:127], v[156:159]
    s_memrealtime s[8:9]
    s_waitcnt lgkmcnt(0)
    s_sub_u32 s8, s8, s30
    s_cmpk_ge_u32 s8, 2218
    s_nop 3
    s_cbranch_scc1 .ap_178
    s_waitcnt vmcnt(5)
    s_cmpk_ge_u32 s8, 2153
    s_cbranch_scc1 .ap_178
    s_waitcnt vmcnt(3)
    s_bitcmp1_b64 s[14:15], 63
    s_cbranch_scc0 1
    s_waitcnt vmcnt(2)
    s_cmpk_ge_u32 s8, 2078
    s_cbranch_scc1 .ap_178
    s_waitcnt vmcnt(1)
.ap_178:
    s_add_u32 s63, s69, 450560
    buffer_load_dwordx4 v[92:95], v2, s[44:47], s63 offen nt
    s_setprio 0
    s_waitcnt vmcnt(6)
    v_perm_b32 v160, v44, v36, s94
    v_perm_b32 v164, v44, v36, s95
    v_perm_b32 v168, v45, v37, s94
    v_perm_b32 v172, v45, v37, s95
    v_perm_b32 v176, v46, v38, s94
    v_perm_b32 v180, v46, v38, s95
    v_perm_b32 v184, v47, v39, s94
    v_perm_b32 v188, v47, v39, s95
    s_waitcnt vmcnt(4)
    v_perm_b32 v161, v60, v52, s94
    v_perm_b32 v165, v60, v52, s95
    v_perm_b32 v169, v61, v53, s94
    v_perm_b32 v173, v61, v53, s95
    v_perm_b32 v177, v62, v54, s94
    v_perm_b32 v181, v62, v54, s95
    v_perm_b32 v185, v63, v55, s94
    v_perm_b32 v189, v63, v55, s95
    v_mfma_f32_16x16x16_bf16 v[128:131], v[108:109], v[160:161], v[128:131]
    v_mfma_f32_16x16x16_bf16 v[132:135], v[108:109], v[164:165], v[132:135]
    v_mfma_f32_16x16x16_bf16 v[136:139], v[108:109], v[168:169], v[136:139]
    v_mfma_f32_16x16x16_bf16 v[140:143], v[108:109], v[172:173], v[140:143]
    v_mfma_f32_16x16x16_bf16 v[144:147], v[108:109], v[176:177], v[144:147]
    v_mfma_f32_16x16x16_bf16 v[148:151], v[108:109], v[180:181], v[148:151]
    v_mfma_f32_16x16x16_bf16 v[152:155], v[108:109], v[184:185], v[152:155]
    v_mfma_f32_16x16x16_bf16 v[156:159], v[108:109], v[188:189], v[156:159]
    s_waitcnt vmcnt(2)
    v_perm_b32 v162, v76, v68, s94
    v_perm_b32 v166, v76, v68, s95
    v_perm_b32 v170, v77, v69, s94
    v_perm_b32 v174, v77, v69, s95
    v_perm_b32 v178, v78, v70, s94
    v_perm_b32 v182, v78, v70, s95
    v_perm_b32 v186, v79, v71, s94
    v_perm_b32 v190, v79, v71, s95
    s_lshl4_add_u32 s59, s67, s66
    s_lshl1_add_u32 s59, s59, s68
    s_lshl_b32 s59, s59, 9
    s_add_u32 s59, s59, 0x210000
    s_mov_b32 s60, 0x07060503
    s_mov_b32 s61, 0x07060502
    s_mov_b32 s62, 0x07060501
.Ltail_bc:
    s_waitcnt vmcnt(0)
    v_perm_b32 v163, v92, v84, s94
    v_perm_b32 v167, v92, v84, s95
    v_perm_b32 v171, v93, v85, s94
    v_perm_b32 v175, v93, v85, s95
    v_perm_b32 v179, v94, v86, s94
    v_perm_b32 v183, v94, v86, s95
    v_perm_b32 v187, v95, v87, s94
    v_perm_b32 v191, v95, v87, s95
    v_mfma_f32_16x16x16_bf16 v[128:131], v[110:111], v[162:163], v[128:131]
    v_mfma_f32_16x16x16_bf16 v[132:135], v[110:111], v[166:167], v[132:135]
    v_mfma_f32_16x16x16_bf16 v[136:139], v[110:111], v[170:171], v[136:139]
    v_mfma_f32_16x16x16_bf16 v[140:143], v[110:111], v[174:175], v[140:143]
    v_mfma_f32_16x16x16_bf16 v[144:147], v[110:111], v[178:179], v[144:147]
    v_mfma_f32_16x16x16_bf16 v[148:151], v[110:111], v[182:183], v[148:151]
    v_mfma_f32_16x16x16_bf16 v[152:155], v[110:111], v[186:187], v[152:155]
    v_mfma_f32_16x16x16_bf16 v[156:159], v[110:111], v[190:191], v[156:159]
    s_mov_b64 exec, 0xffffffff
    s_nop 0
    ds_write2_b32 v10, v128, v132 offset0:0 offset1:1
    s_nop 0
    ds_write2_b32 v10, v136, v140 offset0:2 offset1:3
    s_nop 0
    ds_write2_b32 v10, v144, v148 offset0:4 offset1:5
    s_nop 0
    ds_write2_b32 v10, v152, v156 offset0:6 offset1:7
    s_mov_b64 exec, -1
    s_lshl_b32 s32, s3, 10
    s_add_u32 m0, s32, 40960
    s_add_u32 s56, s101, 2949120
    buffer_load_dwordx4 v6, s[48:51], s56 offen nt lds
    s_add_u32 m0, s32, 49152
    s_add_u32 s56, s101, 3538944
    buffer_load_dwordx4 v6, s[48:51], s56 offen nt lds
    s_add_u32 m0, s32, 57344
    s_add_u32 s56, s101, 4128768
    buffer_load_dwordx4 v6, s[48:51], s56 offen nt lds
    s_waitcnt lgkmcnt(0)
    s_barrier
    s_cmp_lg_u32 s3, 7
    s_cbranch_scc1 .opub_179
    ds_read_b128 v[196:199], v9 offset:0
    ds_read_b128 v[200:203], v9 offset:1024
    ds_read_b128 v[204:207], v9 offset:2048
    ds_read_b128 v[208:211], v9 offset:3072
    ds_read_b128 v[212:215], v9 offset:4096
    ds_read_b128 v[216:219], v9 offset:5120
    ds_read_b128 v[220:223], v9 offset:6144
    ds_read_b128 v[224:227], v9 offset:7168
    s_waitcnt lgkmcnt(6)
    v_pk_add_f32 v[196:197], v[196:197], v[200:201]
    v_pk_add_f32 v[198:199], v[198:199], v[202:203]
    s_waitcnt lgkmcnt(4)
    v_pk_add_f32 v[204:205], v[204:205], v[208:209]
    v_pk_add_f32 v[206:207], v[206:207], v[210:211]
    v_pk_add_f32 v[196:197], v[196:197], v[204:205]
    v_pk_add_f32 v[198:199], v[198:199], v[206:207]
    s_waitcnt lgkmcnt(2)
    v_pk_add_f32 v[212:213], v[212:213], v[216:217]
    v_pk_add_f32 v[214:215], v[214:215], v[218:219]
    s_waitcnt lgkmcnt(0)
    v_pk_add_f32 v[220:221], v[220:221], v[224:225]
    v_pk_add_f32 v[222:223], v[222:223], v[226:227]
    v_pk_add_f32 v[212:213], v[212:213], v[220:221]
    v_pk_add_f32 v[214:215], v[214:215], v[222:223]
    v_pk_add_f32 v[196:197], v[196:197], v[212:213]
    v_pk_add_f32 v[198:199], v[198:199], v[214:215]
    v_perm_b32 v12, v196, v199, s60
    v_perm_b32 v13, v197, v199, s61
    v_perm_b32 v14, v198, v199, s62
    s_add_u32 s57, s59, 0xac000
    buffer_store_dwordx4 v[12:15], v11, s[36:39], s57 offen
    buffer_store_dwordx4 v[12:15], v11, s[36:39], s59 offen sc1
.opub_179:
    s_barrier
    s_bitcmp1_b32 s1, 0
    s_cbranch_scc1 .lt_180
    s_lshl_b32 s32, s3, 10
    s_add_u32 m0, s32, 0
    s_add_u32 s56, s101, 0
    buffer_load_dwordx4 v6, s[48:51], s56 offen nt lds
    s_add_u32 m0, s32, 8192
    s_add_u32 s56, s101, 589824
    buffer_load_dwordx4 v6, s[48:51], s56 offen nt lds
    s_add_u32 m0, s32, 16384
    s_add_u32 s56, s101, 1179648
    buffer_load_dwordx4 v6, s[48:51], s56 offen nt lds
    s_add_u32 m0, s32, 24576
    s_add_u32 s56, s101, 1769472
    buffer_load_dwordx4 v6, s[48:51], s56 offen nt lds
    s_add_u32 m0, s32, 32768
    s_add_u32 s56, s101, 2359296
    buffer_load_dwordx4 v6, s[48:51], s56 offen nt lds
.lt_180:
    s_lshl_b32 s32, s3, 10
    s_add_u32 m0, s32, 65536
    s_add_u32 s56, s101, 4718592
    buffer_load_dwordx4 v6, s[48:51], s56 offen nt lds
    s_add_u32 m0, s32, 73728
    s_add_u32 s56, s33, 0
    buffer_load_dwordx4 v31, s[52:55], s56 offen nt lds
    s_add_u32 m0, s32, 81920
    s_add_u32 s56, s33, 73728
    buffer_load_dwordx4 v31, s[52:55], s56 offen nt lds
    s_add_u32 m0, s32, 90112
    s_add_u32 s56, s33, 147456
    buffer_load_dwordx4 v31, s[52:55], s56 offen nt lds
    s_add_u32 m0, s32, 98304
    s_add_u32 s56, s33, 221184
    buffer_load_dwordx4 v31, s[52:55], s56 offen nt lds
    s_cmp_ge_u32 s3, 4
    s_cbranch_scc1 .nod_181
    s_add_u32 m0, s32, 106496
    s_add_u32 s56, s33, 294912
    buffer_load_dwordx4 v31, s[52:55], s56 offen nt lds
.nod_181:
    s_branch .gpc_183
.gp_182:
    buffer_load_dwordx4 v[32:35], v2, s[36:39], s99 offen offset:0 sc1
    buffer_load_dwordx4 v[40:43], v2, s[36:39], s99 offen offset:1024 sc1
    buffer_load_dwordx2 v[48:49], v5, s[36:39], s99 offen offset:0 sc1
    buffer_load_dwordx4 v[56:59], v2, s[36:39], s100 offen offset:0 sc1
    buffer_load_dwordx4 v[64:67], v2, s[36:39], s100 offen offset:1024 sc1
    buffer_load_dwordx2 v[50:51], v5, s[36:39], s100 offen offset:0 sc1
    s_waitcnt vmcnt(0)
.gpc_183:
    v_min_u32 v7, v33, v35
    v_max_u32 v8, v33, v35
    v_min3_u32 v7, v7, v41, v43
    v_max3_u32 v8, v8, v41, v43
    v_min3_u32 v7, v7, v49, v57
    v_max3_u32 v8, v8, v49, v57
    v_min3_u32 v7, v7, v59, v65
    v_max3_u32 v8, v8, v59, v65
    v_min3_u32 v7, v7, v67, v51
    v_max3_u32 v8, v8, v67, v51
    v_cmp_eq_u32 vcc, s34, v7
    v_cmp_eq_u32 s[56:57], s34, v8
    s_and_b64 vcc, vcc, s[56:57]
    s_cmp_eq_u64 vcc, exec
    s_nop 2
    s_cbranch_scc1 .gpd_184
    s_sub_u32 s35, s35, 1
    s_cbranch_scc1 .Lexit
    s_sleep 2
    s_branch .gp_182
.gpd_184:
    v_lshlrev_b32 v230, 16, v32
    v_and_b32 v231, 0xffff0000, v32
    v_lshlrev_b32 v240, 16, v56
    v_and_b32 v241, 0xffff0000, v56
    v_lshlrev_b32 v232, 16, v34
    v_and_b32 v233, 0xffff0000, v34
    v_lshlrev_b32 v242, 16, v58
    v_and_b32 v243, 0xffff0000, v58
    v_lshlrev_b32 v234, 16, v40
    v_and_b32 v235, 0xffff0000, v40
    v_lshlrev_b32 v244, 16, v64
    v_and_b32 v245, 0xffff0000, v64
    v_lshlrev_b32 v236, 16, v42
    v_and_b32 v237, 0xffff0000, v42
    v_lshlrev_b32 v246, 16, v66
    v_and_b32 v247, 0xffff0000, v66
    v_lshlrev_b32 v238, 16, v48
    v_and_b32 v239, 0xffff0000, v48
    v_lshlrev_b32 v248, 16, v50
    v_and_b32 v249, 0xffff0000, v50
    s_sub_u32 s63, s65, 9
    s_mul_i32 s42, s64, 18432
    s_mul_i32 s56, s3, 2304
    s_add_u32 s42, s42, s56
    s_add_u32 s42, s42, 0x250000
    s_mul_i32 s41, s64, 36864
    s_add_u32 s41, s41, 0x274000
    s_lshr_b32 s57, s63, 1
    s_lshl3_add_u32 s40, s57, s3
    s_and_b32 s63, s63, 1
    s_lshl1_add_u32 s40, s40, s63
    s_lshl_b32 s40, s40, 8
    s_add_u32 s40, s40, s41
    s_mul_i32 s56, s63, 18432
    s_add_u32 s41, s41, s56
    s_mul_i32 s43, s3, 9
    s_add_u32 s43, s43, s57
    s_lshl3_add_u32 s43, s43, s64
    s_lshl1_add_u32 s43, s43, s63
    s_lshl_b32 s43, s43, 8
    s_add_u32 s43, s43, 0x38c000
    v_mov_b32 v143, s34
    s_add_u32 s57, s40, 0xac000
    s_mov_b64 exec, 0xffff
    buffer_load_dwordx4 v[80:83], v2, s[36:39], s57 offen offset:0
    s_mov_b64 exec, -1
    s_waitcnt vmcnt(5)
    s_barrier
    ds_read_b64_tr_b16 v[160:161], v19 offset:0
    ds_read_b64_tr_b16 v[162:163], v19 offset:512
    ds_read_b64_tr_b16 v[164:165], v19 offset:8192
    ds_read_b64_tr_b16 v[166:167], v19 offset:8704
    ds_read_b64_tr_b16 v[168:169], v19 offset:16384
    ds_read_b64_tr_b16 v[170:171], v19 offset:16896
    ds_read_b64_tr_b16 v[172:173], v19 offset:24576
    ds_read_b64_tr_b16 v[174:175], v19 offset:25088
    ds_read_b64_tr_b16 v[176:177], v20 offset:0
    ds_read_b64_tr_b16 v[178:179], v20 offset:512
    ds_read_b64_tr_b16 v[180:181], v20 offset:8192
    ds_read_b64_tr_b16 v[182:183], v20 offset:8704
    ds_read_b64_tr_b16 v[184:185], v20 offset:16384
    ds_read_b64_tr_b16 v[186:187], v20 offset:16896
    ds_read_b64_tr_b16 v[188:189], v20 offset:24576
    ds_read_b64_tr_b16 v[190:191], v20 offset:25088
    ds_read_b64_tr_b16 v[192:193], v20 offset:32768
    ds_read_b64_tr_b16 v[194:195], v20 offset:33280
.Lbc_x:
    s_add_u32 s58, s42, s0
    s_mov_b32 s32, 0
    s_mov_b64 s[88:89], exec
    s_mov_b64 s[90:91], exec
    s_mov_b64 s[92:93], exec
.mp_185:
    s_mov_b64 exec, s[88:89]
    buffer_load_dwordx4 v[144:147], v2, s[36:39], s58 offen offset:0 sc1
    s_mov_b64 exec, s[90:91]
    buffer_load_dwordx4 v[148:151], v2, s[36:39], s58 offen offset:1024 sc1
    s_mov_b64 exec, s[92:93]
    buffer_load_dwordx2 v[152:153], v5, s[36:39], s58 offen offset:0 sc1
    s_mov_b64 exec, -1
    s_sub_u32 s35, s35, 1
    s_cbranch_scc1 .Lexit
    s_add_u32 s32, s32, 1
    s_cmp_eq_u32 s32, 64
    s_cselect_b32 s58, s42, s58
    s_waitcnt vmcnt(0)
.mpj_186:
    v_cmp_ne_u32 s[88:89], s34, v147
    v_cmp_ne_u32 s[90:91], s34, v151
    v_cmp_ne_u32 s[92:93], s34, v153
    s_or_b64 vcc, s[88:89], s[90:91]
    s_or_b64 vcc, vcc, s[92:93]
    s_cbranch_scc1 .mp_185
    s_mov_b32 s56, 0x3f803f80
    v_dot2_f32_bf16 v250, v144, s56, 0
    v_dot2_f32_bf16 v251, v144, v144, 0
    v_dot2_f32_bf16 v250, v146, s56, v250
    v_dot2_f32_bf16 v251, v146, v146, v251
    v_dot2_f32_bf16 v250, v148, s56, v250
    v_dot2_f32_bf16 v251, v148, v148, v251
    v_dot2_f32_bf16 v250, v150, s56, v250
    v_dot2_f32_bf16 v251, v150, v150, v251
    s_mov_b64 exec, 0xffffffff
    v_dot2_f32_bf16 v250, v152, s56, v250
    v_dot2_f32_bf16 v251, v152, v152, v251
    s_mov_b64 exec, -1
    s_nop 1
    v_permlane32_swap_b32 v250, v251
    v_add_f32 v250, v250, v251
    v_mov_b32 v252, v250
    s_nop 1
    v_permlane16_swap_b32 v252, v250
    v_add_f32 v250, v252, v250
    v_lshlrev_b32 v220, 16, v144
    v_and_b32 v221, 0xffff0000, v144
    v_add_f32_dpp v250, v250, v250 row_ror:8 row_mask:0xf bank_mask:0xf
    v_lshlrev_b32 v222, 16, v146
    v_and_b32 v223, 0xffff0000, v146
    v_add_f32_dpp v250, v250, v250 row_ror:4 row_mask:0xf bank_mask:0xf
    v_lshlrev_b32 v224, 16, v148
    v_and_b32 v225, 0xffff0000, v148
    v_add_f32_dpp v250, v250, v250 quad_perm:[2,3,0,1] row_mask:0xf bank_mask:0xf
    v_lshlrev_b32 v226, 16, v150
    v_and_b32 v227, 0xffff0000, v150
    v_add_f32_dpp v250, v250, v250 quad_perm:[1,0,3,2] row_mask:0xf bank_mask:0xf
    v_mul_f32 v250, 0x3ae38e39, v250
    v_lshlrev_b32 v228, 16, v152
    v_and_b32 v229, 0xffff0000, v152
    v_readlane_b32 s56, v250, 0
    v_readlane_b32 s57, v250, 32
    s_nop 0
    v_mov_b32 v250, s56
    v_fma_f32 v251, -v250, v250, s57
    v_max_f32 v251, 0, v251
    v_cvt_pk_bf16_f32 v253, 0, v251
    v_cvt_pk_bf16_f32 v251, 0, -v250
    v_cvt_pk_bf16_f32 v250, 0, -v250
    v_add_f32 v253, 0x3727c5ac, v253
    v_pk_add_f32 v[220:221], v[220:221], v[250:251]
    v_pk_add_f32 v[222:223], v[222:223], v[250:251]
    v_pk_add_f32 v[224:225], v[224:225], v[250:251]
    v_cvt_pk_bf16_f32 v253, 0, v253
    v_pk_add_f32 v[226:227], v[226:227], v[250:251]
    v_pk_add_f32 v[228:229], v[228:229], v[250:251]
    v_cvt_pk_bf16_f32 v220, 0, v220
    v_sqrt_f32 v253, v253
    v_cvt_pk_bf16_f32 v221, 0, v221
    v_cvt_pk_bf16_f32 v222, 0, v222
    v_cvt_pk_bf16_f32 v223, 0, v223
    v_cvt_pk_bf16_f32 v253, 0, v253
    v_cvt_pk_bf16_f32 v224, 0, v224
    v_cvt_pk_bf16_f32 v225, 0, v225
    v_cvt_pk_bf16_f32 v226, 0, v226
    v_rcp_f32 v252, v253
    v_cvt_pk_bf16_f32 v227, 0, v227
    v_cvt_pk_bf16_f32 v228, 0, v228
    v_cvt_pk_bf16_f32 v229, 0, v229
    v_mov_b32 v253, v252
    v_pk_mul_f32 v[220:221], v[220:221], v[252:253]
    v_pk_mul_f32 v[222:223], v[222:223], v[252:253]
    v_pk_mul_f32 v[224:225], v[224:225], v[252:253]
    v_pk_mul_f32 v[226:227], v[226:227], v[252:253]
    v_pk_mul_f32 v[228:229], v[228:229], v[252:253]
    v_cvt_pk_bf16_f32 v220, 0, v220
    v_cvt_pk_bf16_f32 v221, 0, v221
    v_cvt_pk_bf16_f32 v222, 0, v222
    v_cvt_pk_bf16_f32 v223, 0, v223
    v_cvt_pk_bf16_f32 v224, 0, v224
    v_cvt_pk_bf16_f32 v225, 0, v225
    v_cvt_pk_bf16_f32 v226, 0, v226
    v_cvt_pk_bf16_f32 v227, 0, v227
    v_cvt_pk_bf16_f32 v228, 0, v228
    v_cvt_pk_bf16_f32 v229, 0, v229
    v_pk_mul_f32 v[220:221], v[220:221], v[240:241]
    v_pk_mul_f32 v[222:223], v[222:223], v[242:243]
    v_pk_mul_f32 v[224:225], v[224:225], v[244:245]
    v_pk_mul_f32 v[226:227], v[226:227], v[246:247]
    v_pk_mul_f32 v[228:229], v[228:229], v[248:249]
    v_cvt_pk_bf16_f32 v220, 0, v220
    v_cvt_pk_bf16_f32 v221, 0, v221
    v_cvt_pk_bf16_f32 v222, 0, v222
    v_cvt_pk_bf16_f32 v223, 0, v223
    v_cvt_pk_bf16_f32 v224, 0, v224
    v_cvt_pk_bf16_f32 v225, 0, v225
    v_cvt_pk_bf16_f32 v226, 0, v226
    v_cvt_pk_bf16_f32 v227, 0, v227
    v_cvt_pk_bf16_f32 v228, 0, v228
    v_cvt_pk_bf16_f32 v229, 0, v229
    v_pk_add_f32 v[220:221], v[220:221], v[230:231]
    v_pk_add_f32 v[222:223], v[222:223], v[232:233]
    v_pk_add_f32 v[224:225], v[224:225], v[234:235]
    v_pk_add_f32 v[226:227], v[226:227], v[236:237]
    v_pk_add_f32 v[228:229], v[228:229], v[238:239]
    v_cvt_pk_bf16_f32 v154, v220, v221
    v_cvt_pk_bf16_f32 v155, v222, v223
    v_cvt_pk_bf16_f32 v156, v224, v225
    v_cvt_pk_bf16_f32 v157, v226, v227
    v_cvt_pk_bf16_f32 v158, v228, v229
    ds_write_b64 v17, v[154:155]
    ds_write_b64 v17, v[156:157] offset:512
    ds_write_b32 v18, v158
    s_waitcnt lgkmcnt(0)
    s_barrier
    ds_read_b128 v[96:99], v16 offset:0
    ds_read_b128 v[100:103], v16 offset:128
    ds_read_b128 v[104:107], v16 offset:256
    ds_read_b128 v[108:111], v16 offset:384
    ds_read_b128 v[112:115], v16 offset:512
    ds_read_b128 v[116:119], v16 offset:640
    ds_read_b128 v[120:123], v16 offset:768
    ds_read_b128 v[124:127], v16 offset:896
    ds_read_b128 v[128:131], v16 offset:1024
    s_waitcnt lgkmcnt(8)
    v_mfma_f32_16x16x32_bf16 v[132:135], v[160:163], v[96:99], 0
    s_waitcnt lgkmcnt(7)
    v_mfma_f32_16x16x32_bf16 v[132:135], v[164:167], v[100:103], v[132:135]
    s_waitcnt lgkmcnt(6)
    v_mfma_f32_16x16x32_bf16 v[132:135], v[168:171], v[104:107], v[132:135]
    s_waitcnt lgkmcnt(5)
    v_mfma_f32_16x16x32_bf16 v[132:135], v[172:175], v[108:111], v[132:135]
    s_waitcnt lgkmcnt(4)
    v_mfma_f32_16x16x32_bf16 v[132:135], v[176:179], v[112:115], v[132:135]
    s_waitcnt lgkmcnt(3)
    v_mfma_f32_16x16x32_bf16 v[132:135], v[180:183], v[116:119], v[132:135]
    s_waitcnt lgkmcnt(2)
    v_mfma_f32_16x16x32_bf16 v[132:135], v[184:187], v[120:123], v[132:135]
    s_waitcnt lgkmcnt(1)
    v_mfma_f32_16x16x32_bf16 v[132:135], v[188:191], v[124:127], v[132:135]
    s_waitcnt lgkmcnt(0)
    v_mfma_f32_16x16x32_bf16 v[132:135], v[192:195], v[128:131], v[132:135]
    s_nop 7
    v_permlane32_swap_b32 v132, v134
    v_permlane32_swap_b32 v133, v135
    v_cndmask_b32 v133, v133, v134, s[96:97]
    v_cndmask_b32 v132, v132, v135, s[96:97]
    s_nop 1
    v_add_f32_dpp v12, v133, v132 quad_perm:[1,0,3,2] row_mask:0xf bank_mask:0xf
    v_cvt_pk_bf16_f32 v12, 0, v12
    s_cmp_lg_u32 s63, 0
    s_nop 0
    s_cbranch_scc1 .up_189
    v_max_f32 v12, 0xc2ae0000, v12
    v_min_f32 v9, 0x43000000, v12
    v_mul_f32 v7, 0xbfb8aa3b, v9
    v_fma_f32 v8, v9, s98, -v7
    v_fmac_f32 v8, 0xb2a57060, v9
    v_exp_f32 v7, v7
    v_mul_f32 v8, 0x3f317218, v8
    v_fmac_f32 v7, v7, v8
    v_add_f32 v7, 1.0, v7
    v_rcp_f32 v8, v7
    s_nop 0
    v_mul_f32 v9, v12, v8
    v_fma_f32 v7, -v9, v7, v12
    v_fma_f32 v12, v7, v8, v9
.up_189:
    s_nop 1
    v_mov_b32_dpp v137, v12 quad_perm:[0,0,2,2] row_mask:0xf bank_mask:0xf
    v_mov_b32_dpp v139, v12 quad_perm:[1,1,3,3] row_mask:0xf bank_mask:0xf
    v_cvt_pk_bf16_f32 v136, v137, v139
    v_cvt_pk_bf16_f32 v138, v137, v139
    v_mov_b32 v137, s34
    v_mov_b32 v139, s34
    v_permlane32_swap_b32 v136, v138
    s_mov_b64 exec, 0x55555555
    s_add_u32 s57, s40, 0xac000
    buffer_store_dwordx4 v[136:139], v26, s[36:39], s57 offen
    s_cmp_lg_u32 s0, 0
    s_cbranch_scc1 2
    buffer_store_dwordx4 v[136:139], v26, s[36:39], s40 offen sc1
    s_mov_b64 exec, -1
    s_barrier
    ds_read_b64_tr_b16 v[196:197], v21 offset:0
    ds_read_b64_tr_b16 v[198:199], v21 offset:512
    ds_read_b64_tr_b16 v[208:209], v22 offset:0
    ds_read_b64_tr_b16 v[210:211], v22 offset:512
    ds_read_b64_tr_b16 v[200:201], v21 offset:4096
    ds_read_b64_tr_b16 v[202:203], v21 offset:4608
    ds_read_b64_tr_b16 v[212:213], v22 offset:4096
    ds_read_b64_tr_b16 v[214:215], v22 offset:4608
    ds_read_b64_tr_b16 v[204:205], v21 offset:8192
    ds_read_b64_tr_b16 v[206:207], v21 offset:8704
    ds_read_b64_tr_b16 v[216:217], v22 offset:8192
    ds_read_b64_tr_b16 v[218:219], v22 offset:8704
    s_add_u32 s58, s41, s0
    s_mov_b32 s32, 0
    s_mov_b64 s[88:89], exec
    s_mov_b64 s[90:91], exec
    s_and_b64 s[92:93], exec, 0xff
    s_and_b64 s[56:57], exec, 0xff
.mp_190:
    s_mov_b64 exec, s[88:89]
    buffer_load_dwordx4 v[160:163], v27, s[36:39], s58 offen offset:0 sc1
    s_mov_b64 exec, s[90:91]
    buffer_load_dwordx4 v[164:167], v27, s[36:39], s58 offen offset:256 sc1
    s_mov_b64 exec, s[92:93]
    buffer_load_dwordx4 v[168:171], v28, s[36:39], s58 offen offset:0 sc1
    s_mov_b64 exec, s[56:57]
    buffer_load_dwordx4 v[172:175], v28, s[36:39], s58 offen offset:256 sc1
    s_mov_b64 exec, -1
    s_sub_u32 s35, s35, 1
    s_cbranch_scc1 .Lexit
    s_add_u32 s32, s32, 1
    s_cmp_eq_u32 s32, 64
    s_cselect_b32 s58, s41, s58
    s_cbranch_scc0 .mpi_192
    s_mov_b64 exec, 0x55555555
    buffer_store_dwordx4 v[136:139], v26, s[36:39], s40 offen sc1
    s_mov_b64 exec, -1
.mpi_192:
    s_waitcnt vmcnt(0)
.mpj_191:
    v_cmp_ne_u32 s[88:89], s34, v163
    v_cmp_ne_u32 s[90:91], s34, v167
    v_cmp_ne_u32 s[92:93], s34, v171
    s_and_b64 s[92:93], s[92:93], 0xff
    v_cmp_ne_u32 s[56:57], s34, v175
    s_and_b64 s[56:57], s[56:57], 0xff
    s_or_b64 vcc, s[88:89], s[90:91]
    s_or_b64 vcc, vcc, s[92:93]
    s_or_b64 vcc, vcc, s[56:57]
    s_cbranch_scc1 .mp_190
    v_and_b32 v161, 0xffff0000, v160
    v_lshlrev_b32 v160, 16, v160
    v_and_b32 v163, 0xffff0000, v162
    v_lshlrev_b32 v162, 16, v162
    v_and_b32 v165, 0xffff0000, v164
    v_lshlrev_b32 v164, 16, v164
    v_and_b32 v167, 0xffff0000, v166
    v_lshlrev_b32 v166, 16, v166
    v_and_b32 v169, 0xffff0000, v168
    v_lshlrev_b32 v168, 16, v168
    v_and_b32 v171, 0xffff0000, v170
    v_lshlrev_b32 v170, 16, v170
    v_and_b32 v173, 0xffff0000, v172
    v_lshlrev_b32 v172, 16, v172
    v_and_b32 v175, 0xffff0000, v174
    v_lshlrev_b32 v174, 16, v174
    v_pk_mul_f32 v[160:161], v[160:161], v[164:165]
    v_pk_mul_f32 v[162:163], v[162:163], v[166:167]
    v_pk_mul_f32 v[168:169], v[168:169], v[172:173]
    v_pk_mul_f32 v[170:171], v[170:171], v[174:175]
    v_cvt_pk_bf16_f32 v160, v160, v161
    v_cvt_pk_bf16_f32 v161, v162, v163
    v_cvt_pk_bf16_f32 v168, v168, v169
    v_cvt_pk_bf16_f32 v169, v170, v171
    ds_write_b64 v29, v[160:161]
    s_mov_b64 exec, 0xff
    ds_write_b64 v30, v[168:169]
    s_mov_b64 exec, -1
    s_mov_b64 exec, 0x55555555
    buffer_store_dwordx4 v[136:139], v26, s[36:39], s40 offen sc1
    s_mov_b64 exec, -1
    s_waitcnt lgkmcnt(0)
    s_barrier
    s_cmp_ge_u32 s3, 6
    s_cbranch_scc1 .tg_194
    ds_read_b128 v[96:99], v23 offset:0
    ds_read_b128 v[100:103], v23 offset:64
    ds_read_b128 v[104:107], v23 offset:128
    s_waitcnt lgkmcnt(2)
    v_mfma_f32_16x16x32_bf16 v[132:135], v[196:199], v[96:99], 0
    v_mfma_f32_16x16x32_bf16 v[136:139], v[208:211], v[96:99], 0
    s_waitcnt lgkmcnt(1)
    v_mfma_f32_16x16x32_bf16 v[132:135], v[200:203], v[100:103], v[132:135]
    v_mfma_f32_16x16x32_bf16 v[136:139], v[212:215], v[100:103], v[136:139]
    s_waitcnt lgkmcnt(0)
    v_mfma_f32_16x16x32_bf16 v[132:135], v[204:207], v[104:107], v[132:135]
    v_mfma_f32_16x16x32_bf16 v[136:139], v[216:219], v[104:107], v[136:139]
    s_nop 7
    v_cndmask_b32 v132, v132, v136, s[96:97]
    v_cndmask_b32 v133, v133, v137, s[96:97]
    v_cndmask_b32 v134, v134, v138, s[96:97]
    v_cndmask_b32 v135, v135, v139, s[96:97]
    ds_write_b128 v24, v[132:135]
    s_waitcnt lgkmcnt(0)
.tg_194:
    s_barrier
    ds_read_b128 v[112:115], v25 offset:0
    ds_read_b128 v[116:119], v25 offset:2176
    ds_read_b128 v[120:123], v25 offset:4352
    s_mov_b32 s60, 0x07060503
    s_mov_b32 s61, 0x07060502
    s_mov_b32 s62, 0x07060501
    s_waitcnt lgkmcnt(1)
    v_pk_add_f32 v[112:113], v[112:113], v[116:117]
    v_pk_add_f32 v[114:115], v[114:115], v[118:119]
    s_waitcnt lgkmcnt(0)
    v_pk_add_f32 v[112:113], v[112:113], v[120:121]
    v_pk_add_f32 v[114:115], v[114:115], v[122:123]
    v_perm_b32 v140, v112, v115, s60
    v_perm_b32 v141, v113, v115, s61
    v_perm_b32 v142, v114, v115, s62
    s_mov_b64 exec, 0xffff
    buffer_store_dwordx4 v[140:143], v2, s[36:39], s43 offen sc1
    s_mov_b64 exec, -1
    s_nop 0
    s_branch .Lexit
.Latt_n:
    v_and_b32 v8, 1, v0
    v_lshlrev_b32 v8, 8, v8
    v_and_b32 v9, 0x3c, v0
    v_lshl_add_u32 v9, v9, 2, v8
    v_lshlrev_b32 v7, 1, v9
    v_and_b32 v9, 0x3c, v0
    v_lshrrev_b32 v8, 4, v8
    v_and_b32 v9, 2, v0
    v_lshl_add_u32 v9, v9, 6, v8
    s_lshl_b32 s58, s66, 14
    s_lshl_b32 s59, s67, 10
    s_add_u32 s58, s58, s59
    s_add_u32 s58, s58, 0x40000
    s_lshl4_add_u32 s59, s66, s67
    s_lshl_b32 s59, s59, 8
    s_add_u32 s59, s59, 0x200000
    s_memrealtime s[8:9]
    s_waitcnt vmcnt(8)
    s_waitcnt lgkmcnt(0)
    s_sub_u32 s8, s8, s30
    s_cmpk_ge_u32 s8, 1147
    s_cbranch_scc1 .ap_195
    s_waitcnt vmcnt(5)
    s_cmpk_ge_u32 s8, 1082
    s_cbranch_scc1 .ap_195
    s_waitcnt vmcnt(3)
    s_bitcmp1_b64 s[14:15], 26
    s_cbranch_scc0 1
    s_waitcnt vmcnt(2)
    s_cmpk_ge_u32 s8, 1007
    s_cbranch_scc1 .ap_195
    s_waitcnt vmcnt(1)
.ap_195:
    s_add_u32 s63, s69, 409600
    buffer_load_dwordx4 v[88:91], v1, s[40:43], s63 offen nt
    s_memrealtime s[8:9]
    s_waitcnt vmcnt(8)
    s_waitcnt lgkmcnt(0)
    s_sub_u32 s8, s8, s30
    s_cmpk_ge_u32 s8, 1174
    s_cbranch_scc1 .ap_196
    s_waitcnt vmcnt(5)
    s_cmpk_ge_u32 s8, 1109
    s_cbranch_scc1 .ap_196
    s_waitcnt vmcnt(3)
    s_bitcmp1_b64 s[14:15], 27
    s_cbranch_scc0 1
    s_waitcnt vmcnt(2)
    s_cmpk_ge_u32 s8, 1034
    s_cbranch_scc1 .ap_196
    s_waitcnt vmcnt(1)
.ap_196:
    s_add_u32 s63, s69, 417792
    buffer_load_dwordx4 v[92:95], v1, s[40:43], s63 offen nt
    s_memrealtime s[8:9]
    s_waitcnt vmcnt(8)
    s_waitcnt lgkmcnt(0)
    s_sub_u32 s8, s8, s30
    s_cmpk_ge_u32 s8, 1201
    s_cbranch_scc1 .ap_197
    s_waitcnt vmcnt(5)
    s_cmpk_ge_u32 s8, 1136
    s_cbranch_scc1 .ap_197
    s_waitcnt vmcnt(3)
    s_bitcmp1_b64 s[14:15], 28
    s_cbranch_scc0 1
    s_waitcnt vmcnt(2)
    s_cmpk_ge_u32 s8, 1061
    s_cbranch_scc1 .ap_197
    s_waitcnt vmcnt(1)
.ap_197:
    s_add_u32 s63, s69, 425984
    buffer_load_dwordx4 v[120:123], v1, s[40:43], s63 offen nt
    s_memrealtime s[8:9]
    s_waitcnt vmcnt(8)
    s_waitcnt lgkmcnt(0)
    s_sub_u32 s8, s8, s30
    s_cmpk_ge_u32 s8, 1228
    s_cbranch_scc1 .ap_198
    s_waitcnt vmcnt(5)
    s_cmpk_ge_u32 s8, 1163
    s_cbranch_scc1 .ap_198
    s_waitcnt vmcnt(3)
    s_bitcmp1_b64 s[14:15], 29
    s_cbranch_scc0 1
    s_waitcnt vmcnt(2)
    s_cmpk_ge_u32 s8, 1088
    s_cbranch_scc1 .ap_198
    s_waitcnt vmcnt(1)
.ap_198:
    s_add_u32 s63, s69, 434176
    buffer_load_dwordx4 v[124:127], v1, s[40:43], s63 offen nt
    s_memrealtime s[8:9]
    s_waitcnt vmcnt(8)
    s_waitcnt lgkmcnt(0)
    s_sub_u32 s8, s8, s30
    s_cmpk_ge_u32 s8, 1255
    s_cbranch_scc1 .ap_199
    s_waitcnt vmcnt(5)
    s_cmpk_ge_u32 s8, 1190
    s_cbranch_scc1 .ap_199
    s_waitcnt vmcnt(3)
    s_bitcmp1_b64 s[14:15], 30
    s_cbranch_scc0 1
    s_waitcnt vmcnt(2)
    s_cmpk_ge_u32 s8, 1115
    s_cbranch_scc1 .ap_199
    s_waitcnt vmcnt(1)
.ap_199:
    s_add_u32 s63, s69, 442368
    buffer_load_dwordx4 v[152:155], v1, s[40:43], s63 offen nt
    s_memrealtime s[8:9]
    s_waitcnt vmcnt(8)
    s_waitcnt lgkmcnt(0)
    s_sub_u32 s8, s8, s30
    s_cmpk_ge_u32 s8, 1282
    s_cbranch_scc1 .ap_200
    s_waitcnt vmcnt(5)
    s_cmpk_ge_u32 s8, 1217
    s_cbranch_scc1 .ap_200
    s_waitcnt vmcnt(3)
    s_bitcmp1_b64 s[14:15], 31
    s_cbranch_scc0 1
    s_waitcnt vmcnt(2)
    s_cmpk_ge_u32 s8, 1142
    s_cbranch_scc1 .ap_200
    s_waitcnt vmcnt(1)
.ap_200:
    s_add_u32 s63, s69, 450560
    buffer_load_dwordx4 v[156:159], v1, s[40:43], s63 offen nt
    buffer_load_dwordx4 v[16:19], v7, s[36:39], s58 offen offset:0 sc1
    buffer_load_dwordx4 v[20:23], v7, s[36:39], s58 offen offset:16 sc1
    s_memrealtime s[8:9]
    s_waitcnt vmcnt(8)
    s_waitcnt lgkmcnt(0)
    s_sub_u32 s8, s8, s30
    s_cmpk_ge_u32 s8, 1309
    s_cbranch_scc1 .ap_201
    s_waitcnt vmcnt(5)
    s_cmpk_ge_u32 s8, 1244
    s_cbranch_scc1 .ap_201
    s_waitcnt vmcnt(3)
    s_bitcmp1_b64 s[14:15], 32
    s_cbranch_scc0 1
    s_waitcnt vmcnt(2)
    s_cmpk_ge_u32 s8, 1169
    s_cbranch_scc1 .ap_201
    s_waitcnt vmcnt(1)
.ap_201:
    s_add_u32 s63, s69, 0
    buffer_load_dwordx4 v[160:163], v2, s[44:47], s63 offen nt
    s_memrealtime s[8:9]
    s_waitcnt vmcnt(8)
    s_waitcnt lgkmcnt(0)
    s_sub_u32 s8, s8, s30
    s_cmpk_ge_u32 s8, 1336
    s_cbranch_scc1 .ap_202
    s_waitcnt vmcnt(5)
    s_cmpk_ge_u32 s8, 1271
    s_cbranch_scc1 .ap_202
    s_waitcnt vmcnt(3)
    s_bitcmp1_b64 s[14:15], 33
    s_cbranch_scc0 1
    s_waitcnt vmcnt(2)
    s_cmpk_ge_u32 s8, 1196
    s_cbranch_scc1 .ap_202
    s_waitcnt vmcnt(1)
.ap_202:
    s_add_u32 s63, s69, 8192
    buffer_load_dwordx4 v[164:167], v2, s[44:47], s63 offen nt
    s_memrealtime s[8:9]
    s_waitcnt vmcnt(8)
    s_waitcnt lgkmcnt(0)
    s_sub_u32 s8, s8, s30
    s_cmpk_ge_u32 s8, 1363
    s_cbranch_scc1 .ap_203
    s_waitcnt vmcnt(5)
    s_cmpk_ge_u32 s8, 1298
    s_cbranch_scc1 .ap_203
    s_waitcnt vmcnt(3)
    s_bitcmp1_b64 s[14:15], 34
    s_cbranch_scc0 1
    s_waitcnt vmcnt(2)
    s_cmpk_ge_u32 s8, 1223
    s_cbranch_scc1 .ap_203
    s_waitcnt vmcnt(1)
.ap_203:
    s_add_u32 s63, s69, 16384
    buffer_load_dwordx4 v[168:171], v2, s[44:47], s63 offen nt
    s_waitcnt vmcnt(3)
    s_branch .gpc_205
.gp_204:
    buffer_load_dwordx4 v[16:19], v7, s[36:39], s58 offen offset:0 sc1
    buffer_load_dwordx4 v[20:23], v7, s[36:39], s58 offen offset:16 sc1
    s_waitcnt vmcnt(0)
.gpc_205:
    v_min_u32 v10, v17, v19
    v_max_u32 v11, v17, v19
    v_min3_u32 v10, v10, v21, v23
    v_max3_u32 v11, v11, v21, v23
    v_cmp_eq_u32 vcc, s34, v10
    v_cmp_eq_u32 s[56:57], s34, v11
    s_and_b64 vcc, vcc, s[56:57]
    s_cmp_eq_u64 vcc, exec
    s_nop 2
    s_cbranch_scc1 .gpd_206
    s_sub_u32 s35, s35, 1
    s_cbranch_scc1 .Lexit
    s_sleep 1
    s_branch .gp_204
.gpd_206:
    s_mov_b32 vcc_lo, 0xcccccccc
    s_mov_b32 vcc_hi, 0xcccccccc
    v_cndmask_b32_e64 v24, v16, 0, vcc
    v_cndmask_b32_e64 v25, v18, 0, vcc
    v_cndmask_b32_e64 v26, v20, 0, vcc
    v_cndmask_b32_e64 v27, v22, 0, vcc
    v_cndmask_b32_e32 v28, 0, v16, vcc
    v_cndmask_b32_e32 v29, 0, v18, vcc
    v_cndmask_b32_e32 v30, 0, v20, vcc
    v_cndmask_b32_e32 v31, 0, v22, vcc
    v_mfma_f32_16x16x32_bf16 v[16:19], v[32:35], v[24:27], 0
    v_mfma_f32_16x16x32_bf16 v[32:35], v[40:43], v[24:27], 0
    v_mfma_f32_16x16x32_bf16 v[16:19], v[36:39], v[28:31], v[16:19]
    v_mfma_f32_16x16x32_bf16 v[40:43], v[48:51], v[24:27], 0
    v_mfma_f32_16x16x32_bf16 v[32:35], v[44:47], v[28:31], v[32:35]
    v_mfma_f32_16x16x32_bf16 v[48:51], v[56:59], v[24:27], 0
    v_mfma_f32_16x16x32_bf16 v[40:43], v[52:55], v[28:31], v[40:43]
    v_mfma_f32_16x16x32_bf16 v[56:59], v[64:67], v[24:27], 0
    v_mfma_f32_16x16x32_bf16 v[48:51], v[60:63], v[28:31], v[48:51]
    s_nop 1
    v_add_f32_dpp v10, v17, v16 row_ror:12 row_mask:0xf bank_mask:0x1
    s_memrealtime s[8:9]
    s_waitcnt lgkmcnt(0)
    s_sub_u32 s8, s8, s30
    s_cmpk_ge_u32 s8, 1390
    s_nop 0
    s_cbranch_scc1 .ap_207
    s_waitcnt vmcnt(3)
    s_cmpk_ge_u32 s8, 1325
    s_cbranch_scc1 .ap_207
    s_waitcnt vmcnt(3)
    s_bitcmp1_b64 s[14:15], 35
    s_cbranch_scc0 1
    s_waitcnt vmcnt(2)
    s_cmpk_ge_u32 s8, 1250
    s_cbranch_scc1 .ap_207
    s_waitcnt vmcnt(1)
.ap_207:
    s_add_u32 s63, s69, 24576
    buffer_load_dwordx4 v[172:175], v2, s[44:47], s63 offen nt
    v_mfma_f32_16x16x32_bf16 v[64:67], v[72:75], v[24:27], 0
    v_mfma_f32_16x16x32_bf16 v[56:59], v[68:71], v[28:31], v[56:59]
    v_add_f32_dpp v11, v33, v32 row_ror:12 row_mask:0xf bank_mask:0x1
    v_add_f32_dpp v10, v18, v10 row_ror:8 row_mask:0xf bank_mask:0x1
    v_mfma_f32_16x16x32_bf16 v[72:75], v[80:83], v[24:27], 0
    v_mfma_f32_16x16x32_bf16 v[64:67], v[76:79], v[28:31], v[64:67]
    v_add_f32_dpp v12, v41, v40 row_ror:12 row_mask:0xf bank_mask:0x1
    v_add_f32_dpp v11, v34, v11 row_ror:8 row_mask:0xf bank_mask:0x1
    v_add_f32_dpp v10, v19, v10 row_ror:4 row_mask:0xf bank_mask:0x1
    v_mfma_f32_16x16x32_bf16 v[80:83], v[88:91], v[24:27], 0
    v_mfma_f32_16x16x32_bf16 v[72:75], v[84:87], v[28:31], v[72:75]
    v_add_f32_dpp v13, v49, v48 row_ror:12 row_mask:0xf bank_mask:0x1
    v_add_f32_dpp v12, v42, v12 row_ror:8 row_mask:0xf bank_mask:0x1
    v_add_f32_dpp v11, v35, v11 row_ror:4 row_mask:0xf bank_mask:0x1
    v_mfma_f32_16x16x32_bf16 v[88:91], v[96:99], v[24:27], 0
    v_mfma_f32_16x16x32_bf16 v[80:83], v[92:95], v[28:31], v[80:83]
    v_add_f32_dpp v10, v58, v57 row_ror:12 row_mask:0xf bank_mask:0x2
    v_add_f32_dpp v13, v50, v13 row_ror:8 row_mask:0xf bank_mask:0x1
    v_add_f32_dpp v12, v43, v12 row_ror:4 row_mask:0xf bank_mask:0x1
    s_memrealtime s[8:9]
    s_waitcnt lgkmcnt(0)
    s_sub_u32 s8, s8, s30
    s_cmpk_ge_u32 s8, 1417
    s_nop 0
    s_cbranch_scc1 .ap_208
    s_waitcnt vmcnt(4)
    s_cmpk_ge_u32 s8, 1352
    s_cbranch_scc1 .ap_208
    s_waitcnt vmcnt(3)
    s_bitcmp1_b64 s[14:15], 36
    s_cbranch_scc0 1
    s_waitcnt vmcnt(2)
    s_cmpk_ge_u32 s8, 1277
    s_cbranch_scc1 .ap_208
    s_waitcnt vmcnt(1)
.ap_208:
    s_add_u32 s63, s69, 32768
    buffer_load_dwordx4 v[176:179], v2, s[44:47], s63 offen nt
    v_mfma_f32_16x16x32_bf16 v[96:99], v[104:107], v[24:27], 0
    v_mfma_f32_16x16x32_bf16 v[88:91], v[100:103], v[28:31], v[88:91]
    v_add_f32_dpp v11, v66, v65 row_ror:12 row_mask:0xf bank_mask:0x2
    v_add_f32_dpp v10, v59, v10 row_ror:8 row_mask:0xf bank_mask:0x2
    v_add_f32_dpp v13, v51, v13 row_ror:4 row_mask:0xf bank_mask:0x1
    v_mfma_f32_16x16x32_bf16 v[104:107], v[112:115], v[24:27], 0
    v_mfma_f32_16x16x32_bf16 v[96:99], v[108:111], v[28:31], v[96:99]
    v_add_f32_dpp v12, v74, v73 row_ror:12 row_mask:0xf bank_mask:0x2
    v_add_f32_dpp v11, v67, v11 row_ror:8 row_mask:0xf bank_mask:0x2
    v_add_f32_dpp v10, v56, v10 row_ror:4 row_mask:0xf bank_mask:0x2
    v_mfma_f32_16x16x32_bf16 v[112:115], v[120:123], v[24:27], 0
    v_mfma_f32_16x16x32_bf16 v[104:107], v[116:119], v[28:31], v[104:107]
    v_add_f32_dpp v13, v82, v81 row_ror:12 row_mask:0xf bank_mask:0x2
    v_add_f32_dpp v12, v75, v12 row_ror:8 row_mask:0xf bank_mask:0x2
    v_add_f32_dpp v11, v64, v11 row_ror:4 row_mask:0xf bank_mask:0x2
    v_mfma_f32_16x16x32_bf16 v[120:123], v[128:131], v[24:27], 0
    v_mfma_f32_16x16x32_bf16 v[112:115], v[124:127], v[28:31], v[112:115]
    v_add_f32_dpp v10, v91, v90 row_ror:12 row_mask:0xf bank_mask:0x4
    v_add_f32_dpp v13, v83, v13 row_ror:8 row_mask:0xf bank_mask:0x2
    v_add_f32_dpp v12, v72, v12 row_ror:4 row_mask:0xf bank_mask:0x2
    s_memrealtime s[8:9]
    s_waitcnt lgkmcnt(0)
    s_sub_u32 s8, s8, s30
    s_cmpk_ge_u32 s8, 1444
    s_nop 0
    s_cbranch_scc1 .ap_209
    s_waitcnt vmcnt(5)
    s_cmpk_ge_u32 s8, 1379
    s_cbranch_scc1 .ap_209
    s_waitcnt vmcnt(3)
    s_bitcmp1_b64 s[14:15], 37
    s_cbranch_scc0 1
    s_waitcnt vmcnt(2)
    s_cmpk_ge_u32 s8, 1304
    s_cbranch_scc1 .ap_209
    s_waitcnt vmcnt(1)
.ap_209:
    s_add_u32 s63, s69, 40960
    buffer_load_dwordx4 v[180:183], v2, s[44:47], s63 offen nt
    v_mfma_f32_16x16x32_bf16 v[128:131], v[136:139], v[24:27], 0
    v_mfma_f32_16x16x32_bf16 v[120:123], v[132:135], v[28:31], v[120:123]
    v_add_f32_dpp v11, v99, v98 row_ror:12 row_mask:0xf bank_mask:0x4
    v_add_f32_dpp v10, v88, v10 row_ror:8 row_mask:0xf bank_mask:0x4
    v_add_f32_dpp v13, v80, v13 row_ror:4 row_mask:0xf bank_mask:0x2
    v_mfma_f32_16x16x32_bf16 v[136:139], v[144:147], v[24:27], 0
    v_mfma_f32_16x16x32_bf16 v[128:131], v[140:143], v[28:31], v[128:131]
    v_add_f32_dpp v12, v107, v106 row_ror:12 row_mask:0xf bank_mask:0x4
    v_add_f32_dpp v11, v96, v11 row_ror:8 row_mask:0xf bank_mask:0x4
    v_add_f32_dpp v10, v89, v10 row_ror:4 row_mask:0xf bank_mask:0x4
    v_mfma_f32_16x16x32_bf16 v[144:147], v[152:155], v[24:27], 0
    v_mfma_f32_16x16x32_bf16 v[136:139], v[148:151], v[28:31], v[136:139]
    v_add_f32_dpp v13, v115, v114 row_ror:12 row_mask:0xf bank_mask:0x4
    v_add_f32_dpp v12, v104, v12 row_ror:8 row_mask:0xf bank_mask:0x4
    v_add_f32_dpp v11, v97, v11 row_ror:4 row_mask:0xf bank_mask:0x4
    v_mfma_f32_16x16x32_bf16 v[144:147], v[156:159], v[28:31], v[144:147]
    v_add_f32_dpp v10, v120, v123 row_ror:12 row_mask:0xf bank_mask:0x8
    v_add_f32_dpp v13, v112, v13 row_ror:8 row_mask:0xf bank_mask:0x4
    v_add_f32_dpp v12, v105, v12 row_ror:4 row_mask:0xf bank_mask:0x4
    s_memrealtime s[8:9]
    s_waitcnt lgkmcnt(0)
    s_sub_u32 s8, s8, s30
    s_cmpk_ge_u32 s8, 1471
    s_nop 0
    s_cbranch_scc1 .ap_210
    s_waitcnt vmcnt(5)
    s_cmpk_ge_u32 s8, 1406
    s_cbranch_scc1 .ap_210
    s_waitcnt vmcnt(3)
    s_bitcmp1_b64 s[14:15], 38
    s_cbranch_scc0 1
    s_waitcnt vmcnt(2)
    s_cmpk_ge_u32 s8, 1331
    s_cbranch_scc1 .ap_210
    s_waitcnt vmcnt(1)
.ap_210:
    s_add_u32 s63, s69, 49152
    buffer_load_dwordx4 v[184:187], v2, s[44:47], s63 offen nt
    v_add_f32_dpp v11, v128, v131 row_ror:12 row_mask:0xf bank_mask:0x8
    v_add_f32_dpp v10, v121, v10 row_ror:8 row_mask:0xf bank_mask:0x8
    v_add_f32_dpp v13, v113, v13 row_ror:4 row_mask:0xf bank_mask:0x4
    v_add_f32_dpp v12, v136, v139 row_ror:12 row_mask:0xf bank_mask:0x8
    v_add_f32_dpp v11, v129, v11 row_ror:8 row_mask:0xf bank_mask:0x8
    v_add_f32_dpp v10, v122, v10 row_ror:4 row_mask:0xf bank_mask:0x8
    v_add_f32_dpp v13, v144, v147 row_ror:12 row_mask:0xf bank_mask:0x8
    v_add_f32_dpp v12, v137, v12 row_ror:8 row_mask:0xf bank_mask:0x8
    v_add_f32_dpp v11, v130, v11 row_ror:4 row_mask:0xf bank_mask:0x8
    v_add_f32_dpp v13, v145, v13 row_ror:8 row_mask:0xf bank_mask:0x8
    v_add_f32_dpp v12, v138, v12 row_ror:4 row_mask:0xf bank_mask:0x8
    s_memrealtime s[8:9]
    s_waitcnt lgkmcnt(0)
    s_sub_u32 s8, s8, s30
    s_cmpk_ge_u32 s8, 1498
    s_cbranch_scc1 .ap_211
    s_waitcnt vmcnt(5)
    s_cmpk_ge_u32 s8, 1433
    s_cbranch_scc1 .ap_211
    s_waitcnt vmcnt(3)
    s_bitcmp1_b64 s[14:15], 39
    s_cbranch_scc0 1
    s_waitcnt vmcnt(2)
    s_cmpk_ge_u32 s8, 1358
    s_cbranch_scc1 .ap_211
    s_waitcnt vmcnt(1)
.ap_211:
    s_add_u32 s63, s69, 57344
    buffer_load_dwordx4 v[188:191], v2, s[44:47], s63 offen nt
    v_add_f32_dpp v13, v146, v13 row_ror:4 row_mask:0xf bank_mask:0x8
    s_mov_b32 s60, 0x3db504f3
    s_mov_b32 s61, 0x3db504f3
    v_cvt_pk_bf16_f32 v10, 0, v10
    v_cvt_pk_bf16_f32 v11, 0, v11
    v_cvt_pk_bf16_f32 v12, 0, v12
    v_cvt_pk_bf16_f32 v13, 0, v13
    v_pk_mul_f32 v[10:11], v[10:11], s[60:61]
    v_pk_mul_f32 v[12:13], v[12:13], s[60:61]
    v_cvt_pk_bf16_f32 v10, 0, v10
    v_cvt_pk_bf16_f32 v11, 0, v11
    v_cvt_pk_bf16_f32 v12, 0, v12
    v_cvt_pk_bf16_f32 v13, 0, v13
    v_max_f32 v14, v10, v11
    v_max3_f32 v14, v14, v12, v13
    s_mov_b32 s60, 0x3fb8aa3b
    v_mov_b32 v22, s34
    v_mov_b32 v23, s34
    v_max_f32_dpp v14, v14, v14 quad_perm:[2,3,0,1] row_mask:0xf bank_mask:0xf
    s_nop 1
    v_max_f32_dpp v14, v14, v14 row_ror:4 row_mask:0xf bank_mask:0xf
    s_nop 1
    v_max_f32_dpp v14, v14, v14 row_ror:8 row_mask:0xf bank_mask:0xf
    v_mov_b32 v15, v14
    s_nop 1
    v_permlane16_swap_b32 v15, v14
    v_max_f32 v14, v15, v14
    v_mov_b32 v15, v14
    s_nop 1
    v_permlane32_swap_b32 v15, v14
    v_max_f32 v14, v15, v14
    v_mul_f32 v15, 0xbfb8aa3b, v14
    v_fma_f32 v10, v10, s60, v15
    v_fma_f32 v11, v11, s60, v15
    v_fma_f32 v12, v12, s60, v15
    v_fma_f32 v13, v13, s60, v15
    v_exp_f32 v10, v10
    v_exp_f32 v11, v11
    v_exp_f32 v12, v12
    v_exp_f32 v13, v13
    v_mov_b32 v20, v14
    v_pk_add_f32 v[16:17], v[10:11], v[12:13]
    v_add_f32 v21, v16, v17
    s_lshl3_add_u32 s60, s68, s3
    s_lshl_b32 s60, s60, 5
    s_add_u32 s60, s60, s59
    v_add_f32_dpp v21, v21, v21 quad_perm:[2,3,0,1] row_mask:0xf bank_mask:0xf
    s_nop 1
    v_add_f32_dpp v21, v21, v21 row_ror:4 row_mask:0xf bank_mask:0xf
    s_nop 1
    v_add_f32_dpp v21, v21, v21 row_ror:8 row_mask:0xf bank_mask:0xf
    v_mov_b32 v15, v21
    s_nop 1
    v_permlane16_swap_b32 v15, v21
    v_add_f32 v21, v15, v21
    v_mov_b32 v15, v21
    s_nop 1
    v_permlane32_swap_b32 v15, v21
    v_add_f32 v21, v15, v21
    s_lshl_b32 s60, s3, 4
    s_add_u32 s60, s60, 159104
    v_add_u32 v16, s60, v3
    v_mov_b32 v17, 159232
    v_mov_b32 v18, 1
    s_mov_b64 exec, 3
    ds_write_b64 v16, v[20:21]
    s_mov_b64 exec, 1
    s_waitcnt lgkmcnt(0)
    ds_add_rtn_u32 v18, v17, v18
    s_mov_b64 exec, -1
    v_and_b32 v16, 0x78, v3
    v_add_u32 v16, 159104, v16
    s_waitcnt lgkmcnt(0)
    v_readfirstlane_b32 s60, v18
    s_cmp_lg_u32 s60, 7
    s_nop 3
    s_cbranch_scc1 .ml_212
    ds_read_b64 v[18:19], v16
    s_lshl_b32 s60, s68, 7
    s_add_u32 s60, s60, s59
    s_waitcnt lgkmcnt(0)
    v_mov_b32 v20, v18
    s_nop 1
    v_max_f32_dpp v20, v20, v20 quad_perm:[2,3,0,1] row_mask:0xf bank_mask:0xf
    s_nop 1
    v_max_f32_dpp v20, v20, v20 row_ror:4 row_mask:0xf bank_mask:0xf
    s_nop 1
    v_max_f32_dpp v20, v20, v20 row_ror:8 row_mask:0xf bank_mask:0xf
    v_sub_f32 v18, v18, v20
    v_mul_f32 v18, 0x3fb8aa3b, v18
    v_exp_f32 v18, v18
    s_nop 0
    v_mul_f32 v21, v18, v19
    s_nop 1
    v_add_f32_dpp v21, v21, v21 quad_perm:[2,3,0,1] row_mask:0xf bank_mask:0xf
    s_nop 1
    v_add_f32_dpp v21, v21, v21 row_ror:4 row_mask:0xf bank_mask:0xf
    s_nop 1
    v_add_f32_dpp v21, v21, v21 row_ror:8 row_mask:0xf bank_mask:0xf
    s_mov_b64 exec, 0xff
    buffer_store_dwordx4 v[20:23], v2, s[36:39], s60 offen sc1
    s_mov_b64 exec, -1
.ml_212:
    s_memrealtime s[8:9]
    s_waitcnt lgkmcnt(0)
    s_sub_u32 s8, s8, s30
    s_cmpk_ge_u32 s8, 1525
    s_cbranch_scc1 .ap_213
    s_waitcnt vmcnt(5)
    s_cmpk_ge_u32 s8, 1460
    s_cbranch_scc1 .ap_213
    s_waitcnt vmcnt(3)
    s_bitcmp1_b64 s[14:15], 40
    s_cbranch_scc0 1
    s_waitcnt vmcnt(2)
    s_cmpk_ge_u32 s8, 1385
    s_cbranch_scc1 .ap_213
    s_waitcnt vmcnt(1)
.ap_213:
    s_add_u32 s63, s69, 131072
    buffer_load_dwordx4 v[192:195], v2, s[44:47], s63 offen nt
    s_memrealtime s[8:9]
    s_waitcnt vmcnt(8)
    s_waitcnt lgkmcnt(0)
    s_sub_u32 s8, s8, s30
    s_cmpk_ge_u32 s8, 1552
    s_cbranch_scc1 .ap_214
    s_waitcnt vmcnt(5)
    s_cmpk_ge_u32 s8, 1487
    s_cbranch_scc1 .ap_214
    s_waitcnt vmcnt(3)
    s_bitcmp1_b64 s[14:15], 41
    s_cbranch_scc0 1
    s_waitcnt vmcnt(2)
    s_cmpk_ge_u32 s8, 1412
    s_cbranch_scc1 .ap_214
    s_waitcnt vmcnt(1)
.ap_214:
    s_add_u32 s63, s69, 139264
    buffer_load_dwordx4 v[196:199], v2, s[44:47], s63 offen nt
    s_memrealtime s[8:9]
    s_waitcnt vmcnt(8)
    s_waitcnt lgkmcnt(0)
    s_sub_u32 s8, s8, s30
    s_cmpk_ge_u32 s8, 1579
    s_cbranch_scc1 .ap_215
    s_waitcnt vmcnt(5)
    s_cmpk_ge_u32 s8, 1514
    s_cbranch_scc1 .ap_215
    s_waitcnt vmcnt(3)
    s_bitcmp1_b64 s[14:15], 42
    s_cbranch_scc0 1
    s_waitcnt vmcnt(2)
    s_cmpk_ge_u32 s8, 1439
    s_cbranch_scc1 .ap_215
    s_waitcnt vmcnt(1)
.ap_215:
    s_add_u32 s63, s69, 147456
    buffer_load_dwordx4 v[200:203], v2, s[44:47], s63 offen nt
    s_memrealtime s[8:9]
    s_waitcnt vmcnt(8)
    s_waitcnt lgkmcnt(0)
    s_sub_u32 s8, s8, s30
    s_cmpk_ge_u32 s8, 1606
    s_cbranch_scc1 .ap_216
    s_waitcnt vmcnt(5)
    s_cmpk_ge_u32 s8, 1541
    s_cbranch_scc1 .ap_216
    s_waitcnt vmcnt(3)
    s_bitcmp1_b64 s[14:15], 43
    s_cbranch_scc0 1
    s_waitcnt vmcnt(2)
    s_cmpk_ge_u32 s8, 1466
    s_cbranch_scc1 .ap_216
    s_waitcnt vmcnt(1)
.ap_216:
    s_add_u32 s63, s69, 155648
    buffer_load_dwordx4 v[204:207], v2, s[44:47], s63 offen nt
    s_memrealtime s[8:9]
    s_waitcnt vmcnt(8)
    s_waitcnt lgkmcnt(0)
    s_sub_u32 s8, s8, s30
    s_cmpk_ge_u32 s8, 1633
    s_cbranch_scc1 .ap_217
    s_waitcnt vmcnt(5)
    s_cmpk_ge_u32 s8, 1568
    s_cbranch_scc1 .ap_217
    s_waitcnt vmcnt(3)
    s_bitcmp1_b64 s[14:15], 44
    s_cbranch_scc0 1
    s_waitcnt vmcnt(2)
    s_cmpk_ge_u32 s8, 1493
    s_cbranch_scc1 .ap_217
    s_waitcnt vmcnt(1)
.ap_217:
    s_add_u32 s63, s69, 163840
    buffer_load_dwordx4 v[208:211], v2, s[44:47], s63 offen nt
    s_memrealtime s[8:9]
    s_waitcnt vmcnt(8)
    s_waitcnt lgkmcnt(0)
    s_sub_u32 s8, s8, s30
    s_cmpk_ge_u32 s8, 1660
    s_cbranch_scc1 .ap_218
    s_waitcnt vmcnt(5)
    s_cmpk_ge_u32 s8, 1595
    s_cbranch_scc1 .ap_218
    s_waitcnt vmcnt(3)
    s_bitcmp1_b64 s[14:15], 45
    s_cbranch_scc0 1
    s_waitcnt vmcnt(2)
    s_cmpk_ge_u32 s8, 1520
    s_cbranch_scc1 .ap_218
    s_waitcnt vmcnt(1)
.ap_218:
    s_add_u32 s63, s69, 172032
    buffer_load_dwordx4 v[212:215], v2, s[44:47], s63 offen nt
    s_memrealtime s[8:9]
    s_waitcnt vmcnt(8)
    s_waitcnt lgkmcnt(0)
    s_sub_u32 s8, s8, s30
    s_cmpk_ge_u32 s8, 1691
    s_cbranch_scc1 .ap_219
    s_waitcnt vmcnt(5)
    s_cmpk_ge_u32 s8, 1626
    s_cbranch_scc1 .ap_219
    s_waitcnt vmcnt(3)
    s_bitcmp1_b64 s[14:15], 46
    s_cbranch_scc0 1
    s_waitcnt vmcnt(2)
    s_cmpk_ge_u32 s8, 1551
    s_cbranch_scc1 .ap_219
    s_waitcnt vmcnt(1)
.ap_219:
    s_add_u32 s63, s69, 180224
    buffer_load_dwordx4 v[216:219], v2, s[44:47], s63 offen nt
    s_memrealtime s[8:9]
    s_waitcnt vmcnt(8)
    s_waitcnt lgkmcnt(0)
    s_sub_u32 s8, s8, s30
    s_cmpk_ge_u32 s8, 1722
    s_cbranch_scc1 .ap_220
    s_waitcnt vmcnt(5)
    s_cmpk_ge_u32 s8, 1657
    s_cbranch_scc1 .ap_220
    s_waitcnt vmcnt(3)
    s_bitcmp1_b64 s[14:15], 47
    s_cbranch_scc0 1
    s_waitcnt vmcnt(2)
    s_cmpk_ge_u32 s8, 1582
    s_cbranch_scc1 .ap_220
    s_waitcnt vmcnt(1)
.ap_220:
    s_add_u32 s63, s69, 188416
    buffer_load_dwordx4 v[220:223], v2, s[44:47], s63 offen nt
    s_memrealtime s[8:9]
    s_waitcnt vmcnt(8)
    s_waitcnt lgkmcnt(0)
    s_sub_u32 s8, s8, s30
    s_cmpk_ge_u32 s8, 1753
    s_cbranch_scc1 .ap_221
    s_waitcnt vmcnt(5)
    s_cmpk_ge_u32 s8, 1688
    s_cbranch_scc1 .ap_221
    s_waitcnt vmcnt(3)
    s_bitcmp1_b64 s[14:15], 48
    s_cbranch_scc0 1
    s_waitcnt vmcnt(2)
    s_cmpk_ge_u32 s8, 1613
    s_cbranch_scc1 .ap_221
    s_waitcnt vmcnt(1)
.ap_221:
    s_add_u32 s63, s69, 262144
    buffer_load_dwordx4 v[224:227], v2, s[44:47], s63 offen nt
    s_memrealtime s[8:9]
    s_waitcnt vmcnt(8)
    s_waitcnt lgkmcnt(0)
    s_sub_u32 s8, s8, s30
    s_cmpk_ge_u32 s8, 1784
    s_cbranch_scc1 .ap_222
    s_waitcnt vmcnt(5)
    s_cmpk_ge_u32 s8, 1719
    s_cbranch_scc1 .ap_222
    s_waitcnt vmcnt(3)
    s_bitcmp1_b64 s[14:15], 49
    s_cbranch_scc0 1
    s_waitcnt vmcnt(2)
    s_cmpk_ge_u32 s8, 1644
    s_cbranch_scc1 .ap_222
    s_waitcnt vmcnt(1)
.ap_222:
    s_add_u32 s63, s69, 270336
    buffer_load_dwordx4 v[228:231], v2, s[44:47], s63 offen nt
    s_memrealtime s[8:9]
    s_waitcnt vmcnt(8)
    s_waitcnt lgkmcnt(0)
    s_sub_u32 s8, s8, s30
    s_cmpk_ge_u32 s8, 1815
    s_cbranch_scc1 .ap_223
    s_waitcnt vmcnt(5)
    s_cmpk_ge_u32 s8, 1750
    s_cbranch_scc1 .ap_223
    s_waitcnt vmcnt(3)
    s_bitcmp1_b64 s[14:15], 50
    s_cbranch_scc0 1
    s_waitcnt vmcnt(2)
    s_cmpk_ge_u32 s8, 1675
    s_cbranch_scc1 .ap_223
    s_waitcnt vmcnt(1)
.ap_223:
    s_add_u32 s63, s69, 278528
    buffer_load_dwordx4 v[232:235], v2, s[44:47], s63 offen nt
    s_memrealtime s[8:9]
    s_waitcnt vmcnt(8)
    s_waitcnt lgkmcnt(0)
    s_sub_u32 s8, s8, s30
    s_cmpk_ge_u32 s8, 1846
    s_cbranch_scc1 .ap_224
    s_waitcnt vmcnt(5)
    s_cmpk_ge_u32 s8, 1781
    s_cbranch_scc1 .ap_224
    s_waitcnt vmcnt(3)
    s_bitcmp1_b64 s[14:15], 51
    s_cbranch_scc0 1
    s_waitcnt vmcnt(2)
    s_cmpk_ge_u32 s8, 1706
    s_cbranch_scc1 .ap_224
    s_waitcnt vmcnt(1)
.ap_224:
    s_add_u32 s63, s69, 286720
    buffer_load_dwordx4 v[236:239], v2, s[44:47], s63 offen nt
    s_memrealtime s[8:9]
    s_waitcnt vmcnt(8)
    s_waitcnt lgkmcnt(0)
    s_sub_u32 s8, s8, s30
    s_cmpk_ge_u32 s8, 1877
    s_cbranch_scc1 .ap_225
    s_waitcnt vmcnt(5)
    s_cmpk_ge_u32 s8, 1812
    s_cbranch_scc1 .ap_225
    s_waitcnt vmcnt(3)
    s_bitcmp1_b64 s[14:15], 52
    s_cbranch_scc0 1
    s_waitcnt vmcnt(2)
    s_cmpk_ge_u32 s8, 1737
    s_cbranch_scc1 .ap_225
    s_waitcnt vmcnt(1)
.ap_225:
    s_add_u32 s63, s69, 294912
    buffer_load_dwordx4 v[240:243], v2, s[44:47], s63 offen nt
    s_memrealtime s[8:9]
    s_waitcnt vmcnt(8)
    s_waitcnt lgkmcnt(0)
    s_sub_u32 s8, s8, s30
    s_cmpk_ge_u32 s8, 1908
    s_cbranch_scc1 .ap_226
    s_waitcnt vmcnt(5)
    s_cmpk_ge_u32 s8, 1843
    s_cbranch_scc1 .ap_226
    s_waitcnt vmcnt(3)
    s_bitcmp1_b64 s[14:15], 53
    s_cbranch_scc0 1
    s_waitcnt vmcnt(2)
    s_cmpk_ge_u32 s8, 1768
    s_cbranch_scc1 .ap_226
    s_waitcnt vmcnt(1)
.ap_226:
    s_add_u32 s63, s69, 303104
    buffer_load_dwordx4 v[244:247], v2, s[44:47], s63 offen nt
    s_load_dwordx2 s[88:89], s[6:7], s0
    buffer_load_dwordx4 v[24:27], v9, s[36:39], s59 offen offset:0 sc1
    s_memrealtime s[8:9]
    s_waitcnt vmcnt(8)
    s_waitcnt lgkmcnt(0)
    s_sub_u32 s8, s8, s30
    s_cmpk_ge_u32 s8, 1939
    s_cbranch_scc1 .ap_227
    s_waitcnt vmcnt(5)
    s_cmpk_ge_u32 s8, 1874
    s_cbranch_scc1 .ap_227
    s_waitcnt vmcnt(3)
    s_bitcmp1_b64 s[14:15], 54
    s_cbranch_scc0 1
    s_waitcnt vmcnt(2)
    s_cmpk_ge_u32 s8, 1799
    s_cbranch_scc1 .ap_227
    s_waitcnt vmcnt(1)
.ap_227:
    s_add_u32 s63, s69, 311296
    buffer_load_dwordx4 v[248:251], v2, s[44:47], s63 offen nt
    s_sub_u32 s56, s65, 27
    s_lshl3_add_u32 s56, s56, s3
    s_cmp_ge_u32 s56, 11
    s_cbranch_scc1 .cpf_228
    s_getpc_b64 s[8:9]
.Lcpf_pc:
    s_cmp_ge_u32 s56, 6
    s_mov_b32 s57, .Lcpf_pc-.Ltail_ar
    s_cselect_b32 s57, .Lcpf_pc-.Ltail_bc+6144, s57
    s_lshl_b32 s56, s56, 10
    s_sub_u32 s56, s57, s56
    s_sub_u32 s8, s8, s56
    s_subb_u32 s9, s9, 0
    v_mov_b32 v41, s9
    v_add_co_u32 v40, vcc, s8, v2
    s_nop 1
    v_addc_co_u32 v41, vcc, 0, v41, vcc
    global_load_dwordx4 v[32:35], v[40:41], off
.cpf_228:
    s_memrealtime s[8:9]
    s_waitcnt vmcnt(8)
    s_waitcnt lgkmcnt(0)
    s_sub_u32 s8, s8, s30
    s_cmpk_ge_u32 s8, 1970
    s_cbranch_scc1 .ap_229
    s_waitcnt vmcnt(5)
    s_cmpk_ge_u32 s8, 1905
    s_cbranch_scc1 .ap_229
    s_waitcnt vmcnt(3)
    s_bitcmp1_b64 s[14:15], 55
    s_cbranch_scc0 1
    s_waitcnt vmcnt(2)
    s_cmpk_ge_u32 s8, 1830
    s_cbranch_scc1 .ap_229
    s_waitcnt vmcnt(1)
.ap_229:
    s_add_u32 s63, s69, 319488
    buffer_load_dwordx4 v[252:255], v2, s[44:47], s63 offen nt
    s_memrealtime s[8:9]
    s_waitcnt vmcnt(8)
    s_waitcnt lgkmcnt(0)
    s_sub_u32 s8, s8, s30
    s_cmpk_ge_u32 s8, 2001
    s_cbranch_scc1 .ap_230
    s_waitcnt vmcnt(5)
    s_cmpk_ge_u32 s8, 1936
    s_cbranch_scc1 .ap_230
    s_waitcnt vmcnt(3)
    s_bitcmp1_b64 s[14:15], 56
    s_cbranch_scc0 1
    s_waitcnt vmcnt(2)
    s_cmpk_ge_u32 s8, 1861
    s_cbranch_scc1 .ap_230
    s_waitcnt vmcnt(1)
.ap_230:
    s_add_u32 s63, s69, 393216
    buffer_load_dwordx4 v[36:39], v2, s[44:47], s63 offen nt
    s_memrealtime s[8:9]
    s_waitcnt vmcnt(8)
    s_waitcnt lgkmcnt(0)
    s_sub_u32 s8, s8, s30
    s_cmpk_ge_u32 s8, 2032
    s_cbranch_scc1 .ap_231
    s_waitcnt vmcnt(5)
    s_cmpk_ge_u32 s8, 1967
    s_cbranch_scc1 .ap_231
    s_waitcnt vmcnt(3)
    s_bitcmp1_b64 s[14:15], 57
    s_cbranch_scc0 1
    s_waitcnt vmcnt(2)
    s_cmpk_ge_u32 s8, 1892
    s_cbranch_scc1 .ap_231
    s_waitcnt vmcnt(1)
.ap_231:
    s_add_u32 s63, s69, 401408
    buffer_load_dwordx4 v[44:47], v2, s[44:47], s63 offen nt
    s_memrealtime s[8:9]
    s_waitcnt vmcnt(8)
    s_waitcnt lgkmcnt(0)
    s_sub_u32 s8, s8, s30
    s_cmpk_ge_u32 s8, 2063
    s_cbranch_scc1 .ap_232
    s_waitcnt vmcnt(5)
    s_cmpk_ge_u32 s8, 1998
    s_cbranch_scc1 .ap_232
    s_waitcnt vmcnt(3)
    s_bitcmp1_b64 s[14:15], 58
    s_cbranch_scc0 1
    s_waitcnt vmcnt(2)
    s_cmpk_ge_u32 s8, 1923
    s_cbranch_scc1 .ap_232
    s_waitcnt vmcnt(1)
.ap_232:
    s_add_u32 s63, s69, 409600
    buffer_load_dwordx4 v[52:55], v2, s[44:47], s63 offen nt
    s_waitcnt vmcnt(5)
    s_branch .gpc_234
.gp_233:
    buffer_load_dwordx4 v[24:27], v9, s[36:39], s59 offen offset:0 sc1
    s_waitcnt vmcnt(0)
.gpc_234:
    v_cmp_eq_u32 vcc, s34, v26
    s_cmp_eq_u64 vcc, exec
    s_nop 3
    s_cbranch_scc1 .gpd_235
    s_sub_u32 s35, s35, 1
    s_cbranch_scc1 .Lexit
    s_sleep 1
    s_branch .gp_233
.gpd_235:
    s_lshr_b64 s[88:89], s[88:89], s1
    s_and_b32 s88, s88, 0xff
    s_cmp_eq_u32 s88, 32
    s_cselect_b32 s0, 0xac000, 0
    v_mov_b32 v16, v24
    s_nop 1
    v_max_f32_dpp v16, v16, v16 quad_perm:[2,3,0,1] row_mask:0xf bank_mask:0xf
    v_sub_f32 v17, v24, v16
    v_sub_f32 v18, v14, v16
    v_mul_f32 v17, 0x3fb8aa3b, v17
    v_mul_f32 v18, 0x3fb8aa3b, v18
    v_exp_f32 v17, v17
    v_exp_f32 v18, v18
    v_mul_f32 v17, v17, v25
    s_nop 1
    v_add_f32_dpp v17, v17, v17 quad_perm:[2,3,0,1] row_mask:0xf bank_mask:0xf
    v_rcp_f32 v19, v17
    s_nop 0
    v_fma_f32 v15, -v17, v19, 1.0
    v_fma_f32 v19, v15, v19, v19
    v_mul_f32 v18, v18, v19
    v_mul_f32 v10, v10, v18
    v_mul_f32 v11, v11, v18
    v_mul_f32 v12, v12, v18
    v_mul_f32 v13, v13, v18
    v_mov_b32_dpp v112, v10 quad_perm:[2,3,0,1] row_mask:0xf bank_mask:0xf
    v_mov_b32_dpp v113, v11 quad_perm:[2,3,0,1] row_mask:0xf bank_mask:0xf
    v_mov_b32_dpp v114, v12 quad_perm:[2,3,0,1] row_mask:0xf bank_mask:0xf
    v_mov_b32_dpp v115, v13 quad_perm:[2,3,0,1] row_mask:0xf bank_mask:0xf
    v_cvt_pk_bf16_f32 v96, v10, v112
    v_cvt_pk_bf16_f32 v100, v11, v113
    v_cvt_pk_bf16_f32 v104, v12, v114
    v_cvt_pk_bf16_f32 v108, v13, v115
    v_mov_b32_dpp v97, v96 row_ror:12 row_mask:0xf bank_mask:0xf
    v_mov_b32_dpp v101, v100 row_ror:12 row_mask:0xf bank_mask:0xf
    v_mov_b32_dpp v105, v104 row_ror:12 row_mask:0xf bank_mask:0xf
    v_mov_b32_dpp v109, v108 row_ror:12 row_mask:0xf bank_mask:0xf
    v_mov_b32_dpp v98, v96 row_ror:8 row_mask:0xf bank_mask:0xf
    v_mov_b32_dpp v102, v100 row_ror:8 row_mask:0xf bank_mask:0xf
    v_mov_b32_dpp v106, v104 row_ror:8 row_mask:0xf bank_mask:0xf
    v_mov_b32_dpp v110, v108 row_ror:8 row_mask:0xf bank_mask:0xf
    v_mov_b32_dpp v99, v96 row_ror:4 row_mask:0xf bank_mask:0xf
    v_mov_b32_dpp v103, v100 row_ror:4 row_mask:0xf bank_mask:0xf
    v_mov_b32_dpp v107, v104 row_ror:4 row_mask:0xf bank_mask:0xf
    v_mov_b32_dpp v111, v108 row_ror:4 row_mask:0xf bank_mask:0xf
    v_mov_b32_dpp v96, v96 row_shr:3 row_mask:0xf bank_mask:0x2
    v_mov_b32_dpp v97, v97 row_shr:3 row_mask:0xf bank_mask:0x2
    v_mov_b32_dpp v98, v98 row_shr:3 row_mask:0xf bank_mask:0x2
    v_mov_b32_dpp v99, v99 row_shr:3 row_mask:0xf bank_mask:0x2
    v_mov_b32_dpp v100, v100 row_shr:3 row_mask:0xf bank_mask:0x2
    v_mov_b32_dpp v101, v101 row_shr:3 row_mask:0xf bank_mask:0x2
    v_mov_b32_dpp v102, v102 row_shr:3 row_mask:0xf bank_mask:0x2
    v_mov_b32_dpp v103, v103 row_shr:3 row_mask:0xf bank_mask:0x2
    v_mov_b32_dpp v104, v104 row_shr:3 row_mask:0xf bank_mask:0x2
    v_mov_b32_dpp v105, v105 row_shr:3 row_mask:0xf bank_mask:0x2
    v_mov_b32_dpp v106, v106 row_shr:3 row_mask:0xf bank_mask:0x2
    v_mov_b32_dpp v107, v107 row_shr:3 row_mask:0xf bank_mask:0x2
    v_mov_b32_dpp v108, v108 row_shr:3 row_mask:0xf bank_mask:0x2
    v_mov_b32_dpp v109, v109 row_shr:3 row_mask:0xf bank_mask:0x2
    v_mov_b32_dpp v110, v110 row_shr:3 row_mask:0xf bank_mask:0x2
    v_mov_b32_dpp v111, v111 row_shr:3 row_mask:0xf bank_mask:0x2
    s_memrealtime s[8:9]
    s_waitcnt lgkmcnt(0)
    s_sub_u32 s8, s8, s30
    s_cmpk_ge_u32 s8, 2094
    s_cbranch_scc1 .ap_236
    s_waitcnt vmcnt(5)
    s_cmpk_ge_u32 s8, 2029
    s_cbranch_scc1 .ap_236
    s_waitcnt vmcnt(3)
    s_bitcmp1_b64 s[14:15], 59
    s_cbranch_scc0 1
    s_waitcnt vmcnt(2)
    s_cmpk_ge_u32 s8, 1954
    s_cbranch_scc1 .ap_236
    s_waitcnt vmcnt(1)
.ap_236:
    s_add_u32 s63, s69, 417792
    buffer_load_dwordx4 v[60:63], v2, s[44:47], s63 offen nt
    s_lshl_b32 s60, s3, 10
    s_add_u32 s60, s60, 132096
    v_lshlrev_b32 v10, 5, v0
    v_add_u32 v10, s60, v10
    v_lshrrev_b32 v11, 5, v0
    v_lshlrev_b32 v11, 13, v11
    v_and_b32 v12, 31, v0
    v_lshl_add_u32 v11, v12, 4, v11
    v_add_u32 v9, 132096, v2
    v_mov_b32 v15, s34
    s_memrealtime s[8:9]
    s_waitcnt lgkmcnt(0)
    s_sub_u32 s8, s8, s30
    s_cmpk_ge_u32 s8, 2125
    s_cbranch_scc1 .ap_237
    s_waitcnt vmcnt(5)
    s_cmpk_ge_u32 s8, 2060
    s_cbranch_scc1 .ap_237
    s_waitcnt vmcnt(3)
    s_bitcmp1_b64 s[14:15], 60
    s_cbranch_scc0 1
    s_waitcnt vmcnt(2)
    s_cmpk_ge_u32 s8, 1985
    s_cbranch_scc1 .ap_237
    s_waitcnt vmcnt(1)
.ap_237:
    s_add_u32 s63, s69, 425984
    buffer_load_dwordx4 v[68:71], v2, s[44:47], s63 offen nt
    v_perm_b32 v112, v164, v160, s94
    v_perm_b32 v113, v172, v168, s94
    v_perm_b32 v114, v180, v176, s94
    v_perm_b32 v115, v188, v184, s94
    s_nop 1
    v_mfma_f32_16x16x32_bf16 v[128:131], v[96:99], v[112:115], 0
    v_perm_b32 v116, v164, v160, s95
    v_perm_b32 v117, v172, v168, s95
    v_perm_b32 v118, v180, v176, s95
    v_perm_b32 v119, v188, v184, s95
    s_nop 1
    v_mfma_f32_16x16x32_bf16 v[132:135], v[96:99], v[116:119], 0
    v_perm_b32 v120, v165, v161, s94
    v_perm_b32 v121, v173, v169, s94
    v_perm_b32 v122, v181, v177, s94
    v_perm_b32 v123, v189, v185, s94
    s_nop 1
    v_mfma_f32_16x16x32_bf16 v[136:139], v[96:99], v[120:123], 0
    v_perm_b32 v124, v165, v161, s95
    v_perm_b32 v125, v173, v169, s95
    v_perm_b32 v126, v181, v177, s95
    v_perm_b32 v127, v189, v185, s95
    s_nop 1
    v_mfma_f32_16x16x32_bf16 v[140:143], v[96:99], v[124:127], 0
    v_perm_b32 v112, v166, v162, s94
    v_perm_b32 v113, v174, v170, s94
    v_perm_b32 v114, v182, v178, s94
    v_perm_b32 v115, v190, v186, s94
    s_nop 1
    v_mfma_f32_16x16x32_bf16 v[144:147], v[96:99], v[112:115], 0
    v_perm_b32 v116, v166, v162, s95
    v_perm_b32 v117, v174, v170, s95
    v_perm_b32 v118, v182, v178, s95
    v_perm_b32 v119, v190, v186, s95
    s_nop 1
    v_mfma_f32_16x16x32_bf16 v[148:151], v[96:99], v[116:119], 0
    v_perm_b32 v120, v167, v163, s94
    v_perm_b32 v121, v175, v171, s94
    v_perm_b32 v122, v183, v179, s94
    v_perm_b32 v123, v191, v187, s94
    s_nop 1
    v_mfma_f32_16x16x32_bf16 v[152:155], v[96:99], v[120:123], 0
    v_perm_b32 v124, v167, v163, s95
    v_perm_b32 v125, v175, v171, s95
    v_perm_b32 v126, v183, v179, s95
    v_perm_b32 v127, v191, v187, s95
    s_nop 1
    v_mfma_f32_16x16x32_bf16 v[156:159], v[96:99], v[124:127], 0
    s_memrealtime s[8:9]
    s_waitcnt lgkmcnt(0)
    s_sub_u32 s8, s8, s30
    s_cmpk_ge_u32 s8, 2156
    s_nop 3
    s_cbranch_scc1 .ap_238
    s_waitcnt vmcnt(5)
    s_cmpk_ge_u32 s8, 2091
    s_cbranch_scc1 .ap_238
    s_waitcnt vmcnt(3)
    s_bitcmp1_b64 s[14:15], 61
    s_cbranch_scc0 1
    s_waitcnt vmcnt(2)
    s_cmpk_ge_u32 s8, 2016
    s_cbranch_scc1 .ap_238
    s_waitcnt vmcnt(1)
.ap_238:
    s_add_u32 s63, s69, 434176
    buffer_load_dwordx4 v[76:79], v2, s[44:47], s63 offen nt
    v_perm_b32 v112, v196, v192, s94
    v_perm_b32 v113, v204, v200, s94
    v_perm_b32 v114, v212, v208, s94
    v_perm_b32 v115, v220, v216, s94
    s_nop 1
    v_mfma_f32_16x16x32_bf16 v[128:131], v[100:103], v[112:115], v[128:131]
    v_perm_b32 v116, v196, v192, s95
    v_perm_b32 v117, v204, v200, s95
    v_perm_b32 v118, v212, v208, s95
    v_perm_b32 v119, v220, v216, s95
    s_nop 1
    v_mfma_f32_16x16x32_bf16 v[132:135], v[100:103], v[116:119], v[132:135]
    v_perm_b32 v120, v197, v193, s94
    v_perm_b32 v121, v205, v201, s94
    v_perm_b32 v122, v213, v209, s94
    v_perm_b32 v123, v221, v217, s94
    s_nop 1
    v_mfma_f32_16x16x32_bf16 v[136:139], v[100:103], v[120:123], v[136:139]
    v_perm_b32 v124, v197, v193, s95
    v_perm_b32 v125, v205, v201, s95
    v_perm_b32 v126, v213, v209, s95
    v_perm_b32 v127, v221, v217, s95
    s_nop 1
    v_mfma_f32_16x16x32_bf16 v[140:143], v[100:103], v[124:127], v[140:143]
    v_perm_b32 v112, v198, v194, s94
    v_perm_b32 v113, v206, v202, s94
    v_perm_b32 v114, v214, v210, s94
    v_perm_b32 v115, v222, v218, s94
    s_nop 1
    v_mfma_f32_16x16x32_bf16 v[144:147], v[100:103], v[112:115], v[144:147]
    v_perm_b32 v116, v198, v194, s95
    v_perm_b32 v117, v206, v202, s95
    v_perm_b32 v118, v214, v210, s95
    v_perm_b32 v119, v222, v218, s95
    s_nop 1
    v_mfma_f32_16x16x32_bf16 v[148:151], v[100:103], v[116:119], v[148:151]
    v_perm_b32 v120, v199, v195, s94
    v_perm_b32 v121, v207, v203, s94
    v_perm_b32 v122, v215, v211, s94
    v_perm_b32 v123, v223, v219, s94
    s_nop 1
    v_mfma_f32_16x16x32_bf16 v[152:155], v[100:103], v[120:123], v[152:155]
    v_perm_b32 v124, v199, v195, s95
    v_perm_b32 v125, v207, v203, s95
    v_perm_b32 v126, v215, v211, s95
    v_perm_b32 v127, v223, v219, s95
    s_nop 1
    v_mfma_f32_16x16x32_bf16 v[156:159], v[100:103], v[124:127], v[156:159]
    s_memrealtime s[8:9]
    s_waitcnt lgkmcnt(0)
    s_sub_u32 s8, s8, s30
    s_cmpk_ge_u32 s8, 2187
    s_nop 3
    s_cbranch_scc1 .ap_239
    s_waitcnt vmcnt(5)
    s_cmpk_ge_u32 s8, 2122
    s_cbranch_scc1 .ap_239
    s_waitcnt vmcnt(3)
    s_bitcmp1_b64 s[14:15], 62
    s_cbranch_scc0 1
    s_waitcnt vmcnt(2)
    s_cmpk_ge_u32 s8, 2047
    s_cbranch_scc1 .ap_239
    s_waitcnt vmcnt(1)
.ap_239:
    s_add_u32 s63, s69, 442368
    buffer_load_dwordx4 v[84:87], v2, s[44:47], s63 offen nt
    s_waitcnt vmcnt(7)
    v_perm_b32 v112, v228, v224, s94
    v_perm_b32 v113, v236, v232, s94
    v_perm_b32 v114, v244, v240, s94
    v_perm_b32 v115, v252, v248, s94
    s_nop 1
    v_mfma_f32_16x16x32_bf16 v[128:131], v[104:107], v[112:115], v[128:131]
    v_perm_b32 v116, v228, v224, s95
    v_perm_b32 v117, v236, v232, s95
    v_perm_b32 v118, v244, v240, s95
    v_perm_b32 v119, v252, v248, s95
    s_nop 1
    v_mfma_f32_16x16x32_bf16 v[132:135], v[104:107], v[116:119], v[132:135]
    v_perm_b32 v120, v229, v225, s94
    v_perm_b32 v121, v237, v233, s94
    v_perm_b32 v122, v245, v241, s94
    v_perm_b32 v123, v253, v249, s94
    s_nop 1
    v_mfma_f32_16x16x32_bf16 v[136:139], v[104:107], v[120:123], v[136:139]
    v_perm_b32 v124, v229, v225, s95
    v_perm_b32 v125, v237, v233, s95
    v_perm_b32 v126, v245, v241, s95
    v_perm_b32 v127, v253, v249, s95
    s_nop 1
    v_mfma_f32_16x16x32_bf16 v[140:143], v[104:107], v[124:127], v[140:143]
    v_perm_b32 v112, v230, v226, s94
    v_perm_b32 v113, v238, v234, s94
    v_perm_b32 v114, v246, v242, s94
    v_perm_b32 v115, v254, v250, s94
    s_nop 1
    v_mfma_f32_16x16x32_bf16 v[144:147], v[104:107], v[112:115], v[144:147]
    v_perm_b32 v116, v230, v226, s95
    v_perm_b32 v117, v238, v234, s95
    v_perm_b32 v118, v246, v242, s95
    v_perm_b32 v119, v254, v250, s95
    s_nop 1
    v_mfma_f32_16x16x32_bf16 v[148:151], v[104:107], v[116:119], v[148:151]
    v_perm_b32 v120, v231, v227, s94
    v_perm_b32 v121, v239, v235, s94
    v_perm_b32 v122, v247, v243, s94
    v_perm_b32 v123, v255, v251, s94
    s_nop 1
    v_mfma_f32_16x16x32_bf16 v[152:155], v[104:107], v[120:123], v[152:155]
    v_perm_b32 v124, v231, v227, s95
    v_perm_b32 v125, v239, v235, s95
    v_perm_b32 v126, v247, v243, s95
    v_perm_b32 v127, v255, v251, s95
    s_nop 1
    v_mfma_f32_16x16x32_bf16 v[156:159], v[104:107], v[124:127], v[156:159]
    s_memrealtime s[8:9]
    s_waitcnt lgkmcnt(0)
    s_sub_u32 s8, s8, s30
    s_cmpk_ge_u32 s8, 2218
    s_nop 3
    s_cbranch_scc1 .ap_240
    s_waitcnt vmcnt(5)
    s_cmpk_ge_u32 s8, 2153
    s_cbranch_scc1 .ap_240
    s_waitcnt vmcnt(3)
    s_bitcmp1_b64 s[14:15], 63
    s_cbranch_scc0 1
    s_waitcnt vmcnt(2)
    s_cmpk_ge_u32 s8, 2078
    s_cbranch_scc1 .ap_240
    s_waitcnt vmcnt(1)
.ap_240:
    s_add_u32 s63, s69, 450560
    buffer_load_dwordx4 v[92:95], v2, s[44:47], s63 offen nt
    s_setprio 0
    s_waitcnt vmcnt(6)
    v_perm_b32 v160, v44, v36, s94
    v_perm_b32 v164, v44, v36, s95
    v_perm_b32 v168, v45, v37, s94
    v_perm_b32 v172, v45, v37, s95
    v_perm_b32 v176, v46, v38, s94
    v_perm_b32 v180, v46, v38, s95
    v_perm_b32 v184, v47, v39, s94
    v_perm_b32 v188, v47, v39, s95
    s_waitcnt vmcnt(4)
    v_perm_b32 v161, v60, v52, s94
    v_perm_b32 v165, v60, v52, s95
    v_perm_b32 v169, v61, v53, s94
    v_perm_b32 v173, v61, v53, s95
    v_perm_b32 v177, v62, v54, s94
    v_perm_b32 v181, v62, v54, s95
    v_perm_b32 v185, v63, v55, s94
    v_perm_b32 v189, v63, v55, s95
    v_mfma_f32_16x16x16_bf16 v[128:131], v[108:109], v[160:161], v[128:131]
    v_mfma_f32_16x16x16_bf16 v[132:135], v[108:109], v[164:165], v[132:135]
    v_mfma_f32_16x16x16_bf16 v[136:139], v[108:109], v[168:169], v[136:139]
    v_mfma_f32_16x16x16_bf16 v[140:143], v[108:109], v[172:173], v[140:143]
    v_mfma_f32_16x16x16_bf16 v[144:147], v[108:109], v[176:177], v[144:147]
    v_mfma_f32_16x16x16_bf16 v[148:151], v[108:109], v[180:181], v[148:151]
    v_mfma_f32_16x16x16_bf16 v[152:155], v[108:109], v[184:185], v[152:155]
    v_mfma_f32_16x16x16_bf16 v[156:159], v[108:109], v[188:189], v[156:159]
    s_waitcnt vmcnt(2)
    v_perm_b32 v162, v76, v68, s94
    v_perm_b32 v166, v76, v68, s95
    v_perm_b32 v170, v77, v69, s94
    v_perm_b32 v174, v77, v69, s95
    v_perm_b32 v178, v78, v70, s94
    v_perm_b32 v182, v78, v70, s95
    v_perm_b32 v186, v79, v71, s94
    v_perm_b32 v190, v79, v71, s95
    s_lshl4_add_u32 s59, s67, s66
    s_lshl1_add_u32 s59, s59, s68
    s_lshl_b32 s59, s59, 9
    s_add_u32 s59, s59, 0x210000
    s_mov_b32 s60, 0x07060503
    s_mov_b32 s61, 0x07060502
    s_mov_b32 s62, 0x07060501
.Ltail_n:
    s_waitcnt vmcnt(0)
    v_perm_b32 v163, v92, v84, s94
    v_perm_b32 v167, v92, v84, s95
    v_perm_b32 v171, v93, v85, s94
    v_perm_b32 v175, v93, v85, s95
    v_perm_b32 v179, v94, v86, s94
    v_perm_b32 v183, v94, v86, s95
    v_perm_b32 v187, v95, v87, s94
    v_perm_b32 v191, v95, v87, s95
    v_mfma_f32_16x16x16_bf16 v[128:131], v[110:111], v[162:163], v[128:131]
    v_mfma_f32_16x16x16_bf16 v[132:135], v[110:111], v[166:167], v[132:135]
    v_mfma_f32_16x16x16_bf16 v[136:139], v[110:111], v[170:171], v[136:139]
    v_mfma_f32_16x16x16_bf16 v[140:143], v[110:111], v[174:175], v[140:143]
    v_mfma_f32_16x16x16_bf16 v[144:147], v[110:111], v[178:179], v[144:147]
    v_mfma_f32_16x16x16_bf16 v[148:151], v[110:111], v[182:183], v[148:151]
    v_mfma_f32_16x16x16_bf16 v[152:155], v[110:111], v[186:187], v[152:155]
    v_mfma_f32_16x16x16_bf16 v[156:159], v[110:111], v[190:191], v[156:159]
    s_mov_b64 exec, 0xffffffff
    s_nop 0
    ds_write2_b32 v10, v128, v132 offset0:0 offset1:1
    s_nop 0
    ds_write2_b32 v10, v136, v140 offset0:2 offset1:3
    s_nop 0
    ds_write2_b32 v10, v144, v148 offset0:4 offset1:5
    s_nop 0
    ds_write2_b32 v10, v152, v156 offset0:6 offset1:7
    s_mov_b64 exec, -1
    s_waitcnt lgkmcnt(0)
    s_barrier
    s_cmp_lg_u32 s3, 7
    s_cbranch_scc1 .opub_241
    ds_read_b128 v[196:199], v9 offset:0
    ds_read_b128 v[200:203], v9 offset:1024
    ds_read_b128 v[204:207], v9 offset:2048
    ds_read_b128 v[208:211], v9 offset:3072
    ds_read_b128 v[212:215], v9 offset:4096
    ds_read_b128 v[216:219], v9 offset:5120
    ds_read_b128 v[220:223], v9 offset:6144
    ds_read_b128 v[224:227], v9 offset:7168
    s_waitcnt lgkmcnt(6)
    v_pk_add_f32 v[196:197], v[196:197], v[200:201]
    v_pk_add_f32 v[198:199], v[198:199], v[202:203]
    s_waitcnt lgkmcnt(4)
    v_pk_add_f32 v[204:205], v[204:205], v[208:209]
    v_pk_add_f32 v[206:207], v[206:207], v[210:211]
    v_pk_add_f32 v[196:197], v[196:197], v[204:205]
    v_pk_add_f32 v[198:199], v[198:199], v[206:207]
    s_waitcnt lgkmcnt(2)
    v_pk_add_f32 v[212:213], v[212:213], v[216:217]
    v_pk_add_f32 v[214:215], v[214:215], v[218:219]
    s_waitcnt lgkmcnt(0)
    v_pk_add_f32 v[220:221], v[220:221], v[224:225]
    v_pk_add_f32 v[222:223], v[222:223], v[226:227]
    v_pk_add_f32 v[212:213], v[212:213], v[220:221]
    v_pk_add_f32 v[214:215], v[214:215], v[222:223]
    v_pk_add_f32 v[196:197], v[196:197], v[212:213]
    v_pk_add_f32 v[198:199], v[198:199], v[214:215]
    v_perm_b32 v12, v196, v199, s60
    v_perm_b32 v13, v197, v199, s61
    v_perm_b32 v14, v198, v199, s62
    s_add_u32 s57, s59, 0xac000
    buffer_store_dwordx4 v[12:15], v11, s[36:39], s57 offen
    buffer_store_dwordx4 v[12:15], v11, s[36:39], s59 offen sc1
.opub_241:
.Lexit:
.Lend:
s_endpgm
.section .rodata,"a"
.p2align 6
.amdhsa_kernel adaLN_cond__sliding_block_cached__moe_arch_mod__decode_kernel
  .amdhsa_next_free_vgpr 256
  .amdhsa_next_free_sgpr 102
  .amdhsa_accum_offset 256
  .amdhsa_group_segment_fixed_size 0
  .amdhsa_kernarg_size 120
  .amdhsa_user_sgpr_count 2
  .amdhsa_user_sgpr_kernarg_segment_ptr 1
  .amdhsa_system_sgpr_workgroup_id_x 1
.end_amdhsa_kernel
```

```asm
; @launch grid=(256,1,1) block=(512,1,1) lds=159360
.amdgcn_target "amdgcn-amd-amdhsa--gfx950"
.text
.globl adaLN_cond__sliding_block_cached__moe_arch_mod__decode_kernel
.p2align 8
.type adaLN_cond__sliding_block_cached__moe_arch_mod__decode_kernel,@function
adaLN_cond__sliding_block_cached__moe_arch_mod__decode_kernel:
    s_cmp_ge_u32 s2, 256
    s_cbranch_scc1 .Lend
    s_load_dwordx16 s[4:19], s[0:1], 0
    s_load_dwordx8 s[20:27], s[0:1], 64
    s_load_dwordx4 s[28:31], s[0:1], 96
    s_load_dwordx2 s[32:33], s[0:1], 112
    s_memrealtime s[70:71]
    v_lshrrev_b32 v1, 6, v0
    v_and_b32 v0, 63, v0
    v_readfirstlane_b32 s3, v1
    s_mov_b32 s35, 0x3ffff
    s_mov_b32 s98, 0xbfb8aa3b
    s_mov_b32 s94, 0x05040100
    s_mov_b32 s95, 0x07060302
    s_mov_b32 s96, 0xaaaaaaaa
    s_mov_b32 s97, 0xaaaaaaaa
    s_and_b32 s64, s2, 7
    s_lshr_b32 s65, s2, 3
    s_and_b32 s66, s65, 7
    s_lshr_b32 s67, s2, 7
    s_lshl1_add_u32 s67, s64, s67
    s_bfe_u32 s68, s2, 0x10006
    s_lshl4_add_u32 s69, s66, s67
    s_lshl_b32 s69, s69, 21
    s_lshl_b32 s56, s68, 16
    s_add_u32 s69, s69, s56
    s_lshl_b32 s56, s3, 10
    s_add_u32 s69, s69, s56
    s_add_u32 s69, s69, 0x180000
    v_bfe_u32 v1, v0, 2, 2
    v_lshrrev_b32 v2, 4, v0
    v_lshl_add_u32 v1, v1, 2, v2
    v_and_b32 v2, 3, v0
    v_lshl_add_u32 v1, v1, 2, v2
    v_lshlrev_b32 v1, 4, v1
    v_lshlrev_b32 v2, 4, v0
    v_lshlrev_b32 v3, 3, v0
    v_and_b32 v4, 31, v0
    v_lshlrev_b32 v4, 2, v4
    v_add_u32 v4, 1024, v4
    v_lshlrev_b32 v5, 1, v4
    s_waitcnt lgkmcnt(0)
    s_load_dword s34, s[32:33], 0
    s_sub_u32 s99, s2, 216
    s_cmp_ge_u32 s99, 18
    s_cbranch_scc1 .Lmcf_no
    s_mul_i32 s58, s3, 1152
    s_mov_b32 s52, s24
    s_and_b32 s53, s25, 0xffff
    s_mov_b32 s54, 0x2400
    s_mov_b32 s55, 0x00020000
    buffer_load_dwordx2 v[246:247], v3, s[52:55], s58 offen
    buffer_load_dwordx2 v[248:249], v3, s[52:55], s58 offen offset:512
    buffer_load_dword v250, v4, s[52:55], s58 offen
    s_mov_b32 s48, s26
    s_and_b32 s49, s27, 0xffff
    s_mov_b32 s50, 0x3cc000
    s_mov_b32 s51, 0x00020000
    v_bfe_u32 v12, v0, 4, 1
    s_and_b32 s56, s3, 3
    s_lshl_b32 s56, s56, 1
    v_or_b32 v12, s56, v12
    v_and_b32 v19, 7, v0
    v_xor_b32 v12, v12, v19
    v_lshrrev_b32 v19, 3, v0
    v_mul_u32_u24 v19, 6912, v19
    v_lshl_add_u32 v19, v12, 4, v19
    s_mul_i32 s57, s3, 55296
    s_lshl_b32 s59, s99, 7
    s_add_u32 s57, s57, s59
    s_lshl_b32 s100, s3, 10
    s_add_u32 m0, s100, 0
    s_add_u32 s56, s57, 0
    buffer_load_dwordx4 v19, s[48:51], s56 offen nt lds
    s_add_u32 m0, s100, 8192
    s_add_u32 s56, s57, 442368
    buffer_load_dwordx4 v19, s[48:51], s56 offen nt lds
    s_add_u32 m0, s100, 16384
    s_add_u32 s56, s57, 884736
    buffer_load_dwordx4 v19, s[48:51], s56 offen nt lds
    s_add_u32 m0, s100, 24576
    s_add_u32 s56, s57, 1327104
    buffer_load_dwordx4 v19, s[48:51], s56 offen nt lds
    s_add_u32 m0, s100, 32768
    s_add_u32 s56, s57, 1769472
    buffer_load_dwordx4 v19, s[48:51], s56 offen nt lds
    s_add_u32 m0, s100, 40960
    s_add_u32 s56, s57, 2211840
    buffer_load_dwordx4 v19, s[48:51], s56 offen nt lds
    s_add_u32 m0, s100, 49152
    s_add_u32 s56, s57, 2654208
    buffer_load_dwordx4 v19, s[48:51], s56 offen nt lds
    s_add_u32 m0, s100, 57344
    s_add_u32 s56, s57, 3096576
    buffer_load_dwordx4 v19, s[48:51], s56 offen nt lds
    s_add_u32 m0, s100, 65536
    s_add_u32 s56, s57, 3538944
    buffer_load_dwordx4 v19, s[48:51], s56 offen nt lds
.Lmcf_no:
    s_mov_b32 s40, s6
    s_and_b32 s41, s7, 0xffff
    s_mov_b32 s42, 0x10000000
    s_mov_b32 s43, 0x00020000
    s_add_u32 s63, s69, 0
    buffer_load_dwordx4 v[32:35], v1, s[40:43], s63 offen nt
    s_add_u32 s63, s69, 8192
    buffer_load_dwordx4 v[36:39], v1, s[40:43], s63 offen nt
    s_add_u32 s63, s69, 16384
    buffer_load_dwordx4 v[64:67], v1, s[40:43], s63 offen nt
    s_add_u32 s63, s69, 24576
    buffer_load_dwordx4 v[68:71], v1, s[40:43], s63 offen nt
    s_mov_b32 s44, s8
    s_and_b32 s45, s9, 0xffff
    s_mov_b32 s46, 0x10000000
    s_mov_b32 s47, 0x00020000
    s_mov_b32 s36, s32
    s_and_b32 s37, s33, 0xffff
    s_mov_b32 s38, 0x40000000
    s_mov_b32 s39, 0x00020000
    s_lshl3_add_u32 s56, s3, s2
    s_cmp_lt_u32 s56, 8
    s_cbranch_scc0 .Let_no
    s_lshl_b32 s56, s2, 7
    s_add_u32 s56, s56, 0x400
    v_mov_b32 v7, s70
    s_mov_b64 exec, 1
    buffer_store_dword v7, v2, s[36:39], s56 offen sc1
    s_mov_b64 exec, -1
.Let_no:
    s_mov_b32 s52, s30
    s_and_b32 s53, s31, 0xffff
    s_mov_b32 s54, 0x100
    s_mov_b32 s55, 0x00020000
    s_mov_b64 s[6:7], s[30:31]
    s_getreg_b32 s1, hwreg(HW_REG_XCC_ID)
    s_and_b32 s1, s1, 7
    s_lshl_b32 s1, s1, 3
    s_lshl_b32 s0, s64, 5
    s_cmp_lg_u32 s3, 0
    s_cbranch_scc1 .Lxa_no
    s_lshl_b64 s[56:57], 1, s1
    v_mov_b32 v8, s56
    v_mov_b32 v9, s57
    s_mov_b64 exec, 1
    buffer_atomic_add_x2 v[8:9], v2, s[52:55], s0 offen sc1
    v_mov_b32 v8, 0
    v_mov_b32 v9, 159232
    ds_write_b32 v9, v8
    s_waitcnt lgkmcnt(0)
    s_mov_b64 exec, -1
.Lxa_no:
    s_barrier
    s_cmp_lt_u32 s3, 4
    s_cbranch_scc1 1
    s_setprio 1
.Lresume:
    s_cmp_lt_u32 s65, 9
    s_cbranch_scc1 .Le_a
    s_sub_u32 s56, 3, s64
    s_and_b32 s56, s56, 7
    s_lshl1_add_u32 s56, s56, 9
    s_sub_u32 s56, s65, s56
    s_cselect_b32 s57, 18, 0
    s_add_u32 s56, s56, s57
    s_sub_u32 s101, s56, 2
    s_cmp_ge_u32 s56, 5
    s_addc_u32 s101, s101, 0
    s_sub_u32 s99, s56, 5
    s_min_u32 s99, s99, 7
    s_cmp_lt_u32 s65, 27
    s_cbranch_scc1 .Lrole_bc
    s_mov_b32 s101, 3
    s_sub_u32 s99, s65, 27
    s_cmp_ge_u32 s65, 31
    s_cselect_b32 s56, 2, 9
.Lrole_bc:
    s_lshl3_add_u32 s99, s99, s64
    s_sub_u32 s56, s56, 2
    s_cmp_lt_u32 s56, 7
    s_cbranch_scc1 .Le_q
    s_cmp_lt_u32 s99, 18
    s_cbranch_scc1 .Le_mc
    s_cmp_lt_u32 s99, 54
    s_mov_b32 s14, 0xfdff7fdf
    s_cselect_b32 s14, 0x6b5ad6b5, s14
    s_mov_b32 s15, 0xff7fdff7
    s_cselect_b32 s15, 0x5ad6b5ad, s15
    s_cselect_b32 s30, -30, 0
    s_add_u32 s30, s30, 0
    s_add_u32 s30, s30, s70
    s_sub_u32 s56, s65, 9
    s_lshr_b32 s56, s56, 1
    s_add_u32 s56, s56, s64
    s_and_b32 s56, s56, 7
    s_cmp_eq_u32 s56, 3
    s_cselect_b32 s56, -30, 0
    s_cmp_lt_u32 s99, 54
    s_cselect_b32 s56, 0, s56
    s_add_u32 s30, s30, s56
    s_waitcnt vmcnt(3)
    s_bitcmp1_b64 s[14:15], 4
    s_cbranch_scc0 1
    s_waitcnt vmcnt(2)
    s_add_u32 s63, s69, 32768
    buffer_load_dwordx4 v[96:99], v1, s[40:43], s63 offen nt
    s_memrealtime s[8:9]
    s_waitcnt lgkmcnt(0)
    s_sub_u32 s8, s8, s30
    s_cmpk_ge_u32 s8, 290
    s_cbranch_scc1 .ap_1
    s_waitcnt vmcnt(4)
    s_cmpk_ge_u32 s8, 225
    s_cbranch_scc1 .ap_1
    s_waitcnt vmcnt(3)
    s_bitcmp1_b64 s[14:15], 5
    s_cbranch_scc0 1
    s_waitcnt vmcnt(2)
    s_cmpk_ge_u32 s8, 150
    s_cbranch_scc1 .ap_1
    s_waitcnt vmcnt(1)
.ap_1:
    s_add_u32 s63, s69, 40960
    buffer_load_dwordx4 v[100:103], v1, s[40:43], s63 offen nt
    s_memrealtime s[8:9]
    s_waitcnt lgkmcnt(0)
    s_sub_u32 s8, s8, s30
    s_cmpk_ge_u32 s8, 315
    s_cbranch_scc1 .ap_2
    s_waitcnt vmcnt(5)
    s_cmpk_ge_u32 s8, 250
    s_cbranch_scc1 .ap_2
    s_waitcnt vmcnt(3)
    s_bitcmp1_b64 s[14:15], 6
    s_cbranch_scc0 1
    s_waitcnt vmcnt(2)
    s_cmpk_ge_u32 s8, 175
    s_cbranch_scc1 .ap_2
    s_waitcnt vmcnt(1)
.ap_2:
    s_add_u32 s63, s69, 49152
    buffer_load_dwordx4 v[128:131], v1, s[40:43], s63 offen nt
    s_memrealtime s[8:9]
    s_waitcnt lgkmcnt(0)
    s_sub_u32 s8, s8, s30
    s_cmpk_ge_u32 s8, 340
    s_cbranch_scc1 .ap_3
    s_waitcnt vmcnt(5)
    s_cmpk_ge_u32 s8, 275
    s_cbranch_scc1 .ap_3
    s_waitcnt vmcnt(3)
    s_bitcmp1_b64 s[14:15], 7
    s_cbranch_scc0 1
    s_waitcnt vmcnt(2)
    s_cmpk_ge_u32 s8, 200
    s_cbranch_scc1 .ap_3
    s_waitcnt vmcnt(1)
.ap_3:
    s_add_u32 s63, s69, 57344
    buffer_load_dwordx4 v[132:135], v1, s[40:43], s63 offen nt
    s_memrealtime s[8:9]
    s_waitcnt lgkmcnt(0)
    s_sub_u32 s8, s8, s30
    s_cmpk_ge_u32 s8, 365
    s_cbranch_scc1 .ap_4
    s_waitcnt vmcnt(5)
    s_cmpk_ge_u32 s8, 300
    s_cbranch_scc1 .ap_4
    s_waitcnt vmcnt(3)
    s_bitcmp1_b64 s[14:15], 8
    s_cbranch_scc0 1
    s_waitcnt vmcnt(2)
    s_cmpk_ge_u32 s8, 225
    s_cbranch_scc1 .ap_4
    s_waitcnt vmcnt(1)
.ap_4:
    s_add_u32 s63, s69, 131072
    buffer_load_dwordx4 v[40:43], v1, s[40:43], s63 offen nt
    s_memrealtime s[8:9]
    s_waitcnt lgkmcnt(0)
    s_sub_u32 s8, s8, s30
    s_cmpk_ge_u32 s8, 390
    s_cbranch_scc1 .ap_5
    s_waitcnt vmcnt(5)
    s_cmpk_ge_u32 s8, 325
    s_cbranch_scc1 .ap_5
    s_waitcnt vmcnt(3)
    s_bitcmp1_b64 s[14:15], 9
    s_cbranch_scc0 1
    s_waitcnt vmcnt(2)
    s_cmpk_ge_u32 s8, 250
    s_cbranch_scc1 .ap_5
    s_waitcnt vmcnt(1)
.ap_5:
    s_add_u32 s63, s69, 139264
    buffer_load_dwordx4 v[44:47], v1, s[40:43], s63 offen nt
    s_waitcnt lgkmcnt(0)
    s_add_u32 s34, s34, 1
    s_cmp_lt_u32 s99, 54
    s_cbranch_scc1 .Le_mr
    s_sub_u32 s57, s65, 9
    s_bitcmp1_b32 s57, 0
    s_cselect_b32 s48, s20, s18
    s_cselect_b32 s49, s21, s19
    s_cselect_b32 s33, 36, 0
    s_and_b32 s49, s49, 0xffff
    s_mov_b32 s50, 0x510000
    s_mov_b32 s51, 0x00020000
    s_mov_b32 s52, s22
    s_and_b32 s53, s23, 0xffff
    s_mov_b32 s54, 0x510000
    s_mov_b32 s55, 0x00020000
    s_lshr_b32 s57, s57, 1
    s_lshl_b32 s57, s57, 7
    s_mul_i32 s101, s64, 1152
    s_add_u32 s101, s101, s57
    s_mul_i32 s56, s3, 73728
    s_add_u32 s101, s101, s56
    s_mul_i32 s56, s64, 72
    s_add_u32 s33, s33, s56
    s_add_u32 s33, s33, s3
    s_mul_i32 s33, s33, 9216
    s_add_u32 s33, s33, s57
    s_bfe_u32 s56, s101, 0x30007
    s_cmp_eq_u32 s56, 3
    s_cselect_b32 s100, 1, 0
    v_bfe_u32 v12, v0, 4, 1
    s_and_b32 s56, s3, 3
    s_lshl_b32 s56, s56, 1
    v_or_b32 v12, s56, v12
    v_and_b32 v6, 7, v0
    v_xor_b32 v12, v12, v6
    v_lshrrev_b32 v6, 3, v0
    v_mul_u32_u24 v6, 9216, v6
    v_lshl_add_u32 v6, v12, 4, v6
    v_bfe_u32 v12, v0, 4, 1
    s_and_b32 s56, s3, 1
    s_lshl_b32 s56, s56, 2
    v_lshl_or_b32 v12, v12, 1, s56
    v_and_b32 v13, 7, v0
    v_xor_b32 v12, v12, v13
    v_lshrrev_b32 v13, 3, v0
    v_mul_u32_u24 v13, 1152, v13
    v_lshl_add_u32 v31, v12, 4, v13
    s_lshl_b32 s32, s3, 10
    s_memrealtime s[8:9]
    s_waitcnt vmcnt(8)
    s_waitcnt lgkmcnt(0)
    s_sub_u32 s8, s8, s30
    s_cmpk_ge_u32 s8, 436
    s_cbranch_scc1 .ap_6
    s_waitcnt vmcnt(5)
    s_cmpk_ge_u32 s8, 371
    s_cbranch_scc1 .ap_6
    s_waitcnt vmcnt(3)
    s_bitcmp1_b64 s[14:15], 10
    s_cbranch_scc0 1
    s_waitcnt vmcnt(2)
    s_cmpk_ge_u32 s8, 296
    s_cbranch_scc1 .ap_6
    s_waitcnt vmcnt(1)
.ap_6:
    s_add_u32 s63, s69, 147456
    buffer_load_dwordx4 v[72:75], v1, s[40:43], s63 offen nt
    s_cmp_eq_u32 s100, 0
    s_cbranch_scc1 .ls_7
    s_add_u32 m0, s32, 0
    s_add_u32 s56, s101, 0
    buffer_load_dwordx4 v6, s[48:51], s56 offen nt lds
.ls_7:
    s_memrealtime s[8:9]
    s_waitcnt vmcnt(8)
    s_waitcnt lgkmcnt(0)
    s_sub_u32 s8, s8, s30
    s_cmpk_ge_u32 s8, 482
    s_cbranch_scc1 .ap_8
    s_waitcnt vmcnt(5)
    s_cmpk_ge_u32 s8, 417
    s_cbranch_scc1 .ap_8
    s_waitcnt vmcnt(3)
    s_bitcmp1_b64 s[14:15], 11
    s_cbranch_scc0 1
    s_waitcnt vmcnt(2)
    s_cmpk_ge_u32 s8, 342
    s_cbranch_scc1 .ap_8
    s_waitcnt vmcnt(1)
.ap_8:
    s_add_u32 s63, s69, 155648
    buffer_load_dwordx4 v[76:79], v1, s[40:43], s63 offen nt
    s_memrealtime s[8:9]
    s_waitcnt vmcnt(8)
    s_waitcnt lgkmcnt(0)
    s_sub_u32 s8, s8, s30
    s_cmpk_ge_u32 s8, 528
    s_cbranch_scc1 .ap_9
    s_waitcnt vmcnt(5)
    s_cmpk_ge_u32 s8, 463
    s_cbranch_scc1 .ap_9
    s_waitcnt vmcnt(3)
    s_bitcmp1_b64 s[14:15], 12
    s_cbranch_scc0 1
    s_waitcnt vmcnt(2)
    s_cmpk_ge_u32 s8, 388
    s_cbranch_scc1 .ap_9
    s_waitcnt vmcnt(1)
.ap_9:
    s_add_u32 s63, s69, 163840
    buffer_load_dwordx4 v[104:107], v1, s[40:43], s63 offen nt
    s_memrealtime s[8:9]
    s_waitcnt vmcnt(8)
    s_waitcnt lgkmcnt(0)
    s_sub_u32 s8, s8, s30
    s_cmpk_ge_u32 s8, 574
    s_cbranch_scc1 .ap_10
    s_waitcnt vmcnt(5)
    s_cmpk_ge_u32 s8, 509
    s_cbranch_scc1 .ap_10
    s_waitcnt vmcnt(3)
    s_bitcmp1_b64 s[14:15], 13
    s_cbranch_scc0 1
    s_waitcnt vmcnt(2)
    s_cmpk_ge_u32 s8, 434
    s_cbranch_scc1 .ap_10
    s_waitcnt vmcnt(1)
.ap_10:
    s_add_u32 s63, s69, 172032
    buffer_load_dwordx4 v[108:111], v1, s[40:43], s63 offen nt
    s_cmp_eq_u32 s100, 0
    s_cbranch_scc1 .ls_11
    s_add_u32 m0, s32, 8192
    s_add_u32 s56, s101, 589824
    buffer_load_dwordx4 v6, s[48:51], s56 offen nt lds
.ls_11:
    s_memrealtime s[8:9]
    s_waitcnt vmcnt(8)
    s_waitcnt lgkmcnt(0)
    s_sub_u32 s8, s8, s30
    s_cmpk_ge_u32 s8, 620
    s_cbranch_scc1 .ap_12
    s_waitcnt vmcnt(5)
    s_cmpk_ge_u32 s8, 555
    s_cbranch_scc1 .ap_12
    s_waitcnt vmcnt(3)
    s_bitcmp1_b64 s[14:15], 14
    s_cbranch_scc0 1
    s_waitcnt vmcnt(2)
    s_cmpk_ge_u32 s8, 480
    s_cbranch_scc1 .ap_12
    s_waitcnt vmcnt(1)
.ap_12:
    s_add_u32 s63, s69, 180224
    buffer_load_dwordx4 v[136:139], v1, s[40:43], s63 offen nt
    s_memrealtime s[8:9]
    s_waitcnt vmcnt(8)
    s_waitcnt lgkmcnt(0)
    s_sub_u32 s8, s8, s30
    s_cmpk_ge_u32 s8, 666
    s_cbranch_scc1 .ap_13
    s_waitcnt vmcnt(5)
    s_cmpk_ge_u32 s8, 601
    s_cbranch_scc1 .ap_13
    s_waitcnt vmcnt(3)
    s_bitcmp1_b64 s[14:15], 15
    s_cbranch_scc0 1
    s_waitcnt vmcnt(2)
    s_cmpk_ge_u32 s8, 526
    s_cbranch_scc1 .ap_13
    s_waitcnt vmcnt(1)
.ap_13:
    s_add_u32 s63, s69, 188416
    buffer_load_dwordx4 v[140:143], v1, s[40:43], s63 offen nt
    s_memrealtime s[8:9]
    s_waitcnt vmcnt(8)
    s_waitcnt lgkmcnt(0)
    s_sub_u32 s8, s8, s30
    s_cmpk_ge_u32 s8, 712
    s_cbranch_scc1 .ap_14
    s_waitcnt vmcnt(5)
    s_cmpk_ge_u32 s8, 647
    s_cbranch_scc1 .ap_14
    s_waitcnt vmcnt(3)
    s_bitcmp1_b64 s[14:15], 16
    s_cbranch_scc0 1
    s_waitcnt vmcnt(2)
    s_cmpk_ge_u32 s8, 572
    s_cbranch_scc1 .ap_14
    s_waitcnt vmcnt(1)
.ap_14:
    s_add_u32 s63, s69, 262144
    buffer_load_dwordx4 v[48:51], v1, s[40:43], s63 offen nt
    s_cmp_eq_u32 s100, 0
    s_cbranch_scc1 .ls_15
    s_add_u32 m0, s32, 16384
    s_add_u32 s56, s101, 1179648
    buffer_load_dwordx4 v6, s[48:51], s56 offen nt lds
.ls_15:
    s_memrealtime s[8:9]
    s_waitcnt vmcnt(8)
    s_waitcnt lgkmcnt(0)
    s_sub_u32 s8, s8, s30
    s_cmpk_ge_u32 s8, 758
    s_cbranch_scc1 .ap_16
    s_waitcnt vmcnt(5)
    s_cmpk_ge_u32 s8, 693
    s_cbranch_scc1 .ap_16
    s_waitcnt vmcnt(3)
    s_bitcmp1_b64 s[14:15], 17
    s_cbranch_scc0 1
    s_waitcnt vmcnt(2)
    s_cmpk_ge_u32 s8, 618
    s_cbranch_scc1 .ap_16
    s_waitcnt vmcnt(1)
.ap_16:
    s_add_u32 s63, s69, 270336
    buffer_load_dwordx4 v[52:55], v1, s[40:43], s63 offen nt
    s_memrealtime s[8:9]
    s_waitcnt vmcnt(8)
    s_waitcnt lgkmcnt(0)
    s_sub_u32 s8, s8, s30
    s_cmpk_ge_u32 s8, 804
    s_cbranch_scc1 .ap_17
    s_waitcnt vmcnt(5)
    s_cmpk_ge_u32 s8, 739
    s_cbranch_scc1 .ap_17
    s_waitcnt vmcnt(3)
    s_bitcmp1_b64 s[14:15], 18
    s_cbranch_scc0 1
    s_waitcnt vmcnt(2)
    s_cmpk_ge_u32 s8, 664
    s_cbranch_scc1 .ap_17
    s_waitcnt vmcnt(1)
.ap_17:
    s_add_u32 s63, s69, 278528
    buffer_load_dwordx4 v[80:83], v1, s[40:43], s63 offen nt
    v_and_b32 v157, 7, v0
    v_lshlrev_b32 v157, 7, v157
    s_mov_b32 s63, 0x400
    buffer_load_dword v156, v157, s[36:39], s63 offen
    s_memrealtime s[8:9]
    s_waitcnt vmcnt(9)
    s_waitcnt lgkmcnt(0)
    s_sub_u32 s8, s8, s30
    s_cmpk_ge_u32 s8, 850
    s_cbranch_scc1 .ap_18
    s_waitcnt vmcnt(6)
    s_cmpk_ge_u32 s8, 785
    s_cbranch_scc1 .ap_18
    s_waitcnt vmcnt(4)
    s_bitcmp1_b64 s[14:15], 19
    s_cbranch_scc0 1
    s_waitcnt vmcnt(3)
    s_cmpk_ge_u32 s8, 710
    s_cbranch_scc1 .ap_18
    s_waitcnt vmcnt(2)
.ap_18:
    s_add_u32 s63, s69, 286720
    buffer_load_dwordx4 v[84:87], v1, s[40:43], s63 offen nt
    s_cmp_eq_u32 s100, 0
    s_cbranch_scc1 .ls_19
    s_add_u32 m0, s32, 24576
    s_add_u32 s56, s101, 1769472
    buffer_load_dwordx4 v6, s[48:51], s56 offen nt lds
.ls_19:
    s_memrealtime s[8:9]
    s_waitcnt vmcnt(9)
    s_waitcnt lgkmcnt(0)
    s_sub_u32 s8, s8, s30
    s_cmpk_ge_u32 s8, 895
    s_cbranch_scc1 .ap_20
    s_waitcnt vmcnt(6)
    s_cmpk_ge_u32 s8, 830
    s_cbranch_scc1 .ap_20
    s_waitcnt vmcnt(4)
    s_bitcmp1_b64 s[14:15], 20
    s_cbranch_scc0 1
    s_waitcnt vmcnt(3)
    s_cmpk_ge_u32 s8, 755
    s_cbranch_scc1 .ap_20
    s_waitcnt vmcnt(2)
.ap_20:
    s_add_u32 s63, s69, 294912
    buffer_load_dwordx4 v[112:115], v1, s[40:43], s63 offen nt
    s_memrealtime s[8:9]
    s_waitcnt vmcnt(9)
    s_waitcnt lgkmcnt(0)
    s_sub_u32 s8, s8, s30
    s_cmpk_ge_u32 s8, 940
    s_cbranch_scc1 .ap_21
    s_waitcnt vmcnt(6)
    s_cmpk_ge_u32 s8, 875
    s_cbranch_scc1 .ap_21
    s_waitcnt vmcnt(4)
    s_bitcmp1_b64 s[14:15], 21
    s_cbranch_scc0 1
    s_waitcnt vmcnt(3)
    s_cmpk_ge_u32 s8, 800
    s_cbranch_scc1 .ap_21
    s_waitcnt vmcnt(1)
.ap_21:
    s_add_u32 s63, s69, 303104
    buffer_load_dwordx4 v[116:119], v1, s[40:43], s63 offen nt
    s_memrealtime s[8:9]
    s_waitcnt vmcnt(9)
    s_waitcnt lgkmcnt(0)
    s_sub_u32 s8, s8, s30
    s_cmpk_ge_u32 s8, 985
    s_cbranch_scc1 .ap_22
    s_waitcnt vmcnt(6)
    s_cmpk_ge_u32 s8, 920
    s_cbranch_scc1 .ap_22
    s_waitcnt vmcnt(4)
    s_bitcmp1_b64 s[14:15], 22
    s_cbranch_scc0 1
    s_waitcnt vmcnt(2)
    s_cmpk_ge_u32 s8, 845
    s_cbranch_scc1 .ap_22
    s_waitcnt vmcnt(1)
.ap_22:
    s_add_u32 s63, s69, 311296
    buffer_load_dwordx4 v[144:147], v1, s[40:43], s63 offen nt
    s_waitcnt vmcnt(4)
    s_sub_u32 s63, s70, 300
    v_subrev_u32 v156, s63, v156
    v_mov_b32 v157, 600
    v_cmp_lt_u32 s[8:9], v156, v157
    v_add_u32_dpp v156, v156, v156 quad_perm:[1,0,3,2] row_mask:0xf bank_mask:0xf
    s_nop 1
    v_add_u32_dpp v156, v156, v156 quad_perm:[2,3,0,1] row_mask:0xf bank_mask:0xf
    s_nop 1
    v_add_u32_dpp v156, v156, v156 row_ror:4 row_mask:0xf bank_mask:0xf
    s_nop 0
    v_readfirstlane_b32 s63, v156
    s_cmp_eq_u64 s[8:9], -1
    s_nop 3
    s_cbranch_scc0 .et_23
    s_lshr_b32 s63, s63, 3
    s_sub_u32 s63, s63, 300
    s_add_u32 s30, s30, s63
.et_23:
    s_cmp_eq_u32 s100, 0
    s_cbranch_scc1 .ls_24
    s_add_u32 m0, s32, 32768
    s_add_u32 s56, s101, 2359296
    buffer_load_dwordx4 v6, s[48:51], s56 offen nt lds
.ls_24:
    s_memrealtime s[8:9]
    s_waitcnt lgkmcnt(0)
    s_sub_u32 s8, s8, s30
    s_cmpk_ge_u32 s8, 1030
    s_cbranch_scc1 .ap_25
    s_waitcnt vmcnt(4)
    s_cmpk_ge_u32 s8, 965
    s_cbranch_scc1 .ap_25
    s_waitcnt vmcnt(3)
    s_bitcmp1_b64 s[14:15], 23
    s_cbranch_scc0 1
    s_waitcnt vmcnt(2)
    s_cmpk_ge_u32 s8, 890
    s_cbranch_scc1 .ap_25
    s_waitcnt vmcnt(1)
.ap_25:
    s_add_u32 s63, s69, 319488
    buffer_load_dwordx4 v[148:151], v1, s[40:43], s63 offen nt
    s_memrealtime s[8:9]
    s_waitcnt lgkmcnt(0)
    s_sub_u32 s8, s8, s30
    s_cmpk_ge_u32 s8, 1075
    s_cbranch_scc1 .ap_26
    s_waitcnt vmcnt(5)
    s_cmpk_ge_u32 s8, 1010
    s_cbranch_scc1 .ap_26
    s_waitcnt vmcnt(3)
    s_bitcmp1_b64 s[14:15], 24
    s_cbranch_scc0 1
    s_waitcnt vmcnt(2)
    s_cmpk_ge_u32 s8, 935
    s_cbranch_scc1 .ap_26
    s_waitcnt vmcnt(1)
.ap_26:
    s_add_u32 s63, s69, 393216
    buffer_load_dwordx4 v[56:59], v1, s[40:43], s63 offen nt
    s_memrealtime s[8:9]
    s_waitcnt lgkmcnt(0)
    s_sub_u32 s8, s8, s30
    s_cmpk_ge_u32 s8, 1120
    s_cbranch_scc1 .ap_27
    s_waitcnt vmcnt(5)
    s_cmpk_ge_u32 s8, 1055
    s_cbranch_scc1 .ap_27
    s_waitcnt vmcnt(3)
    s_bitcmp1_b64 s[14:15], 25
    s_cbranch_scc0 1
    s_waitcnt vmcnt(2)
    s_cmpk_ge_u32 s8, 980
    s_cbranch_scc1 .ap_27
    s_waitcnt vmcnt(1)
.ap_27:
    s_add_u32 s63, s69, 401408
    buffer_load_dwordx4 v[60:63], v1, s[40:43], s63 offen nt
    s_branch .Latt_bc
.Le_mr:
    s_mul_i32 s58, s3, 1152
    s_mov_b32 s52, s24
    s_and_b32 s53, s25, 0xffff
    s_mov_b32 s54, 0x2400
    s_mov_b32 s55, 0x00020000
    buffer_load_dwordx2 v[246:247], v3, s[52:55], s58 offen
    buffer_load_dwordx2 v[248:249], v3, s[52:55], s58 offen offset:512
    buffer_load_dword v250, v4, s[52:55], s58 offen
    s_mov_b32 s48, s26
    s_and_b32 s49, s27, 0xffff
    s_mov_b32 s50, 0x3cc000
    s_mov_b32 s51, 0x00020000
    v_bfe_u32 v12, v0, 4, 1
    s_and_b32 s56, s3, 3
    s_lshl_b32 s56, s56, 1
    v_or_b32 v12, s56, v12
    v_and_b32 v19, 7, v0
    v_xor_b32 v12, v12, v19
    v_lshrrev_b32 v19, 3, v0
    v_mul_u32_u24 v19, 6912, v19
    v_lshl_add_u32 v19, v12, 4, v19
    s_mul_i32 s57, s3, 55296
    s_lshl_b32 s59, s99, 7
    s_add_u32 s57, s57, s59
    s_lshl_b32 s100, s3, 10
    s_add_u32 m0, s100, 0
    s_add_u32 s56, s57, 0
    buffer_load_dwordx4 v19, s[48:51], s56 offen nt lds
    s_add_u32 m0, s100, 8192
    s_add_u32 s56, s57, 442368
    buffer_load_dwordx4 v19, s[48:51], s56 offen nt lds
    s_add_u32 m0, s100, 16384
    s_add_u32 s56, s57, 884736
    buffer_load_dwordx4 v19, s[48:51], s56 offen nt lds
    s_add_u32 m0, s100, 24576
    s_add_u32 s56, s57, 1327104
    buffer_load_dwordx4 v19, s[48:51], s56 offen nt lds
    s_add_u32 m0, s100, 32768
    s_add_u32 s56, s57, 1769472
    buffer_load_dwordx4 v19, s[48:51], s56 offen nt lds
    s_add_u32 m0, s100, 40960
    s_add_u32 s56, s57, 2211840
    buffer_load_dwordx4 v19, s[48:51], s56 offen nt lds
    s_add_u32 m0, s100, 49152
    s_add_u32 s56, s57, 2654208
    buffer_load_dwordx4 v19, s[48:51], s56 offen nt lds
    s_add_u32 m0, s100, 57344
    s_add_u32 s56, s57, 3096576
    buffer_load_dwordx4 v19, s[48:51], s56 offen nt lds
    s_add_u32 m0, s100, 65536
    s_add_u32 s56, s57, 3538944
    buffer_load_dwordx4 v19, s[48:51], s56 offen nt lds
    v_bfe_u32 v16, v0, 1, 3
    v_mul_u32_u24 v16, 1312, v16
    v_lshrrev_b32 v12, 4, v0
    v_lshl_add_u32 v16, v12, 5, v16
    v_and_b32 v12, 1, v0
    v_lshl_add_u32 v16, v12, 4, v16
    v_add_u32 v16, 147456, v16
    s_mul_i32 s56, s3, 1312
    s_add_u32 s56, s56, 147456
    v_add_u32 v17, s56, v3
    v_add_u32 v18, s56, v4
    v_lshrrev_b32 v12, 4, v0
    v_bfe_u32 v13, v0, 1, 1
    v_lshl_add_u32 v12, v12, 1, v13
    v_bfe_u32 v13, v0, 2, 2
    v_lshl_add_u32 v20, v12, 3, v13
    v_lshlrev_b32 v20, 7, v20
    v_and_b32 v12, 3, v12
    v_lshrrev_b32 v13, 1, v13
    v_lshl_add_u32 v12, v12, 1, v13
    v_xor_b32 v12, s3, v12
    v_lshl_add_u32 v20, v12, 4, v20
    v_and_b32 v12, 1, v0
    v_lshl_add_u32 v20, v12, 3, v20
    v_bfe_u32 v23, v0, 1, 3
    v_mul_u32_u24 v23, 144, v23
    v_bfe_u32 v12, v0, 4, 1
    v_lshl_add_u32 v23, v12, 3, v23
    v_lshrrev_b32 v12, 5, v0
    v_lshl_add_u32 v23, v12, 2, v23
    v_and_b32 v12, 1, v0
    v_lshl_add_u32 v23, v12, 1, v23
    s_lshl_b32 s56, s3, 4
    s_add_u32 s56, s56, 157952
    v_add_u32 v23, s56, v23
    v_and_b32 v24, 15, v0
    v_lshlrev_b32 v24, 3, v24
    s_mul_i32 s56, s3, 144
    s_add_u32 s56, s56, 157952
    v_add_u32 v24, s56, v24
    v_add_u32 v21, 32768, v20
    s_lshl_b32 s100, s3, 10
    v_lshrrev_b32 v12, 4, v0
    v_mul_u32_u24 v12, 18432, v12
    v_and_b32 v13, 15, v0
    v_lshl_add_u32 v22, v13, 4, v12
    s_mul_i32 s57, s99, 57
    s_lshr_b32 s57, s57, 9
    s_mul_i32 s58, s57, 9
    s_sub_u32 s58, s99, s58
    s_mul_i32 s59, s57, 36864
    s_lshl_b32 s58, s58, 8
    s_add_u32 s59, s59, s58
    s_mul_i32 s58, s3, 2304
    s_add_u32 s59, s59, s58
    s_add_u32 s59, s59, 0x3000
    s_mov_b32 s58, 0
    s_cmp_eq_u32 s57, 1
    s_cselect_b32 s58, 1.0, s58
    s_cmp_eq_u32 s57, 4
    s_cselect_b32 s58, 1.0, s58
    s_waitcnt vmcnt(9)
    v_lshlrev_b32 v236, 16, v246
    v_and_b32 v237, 0xffff0000, v246
    v_max_f32 v236, 0xc2ae0000, v236
    v_min_f32 v242, 0x43000000, v236
    v_mul_f32 v238, 0xbfb8aa3b, v242
    v_fma_f32 v240, v242, s98, -v238
    v_fmac_f32 v240, 0xb2a57060, v242
    v_exp_f32 v238, v238
    v_mul_f32 v240, 0x3f317218, v240
    v_fmac_f32 v238, v238, v240
    v_add_f32 v238, 1.0, v238
    v_rcp_f32 v240, v238
    s_nop 0
    v_mul_f32 v242, v236, v240
    v_fma_f32 v238, -v242, v238, v236
    v_fma_f32 v236, v238, v240, v242
    v_max_f32 v237, 0xc2ae0000, v237
    v_min_f32 v243, 0x43000000, v237
    v_mul_f32 v239, 0xbfb8aa3b, v243
    v_fma_f32 v241, v243, s98, -v239
    v_fmac_f32 v241, 0xb2a57060, v243
    v_exp_f32 v239, v239
    v_mul_f32 v241, 0x3f317218, v241
    v_fmac_f32 v239, v239, v241
    v_add_f32 v239, 1.0, v239
    v_rcp_f32 v241, v239
    s_nop 0
    v_mul_f32 v243, v237, v241
    v_fma_f32 v239, -v243, v239, v237
    v_fma_f32 v237, v239, v241, v243
    v_cvt_pk_bf16_f32 v246, v236, v237
    v_lshlrev_b32 v236, 16, v247
    v_and_b32 v237, 0xffff0000, v247
    v_max_f32 v236, 0xc2ae0000, v236
    v_min_f32 v242, 0x43000000, v236
    v_mul_f32 v238, 0xbfb8aa3b, v242
    v_fma_f32 v240, v242, s98, -v238
    v_fmac_f32 v240, 0xb2a57060, v242
    v_exp_f32 v238, v238
    v_mul_f32 v240, 0x3f317218, v240
    v_fmac_f32 v238, v238, v240
    v_add_f32 v238, 1.0, v238
    v_rcp_f32 v240, v238
    s_nop 0
    v_mul_f32 v242, v236, v240
    v_fma_f32 v238, -v242, v238, v236
    v_fma_f32 v236, v238, v240, v242
    v_max_f32 v237, 0xc2ae0000, v237
    v_min_f32 v243, 0x43000000, v237
    v_mul_f32 v239, 0xbfb8aa3b, v243
    v_fma_f32 v241, v243, s98, -v239
    v_fmac_f32 v241, 0xb2a57060, v243
    v_exp_f32 v239, v239
    v_mul_f32 v241, 0x3f317218, v241
    v_fmac_f32 v239, v239, v241
    v_add_f32 v239, 1.0, v239
    v_rcp_f32 v241, v239
    s_nop 0
    v_mul_f32 v243, v237, v241
    v_fma_f32 v239, -v243, v239, v237
    v_fma_f32 v237, v239, v241, v243
    v_cvt_pk_bf16_f32 v247, v236, v237
    v_lshlrev_b32 v236, 16, v248
    v_and_b32 v237, 0xffff0000, v248
    v_max_f32 v236, 0xc2ae0000, v236
    v_min_f32 v242, 0x43000000, v236
    v_mul_f32 v238, 0xbfb8aa3b, v242
    v_fma_f32 v240, v242, s98, -v238
    v_fmac_f32 v240, 0xb2a57060, v242
    v_exp_f32 v238, v238
    v_mul_f32 v240, 0x3f317218, v240
    v_fmac_f32 v238, v238, v240
    v_add_f32 v238, 1.0, v238
    v_rcp_f32 v240, v238
    s_nop 0
    v_mul_f32 v242, v236, v240
    v_fma_f32 v238, -v242, v238, v236
    v_fma_f32 v236, v238, v240, v242
    v_max_f32 v237, 0xc2ae0000, v237
    v_min_f32 v243, 0x43000000, v237
    v_mul_f32 v239, 0xbfb8aa3b, v243
    v_fma_f32 v241, v243, s98, -v239
    v_fmac_f32 v241, 0xb2a57060, v243
    v_exp_f32 v239, v239
    v_mul_f32 v241, 0x3f317218, v241
    v_fmac_f32 v239, v239, v241
    v_add_f32 v239, 1.0, v239
    v_rcp_f32 v241, v239
    s_nop 0
    v_mul_f32 v243, v237, v241
    v_fma_f32 v239, -v243, v239, v237
    v_fma_f32 v237, v239, v241, v243
    v_cvt_pk_bf16_f32 v248, v236, v237
    v_lshlrev_b32 v236, 16, v249
    v_and_b32 v237, 0xffff0000, v249
    v_max_f32 v236, 0xc2ae0000, v236
    v_min_f32 v242, 0x43000000, v236
    v_mul_f32 v238, 0xbfb8aa3b, v242
    v_fma_f32 v240, v242, s98, -v238
    v_fmac_f32 v240, 0xb2a57060, v242
    v_exp_f32 v238, v238
    v_mul_f32 v240, 0x3f317218, v240
    v_fmac_f32 v238, v238, v240
    v_add_f32 v238, 1.0, v238
    v_rcp_f32 v240, v238
    s_nop 0
    v_mul_f32 v242, v236, v240
    v_fma_f32 v238, -v242, v238, v236
    v_fma_f32 v236, v238, v240, v242
    v_max_f32 v237, 0xc2ae0000, v237
    v_min_f32 v243, 0x43000000, v237
    v_mul_f32 v239, 0xbfb8aa3b, v243
    v_fma_f32 v241, v243, s98, -v239
    v_fmac_f32 v241, 0xb2a57060, v243
    v_exp_f32 v239, v239
    v_mul_f32 v241, 0x3f317218, v241
    v_fmac_f32 v239, v239, v241
    v_add_f32 v239, 1.0, v239
    v_rcp_f32 v241, v239
    s_nop 0
    v_mul_f32 v243, v237, v241
    v_fma_f32 v239, -v243, v239, v237
    v_fma_f32 v237, v239, v241, v243
    v_cvt_pk_bf16_f32 v249, v236, v237
    v_lshlrev_b32 v236, 16, v250
    v_and_b32 v237, 0xffff0000, v250
    v_max_f32 v236, 0xc2ae0000, v236
    v_min_f32 v242, 0x43000000, v236
    v_mul_f32 v238, 0xbfb8aa3b, v242
    v_fma_f32 v240, v242, s98, -v238
    v_fmac_f32 v240, 0xb2a57060, v242
    v_exp_f32 v238, v238
    v_mul_f32 v240, 0x3f317218, v240
    v_fmac_f32 v238, v238, v240
    v_add_f32 v238, 1.0, v238
    v_rcp_f32 v240, v238
    s_nop 0
    v_mul_f32 v242, v236, v240
    v_fma_f32 v238, -v242, v238, v236
    v_fma_f32 v236, v238, v240, v242
    v_max_f32 v237, 0xc2ae0000, v237
    v_min_f32 v243, 0x43000000, v237
    v_mul_f32 v239, 0xbfb8aa3b, v243
    v_fma_f32 v241, v243, s98, -v239
    v_fmac_f32 v241, 0xb2a57060, v243
    v_exp_f32 v239, v239
    v_mul_f32 v241, 0x3f317218, v241
    v_fmac_f32 v239, v239, v241
    v_add_f32 v239, 1.0, v239
    v_rcp_f32 v241, v239
    s_nop 0
    v_mul_f32 v243, v237, v241
    v_fma_f32 v239, -v243, v239, v237
    v_fma_f32 v237, v239, v241, v243
    v_cvt_pk_bf16_f32 v250, v236, v237
    ds_write_b64 v17, v[246:247]
    ds_write_b64 v17, v[248:249] offset:512
    ds_write_b32 v18, v250
    s_waitcnt vmcnt(3)
    s_add_u32 s63, s69, 147456
    buffer_load_dwordx4 v[72:75], v1, s[40:43], s63 offen nt
    s_waitcnt vmcnt(3)
    s_add_u32 s63, s69, 155648
    buffer_load_dwordx4 v[76:79], v1, s[40:43], s63 offen nt
    s_waitcnt vmcnt(3)
    s_add_u32 s63, s69, 163840
    buffer_load_dwordx4 v[104:107], v1, s[40:43], s63 offen nt
    s_waitcnt vmcnt(3)
    s_add_u32 s63, s69, 172032
    buffer_load_dwordx4 v[108:111], v1, s[40:43], s63 offen nt
    s_waitcnt vmcnt(3)
    s_add_u32 s63, s69, 180224
    buffer_load_dwordx4 v[136:139], v1, s[40:43], s63 offen nt
    s_waitcnt vmcnt(3)
    s_add_u32 s63, s69, 188416
    buffer_load_dwordx4 v[140:143], v1, s[40:43], s63 offen nt
    s_waitcnt vmcnt(3)
    s_add_u32 s63, s69, 262144
    buffer_load_dwordx4 v[48:51], v1, s[40:43], s63 offen nt
    s_waitcnt vmcnt(3)
    s_add_u32 s63, s69, 270336
    buffer_load_dwordx4 v[52:55], v1, s[40:43], s63 offen nt
    s_waitcnt lgkmcnt(0)
    s_barrier
    ds_read_b64_tr_b16 v[160:161], v20 offset:0
    ds_read_b64_tr_b16 v[162:163], v20 offset:512
    ds_read_b64_tr_b16 v[164:165], v20 offset:8192
    ds_read_b64_tr_b16 v[166:167], v20 offset:8704
    ds_read_b64_tr_b16 v[168:169], v20 offset:16384
    ds_read_b64_tr_b16 v[170:171], v20 offset:16896
    ds_read_b64_tr_b16 v[172:173], v20 offset:24576
    ds_read_b64_tr_b16 v[174:175], v20 offset:25088
    ds_read_b64_tr_b16 v[176:177], v21 offset:0
    ds_read_b64_tr_b16 v[178:179], v21 offset:512
    ds_read_b64_tr_b16 v[180:181], v21 offset:8192
    ds_read_b64_tr_b16 v[182:183], v21 offset:8704
    ds_read_b64_tr_b16 v[184:185], v21 offset:16384
    ds_read_b64_tr_b16 v[186:187], v21 offset:16896
    ds_read_b64_tr_b16 v[188:189], v21 offset:24576
    ds_read_b64_tr_b16 v[190:191], v21 offset:25088
    ds_read_b64_tr_b16 v[192:193], v21 offset:32768
    ds_read_b64_tr_b16 v[194:195], v21 offset:33280
    ds_read_b128 v[196:199], v16 offset:0
    ds_read_b128 v[200:203], v16 offset:128
    ds_read_b128 v[204:207], v16 offset:256
    ds_read_b128 v[208:211], v16 offset:384
    ds_read_b128 v[212:215], v16 offset:512
    ds_read_b128 v[216:219], v16 offset:640
    ds_read_b128 v[220:223], v16 offset:768
    ds_read_b128 v[224:227], v16 offset:896
    ds_read_b128 v[228:231], v16 offset:1024
    s_waitcnt lgkmcnt(8)
    v_mfma_f32_16x16x32_bf16 v[232:235], v[160:163], v[196:199], 0
    s_waitcnt lgkmcnt(7)
    v_mfma_f32_16x16x32_bf16 v[232:235], v[164:167], v[200:203], v[232:235]
    s_waitcnt lgkmcnt(6)
    v_mfma_f32_16x16x32_bf16 v[232:235], v[168:171], v[204:207], v[232:235]
    s_waitcnt lgkmcnt(5)
    v_mfma_f32_16x16x32_bf16 v[232:235], v[172:175], v[208:211], v[232:235]
    s_waitcnt lgkmcnt(4)
    v_mfma_f32_16x16x32_bf16 v[232:235], v[176:179], v[212:215], v[232:235]
    s_waitcnt lgkmcnt(3)
    v_mfma_f32_16x16x32_bf16 v[232:235], v[180:183], v[216:219], v[232:235]
    s_waitcnt lgkmcnt(2)
    v_mfma_f32_16x16x32_bf16 v[232:235], v[184:187], v[220:223], v[232:235]
    s_waitcnt lgkmcnt(1)
    v_mfma_f32_16x16x32_bf16 v[232:235], v[188:191], v[224:227], v[232:235]
    s_waitcnt lgkmcnt(0)
    v_mfma_f32_16x16x32_bf16 v[232:235], v[192:195], v[228:231], v[232:235]
    s_nop 7
    v_permlane32_swap_b32 v232, v234
    v_permlane32_swap_b32 v233, v235
    v_cndmask_b32 v233, v233, v234, s[96:97]
    v_cndmask_b32 v232, v232, v235, s[96:97]
    s_nop 1
    v_add_f32_dpp v236, v233, v232 quad_perm:[1,0,3,2] row_mask:0xf bank_mask:0xf
    v_cvt_pk_bf16_f32 v236, 0, v236
    v_add_f32 v236, s58, v236
    v_cvt_pk_bf16_f32 v236, v236, v236
    ds_write_b16 v23, v236
    v_mov_b32 v243, s34
    s_waitcnt lgkmcnt(0)
    s_barrier
    ds_read2_b32 v[244:245], v24 offset1:1
    v_mov_b32 v241, s34
    s_waitcnt lgkmcnt(0)
    v_mov_b32 v240, v244
    v_mov_b32 v242, v245
    s_mov_b64 exec, 0xffff
    buffer_store_dwordx4 v[240:243], v22, s[36:39], s59 offen sc1
    s_mov_b64 exec, -1
    s_nop 0
    s_branch .Le_m2
.Le_mc:
    v_bfe_u32 v16, v0, 1, 3
    v_mul_u32_u24 v16, 1312, v16
    v_lshrrev_b32 v12, 4, v0
    v_lshl_add_u32 v16, v12, 5, v16
    v_and_b32 v12, 1, v0
    v_lshl_add_u32 v16, v12, 4, v16
    v_add_u32 v16, 147456, v16
    s_mul_i32 s56, s3, 1312
    s_add_u32 s56, s56, 147456
    v_add_u32 v17, s56, v3
    v_add_u32 v18, s56, v4
    v_lshrrev_b32 v12, 4, v0
    v_bfe_u32 v13, v0, 1, 1
    v_lshl_add_u32 v12, v12, 1, v13
    v_bfe_u32 v13, v0, 2, 2
    v_lshl_add_u32 v20, v12, 3, v13
    v_lshlrev_b32 v20, 7, v20
    v_and_b32 v12, 3, v12
    v_lshrrev_b32 v13, 1, v13
    v_lshl_add_u32 v12, v12, 1, v13
    v_xor_b32 v12, s3, v12
    v_lshl_add_u32 v20, v12, 4, v20
    v_and_b32 v12, 1, v0
    v_lshl_add_u32 v20, v12, 3, v20
    v_bfe_u32 v23, v0, 1, 3
    v_mul_u32_u24 v23, 144, v23
    v_bfe_u32 v12, v0, 4, 1
    v_lshl_add_u32 v23, v12, 3, v23
    v_lshrrev_b32 v12, 5, v0
    v_lshl_add_u32 v23, v12, 2, v23
    v_and_b32 v12, 1, v0
    v_lshl_add_u32 v23, v12, 1, v23
    s_lshl_b32 s56, s3, 4
    s_add_u32 s56, s56, 157952
    v_add_u32 v23, s56, v23
    v_and_b32 v24, 15, v0
    v_lshlrev_b32 v24, 3, v24
    s_mul_i32 s56, s3, 144
    s_add_u32 s56, s56, 157952
    v_add_u32 v24, s56, v24
    v_add_u32 v21, 32768, v20
    s_lshl_b32 s100, s3, 10
    s_waitcnt lgkmcnt(0)
    s_add_u32 s34, s34, 1
    v_lshrrev_b32 v12, 4, v0
    v_mul_u32_u24 v12, 18432, v12
    v_and_b32 v13, 15, v0
    v_lshl_add_u32 v22, v13, 4, v12
    s_mul_i32 s57, s99, 57
    s_lshr_b32 s57, s57, 9
    s_mul_i32 s58, s57, 9
    s_sub_u32 s58, s99, s58
    s_mul_i32 s59, s57, 36864
    s_lshl_b32 s58, s58, 8
    s_add_u32 s59, s59, s58
    s_mul_i32 s58, s3, 2304
    s_add_u32 s59, s59, s58
    s_add_u32 s59, s59, 0x3000
    s_mov_b32 s58, 0
    s_cmp_eq_u32 s57, 1
    s_cselect_b32 s58, 1.0, s58
    s_cmp_eq_u32 s57, 4
    s_cselect_b32 s58, 1.0, s58
    s_waitcnt vmcnt(13)
    v_lshlrev_b32 v236, 16, v246
    v_and_b32 v237, 0xffff0000, v246
    v_max_f32 v236, 0xc2ae0000, v236
    v_min_f32 v242, 0x43000000, v236
    v_mul_f32 v238, 0xbfb8aa3b, v242
    v_fma_f32 v240, v242, s98, -v238
    v_fmac_f32 v240, 0xb2a57060, v242
    v_exp_f32 v238, v238
    v_mul_f32 v240, 0x3f317218, v240
    v_fmac_f32 v238, v238, v240
    v_add_f32 v238, 1.0, v238
    v_rcp_f32 v240, v238
    s_nop 0
    v_mul_f32 v242, v236, v240
    v_fma_f32 v238, -v242, v238, v236
    v_fma_f32 v236, v238, v240, v242
    v_max_f32 v237, 0xc2ae0000, v237
    v_min_f32 v243, 0x43000000, v237
    v_mul_f32 v239, 0xbfb8aa3b, v243
    v_fma_f32 v241, v243, s98, -v239
    v_fmac_f32 v241, 0xb2a57060, v243
    v_exp_f32 v239, v239
    v_mul_f32 v241, 0x3f317218, v241
    v_fmac_f32 v239, v239, v241
    v_add_f32 v239, 1.0, v239
    v_rcp_f32 v241, v239
    s_nop 0
    v_mul_f32 v243, v237, v241
    v_fma_f32 v239, -v243, v239, v237
    v_fma_f32 v237, v239, v241, v243
    v_cvt_pk_bf16_f32 v246, v236, v237
    v_lshlrev_b32 v236, 16, v247
    v_and_b32 v237, 0xffff0000, v247
    v_max_f32 v236, 0xc2ae0000, v236
    v_min_f32 v242, 0x43000000, v236
    v_mul_f32 v238, 0xbfb8aa3b, v242
    v_fma_f32 v240, v242, s98, -v238
    v_fmac_f32 v240, 0xb2a57060, v242
    v_exp_f32 v238, v238
    v_mul_f32 v240, 0x3f317218, v240
    v_fmac_f32 v238, v238, v240
    v_add_f32 v238, 1.0, v238
    v_rcp_f32 v240, v238
    s_nop 0
    v_mul_f32 v242, v236, v240
    v_fma_f32 v238, -v242, v238, v236
    v_fma_f32 v236, v238, v240, v242
    v_max_f32 v237, 0xc2ae0000, v237
    v_min_f32 v243, 0x43000000, v237
    v_mul_f32 v239, 0xbfb8aa3b, v243
    v_fma_f32 v241, v243, s98, -v239
    v_fmac_f32 v241, 0xb2a57060, v243
    v_exp_f32 v239, v239
    v_mul_f32 v241, 0x3f317218, v241
    v_fmac_f32 v239, v239, v241
    v_add_f32 v239, 1.0, v239
    v_rcp_f32 v241, v239
    s_nop 0
    v_mul_f32 v243, v237, v241
    v_fma_f32 v239, -v243, v239, v237
    v_fma_f32 v237, v239, v241, v243
    v_cvt_pk_bf16_f32 v247, v236, v237
    v_lshlrev_b32 v236, 16, v248
    v_and_b32 v237, 0xffff0000, v248
    v_max_f32 v236, 0xc2ae0000, v236
    v_min_f32 v242, 0x43000000, v236
    v_mul_f32 v238, 0xbfb8aa3b, v242
    v_fma_f32 v240, v242, s98, -v238
    v_fmac_f32 v240, 0xb2a57060, v242
    v_exp_f32 v238, v238
    v_mul_f32 v240, 0x3f317218, v240
    v_fmac_f32 v238, v238, v240
    v_add_f32 v238, 1.0, v238
    v_rcp_f32 v240, v238
    s_nop 0
    v_mul_f32 v242, v236, v240
    v_fma_f32 v238, -v242, v238, v236
    v_fma_f32 v236, v238, v240, v242
    v_max_f32 v237, 0xc2ae0000, v237
    v_min_f32 v243, 0x43000000, v237
    v_mul_f32 v239, 0xbfb8aa3b, v243
    v_fma_f32 v241, v243, s98, -v239
    v_fmac_f32 v241, 0xb2a57060, v243
    v_exp_f32 v239, v239
    v_mul_f32 v241, 0x3f317218, v241
    v_fmac_f32 v239, v239, v241
    v_add_f32 v239, 1.0, v239
    v_rcp_f32 v241, v239
    s_nop 0
    v_mul_f32 v243, v237, v241
    v_fma_f32 v239, -v243, v239, v237
    v_fma_f32 v237, v239, v241, v243
    v_cvt_pk_bf16_f32 v248, v236, v237
    v_lshlrev_b32 v236, 16, v249
    v_and_b32 v237, 0xffff0000, v249
    v_max_f32 v236, 0xc2ae0000, v236
    v_min_f32 v242, 0x43000000, v236
    v_mul_f32 v238, 0xbfb8aa3b, v242
    v_fma_f32 v240, v242, s98, -v238
    v_fmac_f32 v240, 0xb2a57060, v242
    v_exp_f32 v238, v238
    v_mul_f32 v240, 0x3f317218, v240
    v_fmac_f32 v238, v238, v240
    v_add_f32 v238, 1.0, v238
    v_rcp_f32 v240, v238
    s_nop 0
    v_mul_f32 v242, v236, v240
    v_fma_f32 v238, -v242, v238, v236
    v_fma_f32 v236, v238, v240, v242
    v_max_f32 v237, 0xc2ae0000, v237
    v_min_f32 v243, 0x43000000, v237
    v_mul_f32 v239, 0xbfb8aa3b, v243
    v_fma_f32 v241, v243, s98, -v239
    v_fmac_f32 v241, 0xb2a57060, v243
    v_exp_f32 v239, v239
    v_mul_f32 v241, 0x3f317218, v241
    v_fmac_f32 v239, v239, v241
    v_add_f32 v239, 1.0, v239
    v_rcp_f32 v241, v239
    s_nop 0
    v_mul_f32 v243, v237, v241
    v_fma_f32 v239, -v243, v239, v237
    v_fma_f32 v237, v239, v241, v243
    v_cvt_pk_bf16_f32 v249, v236, v237
    v_lshlrev_b32 v236, 16, v250
    v_and_b32 v237, 0xffff0000, v250
    v_max_f32 v236, 0xc2ae0000, v236
    v_min_f32 v242, 0x43000000, v236
    v_mul_f32 v238, 0xbfb8aa3b, v242
    v_fma_f32 v240, v242, s98, -v238
    v_fmac_f32 v240, 0xb2a57060, v242
    v_exp_f32 v238, v238
    v_mul_f32 v240, 0x3f317218, v240
    v_fmac_f32 v238, v238, v240
    v_add_f32 v238, 1.0, v238
    v_rcp_f32 v240, v238
    s_nop 0
    v_mul_f32 v242, v236, v240
    v_fma_f32 v238, -v242, v238, v236
    v_fma_f32 v236, v238, v240, v242
    v_max_f32 v237, 0xc2ae0000, v237
    v_min_f32 v243, 0x43000000, v237
    v_mul_f32 v239, 0xbfb8aa3b, v243
    v_fma_f32 v241, v243, s98, -v239
    v_fmac_f32 v241, 0xb2a57060, v243
    v_exp_f32 v239, v239
    v_mul_f32 v241, 0x3f317218, v241
    v_fmac_f32 v239, v239, v241
    v_add_f32 v239, 1.0, v239
    v_rcp_f32 v241, v239
    s_nop 0
    v_mul_f32 v243, v237, v241
    v_fma_f32 v239, -v243, v239, v237
    v_fma_f32 v237, v239, v241, v243
    v_cvt_pk_bf16_f32 v250, v236, v237
    ds_write_b64 v17, v[246:247]
    ds_write_b64 v17, v[248:249] offset:512
    ds_write_b32 v18, v250
    s_waitcnt vmcnt(4)
    s_waitcnt lgkmcnt(0)
    s_barrier
    ds_read_b64_tr_b16 v[160:161], v20 offset:0
    ds_read_b64_tr_b16 v[162:163], v20 offset:512
    ds_read_b64_tr_b16 v[164:165], v20 offset:8192
    ds_read_b64_tr_b16 v[166:167], v20 offset:8704
    ds_read_b64_tr_b16 v[168:169], v20 offset:16384
    ds_read_b64_tr_b16 v[170:171], v20 offset:16896
    ds_read_b64_tr_b16 v[172:173], v20 offset:24576
    ds_read_b64_tr_b16 v[174:175], v20 offset:25088
    ds_read_b64_tr_b16 v[176:177], v21 offset:0
    ds_read_b64_tr_b16 v[178:179], v21 offset:512
    ds_read_b64_tr_b16 v[180:181], v21 offset:8192
    ds_read_b64_tr_b16 v[182:183], v21 offset:8704
    ds_read_b64_tr_b16 v[184:185], v21 offset:16384
    ds_read_b64_tr_b16 v[186:187], v21 offset:16896
    ds_read_b64_tr_b16 v[188:189], v21 offset:24576
    ds_read_b64_tr_b16 v[190:191], v21 offset:25088
    ds_read_b64_tr_b16 v[192:193], v21 offset:32768
    ds_read_b64_tr_b16 v[194:195], v21 offset:33280
    ds_read_b128 v[196:199], v16 offset:0
    ds_read_b128 v[200:203], v16 offset:128
    ds_read_b128 v[204:207], v16 offset:256
    ds_read_b128 v[208:211], v16 offset:384
    ds_read_b128 v[212:215], v16 offset:512
    ds_read_b128 v[216:219], v16 offset:640
    ds_read_b128 v[220:223], v16 offset:768
    ds_read_b128 v[224:227], v16 offset:896
    ds_read_b128 v[228:231], v16 offset:1024
    s_waitcnt lgkmcnt(8)
    v_mfma_f32_16x16x32_bf16 v[232:235], v[160:163], v[196:199], 0
    s_waitcnt lgkmcnt(7)
    v_mfma_f32_16x16x32_bf16 v[232:235], v[164:167], v[200:203], v[232:235]
    s_waitcnt lgkmcnt(6)
    v_mfma_f32_16x16x32_bf16 v[232:235], v[168:171], v[204:207], v[232:235]
    s_waitcnt lgkmcnt(5)
    v_mfma_f32_16x16x32_bf16 v[232:235], v[172:175], v[208:211], v[232:235]
    s_waitcnt lgkmcnt(4)
    v_mfma_f32_16x16x32_bf16 v[232:235], v[176:179], v[212:215], v[232:235]
    s_waitcnt lgkmcnt(3)
    v_mfma_f32_16x16x32_bf16 v[232:235], v[180:183], v[216:219], v[232:235]
    s_waitcnt lgkmcnt(2)
    v_mfma_f32_16x16x32_bf16 v[232:235], v[184:187], v[220:223], v[232:235]
    s_waitcnt lgkmcnt(1)
    v_mfma_f32_16x16x32_bf16 v[232:235], v[188:191], v[224:227], v[232:235]
    s_waitcnt lgkmcnt(0)
    v_mfma_f32_16x16x32_bf16 v[232:235], v[192:195], v[228:231], v[232:235]
    s_nop 7
    v_permlane32_swap_b32 v232, v234
    v_permlane32_swap_b32 v233, v235
    v_cndmask_b32 v233, v233, v234, s[96:97]
    v_cndmask_b32 v232, v232, v235, s[96:97]
    s_nop 1
    v_add_f32_dpp v236, v233, v232 quad_perm:[1,0,3,2] row_mask:0xf bank_mask:0xf
    v_cvt_pk_bf16_f32 v236, 0, v236
    v_add_f32 v236, s58, v236
    v_cvt_pk_bf16_f32 v236, v236, v236
    ds_write_b16 v23, v236
    v_mov_b32 v243, s34
    s_waitcnt lgkmcnt(0)
    s_barrier
    ds_read2_b32 v[244:245], v24 offset1:1
    v_mov_b32 v241, s34
    s_waitcnt lgkmcnt(0)
    v_mov_b32 v240, v244
    v_mov_b32 v242, v245
    s_mov_b64 exec, 0xffffffff
    buffer_store_dwordx4 v[240:243], v22, s[36:39], s59 offen sc1
    s_mov_b64 exec, -1
    s_mov_b32 s14, 0x6b5ad6b5
    s_mov_b32 s15, 0x5ad6b5ad
    s_add_u32 s30, s70, -30
    s_waitcnt vmcnt(3)
    s_add_u32 s63, s69, 32768
    buffer_load_dwordx4 v[96:99], v1, s[40:43], s63 offen nt
    s_waitcnt vmcnt(3)
    s_add_u32 s63, s69, 40960
    buffer_load_dwordx4 v[100:103], v1, s[40:43], s63 offen nt
    s_waitcnt vmcnt(3)
    s_add_u32 s63, s69, 49152
    buffer_load_dwordx4 v[128:131], v1, s[40:43], s63 offen nt
    s_waitcnt vmcnt(3)
    s_add_u32 s63, s69, 57344
    buffer_load_dwordx4 v[132:135], v1, s[40:43], s63 offen nt
    s_waitcnt vmcnt(3)
    s_add_u32 s63, s69, 131072
    buffer_load_dwordx4 v[40:43], v1, s[40:43], s63 offen nt
    s_waitcnt vmcnt(3)
    s_add_u32 s63, s69, 139264
    buffer_load_dwordx4 v[44:47], v1, s[40:43], s63 offen nt
    s_waitcnt vmcnt(3)
    s_add_u32 s63, s69, 147456
    buffer_load_dwordx4 v[72:75], v1, s[40:43], s63 offen nt
    s_waitcnt vmcnt(3)
    s_add_u32 s63, s69, 155648
    buffer_load_dwordx4 v[76:79], v1, s[40:43], s63 offen nt
    s_waitcnt vmcnt(3)
    s_add_u32 s63, s69, 163840
    buffer_load_dwordx4 v[104:107], v1, s[40:43], s63 offen nt
    s_waitcnt vmcnt(3)
    s_add_u32 s63, s69, 172032
    buffer_load_dwordx4 v[108:111], v1, s[40:43], s63 offen nt
    s_waitcnt vmcnt(3)
    s_add_u32 s63, s69, 180224
    buffer_load_dwordx4 v[136:139], v1, s[40:43], s63 offen nt
    s_waitcnt vmcnt(3)
    s_add_u32 s63, s69, 188416
    buffer_load_dwordx4 v[140:143], v1, s[40:43], s63 offen nt
    s_waitcnt vmcnt(3)
    s_add_u32 s63, s69, 262144
    buffer_load_dwordx4 v[48:51], v1, s[40:43], s63 offen nt
    s_waitcnt vmcnt(3)
    s_add_u32 s63, s69, 270336
    buffer_load_dwordx4 v[52:55], v1, s[40:43], s63 offen nt
.Le_m2:
    s_waitcnt vmcnt(3)
    s_bitcmp1_b64 s[14:15], 18
    s_cbranch_scc0 1
    s_waitcnt vmcnt(2)
    s_add_u32 s63, s69, 278528
    buffer_load_dwordx4 v[80:83], v1, s[40:43], s63 offen nt
    v_and_b32 v157, 7, v0
    v_lshlrev_b32 v157, 7, v157
    s_mov_b32 s63, 0x400
    buffer_load_dword v156, v157, s[36:39], s63 offen
    s_memrealtime s[8:9]
    s_waitcnt lgkmcnt(0)
    s_sub_u32 s8, s8, s30
    s_cmpk_ge_u32 s8, 850
    s_cbranch_scc1 .ap_28
    s_waitcnt vmcnt(5)
    s_cmpk_ge_u32 s8, 785
    s_cbranch_scc1 .ap_28
    s_waitcnt vmcnt(4)
    s_bitcmp1_b64 s[14:15], 19
    s_cbranch_scc0 1
    s_waitcnt vmcnt(3)
    s_cmpk_ge_u32 s8, 710
    s_cbranch_scc1 .ap_28
    s_waitcnt vmcnt(2)
.ap_28:
    s_add_u32 s63, s69, 286720
    buffer_load_dwordx4 v[84:87], v1, s[40:43], s63 offen nt
    s_memrealtime s[8:9]
    s_waitcnt lgkmcnt(0)
    s_sub_u32 s8, s8, s30
    s_cmpk_ge_u32 s8, 895
    s_cbranch_scc1 .ap_29
    s_waitcnt vmcnt(6)
    s_cmpk_ge_u32 s8, 830
    s_cbranch_scc1 .ap_29
    s_waitcnt vmcnt(4)
    s_bitcmp1_b64 s[14:15], 20
    s_cbranch_scc0 1
    s_waitcnt vmcnt(3)
    s_cmpk_ge_u32 s8, 755
    s_cbranch_scc1 .ap_29
    s_waitcnt vmcnt(2)
.ap_29:
    s_add_u32 s63, s69, 294912
    buffer_load_dwordx4 v[112:115], v1, s[40:43], s63 offen nt
    s_memrealtime s[8:9]
    s_waitcnt lgkmcnt(0)
    s_sub_u32 s8, s8, s30
    s_cmpk_ge_u32 s8, 940
    s_cbranch_scc1 .ap_30
    s_waitcnt vmcnt(6)
    s_cmpk_ge_u32 s8, 875
    s_cbranch_scc1 .ap_30
    s_waitcnt vmcnt(4)
    s_bitcmp1_b64 s[14:15], 21
    s_cbranch_scc0 1
    s_waitcnt vmcnt(3)
    s_cmpk_ge_u32 s8, 800
    s_cbranch_scc1 .ap_30
    s_waitcnt vmcnt(1)
.ap_30:
    s_add_u32 s63, s69, 303104
    buffer_load_dwordx4 v[116:119], v1, s[40:43], s63 offen nt
    s_memrealtime s[8:9]
    s_waitcnt lgkmcnt(0)
    s_sub_u32 s8, s8, s30
    s_cmpk_ge_u32 s8, 985
    s_cbranch_scc1 .ap_31
    s_waitcnt vmcnt(6)
    s_cmpk_ge_u32 s8, 920
    s_cbranch_scc1 .ap_31
    s_waitcnt vmcnt(4)
    s_bitcmp1_b64 s[14:15], 22
    s_cbranch_scc0 1
    s_waitcnt vmcnt(2)
    s_cmpk_ge_u32 s8, 845
    s_cbranch_scc1 .ap_31
    s_waitcnt vmcnt(1)
.ap_31:
    s_add_u32 s63, s69, 311296
    buffer_load_dwordx4 v[144:147], v1, s[40:43], s63 offen nt
    s_waitcnt vmcnt(4)
    s_sub_u32 s63, s70, 300
    v_subrev_u32 v156, s63, v156
    v_mov_b32 v157, 600
    v_cmp_lt_u32 s[8:9], v156, v157
    v_add_u32_dpp v156, v156, v156 quad_perm:[1,0,3,2] row_mask:0xf bank_mask:0xf
    s_nop 1
    v_add_u32_dpp v156, v156, v156 quad_perm:[2,3,0,1] row_mask:0xf bank_mask:0xf
    s_nop 1
    v_add_u32_dpp v156, v156, v156 row_ror:4 row_mask:0xf bank_mask:0xf
    s_nop 0
    v_readfirstlane_b32 s63, v156
    s_cmp_eq_u64 s[8:9], -1
    s_nop 3
    s_cbranch_scc0 .et_32
    s_lshr_b32 s63, s63, 3
    s_sub_u32 s63, s63, 300
    s_add_u32 s30, s30, s63
.et_32:
    s_memrealtime s[8:9]
    s_waitcnt lgkmcnt(0)
    s_sub_u32 s8, s8, s30
    s_cmpk_ge_u32 s8, 1030
    s_cbranch_scc1 .ap_33
    s_waitcnt vmcnt(4)
    s_cmpk_ge_u32 s8, 965
    s_cbranch_scc1 .ap_33
    s_waitcnt vmcnt(3)
    s_bitcmp1_b64 s[14:15], 23
    s_cbranch_scc0 1
    s_waitcnt vmcnt(2)
    s_cmpk_ge_u32 s8, 890
    s_cbranch_scc1 .ap_33
    s_waitcnt vmcnt(1)
.ap_33:
    s_add_u32 s63, s69, 319488
    buffer_load_dwordx4 v[148:151], v1, s[40:43], s63 offen nt
    s_memrealtime s[8:9]
    s_waitcnt lgkmcnt(0)
    s_sub_u32 s8, s8, s30
    s_cmpk_ge_u32 s8, 1075
    s_cbranch_scc1 .ap_34
    s_waitcnt vmcnt(5)
    s_cmpk_ge_u32 s8, 1010
    s_cbranch_scc1 .ap_34
    s_waitcnt vmcnt(3)
    s_bitcmp1_b64 s[14:15], 24
    s_cbranch_scc0 1
    s_waitcnt vmcnt(2)
    s_cmpk_ge_u32 s8, 935
    s_cbranch_scc1 .ap_34
    s_waitcnt vmcnt(1)
.ap_34:
    s_add_u32 s63, s69, 393216
    buffer_load_dwordx4 v[56:59], v1, s[40:43], s63 offen nt
    s_memrealtime s[8:9]
    s_waitcnt lgkmcnt(0)
    s_sub_u32 s8, s8, s30
    s_cmpk_ge_u32 s8, 1120
    s_cbranch_scc1 .ap_35
    s_waitcnt vmcnt(5)
    s_cmpk_ge_u32 s8, 1055
    s_cbranch_scc1 .ap_35
    s_waitcnt vmcnt(3)
    s_bitcmp1_b64 s[14:15], 25
    s_cbranch_scc0 1
    s_waitcnt vmcnt(2)
    s_cmpk_ge_u32 s8, 980
    s_cbranch_scc1 .ap_35
    s_waitcnt vmcnt(1)
.ap_35:
    s_add_u32 s63, s69, 401408
    buffer_load_dwordx4 v[60:63], v1, s[40:43], s63 offen nt
    s_cmp_lt_u32 s2, 216
    s_cbranch_scc1 .Latt_bc
    s_branch .Latt_n
.Le_q:
    s_cmp_ge_u32 s65, 27
    s_mov_b32 s14, 0x94a5294a
    s_cselect_b32 s14, 0x0, s14
    s_mov_b32 s15, 0xa5294a52
    s_cselect_b32 s15, 0x0, s15
    s_cselect_b32 s30, -30, 0
    s_add_u32 s30, s30, 0
    s_add_u32 s30, s30, s70
    s_mul_i32 s58, s3, 1152
    s_mov_b32 s52, s4
    s_and_b32 s53, s5, 0xffff
    s_mov_b32 s54, 0x2400
    s_mov_b32 s55, 0x00020000
    buffer_load_dwordx2 v[246:247], v3, s[52:55], s58 offen
    buffer_load_dwordx2 v[248:249], v3, s[52:55], s58 offen offset:512
    buffer_load_dword v250, v4, s[52:55], s58 offen
    s_mov_b32 s48, s10
    s_and_b32 s49, s11, 0xffff
    s_mov_b32 s50, 0x480000
    s_mov_b32 s51, 0x00020000
    v_bfe_u32 v12, v0, 4, 1
    s_and_b32 s56, s3, 3
    s_lshl_b32 s56, s56, 1
    v_or_b32 v12, s56, v12
    v_and_b32 v19, 7, v0
    v_xor_b32 v12, v12, v19
    v_lshrrev_b32 v19, 3, v0
    v_mul_u32_u24 v19, 8192, v19
    v_lshl_add_u32 v19, v12, 4, v19
    s_lshl3_add_u32 s101, s64, s101
    s_lshl_b32 s99, s3, 16
    s_lshl_b32 s59, s101, 7
    s_add_u32 s99, s99, s59
    s_lshl_b32 s100, s3, 10
    s_add_u32 m0, s100, 0
    s_add_u32 s56, s99, 0
    buffer_load_dwordx4 v19, s[48:51], s56 offen nt lds
    s_add_u32 s63, s69, 32768
    buffer_load_dwordx4 v[96:99], v1, s[40:43], s63 offen nt
    v_bfe_u32 v16, v0, 1, 3
    v_mul_u32_u24 v16, 1312, v16
    v_lshrrev_b32 v12, 4, v0
    v_lshl_add_u32 v16, v12, 5, v16
    v_and_b32 v12, 1, v0
    v_lshl_add_u32 v16, v12, 4, v16
    v_add_u32 v16, 147456, v16
    s_mul_i32 s56, s3, 1312
    s_add_u32 s56, s56, 147456
    v_add_u32 v17, s56, v3
    v_add_u32 v18, s56, v4
    v_lshrrev_b32 v12, 4, v0
    v_bfe_u32 v13, v0, 1, 1
    v_lshl_add_u32 v12, v12, 1, v13
    v_bfe_u32 v13, v0, 2, 2
    v_lshl_add_u32 v20, v12, 3, v13
    v_lshlrev_b32 v20, 7, v20
    v_and_b32 v12, 3, v12
    v_lshrrev_b32 v13, 1, v13
    v_lshl_add_u32 v12, v12, 1, v13
    v_xor_b32 v12, s3, v12
    v_lshl_add_u32 v20, v12, 4, v20
    v_and_b32 v12, 1, v0
    v_lshl_add_u32 v20, v12, 3, v20
    v_bfe_u32 v23, v0, 1, 3
    v_mul_u32_u24 v23, 144, v23
    v_bfe_u32 v12, v0, 4, 1
    v_lshl_add_u32 v23, v12, 3, v23
    v_lshrrev_b32 v12, 5, v0
    v_lshl_add_u32 v23, v12, 2, v23
    v_and_b32 v12, 1, v0
    v_lshl_add_u32 v23, v12, 1, v23
    s_lshl_b32 s56, s3, 4
    s_add_u32 s56, s56, 157952
    v_add_u32 v23, s56, v23
    v_and_b32 v24, 15, v0
    v_lshlrev_b32 v24, 3, v24
    s_mul_i32 s56, s3, 144
    s_add_u32 s56, s56, 157952
    v_add_u32 v24, s56, v24
    v_add_u32 v21, 32768, v20
    s_lshl_b32 s100, s3, 10
    s_waitcnt lgkmcnt(0)
    s_add_u32 s34, s34, 1
    s_lshl_b32 s101, s101, 8
    s_lshl_b32 s58, s3, 14
    s_add_u32 s101, s101, s58
    s_add_u32 s101, s101, 0x40000
    s_and_b32 s58, s64, 1
    s_mul_i32 s58, s58, 18432
    s_mul_i32 s59, s3, 2304
    s_add_u32 s58, s58, s59
    s_add_u32 s58, s58, 0x3000
    s_add_u32 s59, s58, 36864
    s_waitcnt vmcnt(5)
    s_add_u32 m0, s100, 8192
    s_add_u32 s56, s99, 524288
    buffer_load_dwordx4 v19, s[48:51], s56 offen nt lds
    s_waitcnt vmcnt(5)
    s_add_u32 s63, s69, 40960
    buffer_load_dwordx4 v[100:103], v1, s[40:43], s63 offen nt
    s_waitcnt vmcnt(5)
    s_add_u32 m0, s100, 16384
    s_add_u32 s56, s99, 1048576
    buffer_load_dwordx4 v19, s[48:51], s56 offen nt lds
    s_waitcnt vmcnt(5)
    s_add_u32 s63, s69, 49152
    buffer_load_dwordx4 v[128:131], v1, s[40:43], s63 offen nt
    v_lshlrev_b32 v236, 16, v246
    v_and_b32 v237, 0xffff0000, v246
    v_lshlrev_b32 v238, 16, v247
    v_and_b32 v239, 0xffff0000, v247
    v_lshlrev_b32 v240, 16, v248
    v_and_b32 v241, 0xffff0000, v248
    v_lshlrev_b32 v242, 16, v249
    v_and_b32 v243, 0xffff0000, v249
    v_lshlrev_b32 v244, 16, v250
    v_and_b32 v245, 0xffff0000, v250
    s_mov_b32 s56, 0x3f803f80
    v_dot2_f32_bf16 v10, v246, s56, 0
    v_dot2_f32_bf16 v11, v246, v246, 0
    v_dot2_f32_bf16 v10, v247, s56, v10
    v_dot2_f32_bf16 v11, v247, v247, v11
    v_dot2_f32_bf16 v10, v248, s56, v10
    v_dot2_f32_bf16 v11, v248, v248, v11
    v_dot2_f32_bf16 v10, v249, s56, v10
    v_dot2_f32_bf16 v11, v249, v249, v11
    s_mov_b64 exec, 0xffffffff
    v_dot2_f32_bf16 v10, v250, s56, v10
    v_dot2_f32_bf16 v11, v250, v250, v11
    s_mov_b64 exec, -1
    s_nop 1
    v_permlane32_swap_b32 v10, v11
    v_add_f32 v10, v10, v11
    v_mov_b32 v12, v10
    s_nop 1
    v_permlane16_swap_b32 v12, v10
    v_add_f32 v10, v12, v10
    s_nop 1
    v_add_f32_dpp v10, v10, v10 row_ror:8 row_mask:0xf bank_mask:0xf
    s_nop 1
    v_add_f32_dpp v10, v10, v10 row_ror:4 row_mask:0xf bank_mask:0xf
    s_nop 1
    v_add_f32_dpp v10, v10, v10 quad_perm:[2,3,0,1] row_mask:0xf bank_mask:0xf
    s_nop 1
    v_add_f32_dpp v10, v10, v10 quad_perm:[1,0,3,2] row_mask:0xf bank_mask:0xf
    v_mul_f32 v10, 0x3ae38e39, v10
    s_nop 0
    v_readlane_b32 s56, v10, 0
    v_readlane_b32 s57, v10, 32
    s_nop 0
    v_mov_b32 v10, s56
    v_fma_f32 v11, -v10, v10, s57
    v_max_f32 v11, 0, v11
    v_cvt_pk_bf16_f32 v13, 0, v11
    v_cvt_pk_bf16_f32 v11, 0, -v10
    v_cvt_pk_bf16_f32 v10, 0, -v10
    v_add_f32 v13, 0x3727c5ac, v13
    v_pk_add_f32 v[236:237], v[236:237], v[10:11]
    v_pk_add_f32 v[238:239], v[238:239], v[10:11]
    v_pk_add_f32 v[240:241], v[240:241], v[10:11]
    v_cvt_pk_bf16_f32 v13, 0, v13
    v_pk_add_f32 v[242:243], v[242:243], v[10:11]
    v_pk_add_f32 v[244:245], v[244:245], v[10:11]
    v_cvt_pk_bf16_f32 v236, 0, v236
    v_sqrt_f32 v13, v13
    v_cvt_pk_bf16_f32 v237, 0, v237
    v_cvt_pk_bf16_f32 v238, 0, v238
    v_cvt_pk_bf16_f32 v239, 0, v239
    v_cvt_pk_bf16_f32 v13, 0, v13
    v_cvt_pk_bf16_f32 v240, 0, v240
    v_cvt_pk_bf16_f32 v241, 0, v241
    v_cvt_pk_bf16_f32 v242, 0, v242
    v_rcp_f32 v12, v13
    v_cvt_pk_bf16_f32 v243, 0, v243
    v_cvt_pk_bf16_f32 v244, 0, v244
    v_cvt_pk_bf16_f32 v245, 0, v245
    v_mov_b32 v13, v12
    v_pk_mul_f32 v[236:237], v[236:237], v[12:13]
    v_pk_mul_f32 v[238:239], v[238:239], v[12:13]
    v_pk_mul_f32 v[240:241], v[240:241], v[12:13]
    v_pk_mul_f32 v[242:243], v[242:243], v[12:13]
    v_pk_mul_f32 v[244:245], v[244:245], v[12:13]
    v_cvt_pk_bf16_f32 v236, 0, v236
    v_cvt_pk_bf16_f32 v237, 0, v237
    v_cvt_pk_bf16_f32 v238, 0, v238
    v_cvt_pk_bf16_f32 v239, 0, v239
    v_cvt_pk_bf16_f32 v240, 0, v240
    v_cvt_pk_bf16_f32 v241, 0, v241
    v_cvt_pk_bf16_f32 v242, 0, v242
    v_cvt_pk_bf16_f32 v243, 0, v243
    v_cvt_pk_bf16_f32 v244, 0, v244
    v_cvt_pk_bf16_f32 v245, 0, v245
    s_waitcnt vmcnt(5)
    s_add_u32 m0, s100, 24576
    s_add_u32 s56, s99, 1572864
    buffer_load_dwordx4 v19, s[48:51], s56 offen nt lds
    s_waitcnt vmcnt(5)
    s_add_u32 s63, s69, 57344
    buffer_load_dwordx4 v[132:135], v1, s[40:43], s63 offen nt
    s_waitcnt vmcnt(5)
    s_add_u32 m0, s100, 32768
    s_add_u32 s56, s99, 2097152
    buffer_load_dwordx4 v19, s[48:51], s56 offen nt lds
    s_waitcnt vmcnt(5)
    s_add_u32 s63, s69, 131072
    buffer_load_dwordx4 v[40:43], v1, s[40:43], s63 offen nt
    s_waitcnt vmcnt(5)
    s_add_u32 m0, s100, 40960
    s_add_u32 s56, s99, 2621440
    buffer_load_dwordx4 v19, s[48:51], s56 offen nt lds
    s_waitcnt vmcnt(5)
    s_add_u32 s63, s69, 139264
    buffer_load_dwordx4 v[44:47], v1, s[40:43], s63 offen nt
    s_waitcnt vmcnt(5)
    s_add_u32 m0, s100, 49152
    s_add_u32 s56, s99, 3145728
    buffer_load_dwordx4 v19, s[48:51], s56 offen nt lds
    s_waitcnt vmcnt(5)
    s_add_u32 s63, s69, 147456
    buffer_load_dwordx4 v[72:75], v1, s[40:43], s63 offen nt
    s_waitcnt vmcnt(5)
    s_add_u32 m0, s100, 57344
    s_add_u32 s56, s99, 3670016
    buffer_load_dwordx4 v19, s[48:51], s56 offen nt lds
    s_waitcnt vmcnt(5)
    s_add_u32 s63, s69, 155648
    buffer_load_dwordx4 v[76:79], v1, s[40:43], s63 offen nt
    s_waitcnt vmcnt(5)
    s_add_u32 m0, s100, 65536
    s_add_u32 s56, s99, 4194304
    buffer_load_dwordx4 v19, s[48:51], s56 offen nt lds
    s_waitcnt vmcnt(5)
    s_add_u32 s63, s69, 163840
    buffer_load_dwordx4 v[104:107], v1, s[40:43], s63 offen nt
    s_waitcnt vmcnt(5)
    s_add_u32 s63, s69, 172032
    buffer_load_dwordx4 v[108:111], v1, s[40:43], s63 offen nt
    buffer_load_dwordx4 v[196:199], v2, s[36:39], s58 offen offset:0 sc1
    buffer_load_dwordx4 v[200:203], v2, s[36:39], s58 offen offset:1024 sc1
    buffer_load_dwordx2 v[204:205], v5, s[36:39], s58 offen offset:0 sc1
    buffer_load_dwordx4 v[206:209], v2, s[36:39], s59 offen offset:0 sc1
    buffer_load_dwordx4 v[210:213], v2, s[36:39], s59 offen offset:1024 sc1
    buffer_load_dwordx2 v[214:215], v5, s[36:39], s59 offen offset:0 sc1
    s_add_u32 s63, s69, 180224
    buffer_load_dwordx4 v[136:139], v1, s[40:43], s63 offen nt
    s_add_u32 s63, s69, 188416
    buffer_load_dwordx4 v[140:143], v1, s[40:43], s63 offen nt
    s_add_u32 s63, s69, 262144
    buffer_load_dwordx4 v[48:51], v1, s[40:43], s63 offen nt
    s_add_u32 s63, s69, 270336
    buffer_load_dwordx4 v[52:55], v1, s[40:43], s63 offen nt
    s_waitcnt vmcnt(12)
    s_barrier
    ds_read_b64_tr_b16 v[160:161], v20 offset:0
    ds_read_b64_tr_b16 v[162:163], v20 offset:512
    ds_read_b64_tr_b16 v[164:165], v20 offset:8192
    ds_read_b64_tr_b16 v[166:167], v20 offset:8704
    ds_read_b64_tr_b16 v[168:169], v20 offset:16384
    ds_read_b64_tr_b16 v[170:171], v20 offset:16896
    ds_read_b64_tr_b16 v[172:173], v20 offset:24576
    ds_read_b64_tr_b16 v[174:175], v20 offset:25088
    ds_read_b64_tr_b16 v[176:177], v21 offset:0
    ds_read_b64_tr_b16 v[178:179], v21 offset:512
    ds_read_b64_tr_b16 v[180:181], v21 offset:8192
    ds_read_b64_tr_b16 v[182:183], v21 offset:8704
    ds_read_b64_tr_b16 v[184:185], v21 offset:16384
    ds_read_b64_tr_b16 v[186:187], v21 offset:16896
    ds_read_b64_tr_b16 v[188:189], v21 offset:24576
    ds_read_b64_tr_b16 v[190:191], v21 offset:25088
    ds_read_b64_tr_b16 v[192:193], v21 offset:32768
    ds_read_b64_tr_b16 v[194:195], v21 offset:33280
    s_waitcnt vmcnt(4)
    s_branch .gpc_37
.gp_36:
    buffer_load_dwordx4 v[196:199], v2, s[36:39], s58 offen offset:0 sc1
    buffer_load_dwordx4 v[200:203], v2, s[36:39], s58 offen offset:1024 sc1
    buffer_load_dwordx2 v[204:205], v5, s[36:39], s58 offen offset:0 sc1
    buffer_load_dwordx4 v[206:209], v2, s[36:39], s59 offen offset:0 sc1
    buffer_load_dwordx4 v[210:213], v2, s[36:39], s59 offen offset:1024 sc1
    buffer_load_dwordx2 v[214:215], v5, s[36:39], s59 offen offset:0 sc1
    s_waitcnt vmcnt(0)
.gpc_37:
    v_min_u32 v10, v197, v199
    v_max_u32 v11, v197, v199
    v_min3_u32 v10, v10, v201, v203
    v_max3_u32 v11, v11, v201, v203
    v_min3_u32 v10, v10, v205, v207
    v_max3_u32 v11, v11, v205, v207
    v_min3_u32 v10, v10, v209, v211
    v_max3_u32 v11, v11, v209, v211
    v_min3_u32 v10, v10, v213, v215
    v_max3_u32 v11, v11, v213, v215
    v_cmp_eq_u32 vcc, s34, v10
    v_cmp_eq_u32 s[56:57], s34, v11
    s_and_b64 vcc, vcc, s[56:57]
    s_cmp_eq_u64 vcc, exec
    s_nop 2
    s_cbranch_scc1 .gpd_38
    s_sub_u32 s35, s35, 1
    s_cbranch_scc1 .Lexit
    s_branch .gp_36
.gpd_38:
    v_and_b32 v207, 0xffff0000, v206
    v_lshlrev_b32 v206, 16, v206
    v_and_b32 v209, 0xffff0000, v208
    v_lshlrev_b32 v208, 16, v208
    v_and_b32 v211, 0xffff0000, v210
    v_lshlrev_b32 v210, 16, v210
    v_and_b32 v213, 0xffff0000, v212
    v_lshlrev_b32 v212, 16, v212
    v_and_b32 v215, 0xffff0000, v214
    v_lshlrev_b32 v214, 16, v214
    v_and_b32 v197, 0xffff0000, v196
    v_lshlrev_b32 v196, 16, v196
    v_and_b32 v199, 0xffff0000, v198
    v_lshlrev_b32 v198, 16, v198
    v_and_b32 v201, 0xffff0000, v200
    v_lshlrev_b32 v200, 16, v200
    v_and_b32 v203, 0xffff0000, v202
    v_lshlrev_b32 v202, 16, v202
    v_and_b32 v205, 0xffff0000, v204
    v_lshlrev_b32 v204, 16, v204
    v_pk_mul_f32 v[236:237], v[236:237], v[206:207]
    v_pk_mul_f32 v[238:239], v[238:239], v[208:209]
    v_pk_mul_f32 v[240:241], v[240:241], v[210:211]
    v_pk_mul_f32 v[242:243], v[242:243], v[212:213]
    v_pk_mul_f32 v[244:245], v[244:245], v[214:215]
    v_cvt_pk_bf16_f32 v236, 0, v236
    v_cvt_pk_bf16_f32 v237, 0, v237
    v_cvt_pk_bf16_f32 v238, 0, v238
    v_cvt_pk_bf16_f32 v239, 0, v239
    v_cvt_pk_bf16_f32 v240, 0, v240
    v_cvt_pk_bf16_f32 v241, 0, v241
    v_cvt_pk_bf16_f32 v242, 0, v242
    v_cvt_pk_bf16_f32 v243, 0, v243
    v_cvt_pk_bf16_f32 v244, 0, v244
    v_cvt_pk_bf16_f32 v245, 0, v245
    v_pk_add_f32 v[236:237], v[236:237], v[196:197]
    v_pk_add_f32 v[238:239], v[238:239], v[198:199]
    v_pk_add_f32 v[240:241], v[240:241], v[200:201]
    v_pk_add_f32 v[242:243], v[242:243], v[202:203]
    v_pk_add_f32 v[244:245], v[244:245], v[204:205]
    v_cvt_pk_bf16_f32 v246, v236, v237
    v_cvt_pk_bf16_f32 v247, v238, v239
    v_cvt_pk_bf16_f32 v248, v240, v241
    v_cvt_pk_bf16_f32 v249, v242, v243
    v_cvt_pk_bf16_f32 v250, v244, v245
    ds_write_b64 v17, v[246:247]
    ds_write_b64 v17, v[248:249] offset:512
    ds_write_b32 v18, v250
    s_waitcnt lgkmcnt(0)
    s_barrier
    ds_read_b128 v[196:199], v16 offset:0
    ds_read_b128 v[200:203], v16 offset:128
    ds_read_b128 v[204:207], v16 offset:256
    ds_read_b128 v[208:211], v16 offset:384
    ds_read_b128 v[212:215], v16 offset:512
    ds_read_b128 v[216:219], v16 offset:640
    ds_read_b128 v[220:223], v16 offset:768
    ds_read_b128 v[224:227], v16 offset:896
    ds_read_b128 v[228:231], v16 offset:1024
    s_waitcnt lgkmcnt(8)
    v_mfma_f32_16x16x32_bf16 v[232:235], v[160:163], v[196:199], 0
    s_waitcnt lgkmcnt(7)
    v_mfma_f32_16x16x32_bf16 v[232:235], v[164:167], v[200:203], v[232:235]
    s_waitcnt lgkmcnt(6)
    v_mfma_f32_16x16x32_bf16 v[232:235], v[168:171], v[204:207], v[232:235]
    s_waitcnt lgkmcnt(5)
    v_mfma_f32_16x16x32_bf16 v[232:235], v[172:175], v[208:211], v[232:235]
    s_waitcnt lgkmcnt(4)
    v_mfma_f32_16x16x32_bf16 v[232:235], v[176:179], v[212:215], v[232:235]
    s_waitcnt lgkmcnt(3)
    v_mfma_f32_16x16x32_bf16 v[232:235], v[180:183], v[216:219], v[232:235]
    s_waitcnt lgkmcnt(2)
    v_mfma_f32_16x16x32_bf16 v[232:235], v[184:187], v[220:223], v[232:235]
    s_waitcnt lgkmcnt(1)
    v_mfma_f32_16x16x32_bf16 v[232:235], v[188:191], v[224:227], v[232:235]
    s_waitcnt lgkmcnt(0)
    v_mfma_f32_16x16x32_bf16 v[232:235], v[192:195], v[228:231], v[232:235]
    s_nop 7
    v_permlane32_swap_b32 v232, v234
    v_permlane32_swap_b32 v233, v235
    v_cndmask_b32 v233, v233, v234, s[96:97]
    v_cndmask_b32 v232, v232, v235, s[96:97]
    s_nop 1
    v_add_f32_dpp v236, v233, v232 quad_perm:[1,0,3,2] row_mask:0xf bank_mask:0xf
    v_cvt_pk_bf16_f32 v236, v236, v236
    ds_write_b16 v23, v236
    v_mov_b32 v243, s34
    s_waitcnt lgkmcnt(0)
    s_barrier
    ds_read2_b32 v[244:245], v24 offset1:1
    v_mov_b32 v241, s34
    s_waitcnt lgkmcnt(0)
    v_mov_b32 v240, v244
    v_mov_b32 v242, v245
    s_mov_b64 exec, 0xffff
    buffer_store_dwordx4 v[240:243], v2, s[36:39], s101 offen sc1
    s_mov_b64 exec, -1
.Lq_done:
    s_waitcnt vmcnt(3)
    s_bitcmp1_b64 s[14:15], 18
    s_cbranch_scc0 1
    s_waitcnt vmcnt(2)
    s_add_u32 s63, s69, 278528
    buffer_load_dwordx4 v[80:83], v1, s[40:43], s63 offen nt
    v_and_b32 v157, 7, v0
    v_lshlrev_b32 v157, 7, v157
    s_mov_b32 s63, 0x400
    buffer_load_dword v156, v157, s[36:39], s63 offen
    s_memrealtime s[8:9]
    s_waitcnt lgkmcnt(0)
    s_sub_u32 s8, s8, s30
    s_cmpk_ge_u32 s8, 850
    s_cbranch_scc1 .ap_39
    s_waitcnt vmcnt(5)
    s_cmpk_ge_u32 s8, 785
    s_cbranch_scc1 .ap_39
    s_waitcnt vmcnt(4)
    s_bitcmp1_b64 s[14:15], 19
    s_cbranch_scc0 1
    s_waitcnt vmcnt(3)
    s_cmpk_ge_u32 s8, 710
    s_cbranch_scc1 .ap_39
    s_waitcnt vmcnt(2)
.ap_39:
    s_add_u32 s63, s69, 286720
    buffer_load_dwordx4 v[84:87], v1, s[40:43], s63 offen nt
    s_memrealtime s[8:9]
    s_waitcnt lgkmcnt(0)
    s_sub_u32 s8, s8, s30
    s_cmpk_ge_u32 s8, 895
    s_cbranch_scc1 .ap_40
    s_waitcnt vmcnt(6)
    s_cmpk_ge_u32 s8, 830
    s_cbranch_scc1 .ap_40
    s_waitcnt vmcnt(4)
    s_bitcmp1_b64 s[14:15], 20
    s_cbranch_scc0 1
    s_waitcnt vmcnt(3)
    s_cmpk_ge_u32 s8, 755
    s_cbranch_scc1 .ap_40
    s_waitcnt vmcnt(2)
.ap_40:
    s_add_u32 s63, s69, 294912
    buffer_load_dwordx4 v[112:115], v1, s[40:43], s63 offen nt
    s_memrealtime s[8:9]
    s_waitcnt lgkmcnt(0)
    s_sub_u32 s8, s8, s30
    s_cmpk_ge_u32 s8, 940
    s_cbranch_scc1 .ap_41
    s_waitcnt vmcnt(6)
    s_cmpk_ge_u32 s8, 875
    s_cbranch_scc1 .ap_41
    s_waitcnt vmcnt(4)
    s_bitcmp1_b64 s[14:15], 21
    s_cbranch_scc0 1
    s_waitcnt vmcnt(3)
    s_cmpk_ge_u32 s8, 800
    s_cbranch_scc1 .ap_41
    s_waitcnt vmcnt(1)
.ap_41:
    s_add_u32 s63, s69, 303104
    buffer_load_dwordx4 v[116:119], v1, s[40:43], s63 offen nt
    s_memrealtime s[8:9]
    s_waitcnt lgkmcnt(0)
    s_sub_u32 s8, s8, s30
    s_cmpk_ge_u32 s8, 985
    s_cbranch_scc1 .ap_42
    s_waitcnt vmcnt(6)
    s_cmpk_ge_u32 s8, 920
    s_cbranch_scc1 .ap_42
    s_waitcnt vmcnt(4)
    s_bitcmp1_b64 s[14:15], 22
    s_cbranch_scc0 1
    s_waitcnt vmcnt(2)
    s_cmpk_ge_u32 s8, 845
    s_cbranch_scc1 .ap_42
    s_waitcnt vmcnt(1)
.ap_42:
    s_add_u32 s63, s69, 311296
    buffer_load_dwordx4 v[144:147], v1, s[40:43], s63 offen nt
    s_waitcnt vmcnt(4)
    s_sub_u32 s63, s70, 300
    v_subrev_u32 v156, s63, v156
    v_mov_b32 v157, 600
    v_cmp_lt_u32 s[8:9], v156, v157
    v_add_u32_dpp v156, v156, v156 quad_perm:[1,0,3,2] row_mask:0xf bank_mask:0xf
    s_nop 1
    v_add_u32_dpp v156, v156, v156 quad_perm:[2,3,0,1] row_mask:0xf bank_mask:0xf
    s_nop 1
    v_add_u32_dpp v156, v156, v156 row_ror:4 row_mask:0xf bank_mask:0xf
    s_nop 0
    v_readfirstlane_b32 s63, v156
    s_cmp_eq_u64 s[8:9], -1
    s_nop 3
    s_cbranch_scc0 .et_43
    s_lshr_b32 s63, s63, 3
    s_sub_u32 s63, s63, 300
    s_add_u32 s30, s30, s63
.et_43:
    s_memrealtime s[8:9]
    s_waitcnt lgkmcnt(0)
    s_sub_u32 s8, s8, s30
    s_cmpk_ge_u32 s8, 1030
    s_cbranch_scc1 .ap_44
    s_waitcnt vmcnt(4)
    s_cmpk_ge_u32 s8, 965
    s_cbranch_scc1 .ap_44
    s_waitcnt vmcnt(3)
    s_bitcmp1_b64 s[14:15], 23
    s_cbranch_scc0 1
    s_waitcnt vmcnt(2)
    s_cmpk_ge_u32 s8, 890
    s_cbranch_scc1 .ap_44
    s_waitcnt vmcnt(1)
.ap_44:
    s_add_u32 s63, s69, 319488
    buffer_load_dwordx4 v[148:151], v1, s[40:43], s63 offen nt
    s_memrealtime s[8:9]
    s_waitcnt lgkmcnt(0)
    s_sub_u32 s8, s8, s30
    s_cmpk_ge_u32 s8, 1075
    s_cbranch_scc1 .ap_45
    s_waitcnt vmcnt(5)
    s_cmpk_ge_u32 s8, 1010
    s_cbranch_scc1 .ap_45
    s_waitcnt vmcnt(3)
    s_bitcmp1_b64 s[14:15], 24
    s_cbranch_scc0 1
    s_waitcnt vmcnt(2)
    s_cmpk_ge_u32 s8, 935
    s_cbranch_scc1 .ap_45
    s_waitcnt vmcnt(1)
.ap_45:
    s_add_u32 s63, s69, 393216
    buffer_load_dwordx4 v[56:59], v1, s[40:43], s63 offen nt
    s_memrealtime s[8:9]
    s_waitcnt lgkmcnt(0)
    s_sub_u32 s8, s8, s30
    s_cmpk_ge_u32 s8, 1120
    s_cbranch_scc1 .ap_46
    s_waitcnt vmcnt(5)
    s_cmpk_ge_u32 s8, 1055
    s_cbranch_scc1 .ap_46
    s_waitcnt vmcnt(3)
    s_bitcmp1_b64 s[14:15], 25
    s_cbranch_scc0 1
    s_waitcnt vmcnt(2)
    s_cmpk_ge_u32 s8, 980
    s_cbranch_scc1 .ap_46
    s_waitcnt vmcnt(1)
.ap_46:
    s_add_u32 s63, s69, 401408
    buffer_load_dwordx4 v[60:63], v1, s[40:43], s63 offen nt
    s_cmp_lt_u32 s2, 216
    s_cbranch_scc1 .Latt_bc
    s_branch .Latt_n
.Le_a:
    s_mov_b32 s14, 0x6ddb76dd
    s_mov_b32 s15, 0xdb76ddb7
    s_add_u32 s30, s70, -50
    s_mov_b32 s48, s12
    s_and_b32 s49, s13, 0xffff
    s_mov_b32 s50, 0x480000
    s_mov_b32 s51, 0x00020000
    v_bfe_u32 v12, v0, 4, 1
    s_and_b32 s56, s3, 1
    s_lshl_b32 s56, s56, 2
    v_lshl_or_b32 v12, v12, 1, s56
    v_and_b32 v13, 7, v0
    v_xor_b32 v12, v12, v13
    v_lshrrev_b32 v13, 3, v0
    v_mul_u32_u24 v13, 1152, v13
    v_lshl_add_u32 v6, v12, 4, v13
    s_lshl_b32 s101, s64, 6
    s_add_u32 s101, s101, s3
    s_mul_i32 s101, s101, 9216
    s_lshl_b32 s56, s65, 7
    s_add_u32 s101, s101, s56
    s_lshl_b32 s100, s3, 10
    s_waitcnt vmcnt(3)
    s_add_u32 m0, s100, 0
    s_add_u32 s56, s101, 0
    buffer_load_dwordx4 v6, s[48:51], s56 offen nt lds
    s_waitcnt vmcnt(3)
    s_bitcmp1_b64 s[14:15], 4
    s_cbranch_scc0 1
    s_waitcnt vmcnt(2)
    s_add_u32 s63, s69, 32768
    buffer_load_dwordx4 v[96:99], v1, s[40:43], s63 offen nt
    s_waitcnt vmcnt(3)
    s_add_u32 m0, s100, 8192
    s_add_u32 s56, s101, 73728
    buffer_load_dwordx4 v6, s[48:51], s56 offen nt lds
    s_waitcnt vmcnt(3)
    s_bitcmp1_b64 s[14:15], 5
    s_cbranch_scc0 1
    s_waitcnt vmcnt(2)
    s_add_u32 s63, s69, 40960
    buffer_load_dwordx4 v[100:103], v1, s[40:43], s63 offen nt
    s_waitcnt vmcnt(3)
    s_bitcmp1_b64 s[14:15], 6
    s_cbranch_scc0 1
    s_waitcnt vmcnt(2)
    s_add_u32 s63, s69, 49152
    buffer_load_dwordx4 v[128:131], v1, s[40:43], s63 offen nt
    s_waitcnt vmcnt(3)
    s_bitcmp1_b64 s[14:15], 7
    s_cbranch_scc0 1
    s_waitcnt vmcnt(2)
    s_add_u32 s63, s69, 57344
    buffer_load_dwordx4 v[132:135], v1, s[40:43], s63 offen nt
    s_waitcnt vmcnt(3)
    s_add_u32 m0, s100, 16384
    s_add_u32 s56, s101, 147456
    buffer_load_dwordx4 v6, s[48:51], s56 offen nt lds
    s_waitcnt vmcnt(3)
    s_bitcmp1_b64 s[14:15], 8
    s_cbranch_scc0 1
    s_waitcnt vmcnt(2)
    s_add_u32 s63, s69, 131072
    buffer_load_dwordx4 v[40:43], v1, s[40:43], s63 offen nt
    s_waitcnt vmcnt(3)
    s_bitcmp1_b64 s[14:15], 9
    s_cbranch_scc0 1
    s_waitcnt vmcnt(2)
    s_add_u32 s63, s69, 139264
    buffer_load_dwordx4 v[44:47], v1, s[40:43], s63 offen nt
    s_memrealtime s[8:9]
    s_waitcnt lgkmcnt(0)
    s_sub_u32 s8, s8, s30
    s_cmpk_ge_u32 s8, 436
    s_cbranch_scc1 .ap_47
    s_waitcnt vmcnt(4)
    s_cmpk_ge_u32 s8, 371
    s_cbranch_scc1 .ap_47
    s_waitcnt vmcnt(3)
    s_bitcmp1_b64 s[14:15], 10
    s_cbranch_scc0 1
    s_waitcnt vmcnt(2)
    s_cmpk_ge_u32 s8, 296
    s_cbranch_scc1 .ap_47
    s_waitcnt vmcnt(1)
.ap_47:
    s_add_u32 s63, s69, 147456
    buffer_load_dwordx4 v[72:75], v1, s[40:43], s63 offen nt
    s_waitcnt vmcnt(3)
    s_add_u32 m0, s100, 24576
    s_add_u32 s56, s101, 221184
    buffer_load_dwordx4 v6, s[48:51], s56 offen nt lds
    s_memrealtime s[8:9]
    s_waitcnt lgkmcnt(0)
    s_sub_u32 s8, s8, s30
    s_cmpk_ge_u32 s8, 482
    s_cbranch_scc1 .ap_48
    s_waitcnt vmcnt(4)
    s_cmpk_ge_u32 s8, 417
    s_cbranch_scc1 .ap_48
    s_waitcnt vmcnt(3)
    s_bitcmp1_b64 s[14:15], 11
    s_cbranch_scc0 1
    s_waitcnt vmcnt(2)
    s_cmpk_ge_u32 s8, 342
    s_cbranch_scc1 .ap_48
    s_waitcnt vmcnt(1)
.ap_48:
    s_add_u32 s63, s69, 155648
    buffer_load_dwordx4 v[76:79], v1, s[40:43], s63 offen nt
    s_waitcnt lgkmcnt(0)
    s_add_u32 s34, s34, 1
    s_memrealtime s[8:9]
    s_waitcnt lgkmcnt(0)
    s_sub_u32 s8, s8, s30
    s_cmpk_ge_u32 s8, 528
    s_cbranch_scc1 .ap_49
    s_waitcnt vmcnt(5)
    s_cmpk_ge_u32 s8, 463
    s_cbranch_scc1 .ap_49
    s_waitcnt vmcnt(3)
    s_bitcmp1_b64 s[14:15], 12
    s_cbranch_scc0 1
    s_waitcnt vmcnt(2)
    s_cmpk_ge_u32 s8, 388
    s_cbranch_scc1 .ap_49
    s_waitcnt vmcnt(1)
.ap_49:
    s_add_u32 s63, s69, 163840
    buffer_load_dwordx4 v[104:107], v1, s[40:43], s63 offen nt
    s_memrealtime s[8:9]
    s_waitcnt lgkmcnt(0)
    s_sub_u32 s8, s8, s30
    s_cmpk_ge_u32 s8, 574
    s_cbranch_scc1 .ap_50
    s_waitcnt vmcnt(5)
    s_cmpk_ge_u32 s8, 509
    s_cbranch_scc1 .ap_50
    s_waitcnt vmcnt(3)
    s_bitcmp1_b64 s[14:15], 13
    s_cbranch_scc0 1
    s_waitcnt vmcnt(2)
    s_cmpk_ge_u32 s8, 434
    s_cbranch_scc1 .ap_50
    s_waitcnt vmcnt(1)
.ap_50:
    s_add_u32 s63, s69, 172032
    buffer_load_dwordx4 v[108:111], v1, s[40:43], s63 offen nt
    s_waitcnt vmcnt(3)
    s_add_u32 m0, s100, 32768
    s_add_u32 s56, s101, 294912
    buffer_load_dwordx4 v6, s[48:51], s56 offen nt lds
    s_memrealtime s[8:9]
    s_waitcnt lgkmcnt(0)
    s_sub_u32 s8, s8, s30
    s_cmpk_ge_u32 s8, 620
    s_cbranch_scc1 .ap_51
    s_waitcnt vmcnt(4)
    s_cmpk_ge_u32 s8, 555
    s_cbranch_scc1 .ap_51
    s_waitcnt vmcnt(3)
    s_bitcmp1_b64 s[14:15], 14
    s_cbranch_scc0 1
    s_waitcnt vmcnt(2)
    s_cmpk_ge_u32 s8, 480
    s_cbranch_scc1 .ap_51
    s_waitcnt vmcnt(1)
.ap_51:
    s_add_u32 s63, s69, 180224
    buffer_load_dwordx4 v[136:139], v1, s[40:43], s63 offen nt
    s_memrealtime s[8:9]
    s_waitcnt lgkmcnt(0)
    s_sub_u32 s8, s8, s30
    s_cmpk_ge_u32 s8, 666
    s_cbranch_scc1 .ap_52
    s_waitcnt vmcnt(5)
    s_cmpk_ge_u32 s8, 601
    s_cbranch_scc1 .ap_52
    s_waitcnt vmcnt(3)
    s_bitcmp1_b64 s[14:15], 15
    s_cbranch_scc0 1
    s_waitcnt vmcnt(2)
    s_cmpk_ge_u32 s8, 526
    s_cbranch_scc1 .ap_52
    s_waitcnt vmcnt(1)
.ap_52:
    s_add_u32 s63, s69, 188416
    buffer_load_dwordx4 v[140:143], v1, s[40:43], s63 offen nt
    s_memrealtime s[8:9]
    s_waitcnt lgkmcnt(0)
    s_sub_u32 s8, s8, s30
    s_cmpk_ge_u32 s8, 712
    s_cbranch_scc1 .ap_53
    s_waitcnt vmcnt(5)
    s_cmpk_ge_u32 s8, 647
    s_cbranch_scc1 .ap_53
    s_waitcnt vmcnt(3)
    s_bitcmp1_b64 s[14:15], 16
    s_cbranch_scc0 1
    s_waitcnt vmcnt(2)
    s_cmpk_ge_u32 s8, 572
    s_cbranch_scc1 .ap_53
    s_waitcnt vmcnt(1)
.ap_53:
    s_add_u32 s63, s69, 262144
    buffer_load_dwordx4 v[48:51], v1, s[40:43], s63 offen nt
    s_waitcnt vmcnt(3)
    s_add_u32 m0, s100, 40960
    s_add_u32 s56, s101, 368640
    buffer_load_dwordx4 v6, s[48:51], s56 offen nt lds
    s_memrealtime s[8:9]
    s_waitcnt lgkmcnt(0)
    s_sub_u32 s8, s8, s30
    s_cmpk_ge_u32 s8, 758
    s_cbranch_scc1 .ap_54
    s_waitcnt vmcnt(4)
    s_cmpk_ge_u32 s8, 693
    s_cbranch_scc1 .ap_54
    s_waitcnt vmcnt(3)
    s_bitcmp1_b64 s[14:15], 17
    s_cbranch_scc0 1
    s_waitcnt vmcnt(2)
    s_cmpk_ge_u32 s8, 618
    s_cbranch_scc1 .ap_54
    s_waitcnt vmcnt(1)
.ap_54:
    s_add_u32 s63, s69, 270336
    buffer_load_dwordx4 v[52:55], v1, s[40:43], s63 offen nt
    s_memrealtime s[8:9]
    s_waitcnt lgkmcnt(0)
    s_sub_u32 s8, s8, s30
    s_cmpk_ge_u32 s8, 804
    s_cbranch_scc1 .ap_55
    s_waitcnt vmcnt(5)
    s_cmpk_ge_u32 s8, 739
    s_cbranch_scc1 .ap_55
    s_waitcnt vmcnt(3)
    s_bitcmp1_b64 s[14:15], 18
    s_cbranch_scc0 1
    s_waitcnt vmcnt(2)
    s_cmpk_ge_u32 s8, 664
    s_cbranch_scc1 .ap_55
    s_waitcnt vmcnt(1)
.ap_55:
    s_add_u32 s63, s69, 278528
    buffer_load_dwordx4 v[80:83], v1, s[40:43], s63 offen nt
    v_and_b32 v157, 7, v0
    v_lshlrev_b32 v157, 7, v157
    s_mov_b32 s63, 0x400
    buffer_load_dword v156, v157, s[36:39], s63 offen
    s_memrealtime s[8:9]
    s_waitcnt lgkmcnt(0)
    s_sub_u32 s8, s8, s30
    s_cmpk_ge_u32 s8, 850
    s_cbranch_scc1 .ap_56
    s_waitcnt vmcnt(6)
    s_cmpk_ge_u32 s8, 785
    s_cbranch_scc1 .ap_56
    s_waitcnt vmcnt(4)
    s_bitcmp1_b64 s[14:15], 19
    s_cbranch_scc0 1
    s_waitcnt vmcnt(3)
    s_cmpk_ge_u32 s8, 710
    s_cbranch_scc1 .ap_56
    s_waitcnt vmcnt(2)
.ap_56:
    s_add_u32 s63, s69, 286720
    buffer_load_dwordx4 v[84:87], v1, s[40:43], s63 offen nt
    s_waitcnt vmcnt(4)
    s_add_u32 m0, s100, 49152
    s_add_u32 s56, s101, 442368
    buffer_load_dwordx4 v6, s[48:51], s56 offen nt lds
    s_memrealtime s[8:9]
    s_waitcnt lgkmcnt(0)
    s_sub_u32 s8, s8, s30
    s_cmpk_ge_u32 s8, 895
    s_cbranch_scc1 .ap_57
    s_waitcnt vmcnt(5)
    s_cmpk_ge_u32 s8, 830
    s_cbranch_scc1 .ap_57
    s_waitcnt vmcnt(4)
    s_bitcmp1_b64 s[14:15], 20
    s_cbranch_scc0 1
    s_waitcnt vmcnt(3)
    s_cmpk_ge_u32 s8, 755
    s_cbranch_scc1 .ap_57
    s_waitcnt vmcnt(1)
.ap_57:
    s_add_u32 s63, s69, 294912
    buffer_load_dwordx4 v[112:115], v1, s[40:43], s63 offen nt
    s_memrealtime s[8:9]
    s_waitcnt lgkmcnt(0)
    s_sub_u32 s8, s8, s30
    s_cmpk_ge_u32 s8, 940
    s_cbranch_scc1 .ap_58
    s_waitcnt vmcnt(6)
    s_cmpk_ge_u32 s8, 875
    s_cbranch_scc1 .ap_58
    s_waitcnt vmcnt(4)
    s_bitcmp1_b64 s[14:15], 21
    s_cbranch_scc0 1
    s_waitcnt vmcnt(2)
    s_cmpk_ge_u32 s8, 800
    s_cbranch_scc1 .ap_58
    s_waitcnt vmcnt(1)
.ap_58:
    s_add_u32 s63, s69, 303104
    buffer_load_dwordx4 v[116:119], v1, s[40:43], s63 offen nt
    s_memrealtime s[8:9]
    s_waitcnt lgkmcnt(0)
    s_sub_u32 s8, s8, s30
    s_cmpk_ge_u32 s8, 985
    s_cbranch_scc1 .ap_59
    s_waitcnt vmcnt(6)
    s_cmpk_ge_u32 s8, 920
    s_cbranch_scc1 .ap_59
    s_waitcnt vmcnt(3)
    s_bitcmp1_b64 s[14:15], 22
    s_cbranch_scc0 1
    s_waitcnt vmcnt(2)
    s_cmpk_ge_u32 s8, 845
    s_cbranch_scc1 .ap_59
    s_waitcnt vmcnt(1)
.ap_59:
    s_add_u32 s63, s69, 311296
    buffer_load_dwordx4 v[144:147], v1, s[40:43], s63 offen nt
    s_waitcnt vmcnt(5)
    s_sub_u32 s63, s70, 300
    v_subrev_u32 v156, s63, v156
    v_mov_b32 v157, 600
    v_cmp_lt_u32 s[8:9], v156, v157
    v_add_u32_dpp v156, v156, v156 quad_perm:[1,0,3,2] row_mask:0xf bank_mask:0xf
    s_nop 1
    v_add_u32_dpp v156, v156, v156 quad_perm:[2,3,0,1] row_mask:0xf bank_mask:0xf
    s_nop 1
    v_add_u32_dpp v156, v156, v156 row_ror:4 row_mask:0xf bank_mask:0xf
    s_nop 0
    v_readfirstlane_b32 s63, v156
    s_cmp_eq_u64 s[8:9], -1
    s_nop 3
    s_cbranch_scc0 .et_60
    s_lshr_b32 s63, s63, 3
    s_sub_u32 s63, s63, 300
    s_add_u32 s30, s30, s63
.et_60:
    s_waitcnt vmcnt(3)
    s_add_u32 m0, s100, 57344
    s_add_u32 s56, s101, 516096
    buffer_load_dwordx4 v6, s[48:51], s56 offen nt lds
    s_memrealtime s[8:9]
    s_waitcnt lgkmcnt(0)
    s_sub_u32 s8, s8, s30
    s_cmpk_ge_u32 s8, 1030
    s_cbranch_scc1 .ap_61
    s_waitcnt vmcnt(4)
    s_cmpk_ge_u32 s8, 965
    s_cbranch_scc1 .ap_61
    s_waitcnt vmcnt(3)
    s_bitcmp1_b64 s[14:15], 23
    s_cbranch_scc0 1
    s_waitcnt vmcnt(2)
    s_cmpk_ge_u32 s8, 890
    s_cbranch_scc1 .ap_61
    s_waitcnt vmcnt(1)
.ap_61:
    s_add_u32 s63, s69, 319488
    buffer_load_dwordx4 v[148:151], v1, s[40:43], s63 offen nt
    s_memrealtime s[8:9]
    s_waitcnt lgkmcnt(0)
    s_sub_u32 s8, s8, s30
    s_cmpk_ge_u32 s8, 1075
    s_cbranch_scc1 .ap_62
    s_waitcnt vmcnt(5)
    s_cmpk_ge_u32 s8, 1010
    s_cbranch_scc1 .ap_62
    s_waitcnt vmcnt(3)
    s_bitcmp1_b64 s[14:15], 24
    s_cbranch_scc0 1
    s_waitcnt vmcnt(2)
    s_cmpk_ge_u32 s8, 935
    s_cbranch_scc1 .ap_62
    s_waitcnt vmcnt(1)
.ap_62:
    s_add_u32 s63, s69, 393216
    buffer_load_dwordx4 v[56:59], v1, s[40:43], s63 offen nt
    s_memrealtime s[8:9]
    s_waitcnt lgkmcnt(0)
    s_sub_u32 s8, s8, s30
    s_cmpk_ge_u32 s8, 1120
    s_cbranch_scc1 .ap_63
    s_waitcnt vmcnt(5)
    s_cmpk_ge_u32 s8, 1055
    s_cbranch_scc1 .ap_63
    s_waitcnt vmcnt(3)
    s_bitcmp1_b64 s[14:15], 25
    s_cbranch_scc0 1
    s_waitcnt vmcnt(2)
    s_cmpk_ge_u32 s8, 980
    s_cbranch_scc1 .ap_63
    s_waitcnt vmcnt(1)
.ap_63:
    s_add_u32 s63, s69, 401408
    buffer_load_dwordx4 v[60:63], v1, s[40:43], s63 offen nt
.Latt_ar:
    v_and_b32 v8, 1, v0
    v_lshlrev_b32 v8, 8, v8
    v_and_b32 v9, 0x3c, v0
    v_lshl_add_u32 v9, v9, 2, v8
    v_lshlrev_b32 v7, 1, v9
    v_and_b32 v9, 0x3c, v0
    v_lshrrev_b32 v8, 4, v8
    v_and_b32 v9, 2, v0
    v_lshl_add_u32 v9, v9, 6, v8
    s_lshl_b32 s58, s66, 14
    s_lshl_b32 s59, s67, 10
    s_add_u32 s58, s58, s59
    s_add_u32 s58, s58, 0x40000
    s_lshl4_add_u32 s59, s66, s67
    s_lshl_b32 s59, s59, 8
    s_add_u32 s59, s59, 0x200000
    s_memrealtime s[8:9]
    s_waitcnt vmcnt(8)
    s_waitcnt lgkmcnt(0)
    s_sub_u32 s8, s8, s30
    s_cmpk_ge_u32 s8, 1147
    s_cbranch_scc1 .ap_64
    s_waitcnt vmcnt(5)
    s_cmpk_ge_u32 s8, 1082
    s_cbranch_scc1 .ap_64
    s_waitcnt vmcnt(3)
    s_bitcmp1_b64 s[14:15], 26
    s_cbranch_scc0 1
    s_waitcnt vmcnt(2)
    s_cmpk_ge_u32 s8, 1007
    s_cbranch_scc1 .ap_64
    s_waitcnt vmcnt(1)
.ap_64:
    s_add_u32 s63, s69, 409600
    buffer_load_dwordx4 v[88:91], v1, s[40:43], s63 offen nt
    s_memrealtime s[8:9]
    s_waitcnt vmcnt(8)
    s_waitcnt lgkmcnt(0)
    s_sub_u32 s8, s8, s30
    s_cmpk_ge_u32 s8, 1174
    s_cbranch_scc1 .ap_65
    s_waitcnt vmcnt(5)
    s_cmpk_ge_u32 s8, 1109
    s_cbranch_scc1 .ap_65
    s_waitcnt vmcnt(3)
    s_bitcmp1_b64 s[14:15], 27
    s_cbranch_scc0 1
    s_waitcnt vmcnt(2)
    s_cmpk_ge_u32 s8, 1034
    s_cbranch_scc1 .ap_65
    s_waitcnt vmcnt(1)
.ap_65:
    s_add_u32 s63, s69, 417792
    buffer_load_dwordx4 v[92:95], v1, s[40:43], s63 offen nt
    s_memrealtime s[8:9]
    s_waitcnt vmcnt(8)
    s_waitcnt lgkmcnt(0)
    s_sub_u32 s8, s8, s30
    s_cmpk_ge_u32 s8, 1201
    s_cbranch_scc1 .ap_66
    s_waitcnt vmcnt(5)
    s_cmpk_ge_u32 s8, 1136
    s_cbranch_scc1 .ap_66
    s_waitcnt vmcnt(3)
    s_bitcmp1_b64 s[14:15], 28
    s_cbranch_scc0 1
    s_waitcnt vmcnt(2)
    s_cmpk_ge_u32 s8, 1061
    s_cbranch_scc1 .ap_66
    s_waitcnt vmcnt(1)
.ap_66:
    s_add_u32 s63, s69, 425984
    buffer_load_dwordx4 v[120:123], v1, s[40:43], s63 offen nt
    s_memrealtime s[8:9]
    s_waitcnt vmcnt(8)
    s_waitcnt lgkmcnt(0)
    s_sub_u32 s8, s8, s30
    s_cmpk_ge_u32 s8, 1228
    s_cbranch_scc1 .ap_67
    s_waitcnt vmcnt(5)
    s_cmpk_ge_u32 s8, 1163
    s_cbranch_scc1 .ap_67
    s_waitcnt vmcnt(3)
    s_bitcmp1_b64 s[14:15], 29
    s_cbranch_scc0 1
    s_waitcnt vmcnt(2)
    s_cmpk_ge_u32 s8, 1088
    s_cbranch_scc1 .ap_67
    s_waitcnt vmcnt(1)
.ap_67:
    s_add_u32 s63, s69, 434176
    buffer_load_dwordx4 v[124:127], v1, s[40:43], s63 offen nt
    s_memrealtime s[8:9]
    s_waitcnt vmcnt(8)
    s_waitcnt lgkmcnt(0)
    s_sub_u32 s8, s8, s30
    s_cmpk_ge_u32 s8, 1255
    s_cbranch_scc1 .ap_68
    s_waitcnt vmcnt(5)
    s_cmpk_ge_u32 s8, 1190
    s_cbranch_scc1 .ap_68
    s_waitcnt vmcnt(3)
    s_bitcmp1_b64 s[14:15], 30
    s_cbranch_scc0 1
    s_waitcnt vmcnt(2)
    s_cmpk_ge_u32 s8, 1115
    s_cbranch_scc1 .ap_68
    s_waitcnt vmcnt(1)
.ap_68:
    s_add_u32 s63, s69, 442368
    buffer_load_dwordx4 v[152:155], v1, s[40:43], s63 offen nt
    s_memrealtime s[8:9]
    s_waitcnt vmcnt(8)
    s_waitcnt lgkmcnt(0)
    s_sub_u32 s8, s8, s30
    s_cmpk_ge_u32 s8, 1282
    s_cbranch_scc1 .ap_69
    s_waitcnt vmcnt(5)
    s_cmpk_ge_u32 s8, 1217
    s_cbranch_scc1 .ap_69
    s_waitcnt vmcnt(3)
    s_bitcmp1_b64 s[14:15], 31
    s_cbranch_scc0 1
    s_waitcnt vmcnt(2)
    s_cmpk_ge_u32 s8, 1142
    s_cbranch_scc1 .ap_69
    s_waitcnt vmcnt(1)
.ap_69:
    s_add_u32 s63, s69, 450560
    buffer_load_dwordx4 v[156:159], v1, s[40:43], s63 offen nt
    buffer_load_dwordx4 v[16:19], v7, s[36:39], s58 offen offset:0 sc1
    buffer_load_dwordx4 v[20:23], v7, s[36:39], s58 offen offset:16 sc1
    s_memrealtime s[8:9]
    s_waitcnt vmcnt(8)
    s_waitcnt lgkmcnt(0)
    s_sub_u32 s8, s8, s30
    s_cmpk_ge_u32 s8, 1309
    s_cbranch_scc1 .ap_70
    s_waitcnt vmcnt(5)
    s_cmpk_ge_u32 s8, 1244
    s_cbranch_scc1 .ap_70
    s_waitcnt vmcnt(3)
    s_bitcmp1_b64 s[14:15], 32
    s_cbranch_scc0 1
    s_waitcnt vmcnt(2)
    s_cmpk_ge_u32 s8, 1169
    s_cbranch_scc1 .ap_70
    s_waitcnt vmcnt(1)
.ap_70:
    s_add_u32 s63, s69, 0
    buffer_load_dwordx4 v[160:163], v2, s[44:47], s63 offen nt
    s_memrealtime s[8:9]
    s_waitcnt vmcnt(8)
    s_waitcnt lgkmcnt(0)
    s_sub_u32 s8, s8, s30
    s_cmpk_ge_u32 s8, 1336
    s_cbranch_scc1 .ap_71
    s_waitcnt vmcnt(5)
    s_cmpk_ge_u32 s8, 1271
    s_cbranch_scc1 .ap_71
    s_waitcnt vmcnt(3)
    s_bitcmp1_b64 s[14:15], 33
    s_cbranch_scc0 1
    s_waitcnt vmcnt(2)
    s_cmpk_ge_u32 s8, 1196
    s_cbranch_scc1 .ap_71
    s_waitcnt vmcnt(1)
.ap_71:
    s_add_u32 s63, s69, 8192
    buffer_load_dwordx4 v[164:167], v2, s[44:47], s63 offen nt
    s_memrealtime s[8:9]
    s_waitcnt vmcnt(8)
    s_waitcnt lgkmcnt(0)
    s_sub_u32 s8, s8, s30
    s_cmpk_ge_u32 s8, 1363
    s_cbranch_scc1 .ap_72
    s_waitcnt vmcnt(5)
    s_cmpk_ge_u32 s8, 1298
    s_cbranch_scc1 .ap_72
    s_waitcnt vmcnt(3)
    s_bitcmp1_b64 s[14:15], 34
    s_cbranch_scc0 1
    s_waitcnt vmcnt(2)
    s_cmpk_ge_u32 s8, 1223
    s_cbranch_scc1 .ap_72
    s_waitcnt vmcnt(1)
.ap_72:
    s_add_u32 s63, s69, 16384
    buffer_load_dwordx4 v[168:171], v2, s[44:47], s63 offen nt
    s_waitcnt vmcnt(3)
    s_branch .gpc_74
.gp_73:
    buffer_load_dwordx4 v[16:19], v7, s[36:39], s58 offen offset:0 sc1
    buffer_load_dwordx4 v[20:23], v7, s[36:39], s58 offen offset:16 sc1
    s_waitcnt vmcnt(0)
.gpc_74:
    v_min_u32 v10, v17, v19
    v_max_u32 v11, v17, v19
    v_min3_u32 v10, v10, v21, v23
    v_max3_u32 v11, v11, v21, v23
    v_cmp_eq_u32 vcc, s34, v10
    v_cmp_eq_u32 s[56:57], s34, v11
    s_and_b64 vcc, vcc, s[56:57]
    s_cmp_eq_u64 vcc, exec
    s_nop 2
    s_cbranch_scc1 .gpd_75
    s_sub_u32 s35, s35, 1
    s_cbranch_scc1 .Lexit
    s_sleep 1
    s_branch .gp_73
.gpd_75:
    s_mov_b32 vcc_lo, 0xcccccccc
    s_mov_b32 vcc_hi, 0xcccccccc
    v_cndmask_b32_e64 v24, v16, 0, vcc
    v_cndmask_b32_e64 v25, v18, 0, vcc
    v_cndmask_b32_e64 v26, v20, 0, vcc
    v_cndmask_b32_e64 v27, v22, 0, vcc
    v_cndmask_b32_e32 v28, 0, v16, vcc
    v_cndmask_b32_e32 v29, 0, v18, vcc
    v_cndmask_b32_e32 v30, 0, v20, vcc
    v_cndmask_b32_e32 v31, 0, v22, vcc
    v_mfma_f32_16x16x32_bf16 v[16:19], v[32:35], v[24:27], 0
    v_mfma_f32_16x16x32_bf16 v[32:35], v[40:43], v[24:27], 0
    v_mfma_f32_16x16x32_bf16 v[16:19], v[36:39], v[28:31], v[16:19]
    v_mfma_f32_16x16x32_bf16 v[40:43], v[48:51], v[24:27], 0
    v_mfma_f32_16x16x32_bf16 v[32:35], v[44:47], v[28:31], v[32:35]
    v_mfma_f32_16x16x32_bf16 v[48:51], v[56:59], v[24:27], 0
    v_mfma_f32_16x16x32_bf16 v[40:43], v[52:55], v[28:31], v[40:43]
    v_mfma_f32_16x16x32_bf16 v[56:59], v[64:67], v[24:27], 0
    v_mfma_f32_16x16x32_bf16 v[48:51], v[60:63], v[28:31], v[48:51]
    s_nop 1
    v_add_f32_dpp v10, v17, v16 row_ror:12 row_mask:0xf bank_mask:0x1
    s_memrealtime s[8:9]
    s_waitcnt lgkmcnt(0)
    s_sub_u32 s8, s8, s30
    s_cmpk_ge_u32 s8, 1390
    s_nop 0
    s_cbranch_scc1 .ap_76
    s_waitcnt vmcnt(3)
    s_cmpk_ge_u32 s8, 1325
    s_cbranch_scc1 .ap_76
    s_waitcnt vmcnt(3)
    s_bitcmp1_b64 s[14:15], 35
    s_cbranch_scc0 1
    s_waitcnt vmcnt(2)
    s_cmpk_ge_u32 s8, 1250
    s_cbranch_scc1 .ap_76
    s_waitcnt vmcnt(1)
.ap_76:
    s_add_u32 s63, s69, 24576
    buffer_load_dwordx4 v[172:175], v2, s[44:47], s63 offen nt
    v_mfma_f32_16x16x32_bf16 v[64:67], v[72:75], v[24:27], 0
    v_mfma_f32_16x16x32_bf16 v[56:59], v[68:71], v[28:31], v[56:59]
    v_add_f32_dpp v11, v33, v32 row_ror:12 row_mask:0xf bank_mask:0x1
    v_add_f32_dpp v10, v18, v10 row_ror:8 row_mask:0xf bank_mask:0x1
    v_mfma_f32_16x16x32_bf16 v[72:75], v[80:83], v[24:27], 0
    v_mfma_f32_16x16x32_bf16 v[64:67], v[76:79], v[28:31], v[64:67]
    v_add_f32_dpp v12, v41, v40 row_ror:12 row_mask:0xf bank_mask:0x1
    v_add_f32_dpp v11, v34, v11 row_ror:8 row_mask:0xf bank_mask:0x1
    v_add_f32_dpp v10, v19, v10 row_ror:4 row_mask:0xf bank_mask:0x1
    v_mfma_f32_16x16x32_bf16 v[80:83], v[88:91], v[24:27], 0
    v_mfma_f32_16x16x32_bf16 v[72:75], v[84:87], v[28:31], v[72:75]
    v_add_f32_dpp v13, v49, v48 row_ror:12 row_mask:0xf bank_mask:0x1
    v_add_f32_dpp v12, v42, v12 row_ror:8 row_mask:0xf bank_mask:0x1
    v_add_f32_dpp v11, v35, v11 row_ror:4 row_mask:0xf bank_mask:0x1
    v_mfma_f32_16x16x32_bf16 v[88:91], v[96:99], v[24:27], 0
    v_mfma_f32_16x16x32_bf16 v[80:83], v[92:95], v[28:31], v[80:83]
    v_add_f32_dpp v10, v58, v57 row_ror:12 row_mask:0xf bank_mask:0x2
    v_add_f32_dpp v13, v50, v13 row_ror:8 row_mask:0xf bank_mask:0x1
    v_add_f32_dpp v12, v43, v12 row_ror:4 row_mask:0xf bank_mask:0x1
    s_memrealtime s[8:9]
    s_waitcnt lgkmcnt(0)
    s_sub_u32 s8, s8, s30
    s_cmpk_ge_u32 s8, 1417
    s_nop 0
    s_cbranch_scc1 .ap_77
    s_waitcnt vmcnt(4)
    s_cmpk_ge_u32 s8, 1352
    s_cbranch_scc1 .ap_77
    s_waitcnt vmcnt(3)
    s_bitcmp1_b64 s[14:15], 36
    s_cbranch_scc0 1
    s_waitcnt vmcnt(2)
    s_cmpk_ge_u32 s8, 1277
    s_cbranch_scc1 .ap_77
    s_waitcnt vmcnt(1)
.ap_77:
    s_add_u32 s63, s69, 32768
    buffer_load_dwordx4 v[176:179], v2, s[44:47], s63 offen nt
    v_mfma_f32_16x16x32_bf16 v[96:99], v[104:107], v[24:27], 0
    v_mfma_f32_16x16x32_bf16 v[88:91], v[100:103], v[28:31], v[88:91]
    v_add_f32_dpp v11, v66, v65 row_ror:12 row_mask:0xf bank_mask:0x2
    v_add_f32_dpp v10, v59, v10 row_ror:8 row_mask:0xf bank_mask:0x2
    v_add_f32_dpp v13, v51, v13 row_ror:4 row_mask:0xf bank_mask:0x1
    v_mfma_f32_16x16x32_bf16 v[104:107], v[112:115], v[24:27], 0
    v_mfma_f32_16x16x32_bf16 v[96:99], v[108:111], v[28:31], v[96:99]
    v_add_f32_dpp v12, v74, v73 row_ror:12 row_mask:0xf bank_mask:0x2
    v_add_f32_dpp v11, v67, v11 row_ror:8 row_mask:0xf bank_mask:0x2
    v_add_f32_dpp v10, v56, v10 row_ror:4 row_mask:0xf bank_mask:0x2
    v_mfma_f32_16x16x32_bf16 v[112:115], v[120:123], v[24:27], 0
    v_mfma_f32_16x16x32_bf16 v[104:107], v[116:119], v[28:31], v[104:107]
    v_add_f32_dpp v13, v82, v81 row_ror:12 row_mask:0xf bank_mask:0x2
    v_add_f32_dpp v12, v75, v12 row_ror:8 row_mask:0xf bank_mask:0x2
    v_add_f32_dpp v11, v64, v11 row_ror:4 row_mask:0xf bank_mask:0x2
    v_mfma_f32_16x16x32_bf16 v[120:123], v[128:131], v[24:27], 0
    v_mfma_f32_16x16x32_bf16 v[112:115], v[124:127], v[28:31], v[112:115]
    v_add_f32_dpp v10, v91, v90 row_ror:12 row_mask:0xf bank_mask:0x4
    v_add_f32_dpp v13, v83, v13 row_ror:8 row_mask:0xf bank_mask:0x2
    v_add_f32_dpp v12, v72, v12 row_ror:4 row_mask:0xf bank_mask:0x2
    s_memrealtime s[8:9]
    s_waitcnt lgkmcnt(0)
    s_sub_u32 s8, s8, s30
    s_cmpk_ge_u32 s8, 1444
    s_nop 0
    s_cbranch_scc1 .ap_78
    s_waitcnt vmcnt(5)
    s_cmpk_ge_u32 s8, 1379
    s_cbranch_scc1 .ap_78
    s_waitcnt vmcnt(3)
    s_bitcmp1_b64 s[14:15], 37
    s_cbranch_scc0 1
    s_waitcnt vmcnt(2)
    s_cmpk_ge_u32 s8, 1304
    s_cbranch_scc1 .ap_78
    s_waitcnt vmcnt(1)
.ap_78:
    s_add_u32 s63, s69, 40960
    buffer_load_dwordx4 v[180:183], v2, s[44:47], s63 offen nt
    v_mfma_f32_16x16x32_bf16 v[128:131], v[136:139], v[24:27], 0
    v_mfma_f32_16x16x32_bf16 v[120:123], v[132:135], v[28:31], v[120:123]
    v_add_f32_dpp v11, v99, v98 row_ror:12 row_mask:0xf bank_mask:0x4
    v_add_f32_dpp v10, v88, v10 row_ror:8 row_mask:0xf bank_mask:0x4
    v_add_f32_dpp v13, v80, v13 row_ror:4 row_mask:0xf bank_mask:0x2
    v_mfma_f32_16x16x32_bf16 v[136:139], v[144:147], v[24:27], 0
    v_mfma_f32_16x16x32_bf16 v[128:131], v[140:143], v[28:31], v[128:131]
    v_add_f32_dpp v12, v107, v106 row_ror:12 row_mask:0xf bank_mask:0x4
    v_add_f32_dpp v11, v96, v11 row_ror:8 row_mask:0xf bank_mask:0x4
    v_add_f32_dpp v10, v89, v10 row_ror:4 row_mask:0xf bank_mask:0x4
    v_mfma_f32_16x16x32_bf16 v[144:147], v[152:155], v[24:27], 0
    v_mfma_f32_16x16x32_bf16 v[136:139], v[148:151], v[28:31], v[136:139]
    v_add_f32_dpp v13, v115, v114 row_ror:12 row_mask:0xf bank_mask:0x4
    v_add_f32_dpp v12, v104, v12 row_ror:8 row_mask:0xf bank_mask:0x4
    v_add_f32_dpp v11, v97, v11 row_ror:4 row_mask:0xf bank_mask:0x4
    v_mfma_f32_16x16x32_bf16 v[144:147], v[156:159], v[28:31], v[144:147]
    v_add_f32_dpp v10, v120, v123 row_ror:12 row_mask:0xf bank_mask:0x8
    v_add_f32_dpp v13, v112, v13 row_ror:8 row_mask:0xf bank_mask:0x4
    v_add_f32_dpp v12, v105, v12 row_ror:4 row_mask:0xf bank_mask:0x4
    s_memrealtime s[8:9]
    s_waitcnt lgkmcnt(0)
    s_sub_u32 s8, s8, s30
    s_cmpk_ge_u32 s8, 1471
    s_nop 0
    s_cbranch_scc1 .ap_79
    s_waitcnt vmcnt(5)
    s_cmpk_ge_u32 s8, 1406
    s_cbranch_scc1 .ap_79
    s_waitcnt vmcnt(3)
    s_bitcmp1_b64 s[14:15], 38
    s_cbranch_scc0 1
    s_waitcnt vmcnt(2)
    s_cmpk_ge_u32 s8, 1331
    s_cbranch_scc1 .ap_79
    s_waitcnt vmcnt(1)
.ap_79:
    s_add_u32 s63, s69, 49152
    buffer_load_dwordx4 v[184:187], v2, s[44:47], s63 offen nt
    v_add_f32_dpp v11, v128, v131 row_ror:12 row_mask:0xf bank_mask:0x8
    v_add_f32_dpp v10, v121, v10 row_ror:8 row_mask:0xf bank_mask:0x8
    v_add_f32_dpp v13, v113, v13 row_ror:4 row_mask:0xf bank_mask:0x4
    v_add_f32_dpp v12, v136, v139 row_ror:12 row_mask:0xf bank_mask:0x8
    v_add_f32_dpp v11, v129, v11 row_ror:8 row_mask:0xf bank_mask:0x8
    v_add_f32_dpp v10, v122, v10 row_ror:4 row_mask:0xf bank_mask:0x8
    v_add_f32_dpp v13, v144, v147 row_ror:12 row_mask:0xf bank_mask:0x8
    v_add_f32_dpp v12, v137, v12 row_ror:8 row_mask:0xf bank_mask:0x8
    v_add_f32_dpp v11, v130, v11 row_ror:4 row_mask:0xf bank_mask:0x8
    v_add_f32_dpp v13, v145, v13 row_ror:8 row_mask:0xf bank_mask:0x8
    v_add_f32_dpp v12, v138, v12 row_ror:4 row_mask:0xf bank_mask:0x8
    s_memrealtime s[8:9]
    s_waitcnt lgkmcnt(0)
    s_sub_u32 s8, s8, s30
    s_cmpk_ge_u32 s8, 1498
    s_cbranch_scc1 .ap_80
    s_waitcnt vmcnt(5)
    s_cmpk_ge_u32 s8, 1433
    s_cbranch_scc1 .ap_80
    s_waitcnt vmcnt(3)
    s_bitcmp1_b64 s[14:15], 39
    s_cbranch_scc0 1
    s_waitcnt vmcnt(2)
    s_cmpk_ge_u32 s8, 1358
    s_cbranch_scc1 .ap_80
    s_waitcnt vmcnt(1)
.ap_80:
    s_add_u32 s63, s69, 57344
    buffer_load_dwordx4 v[188:191], v2, s[44:47], s63 offen nt
    v_add_f32_dpp v13, v146, v13 row_ror:4 row_mask:0xf bank_mask:0x8
    s_mov_b32 s60, 0x3db504f3
    s_mov_b32 s61, 0x3db504f3
    v_cvt_pk_bf16_f32 v10, 0, v10
    v_cvt_pk_bf16_f32 v11, 0, v11
    v_cvt_pk_bf16_f32 v12, 0, v12
    v_cvt_pk_bf16_f32 v13, 0, v13
    v_pk_mul_f32 v[10:11], v[10:11], s[60:61]
    v_pk_mul_f32 v[12:13], v[12:13], s[60:61]
    v_cvt_pk_bf16_f32 v10, 0, v10
    v_cvt_pk_bf16_f32 v11, 0, v11
    v_cvt_pk_bf16_f32 v12, 0, v12
    v_cvt_pk_bf16_f32 v13, 0, v13
    v_max_f32 v14, v10, v11
    v_max3_f32 v14, v14, v12, v13
    s_mov_b32 s60, 0x3fb8aa3b
    v_mov_b32 v22, s34
    v_mov_b32 v23, s34
    v_max_f32_dpp v14, v14, v14 quad_perm:[2,3,0,1] row_mask:0xf bank_mask:0xf
    s_nop 1
    v_max_f32_dpp v14, v14, v14 row_ror:4 row_mask:0xf bank_mask:0xf
    s_nop 1
    v_max_f32_dpp v14, v14, v14 row_ror:8 row_mask:0xf bank_mask:0xf
    v_mov_b32 v15, v14
    s_nop 1
    v_permlane16_swap_b32 v15, v14
    v_max_f32 v14, v15, v14
    v_mov_b32 v15, v14
    s_nop 1
    v_permlane32_swap_b32 v15, v14
    v_max_f32 v14, v15, v14
    v_mul_f32 v15, 0xbfb8aa3b, v14
    v_fma_f32 v10, v10, s60, v15
    v_fma_f32 v11, v11, s60, v15
    v_fma_f32 v12, v12, s60, v15
    v_fma_f32 v13, v13, s60, v15
    v_exp_f32 v10, v10
    v_exp_f32 v11, v11
    v_exp_f32 v12, v12
    v_exp_f32 v13, v13
    v_mov_b32 v20, v14
    v_pk_add_f32 v[16:17], v[10:11], v[12:13]
    v_add_f32 v21, v16, v17
    s_lshl3_add_u32 s60, s68, s3
    s_lshl_b32 s60, s60, 5
    s_add_u32 s60, s60, s59
    v_add_f32_dpp v21, v21, v21 quad_perm:[2,3,0,1] row_mask:0xf bank_mask:0xf
    s_nop 1
    v_add_f32_dpp v21, v21, v21 row_ror:4 row_mask:0xf bank_mask:0xf
    s_nop 1
    v_add_f32_dpp v21, v21, v21 row_ror:8 row_mask:0xf bank_mask:0xf
    v_mov_b32 v15, v21
    s_nop 1
    v_permlane16_swap_b32 v15, v21
    v_add_f32 v21, v15, v21
    v_mov_b32 v15, v21
    s_nop 1
    v_permlane32_swap_b32 v15, v21
    v_add_f32 v21, v15, v21
    s_lshl_b32 s60, s3, 4
    s_add_u32 s60, s60, 159104
    v_add_u32 v16, s60, v3
    v_mov_b32 v17, 159232
    v_mov_b32 v18, 1
    s_mov_b64 exec, 3
    ds_write_b64 v16, v[20:21]
    s_mov_b64 exec, 1
    s_waitcnt lgkmcnt(0)
    ds_add_rtn_u32 v18, v17, v18
    s_mov_b64 exec, -1
    v_and_b32 v16, 0x78, v3
    v_add_u32 v16, 159104, v16
    s_waitcnt lgkmcnt(0)
    v_readfirstlane_b32 s60, v18
    s_cmp_lg_u32 s60, 7
    s_nop 3
    s_cbranch_scc1 .ml_81
    ds_read_b64 v[18:19], v16
    s_lshl_b32 s60, s68, 7
    s_add_u32 s60, s60, s59
    s_waitcnt lgkmcnt(0)
    v_mov_b32 v20, v18
    s_nop 1
    v_max_f32_dpp v20, v20, v20 quad_perm:[2,3,0,1] row_mask:0xf bank_mask:0xf
    s_nop 1
    v_max_f32_dpp v20, v20, v20 row_ror:4 row_mask:0xf bank_mask:0xf
    s_nop 1
    v_max_f32_dpp v20, v20, v20 row_ror:8 row_mask:0xf bank_mask:0xf
    v_sub_f32 v18, v18, v20
    v_mul_f32 v18, 0x3fb8aa3b, v18
    v_exp_f32 v18, v18
    s_nop 0
    v_mul_f32 v21, v18, v19
    s_nop 1
    v_add_f32_dpp v21, v21, v21 quad_perm:[2,3,0,1] row_mask:0xf bank_mask:0xf
    s_nop 1
    v_add_f32_dpp v21, v21, v21 row_ror:4 row_mask:0xf bank_mask:0xf
    s_nop 1
    v_add_f32_dpp v21, v21, v21 row_ror:8 row_mask:0xf bank_mask:0xf
    s_mov_b64 exec, 0xff
    buffer_store_dwordx4 v[20:23], v2, s[36:39], s60 offen sc1
    s_mov_b64 exec, -1
.ml_81:
    s_memrealtime s[8:9]
    s_waitcnt lgkmcnt(0)
    s_sub_u32 s8, s8, s30
    s_cmpk_ge_u32 s8, 1525
    s_cbranch_scc1 .ap_82
    s_waitcnt vmcnt(5)
    s_cmpk_ge_u32 s8, 1460
    s_cbranch_scc1 .ap_82
    s_waitcnt vmcnt(3)
    s_bitcmp1_b64 s[14:15], 40
    s_cbranch_scc0 1
    s_waitcnt vmcnt(2)
    s_cmpk_ge_u32 s8, 1385
    s_cbranch_scc1 .ap_82
    s_waitcnt vmcnt(1)
.ap_82:
    s_add_u32 s63, s69, 131072
    buffer_load_dwordx4 v[192:195], v2, s[44:47], s63 offen nt
    s_memrealtime s[8:9]
    s_waitcnt vmcnt(8)
    s_waitcnt lgkmcnt(0)
    s_sub_u32 s8, s8, s30
    s_cmpk_ge_u32 s8, 1552
    s_cbranch_scc1 .ap_83
    s_waitcnt vmcnt(5)
    s_cmpk_ge_u32 s8, 1487
    s_cbranch_scc1 .ap_83
    s_waitcnt vmcnt(3)
    s_bitcmp1_b64 s[14:15], 41
    s_cbranch_scc0 1
    s_waitcnt vmcnt(2)
    s_cmpk_ge_u32 s8, 1412
    s_cbranch_scc1 .ap_83
    s_waitcnt vmcnt(1)
.ap_83:
    s_add_u32 s63, s69, 139264
    buffer_load_dwordx4 v[196:199], v2, s[44:47], s63 offen nt
    s_memrealtime s[8:9]
    s_waitcnt vmcnt(8)
    s_waitcnt lgkmcnt(0)
    s_sub_u32 s8, s8, s30
    s_cmpk_ge_u32 s8, 1579
    s_cbranch_scc1 .ap_84
    s_waitcnt vmcnt(5)
    s_cmpk_ge_u32 s8, 1514
    s_cbranch_scc1 .ap_84
    s_waitcnt vmcnt(3)
    s_bitcmp1_b64 s[14:15], 42
    s_cbranch_scc0 1
    s_waitcnt vmcnt(2)
    s_cmpk_ge_u32 s8, 1439
    s_cbranch_scc1 .ap_84
    s_waitcnt vmcnt(1)
.ap_84:
    s_add_u32 s63, s69, 147456
    buffer_load_dwordx4 v[200:203], v2, s[44:47], s63 offen nt
    s_memrealtime s[8:9]
    s_waitcnt vmcnt(8)
    s_waitcnt lgkmcnt(0)
    s_sub_u32 s8, s8, s30
    s_cmpk_ge_u32 s8, 1606
    s_cbranch_scc1 .ap_85
    s_waitcnt vmcnt(5)
    s_cmpk_ge_u32 s8, 1541
    s_cbranch_scc1 .ap_85
    s_waitcnt vmcnt(3)
    s_bitcmp1_b64 s[14:15], 43
    s_cbranch_scc0 1
    s_waitcnt vmcnt(2)
    s_cmpk_ge_u32 s8, 1466
    s_cbranch_scc1 .ap_85
    s_waitcnt vmcnt(1)
.ap_85:
    s_add_u32 s63, s69, 155648
    buffer_load_dwordx4 v[204:207], v2, s[44:47], s63 offen nt
    s_memrealtime s[8:9]
    s_waitcnt vmcnt(8)
    s_waitcnt lgkmcnt(0)
    s_sub_u32 s8, s8, s30
    s_cmpk_ge_u32 s8, 1633
    s_cbranch_scc1 .ap_86
    s_waitcnt vmcnt(5)
    s_cmpk_ge_u32 s8, 1568
    s_cbranch_scc1 .ap_86
    s_waitcnt vmcnt(3)
    s_bitcmp1_b64 s[14:15], 44
    s_cbranch_scc0 1
    s_waitcnt vmcnt(2)
    s_cmpk_ge_u32 s8, 1493
    s_cbranch_scc1 .ap_86
    s_waitcnt vmcnt(1)
.ap_86:
    s_add_u32 s63, s69, 163840
    buffer_load_dwordx4 v[208:211], v2, s[44:47], s63 offen nt
    v_and_b32 v16, 15, v0
    v_lshrrev_b32 v17, 4, v0
    v_lshl_add_u32 v16, v16, 2, v17
    v_lshlrev_b32 v31, 1, v16
    s_lshl_b32 s56, s65, 7
    v_add_u32 v31, s56, v31
    v_and_b32 v6, -4, v31
    v_lshlrev_b32 v6, 1, v6
    s_mul_i32 s56, s3, 1152
    s_mov_b32 s52, s4
    s_and_b32 s53, s5, 0xffff
    s_mov_b32 s54, 0x2400
    s_mov_b32 s55, 0x00020000
    buffer_load_ushort v29, v31, s[52:55], s56 offen
    s_mul_i32 s101, s3, 2304
    s_add_u32 s101, s101, 0x15000
    s_add_u32 s99, s101, 36864
    s_add_u32 s100, s101, 73728
    s_add_u32 s33, s101, 110592
    buffer_load_dwordx2 v[72:73], v6, s[36:39], s101 offen offset:0
    s_cmp_lg_u32 s3, s64
    s_cbranch_scc1 .rin_87
    buffer_load_dwordx4 v[32:35], v2, s[36:39], s99 offen offset:0
    buffer_load_dwordx4 v[40:43], v2, s[36:39], s99 offen offset:1024
    buffer_load_dwordx2 v[48:49], v5, s[36:39], s99 offen offset:0
    buffer_load_dwordx4 v[56:59], v2, s[36:39], s100 offen offset:0
    buffer_load_dwordx4 v[64:67], v2, s[36:39], s100 offen offset:1024
    buffer_load_dwordx2 v[50:51], v5, s[36:39], s100 offen offset:0
    buffer_load_dwordx2 v[74:75], v6, s[36:39], s99 offen offset:0
    buffer_load_dwordx2 v[80:81], v6, s[36:39], s100 offen offset:0
    buffer_load_dwordx2 v[82:83], v6, s[36:39], s33 offen offset:0
    s_mov_b32 s48, s16
    s_and_b32 s49, s17, 0xffff
    s_mov_b32 s50, 0x480
    s_mov_b32 s51, 0x00020000
    buffer_load_dwordx2 v[88:89], v3, s[48:51], 0 offen
    buffer_load_dwordx2 v[90:91], v3, s[48:51], 0 offen offset:512
    buffer_load_dword v30, v4, s[48:51], 0 offen
    s_mov_b32 s48, s28
    s_and_b32 s49, s29, 0xffff
    s_mov_b32 s50, 0x2400
    s_mov_b32 s51, 0x00020000
    buffer_load_ushort v17, v31, s[48:51], s56 offen nt
.rin_87:
    s_memrealtime s[8:9]
    s_waitcnt vmcnt(10)
    s_waitcnt lgkmcnt(0)
    s_sub_u32 s8, s8, s30
    s_cmpk_ge_u32 s8, 1660
    s_cbranch_scc1 .ap_88
    s_waitcnt vmcnt(7)
    s_cmpk_ge_u32 s8, 1595
    s_cbranch_scc1 .ap_88
    s_waitcnt vmcnt(5)
    s_bitcmp1_b64 s[14:15], 45
    s_cbranch_scc0 1
    s_waitcnt vmcnt(4)
    s_cmpk_ge_u32 s8, 1520
    s_cbranch_scc1 .ap_88
    s_waitcnt vmcnt(3)
.ap_88:
    s_add_u32 s63, s69, 172032
    buffer_load_dwordx4 v[212:215], v2, s[44:47], s63 offen nt
    s_memrealtime s[8:9]
    s_waitcnt vmcnt(10)
    s_waitcnt lgkmcnt(0)
    s_sub_u32 s8, s8, s30
    s_cmpk_ge_u32 s8, 1691
    s_cbranch_scc1 .ap_89
    s_waitcnt vmcnt(7)
    s_cmpk_ge_u32 s8, 1626
    s_cbranch_scc1 .ap_89
    s_waitcnt vmcnt(5)
    s_bitcmp1_b64 s[14:15], 46
    s_cbranch_scc0 1
    s_waitcnt vmcnt(4)
    s_cmpk_ge_u32 s8, 1551
    s_cbranch_scc1 .ap_89
    s_waitcnt vmcnt(3)
.ap_89:
    s_add_u32 s63, s69, 180224
    buffer_load_dwordx4 v[216:219], v2, s[44:47], s63 offen nt
    s_memrealtime s[8:9]
    s_waitcnt vmcnt(10)
    s_waitcnt lgkmcnt(0)
    s_sub_u32 s8, s8, s30
    s_cmpk_ge_u32 s8, 1722
    s_cbranch_scc1 .ap_90
    s_waitcnt vmcnt(7)
    s_cmpk_ge_u32 s8, 1657
    s_cbranch_scc1 .ap_90
    s_waitcnt vmcnt(5)
    s_bitcmp1_b64 s[14:15], 47
    s_cbranch_scc0 1
    s_waitcnt vmcnt(4)
    s_cmpk_ge_u32 s8, 1582
    s_cbranch_scc1 .ap_90
    s_waitcnt vmcnt(1)
.ap_90:
    s_add_u32 s63, s69, 188416
    buffer_load_dwordx4 v[220:223], v2, s[44:47], s63 offen nt
    s_memrealtime s[8:9]
    s_waitcnt vmcnt(10)
    s_waitcnt lgkmcnt(0)
    s_sub_u32 s8, s8, s30
    s_cmpk_ge_u32 s8, 1753
    s_cbranch_scc1 .ap_91
    s_waitcnt vmcnt(7)
    s_cmpk_ge_u32 s8, 1688
    s_cbranch_scc1 .ap_91
    s_waitcnt vmcnt(5)
    s_bitcmp1_b64 s[14:15], 48
    s_cbranch_scc0 1
    s_waitcnt vmcnt(2)
    s_cmpk_ge_u32 s8, 1613
    s_cbranch_scc1 .ap_91
    s_waitcnt vmcnt(1)
.ap_91:
    s_add_u32 s63, s69, 262144
    buffer_load_dwordx4 v[224:227], v2, s[44:47], s63 offen nt
    s_memrealtime s[8:9]
    s_waitcnt vmcnt(10)
    s_waitcnt lgkmcnt(0)
    s_sub_u32 s8, s8, s30
    s_cmpk_ge_u32 s8, 1784
    s_cbranch_scc1 .ap_92
    s_waitcnt vmcnt(7)
    s_cmpk_ge_u32 s8, 1719
    s_cbranch_scc1 .ap_92
    s_waitcnt vmcnt(3)
    s_bitcmp1_b64 s[14:15], 49
    s_cbranch_scc0 1
    s_waitcnt vmcnt(2)
    s_cmpk_ge_u32 s8, 1644
    s_cbranch_scc1 .ap_92
    s_waitcnt vmcnt(1)
.ap_92:
    s_add_u32 s63, s69, 270336
    buffer_load_dwordx4 v[228:231], v2, s[44:47], s63 offen nt
    s_memrealtime s[8:9]
    s_waitcnt vmcnt(10)
    s_waitcnt lgkmcnt(0)
    s_sub_u32 s8, s8, s30
    s_cmpk_ge_u32 s8, 1815
    s_cbranch_scc1 .ap_93
    s_waitcnt vmcnt(7)
    s_cmpk_ge_u32 s8, 1750
    s_cbranch_scc1 .ap_93
    s_waitcnt vmcnt(3)
    s_bitcmp1_b64 s[14:15], 50
    s_cbranch_scc0 1
    s_waitcnt vmcnt(2)
    s_cmpk_ge_u32 s8, 1675
    s_cbranch_scc1 .ap_93
    s_waitcnt vmcnt(1)
.ap_93:
    s_add_u32 s63, s69, 278528
    buffer_load_dwordx4 v[232:235], v2, s[44:47], s63 offen nt
    s_memrealtime s[8:9]
    s_waitcnt vmcnt(10)
    s_waitcnt lgkmcnt(0)
    s_sub_u32 s8, s8, s30
    s_cmpk_ge_u32 s8, 1846
    s_cbranch_scc1 .ap_94
    s_waitcnt vmcnt(5)
    s_cmpk_ge_u32 s8, 1781
    s_cbranch_scc1 .ap_94
    s_waitcnt vmcnt(3)
    s_bitcmp1_b64 s[14:15], 51
    s_cbranch_scc0 1
    s_waitcnt vmcnt(2)
    s_cmpk_ge_u32 s8, 1706
    s_cbranch_scc1 .ap_94
    s_waitcnt vmcnt(1)
.ap_94:
    s_add_u32 s63, s69, 286720
    buffer_load_dwordx4 v[236:239], v2, s[44:47], s63 offen nt
    s_memrealtime s[8:9]
    s_waitcnt vmcnt(10)
    s_waitcnt lgkmcnt(0)
    s_sub_u32 s8, s8, s30
    s_cmpk_ge_u32 s8, 1877
    s_cbranch_scc1 .ap_95
    s_waitcnt vmcnt(5)
    s_cmpk_ge_u32 s8, 1812
    s_cbranch_scc1 .ap_95
    s_waitcnt vmcnt(3)
    s_bitcmp1_b64 s[14:15], 52
    s_cbranch_scc0 1
    s_waitcnt vmcnt(2)
    s_cmpk_ge_u32 s8, 1737
    s_cbranch_scc1 .ap_95
    s_waitcnt vmcnt(1)
.ap_95:
    s_add_u32 s63, s69, 294912
    buffer_load_dwordx4 v[240:243], v2, s[44:47], s63 offen nt
    s_memrealtime s[8:9]
    s_waitcnt vmcnt(10)
    s_waitcnt lgkmcnt(0)
    s_sub_u32 s8, s8, s30
    s_cmpk_ge_u32 s8, 1908
    s_cbranch_scc1 .ap_96
    s_waitcnt vmcnt(5)
    s_cmpk_ge_u32 s8, 1843
    s_cbranch_scc1 .ap_96
    s_waitcnt vmcnt(3)
    s_bitcmp1_b64 s[14:15], 53
    s_cbranch_scc0 1
    s_waitcnt vmcnt(2)
    s_cmpk_ge_u32 s8, 1768
    s_cbranch_scc1 .ap_96
    s_waitcnt vmcnt(1)
.ap_96:
    s_add_u32 s63, s69, 303104
    buffer_load_dwordx4 v[244:247], v2, s[44:47], s63 offen nt
    s_load_dwordx2 s[88:89], s[6:7], s0
    buffer_load_dwordx4 v[24:27], v9, s[36:39], s59 offen offset:0 sc1
    s_memrealtime s[8:9]
    s_waitcnt vmcnt(8)
    s_waitcnt lgkmcnt(0)
    s_sub_u32 s8, s8, s30
    s_cmpk_ge_u32 s8, 1939
    s_cbranch_scc1 .ap_97
    s_waitcnt vmcnt(5)
    s_cmpk_ge_u32 s8, 1874
    s_cbranch_scc1 .ap_97
    s_waitcnt vmcnt(3)
    s_bitcmp1_b64 s[14:15], 54
    s_cbranch_scc0 1
    s_waitcnt vmcnt(2)
    s_cmpk_ge_u32 s8, 1799
    s_cbranch_scc1 .ap_97
    s_waitcnt vmcnt(1)
.ap_97:
    s_add_u32 s63, s69, 311296
    buffer_load_dwordx4 v[248:251], v2, s[44:47], s63 offen nt
    s_memrealtime s[8:9]
    s_waitcnt vmcnt(8)
    s_waitcnt lgkmcnt(0)
    s_sub_u32 s8, s8, s30
    s_cmpk_ge_u32 s8, 1970
    s_cbranch_scc1 .ap_98
    s_waitcnt vmcnt(5)
    s_cmpk_ge_u32 s8, 1905
    s_cbranch_scc1 .ap_98
    s_waitcnt vmcnt(3)
    s_bitcmp1_b64 s[14:15], 55
    s_cbranch_scc0 1
    s_waitcnt vmcnt(2)
    s_cmpk_ge_u32 s8, 1830
    s_cbranch_scc1 .ap_98
    s_waitcnt vmcnt(1)
.ap_98:
    s_add_u32 s63, s69, 319488
    buffer_load_dwordx4 v[252:255], v2, s[44:47], s63 offen nt
    s_memrealtime s[8:9]
    s_waitcnt vmcnt(8)
    s_waitcnt lgkmcnt(0)
    s_sub_u32 s8, s8, s30
    s_cmpk_ge_u32 s8, 2001
    s_cbranch_scc1 .ap_99
    s_waitcnt vmcnt(5)
    s_cmpk_ge_u32 s8, 1936
    s_cbranch_scc1 .ap_99
    s_waitcnt vmcnt(3)
    s_bitcmp1_b64 s[14:15], 56
    s_cbranch_scc0 1
    s_waitcnt vmcnt(2)
    s_cmpk_ge_u32 s8, 1861
    s_cbranch_scc1 .ap_99
    s_waitcnt vmcnt(1)
.ap_99:
    s_add_u32 s63, s69, 393216
    buffer_load_dwordx4 v[36:39], v2, s[44:47], s63 offen nt
    s_memrealtime s[8:9]
    s_waitcnt vmcnt(8)
    s_waitcnt lgkmcnt(0)
    s_sub_u32 s8, s8, s30
    s_cmpk_ge_u32 s8, 2032
    s_cbranch_scc1 .ap_100
    s_waitcnt vmcnt(5)
    s_cmpk_ge_u32 s8, 1967
    s_cbranch_scc1 .ap_100
    s_waitcnt vmcnt(3)
    s_bitcmp1_b64 s[14:15], 57
    s_cbranch_scc0 1
    s_waitcnt vmcnt(2)
    s_cmpk_ge_u32 s8, 1892
    s_cbranch_scc1 .ap_100
    s_waitcnt vmcnt(1)
.ap_100:
    s_add_u32 s63, s69, 401408
    buffer_load_dwordx4 v[44:47], v2, s[44:47], s63 offen nt
    s_memrealtime s[8:9]
    s_waitcnt vmcnt(8)
    s_waitcnt lgkmcnt(0)
    s_sub_u32 s8, s8, s30
    s_cmpk_ge_u32 s8, 2063
    s_cbranch_scc1 .ap_101
    s_waitcnt vmcnt(5)
    s_cmpk_ge_u32 s8, 1998
    s_cbranch_scc1 .ap_101
    s_waitcnt vmcnt(3)
    s_bitcmp1_b64 s[14:15], 58
    s_cbranch_scc0 1
    s_waitcnt vmcnt(2)
    s_cmpk_ge_u32 s8, 1923
    s_cbranch_scc1 .ap_101
    s_waitcnt vmcnt(1)
.ap_101:
    s_add_u32 s63, s69, 409600
    buffer_load_dwordx4 v[52:55], v2, s[44:47], s63 offen nt
    s_waitcnt vmcnt(5)
    s_branch .gpc_103
.gp_102:
    buffer_load_dwordx4 v[24:27], v9, s[36:39], s59 offen offset:0 sc1
    s_waitcnt vmcnt(0)
.gpc_103:
    v_cmp_eq_u32 vcc, s34, v26
    v_cmp_eq_u32 s[56:57], s34, v27
    s_and_b64 vcc, vcc, s[56:57]
    s_cmp_eq_u64 vcc, exec
    s_nop 2
    s_cbranch_scc1 .gpd_104
    s_sub_u32 s35, s35, 1
    s_cbranch_scc1 .Lexit
    s_sleep 1
    s_branch .gp_102
.gpd_104:
    s_lshr_b64 s[88:89], s[88:89], s1
    s_and_b32 s88, s88, 0xff
    s_cmp_eq_u32 s88, 32
    s_cselect_b32 s0, 0xac000, 0
    v_mov_b32 v16, v24
    s_nop 1
    v_max_f32_dpp v16, v16, v16 quad_perm:[2,3,0,1] row_mask:0xf bank_mask:0xf
    v_sub_f32 v17, v24, v16
    v_sub_f32 v18, v14, v16
    v_mul_f32 v17, 0x3fb8aa3b, v17
    v_mul_f32 v18, 0x3fb8aa3b, v18
    v_exp_f32 v17, v17
    v_exp_f32 v18, v18
    v_mul_f32 v17, v17, v25
    s_nop 1
    v_add_f32_dpp v17, v17, v17 quad_perm:[2,3,0,1] row_mask:0xf bank_mask:0xf
    v_rcp_f32 v19, v17
    s_nop 0
    v_fma_f32 v15, -v17, v19, 1.0
    v_fma_f32 v19, v15, v19, v19
    v_mul_f32 v18, v18, v19
    v_mul_f32 v10, v10, v18
    v_mul_f32 v11, v11, v18
    v_mul_f32 v12, v12, v18
    v_mul_f32 v13, v13, v18
    v_mov_b32_dpp v112, v10 quad_perm:[2,3,0,1] row_mask:0xf bank_mask:0xf
    v_mov_b32_dpp v113, v11 quad_perm:[2,3,0,1] row_mask:0xf bank_mask:0xf
    v_mov_b32_dpp v114, v12 quad_perm:[2,3,0,1] row_mask:0xf bank_mask:0xf
    v_mov_b32_dpp v115, v13 quad_perm:[2,3,0,1] row_mask:0xf bank_mask:0xf
    v_cvt_pk_bf16_f32 v96, v10, v112
    v_cvt_pk_bf16_f32 v100, v11, v113
    v_cvt_pk_bf16_f32 v104, v12, v114
    v_cvt_pk_bf16_f32 v108, v13, v115
    v_mov_b32_dpp v97, v96 row_ror:12 row_mask:0xf bank_mask:0xf
    v_mov_b32_dpp v101, v100 row_ror:12 row_mask:0xf bank_mask:0xf
    v_mov_b32_dpp v105, v104 row_ror:12 row_mask:0xf bank_mask:0xf
    v_mov_b32_dpp v109, v108 row_ror:12 row_mask:0xf bank_mask:0xf
    v_mov_b32_dpp v98, v96 row_ror:8 row_mask:0xf bank_mask:0xf
    v_mov_b32_dpp v102, v100 row_ror:8 row_mask:0xf bank_mask:0xf
    v_mov_b32_dpp v106, v104 row_ror:8 row_mask:0xf bank_mask:0xf
    v_mov_b32_dpp v110, v108 row_ror:8 row_mask:0xf bank_mask:0xf
    v_mov_b32_dpp v99, v96 row_ror:4 row_mask:0xf bank_mask:0xf
    v_mov_b32_dpp v103, v100 row_ror:4 row_mask:0xf bank_mask:0xf
    v_mov_b32_dpp v107, v104 row_ror:4 row_mask:0xf bank_mask:0xf
    v_mov_b32_dpp v111, v108 row_ror:4 row_mask:0xf bank_mask:0xf
    v_mov_b32_dpp v96, v96 row_shr:3 row_mask:0xf bank_mask:0x2
    v_mov_b32_dpp v97, v97 row_shr:3 row_mask:0xf bank_mask:0x2
    v_mov_b32_dpp v98, v98 row_shr:3 row_mask:0xf bank_mask:0x2
    v_mov_b32_dpp v99, v99 row_shr:3 row_mask:0xf bank_mask:0x2
    v_mov_b32_dpp v100, v100 row_shr:3 row_mask:0xf bank_mask:0x2
    v_mov_b32_dpp v101, v101 row_shr:3 row_mask:0xf bank_mask:0x2
    v_mov_b32_dpp v102, v102 row_shr:3 row_mask:0xf bank_mask:0x2
    v_mov_b32_dpp v103, v103 row_shr:3 row_mask:0xf bank_mask:0x2
    v_mov_b32_dpp v104, v104 row_shr:3 row_mask:0xf bank_mask:0x2
    v_mov_b32_dpp v105, v105 row_shr:3 row_mask:0xf bank_mask:0x2
    v_mov_b32_dpp v106, v106 row_shr:3 row_mask:0xf bank_mask:0x2
    v_mov_b32_dpp v107, v107 row_shr:3 row_mask:0xf bank_mask:0x2
    v_mov_b32_dpp v108, v108 row_shr:3 row_mask:0xf bank_mask:0x2
    v_mov_b32_dpp v109, v109 row_shr:3 row_mask:0xf bank_mask:0x2
    v_mov_b32_dpp v110, v110 row_shr:3 row_mask:0xf bank_mask:0x2
    v_mov_b32_dpp v111, v111 row_shr:3 row_mask:0xf bank_mask:0x2
    s_memrealtime s[8:9]
    s_waitcnt lgkmcnt(0)
    s_sub_u32 s8, s8, s30
    s_cmpk_ge_u32 s8, 2094
    s_cbranch_scc1 .ap_105
    s_waitcnt vmcnt(5)
    s_cmpk_ge_u32 s8, 2029
    s_cbranch_scc1 .ap_105
    s_waitcnt vmcnt(3)
    s_bitcmp1_b64 s[14:15], 59
    s_cbranch_scc0 1
    s_waitcnt vmcnt(2)
    s_cmpk_ge_u32 s8, 1954
    s_cbranch_scc1 .ap_105
    s_waitcnt vmcnt(1)
.ap_105:
    s_add_u32 s63, s69, 417792
    buffer_load_dwordx4 v[60:63], v2, s[44:47], s63 offen nt
    s_lshl_b32 s60, s3, 10
    s_add_u32 s60, s60, 132096
    v_lshlrev_b32 v10, 5, v0
    v_add_u32 v10, s60, v10
    v_lshrrev_b32 v11, 5, v0
    v_lshlrev_b32 v11, 13, v11
    v_and_b32 v12, 31, v0
    v_lshl_add_u32 v11, v12, 4, v11
    v_add_u32 v9, 132096, v2
    v_mov_b32 v15, s34
    v_lshrrev_b32 v25, 4, v0
    v_bfe_u32 v26, v0, 2, 2
    v_lshl_add_u32 v16, v25, 3, v26
    v_lshlrev_b32 v16, 7, v16
    v_and_b32 v25, 1, v25
    v_lshrrev_b32 v26, 1, v26
    v_lshl_add_u32 v25, v25, 1, v26
    s_and_b32 s56, s3, 1
    s_lshl_b32 s56, s56, 1
    v_xor_b32 v25, s56, v25
    v_and_b32 v26, 3, v0
    v_lshl_add_u32 v16, v26, 3, v16
    s_lshr_b32 s56, s3, 1
    s_mul_i32 s56, s56, 16384
    v_add_u32 v16, s56, v16
    v_xor_b32 v26, 1, v25
    v_lshl_add_u32 v17, v26, 5, v16
    v_lshl_add_u32 v16, v25, 5, v16
    v_bfe_u32 v25, v0, 1, 3
    v_mul_u32_u24 v19, 1312, v25
    v_mul_u32_u24 v20, 272, v25
    v_and_b32 v25, 48, v0
    s_lshr_b32 s56, s3, 1
    s_mul_i32 s57, s56, 256
    s_add_u32 s57, s57, 147456
    v_add3_u32 v19, v19, v25, s57
    s_mul_i32 s56, s56, 2176
    s_and_b32 s57, s3, 1
    s_lshl_b32 s57, s57, 7
    s_add_u32 s56, s56, s57
    s_add_u32 s56, s56, 122880
    v_add3_u32 v20, v20, v25, s56
    v_and_b32 v25, 1, v0
    v_lshl_add_u32 v20, v25, 6, v20
    v_and_b32 v25, 15, v0
    s_mul_i32 s56, s3, 272
    s_add_u32 s56, s56, 122880
    v_lshl_add_u32 v21, v25, 4, s56
    s_mul_i32 s56, s3, 1312
    s_add_u32 s56, s56, 147456
    v_add_u32 v18, s56, v3
    v_add_u32 v7, 16384, v11
    s_nop 1
    s_branch .gpc_107
.gp_106:
    buffer_load_dwordx2 v[72:73], v6, s[36:39], s101 offen offset:0 sc1
    s_waitcnt vmcnt(0)
.gpc_107:
    v_cmp_eq_u32 vcc, s34, v73
    s_cmp_eq_u64 vcc, exec
    s_nop 3
    s_cbranch_scc1 .gpd_108
    s_sub_u32 s35, s35, 1
    s_cbranch_scc1 .Lexit
    s_sleep 2
    s_branch .gp_106
.gpd_108:
    v_lshlrev_b32 v23, 16, v72
    v_and_b32 v72, 0xffff0000, v72
    s_mov_b32 vcc_lo, 0xffff0000
    s_mov_b32 vcc_hi, 0xffff0000
    v_cndmask_b32 v23, v23, v72, vcc
    v_lshlrev_b32 v29, 16, v29
    s_memrealtime s[8:9]
    s_waitcnt lgkmcnt(0)
    s_sub_u32 s8, s8, s30
    s_cmpk_ge_u32 s8, 2125
    s_cbranch_scc1 .ap_109
    s_waitcnt vmcnt(5)
    s_cmpk_ge_u32 s8, 2060
    s_cbranch_scc1 .ap_109
    s_waitcnt vmcnt(3)
    s_bitcmp1_b64 s[14:15], 60
    s_cbranch_scc0 1
    s_waitcnt vmcnt(2)
    s_cmpk_ge_u32 s8, 1985
    s_cbranch_scc1 .ap_109
    s_waitcnt vmcnt(1)
.ap_109:
    s_add_u32 s63, s69, 425984
    buffer_load_dwordx4 v[68:71], v2, s[44:47], s63 offen nt
    v_perm_b32 v112, v164, v160, s94
    v_perm_b32 v113, v172, v168, s94
    v_perm_b32 v114, v180, v176, s94
    v_perm_b32 v115, v188, v184, s94
    s_nop 1
    v_mfma_f32_16x16x32_bf16 v[128:131], v[96:99], v[112:115], 0
    v_perm_b32 v116, v164, v160, s95
    v_perm_b32 v117, v172, v168, s95
    v_perm_b32 v118, v180, v176, s95
    v_perm_b32 v119, v188, v184, s95
    s_nop 1
    v_mfma_f32_16x16x32_bf16 v[132:135], v[96:99], v[116:119], 0
    v_perm_b32 v120, v165, v161, s94
    v_perm_b32 v121, v173, v169, s94
    v_perm_b32 v122, v181, v177, s94
    v_perm_b32 v123, v189, v185, s94
    s_nop 1
    v_mfma_f32_16x16x32_bf16 v[136:139], v[96:99], v[120:123], 0
    v_perm_b32 v124, v165, v161, s95
    v_perm_b32 v125, v173, v169, s95
    v_perm_b32 v126, v181, v177, s95
    v_perm_b32 v127, v189, v185, s95
    s_nop 1
    v_mfma_f32_16x16x32_bf16 v[140:143], v[96:99], v[124:127], 0
    v_perm_b32 v112, v166, v162, s94
    v_perm_b32 v113, v174, v170, s94
    v_perm_b32 v114, v182, v178, s94
    v_perm_b32 v115, v190, v186, s94
    s_nop 1
    v_mfma_f32_16x16x32_bf16 v[144:147], v[96:99], v[112:115], 0
    v_perm_b32 v116, v166, v162, s95
    v_perm_b32 v117, v174, v170, s95
    v_perm_b32 v118, v182, v178, s95
    v_perm_b32 v119, v190, v186, s95
    s_nop 1
    v_mfma_f32_16x16x32_bf16 v[148:151], v[96:99], v[116:119], 0
    v_perm_b32 v120, v167, v163, s94
    v_perm_b32 v121, v175, v171, s94
    v_perm_b32 v122, v183, v179, s94
    v_perm_b32 v123, v191, v187, s94
    s_nop 1
    v_mfma_f32_16x16x32_bf16 v[152:155], v[96:99], v[120:123], 0
    v_perm_b32 v124, v167, v163, s95
    v_perm_b32 v125, v175, v171, s95
    v_perm_b32 v126, v183, v179, s95
    v_perm_b32 v127, v191, v187, s95
    s_nop 1
    v_mfma_f32_16x16x32_bf16 v[156:159], v[96:99], v[124:127], 0
    s_memrealtime s[8:9]
    s_waitcnt lgkmcnt(0)
    s_sub_u32 s8, s8, s30
    s_cmpk_ge_u32 s8, 2156
    s_nop 3
    s_cbranch_scc1 .ap_110
    s_waitcnt vmcnt(5)
    s_cmpk_ge_u32 s8, 2091
    s_cbranch_scc1 .ap_110
    s_waitcnt vmcnt(3)
    s_bitcmp1_b64 s[14:15], 61
    s_cbranch_scc0 1
    s_waitcnt vmcnt(2)
    s_cmpk_ge_u32 s8, 2016
    s_cbranch_scc1 .ap_110
    s_waitcnt vmcnt(1)
.ap_110:
    s_add_u32 s63, s69, 434176
    buffer_load_dwordx4 v[76:79], v2, s[44:47], s63 offen nt
    v_perm_b32 v112, v196, v192, s94
    v_perm_b32 v113, v204, v200, s94
    v_perm_b32 v114, v212, v208, s94
    v_perm_b32 v115, v220, v216, s94
    s_nop 1
    v_mfma_f32_16x16x32_bf16 v[128:131], v[100:103], v[112:115], v[128:131]
    v_perm_b32 v116, v196, v192, s95
    v_perm_b32 v117, v204, v200, s95
    v_perm_b32 v118, v212, v208, s95
    v_perm_b32 v119, v220, v216, s95
    s_nop 1
    v_mfma_f32_16x16x32_bf16 v[132:135], v[100:103], v[116:119], v[132:135]
    v_perm_b32 v120, v197, v193, s94
    v_perm_b32 v121, v205, v201, s94
    v_perm_b32 v122, v213, v209, s94
    v_perm_b32 v123, v221, v217, s94
    s_nop 1
    v_mfma_f32_16x16x32_bf16 v[136:139], v[100:103], v[120:123], v[136:139]
    v_perm_b32 v124, v197, v193, s95
    v_perm_b32 v125, v205, v201, s95
    v_perm_b32 v126, v213, v209, s95
    v_perm_b32 v127, v221, v217, s95
    s_nop 1
    v_mfma_f32_16x16x32_bf16 v[140:143], v[100:103], v[124:127], v[140:143]
    v_perm_b32 v112, v198, v194, s94
    v_perm_b32 v113, v206, v202, s94
    v_perm_b32 v114, v214, v210, s94
    v_perm_b32 v115, v222, v218, s94
    s_nop 1
    v_mfma_f32_16x16x32_bf16 v[144:147], v[100:103], v[112:115], v[144:147]
    v_perm_b32 v116, v198, v194, s95
    v_perm_b32 v117, v206, v202, s95
    v_perm_b32 v118, v214, v210, s95
    v_perm_b32 v119, v222, v218, s95
    s_nop 1
    v_mfma_f32_16x16x32_bf16 v[148:151], v[100:103], v[116:119], v[148:151]
    v_perm_b32 v120, v199, v195, s94
    v_perm_b32 v121, v207, v203, s94
    v_perm_b32 v122, v215, v211, s94
    v_perm_b32 v123, v223, v219, s94
    s_nop 1
    v_mfma_f32_16x16x32_bf16 v[152:155], v[100:103], v[120:123], v[152:155]
    v_perm_b32 v124, v199, v195, s95
    v_perm_b32 v125, v207, v203, s95
    v_perm_b32 v126, v215, v211, s95
    v_perm_b32 v127, v223, v219, s95
    s_nop 1
    v_mfma_f32_16x16x32_bf16 v[156:159], v[100:103], v[124:127], v[156:159]
    s_memrealtime s[8:9]
    s_waitcnt lgkmcnt(0)
    s_sub_u32 s8, s8, s30
    s_cmpk_ge_u32 s8, 2187
    s_nop 3
    s_cbranch_scc1 .ap_111
    s_waitcnt vmcnt(5)
    s_cmpk_ge_u32 s8, 2122
    s_cbranch_scc1 .ap_111
    s_waitcnt vmcnt(3)
    s_bitcmp1_b64 s[14:15], 62
    s_cbranch_scc0 1
    s_waitcnt vmcnt(2)
    s_cmpk_ge_u32 s8, 2047
    s_cbranch_scc1 .ap_111
    s_waitcnt vmcnt(1)
.ap_111:
    s_add_u32 s63, s69, 442368
    buffer_load_dwordx4 v[84:87], v2, s[44:47], s63 offen nt
    s_waitcnt vmcnt(7)
    v_perm_b32 v112, v228, v224, s94
    v_perm_b32 v113, v236, v232, s94
    v_perm_b32 v114, v244, v240, s94
    v_perm_b32 v115, v252, v248, s94
    s_nop 1
    v_mfma_f32_16x16x32_bf16 v[128:131], v[104:107], v[112:115], v[128:131]
    v_perm_b32 v116, v228, v224, s95
    v_perm_b32 v117, v236, v232, s95
    v_perm_b32 v118, v244, v240, s95
    v_perm_b32 v119, v252, v248, s95
    s_nop 1
    v_mfma_f32_16x16x32_bf16 v[132:135], v[104:107], v[116:119], v[132:135]
    v_perm_b32 v120, v229, v225, s94
    v_perm_b32 v121, v237, v233, s94
    v_perm_b32 v122, v245, v241, s94
    v_perm_b32 v123, v253, v249, s94
    s_nop 1
    v_mfma_f32_16x16x32_bf16 v[136:139], v[104:107], v[120:123], v[136:139]
    v_perm_b32 v124, v229, v225, s95
    v_perm_b32 v125, v237, v233, s95
    v_perm_b32 v126, v245, v241, s95
    v_perm_b32 v127, v253, v249, s95
    s_nop 1
    v_mfma_f32_16x16x32_bf16 v[140:143], v[104:107], v[124:127], v[140:143]
    v_perm_b32 v112, v230, v226, s94
    v_perm_b32 v113, v238, v234, s94
    v_perm_b32 v114, v246, v242, s94
    v_perm_b32 v115, v254, v250, s94
    s_nop 1
    v_mfma_f32_16x16x32_bf16 v[144:147], v[104:107], v[112:115], v[144:147]
    v_perm_b32 v116, v230, v226, s95
    v_perm_b32 v117, v238, v234, s95
    v_perm_b32 v118, v246, v242, s95
    v_perm_b32 v119, v254, v250, s95
    s_nop 1
    v_mfma_f32_16x16x32_bf16 v[148:151], v[104:107], v[116:119], v[148:151]
    v_perm_b32 v120, v231, v227, s94
    v_perm_b32 v121, v239, v235, s94
    v_perm_b32 v122, v247, v243, s94
    v_perm_b32 v123, v255, v251, s94
    s_nop 1
    v_mfma_f32_16x16x32_bf16 v[152:155], v[104:107], v[120:123], v[152:155]
    v_perm_b32 v124, v231, v227, s95
    v_perm_b32 v125, v239, v235, s95
    v_perm_b32 v126, v247, v243, s95
    v_perm_b32 v127, v255, v251, s95
    s_nop 1
    v_mfma_f32_16x16x32_bf16 v[156:159], v[104:107], v[124:127], v[156:159]
    s_memrealtime s[8:9]
    s_waitcnt lgkmcnt(0)
    s_sub_u32 s8, s8, s30
    s_cmpk_ge_u32 s8, 2218
    s_nop 3
    s_cbranch_scc1 .ap_112
    s_waitcnt vmcnt(5)
    s_cmpk_ge_u32 s8, 2153
    s_cbranch_scc1 .ap_112
    s_waitcnt vmcnt(3)
    s_bitcmp1_b64 s[14:15], 63
    s_cbranch_scc0 1
    s_waitcnt vmcnt(2)
    s_cmpk_ge_u32 s8, 2078
    s_cbranch_scc1 .ap_112
    s_waitcnt vmcnt(1)
.ap_112:
    s_add_u32 s63, s69, 450560
    buffer_load_dwordx4 v[92:95], v2, s[44:47], s63 offen nt
    s_setprio 0
    s_waitcnt vmcnt(6)
    v_perm_b32 v160, v44, v36, s94
    v_perm_b32 v164, v44, v36, s95
    v_perm_b32 v168, v45, v37, s94
    v_perm_b32 v172, v45, v37, s95
    v_perm_b32 v176, v46, v38, s94
    v_perm_b32 v180, v46, v38, s95
    v_perm_b32 v184, v47, v39, s94
    v_perm_b32 v188, v47, v39, s95
    s_waitcnt vmcnt(4)
    v_perm_b32 v161, v60, v52, s94
    v_perm_b32 v165, v60, v52, s95
    v_perm_b32 v169, v61, v53, s94
    v_perm_b32 v173, v61, v53, s95
    v_perm_b32 v177, v62, v54, s94
    v_perm_b32 v181, v62, v54, s95
    v_perm_b32 v185, v63, v55, s94
    v_perm_b32 v189, v63, v55, s95
    v_mfma_f32_16x16x16_bf16 v[128:131], v[108:109], v[160:161], v[128:131]
    v_mfma_f32_16x16x16_bf16 v[132:135], v[108:109], v[164:165], v[132:135]
    v_mfma_f32_16x16x16_bf16 v[136:139], v[108:109], v[168:169], v[136:139]
    v_mfma_f32_16x16x16_bf16 v[140:143], v[108:109], v[172:173], v[140:143]
    v_mfma_f32_16x16x16_bf16 v[144:147], v[108:109], v[176:177], v[144:147]
    v_mfma_f32_16x16x16_bf16 v[148:151], v[108:109], v[180:181], v[148:151]
    v_mfma_f32_16x16x16_bf16 v[152:155], v[108:109], v[184:185], v[152:155]
    v_mfma_f32_16x16x16_bf16 v[156:159], v[108:109], v[188:189], v[156:159]
    s_waitcnt vmcnt(2)
    v_perm_b32 v162, v76, v68, s94
    v_perm_b32 v166, v76, v68, s95
    v_perm_b32 v170, v77, v69, s94
    v_perm_b32 v174, v77, v69, s95
    v_perm_b32 v178, v78, v70, s94
    v_perm_b32 v182, v78, v70, s95
    v_perm_b32 v186, v79, v71, s94
    v_perm_b32 v190, v79, v71, s95
    s_lshl4_add_u32 s59, s67, s66
    s_lshl1_add_u32 s59, s59, s68
    s_lshl_b32 s59, s59, 9
    s_add_u32 s59, s59, 0x210000
    s_mov_b32 s60, 0x07060503
    s_mov_b32 s61, 0x07060502
    s_mov_b32 s62, 0x07060501
.Ltail_ar:
    s_waitcnt vmcnt(0)
    v_perm_b32 v163, v92, v84, s94
    v_perm_b32 v167, v92, v84, s95
    v_perm_b32 v171, v93, v85, s94
    v_perm_b32 v175, v93, v85, s95
    v_perm_b32 v179, v94, v86, s94
    v_perm_b32 v183, v94, v86, s95
    v_perm_b32 v187, v95, v87, s94
    v_perm_b32 v191, v95, v87, s95
    v_mfma_f32_16x16x16_bf16 v[128:131], v[110:111], v[162:163], v[128:131]
    v_mfma_f32_16x16x16_bf16 v[132:135], v[110:111], v[166:167], v[132:135]
    v_mfma_f32_16x16x16_bf16 v[136:139], v[110:111], v[170:171], v[136:139]
    v_mfma_f32_16x16x16_bf16 v[140:143], v[110:111], v[174:175], v[140:143]
    v_mfma_f32_16x16x16_bf16 v[144:147], v[110:111], v[178:179], v[144:147]
    v_mfma_f32_16x16x16_bf16 v[148:151], v[110:111], v[182:183], v[148:151]
    v_mfma_f32_16x16x16_bf16 v[152:155], v[110:111], v[186:187], v[152:155]
    v_mfma_f32_16x16x16_bf16 v[156:159], v[110:111], v[190:191], v[156:159]
    s_mov_b64 exec, 0xffffffff
    s_nop 0
    ds_write2_b32 v10, v128, v132 offset0:0 offset1:1
    s_nop 0
    ds_write2_b32 v10, v136, v140 offset0:2 offset1:3
    s_nop 0
    ds_write2_b32 v10, v144, v148 offset0:4 offset1:5
    s_nop 0
    ds_write2_b32 v10, v152, v156 offset0:6 offset1:7
    s_mov_b64 exec, -1
    s_waitcnt lgkmcnt(0)
    s_barrier
    s_cmp_lg_u32 s3, 7
    s_cbranch_scc1 .opub_113
    ds_read_b128 v[196:199], v9 offset:0
    ds_read_b128 v[200:203], v9 offset:1024
    ds_read_b128 v[204:207], v9 offset:2048
    ds_read_b128 v[208:211], v9 offset:3072
    ds_read_b128 v[212:215], v9 offset:4096
    ds_read_b128 v[216:219], v9 offset:5120
    ds_read_b128 v[220:223], v9 offset:6144
    ds_read_b128 v[224:227], v9 offset:7168
    s_waitcnt lgkmcnt(6)
    v_pk_add_f32 v[196:197], v[196:197], v[200:201]
    v_pk_add_f32 v[198:199], v[198:199], v[202:203]
    s_waitcnt lgkmcnt(4)
    v_pk_add_f32 v[204:205], v[204:205], v[208:209]
    v_pk_add_f32 v[206:207], v[206:207], v[210:211]
    v_pk_add_f32 v[196:197], v[196:197], v[204:205]
    v_pk_add_f32 v[198:199], v[198:199], v[206:207]
    s_waitcnt lgkmcnt(2)
    v_pk_add_f32 v[212:213], v[212:213], v[216:217]
    v_pk_add_f32 v[214:215], v[214:215], v[218:219]
    s_waitcnt lgkmcnt(0)
    v_pk_add_f32 v[220:221], v[220:221], v[224:225]
    v_pk_add_f32 v[222:223], v[222:223], v[226:227]
    v_pk_add_f32 v[212:213], v[212:213], v[220:221]
    v_pk_add_f32 v[214:215], v[214:215], v[222:223]
    v_pk_add_f32 v[196:197], v[196:197], v[212:213]
    v_pk_add_f32 v[198:199], v[198:199], v[214:215]
    v_perm_b32 v12, v196, v199, s60
    v_perm_b32 v13, v197, v199, s61
    v_perm_b32 v14, v198, v199, s62
    s_add_u32 s57, s59, 0xac000
    buffer_store_dwordx4 v[12:15], v11, s[36:39], s57 offen
    buffer_store_dwordx4 v[12:15], v11, s[36:39], s59 offen sc1
.opub_113:
    ds_read_b64_tr_b16 v[160:161], v16 offset:0
    ds_read_b64_tr_b16 v[162:163], v16 offset:512
    ds_read_b64_tr_b16 v[176:177], v17 offset:0
    ds_read_b64_tr_b16 v[178:179], v17 offset:512
    ds_read_b64_tr_b16 v[164:165], v16 offset:4096
    ds_read_b64_tr_b16 v[166:167], v16 offset:4608
    ds_read_b64_tr_b16 v[180:181], v17 offset:4096
    ds_read_b64_tr_b16 v[182:183], v17 offset:4608
    ds_read_b64_tr_b16 v[168:169], v16 offset:8192
    ds_read_b64_tr_b16 v[170:171], v16 offset:8704
    ds_read_b64_tr_b16 v[184:185], v17 offset:8192
    ds_read_b64_tr_b16 v[186:187], v17 offset:8704
    ds_read_b64_tr_b16 v[172:173], v16 offset:12288
    ds_read_b64_tr_b16 v[174:175], v16 offset:12800
    ds_read_b64_tr_b16 v[188:189], v17 offset:12288
    ds_read_b64_tr_b16 v[190:191], v17 offset:12800
    s_lshl_b32 s59, s64, 5
    s_add_u32 s59, s59, s3
    s_lshl_b32 s59, s59, 10
    s_add_u32 s59, s59, 0x210000
    s_mov_b32 s60, 0x04000c0c
    s_mov_b32 s61, 0x0706000c
    v_mov_b32 v143, s34
    s_mul_i32 s40, s3, 9
    s_add_u32 s40, s40, s65
    s_lshl_b32 s40, s40, 11
    s_add_u32 s41, s40, 0x368000
    s_lshl_b32 s63, s64, 8
    s_add_u32 s63, s63, s41
    s_mul_i32 s101, s64, 18432
    s_mul_i32 s56, s3, 2304
    s_add_u32 s101, s101, s56
    s_add_u32 s101, s101, 0x250000
    s_lshl_b32 s42, s65, 8
    s_add_u32 s42, s42, s101
    v_mov_b32 v253, s34
    v_mov_b32 v255, s34
    s_add_u32 s58, s59, s0
    s_mov_b32 s32, 0
    s_mov_b64 s[88:89], exec
    s_mov_b64 s[90:91], exec
    s_mov_b64 s[92:93], exec
    s_mov_b64 s[56:57], exec
.mp_114:
    s_mov_b64 exec, s[88:89]
    buffer_load_dwordx4 v[192:195], v11, s[36:39], s58 offen offset:0 sc1
    s_mov_b64 exec, s[90:91]
    buffer_load_dwordx4 v[196:199], v11, s[36:39], s58 offen offset:512 sc1
    s_mov_b64 exec, s[92:93]
    buffer_load_dwordx4 v[200:203], v7, s[36:39], s58 offen offset:0 sc1
    s_mov_b64 exec, s[56:57]
    buffer_load_dwordx4 v[204:207], v7, s[36:39], s58 offen offset:512 sc1
    s_mov_b64 exec, -1
    s_sub_u32 s35, s35, 1
    s_cbranch_scc1 .Lexit
    s_add_u32 s32, s32, 1
    s_cmp_eq_u32 s32, 64
    s_cselect_b32 s58, s59, s58
    s_waitcnt vmcnt(0)
.mpj_115:
    v_cmp_ne_u32 s[88:89], s34, v195
    v_cmp_ne_u32 s[90:91], s34, v199
    v_cmp_ne_u32 s[92:93], s34, v203
    v_cmp_ne_u32 s[56:57], s34, v207
    s_or_b64 vcc, s[88:89], s[90:91]
    s_or_b64 vcc, vcc, s[92:93]
    s_or_b64 vcc, vcc, s[56:57]
    s_cbranch_scc1 .mp_114
    v_perm_b32 v195, v192, v193, s60
    v_perm_b32 v199, v196, v197, s60
    v_perm_b32 v203, v200, v201, s60
    v_perm_b32 v207, v204, v205, s60
    v_perm_b32 v195, v195, v194, s61
    v_perm_b32 v199, v199, v198, s61
    v_perm_b32 v203, v203, v202, s61
    v_perm_b32 v207, v207, v206, s61
    v_pk_add_f32 v[192:193], v[192:193], v[196:197]
    v_pk_add_f32 v[194:195], v[194:195], v[198:199]
    v_pk_add_f32 v[200:201], v[200:201], v[204:205]
    v_pk_add_f32 v[202:203], v[202:203], v[206:207]
    v_cvt_pk_bf16_f32 v192, v192, v193
    v_cvt_pk_bf16_f32 v193, v194, v195
    v_cvt_pk_bf16_f32 v200, v200, v201
    v_cvt_pk_bf16_f32 v201, v202, v203
    ds_write_b64 v18, v[192:193]
    ds_write_b64 v18, v[200:201] offset:512
    s_waitcnt lgkmcnt(0)
    s_barrier
    ds_read_b128 v[224:227], v19 offset:0
    ds_read_b128 v[228:231], v19 offset:64
    ds_read_b128 v[232:235], v19 offset:128
    ds_read_b128 v[236:239], v19 offset:192
    s_waitcnt lgkmcnt(3)
    v_mfma_f32_16x16x32_bf16 v[132:135], v[160:163], v[224:227], 0
    v_mfma_f32_16x16x32_bf16 v[136:139], v[176:179], v[224:227], 0
    s_waitcnt lgkmcnt(2)
    v_mfma_f32_16x16x32_bf16 v[132:135], v[164:167], v[228:231], v[132:135]
    v_mfma_f32_16x16x32_bf16 v[136:139], v[180:183], v[228:231], v[136:139]
    s_waitcnt lgkmcnt(1)
    v_mfma_f32_16x16x32_bf16 v[132:135], v[168:171], v[232:235], v[132:135]
    v_mfma_f32_16x16x32_bf16 v[136:139], v[184:187], v[232:235], v[136:139]
    s_waitcnt lgkmcnt(0)
    v_mfma_f32_16x16x32_bf16 v[132:135], v[172:175], v[236:239], v[132:135]
    v_mfma_f32_16x16x32_bf16 v[136:139], v[188:191], v[236:239], v[136:139]
    s_nop 7
    v_cndmask_b32 v132, v132, v136, s[96:97]
    v_cndmask_b32 v133, v133, v137, s[96:97]
    v_cndmask_b32 v134, v134, v138, s[96:97]
    v_cndmask_b32 v135, v135, v139, s[96:97]
    ds_write_b128 v20, v[132:135]
    s_waitcnt lgkmcnt(0)
    s_barrier
    ds_read_b128 v[224:227], v21 offset:0
    ds_read_b128 v[228:231], v21 offset:2176
    ds_read_b128 v[232:235], v21 offset:4352
    ds_read_b128 v[236:239], v21 offset:6528
    s_mov_b32 s60, 0x07060503
    s_mov_b32 s61, 0x07060502
    s_mov_b32 s62, 0x07060501
    s_waitcnt lgkmcnt(2)
    v_pk_add_f32 v[224:225], v[224:225], v[228:229]
    v_pk_add_f32 v[226:227], v[226:227], v[230:231]
    s_waitcnt lgkmcnt(0)
    v_pk_add_f32 v[232:233], v[232:233], v[236:237]
    v_pk_add_f32 v[234:235], v[234:235], v[238:239]
    v_pk_add_f32 v[224:225], v[224:225], v[232:233]
    v_pk_add_f32 v[226:227], v[226:227], v[234:235]
    v_perm_b32 v140, v224, v227, s60
    v_perm_b32 v141, v225, v227, s61
    v_perm_b32 v142, v226, v227, s62
    s_mov_b64 exec, 0xffff
    buffer_store_dwordx4 v[140:143], v2, s[36:39], s63 offen sc1
    s_mov_b64 exec, -1
    s_barrier
    s_mov_b32 s60, 0x04000c0c
    s_mov_b32 s61, 0x0706000c
    s_mov_b64 s[88:89], exec
    s_mov_b64 s[90:91], exec
.mp_118:
    s_mov_b64 exec, s[88:89]
    buffer_load_dwordx4 v[108:111], v2, s[36:39], s41 offen offset:0 sc1
    s_mov_b64 exec, s[90:91]
    buffer_load_dwordx4 v[112:115], v2, s[36:39], s41 offen offset:1024 sc1
    s_mov_b64 exec, -1
    s_sub_u32 s35, s35, 1
    s_cbranch_scc1 .Lexit
    s_waitcnt vmcnt(0)
.mpj_119:
    v_cmp_ne_u32 s[88:89], s34, v111
    v_cmp_ne_u32 s[90:91], s34, v115
    s_or_b64 vcc, s[88:89], s[90:91]
    s_cbranch_scc1 .mp_118
    v_perm_b32 v111, v108, v109, s60
    v_perm_b32 v115, v112, v113, s60
    v_perm_b32 v111, v111, v110, s61
    v_perm_b32 v115, v115, v114, s61
    v_pk_add_f32 v[248:249], v[108:109], v[112:113]
    v_pk_add_f32 v[250:251], v[110:111], v[114:115]
    s_nop 1
    v_permlane32_swap_b32 v248, v250
    v_permlane32_swap_b32 v249, v251
    v_pk_add_f32 v[248:249], v[248:249], v[250:251]
    s_nop 1
    v_permlane16_swap_b32 v248, v249
    v_add_f32 v248, v248, v249
    v_cvt_pk_bf16_f32 v248, 0, v248
    v_mul_f32 v248, v248, v23
    v_cvt_pk_bf16_f32 v248, 0, v248
    v_add_f32 v249, v248, v29
    v_add_f32 v248, v248, v29
    v_mov_b32 v24, v248
    s_nop 0
    v_permlane16_swap_b32 v248, v249
    v_cvt_pk_bf16_f32 v252, v248, v249
    v_cvt_pk_bf16_f32 v254, v248, v249
    s_nop 1
    v_permlane32_swap_b32 v252, v254
    s_mov_b64 exec, 0xffff
    s_add_u32 s57, s42, 0xac000
    buffer_store_dwordx4 v[252:255], v2, s[36:39], s57 offen
    buffer_store_dwordx4 v[252:255], v2, s[36:39], s42 offen sc1
    s_mov_b64 exec, -1
    s_cmp_eq_u32 s3, s64
    s_cbranch_scc1 .r2_122
    s_branch .Lexit
.r2_122:
    v_cvt_pk_bf16_f32 v24, 0, v24
    s_nop 1
    s_branch .gpc_124
.gp_123:
    buffer_load_dwordx4 v[32:35], v2, s[36:39], s99 offen offset:0 sc1
    buffer_load_dwordx4 v[40:43], v2, s[36:39], s99 offen offset:1024 sc1
    buffer_load_dwordx2 v[48:49], v5, s[36:39], s99 offen offset:0 sc1
    buffer_load_dwordx4 v[56:59], v2, s[36:39], s100 offen offset:0 sc1
    buffer_load_dwordx4 v[64:67], v2, s[36:39], s100 offen offset:1024 sc1
    buffer_load_dwordx2 v[50:51], v5, s[36:39], s100 offen offset:0 sc1
    buffer_load_dwordx2 v[74:75], v6, s[36:39], s99 offen offset:0 sc1
    buffer_load_dwordx2 v[80:81], v6, s[36:39], s100 offen offset:0 sc1
    buffer_load_dwordx2 v[82:83], v6, s[36:39], s33 offen offset:0 sc1
    s_waitcnt vmcnt(0)
.gpc_124:
    v_min3_u32 v25, v33, v35, v41
    v_max3_u32 v26, v33, v35, v41
    v_min3_u32 v25, v25, v43, v49
    v_max3_u32 v26, v26, v43, v49
    v_min3_u32 v25, v25, v57, v59
    v_max3_u32 v26, v26, v57, v59
    v_min3_u32 v25, v25, v65, v67
    v_max3_u32 v26, v26, v65, v67
    v_min3_u32 v25, v25, v51, v75
    v_max3_u32 v26, v26, v51, v75
    v_min3_u32 v25, v25, v81, v83
    v_max3_u32 v26, v26, v81, v83
    v_cmp_eq_u32 vcc, s34, v25
    v_cmp_eq_u32 s[56:57], s34, v26
    s_and_b64 vcc, vcc, s[56:57]
    s_cmp_eq_u64 vcc, exec
    s_nop 2
    s_cbranch_scc1 .gpd_125
    s_sub_u32 s35, s35, 1
    s_cbranch_scc1 .Lexit
    s_sleep 2
    s_branch .gp_123
.gpd_125:
    v_lshlrev_b32 v160, 16, v32
    v_and_b32 v161, 0xffff0000, v32
    v_lshlrev_b32 v170, 16, v56
    v_and_b32 v171, 0xffff0000, v56
    v_lshlrev_b32 v162, 16, v34
    v_and_b32 v163, 0xffff0000, v34
    v_lshlrev_b32 v172, 16, v58
    v_and_b32 v173, 0xffff0000, v58
    v_lshlrev_b32 v164, 16, v40
    v_and_b32 v165, 0xffff0000, v40
    v_lshlrev_b32 v174, 16, v64
    v_and_b32 v175, 0xffff0000, v64
    v_lshlrev_b32 v166, 16, v42
    v_and_b32 v167, 0xffff0000, v42
    v_lshlrev_b32 v176, 16, v66
    v_and_b32 v177, 0xffff0000, v66
    v_lshlrev_b32 v168, 16, v48
    v_and_b32 v169, 0xffff0000, v48
    v_lshlrev_b32 v178, 16, v50
    v_and_b32 v179, 0xffff0000, v50
    v_lshlrev_b32 v75, 16, v74
    v_and_b32 v74, 0xffff0000, v74
    s_mov_b32 vcc_lo, 0xffff0000
    s_mov_b32 vcc_hi, 0xffff0000
    v_cndmask_b32 v75, v75, v74, vcc
    v_lshlrev_b32 v81, 16, v80
    v_and_b32 v80, 0xffff0000, v80
    s_mov_b32 vcc_lo, 0xffff0000
    s_mov_b32 vcc_hi, 0xffff0000
    v_cndmask_b32 v81, v81, v80, vcc
    v_lshlrev_b32 v83, 16, v82
    v_and_b32 v82, 0xffff0000, v82
    s_mov_b32 vcc_lo, 0xffff0000
    s_mov_b32 vcc_hi, 0xffff0000
    v_cndmask_b32 v83, v83, v82, vcc
    s_waitcnt vmcnt(0)
    s_add_u32 s58, s101, s0
    s_mov_b32 s32, 0
    s_mov_b64 s[88:89], exec
    s_mov_b64 s[90:91], exec
    s_mov_b64 s[92:93], exec
.mp_126:
    s_mov_b64 exec, s[88:89]
    buffer_load_dwordx4 v[180:183], v2, s[36:39], s58 offen offset:0 sc1
    s_mov_b64 exec, s[90:91]
    buffer_load_dwordx4 v[184:187], v2, s[36:39], s58 offen offset:1024 sc1
    s_mov_b64 exec, s[92:93]
    buffer_load_dwordx2 v[188:189], v5, s[36:39], s58 offen offset:0 sc1
    s_mov_b64 exec, -1
    s_sub_u32 s35, s35, 1
    s_cbranch_scc1 .Lexit
    s_add_u32 s32, s32, 1
    s_cmp_eq_u32 s32, 64
    s_cselect_b32 s58, s101, s58
    s_waitcnt vmcnt(0)
.mpj_127:
    v_cmp_ne_u32 s[88:89], s34, v181
    v_cmp_ne_u32 vcc, s34, v183
    s_or_b64 s[88:89], s[88:89], vcc
    v_cmp_ne_u32 s[90:91], s34, v185
    v_cmp_ne_u32 vcc, s34, v187
    s_or_b64 s[90:91], s[90:91], vcc
    v_cmp_ne_u32 s[92:93], s34, v189
    s_or_b64 vcc, s[88:89], s[90:91]
    s_or_b64 vcc, vcc, s[92:93]
    s_cbranch_scc1 .mp_126
    s_mov_b32 s56, 0x3f803f80
    v_dot2_f32_bf16 v200, v180, s56, 0
    v_dot2_f32_bf16 v201, v180, v180, 0
    v_dot2_f32_bf16 v200, v182, s56, v200
    v_dot2_f32_bf16 v201, v182, v182, v201
    v_dot2_f32_bf16 v200, v184, s56, v200
    v_dot2_f32_bf16 v201, v184, v184, v201
    v_dot2_f32_bf16 v200, v186, s56, v200
    v_dot2_f32_bf16 v201, v186, v186, v201
    s_mov_b64 exec, 0xffffffff
    v_dot2_f32_bf16 v200, v188, s56, v200
    v_dot2_f32_bf16 v201, v188, v188, v201
    s_mov_b64 exec, -1
    s_nop 1
    v_permlane32_swap_b32 v200, v201
    v_add_f32 v200, v200, v201
    v_mov_b32 v202, v200
    s_nop 1
    v_permlane16_swap_b32 v202, v200
    v_add_f32 v200, v202, v200
    v_lshlrev_b32 v190, 16, v180
    v_and_b32 v191, 0xffff0000, v180
    v_add_f32_dpp v200, v200, v200 row_ror:8 row_mask:0xf bank_mask:0xf
    v_lshlrev_b32 v192, 16, v182
    v_and_b32 v193, 0xffff0000, v182
    v_add_f32_dpp v200, v200, v200 row_ror:4 row_mask:0xf bank_mask:0xf
    v_lshlrev_b32 v194, 16, v184
    v_and_b32 v195, 0xffff0000, v184
    v_add_f32_dpp v200, v200, v200 quad_perm:[2,3,0,1] row_mask:0xf bank_mask:0xf
    v_lshlrev_b32 v196, 16, v186
    v_and_b32 v197, 0xffff0000, v186
    v_add_f32_dpp v200, v200, v200 quad_perm:[1,0,3,2] row_mask:0xf bank_mask:0xf
    v_mul_f32 v200, 0x3ae38e39, v200
    v_lshlrev_b32 v198, 16, v188
    v_and_b32 v199, 0xffff0000, v188
    v_readlane_b32 s56, v200, 0
    v_readlane_b32 s57, v200, 32
    s_nop 0
    v_mov_b32 v200, s56
    v_fma_f32 v201, -v200, v200, s57
    v_max_f32 v201, 0, v201
    v_cvt_pk_bf16_f32 v203, 0, v201
    v_cvt_pk_bf16_f32 v201, 0, -v200
    v_cvt_pk_bf16_f32 v200, 0, -v200
    v_add_f32 v203, 0x3727c5ac, v203
    v_pk_add_f32 v[190:191], v[190:191], v[200:201]
    v_pk_add_f32 v[192:193], v[192:193], v[200:201]
    v_pk_add_f32 v[194:195], v[194:195], v[200:201]
    v_cvt_pk_bf16_f32 v203, 0, v203
    v_pk_add_f32 v[196:197], v[196:197], v[200:201]
    v_pk_add_f32 v[198:199], v[198:199], v[200:201]
    v_cvt_pk_bf16_f32 v190, 0, v190
    v_sqrt_f32 v203, v203
    v_cvt_pk_bf16_f32 v191, 0, v191
    v_cvt_pk_bf16_f32 v192, 0, v192
    v_cvt_pk_bf16_f32 v193, 0, v193
    v_cvt_pk_bf16_f32 v203, 0, v203
    v_cvt_pk_bf16_f32 v194, 0, v194
    v_cvt_pk_bf16_f32 v195, 0, v195
    v_cvt_pk_bf16_f32 v196, 0, v196
    v_rcp_f32 v202, v203
    v_cvt_pk_bf16_f32 v197, 0, v197
    v_cvt_pk_bf16_f32 v198, 0, v198
    v_cvt_pk_bf16_f32 v199, 0, v199
    v_mov_b32 v203, v202
    v_pk_mul_f32 v[190:191], v[190:191], v[202:203]
    v_pk_mul_f32 v[192:193], v[192:193], v[202:203]
    v_pk_mul_f32 v[194:195], v[194:195], v[202:203]
    v_pk_mul_f32 v[196:197], v[196:197], v[202:203]
    v_pk_mul_f32 v[198:199], v[198:199], v[202:203]
    v_cvt_pk_bf16_f32 v190, 0, v190
    v_cvt_pk_bf16_f32 v191, 0, v191
    v_cvt_pk_bf16_f32 v192, 0, v192
    v_cvt_pk_bf16_f32 v193, 0, v193
    v_cvt_pk_bf16_f32 v194, 0, v194
    v_cvt_pk_bf16_f32 v195, 0, v195
    v_cvt_pk_bf16_f32 v196, 0, v196
    v_cvt_pk_bf16_f32 v197, 0, v197
    v_cvt_pk_bf16_f32 v198, 0, v198
    v_cvt_pk_bf16_f32 v199, 0, v199
    v_pk_mul_f32 v[190:191], v[190:191], v[170:171]
    v_pk_mul_f32 v[192:193], v[192:193], v[172:173]
    v_pk_mul_f32 v[194:195], v[194:195], v[174:175]
    v_pk_mul_f32 v[196:197], v[196:197], v[176:177]
    v_pk_mul_f32 v[198:199], v[198:199], v[178:179]
    v_cvt_pk_bf16_f32 v190, 0, v190
    v_cvt_pk_bf16_f32 v191, 0, v191
    v_cvt_pk_bf16_f32 v192, 0, v192
    v_cvt_pk_bf16_f32 v193, 0, v193
    v_cvt_pk_bf16_f32 v194, 0, v194
    v_cvt_pk_bf16_f32 v195, 0, v195
    v_cvt_pk_bf16_f32 v196, 0, v196
    v_cvt_pk_bf16_f32 v197, 0, v197
    v_cvt_pk_bf16_f32 v198, 0, v198
    v_cvt_pk_bf16_f32 v199, 0, v199
    v_pk_add_f32 v[190:191], v[190:191], v[160:161]
    v_pk_add_f32 v[192:193], v[192:193], v[162:163]
    v_pk_add_f32 v[194:195], v[194:195], v[164:165]
    v_pk_add_f32 v[196:197], v[196:197], v[166:167]
    v_pk_add_f32 v[198:199], v[198:199], v[168:169]
    v_cvt_pk_bf16_f32 v206, v190, v191
    v_cvt_pk_bf16_f32 v207, v192, v193
    v_cvt_pk_bf16_f32 v208, v194, v195
    v_cvt_pk_bf16_f32 v209, v196, v197
    v_cvt_pk_bf16_f32 v210, v198, v199
    v_dot2_f32_bf16 v14, v206, v88, 0
    v_dot2_f32_bf16 v14, v207, v89, v14
    v_dot2_f32_bf16 v14, v208, v90, v14
    v_dot2_f32_bf16 v14, v209, v91, v14
    s_mov_b64 exec, 0xffffffff
    v_dot2_f32_bf16 v14, v210, v30, v14
    s_mov_b64 exec, -1
    s_nop 1
    v_mov_b32 v15, v14
    s_nop 1
    v_permlane32_swap_b32 v15, v14
    v_add_f32 v14, v15, v14
    v_mov_b32 v15, v14
    s_nop 1
    v_permlane16_swap_b32 v15, v14
    v_add_f32 v14, v15, v14
    s_nop 1
    v_add_f32_dpp v14, v14, v14 row_ror:8 row_mask:0xf bank_mask:0xf
    s_nop 1
    v_add_f32_dpp v14, v14, v14 row_ror:4 row_mask:0xf bank_mask:0xf
    s_nop 1
    v_add_f32_dpp v14, v14, v14 quad_perm:[2,3,0,1] row_mask:0xf bank_mask:0xf
    s_nop 1
    v_add_f32_dpp v14, v14, v14 quad_perm:[1,0,3,2] row_mask:0xf bank_mask:0xf
    v_cvt_pk_bf16_f32 v14, 0, v14
    v_max_f32 v14, 0xc2ae0000, v14
    v_min_f32 v14, 0x43000000, v14
    v_mul_f32 v15, 0xbfb8aa3b, v14
    v_fma_f32 v16, v14, s98, -v15
    v_fmac_f32 v16, 0xb2a57060, v14
    v_exp_f32 v15, v15
    v_mul_f32 v16, 0x3f317218, v16
    v_fmac_f32 v15, v15, v16
    v_add_f32 v15, 1.0, v15
    v_rcp_f32 v16, v15
    s_nop 0
    v_fma_f32 v15, -v15, v16, 1.0
    v_fma_f32 v14, v15, v16, v16
    v_cvt_pk_bf16_f32 v14, 0, v14
    v_add_f32 v17, v24, v200
    v_cvt_pk_bf16_f32 v17, 0, v17
    v_mul_f32 v17, v17, v202
    v_cvt_pk_bf16_f32 v17, 0, v17
    v_mul_f32 v17, v17, v81
    v_cvt_pk_bf16_f32 v17, 0, v17
    v_add_f32 v17, v17, v75
    v_cvt_pk_bf16_f32 v17, 0, v17
    s_lshl_b32 s59, s40, 1
    s_add_u32 s58, s59, 0x38c000
    s_mov_b32 s60, 0x04000c0c
    s_mov_b32 s61, 0x0706000c
    s_mov_b32 s48, s28
    s_and_b32 s49, s29, 0xffff
    s_mov_b32 s50, 0x2400
    s_mov_b32 s51, 0x00020000
    s_mul_i32 s63, s3, 1152
    s_mov_b64 s[88:89], exec
    s_mov_b64 s[90:91], exec
    s_mov_b64 s[92:93], exec
    s_mov_b64 s[56:57], exec
.mp_130:
    s_mov_b64 exec, s[88:89]
    buffer_load_dwordx4 v[96:99], v2, s[36:39], s58 offen offset:0 sc1
    s_mov_b64 exec, s[90:91]
    buffer_load_dwordx4 v[100:103], v2, s[36:39], s58 offen offset:1024 sc1
    s_mov_b64 exec, s[92:93]
    buffer_load_dwordx4 v[104:107], v2, s[36:39], s58 offen offset:2048 sc1
    s_mov_b64 exec, s[56:57]
    buffer_load_dwordx4 v[108:111], v2, s[36:39], s58 offen offset:3072 sc1
    s_mov_b64 exec, -1
    s_sub_u32 s35, s35, 1
    s_cbranch_scc1 .Lexit
    s_waitcnt vmcnt(0)
.mpj_131:
    v_cmp_ne_u32 s[88:89], s34, v99
    v_cmp_ne_u32 s[90:91], s34, v103
    v_cmp_ne_u32 s[92:93], s34, v107
    v_cmp_ne_u32 s[56:57], s34, v111
    s_or_b64 vcc, s[88:89], s[90:91]
    s_or_b64 vcc, vcc, s[92:93]
    s_or_b64 vcc, vcc, s[56:57]
    s_cbranch_scc1 .mp_130
    v_perm_b32 v99, v96, v97, s60
    v_perm_b32 v103, v100, v101, s60
    v_perm_b32 v107, v104, v105, s60
    v_perm_b32 v111, v108, v109, s60
    v_perm_b32 v99, v99, v98, s61
    v_perm_b32 v103, v103, v102, s61
    v_perm_b32 v107, v107, v106, s61
    v_perm_b32 v111, v111, v110, s61
    v_pk_add_f32 v[96:97], v[96:97], v[100:101]
    v_pk_add_f32 v[98:99], v[98:99], v[102:103]
    v_pk_add_f32 v[248:249], v[104:105], v[108:109]
    v_pk_add_f32 v[250:251], v[106:107], v[110:111]
    v_pk_add_f32 v[248:249], v[248:249], v[96:97]
    v_pk_add_f32 v[250:251], v[250:251], v[98:99]
    s_nop 1
    v_permlane32_swap_b32 v248, v250
    v_permlane32_swap_b32 v249, v251
    v_pk_add_f32 v[248:249], v[248:249], v[250:251]
    s_nop 1
    v_permlane16_swap_b32 v248, v249
    v_add_f32 v248, v248, v249
    v_cvt_pk_bf16_f32 v248, 0, v248
    v_mul_f32 v248, v248, v14
    v_cvt_pk_bf16_f32 v248, 0, v248
    v_add_f32 v248, v248, v17
    v_cvt_pk_bf16_f32 v248, 0, v248
    v_mul_f32 v248, v248, v83
    v_cvt_pk_bf16_f32 v248, 0, v248
    v_add_f32 v248, v248, v24
    v_cvt_pk_bf16_f32 v248, v248, v248
    buffer_store_short v248, v31, s[48:51], s63 offen
    s_cmp_lg_u32 s2, 0
    s_cbranch_scc1 .Lexit
    v_mov_b32 v13, s34
    s_mov_b64 exec, 1
    buffer_store_dword v13, v2, s[36:39], 0 offen
    s_mov_b64 exec, -1
    s_branch .Lexit
.Latt_bc:
    v_and_b32 v8, 1, v0
    v_lshlrev_b32 v8, 8, v8
    v_and_b32 v9, 0x3c, v0
    v_lshl_add_u32 v9, v9, 2, v8
    v_lshlrev_b32 v7, 1, v9
    v_and_b32 v9, 0x3c, v0
    v_lshrrev_b32 v8, 4, v8
    v_and_b32 v9, 2, v0
    v_lshl_add_u32 v9, v9, 6, v8
    s_lshl_b32 s58, s66, 14
    s_lshl_b32 s59, s67, 10
    s_add_u32 s58, s58, s59
    s_add_u32 s58, s58, 0x40000
    s_lshl4_add_u32 s59, s66, s67
    s_lshl_b32 s59, s59, 8
    s_add_u32 s59, s59, 0x200000
    s_memrealtime s[8:9]
    s_waitcnt vmcnt(8)
    s_waitcnt lgkmcnt(0)
    s_sub_u32 s8, s8, s30
    s_cmpk_ge_u32 s8, 1147
    s_cbranch_scc1 .ap_134
    s_waitcnt vmcnt(5)
    s_cmpk_ge_u32 s8, 1082
    s_cbranch_scc1 .ap_134
    s_waitcnt vmcnt(3)
    s_bitcmp1_b64 s[14:15], 26
    s_cbranch_scc0 1
    s_waitcnt vmcnt(2)
    s_cmpk_ge_u32 s8, 1007
    s_cbranch_scc1 .ap_134
    s_waitcnt vmcnt(1)
.ap_134:
    s_add_u32 s63, s69, 409600
    buffer_load_dwordx4 v[88:91], v1, s[40:43], s63 offen nt
    s_memrealtime s[8:9]
    s_waitcnt vmcnt(8)
    s_waitcnt lgkmcnt(0)
    s_sub_u32 s8, s8, s30
    s_cmpk_ge_u32 s8, 1174
    s_cbranch_scc1 .ap_135
    s_waitcnt vmcnt(5)
    s_cmpk_ge_u32 s8, 1109
    s_cbranch_scc1 .ap_135
    s_waitcnt vmcnt(3)
    s_bitcmp1_b64 s[14:15], 27
    s_cbranch_scc0 1
    s_waitcnt vmcnt(2)
    s_cmpk_ge_u32 s8, 1034
    s_cbranch_scc1 .ap_135
    s_waitcnt vmcnt(1)
.ap_135:
    s_add_u32 s63, s69, 417792
    buffer_load_dwordx4 v[92:95], v1, s[40:43], s63 offen nt
    s_memrealtime s[8:9]
    s_waitcnt vmcnt(8)
    s_waitcnt lgkmcnt(0)
    s_sub_u32 s8, s8, s30
    s_cmpk_ge_u32 s8, 1201
    s_cbranch_scc1 .ap_136
    s_waitcnt vmcnt(5)
    s_cmpk_ge_u32 s8, 1136
    s_cbranch_scc1 .ap_136
    s_waitcnt vmcnt(3)
    s_bitcmp1_b64 s[14:15], 28
    s_cbranch_scc0 1
    s_waitcnt vmcnt(2)
    s_cmpk_ge_u32 s8, 1061
    s_cbranch_scc1 .ap_136
    s_waitcnt vmcnt(1)
.ap_136:
    s_add_u32 s63, s69, 425984
    buffer_load_dwordx4 v[120:123], v1, s[40:43], s63 offen nt
    s_memrealtime s[8:9]
    s_waitcnt vmcnt(8)
    s_waitcnt lgkmcnt(0)
    s_sub_u32 s8, s8, s30
    s_cmpk_ge_u32 s8, 1228
    s_cbranch_scc1 .ap_137
    s_waitcnt vmcnt(5)
    s_cmpk_ge_u32 s8, 1163
    s_cbranch_scc1 .ap_137
    s_waitcnt vmcnt(3)
    s_bitcmp1_b64 s[14:15], 29
    s_cbranch_scc0 1
    s_waitcnt vmcnt(2)
    s_cmpk_ge_u32 s8, 1088
    s_cbranch_scc1 .ap_137
    s_waitcnt vmcnt(1)
.ap_137:
    s_add_u32 s63, s69, 434176
    buffer_load_dwordx4 v[124:127], v1, s[40:43], s63 offen nt
    s_memrealtime s[8:9]
    s_waitcnt vmcnt(8)
    s_waitcnt lgkmcnt(0)
    s_sub_u32 s8, s8, s30
    s_cmpk_ge_u32 s8, 1255
    s_cbranch_scc1 .ap_138
    s_waitcnt vmcnt(5)
    s_cmpk_ge_u32 s8, 1190
    s_cbranch_scc1 .ap_138
    s_waitcnt vmcnt(3)
    s_bitcmp1_b64 s[14:15], 30
    s_cbranch_scc0 1
    s_waitcnt vmcnt(2)
    s_cmpk_ge_u32 s8, 1115
    s_cbranch_scc1 .ap_138
    s_waitcnt vmcnt(1)
.ap_138:
    s_add_u32 s63, s69, 442368
    buffer_load_dwordx4 v[152:155], v1, s[40:43], s63 offen nt
    s_memrealtime s[8:9]
    s_waitcnt vmcnt(8)
    s_waitcnt lgkmcnt(0)
    s_sub_u32 s8, s8, s30
    s_cmpk_ge_u32 s8, 1282
    s_cbranch_scc1 .ap_139
    s_waitcnt vmcnt(5)
    s_cmpk_ge_u32 s8, 1217
    s_cbranch_scc1 .ap_139
    s_waitcnt vmcnt(3)
    s_bitcmp1_b64 s[14:15], 31
    s_cbranch_scc0 1
    s_waitcnt vmcnt(2)
    s_cmpk_ge_u32 s8, 1142
    s_cbranch_scc1 .ap_139
    s_waitcnt vmcnt(1)
.ap_139:
    s_add_u32 s63, s69, 450560
    buffer_load_dwordx4 v[156:159], v1, s[40:43], s63 offen nt
    buffer_load_dwordx4 v[16:19], v7, s[36:39], s58 offen offset:0 sc1
    buffer_load_dwordx4 v[20:23], v7, s[36:39], s58 offen offset:16 sc1
    s_memrealtime s[8:9]
    s_waitcnt vmcnt(8)
    s_waitcnt lgkmcnt(0)
    s_sub_u32 s8, s8, s30
    s_cmpk_ge_u32 s8, 1309
    s_cbranch_scc1 .ap_140
    s_waitcnt vmcnt(5)
    s_cmpk_ge_u32 s8, 1244
    s_cbranch_scc1 .ap_140
    s_waitcnt vmcnt(3)
    s_bitcmp1_b64 s[14:15], 32
    s_cbranch_scc0 1
    s_waitcnt vmcnt(2)
    s_cmpk_ge_u32 s8, 1169
    s_cbranch_scc1 .ap_140
    s_waitcnt vmcnt(1)
.ap_140:
    s_add_u32 s63, s69, 0
    buffer_load_dwordx4 v[160:163], v2, s[44:47], s63 offen nt
    s_memrealtime s[8:9]
    s_waitcnt vmcnt(8)
    s_waitcnt lgkmcnt(0)
    s_sub_u32 s8, s8, s30
    s_cmpk_ge_u32 s8, 1336
    s_cbranch_scc1 .ap_141
    s_waitcnt vmcnt(5)
    s_cmpk_ge_u32 s8, 1271
    s_cbranch_scc1 .ap_141
    s_waitcnt vmcnt(3)
    s_bitcmp1_b64 s[14:15], 33
    s_cbranch_scc0 1
    s_waitcnt vmcnt(2)
    s_cmpk_ge_u32 s8, 1196
    s_cbranch_scc1 .ap_141
    s_waitcnt vmcnt(1)
.ap_141:
    s_add_u32 s63, s69, 8192
    buffer_load_dwordx4 v[164:167], v2, s[44:47], s63 offen nt
    s_memrealtime s[8:9]
    s_waitcnt vmcnt(8)
    s_waitcnt lgkmcnt(0)
    s_sub_u32 s8, s8, s30
    s_cmpk_ge_u32 s8, 1363
    s_cbranch_scc1 .ap_142
    s_waitcnt vmcnt(5)
    s_cmpk_ge_u32 s8, 1298
    s_cbranch_scc1 .ap_142
    s_waitcnt vmcnt(3)
    s_bitcmp1_b64 s[14:15], 34
    s_cbranch_scc0 1
    s_waitcnt vmcnt(2)
    s_cmpk_ge_u32 s8, 1223
    s_cbranch_scc1 .ap_142
    s_waitcnt vmcnt(1)
.ap_142:
    s_add_u32 s63, s69, 16384
    buffer_load_dwordx4 v[168:171], v2, s[44:47], s63 offen nt
    s_waitcnt vmcnt(3)
    s_branch .gpc_144
.gp_143:
    buffer_load_dwordx4 v[16:19], v7, s[36:39], s58 offen offset:0 sc1
    buffer_load_dwordx4 v[20:23], v7, s[36:39], s58 offen offset:16 sc1
    s_waitcnt vmcnt(0)
.gpc_144:
    v_min_u32 v10, v17, v19
    v_max_u32 v11, v17, v19
    v_min3_u32 v10, v10, v21, v23
    v_max3_u32 v11, v11, v21, v23
    v_cmp_eq_u32 vcc, s34, v10
    v_cmp_eq_u32 s[56:57], s34, v11
    s_and_b64 vcc, vcc, s[56:57]
    s_cmp_eq_u64 vcc, exec
    s_nop 2
    s_cbranch_scc1 .gpd_145
    s_sub_u32 s35, s35, 1
    s_cbranch_scc1 .Lexit
    s_sleep 1
    s_branch .gp_143
.gpd_145:
    s_mov_b32 vcc_lo, 0xcccccccc
    s_mov_b32 vcc_hi, 0xcccccccc
    v_cndmask_b32_e64 v24, v16, 0, vcc
    v_cndmask_b32_e64 v25, v18, 0, vcc
    v_cndmask_b32_e64 v26, v20, 0, vcc
    v_cndmask_b32_e64 v27, v22, 0, vcc
    v_cndmask_b32_e32 v28, 0, v16, vcc
    v_cndmask_b32_e32 v29, 0, v18, vcc
    v_cndmask_b32_e32 v30, 0, v20, vcc
    v_cndmask_b32_e32 v31, 0, v22, vcc
    v_mfma_f32_16x16x32_bf16 v[16:19], v[32:35], v[24:27], 0
    v_mfma_f32_16x16x32_bf16 v[32:35], v[40:43], v[24:27], 0
    v_mfma_f32_16x16x32_bf16 v[16:19], v[36:39], v[28:31], v[16:19]
    v_mfma_f32_16x16x32_bf16 v[40:43], v[48:51], v[24:27], 0
    v_mfma_f32_16x16x32_bf16 v[32:35], v[44:47], v[28:31], v[32:35]
    v_mfma_f32_16x16x32_bf16 v[48:51], v[56:59], v[24:27], 0
    v_mfma_f32_16x16x32_bf16 v[40:43], v[52:55], v[28:31], v[40:43]
    v_mfma_f32_16x16x32_bf16 v[56:59], v[64:67], v[24:27], 0
    v_mfma_f32_16x16x32_bf16 v[48:51], v[60:63], v[28:31], v[48:51]
    s_nop 1
    v_add_f32_dpp v10, v17, v16 row_ror:12 row_mask:0xf bank_mask:0x1
    s_memrealtime s[8:9]
    s_waitcnt lgkmcnt(0)
    s_sub_u32 s8, s8, s30
    s_cmpk_ge_u32 s8, 1390
    s_nop 0
    s_cbranch_scc1 .ap_146
    s_waitcnt vmcnt(3)
    s_cmpk_ge_u32 s8, 1325
    s_cbranch_scc1 .ap_146
    s_waitcnt vmcnt(3)
    s_bitcmp1_b64 s[14:15], 35
    s_cbranch_scc0 1
    s_waitcnt vmcnt(2)
    s_cmpk_ge_u32 s8, 1250
    s_cbranch_scc1 .ap_146
    s_waitcnt vmcnt(1)
.ap_146:
    s_add_u32 s63, s69, 24576
    buffer_load_dwordx4 v[172:175], v2, s[44:47], s63 offen nt
    v_mfma_f32_16x16x32_bf16 v[64:67], v[72:75], v[24:27], 0
    v_mfma_f32_16x16x32_bf16 v[56:59], v[68:71], v[28:31], v[56:59]
    v_add_f32_dpp v11, v33, v32 row_ror:12 row_mask:0xf bank_mask:0x1
    v_add_f32_dpp v10, v18, v10 row_ror:8 row_mask:0xf bank_mask:0x1
    v_mfma_f32_16x16x32_bf16 v[72:75], v[80:83], v[24:27], 0
    v_mfma_f32_16x16x32_bf16 v[64:67], v[76:79], v[28:31], v[64:67]
    v_add_f32_dpp v12, v41, v40 row_ror:12 row_mask:0xf bank_mask:0x1
    v_add_f32_dpp v11, v34, v11 row_ror:8 row_mask:0xf bank_mask:0x1
    v_add_f32_dpp v10, v19, v10 row_ror:4 row_mask:0xf bank_mask:0x1
    v_mfma_f32_16x16x32_bf16 v[80:83], v[88:91], v[24:27], 0
    v_mfma_f32_16x16x32_bf16 v[72:75], v[84:87], v[28:31], v[72:75]
    v_add_f32_dpp v13, v49, v48 row_ror:12 row_mask:0xf bank_mask:0x1
    v_add_f32_dpp v12, v42, v12 row_ror:8 row_mask:0xf bank_mask:0x1
    v_add_f32_dpp v11, v35, v11 row_ror:4 row_mask:0xf bank_mask:0x1
    v_mfma_f32_16x16x32_bf16 v[88:91], v[96:99], v[24:27], 0
    v_mfma_f32_16x16x32_bf16 v[80:83], v[92:95], v[28:31], v[80:83]
    v_add_f32_dpp v10, v58, v57 row_ror:12 row_mask:0xf bank_mask:0x2
    v_add_f32_dpp v13, v50, v13 row_ror:8 row_mask:0xf bank_mask:0x1
    v_add_f32_dpp v12, v43, v12 row_ror:4 row_mask:0xf bank_mask:0x1
    s_memrealtime s[8:9]
    s_waitcnt lgkmcnt(0)
    s_sub_u32 s8, s8, s30
    s_cmpk_ge_u32 s8, 1417
    s_nop 0
    s_cbranch_scc1 .ap_147
    s_waitcnt vmcnt(4)
    s_cmpk_ge_u32 s8, 1352
    s_cbranch_scc1 .ap_147
    s_waitcnt vmcnt(3)
    s_bitcmp1_b64 s[14:15], 36
    s_cbranch_scc0 1
    s_waitcnt vmcnt(2)
    s_cmpk_ge_u32 s8, 1277
    s_cbranch_scc1 .ap_147
    s_waitcnt vmcnt(1)
.ap_147:
    s_add_u32 s63, s69, 32768
    buffer_load_dwordx4 v[176:179], v2, s[44:47], s63 offen nt
    v_mfma_f32_16x16x32_bf16 v[96:99], v[104:107], v[24:27], 0
    v_mfma_f32_16x16x32_bf16 v[88:91], v[100:103], v[28:31], v[88:91]
    v_add_f32_dpp v11, v66, v65 row_ror:12 row_mask:0xf bank_mask:0x2
    v_add_f32_dpp v10, v59, v10 row_ror:8 row_mask:0xf bank_mask:0x2
    v_add_f32_dpp v13, v51, v13 row_ror:4 row_mask:0xf bank_mask:0x1
    v_mfma_f32_16x16x32_bf16 v[104:107], v[112:115], v[24:27], 0
    v_mfma_f32_16x16x32_bf16 v[96:99], v[108:111], v[28:31], v[96:99]
    v_add_f32_dpp v12, v74, v73 row_ror:12 row_mask:0xf bank_mask:0x2
    v_add_f32_dpp v11, v67, v11 row_ror:8 row_mask:0xf bank_mask:0x2
    v_add_f32_dpp v10, v56, v10 row_ror:4 row_mask:0xf bank_mask:0x2
    v_mfma_f32_16x16x32_bf16 v[112:115], v[120:123], v[24:27], 0
    v_mfma_f32_16x16x32_bf16 v[104:107], v[116:119], v[28:31], v[104:107]
    v_add_f32_dpp v13, v82, v81 row_ror:12 row_mask:0xf bank_mask:0x2
    v_add_f32_dpp v12, v75, v12 row_ror:8 row_mask:0xf bank_mask:0x2
    v_add_f32_dpp v11, v64, v11 row_ror:4 row_mask:0xf bank_mask:0x2
    v_mfma_f32_16x16x32_bf16 v[120:123], v[128:131], v[24:27], 0
    v_mfma_f32_16x16x32_bf16 v[112:115], v[124:127], v[28:31], v[112:115]
    v_add_f32_dpp v10, v91, v90 row_ror:12 row_mask:0xf bank_mask:0x4
    v_add_f32_dpp v13, v83, v13 row_ror:8 row_mask:0xf bank_mask:0x2
    v_add_f32_dpp v12, v72, v12 row_ror:4 row_mask:0xf bank_mask:0x2
    s_memrealtime s[8:9]
    s_waitcnt lgkmcnt(0)
    s_sub_u32 s8, s8, s30
    s_cmpk_ge_u32 s8, 1444
    s_nop 0
    s_cbranch_scc1 .ap_148
    s_waitcnt vmcnt(5)
    s_cmpk_ge_u32 s8, 1379
    s_cbranch_scc1 .ap_148
    s_waitcnt vmcnt(3)
    s_bitcmp1_b64 s[14:15], 37
    s_cbranch_scc0 1
    s_waitcnt vmcnt(2)
    s_cmpk_ge_u32 s8, 1304
    s_cbranch_scc1 .ap_148
    s_waitcnt vmcnt(1)
.ap_148:
    s_add_u32 s63, s69, 40960
    buffer_load_dwordx4 v[180:183], v2, s[44:47], s63 offen nt
    v_mfma_f32_16x16x32_bf16 v[128:131], v[136:139], v[24:27], 0
    v_mfma_f32_16x16x32_bf16 v[120:123], v[132:135], v[28:31], v[120:123]
    v_add_f32_dpp v11, v99, v98 row_ror:12 row_mask:0xf bank_mask:0x4
    v_add_f32_dpp v10, v88, v10 row_ror:8 row_mask:0xf bank_mask:0x4
    v_add_f32_dpp v13, v80, v13 row_ror:4 row_mask:0xf bank_mask:0x2
    v_mfma_f32_16x16x32_bf16 v[136:139], v[144:147], v[24:27], 0
    v_mfma_f32_16x16x32_bf16 v[128:131], v[140:143], v[28:31], v[128:131]
    v_add_f32_dpp v12, v107, v106 row_ror:12 row_mask:0xf bank_mask:0x4
    v_add_f32_dpp v11, v96, v11 row_ror:8 row_mask:0xf bank_mask:0x4
    v_add_f32_dpp v10, v89, v10 row_ror:4 row_mask:0xf bank_mask:0x4
    v_mfma_f32_16x16x32_bf16 v[144:147], v[152:155], v[24:27], 0
    v_mfma_f32_16x16x32_bf16 v[136:139], v[148:151], v[28:31], v[136:139]
    v_add_f32_dpp v13, v115, v114 row_ror:12 row_mask:0xf bank_mask:0x4
    v_add_f32_dpp v12, v104, v12 row_ror:8 row_mask:0xf bank_mask:0x4
    v_add_f32_dpp v11, v97, v11 row_ror:4 row_mask:0xf bank_mask:0x4
    v_mfma_f32_16x16x32_bf16 v[144:147], v[156:159], v[28:31], v[144:147]
    v_add_f32_dpp v10, v120, v123 row_ror:12 row_mask:0xf bank_mask:0x8
    v_add_f32_dpp v13, v112, v13 row_ror:8 row_mask:0xf bank_mask:0x4
    v_add_f32_dpp v12, v105, v12 row_ror:4 row_mask:0xf bank_mask:0x4
    s_memrealtime s[8:9]
    s_waitcnt lgkmcnt(0)
    s_sub_u32 s8, s8, s30
    s_cmpk_ge_u32 s8, 1471
    s_nop 0
    s_cbranch_scc1 .ap_149
    s_waitcnt vmcnt(5)
    s_cmpk_ge_u32 s8, 1406
    s_cbranch_scc1 .ap_149
    s_waitcnt vmcnt(3)
    s_bitcmp1_b64 s[14:15], 38
    s_cbranch_scc0 1
    s_waitcnt vmcnt(2)
    s_cmpk_ge_u32 s8, 1331
    s_cbranch_scc1 .ap_149
    s_waitcnt vmcnt(1)
.ap_149:
    s_add_u32 s63, s69, 49152
    buffer_load_dwordx4 v[184:187], v2, s[44:47], s63 offen nt
    v_add_f32_dpp v11, v128, v131 row_ror:12 row_mask:0xf bank_mask:0x8
    v_add_f32_dpp v10, v121, v10 row_ror:8 row_mask:0xf bank_mask:0x8
    v_add_f32_dpp v13, v113, v13 row_ror:4 row_mask:0xf bank_mask:0x4
    v_add_f32_dpp v12, v136, v139 row_ror:12 row_mask:0xf bank_mask:0x8
    v_add_f32_dpp v11, v129, v11 row_ror:8 row_mask:0xf bank_mask:0x8
    v_add_f32_dpp v10, v122, v10 row_ror:4 row_mask:0xf bank_mask:0x8
    v_add_f32_dpp v13, v144, v147 row_ror:12 row_mask:0xf bank_mask:0x8
    v_add_f32_dpp v12, v137, v12 row_ror:8 row_mask:0xf bank_mask:0x8
    v_add_f32_dpp v11, v130, v11 row_ror:4 row_mask:0xf bank_mask:0x8
    v_add_f32_dpp v13, v145, v13 row_ror:8 row_mask:0xf bank_mask:0x8
    v_add_f32_dpp v12, v138, v12 row_ror:4 row_mask:0xf bank_mask:0x8
    s_memrealtime s[8:9]
    s_waitcnt lgkmcnt(0)
    s_sub_u32 s8, s8, s30
    s_cmpk_ge_u32 s8, 1498
    s_cbranch_scc1 .ap_150
    s_waitcnt vmcnt(5)
    s_cmpk_ge_u32 s8, 1433
    s_cbranch_scc1 .ap_150
    s_waitcnt vmcnt(3)
    s_bitcmp1_b64 s[14:15], 39
    s_cbranch_scc0 1
    s_waitcnt vmcnt(2)
    s_cmpk_ge_u32 s8, 1358
    s_cbranch_scc1 .ap_150
    s_waitcnt vmcnt(1)
.ap_150:
    s_add_u32 s63, s69, 57344
    buffer_load_dwordx4 v[188:191], v2, s[44:47], s63 offen nt
    v_add_f32_dpp v13, v146, v13 row_ror:4 row_mask:0xf bank_mask:0x8
    s_mov_b32 s60, 0x3db504f3
    s_mov_b32 s61, 0x3db504f3
    v_cvt_pk_bf16_f32 v10, 0, v10
    v_cvt_pk_bf16_f32 v11, 0, v11
    v_cvt_pk_bf16_f32 v12, 0, v12
    v_cvt_pk_bf16_f32 v13, 0, v13
    v_pk_mul_f32 v[10:11], v[10:11], s[60:61]
    v_pk_mul_f32 v[12:13], v[12:13], s[60:61]
    v_cvt_pk_bf16_f32 v10, 0, v10
    v_cvt_pk_bf16_f32 v11, 0, v11
    v_cvt_pk_bf16_f32 v12, 0, v12
    v_cvt_pk_bf16_f32 v13, 0, v13
    v_max_f32 v14, v10, v11
    v_max3_f32 v14, v14, v12, v13
    s_mov_b32 s60, 0x3fb8aa3b
    v_mov_b32 v22, s34
    v_mov_b32 v23, s34
    v_max_f32_dpp v14, v14, v14 quad_perm:[2,3,0,1] row_mask:0xf bank_mask:0xf
    s_nop 1
    v_max_f32_dpp v14, v14, v14 row_ror:4 row_mask:0xf bank_mask:0xf
    s_nop 1
    v_max_f32_dpp v14, v14, v14 row_ror:8 row_mask:0xf bank_mask:0xf
    v_mov_b32 v15, v14
    s_nop 1
    v_permlane16_swap_b32 v15, v14
    v_max_f32 v14, v15, v14
    v_mov_b32 v15, v14
    s_nop 1
    v_permlane32_swap_b32 v15, v14
    v_max_f32 v14, v15, v14
    v_mul_f32 v15, 0xbfb8aa3b, v14
    v_fma_f32 v10, v10, s60, v15
    v_fma_f32 v11, v11, s60, v15
    v_fma_f32 v12, v12, s60, v15
    v_fma_f32 v13, v13, s60, v15
    v_exp_f32 v10, v10
    v_exp_f32 v11, v11
    v_exp_f32 v12, v12
    v_exp_f32 v13, v13
    v_mov_b32 v20, v14
    v_pk_add_f32 v[16:17], v[10:11], v[12:13]
    v_add_f32 v21, v16, v17
    s_lshl3_add_u32 s60, s68, s3
    s_lshl_b32 s60, s60, 5
    s_add_u32 s60, s60, s59
    v_add_f32_dpp v21, v21, v21 quad_perm:[2,3,0,1] row_mask:0xf bank_mask:0xf
    s_nop 1
    v_add_f32_dpp v21, v21, v21 row_ror:4 row_mask:0xf bank_mask:0xf
    s_nop 1
    v_add_f32_dpp v21, v21, v21 row_ror:8 row_mask:0xf bank_mask:0xf
    v_mov_b32 v15, v21
    s_nop 1
    v_permlane16_swap_b32 v15, v21
    v_add_f32 v21, v15, v21
    v_mov_b32 v15, v21
    s_nop 1
    v_permlane32_swap_b32 v15, v21
    v_add_f32 v21, v15, v21
    s_lshl_b32 s60, s3, 4
    s_add_u32 s60, s60, 159104
    v_add_u32 v16, s60, v3
    v_mov_b32 v17, 159232
    v_mov_b32 v18, 1
    s_mov_b64 exec, 3
    ds_write_b64 v16, v[20:21]
    s_mov_b64 exec, 1
    s_waitcnt lgkmcnt(0)
    ds_add_rtn_u32 v18, v17, v18
    s_mov_b64 exec, -1
    v_and_b32 v16, 0x78, v3
    v_add_u32 v16, 159104, v16
    s_waitcnt lgkmcnt(0)
    v_readfirstlane_b32 s60, v18
    s_cmp_lg_u32 s60, 7
    s_nop 3
    s_cbranch_scc1 .ml_151
    ds_read_b64 v[18:19], v16
    s_lshl_b32 s60, s68, 7
    s_add_u32 s60, s60, s59
    s_waitcnt lgkmcnt(0)
    v_mov_b32 v20, v18
    s_nop 1
    v_max_f32_dpp v20, v20, v20 quad_perm:[2,3,0,1] row_mask:0xf bank_mask:0xf
    s_nop 1
    v_max_f32_dpp v20, v20, v20 row_ror:4 row_mask:0xf bank_mask:0xf
    s_nop 1
    v_max_f32_dpp v20, v20, v20 row_ror:8 row_mask:0xf bank_mask:0xf
    v_sub_f32 v18, v18, v20
    v_mul_f32 v18, 0x3fb8aa3b, v18
    v_exp_f32 v18, v18
    s_nop 0
    v_mul_f32 v21, v18, v19
    s_nop 1
    v_add_f32_dpp v21, v21, v21 quad_perm:[2,3,0,1] row_mask:0xf bank_mask:0xf
    s_nop 1
    v_add_f32_dpp v21, v21, v21 row_ror:4 row_mask:0xf bank_mask:0xf
    s_nop 1
    v_add_f32_dpp v21, v21, v21 row_ror:8 row_mask:0xf bank_mask:0xf
    s_mov_b64 exec, 0xff
    buffer_store_dwordx4 v[20:23], v2, s[36:39], s60 offen sc1
    s_mov_b64 exec, -1
.ml_151:
    s_memrealtime s[8:9]
    s_waitcnt lgkmcnt(0)
    s_sub_u32 s8, s8, s30
    s_cmpk_ge_u32 s8, 1525
    s_cbranch_scc1 .ap_152
    s_waitcnt vmcnt(5)
    s_cmpk_ge_u32 s8, 1460
    s_cbranch_scc1 .ap_152
    s_waitcnt vmcnt(3)
    s_bitcmp1_b64 s[14:15], 40
    s_cbranch_scc0 1
    s_waitcnt vmcnt(2)
    s_cmpk_ge_u32 s8, 1385
    s_cbranch_scc1 .ap_152
    s_waitcnt vmcnt(1)
.ap_152:
    s_add_u32 s63, s69, 131072
    buffer_load_dwordx4 v[192:195], v2, s[44:47], s63 offen nt
    s_sub_u32 s57, s65, 9
    s_bitcmp1_b32 s57, 0
    s_cselect_b32 s48, s20, s18
    s_cselect_b32 s49, s21, s19
    s_cselect_b32 s33, 36, 0
    s_and_b32 s49, s49, 0xffff
    s_mov_b32 s50, 0x510000
    s_mov_b32 s51, 0x00020000
    s_mov_b32 s52, s22
    s_and_b32 s53, s23, 0xffff
    s_mov_b32 s54, 0x510000
    s_mov_b32 s55, 0x00020000
    s_lshr_b32 s57, s57, 1
    s_lshl_b32 s57, s57, 7
    s_mul_i32 s101, s64, 1152
    s_add_u32 s101, s101, s57
    s_mul_i32 s56, s3, 73728
    s_add_u32 s101, s101, s56
    s_mul_i32 s56, s64, 72
    s_add_u32 s33, s33, s56
    s_add_u32 s33, s33, s3
    s_mul_i32 s33, s33, 9216
    s_add_u32 s33, s33, s57
    s_bfe_u32 s56, s101, 0x30007
    s_cmp_eq_u32 s56, 3
    s_cselect_b32 s43, 1, 0
    v_bfe_u32 v16, v0, 4, 1
    s_and_b32 s56, s3, 3
    s_lshl_b32 s56, s56, 1
    v_or_b32 v16, s56, v16
    v_and_b32 v6, 7, v0
    v_xor_b32 v16, v16, v6
    v_lshrrev_b32 v6, 3, v0
    v_mul_u32_u24 v6, 9216, v6
    v_lshl_add_u32 v6, v16, 4, v6
    v_bfe_u32 v16, v0, 4, 1
    s_and_b32 s56, s3, 1
    s_lshl_b32 s56, s56, 2
    v_lshl_or_b32 v16, v16, 1, s56
    v_and_b32 v17, 7, v0
    v_xor_b32 v16, v16, v17
    v_lshrrev_b32 v17, 3, v0
    v_mul_u32_u24 v17, 1152, v17
    v_lshl_add_u32 v31, v16, 4, v17
    s_memrealtime s[8:9]
    s_waitcnt vmcnt(8)
    s_waitcnt lgkmcnt(0)
    s_sub_u32 s8, s8, s30
    s_cmpk_ge_u32 s8, 1552
    s_cbranch_scc1 .ap_153
    s_waitcnt vmcnt(5)
    s_cmpk_ge_u32 s8, 1487
    s_cbranch_scc1 .ap_153
    s_waitcnt vmcnt(3)
    s_bitcmp1_b64 s[14:15], 41
    s_cbranch_scc0 1
    s_waitcnt vmcnt(2)
    s_cmpk_ge_u32 s8, 1412
    s_cbranch_scc1 .ap_153
    s_waitcnt vmcnt(1)
.ap_153:
    s_add_u32 s63, s69, 139264
    buffer_load_dwordx4 v[196:199], v2, s[44:47], s63 offen nt
    s_memrealtime s[8:9]
    s_waitcnt vmcnt(8)
    s_waitcnt lgkmcnt(0)
    s_sub_u32 s8, s8, s30
    s_cmpk_ge_u32 s8, 1579
    s_cbranch_scc1 .ap_154
    s_waitcnt vmcnt(5)
    s_cmpk_ge_u32 s8, 1514
    s_cbranch_scc1 .ap_154
    s_waitcnt vmcnt(3)
    s_bitcmp1_b64 s[14:15], 42
    s_cbranch_scc0 1
    s_waitcnt vmcnt(2)
    s_cmpk_ge_u32 s8, 1439
    s_cbranch_scc1 .ap_154
    s_waitcnt vmcnt(1)
.ap_154:
    s_add_u32 s63, s69, 147456
    buffer_load_dwordx4 v[200:203], v2, s[44:47], s63 offen nt
    s_memrealtime s[8:9]
    s_waitcnt vmcnt(8)
    s_waitcnt lgkmcnt(0)
    s_sub_u32 s8, s8, s30
    s_cmpk_ge_u32 s8, 1606
    s_cbranch_scc1 .ap_155
    s_waitcnt vmcnt(5)
    s_cmpk_ge_u32 s8, 1541
    s_cbranch_scc1 .ap_155
    s_waitcnt vmcnt(3)
    s_bitcmp1_b64 s[14:15], 43
    s_cbranch_scc0 1
    s_waitcnt vmcnt(2)
    s_cmpk_ge_u32 s8, 1466
    s_cbranch_scc1 .ap_155
    s_waitcnt vmcnt(1)
.ap_155:
    s_add_u32 s63, s69, 155648
    buffer_load_dwordx4 v[204:207], v2, s[44:47], s63 offen nt
    s_memrealtime s[8:9]
    s_waitcnt vmcnt(8)
    s_waitcnt lgkmcnt(0)
    s_sub_u32 s8, s8, s30
    s_cmpk_ge_u32 s8, 1633
    s_cbranch_scc1 .ap_156
    s_waitcnt vmcnt(5)
    s_cmpk_ge_u32 s8, 1568
    s_cbranch_scc1 .ap_156
    s_waitcnt vmcnt(3)
    s_bitcmp1_b64 s[14:15], 44
    s_cbranch_scc0 1
    s_waitcnt vmcnt(2)
    s_cmpk_ge_u32 s8, 1493
    s_cbranch_scc1 .ap_156
    s_waitcnt vmcnt(1)
.ap_156:
    s_add_u32 s63, s69, 163840
    buffer_load_dwordx4 v[208:211], v2, s[44:47], s63 offen nt
    s_memrealtime s[8:9]
    s_waitcnt vmcnt(8)
    s_waitcnt lgkmcnt(0)
    s_sub_u32 s8, s8, s30
    s_cmpk_ge_u32 s8, 1660
    s_cbranch_scc1 .ap_157
    s_waitcnt vmcnt(5)
    s_cmpk_ge_u32 s8, 1595
    s_cbranch_scc1 .ap_157
    s_waitcnt vmcnt(3)
    s_bitcmp1_b64 s[14:15], 45
    s_cbranch_scc0 1
    s_waitcnt vmcnt(2)
    s_cmpk_ge_u32 s8, 1520
    s_cbranch_scc1 .ap_157
    s_waitcnt vmcnt(1)
.ap_157:
    s_add_u32 s63, s69, 172032
    buffer_load_dwordx4 v[212:215], v2, s[44:47], s63 offen nt
    s_memrealtime s[8:9]
    s_waitcnt vmcnt(8)
    s_waitcnt lgkmcnt(0)
    s_sub_u32 s8, s8, s30
    s_cmpk_ge_u32 s8, 1691
    s_cbranch_scc1 .ap_158
    s_waitcnt vmcnt(5)
    s_cmpk_ge_u32 s8, 1626
    s_cbranch_scc1 .ap_158
    s_waitcnt vmcnt(3)
    s_bitcmp1_b64 s[14:15], 46
    s_cbranch_scc0 1
    s_waitcnt vmcnt(2)
    s_cmpk_ge_u32 s8, 1551
    s_cbranch_scc1 .ap_158
    s_waitcnt vmcnt(1)
.ap_158:
    s_add_u32 s63, s69, 180224
    buffer_load_dwordx4 v[216:219], v2, s[44:47], s63 offen nt
    s_memrealtime s[8:9]
    s_waitcnt vmcnt(8)
    s_waitcnt lgkmcnt(0)
    s_sub_u32 s8, s8, s30
    s_cmpk_ge_u32 s8, 1722
    s_cbranch_scc1 .ap_159
    s_waitcnt vmcnt(5)
    s_cmpk_ge_u32 s8, 1657
    s_cbranch_scc1 .ap_159
    s_waitcnt vmcnt(3)
    s_bitcmp1_b64 s[14:15], 47
    s_cbranch_scc0 1
    s_waitcnt vmcnt(2)
    s_cmpk_ge_u32 s8, 1582
    s_cbranch_scc1 .ap_159
    s_waitcnt vmcnt(1)
.ap_159:
    s_add_u32 s63, s69, 188416
    buffer_load_dwordx4 v[220:223], v2, s[44:47], s63 offen nt
    s_mul_i32 s99, s3, 2304
    s_add_u32 s99, s99, 0x1e000
    buffer_load_dwordx4 v[32:35], v2, s[36:39], s99 offen offset:0
    buffer_load_dwordx4 v[40:43], v2, s[36:39], s99 offen offset:1024
    buffer_load_dwordx2 v[48:49], v5, s[36:39], s99 offen offset:0
    s_memrealtime s[8:9]
    s_waitcnt vmcnt(11)
    s_waitcnt lgkmcnt(0)
    s_sub_u32 s8, s8, s30
    s_cmpk_ge_u32 s8, 1753
    s_cbranch_scc1 .ap_160
    s_waitcnt vmcnt(8)
    s_cmpk_ge_u32 s8, 1688
    s_cbranch_scc1 .ap_160
    s_waitcnt vmcnt(6)
    s_bitcmp1_b64 s[14:15], 48
    s_cbranch_scc0 1
    s_waitcnt vmcnt(5)
    s_cmpk_ge_u32 s8, 1613
    s_cbranch_scc1 .ap_160
    s_waitcnt vmcnt(4)
.ap_160:
    s_add_u32 s63, s69, 262144
    buffer_load_dwordx4 v[224:227], v2, s[44:47], s63 offen nt
    s_memrealtime s[8:9]
    s_waitcnt vmcnt(11)
    s_waitcnt lgkmcnt(0)
    s_sub_u32 s8, s8, s30
    s_cmpk_ge_u32 s8, 1784
    s_cbranch_scc1 .ap_161
    s_waitcnt vmcnt(8)
    s_cmpk_ge_u32 s8, 1719
    s_cbranch_scc1 .ap_161
    s_waitcnt vmcnt(6)
    s_bitcmp1_b64 s[14:15], 49
    s_cbranch_scc0 1
    s_waitcnt vmcnt(5)
    s_cmpk_ge_u32 s8, 1644
    s_cbranch_scc1 .ap_161
    s_waitcnt vmcnt(4)
.ap_161:
    s_add_u32 s63, s69, 270336
    buffer_load_dwordx4 v[228:231], v2, s[44:47], s63 offen nt
    s_mul_i32 s100, s3, 2304
    s_add_u32 s100, s100, 0x27000
    buffer_load_dwordx4 v[56:59], v2, s[36:39], s100 offen offset:0
    buffer_load_dwordx4 v[64:67], v2, s[36:39], s100 offen offset:1024
    buffer_load_dwordx2 v[50:51], v5, s[36:39], s100 offen offset:0
    s_memrealtime s[8:9]
    s_waitcnt vmcnt(14)
    s_waitcnt lgkmcnt(0)
    s_sub_u32 s8, s8, s30
    s_cmpk_ge_u32 s8, 1815
    s_cbranch_scc1 .ap_162
    s_waitcnt vmcnt(11)
    s_cmpk_ge_u32 s8, 1750
    s_cbranch_scc1 .ap_162
    s_waitcnt vmcnt(9)
    s_bitcmp1_b64 s[14:15], 50
    s_cbranch_scc0 1
    s_waitcnt vmcnt(8)
    s_cmpk_ge_u32 s8, 1675
    s_cbranch_scc1 .ap_162
    s_waitcnt vmcnt(4)
.ap_162:
    s_add_u32 s63, s69, 278528
    buffer_load_dwordx4 v[232:235], v2, s[44:47], s63 offen nt
    s_memrealtime s[8:9]
    s_waitcnt vmcnt(14)
    s_waitcnt lgkmcnt(0)
    s_sub_u32 s8, s8, s30
    s_cmpk_ge_u32 s8, 1846
    s_cbranch_scc1 .ap_163
    s_waitcnt vmcnt(11)
    s_cmpk_ge_u32 s8, 1781
    s_cbranch_scc1 .ap_163
    s_waitcnt vmcnt(9)
    s_bitcmp1_b64 s[14:15], 51
    s_cbranch_scc0 1
    s_waitcnt vmcnt(5)
    s_cmpk_ge_u32 s8, 1706
    s_cbranch_scc1 .ap_163
    s_waitcnt vmcnt(4)
.ap_163:
    s_add_u32 s63, s69, 286720
    buffer_load_dwordx4 v[236:239], v2, s[44:47], s63 offen nt
    s_memrealtime s[8:9]
    s_waitcnt vmcnt(14)
    s_waitcnt lgkmcnt(0)
    s_sub_u32 s8, s8, s30
    s_cmpk_ge_u32 s8, 1877
    s_cbranch_scc1 .ap_164
    s_waitcnt vmcnt(11)
    s_cmpk_ge_u32 s8, 1812
    s_cbranch_scc1 .ap_164
    s_waitcnt vmcnt(6)
    s_bitcmp1_b64 s[14:15], 52
    s_cbranch_scc0 1
    s_waitcnt vmcnt(5)
    s_cmpk_ge_u32 s8, 1737
    s_cbranch_scc1 .ap_164
    s_waitcnt vmcnt(1)
.ap_164:
    s_add_u32 s63, s69, 294912
    buffer_load_dwordx4 v[240:243], v2, s[44:47], s63 offen nt
    s_memrealtime s[8:9]
    s_waitcnt vmcnt(14)
    s_waitcnt lgkmcnt(0)
    s_sub_u32 s8, s8, s30
    s_cmpk_ge_u32 s8, 1908
    s_cbranch_scc1 .ap_165
    s_waitcnt vmcnt(11)
    s_cmpk_ge_u32 s8, 1843
    s_cbranch_scc1 .ap_165
    s_waitcnt vmcnt(6)
    s_bitcmp1_b64 s[14:15], 53
    s_cbranch_scc0 1
    s_waitcnt vmcnt(2)
    s_cmpk_ge_u32 s8, 1768
    s_cbranch_scc1 .ap_165
    s_waitcnt vmcnt(1)
.ap_165:
    s_add_u32 s63, s69, 303104
    buffer_load_dwordx4 v[244:247], v2, s[44:47], s63 offen nt
    s_load_dwordx2 s[88:89], s[6:7], s0
    buffer_load_dwordx4 v[24:27], v9, s[36:39], s59 offen offset:0 sc1
    s_memrealtime s[8:9]
    s_waitcnt vmcnt(14)
    s_waitcnt lgkmcnt(0)
    s_sub_u32 s8, s8, s30
    s_cmpk_ge_u32 s8, 1939
    s_cbranch_scc1 .ap_166
    s_waitcnt vmcnt(8)
    s_cmpk_ge_u32 s8, 1874
    s_cbranch_scc1 .ap_166
    s_waitcnt vmcnt(3)
    s_bitcmp1_b64 s[14:15], 54
    s_cbranch_scc0 1
    s_waitcnt vmcnt(2)
    s_cmpk_ge_u32 s8, 1799
    s_cbranch_scc1 .ap_166
    s_waitcnt vmcnt(1)
.ap_166:
    s_add_u32 s63, s69, 311296
    buffer_load_dwordx4 v[248:251], v2, s[44:47], s63 offen nt
    s_memrealtime s[8:9]
    s_waitcnt vmcnt(14)
    s_waitcnt lgkmcnt(0)
    s_sub_u32 s8, s8, s30
    s_cmpk_ge_u32 s8, 1970
    s_cbranch_scc1 .ap_167
    s_waitcnt vmcnt(5)
    s_cmpk_ge_u32 s8, 1905
    s_cbranch_scc1 .ap_167
    s_waitcnt vmcnt(3)
    s_bitcmp1_b64 s[14:15], 55
    s_cbranch_scc0 1
    s_waitcnt vmcnt(2)
    s_cmpk_ge_u32 s8, 1830
    s_cbranch_scc1 .ap_167
    s_waitcnt vmcnt(1)
.ap_167:
    s_add_u32 s63, s69, 319488
    buffer_load_dwordx4 v[252:255], v2, s[44:47], s63 offen nt
    s_memrealtime s[8:9]
    s_waitcnt vmcnt(11)
    s_waitcnt lgkmcnt(0)
    s_sub_u32 s8, s8, s30
    s_cmpk_ge_u32 s8, 2001
    s_cbranch_scc1 .ap_168
    s_waitcnt vmcnt(5)
    s_cmpk_ge_u32 s8, 1936
    s_cbranch_scc1 .ap_168
    s_waitcnt vmcnt(3)
    s_bitcmp1_b64 s[14:15], 56
    s_cbranch_scc0 1
    s_waitcnt vmcnt(2)
    s_cmpk_ge_u32 s8, 1861
    s_cbranch_scc1 .ap_168
    s_waitcnt vmcnt(1)
.ap_168:
    s_add_u32 s63, s69, 393216
    buffer_load_dwordx4 v[36:39], v2, s[44:47], s63 offen nt
    s_memrealtime s[8:9]
    s_waitcnt vmcnt(11)
    s_waitcnt lgkmcnt(0)
    s_sub_u32 s8, s8, s30
    s_cmpk_ge_u32 s8, 2032
    s_cbranch_scc1 .ap_169
    s_waitcnt vmcnt(5)
    s_cmpk_ge_u32 s8, 1967
    s_cbranch_scc1 .ap_169
    s_waitcnt vmcnt(3)
    s_bitcmp1_b64 s[14:15], 57
    s_cbranch_scc0 1
    s_waitcnt vmcnt(2)
    s_cmpk_ge_u32 s8, 1892
    s_cbranch_scc1 .ap_169
    s_waitcnt vmcnt(1)
.ap_169:
    s_add_u32 s63, s69, 401408
    buffer_load_dwordx4 v[44:47], v2, s[44:47], s63 offen nt
    s_memrealtime s[8:9]
    s_waitcnt vmcnt(8)
    s_waitcnt lgkmcnt(0)
    s_sub_u32 s8, s8, s30
    s_cmpk_ge_u32 s8, 2063
    s_cbranch_scc1 .ap_170
    s_waitcnt vmcnt(5)
    s_cmpk_ge_u32 s8, 1998
    s_cbranch_scc1 .ap_170
    s_waitcnt vmcnt(3)
    s_bitcmp1_b64 s[14:15], 58
    s_cbranch_scc0 1
    s_waitcnt vmcnt(2)
    s_cmpk_ge_u32 s8, 1923
    s_cbranch_scc1 .ap_170
    s_waitcnt vmcnt(1)
.ap_170:
    s_add_u32 s63, s69, 409600
    buffer_load_dwordx4 v[52:55], v2, s[44:47], s63 offen nt
    s_waitcnt vmcnt(5)
    s_branch .gpc_172
.gp_171:
    buffer_load_dwordx4 v[24:27], v9, s[36:39], s59 offen offset:0 sc1
    s_waitcnt vmcnt(0)
.gpc_172:
    v_cmp_eq_u32 vcc, s34, v26
    v_cmp_eq_u32 s[56:57], s34, v27
    s_and_b64 vcc, vcc, s[56:57]
    s_cmp_eq_u64 vcc, exec
    s_nop 2
    s_cbranch_scc1 .gpd_173
    s_sub_u32 s35, s35, 1
    s_cbranch_scc1 .Lexit
    s_sleep 1
    s_branch .gp_171
.gpd_173:
    s_lshr_b64 s[88:89], s[88:89], s1
    s_and_b32 s88, s88, 0xff
    s_cmp_eq_u32 s88, 32
    s_cselect_b32 s0, 0xac000, 0
    v_mov_b32 v16, v24
    s_nop 1
    v_max_f32_dpp v16, v16, v16 quad_perm:[2,3,0,1] row_mask:0xf bank_mask:0xf
    v_sub_f32 v17, v24, v16
    v_sub_f32 v18, v14, v16
    v_mul_f32 v17, 0x3fb8aa3b, v17
    v_mul_f32 v18, 0x3fb8aa3b, v18
    v_exp_f32 v17, v17
    v_exp_f32 v18, v18
    v_mul_f32 v17, v17, v25
    s_nop 1
    v_add_f32_dpp v17, v17, v17 quad_perm:[2,3,0,1] row_mask:0xf bank_mask:0xf
    v_rcp_f32 v19, v17
    s_nop 0
    v_fma_f32 v15, -v17, v19, 1.0
    v_fma_f32 v19, v15, v19, v19
    v_mul_f32 v18, v18, v19
    v_mul_f32 v10, v10, v18
    v_mul_f32 v11, v11, v18
    v_mul_f32 v12, v12, v18
    v_mul_f32 v13, v13, v18
    v_mov_b32_dpp v112, v10 quad_perm:[2,3,0,1] row_mask:0xf bank_mask:0xf
    v_mov_b32_dpp v113, v11 quad_perm:[2,3,0,1] row_mask:0xf bank_mask:0xf
    v_mov_b32_dpp v114, v12 quad_perm:[2,3,0,1] row_mask:0xf bank_mask:0xf
    v_mov_b32_dpp v115, v13 quad_perm:[2,3,0,1] row_mask:0xf bank_mask:0xf
    v_cvt_pk_bf16_f32 v96, v10, v112
    v_cvt_pk_bf16_f32 v100, v11, v113
    v_cvt_pk_bf16_f32 v104, v12, v114
    v_cvt_pk_bf16_f32 v108, v13, v115
    v_mov_b32_dpp v97, v96 row_ror:12 row_mask:0xf bank_mask:0xf
    v_mov_b32_dpp v101, v100 row_ror:12 row_mask:0xf bank_mask:0xf
    v_mov_b32_dpp v105, v104 row_ror:12 row_mask:0xf bank_mask:0xf
    v_mov_b32_dpp v109, v108 row_ror:12 row_mask:0xf bank_mask:0xf
    v_mov_b32_dpp v98, v96 row_ror:8 row_mask:0xf bank_mask:0xf
    v_mov_b32_dpp v102, v100 row_ror:8 row_mask:0xf bank_mask:0xf
    v_mov_b32_dpp v106, v104 row_ror:8 row_mask:0xf bank_mask:0xf
    v_mov_b32_dpp v110, v108 row_ror:8 row_mask:0xf bank_mask:0xf
    v_mov_b32_dpp v99, v96 row_ror:4 row_mask:0xf bank_mask:0xf
    v_mov_b32_dpp v103, v100 row_ror:4 row_mask:0xf bank_mask:0xf
    v_mov_b32_dpp v107, v104 row_ror:4 row_mask:0xf bank_mask:0xf
    v_mov_b32_dpp v111, v108 row_ror:4 row_mask:0xf bank_mask:0xf
    v_mov_b32_dpp v96, v96 row_shr:3 row_mask:0xf bank_mask:0x2
    v_mov_b32_dpp v97, v97 row_shr:3 row_mask:0xf bank_mask:0x2
    v_mov_b32_dpp v98, v98 row_shr:3 row_mask:0xf bank_mask:0x2
    v_mov_b32_dpp v99, v99 row_shr:3 row_mask:0xf bank_mask:0x2
    v_mov_b32_dpp v100, v100 row_shr:3 row_mask:0xf bank_mask:0x2
    v_mov_b32_dpp v101, v101 row_shr:3 row_mask:0xf bank_mask:0x2
    v_mov_b32_dpp v102, v102 row_shr:3 row_mask:0xf bank_mask:0x2
    v_mov_b32_dpp v103, v103 row_shr:3 row_mask:0xf bank_mask:0x2
    v_mov_b32_dpp v104, v104 row_shr:3 row_mask:0xf bank_mask:0x2
    v_mov_b32_dpp v105, v105 row_shr:3 row_mask:0xf bank_mask:0x2
    v_mov_b32_dpp v106, v106 row_shr:3 row_mask:0xf bank_mask:0x2
    v_mov_b32_dpp v107, v107 row_shr:3 row_mask:0xf bank_mask:0x2
    v_mov_b32_dpp v108, v108 row_shr:3 row_mask:0xf bank_mask:0x2
    v_mov_b32_dpp v109, v109 row_shr:3 row_mask:0xf bank_mask:0x2
    v_mov_b32_dpp v110, v110 row_shr:3 row_mask:0xf bank_mask:0x2
    v_mov_b32_dpp v111, v111 row_shr:3 row_mask:0xf bank_mask:0x2
    s_memrealtime s[8:9]
    s_waitcnt lgkmcnt(0)
    s_sub_u32 s8, s8, s30
    s_cmpk_ge_u32 s8, 2094
    s_cbranch_scc1 .ap_174
    s_waitcnt vmcnt(5)
    s_cmpk_ge_u32 s8, 2029
    s_cbranch_scc1 .ap_174
    s_waitcnt vmcnt(3)
    s_bitcmp1_b64 s[14:15], 59
    s_cbranch_scc0 1
    s_waitcnt vmcnt(2)
    s_cmpk_ge_u32 s8, 1954
    s_cbranch_scc1 .ap_174
    s_waitcnt vmcnt(1)
.ap_174:
    s_add_u32 s63, s69, 417792
    buffer_load_dwordx4 v[60:63], v2, s[44:47], s63 offen nt
    s_lshl_b32 s60, s3, 10
    s_add_u32 s60, s60, 132096
    v_lshlrev_b32 v10, 5, v0
    v_add_u32 v10, s60, v10
    v_lshrrev_b32 v11, 5, v0
    v_lshlrev_b32 v11, 13, v11
    v_and_b32 v12, 31, v0
    v_lshl_add_u32 v11, v12, 4, v11
    v_add_u32 v9, 132096, v2
    v_mov_b32 v15, s34
    v_mov_b32 v13, 110592
    s_mov_b32 s1, s43
    v_bfe_u32 v16, v0, 1, 3
    v_mul_u32_u24 v16, 1312, v16
    v_lshrrev_b32 v7, 4, v0
    v_lshl_add_u32 v16, v7, 5, v16
    v_and_b32 v7, 1, v0
    v_lshl_add_u32 v16, v7, 4, v16
    v_add_u32 v16, 147456, v16
    s_mul_i32 s56, s3, 1312
    s_add_u32 s56, s56, 147456
    v_add_u32 v17, s56, v3
    v_add_u32 v18, s56, v4
    v_lshrrev_b32 v7, 4, v0
    v_bfe_u32 v8, v0, 1, 1
    v_lshl_add_u32 v7, v7, 1, v8
    v_bfe_u32 v8, v0, 2, 2
    v_lshl_add_u32 v19, v7, 3, v8
    v_lshlrev_b32 v19, 7, v19
    v_and_b32 v7, 3, v7
    v_lshrrev_b32 v8, 1, v8
    v_lshl_add_u32 v7, v7, 1, v8
    v_xor_b32 v7, s3, v7
    v_lshl_add_u32 v19, v7, 4, v19
    v_and_b32 v7, 1, v0
    v_lshl_add_u32 v19, v7, 3, v19
    v_add_u32 v20, 32768, v19
    v_lshrrev_b32 v7, 4, v0
    v_bfe_u32 v8, v0, 2, 2
    v_lshl_add_u32 v21, v7, 3, v8
    v_lshlrev_b32 v21, 7, v21
    v_and_b32 v7, 1, v7
    v_lshrrev_b32 v8, 1, v8
    v_lshl_add_u32 v7, v7, 1, v8
    s_and_b32 s56, s3, 1
    s_lshl_b32 s56, s56, 1
    v_xor_b32 v7, s56, v7
    v_and_b32 v8, 3, v0
    v_lshl_add_u32 v21, v8, 3, v21
    s_lshr_b32 s56, s3, 1
    s_mul_i32 s56, s56, 12288
    s_add_u32 s56, s56, 73728
    v_add_u32 v21, s56, v21
    v_xor_b32 v8, 1, v7
    v_lshl_add_u32 v22, v8, 5, v21
    v_lshl_add_u32 v21, v7, 5, v21
    v_bfe_u32 v7, v0, 1, 3
    v_mul_u32_u24 v23, 1312, v7
    v_mul_u32_u24 v24, 272, v7
    v_and_b32 v7, 48, v0
    s_lshr_b32 s56, s3, 1
    s_mul_i32 s57, s56, 192
    s_add_u32 s57, s57, 110592
    v_add3_u32 v23, v23, v7, s57
    s_mul_i32 s56, s56, 2176
    s_and_b32 s57, s3, 1
    s_lshl_b32 s57, s57, 7
    s_add_u32 s56, s56, s57
    s_add_u32 s56, s56, 122880
    v_add3_u32 v24, v24, v7, s56
    v_and_b32 v7, 1, v0
    v_lshl_add_u32 v24, v7, 6, v24
    v_and_b32 v7, 15, v0
    s_mul_i32 s56, s3, 272
    s_add_u32 s56, s56, 122880
    v_lshl_add_u32 v25, v7, 4, s56
    v_bfe_u32 v26, v0, 1, 4
    v_lshlrev_b32 v26, 4, v26
    s_mul_i32 s56, s3, 72
    v_add_u32 v7, s56, v0
    v_lshrrev_b32 v8, 4, v7
    v_lshlrev_b32 v27, 9, v8
    v_and_b32 v29, 15, v7
    v_lshl_add_u32 v27, v29, 4, v27
    v_and_b32 v29, 7, v7
    v_mul_u32_u24 v29, 1312, v29
    v_and_b32 v7, -8, v7
    v_add3_u32 v29, v29, v7, v13
    v_and_b32 v7, 7, v0
    v_add3_u32 v7, v7, s56, 64
    v_lshrrev_b32 v8, 4, v7
    v_lshlrev_b32 v28, 9, v8
    v_and_b32 v30, 15, v7
    v_lshl_add_u32 v28, v30, 4, v28
    v_and_b32 v30, 7, v7
    v_mul_u32_u24 v30, 1312, v30
    v_and_b32 v7, -8, v7
    v_add3_u32 v30, v30, v7, v13
    s_memrealtime s[8:9]
    s_waitcnt lgkmcnt(0)
    s_sub_u32 s8, s8, s30
    s_cmpk_ge_u32 s8, 2125
    s_cbranch_scc1 .ap_175
    s_waitcnt vmcnt(5)
    s_cmpk_ge_u32 s8, 2060
    s_cbranch_scc1 .ap_175
    s_waitcnt vmcnt(3)
    s_bitcmp1_b64 s[14:15], 60
    s_cbranch_scc0 1
    s_waitcnt vmcnt(2)
    s_cmpk_ge_u32 s8, 1985
    s_cbranch_scc1 .ap_175
    s_waitcnt vmcnt(1)
.ap_175:
    s_add_u32 s63, s69, 425984
    buffer_load_dwordx4 v[68:71], v2, s[44:47], s63 offen nt
    v_perm_b32 v112, v164, v160, s94
    v_perm_b32 v113, v172, v168, s94
    v_perm_b32 v114, v180, v176, s94
    v_perm_b32 v115, v188, v184, s94
    s_nop 1
    v_mfma_f32_16x16x32_bf16 v[128:131], v[96:99], v[112:115], 0
    v_perm_b32 v116, v164, v160, s95
    v_perm_b32 v117, v172, v168, s95
    v_perm_b32 v118, v180, v176, s95
    v_perm_b32 v119, v188, v184, s95
    s_nop 1
    v_mfma_f32_16x16x32_bf16 v[132:135], v[96:99], v[116:119], 0
    v_perm_b32 v120, v165, v161, s94
    v_perm_b32 v121, v173, v169, s94
    v_perm_b32 v122, v181, v177, s94
    v_perm_b32 v123, v189, v185, s94
    s_nop 1
    v_mfma_f32_16x16x32_bf16 v[136:139], v[96:99], v[120:123], 0
    v_perm_b32 v124, v165, v161, s95
    v_perm_b32 v125, v173, v169, s95
    v_perm_b32 v126, v181, v177, s95
    v_perm_b32 v127, v189, v185, s95
    s_nop 1
    v_mfma_f32_16x16x32_bf16 v[140:143], v[96:99], v[124:127], 0
    v_perm_b32 v112, v166, v162, s94
    v_perm_b32 v113, v174, v170, s94
    v_perm_b32 v114, v182, v178, s94
    v_perm_b32 v115, v190, v186, s94
    s_nop 1
    v_mfma_f32_16x16x32_bf16 v[144:147], v[96:99], v[112:115], 0
    v_perm_b32 v116, v166, v162, s95
    v_perm_b32 v117, v174, v170, s95
    v_perm_b32 v118, v182, v178, s95
    v_perm_b32 v119, v190, v186, s95
    s_nop 1
    v_mfma_f32_16x16x32_bf16 v[148:151], v[96:99], v[116:119], 0
    v_perm_b32 v120, v167, v163, s94
    v_perm_b32 v121, v175, v171, s94
    v_perm_b32 v122, v183, v179, s94
    v_perm_b32 v123, v191, v187, s94
    s_nop 1
    v_mfma_f32_16x16x32_bf16 v[152:155], v[96:99], v[120:123], 0
    v_perm_b32 v124, v167, v163, s95
    v_perm_b32 v125, v175, v171, s95
    v_perm_b32 v126, v183, v179, s95
    v_perm_b32 v127, v191, v187, s95
    s_nop 1
    v_mfma_f32_16x16x32_bf16 v[156:159], v[96:99], v[124:127], 0
    s_memrealtime s[8:9]
    s_waitcnt lgkmcnt(0)
    s_sub_u32 s8, s8, s30
    s_cmpk_ge_u32 s8, 2156
    s_nop 3
    s_cbranch_scc1 .ap_176
    s_waitcnt vmcnt(5)
    s_cmpk_ge_u32 s8, 2091
    s_cbranch_scc1 .ap_176
    s_waitcnt vmcnt(3)
    s_bitcmp1_b64 s[14:15], 61
    s_cbranch_scc0 1
    s_waitcnt vmcnt(2)
    s_cmpk_ge_u32 s8, 2016
    s_cbranch_scc1 .ap_176
    s_waitcnt vmcnt(1)
.ap_176:
    s_add_u32 s63, s69, 434176
    buffer_load_dwordx4 v[76:79], v2, s[44:47], s63 offen nt
    v_perm_b32 v112, v196, v192, s94
    v_perm_b32 v113, v204, v200, s94
    v_perm_b32 v114, v212, v208, s94
    v_perm_b32 v115, v220, v216, s94
    s_nop 1
    v_mfma_f32_16x16x32_bf16 v[128:131], v[100:103], v[112:115], v[128:131]
    v_perm_b32 v116, v196, v192, s95
    v_perm_b32 v117, v204, v200, s95
    v_perm_b32 v118, v212, v208, s95
    v_perm_b32 v119, v220, v216, s95
    s_nop 1
    v_mfma_f32_16x16x32_bf16 v[132:135], v[100:103], v[116:119], v[132:135]
    v_perm_b32 v120, v197, v193, s94
    v_perm_b32 v121, v205, v201, s94
    v_perm_b32 v122, v213, v209, s94
    v_perm_b32 v123, v221, v217, s94
    s_nop 1
    v_mfma_f32_16x16x32_bf16 v[136:139], v[100:103], v[120:123], v[136:139]
    v_perm_b32 v124, v197, v193, s95
    v_perm_b32 v125, v205, v201, s95
    v_perm_b32 v126, v213, v209, s95
    v_perm_b32 v127, v221, v217, s95
    s_nop 1
    v_mfma_f32_16x16x32_bf16 v[140:143], v[100:103], v[124:127], v[140:143]
    v_perm_b32 v112, v198, v194, s94
    v_perm_b32 v113, v206, v202, s94
    v_perm_b32 v114, v214, v210, s94
    v_perm_b32 v115, v222, v218, s94
    s_nop 1
    v_mfma_f32_16x16x32_bf16 v[144:147], v[100:103], v[112:115], v[144:147]
    v_perm_b32 v116, v198, v194, s95
    v_perm_b32 v117, v206, v202, s95
    v_perm_b32 v118, v214, v210, s95
    v_perm_b32 v119, v222, v218, s95
    s_nop 1
    v_mfma_f32_16x16x32_bf16 v[148:151], v[100:103], v[116:119], v[148:151]
    v_perm_b32 v120, v199, v195, s94
    v_perm_b32 v121, v207, v203, s94
    v_perm_b32 v122, v215, v211, s94
    v_perm_b32 v123, v223, v219, s94
    s_nop 1
    v_mfma_f32_16x16x32_bf16 v[152:155], v[100:103], v[120:123], v[152:155]
    v_perm_b32 v124, v199, v195, s95
    v_perm_b32 v125, v207, v203, s95
    v_perm_b32 v126, v215, v211, s95
    v_perm_b32 v127, v223, v219, s95
    s_nop 1
    v_mfma_f32_16x16x32_bf16 v[156:159], v[100:103], v[124:127], v[156:159]
    s_memrealtime s[8:9]
    s_waitcnt lgkmcnt(0)
    s_sub_u32 s8, s8, s30
    s_cmpk_ge_u32 s8, 2187
    s_nop 3
    s_cbranch_scc1 .ap_177
    s_waitcnt vmcnt(5)
    s_cmpk_ge_u32 s8, 2122
    s_cbranch_scc1 .ap_177
    s_waitcnt vmcnt(3)
    s_bitcmp1_b64 s[14:15], 62
    s_cbranch_scc0 1
    s_waitcnt vmcnt(2)
    s_cmpk_ge_u32 s8, 2047
    s_cbranch_scc1 .ap_177
    s_waitcnt vmcnt(1)
.ap_177:
    s_add_u32 s63, s69, 442368
    buffer_load_dwordx4 v[84:87], v2, s[44:47], s63 offen nt
    s_waitcnt vmcnt(7)
    v_perm_b32 v112, v228, v224, s94
    v_perm_b32 v113, v236, v232, s94
    v_perm_b32 v114, v244, v240, s94
    v_perm_b32 v115, v252, v248, s94
    s_nop 1
    v_mfma_f32_16x16x32_bf16 v[128:131], v[104:107], v[112:115], v[128:131]
    v_perm_b32 v116, v228, v224, s95
    v_perm_b32 v117, v236, v232, s95
    v_perm_b32 v118, v244, v240, s95
    v_perm_b32 v119, v252, v248, s95
    s_nop 1
    v_mfma_f32_16x16x32_bf16 v[132:135], v[104:107], v[116:119], v[132:135]
    v_perm_b32 v120, v229, v225, s94
    v_perm_b32 v121, v237, v233, s94
    v_perm_b32 v122, v245, v241, s94
    v_perm_b32 v123, v253, v249, s94
    s_nop 1
    v_mfma_f32_16x16x32_bf16 v[136:139], v[104:107], v[120:123], v[136:139]
    v_perm_b32 v124, v229, v225, s95
    v_perm_b32 v125, v237, v233, s95
    v_perm_b32 v126, v245, v241, s95
    v_perm_b32 v127, v253, v249, s95
    s_nop 1
    v_mfma_f32_16x16x32_bf16 v[140:143], v[104:107], v[124:127], v[140:143]
    v_perm_b32 v112, v230, v226, s94
    v_perm_b32 v113, v238, v234, s94
    v_perm_b32 v114, v246, v242, s94
    v_perm_b32 v115, v254, v250, s94
    s_nop 1
    v_mfma_f32_16x16x32_bf16 v[144:147], v[104:107], v[112:115], v[144:147]
    v_perm_b32 v116, v230, v226, s95
    v_perm_b32 v117, v238, v234, s95
    v_perm_b32 v118, v246, v242, s95
    v_perm_b32 v119, v254, v250, s95
    s_nop 1
    v_mfma_f32_16x16x32_bf16 v[148:151], v[104:107], v[116:119], v[148:151]
    v_perm_b32 v120, v231, v227, s94
    v_perm_b32 v121, v239, v235, s94
    v_perm_b32 v122, v247, v243, s94
    v_perm_b32 v123, v255, v251, s94
    s_nop 1
    v_mfma_f32_16x16x32_bf16 v[152:155], v[104:107], v[120:123], v[152:155]
    v_perm_b32 v124, v231, v227, s95
    v_perm_b32 v125, v239, v235, s95
    v_perm_b32 v126, v247, v243, s95
    v_perm_b32 v127, v255, v251, s95
    s_nop 1
    v_mfma_f32_16x16x32_bf16 v[156:159], v[104:107], v[124:127], v[156:159]
    s_memrealtime s[8:9]
    s_waitcnt lgkmcnt(0)
    s_sub_u32 s8, s8, s30
    s_cmpk_ge_u32 s8, 2218
    s_nop 3
    s_cbranch_scc1 .ap_178
    s_waitcnt vmcnt(5)
    s_cmpk_ge_u32 s8, 2153
    s_cbranch_scc1 .ap_178
    s_waitcnt vmcnt(3)
    s_bitcmp1_b64 s[14:15], 63
    s_cbranch_scc0 1
    s_waitcnt vmcnt(2)
    s_cmpk_ge_u32 s8, 2078
    s_cbranch_scc1 .ap_178
    s_waitcnt vmcnt(1)
.ap_178:
    s_add_u32 s63, s69, 450560
    buffer_load_dwordx4 v[92:95], v2, s[44:47], s63 offen nt
    s_setprio 0
    s_waitcnt vmcnt(6)
    v_perm_b32 v160, v44, v36, s94
    v_perm_b32 v164, v44, v36, s95
    v_perm_b32 v168, v45, v37, s94
    v_perm_b32 v172, v45, v37, s95
    v_perm_b32 v176, v46, v38, s94
    v_perm_b32 v180, v46, v38, s95
    v_perm_b32 v184, v47, v39, s94
    v_perm_b32 v188, v47, v39, s95
    s_waitcnt vmcnt(4)
    v_perm_b32 v161, v60, v52, s94
    v_perm_b32 v165, v60, v52, s95
    v_perm_b32 v169, v61, v53, s94
    v_perm_b32 v173, v61, v53, s95
    v_perm_b32 v177, v62, v54, s94
    v_perm_b32 v181, v62, v54, s95
    v_perm_b32 v185, v63, v55, s94
    v_perm_b32 v189, v63, v55, s95
    v_mfma_f32_16x16x16_bf16 v[128:131], v[108:109], v[160:161], v[128:131]
    v_mfma_f32_16x16x16_bf16 v[132:135], v[108:109], v[164:165], v[132:135]
    v_mfma_f32_16x16x16_bf16 v[136:139], v[108:109], v[168:169], v[136:139]
    v_mfma_f32_16x16x16_bf16 v[140:143], v[108:109], v[172:173], v[140:143]
    v_mfma_f32_16x16x16_bf16 v[144:147], v[108:109], v[176:177], v[144:147]
    v_mfma_f32_16x16x16_bf16 v[148:151], v[108:109], v[180:181], v[148:151]
    v_mfma_f32_16x16x16_bf16 v[152:155], v[108:109], v[184:185], v[152:155]
    v_mfma_f32_16x16x16_bf16 v[156:159], v[108:109], v[188:189], v[156:159]
    s_waitcnt vmcnt(2)
    v_perm_b32 v162, v76, v68, s94
    v_perm_b32 v166, v76, v68, s95
    v_perm_b32 v170, v77, v69, s94
    v_perm_b32 v174, v77, v69, s95
    v_perm_b32 v178, v78, v70, s94
    v_perm_b32 v182, v78, v70, s95
    v_perm_b32 v186, v79, v71, s94
    v_perm_b32 v190, v79, v71, s95
    s_lshl4_add_u32 s59, s67, s66
    s_lshl1_add_u32 s59, s59, s68
    s_lshl_b32 s59, s59, 9
    s_add_u32 s59, s59, 0x210000
    s_mov_b32 s60, 0x07060503
    s_mov_b32 s61, 0x07060502
    s_mov_b32 s62, 0x07060501
.Ltail_bc:
    s_waitcnt vmcnt(0)
    v_perm_b32 v163, v92, v84, s94
    v_perm_b32 v167, v92, v84, s95
    v_perm_b32 v171, v93, v85, s94
    v_perm_b32 v175, v93, v85, s95
    v_perm_b32 v179, v94, v86, s94
    v_perm_b32 v183, v94, v86, s95
    v_perm_b32 v187, v95, v87, s94
    v_perm_b32 v191, v95, v87, s95
    v_mfma_f32_16x16x16_bf16 v[128:131], v[110:111], v[162:163], v[128:131]
    v_mfma_f32_16x16x16_bf16 v[132:135], v[110:111], v[166:167], v[132:135]
    v_mfma_f32_16x16x16_bf16 v[136:139], v[110:111], v[170:171], v[136:139]
    v_mfma_f32_16x16x16_bf16 v[140:143], v[110:111], v[174:175], v[140:143]
    v_mfma_f32_16x16x16_bf16 v[144:147], v[110:111], v[178:179], v[144:147]
    v_mfma_f32_16x16x16_bf16 v[148:151], v[110:111], v[182:183], v[148:151]
    v_mfma_f32_16x16x16_bf16 v[152:155], v[110:111], v[186:187], v[152:155]
    v_mfma_f32_16x16x16_bf16 v[156:159], v[110:111], v[190:191], v[156:159]
    s_mov_b64 exec, 0xffffffff
    s_nop 0
    ds_write2_b32 v10, v128, v132 offset0:0 offset1:1
    s_nop 0
    ds_write2_b32 v10, v136, v140 offset0:2 offset1:3
    s_nop 0
    ds_write2_b32 v10, v144, v148 offset0:4 offset1:5
    s_nop 0
    ds_write2_b32 v10, v152, v156 offset0:6 offset1:7
    s_mov_b64 exec, -1
    s_lshl_b32 s32, s3, 10
    s_add_u32 m0, s32, 40960
    s_add_u32 s56, s101, 2949120
    buffer_load_dwordx4 v6, s[48:51], s56 offen nt lds
    s_add_u32 m0, s32, 49152
    s_add_u32 s56, s101, 3538944
    buffer_load_dwordx4 v6, s[48:51], s56 offen nt lds
    s_add_u32 m0, s32, 57344
    s_add_u32 s56, s101, 4128768
    buffer_load_dwordx4 v6, s[48:51], s56 offen nt lds
    s_waitcnt lgkmcnt(0)
    s_barrier
    s_cmp_lg_u32 s3, 7
    s_cbranch_scc1 .opub_179
    ds_read_b128 v[196:199], v9 offset:0
    ds_read_b128 v[200:203], v9 offset:1024
    ds_read_b128 v[204:207], v9 offset:2048
    ds_read_b128 v[208:211], v9 offset:3072
    ds_read_b128 v[212:215], v9 offset:4096
    ds_read_b128 v[216:219], v9 offset:5120
    ds_read_b128 v[220:223], v9 offset:6144
    ds_read_b128 v[224:227], v9 offset:7168
    s_waitcnt lgkmcnt(6)
    v_pk_add_f32 v[196:197], v[196:197], v[200:201]
    v_pk_add_f32 v[198:199], v[198:199], v[202:203]
    s_waitcnt lgkmcnt(4)
    v_pk_add_f32 v[204:205], v[204:205], v[208:209]
    v_pk_add_f32 v[206:207], v[206:207], v[210:211]
    v_pk_add_f32 v[196:197], v[196:197], v[204:205]
    v_pk_add_f32 v[198:199], v[198:199], v[206:207]
    s_waitcnt lgkmcnt(2)
    v_pk_add_f32 v[212:213], v[212:213], v[216:217]
    v_pk_add_f32 v[214:215], v[214:215], v[218:219]
    s_waitcnt lgkmcnt(0)
    v_pk_add_f32 v[220:221], v[220:221], v[224:225]
    v_pk_add_f32 v[222:223], v[222:223], v[226:227]
    v_pk_add_f32 v[212:213], v[212:213], v[220:221]
    v_pk_add_f32 v[214:215], v[214:215], v[222:223]
    v_pk_add_f32 v[196:197], v[196:197], v[212:213]
    v_pk_add_f32 v[198:199], v[198:199], v[214:215]
    v_perm_b32 v12, v196, v199, s60
    v_perm_b32 v13, v197, v199, s61
    v_perm_b32 v14, v198, v199, s62
    s_add_u32 s57, s59, 0xac000
    buffer_store_dwordx4 v[12:15], v11, s[36:39], s57 offen
    buffer_store_dwordx4 v[12:15], v11, s[36:39], s59 offen sc1
.opub_179:
    s_barrier
    s_bitcmp1_b32 s1, 0
    s_cbranch_scc1 .lt_180
    s_lshl_b32 s32, s3, 10
    s_add_u32 m0, s32, 0
    s_add_u32 s56, s101, 0
    buffer_load_dwordx4 v6, s[48:51], s56 offen nt lds
    s_add_u32 m0, s32, 8192
    s_add_u32 s56, s101, 589824
    buffer_load_dwordx4 v6, s[48:51], s56 offen nt lds
    s_add_u32 m0, s32, 16384
    s_add_u32 s56, s101, 1179648
    buffer_load_dwordx4 v6, s[48:51], s56 offen nt lds
    s_add_u32 m0, s32, 24576
    s_add_u32 s56, s101, 1769472
    buffer_load_dwordx4 v6, s[48:51], s56 offen nt lds
    s_add_u32 m0, s32, 32768
    s_add_u32 s56, s101, 2359296
    buffer_load_dwordx4 v6, s[48:51], s56 offen nt lds
.lt_180:
    s_lshl_b32 s32, s3, 10
    s_add_u32 m0, s32, 65536
    s_add_u32 s56, s101, 4718592
    buffer_load_dwordx4 v6, s[48:51], s56 offen nt lds
    s_add_u32 m0, s32, 73728
    s_add_u32 s56, s33, 0
    buffer_load_dwordx4 v31, s[52:55], s56 offen nt lds
    s_add_u32 m0, s32, 81920
    s_add_u32 s56, s33, 73728
    buffer_load_dwordx4 v31, s[52:55], s56 offen nt lds
    s_add_u32 m0, s32, 90112
    s_add_u32 s56, s33, 147456
    buffer_load_dwordx4 v31, s[52:55], s56 offen nt lds
    s_add_u32 m0, s32, 98304
    s_add_u32 s56, s33, 221184
    buffer_load_dwordx4 v31, s[52:55], s56 offen nt lds
    s_cmp_ge_u32 s3, 4
    s_cbranch_scc1 .nod_181
    s_add_u32 m0, s32, 106496
    s_add_u32 s56, s33, 294912
    buffer_load_dwordx4 v31, s[52:55], s56 offen nt lds
.nod_181:
    s_branch .gpc_183
.gp_182:
    buffer_load_dwordx4 v[32:35], v2, s[36:39], s99 offen offset:0 sc1
    buffer_load_dwordx4 v[40:43], v2, s[36:39], s99 offen offset:1024 sc1
    buffer_load_dwordx2 v[48:49], v5, s[36:39], s99 offen offset:0 sc1
    buffer_load_dwordx4 v[56:59], v2, s[36:39], s100 offen offset:0 sc1
    buffer_load_dwordx4 v[64:67], v2, s[36:39], s100 offen offset:1024 sc1
    buffer_load_dwordx2 v[50:51], v5, s[36:39], s100 offen offset:0 sc1
    s_waitcnt vmcnt(0)
.gpc_183:
    v_min_u32 v7, v33, v35
    v_max_u32 v8, v33, v35
    v_min3_u32 v7, v7, v41, v43
    v_max3_u32 v8, v8, v41, v43
    v_min3_u32 v7, v7, v49, v57
    v_max3_u32 v8, v8, v49, v57
    v_min3_u32 v7, v7, v59, v65
    v_max3_u32 v8, v8, v59, v65
    v_min3_u32 v7, v7, v67, v51
    v_max3_u32 v8, v8, v67, v51
    v_cmp_eq_u32 vcc, s34, v7
    v_cmp_eq_u32 s[56:57], s34, v8
    s_and_b64 vcc, vcc, s[56:57]
    s_cmp_eq_u64 vcc, exec
    s_nop 2
    s_cbranch_scc1 .gpd_184
    s_sub_u32 s35, s35, 1
    s_cbranch_scc1 .Lexit
    s_sleep 2
    s_branch .gp_182
.gpd_184:
    v_lshlrev_b32 v230, 16, v32
    v_and_b32 v231, 0xffff0000, v32
    v_lshlrev_b32 v240, 16, v56
    v_and_b32 v241, 0xffff0000, v56
    v_lshlrev_b32 v232, 16, v34
    v_and_b32 v233, 0xffff0000, v34
    v_lshlrev_b32 v242, 16, v58
    v_and_b32 v243, 0xffff0000, v58
    v_lshlrev_b32 v234, 16, v40
    v_and_b32 v235, 0xffff0000, v40
    v_lshlrev_b32 v244, 16, v64
    v_and_b32 v245, 0xffff0000, v64
    v_lshlrev_b32 v236, 16, v42
    v_and_b32 v237, 0xffff0000, v42
    v_lshlrev_b32 v246, 16, v66
    v_and_b32 v247, 0xffff0000, v66
    v_lshlrev_b32 v238, 16, v48
    v_and_b32 v239, 0xffff0000, v48
    v_lshlrev_b32 v248, 16, v50
    v_and_b32 v249, 0xffff0000, v50
    s_sub_u32 s63, s65, 9
    s_mul_i32 s42, s64, 18432
    s_mul_i32 s56, s3, 2304
    s_add_u32 s42, s42, s56
    s_add_u32 s42, s42, 0x250000
    s_mul_i32 s41, s64, 36864
    s_add_u32 s41, s41, 0x274000
    s_lshr_b32 s57, s63, 1
    s_lshl3_add_u32 s40, s57, s3
    s_and_b32 s63, s63, 1
    s_lshl1_add_u32 s40, s40, s63
    s_lshl_b32 s40, s40, 8
    s_add_u32 s40, s40, s41
    s_mul_i32 s56, s63, 18432
    s_add_u32 s41, s41, s56
    s_mul_i32 s43, s3, 9
    s_add_u32 s43, s43, s57
    s_lshl3_add_u32 s43, s43, s64
    s_lshl1_add_u32 s43, s43, s63
    s_lshl_b32 s43, s43, 8
    s_add_u32 s43, s43, 0x38c000
    v_mov_b32 v143, s34
    s_add_u32 s57, s40, 0xac000
    s_mov_b64 exec, 0xffff
    buffer_load_dwordx4 v[80:83], v2, s[36:39], s57 offen offset:0
    s_mov_b64 exec, -1
    s_waitcnt vmcnt(5)
    s_barrier
    ds_read_b64_tr_b16 v[160:161], v19 offset:0
    ds_read_b64_tr_b16 v[162:163], v19 offset:512
    ds_read_b64_tr_b16 v[164:165], v19 offset:8192
    ds_read_b64_tr_b16 v[166:167], v19 offset:8704
    ds_read_b64_tr_b16 v[168:169], v19 offset:16384
    ds_read_b64_tr_b16 v[170:171], v19 offset:16896
    ds_read_b64_tr_b16 v[172:173], v19 offset:24576
    ds_read_b64_tr_b16 v[174:175], v19 offset:25088
    ds_read_b64_tr_b16 v[176:177], v20 offset:0
    ds_read_b64_tr_b16 v[178:179], v20 offset:512
    ds_read_b64_tr_b16 v[180:181], v20 offset:8192
    ds_read_b64_tr_b16 v[182:183], v20 offset:8704
    ds_read_b64_tr_b16 v[184:185], v20 offset:16384
    ds_read_b64_tr_b16 v[186:187], v20 offset:16896
    ds_read_b64_tr_b16 v[188:189], v20 offset:24576
    ds_read_b64_tr_b16 v[190:191], v20 offset:25088
    ds_read_b64_tr_b16 v[192:193], v20 offset:32768
    ds_read_b64_tr_b16 v[194:195], v20 offset:33280
.Lbc_x:
    s_add_u32 s58, s42, s0
    s_mov_b32 s32, 0
    s_mov_b64 s[88:89], exec
    s_mov_b64 s[90:91], exec
    s_mov_b64 s[92:93], exec
.mp_185:
    s_mov_b64 exec, s[88:89]
    buffer_load_dwordx4 v[144:147], v2, s[36:39], s58 offen offset:0 sc1
    s_mov_b64 exec, s[90:91]
    buffer_load_dwordx4 v[148:151], v2, s[36:39], s58 offen offset:1024 sc1
    s_mov_b64 exec, s[92:93]
    buffer_load_dwordx2 v[152:153], v5, s[36:39], s58 offen offset:0 sc1
    s_mov_b64 exec, -1
    s_sub_u32 s35, s35, 1
    s_cbranch_scc1 .Lexit
    s_add_u32 s32, s32, 1
    s_cmp_eq_u32 s32, 64
    s_cselect_b32 s58, s42, s58
    s_waitcnt vmcnt(0)
.mpj_186:
    v_cmp_ne_u32 s[88:89], s34, v145
    v_cmp_ne_u32 vcc, s34, v147
    s_or_b64 s[88:89], s[88:89], vcc
    v_cmp_ne_u32 s[90:91], s34, v149
    v_cmp_ne_u32 vcc, s34, v151
    s_or_b64 s[90:91], s[90:91], vcc
    v_cmp_ne_u32 s[92:93], s34, v153
    s_or_b64 vcc, s[88:89], s[90:91]
    s_or_b64 vcc, vcc, s[92:93]
    s_cbranch_scc1 .mp_185
    s_mov_b32 s56, 0x3f803f80
    v_dot2_f32_bf16 v250, v144, s56, 0
    v_dot2_f32_bf16 v251, v144, v144, 0
    v_dot2_f32_bf16 v250, v146, s56, v250
    v_dot2_f32_bf16 v251, v146, v146, v251
    v_dot2_f32_bf16 v250, v148, s56, v250
    v_dot2_f32_bf16 v251, v148, v148, v251
    v_dot2_f32_bf16 v250, v150, s56, v250
    v_dot2_f32_bf16 v251, v150, v150, v251
    s_mov_b64 exec, 0xffffffff
    v_dot2_f32_bf16 v250, v152, s56, v250
    v_dot2_f32_bf16 v251, v152, v152, v251
    s_mov_b64 exec, -1
    s_nop 1
    v_permlane32_swap_b32 v250, v251
    v_add_f32 v250, v250, v251
    v_mov_b32 v252, v250
    s_nop 1
    v_permlane16_swap_b32 v252, v250
    v_add_f32 v250, v252, v250
    v_lshlrev_b32 v220, 16, v144
    v_and_b32 v221, 0xffff0000, v144
    v_add_f32_dpp v250, v250, v250 row_ror:8 row_mask:0xf bank_mask:0xf
    v_lshlrev_b32 v222, 16, v146
    v_and_b32 v223, 0xffff0000, v146
    v_add_f32_dpp v250, v250, v250 row_ror:4 row_mask:0xf bank_mask:0xf
    v_lshlrev_b32 v224, 16, v148
    v_and_b32 v225, 0xffff0000, v148
    v_add_f32_dpp v250, v250, v250 quad_perm:[2,3,0,1] row_mask:0xf bank_mask:0xf
    v_lshlrev_b32 v226, 16, v150
    v_and_b32 v227, 0xffff0000, v150
    v_add_f32_dpp v250, v250, v250 quad_perm:[1,0,3,2] row_mask:0xf bank_mask:0xf
    v_mul_f32 v250, 0x3ae38e39, v250
    v_lshlrev_b32 v228, 16, v152
    v_and_b32 v229, 0xffff0000, v152
    v_readlane_b32 s56, v250, 0
    v_readlane_b32 s57, v250, 32
    s_nop 0
    v_mov_b32 v250, s56
    v_fma_f32 v251, -v250, v250, s57
    v_max_f32 v251, 0, v251
    v_add_f32 v251, 0x3727c5ac, v251
    v_rsq_f32 v252, v251
    s_nop 0
    v_mul_f32 v251, -v250, v252
    v_mul_f32 v250, -v250, v252
    v_mov_b32 v253, v252
    v_pk_fma_f32 v[220:221], v[220:221], v[252:253], v[250:251]
    v_pk_fma_f32 v[222:223], v[222:223], v[252:253], v[250:251]
    v_pk_fma_f32 v[224:225], v[224:225], v[252:253], v[250:251]
    v_pk_fma_f32 v[226:227], v[226:227], v[252:253], v[250:251]
    v_pk_fma_f32 v[228:229], v[228:229], v[252:253], v[250:251]
    v_pk_fma_f32 v[220:221], v[220:221], v[240:241], v[230:231]
    v_pk_fma_f32 v[222:223], v[222:223], v[242:243], v[232:233]
    v_pk_fma_f32 v[224:225], v[224:225], v[244:245], v[234:235]
    v_pk_fma_f32 v[226:227], v[226:227], v[246:247], v[236:237]
    v_pk_fma_f32 v[228:229], v[228:229], v[248:249], v[238:239]
    v_cvt_pk_bf16_f32 v154, v220, v221
    v_cvt_pk_bf16_f32 v155, v222, v223
    v_cvt_pk_bf16_f32 v156, v224, v225
    v_cvt_pk_bf16_f32 v157, v226, v227
    v_cvt_pk_bf16_f32 v158, v228, v229
    ds_write_b64 v17, v[154:155]
    ds_write_b64 v17, v[156:157] offset:512
    ds_write_b32 v18, v158
    s_waitcnt lgkmcnt(0)
    s_barrier
    ds_read_b128 v[96:99], v16 offset:0
    ds_read_b128 v[100:103], v16 offset:128
    ds_read_b128 v[104:107], v16 offset:256
    ds_read_b128 v[108:111], v16 offset:384
    ds_read_b128 v[112:115], v16 offset:512
    ds_read_b128 v[116:119], v16 offset:640
    ds_read_b128 v[120:123], v16 offset:768
    ds_read_b128 v[124:127], v16 offset:896
    ds_read_b128 v[128:131], v16 offset:1024
    s_waitcnt lgkmcnt(8)
    v_mfma_f32_16x16x32_bf16 v[132:135], v[160:163], v[96:99], 0
    s_waitcnt lgkmcnt(7)
    v_mfma_f32_16x16x32_bf16 v[132:135], v[164:167], v[100:103], v[132:135]
    s_waitcnt lgkmcnt(6)
    v_mfma_f32_16x16x32_bf16 v[132:135], v[168:171], v[104:107], v[132:135]
    s_waitcnt lgkmcnt(5)
    v_mfma_f32_16x16x32_bf16 v[132:135], v[172:175], v[108:111], v[132:135]
    s_waitcnt lgkmcnt(4)
    v_mfma_f32_16x16x32_bf16 v[132:135], v[176:179], v[112:115], v[132:135]
    s_waitcnt lgkmcnt(3)
    v_mfma_f32_16x16x32_bf16 v[132:135], v[180:183], v[116:119], v[132:135]
    s_waitcnt lgkmcnt(2)
    v_mfma_f32_16x16x32_bf16 v[132:135], v[184:187], v[120:123], v[132:135]
    s_waitcnt lgkmcnt(1)
    v_mfma_f32_16x16x32_bf16 v[132:135], v[188:191], v[124:127], v[132:135]
    s_waitcnt lgkmcnt(0)
    v_mfma_f32_16x16x32_bf16 v[132:135], v[192:195], v[128:131], v[132:135]
    s_cmp_lg_u32 s63, 0
    s_nop 6
    v_permlane32_swap_b32 v132, v134
    v_permlane32_swap_b32 v133, v135
    v_cndmask_b32 v133, v133, v134, s[96:97]
    v_cndmask_b32 v132, v132, v135, s[96:97]
    s_nop 1
    v_add_f32_dpp v12, v133, v132 quad_perm:[1,0,3,2] row_mask:0xf bank_mask:0xf
    s_nop 1
    s_cbranch_scc1 .up_189
    v_mul_f32 v7, 0xbfb8aa3b, v12
    v_exp_f32 v7, v7
    s_nop 0
    v_add_f32 v7, 1.0, v7
    v_rcp_f32 v7, v7
    s_nop 0
    v_mul_f32 v12, v12, v7
.up_189:
    s_nop 1
    v_mov_b32_dpp v137, v12 quad_perm:[0,0,2,2] row_mask:0xf bank_mask:0xf
    v_mov_b32_dpp v139, v12 quad_perm:[1,1,3,3] row_mask:0xf bank_mask:0xf
    v_cvt_pk_bf16_f32 v136, v137, v139
    v_cvt_pk_bf16_f32 v138, v137, v139
    v_mov_b32 v137, s34
    v_mov_b32 v139, s34
    v_permlane32_swap_b32 v136, v138
    s_mov_b64 exec, 0x55555555
    s_add_u32 s57, s40, 0xac000
    buffer_store_dwordx4 v[136:139], v26, s[36:39], s57 offen
    s_cmp_lg_u32 s0, 0
    s_cbranch_scc1 2
    buffer_store_dwordx4 v[136:139], v26, s[36:39], s40 offen sc1
    s_mov_b64 exec, -1
    s_barrier
    ds_read_b64_tr_b16 v[196:197], v21 offset:0
    ds_read_b64_tr_b16 v[198:199], v21 offset:512
    ds_read_b64_tr_b16 v[208:209], v22 offset:0
    ds_read_b64_tr_b16 v[210:211], v22 offset:512
    ds_read_b64_tr_b16 v[200:201], v21 offset:4096
    ds_read_b64_tr_b16 v[202:203], v21 offset:4608
    ds_read_b64_tr_b16 v[212:213], v22 offset:4096
    ds_read_b64_tr_b16 v[214:215], v22 offset:4608
    ds_read_b64_tr_b16 v[204:205], v21 offset:8192
    ds_read_b64_tr_b16 v[206:207], v21 offset:8704
    ds_read_b64_tr_b16 v[216:217], v22 offset:8192
    ds_read_b64_tr_b16 v[218:219], v22 offset:8704
    s_add_u32 s58, s41, s0
    s_mov_b32 s32, 0
    s_mov_b64 s[88:89], exec
    s_mov_b64 s[90:91], exec
    s_and_b64 s[92:93], exec, 0xff
    s_and_b64 s[56:57], exec, 0xff
.mp_190:
    s_mov_b64 exec, s[88:89]
    buffer_load_dwordx4 v[160:163], v27, s[36:39], s58 offen offset:0 sc1
    s_mov_b64 exec, s[90:91]
    buffer_load_dwordx4 v[164:167], v27, s[36:39], s58 offen offset:256 sc1
    s_mov_b64 exec, s[92:93]
    buffer_load_dwordx4 v[168:171], v28, s[36:39], s58 offen offset:0 sc1
    s_mov_b64 exec, s[56:57]
    buffer_load_dwordx4 v[172:175], v28, s[36:39], s58 offen offset:256 sc1
    s_mov_b64 exec, -1
    s_sub_u32 s35, s35, 1
    s_cbranch_scc1 .Lexit
    s_add_u32 s32, s32, 1
    s_cmp_eq_u32 s32, 64
    s_cselect_b32 s58, s41, s58
    s_cbranch_scc0 .mpi_192
    s_mov_b64 exec, 0x55555555
    buffer_store_dwordx4 v[136:139], v26, s[36:39], s40 offen sc1
    s_mov_b64 exec, -1
.mpi_192:
    s_waitcnt vmcnt(0)
.mpj_191:
    v_cmp_ne_u32 s[88:89], s34, v161
    v_cmp_ne_u32 vcc, s34, v163
    s_or_b64 s[88:89], s[88:89], vcc
    v_cmp_ne_u32 s[90:91], s34, v165
    v_cmp_ne_u32 vcc, s34, v167
    s_or_b64 s[90:91], s[90:91], vcc
    v_cmp_ne_u32 s[92:93], s34, v169
    v_cmp_ne_u32 vcc, s34, v171
    s_or_b64 s[92:93], s[92:93], vcc
    s_and_b64 s[92:93], s[92:93], 0xff
    v_cmp_ne_u32 s[56:57], s34, v173
    v_cmp_ne_u32 vcc, s34, v175
    s_or_b64 s[56:57], s[56:57], vcc
    s_and_b64 s[56:57], s[56:57], 0xff
    s_or_b64 vcc, s[88:89], s[90:91]
    s_or_b64 vcc, vcc, s[92:93]
    s_or_b64 vcc, vcc, s[56:57]
    s_cbranch_scc1 .mp_190
    v_and_b32 v161, 0xffff0000, v160
    v_lshlrev_b32 v160, 16, v160
    v_and_b32 v163, 0xffff0000, v162
    v_lshlrev_b32 v162, 16, v162
    v_and_b32 v165, 0xffff0000, v164
    v_lshlrev_b32 v164, 16, v164
    v_and_b32 v167, 0xffff0000, v166
    v_lshlrev_b32 v166, 16, v166
    v_and_b32 v169, 0xffff0000, v168
    v_lshlrev_b32 v168, 16, v168
    v_and_b32 v171, 0xffff0000, v170
    v_lshlrev_b32 v170, 16, v170
    v_and_b32 v173, 0xffff0000, v172
    v_lshlrev_b32 v172, 16, v172
    v_and_b32 v175, 0xffff0000, v174
    v_lshlrev_b32 v174, 16, v174
    v_pk_mul_f32 v[160:161], v[160:161], v[164:165]
    v_pk_mul_f32 v[162:163], v[162:163], v[166:167]
    v_pk_mul_f32 v[168:169], v[168:169], v[172:173]
    v_pk_mul_f32 v[170:171], v[170:171], v[174:175]
    v_cvt_pk_bf16_f32 v160, v160, v161
    v_cvt_pk_bf16_f32 v161, v162, v163
    v_cvt_pk_bf16_f32 v168, v168, v169
    v_cvt_pk_bf16_f32 v169, v170, v171
    ds_write_b64 v29, v[160:161]
    s_mov_b64 exec, 0xff
    ds_write_b64 v30, v[168:169]
    s_mov_b64 exec, -1
    s_mov_b64 exec, 0x55555555
    buffer_store_dwordx4 v[136:139], v26, s[36:39], s40 offen sc1
    s_mov_b64 exec, -1
    s_waitcnt lgkmcnt(0)
    s_barrier
    s_cmp_ge_u32 s3, 6
    s_cbranch_scc1 .tg_194
    ds_read_b128 v[96:99], v23 offset:0
    ds_read_b128 v[100:103], v23 offset:64
    ds_read_b128 v[104:107], v23 offset:128
    s_waitcnt lgkmcnt(2)
    v_mfma_f32_16x16x32_bf16 v[132:135], v[196:199], v[96:99], 0
    v_mfma_f32_16x16x32_bf16 v[136:139], v[208:211], v[96:99], 0
    s_waitcnt lgkmcnt(1)
    v_mfma_f32_16x16x32_bf16 v[132:135], v[200:203], v[100:103], v[132:135]
    v_mfma_f32_16x16x32_bf16 v[136:139], v[212:215], v[100:103], v[136:139]
    s_waitcnt lgkmcnt(0)
    v_mfma_f32_16x16x32_bf16 v[132:135], v[204:207], v[104:107], v[132:135]
    v_mfma_f32_16x16x32_bf16 v[136:139], v[216:219], v[104:107], v[136:139]
    s_nop 7
    v_cndmask_b32 v132, v132, v136, s[96:97]
    v_cndmask_b32 v133, v133, v137, s[96:97]
    v_cndmask_b32 v134, v134, v138, s[96:97]
    v_cndmask_b32 v135, v135, v139, s[96:97]
    ds_write_b128 v24, v[132:135]
    s_waitcnt lgkmcnt(0)
.tg_194:
    s_barrier
    ds_read_b128 v[112:115], v25 offset:0
    ds_read_b128 v[116:119], v25 offset:2176
    ds_read_b128 v[120:123], v25 offset:4352
    s_mov_b32 s60, 0x07060503
    s_mov_b32 s61, 0x07060502
    s_mov_b32 s62, 0x07060501
    s_waitcnt lgkmcnt(1)
    v_pk_add_f32 v[112:113], v[112:113], v[116:117]
    v_pk_add_f32 v[114:115], v[114:115], v[118:119]
    s_waitcnt lgkmcnt(0)
    v_pk_add_f32 v[112:113], v[112:113], v[120:121]
    v_pk_add_f32 v[114:115], v[114:115], v[122:123]
    v_perm_b32 v140, v112, v115, s60
    v_perm_b32 v141, v113, v115, s61
    v_perm_b32 v142, v114, v115, s62
    s_mov_b64 exec, 0xffff
    buffer_store_dwordx4 v[140:143], v2, s[36:39], s43 offen sc1
    s_mov_b64 exec, -1
    s_nop 0
    s_branch .Lexit
.Latt_n:
    v_and_b32 v8, 1, v0
    v_lshlrev_b32 v8, 8, v8
    v_and_b32 v9, 0x3c, v0
    v_lshl_add_u32 v9, v9, 2, v8
    v_lshlrev_b32 v7, 1, v9
    v_and_b32 v9, 0x3c, v0
    v_lshrrev_b32 v8, 4, v8
    v_and_b32 v9, 2, v0
    v_lshl_add_u32 v9, v9, 6, v8
    s_lshl_b32 s58, s66, 14
    s_lshl_b32 s59, s67, 10
    s_add_u32 s58, s58, s59
    s_add_u32 s58, s58, 0x40000
    s_lshl4_add_u32 s59, s66, s67
    s_lshl_b32 s59, s59, 8
    s_add_u32 s59, s59, 0x200000
    s_memrealtime s[8:9]
    s_waitcnt vmcnt(8)
    s_waitcnt lgkmcnt(0)
    s_sub_u32 s8, s8, s30
    s_cmpk_ge_u32 s8, 1147
    s_cbranch_scc1 .ap_195
    s_waitcnt vmcnt(5)
    s_cmpk_ge_u32 s8, 1082
    s_cbranch_scc1 .ap_195
    s_waitcnt vmcnt(3)
    s_bitcmp1_b64 s[14:15], 26
    s_cbranch_scc0 1
    s_waitcnt vmcnt(2)
    s_cmpk_ge_u32 s8, 1007
    s_cbranch_scc1 .ap_195
    s_waitcnt vmcnt(1)
.ap_195:
    s_add_u32 s63, s69, 409600
    buffer_load_dwordx4 v[88:91], v1, s[40:43], s63 offen nt
    s_memrealtime s[8:9]
    s_waitcnt vmcnt(8)
    s_waitcnt lgkmcnt(0)
    s_sub_u32 s8, s8, s30
    s_cmpk_ge_u32 s8, 1174
    s_cbranch_scc1 .ap_196
    s_waitcnt vmcnt(5)
    s_cmpk_ge_u32 s8, 1109
    s_cbranch_scc1 .ap_196
    s_waitcnt vmcnt(3)
    s_bitcmp1_b64 s[14:15], 27
    s_cbranch_scc0 1
    s_waitcnt vmcnt(2)
    s_cmpk_ge_u32 s8, 1034
    s_cbranch_scc1 .ap_196
    s_waitcnt vmcnt(1)
.ap_196:
    s_add_u32 s63, s69, 417792
    buffer_load_dwordx4 v[92:95], v1, s[40:43], s63 offen nt
    s_memrealtime s[8:9]
    s_waitcnt vmcnt(8)
    s_waitcnt lgkmcnt(0)
    s_sub_u32 s8, s8, s30
    s_cmpk_ge_u32 s8, 1201
    s_cbranch_scc1 .ap_197
    s_waitcnt vmcnt(5)
    s_cmpk_ge_u32 s8, 1136
    s_cbranch_scc1 .ap_197
    s_waitcnt vmcnt(3)
    s_bitcmp1_b64 s[14:15], 28
    s_cbranch_scc0 1
    s_waitcnt vmcnt(2)
    s_cmpk_ge_u32 s8, 1061
    s_cbranch_scc1 .ap_197
    s_waitcnt vmcnt(1)
.ap_197:
    s_add_u32 s63, s69, 425984
    buffer_load_dwordx4 v[120:123], v1, s[40:43], s63 offen nt
    s_memrealtime s[8:9]
    s_waitcnt vmcnt(8)
    s_waitcnt lgkmcnt(0)
    s_sub_u32 s8, s8, s30
    s_cmpk_ge_u32 s8, 1228
    s_cbranch_scc1 .ap_198
    s_waitcnt vmcnt(5)
    s_cmpk_ge_u32 s8, 1163
    s_cbranch_scc1 .ap_198
    s_waitcnt vmcnt(3)
    s_bitcmp1_b64 s[14:15], 29
    s_cbranch_scc0 1
    s_waitcnt vmcnt(2)
    s_cmpk_ge_u32 s8, 1088
    s_cbranch_scc1 .ap_198
    s_waitcnt vmcnt(1)
.ap_198:
    s_add_u32 s63, s69, 434176
    buffer_load_dwordx4 v[124:127], v1, s[40:43], s63 offen nt
    s_memrealtime s[8:9]
    s_waitcnt vmcnt(8)
    s_waitcnt lgkmcnt(0)
    s_sub_u32 s8, s8, s30
    s_cmpk_ge_u32 s8, 1255
    s_cbranch_scc1 .ap_199
    s_waitcnt vmcnt(5)
    s_cmpk_ge_u32 s8, 1190
    s_cbranch_scc1 .ap_199
    s_waitcnt vmcnt(3)
    s_bitcmp1_b64 s[14:15], 30
    s_cbranch_scc0 1
    s_waitcnt vmcnt(2)
    s_cmpk_ge_u32 s8, 1115
    s_cbranch_scc1 .ap_199
    s_waitcnt vmcnt(1)
.ap_199:
    s_add_u32 s63, s69, 442368
    buffer_load_dwordx4 v[152:155], v1, s[40:43], s63 offen nt
    s_memrealtime s[8:9]
    s_waitcnt vmcnt(8)
    s_waitcnt lgkmcnt(0)
    s_sub_u32 s8, s8, s30
    s_cmpk_ge_u32 s8, 1282
    s_cbranch_scc1 .ap_200
    s_waitcnt vmcnt(5)
    s_cmpk_ge_u32 s8, 1217
    s_cbranch_scc1 .ap_200
    s_waitcnt vmcnt(3)
    s_bitcmp1_b64 s[14:15], 31
    s_cbranch_scc0 1
    s_waitcnt vmcnt(2)
    s_cmpk_ge_u32 s8, 1142
    s_cbranch_scc1 .ap_200
    s_waitcnt vmcnt(1)
.ap_200:
    s_add_u32 s63, s69, 450560
    buffer_load_dwordx4 v[156:159], v1, s[40:43], s63 offen nt
    buffer_load_dwordx4 v[16:19], v7, s[36:39], s58 offen offset:0 sc1
    buffer_load_dwordx4 v[20:23], v7, s[36:39], s58 offen offset:16 sc1
    s_memrealtime s[8:9]
    s_waitcnt vmcnt(8)
    s_waitcnt lgkmcnt(0)
    s_sub_u32 s8, s8, s30
    s_cmpk_ge_u32 s8, 1309
    s_cbranch_scc1 .ap_201
    s_waitcnt vmcnt(5)
    s_cmpk_ge_u32 s8, 1244
    s_cbranch_scc1 .ap_201
    s_waitcnt vmcnt(3)
    s_bitcmp1_b64 s[14:15], 32
    s_cbranch_scc0 1
    s_waitcnt vmcnt(2)
    s_cmpk_ge_u32 s8, 1169
    s_cbranch_scc1 .ap_201
    s_waitcnt vmcnt(1)
.ap_201:
    s_add_u32 s63, s69, 0
    buffer_load_dwordx4 v[160:163], v2, s[44:47], s63 offen nt
    s_memrealtime s[8:9]
    s_waitcnt vmcnt(8)
    s_waitcnt lgkmcnt(0)
    s_sub_u32 s8, s8, s30
    s_cmpk_ge_u32 s8, 1336
    s_cbranch_scc1 .ap_202
    s_waitcnt vmcnt(5)
    s_cmpk_ge_u32 s8, 1271
    s_cbranch_scc1 .ap_202
    s_waitcnt vmcnt(3)
    s_bitcmp1_b64 s[14:15], 33
    s_cbranch_scc0 1
    s_waitcnt vmcnt(2)
    s_cmpk_ge_u32 s8, 1196
    s_cbranch_scc1 .ap_202
    s_waitcnt vmcnt(1)
.ap_202:
    s_add_u32 s63, s69, 8192
    buffer_load_dwordx4 v[164:167], v2, s[44:47], s63 offen nt
    s_memrealtime s[8:9]
    s_waitcnt vmcnt(8)
    s_waitcnt lgkmcnt(0)
    s_sub_u32 s8, s8, s30
    s_cmpk_ge_u32 s8, 1363
    s_cbranch_scc1 .ap_203
    s_waitcnt vmcnt(5)
    s_cmpk_ge_u32 s8, 1298
    s_cbranch_scc1 .ap_203
    s_waitcnt vmcnt(3)
    s_bitcmp1_b64 s[14:15], 34
    s_cbranch_scc0 1
    s_waitcnt vmcnt(2)
    s_cmpk_ge_u32 s8, 1223
    s_cbranch_scc1 .ap_203
    s_waitcnt vmcnt(1)
.ap_203:
    s_add_u32 s63, s69, 16384
    buffer_load_dwordx4 v[168:171], v2, s[44:47], s63 offen nt
    s_waitcnt vmcnt(3)
    s_branch .gpc_205
.gp_204:
    buffer_load_dwordx4 v[16:19], v7, s[36:39], s58 offen offset:0 sc1
    buffer_load_dwordx4 v[20:23], v7, s[36:39], s58 offen offset:16 sc1
    s_waitcnt vmcnt(0)
.gpc_205:
    v_min_u32 v10, v17, v19
    v_max_u32 v11, v17, v19
    v_min3_u32 v10, v10, v21, v23
    v_max3_u32 v11, v11, v21, v23
    v_cmp_eq_u32 vcc, s34, v10
    v_cmp_eq_u32 s[56:57], s34, v11
    s_and_b64 vcc, vcc, s[56:57]
    s_cmp_eq_u64 vcc, exec
    s_nop 2
    s_cbranch_scc1 .gpd_206
    s_sub_u32 s35, s35, 1
    s_cbranch_scc1 .Lexit
    s_sleep 1
    s_branch .gp_204
.gpd_206:
    s_mov_b32 vcc_lo, 0xcccccccc
    s_mov_b32 vcc_hi, 0xcccccccc
    v_cndmask_b32_e64 v24, v16, 0, vcc
    v_cndmask_b32_e64 v25, v18, 0, vcc
    v_cndmask_b32_e64 v26, v20, 0, vcc
    v_cndmask_b32_e64 v27, v22, 0, vcc
    v_cndmask_b32_e32 v28, 0, v16, vcc
    v_cndmask_b32_e32 v29, 0, v18, vcc
    v_cndmask_b32_e32 v30, 0, v20, vcc
    v_cndmask_b32_e32 v31, 0, v22, vcc
    v_mfma_f32_16x16x32_bf16 v[16:19], v[32:35], v[24:27], 0
    v_mfma_f32_16x16x32_bf16 v[32:35], v[40:43], v[24:27], 0
    v_mfma_f32_16x16x32_bf16 v[16:19], v[36:39], v[28:31], v[16:19]
    v_mfma_f32_16x16x32_bf16 v[40:43], v[48:51], v[24:27], 0
    v_mfma_f32_16x16x32_bf16 v[32:35], v[44:47], v[28:31], v[32:35]
    v_mfma_f32_16x16x32_bf16 v[48:51], v[56:59], v[24:27], 0
    v_mfma_f32_16x16x32_bf16 v[40:43], v[52:55], v[28:31], v[40:43]
    v_mfma_f32_16x16x32_bf16 v[56:59], v[64:67], v[24:27], 0
    v_mfma_f32_16x16x32_bf16 v[48:51], v[60:63], v[28:31], v[48:51]
    s_nop 1
    v_add_f32_dpp v10, v17, v16 row_ror:12 row_mask:0xf bank_mask:0x1
    s_memrealtime s[8:9]
    s_waitcnt lgkmcnt(0)
    s_sub_u32 s8, s8, s30
    s_cmpk_ge_u32 s8, 1390
    s_nop 0
    s_cbranch_scc1 .ap_207
    s_waitcnt vmcnt(3)
    s_cmpk_ge_u32 s8, 1325
    s_cbranch_scc1 .ap_207
    s_waitcnt vmcnt(3)
    s_bitcmp1_b64 s[14:15], 35
    s_cbranch_scc0 1
    s_waitcnt vmcnt(2)
    s_cmpk_ge_u32 s8, 1250
    s_cbranch_scc1 .ap_207
    s_waitcnt vmcnt(1)
.ap_207:
    s_add_u32 s63, s69, 24576
    buffer_load_dwordx4 v[172:175], v2, s[44:47], s63 offen nt
    v_mfma_f32_16x16x32_bf16 v[64:67], v[72:75], v[24:27], 0
    v_mfma_f32_16x16x32_bf16 v[56:59], v[68:71], v[28:31], v[56:59]
    v_add_f32_dpp v11, v33, v32 row_ror:12 row_mask:0xf bank_mask:0x1
    v_add_f32_dpp v10, v18, v10 row_ror:8 row_mask:0xf bank_mask:0x1
    v_mfma_f32_16x16x32_bf16 v[72:75], v[80:83], v[24:27], 0
    v_mfma_f32_16x16x32_bf16 v[64:67], v[76:79], v[28:31], v[64:67]
    v_add_f32_dpp v12, v41, v40 row_ror:12 row_mask:0xf bank_mask:0x1
    v_add_f32_dpp v11, v34, v11 row_ror:8 row_mask:0xf bank_mask:0x1
    v_add_f32_dpp v10, v19, v10 row_ror:4 row_mask:0xf bank_mask:0x1
    v_mfma_f32_16x16x32_bf16 v[80:83], v[88:91], v[24:27], 0
    v_mfma_f32_16x16x32_bf16 v[72:75], v[84:87], v[28:31], v[72:75]
    v_add_f32_dpp v13, v49, v48 row_ror:12 row_mask:0xf bank_mask:0x1
    v_add_f32_dpp v12, v42, v12 row_ror:8 row_mask:0xf bank_mask:0x1
    v_add_f32_dpp v11, v35, v11 row_ror:4 row_mask:0xf bank_mask:0x1
    v_mfma_f32_16x16x32_bf16 v[88:91], v[96:99], v[24:27], 0
    v_mfma_f32_16x16x32_bf16 v[80:83], v[92:95], v[28:31], v[80:83]
    v_add_f32_dpp v10, v58, v57 row_ror:12 row_mask:0xf bank_mask:0x2
    v_add_f32_dpp v13, v50, v13 row_ror:8 row_mask:0xf bank_mask:0x1
    v_add_f32_dpp v12, v43, v12 row_ror:4 row_mask:0xf bank_mask:0x1
    s_memrealtime s[8:9]
    s_waitcnt lgkmcnt(0)
    s_sub_u32 s8, s8, s30
    s_cmpk_ge_u32 s8, 1417
    s_nop 0
    s_cbranch_scc1 .ap_208
    s_waitcnt vmcnt(4)
    s_cmpk_ge_u32 s8, 1352
    s_cbranch_scc1 .ap_208
    s_waitcnt vmcnt(3)
    s_bitcmp1_b64 s[14:15], 36
    s_cbranch_scc0 1
    s_waitcnt vmcnt(2)
    s_cmpk_ge_u32 s8, 1277
    s_cbranch_scc1 .ap_208
    s_waitcnt vmcnt(1)
.ap_208:
    s_add_u32 s63, s69, 32768
    buffer_load_dwordx4 v[176:179], v2, s[44:47], s63 offen nt
    v_mfma_f32_16x16x32_bf16 v[96:99], v[104:107], v[24:27], 0
    v_mfma_f32_16x16x32_bf16 v[88:91], v[100:103], v[28:31], v[88:91]
    v_add_f32_dpp v11, v66, v65 row_ror:12 row_mask:0xf bank_mask:0x2
    v_add_f32_dpp v10, v59, v10 row_ror:8 row_mask:0xf bank_mask:0x2
    v_add_f32_dpp v13, v51, v13 row_ror:4 row_mask:0xf bank_mask:0x1
    v_mfma_f32_16x16x32_bf16 v[104:107], v[112:115], v[24:27], 0
    v_mfma_f32_16x16x32_bf16 v[96:99], v[108:111], v[28:31], v[96:99]
    v_add_f32_dpp v12, v74, v73 row_ror:12 row_mask:0xf bank_mask:0x2
    v_add_f32_dpp v11, v67, v11 row_ror:8 row_mask:0xf bank_mask:0x2
    v_add_f32_dpp v10, v56, v10 row_ror:4 row_mask:0xf bank_mask:0x2
    v_mfma_f32_16x16x32_bf16 v[112:115], v[120:123], v[24:27], 0
    v_mfma_f32_16x16x32_bf16 v[104:107], v[116:119], v[28:31], v[104:107]
    v_add_f32_dpp v13, v82, v81 row_ror:12 row_mask:0xf bank_mask:0x2
    v_add_f32_dpp v12, v75, v12 row_ror:8 row_mask:0xf bank_mask:0x2
    v_add_f32_dpp v11, v64, v11 row_ror:4 row_mask:0xf bank_mask:0x2
    v_mfma_f32_16x16x32_bf16 v[120:123], v[128:131], v[24:27], 0
    v_mfma_f32_16x16x32_bf16 v[112:115], v[124:127], v[28:31], v[112:115]
    v_add_f32_dpp v10, v91, v90 row_ror:12 row_mask:0xf bank_mask:0x4
    v_add_f32_dpp v13, v83, v13 row_ror:8 row_mask:0xf bank_mask:0x2
    v_add_f32_dpp v12, v72, v12 row_ror:4 row_mask:0xf bank_mask:0x2
    s_memrealtime s[8:9]
    s_waitcnt lgkmcnt(0)
    s_sub_u32 s8, s8, s30
    s_cmpk_ge_u32 s8, 1444
    s_nop 0
    s_cbranch_scc1 .ap_209
    s_waitcnt vmcnt(5)
    s_cmpk_ge_u32 s8, 1379
    s_cbranch_scc1 .ap_209
    s_waitcnt vmcnt(3)
    s_bitcmp1_b64 s[14:15], 37
    s_cbranch_scc0 1
    s_waitcnt vmcnt(2)
    s_cmpk_ge_u32 s8, 1304
    s_cbranch_scc1 .ap_209
    s_waitcnt vmcnt(1)
.ap_209:
    s_add_u32 s63, s69, 40960
    buffer_load_dwordx4 v[180:183], v2, s[44:47], s63 offen nt
    v_mfma_f32_16x16x32_bf16 v[128:131], v[136:139], v[24:27], 0
    v_mfma_f32_16x16x32_bf16 v[120:123], v[132:135], v[28:31], v[120:123]
    v_add_f32_dpp v11, v99, v98 row_ror:12 row_mask:0xf bank_mask:0x4
    v_add_f32_dpp v10, v88, v10 row_ror:8 row_mask:0xf bank_mask:0x4
    v_add_f32_dpp v13, v80, v13 row_ror:4 row_mask:0xf bank_mask:0x2
    v_mfma_f32_16x16x32_bf16 v[136:139], v[144:147], v[24:27], 0
    v_mfma_f32_16x16x32_bf16 v[128:131], v[140:143], v[28:31], v[128:131]
    v_add_f32_dpp v12, v107, v106 row_ror:12 row_mask:0xf bank_mask:0x4
    v_add_f32_dpp v11, v96, v11 row_ror:8 row_mask:0xf bank_mask:0x4
    v_add_f32_dpp v10, v89, v10 row_ror:4 row_mask:0xf bank_mask:0x4
    v_mfma_f32_16x16x32_bf16 v[144:147], v[152:155], v[24:27], 0
    v_mfma_f32_16x16x32_bf16 v[136:139], v[148:151], v[28:31], v[136:139]
    v_add_f32_dpp v13, v115, v114 row_ror:12 row_mask:0xf bank_mask:0x4
    v_add_f32_dpp v12, v104, v12 row_ror:8 row_mask:0xf bank_mask:0x4
    v_add_f32_dpp v11, v97, v11 row_ror:4 row_mask:0xf bank_mask:0x4
    v_mfma_f32_16x16x32_bf16 v[144:147], v[156:159], v[28:31], v[144:147]
    v_add_f32_dpp v10, v120, v123 row_ror:12 row_mask:0xf bank_mask:0x8
    v_add_f32_dpp v13, v112, v13 row_ror:8 row_mask:0xf bank_mask:0x4
    v_add_f32_dpp v12, v105, v12 row_ror:4 row_mask:0xf bank_mask:0x4
    s_memrealtime s[8:9]
    s_waitcnt lgkmcnt(0)
    s_sub_u32 s8, s8, s30
    s_cmpk_ge_u32 s8, 1471
    s_nop 0
    s_cbranch_scc1 .ap_210
    s_waitcnt vmcnt(5)
    s_cmpk_ge_u32 s8, 1406
    s_cbranch_scc1 .ap_210
    s_waitcnt vmcnt(3)
    s_bitcmp1_b64 s[14:15], 38
    s_cbranch_scc0 1
    s_waitcnt vmcnt(2)
    s_cmpk_ge_u32 s8, 1331
    s_cbranch_scc1 .ap_210
    s_waitcnt vmcnt(1)
.ap_210:
    s_add_u32 s63, s69, 49152
    buffer_load_dwordx4 v[184:187], v2, s[44:47], s63 offen nt
    v_add_f32_dpp v11, v128, v131 row_ror:12 row_mask:0xf bank_mask:0x8
    v_add_f32_dpp v10, v121, v10 row_ror:8 row_mask:0xf bank_mask:0x8
    v_add_f32_dpp v13, v113, v13 row_ror:4 row_mask:0xf bank_mask:0x4
    v_add_f32_dpp v12, v136, v139 row_ror:12 row_mask:0xf bank_mask:0x8
    v_add_f32_dpp v11, v129, v11 row_ror:8 row_mask:0xf bank_mask:0x8
    v_add_f32_dpp v10, v122, v10 row_ror:4 row_mask:0xf bank_mask:0x8
    v_add_f32_dpp v13, v144, v147 row_ror:12 row_mask:0xf bank_mask:0x8
    v_add_f32_dpp v12, v137, v12 row_ror:8 row_mask:0xf bank_mask:0x8
    v_add_f32_dpp v11, v130, v11 row_ror:4 row_mask:0xf bank_mask:0x8
    v_add_f32_dpp v13, v145, v13 row_ror:8 row_mask:0xf bank_mask:0x8
    v_add_f32_dpp v12, v138, v12 row_ror:4 row_mask:0xf bank_mask:0x8
    s_memrealtime s[8:9]
    s_waitcnt lgkmcnt(0)
    s_sub_u32 s8, s8, s30
    s_cmpk_ge_u32 s8, 1498
    s_cbranch_scc1 .ap_211
    s_waitcnt vmcnt(5)
    s_cmpk_ge_u32 s8, 1433
    s_cbranch_scc1 .ap_211
    s_waitcnt vmcnt(3)
    s_bitcmp1_b64 s[14:15], 39
    s_cbranch_scc0 1
    s_waitcnt vmcnt(2)
    s_cmpk_ge_u32 s8, 1358
    s_cbranch_scc1 .ap_211
    s_waitcnt vmcnt(1)
.ap_211:
    s_add_u32 s63, s69, 57344
    buffer_load_dwordx4 v[188:191], v2, s[44:47], s63 offen nt
    v_add_f32_dpp v13, v146, v13 row_ror:4 row_mask:0xf bank_mask:0x8
    s_mov_b32 s60, 0x3db504f3
    s_mov_b32 s61, 0x3db504f3
    v_cvt_pk_bf16_f32 v10, 0, v10
    v_cvt_pk_bf16_f32 v11, 0, v11
    v_cvt_pk_bf16_f32 v12, 0, v12
    v_cvt_pk_bf16_f32 v13, 0, v13
    v_pk_mul_f32 v[10:11], v[10:11], s[60:61]
    v_pk_mul_f32 v[12:13], v[12:13], s[60:61]
    v_cvt_pk_bf16_f32 v10, 0, v10
    v_cvt_pk_bf16_f32 v11, 0, v11
    v_cvt_pk_bf16_f32 v12, 0, v12
    v_cvt_pk_bf16_f32 v13, 0, v13
    v_max_f32 v14, v10, v11
    v_max3_f32 v14, v14, v12, v13
    s_mov_b32 s60, 0x3fb8aa3b
    v_mov_b32 v22, s34
    v_mov_b32 v23, s34
    v_max_f32_dpp v14, v14, v14 quad_perm:[2,3,0,1] row_mask:0xf bank_mask:0xf
    s_nop 1
    v_max_f32_dpp v14, v14, v14 row_ror:4 row_mask:0xf bank_mask:0xf
    s_nop 1
    v_max_f32_dpp v14, v14, v14 row_ror:8 row_mask:0xf bank_mask:0xf
    v_mov_b32 v15, v14
    s_nop 1
    v_permlane16_swap_b32 v15, v14
    v_max_f32 v14, v15, v14
    v_mov_b32 v15, v14
    s_nop 1
    v_permlane32_swap_b32 v15, v14
    v_max_f32 v14, v15, v14
    v_mul_f32 v15, 0xbfb8aa3b, v14
    v_fma_f32 v10, v10, s60, v15
    v_fma_f32 v11, v11, s60, v15
    v_fma_f32 v12, v12, s60, v15
    v_fma_f32 v13, v13, s60, v15
    v_exp_f32 v10, v10
    v_exp_f32 v11, v11
    v_exp_f32 v12, v12
    v_exp_f32 v13, v13
    v_mov_b32 v20, v14
    v_pk_add_f32 v[16:17], v[10:11], v[12:13]
    v_add_f32 v21, v16, v17
    s_lshl3_add_u32 s60, s68, s3
    s_lshl_b32 s60, s60, 5
    s_add_u32 s60, s60, s59
    v_add_f32_dpp v21, v21, v21 quad_perm:[2,3,0,1] row_mask:0xf bank_mask:0xf
    s_nop 1
    v_add_f32_dpp v21, v21, v21 row_ror:4 row_mask:0xf bank_mask:0xf
    s_nop 1
    v_add_f32_dpp v21, v21, v21 row_ror:8 row_mask:0xf bank_mask:0xf
    v_mov_b32 v15, v21
    s_nop 1
    v_permlane16_swap_b32 v15, v21
    v_add_f32 v21, v15, v21
    v_mov_b32 v15, v21
    s_nop 1
    v_permlane32_swap_b32 v15, v21
    v_add_f32 v21, v15, v21
    s_lshl_b32 s60, s3, 4
    s_add_u32 s60, s60, 159104
    v_add_u32 v16, s60, v3
    v_mov_b32 v17, 159232
    v_mov_b32 v18, 1
    s_mov_b64 exec, 3
    ds_write_b64 v16, v[20:21]
    s_mov_b64 exec, 1
    s_waitcnt lgkmcnt(0)
    ds_add_rtn_u32 v18, v17, v18
    s_mov_b64 exec, -1
    v_and_b32 v16, 0x78, v3
    v_add_u32 v16, 159104, v16
    s_waitcnt lgkmcnt(0)
    v_readfirstlane_b32 s60, v18
    s_cmp_lg_u32 s60, 7
    s_nop 3
    s_cbranch_scc1 .ml_212
    ds_read_b64 v[18:19], v16
    s_lshl_b32 s60, s68, 7
    s_add_u32 s60, s60, s59
    s_waitcnt lgkmcnt(0)
    v_mov_b32 v20, v18
    s_nop 1
    v_max_f32_dpp v20, v20, v20 quad_perm:[2,3,0,1] row_mask:0xf bank_mask:0xf
    s_nop 1
    v_max_f32_dpp v20, v20, v20 row_ror:4 row_mask:0xf bank_mask:0xf
    s_nop 1
    v_max_f32_dpp v20, v20, v20 row_ror:8 row_mask:0xf bank_mask:0xf
    v_sub_f32 v18, v18, v20
    v_mul_f32 v18, 0x3fb8aa3b, v18
    v_exp_f32 v18, v18
    s_nop 0
    v_mul_f32 v21, v18, v19
    s_nop 1
    v_add_f32_dpp v21, v21, v21 quad_perm:[2,3,0,1] row_mask:0xf bank_mask:0xf
    s_nop 1
    v_add_f32_dpp v21, v21, v21 row_ror:4 row_mask:0xf bank_mask:0xf
    s_nop 1
    v_add_f32_dpp v21, v21, v21 row_ror:8 row_mask:0xf bank_mask:0xf
    s_mov_b64 exec, 0xff
    buffer_store_dwordx4 v[20:23], v2, s[36:39], s60 offen sc1
    s_mov_b64 exec, -1
.ml_212:
    s_memrealtime s[8:9]
    s_waitcnt lgkmcnt(0)
    s_sub_u32 s8, s8, s30
    s_cmpk_ge_u32 s8, 1525
    s_cbranch_scc1 .ap_213
    s_waitcnt vmcnt(5)
    s_cmpk_ge_u32 s8, 1460
    s_cbranch_scc1 .ap_213
    s_waitcnt vmcnt(3)
    s_bitcmp1_b64 s[14:15], 40
    s_cbranch_scc0 1
    s_waitcnt vmcnt(2)
    s_cmpk_ge_u32 s8, 1385
    s_cbranch_scc1 .ap_213
    s_waitcnt vmcnt(1)
.ap_213:
    s_add_u32 s63, s69, 131072
    buffer_load_dwordx4 v[192:195], v2, s[44:47], s63 offen nt
    s_memrealtime s[8:9]
    s_waitcnt vmcnt(8)
    s_waitcnt lgkmcnt(0)
    s_sub_u32 s8, s8, s30
    s_cmpk_ge_u32 s8, 1552
    s_cbranch_scc1 .ap_214
    s_waitcnt vmcnt(5)
    s_cmpk_ge_u32 s8, 1487
    s_cbranch_scc1 .ap_214
    s_waitcnt vmcnt(3)
    s_bitcmp1_b64 s[14:15], 41
    s_cbranch_scc0 1
    s_waitcnt vmcnt(2)
    s_cmpk_ge_u32 s8, 1412
    s_cbranch_scc1 .ap_214
    s_waitcnt vmcnt(1)
.ap_214:
    s_add_u32 s63, s69, 139264
    buffer_load_dwordx4 v[196:199], v2, s[44:47], s63 offen nt
    s_memrealtime s[8:9]
    s_waitcnt vmcnt(8)
    s_waitcnt lgkmcnt(0)
    s_sub_u32 s8, s8, s30
    s_cmpk_ge_u32 s8, 1579
    s_cbranch_scc1 .ap_215
    s_waitcnt vmcnt(5)
    s_cmpk_ge_u32 s8, 1514
    s_cbranch_scc1 .ap_215
    s_waitcnt vmcnt(3)
    s_bitcmp1_b64 s[14:15], 42
    s_cbranch_scc0 1
    s_waitcnt vmcnt(2)
    s_cmpk_ge_u32 s8, 1439
    s_cbranch_scc1 .ap_215
    s_waitcnt vmcnt(1)
.ap_215:
    s_add_u32 s63, s69, 147456
    buffer_load_dwordx4 v[200:203], v2, s[44:47], s63 offen nt
    s_memrealtime s[8:9]
    s_waitcnt vmcnt(8)
    s_waitcnt lgkmcnt(0)
    s_sub_u32 s8, s8, s30
    s_cmpk_ge_u32 s8, 1606
    s_cbranch_scc1 .ap_216
    s_waitcnt vmcnt(5)
    s_cmpk_ge_u32 s8, 1541
    s_cbranch_scc1 .ap_216
    s_waitcnt vmcnt(3)
    s_bitcmp1_b64 s[14:15], 43
    s_cbranch_scc0 1
    s_waitcnt vmcnt(2)
    s_cmpk_ge_u32 s8, 1466
    s_cbranch_scc1 .ap_216
    s_waitcnt vmcnt(1)
.ap_216:
    s_add_u32 s63, s69, 155648
    buffer_load_dwordx4 v[204:207], v2, s[44:47], s63 offen nt
    s_memrealtime s[8:9]
    s_waitcnt vmcnt(8)
    s_waitcnt lgkmcnt(0)
    s_sub_u32 s8, s8, s30
    s_cmpk_ge_u32 s8, 1633
    s_cbranch_scc1 .ap_217
    s_waitcnt vmcnt(5)
    s_cmpk_ge_u32 s8, 1568
    s_cbranch_scc1 .ap_217
    s_waitcnt vmcnt(3)
    s_bitcmp1_b64 s[14:15], 44
    s_cbranch_scc0 1
    s_waitcnt vmcnt(2)
    s_cmpk_ge_u32 s8, 1493
    s_cbranch_scc1 .ap_217
    s_waitcnt vmcnt(1)
.ap_217:
    s_add_u32 s63, s69, 163840
    buffer_load_dwordx4 v[208:211], v2, s[44:47], s63 offen nt
    s_memrealtime s[8:9]
    s_waitcnt vmcnt(8)
    s_waitcnt lgkmcnt(0)
    s_sub_u32 s8, s8, s30
    s_cmpk_ge_u32 s8, 1660
    s_cbranch_scc1 .ap_218
    s_waitcnt vmcnt(5)
    s_cmpk_ge_u32 s8, 1595
    s_cbranch_scc1 .ap_218
    s_waitcnt vmcnt(3)
    s_bitcmp1_b64 s[14:15], 45
    s_cbranch_scc0 1
    s_waitcnt vmcnt(2)
    s_cmpk_ge_u32 s8, 1520
    s_cbranch_scc1 .ap_218
    s_waitcnt vmcnt(1)
.ap_218:
    s_add_u32 s63, s69, 172032
    buffer_load_dwordx4 v[212:215], v2, s[44:47], s63 offen nt
    s_memrealtime s[8:9]
    s_waitcnt vmcnt(8)
    s_waitcnt lgkmcnt(0)
    s_sub_u32 s8, s8, s30
    s_cmpk_ge_u32 s8, 1691
    s_cbranch_scc1 .ap_219
    s_waitcnt vmcnt(5)
    s_cmpk_ge_u32 s8, 1626
    s_cbranch_scc1 .ap_219
    s_waitcnt vmcnt(3)
    s_bitcmp1_b64 s[14:15], 46
    s_cbranch_scc0 1
    s_waitcnt vmcnt(2)
    s_cmpk_ge_u32 s8, 1551
    s_cbranch_scc1 .ap_219
    s_waitcnt vmcnt(1)
.ap_219:
    s_add_u32 s63, s69, 180224
    buffer_load_dwordx4 v[216:219], v2, s[44:47], s63 offen nt
    s_memrealtime s[8:9]
    s_waitcnt vmcnt(8)
    s_waitcnt lgkmcnt(0)
    s_sub_u32 s8, s8, s30
    s_cmpk_ge_u32 s8, 1722
    s_cbranch_scc1 .ap_220
    s_waitcnt vmcnt(5)
    s_cmpk_ge_u32 s8, 1657
    s_cbranch_scc1 .ap_220
    s_waitcnt vmcnt(3)
    s_bitcmp1_b64 s[14:15], 47
    s_cbranch_scc0 1
    s_waitcnt vmcnt(2)
    s_cmpk_ge_u32 s8, 1582
    s_cbranch_scc1 .ap_220
    s_waitcnt vmcnt(1)
.ap_220:
    s_add_u32 s63, s69, 188416
    buffer_load_dwordx4 v[220:223], v2, s[44:47], s63 offen nt
    s_memrealtime s[8:9]
    s_waitcnt vmcnt(8)
    s_waitcnt lgkmcnt(0)
    s_sub_u32 s8, s8, s30
    s_cmpk_ge_u32 s8, 1753
    s_cbranch_scc1 .ap_221
    s_waitcnt vmcnt(5)
    s_cmpk_ge_u32 s8, 1688
    s_cbranch_scc1 .ap_221
    s_waitcnt vmcnt(3)
    s_bitcmp1_b64 s[14:15], 48
    s_cbranch_scc0 1
    s_waitcnt vmcnt(2)
    s_cmpk_ge_u32 s8, 1613
    s_cbranch_scc1 .ap_221
    s_waitcnt vmcnt(1)
.ap_221:
    s_add_u32 s63, s69, 262144
    buffer_load_dwordx4 v[224:227], v2, s[44:47], s63 offen nt
    s_memrealtime s[8:9]
    s_waitcnt vmcnt(8)
    s_waitcnt lgkmcnt(0)
    s_sub_u32 s8, s8, s30
    s_cmpk_ge_u32 s8, 1784
    s_cbranch_scc1 .ap_222
    s_waitcnt vmcnt(5)
    s_cmpk_ge_u32 s8, 1719
    s_cbranch_scc1 .ap_222
    s_waitcnt vmcnt(3)
    s_bitcmp1_b64 s[14:15], 49
    s_cbranch_scc0 1
    s_waitcnt vmcnt(2)
    s_cmpk_ge_u32 s8, 1644
    s_cbranch_scc1 .ap_222
    s_waitcnt vmcnt(1)
.ap_222:
    s_add_u32 s63, s69, 270336
    buffer_load_dwordx4 v[228:231], v2, s[44:47], s63 offen nt
    s_memrealtime s[8:9]
    s_waitcnt vmcnt(8)
    s_waitcnt lgkmcnt(0)
    s_sub_u32 s8, s8, s30
    s_cmpk_ge_u32 s8, 1815
    s_cbranch_scc1 .ap_223
    s_waitcnt vmcnt(5)
    s_cmpk_ge_u32 s8, 1750
    s_cbranch_scc1 .ap_223
    s_waitcnt vmcnt(3)
    s_bitcmp1_b64 s[14:15], 50
    s_cbranch_scc0 1
    s_waitcnt vmcnt(2)
    s_cmpk_ge_u32 s8, 1675
    s_cbranch_scc1 .ap_223
    s_waitcnt vmcnt(1)
.ap_223:
    s_add_u32 s63, s69, 278528
    buffer_load_dwordx4 v[232:235], v2, s[44:47], s63 offen nt
    s_memrealtime s[8:9]
    s_waitcnt vmcnt(8)
    s_waitcnt lgkmcnt(0)
    s_sub_u32 s8, s8, s30
    s_cmpk_ge_u32 s8, 1846
    s_cbranch_scc1 .ap_224
    s_waitcnt vmcnt(5)
    s_cmpk_ge_u32 s8, 1781
    s_cbranch_scc1 .ap_224
    s_waitcnt vmcnt(3)
    s_bitcmp1_b64 s[14:15], 51
    s_cbranch_scc0 1
    s_waitcnt vmcnt(2)
    s_cmpk_ge_u32 s8, 1706
    s_cbranch_scc1 .ap_224
    s_waitcnt vmcnt(1)
.ap_224:
    s_add_u32 s63, s69, 286720
    buffer_load_dwordx4 v[236:239], v2, s[44:47], s63 offen nt
    s_memrealtime s[8:9]
    s_waitcnt vmcnt(8)
    s_waitcnt lgkmcnt(0)
    s_sub_u32 s8, s8, s30
    s_cmpk_ge_u32 s8, 1877
    s_cbranch_scc1 .ap_225
    s_waitcnt vmcnt(5)
    s_cmpk_ge_u32 s8, 1812
    s_cbranch_scc1 .ap_225
    s_waitcnt vmcnt(3)
    s_bitcmp1_b64 s[14:15], 52
    s_cbranch_scc0 1
    s_waitcnt vmcnt(2)
    s_cmpk_ge_u32 s8, 1737
    s_cbranch_scc1 .ap_225
    s_waitcnt vmcnt(1)
.ap_225:
    s_add_u32 s63, s69, 294912
    buffer_load_dwordx4 v[240:243], v2, s[44:47], s63 offen nt
    s_memrealtime s[8:9]
    s_waitcnt vmcnt(8)
    s_waitcnt lgkmcnt(0)
    s_sub_u32 s8, s8, s30
    s_cmpk_ge_u32 s8, 1908
    s_cbranch_scc1 .ap_226
    s_waitcnt vmcnt(5)
    s_cmpk_ge_u32 s8, 1843
    s_cbranch_scc1 .ap_226
    s_waitcnt vmcnt(3)
    s_bitcmp1_b64 s[14:15], 53
    s_cbranch_scc0 1
    s_waitcnt vmcnt(2)
    s_cmpk_ge_u32 s8, 1768
    s_cbranch_scc1 .ap_226
    s_waitcnt vmcnt(1)
.ap_226:
    s_add_u32 s63, s69, 303104
    buffer_load_dwordx4 v[244:247], v2, s[44:47], s63 offen nt
    s_load_dwordx2 s[88:89], s[6:7], s0
    buffer_load_dwordx4 v[24:27], v9, s[36:39], s59 offen offset:0 sc1
    s_memrealtime s[8:9]
    s_waitcnt vmcnt(8)
    s_waitcnt lgkmcnt(0)
    s_sub_u32 s8, s8, s30
    s_cmpk_ge_u32 s8, 1939
    s_cbranch_scc1 .ap_227
    s_waitcnt vmcnt(5)
    s_cmpk_ge_u32 s8, 1874
    s_cbranch_scc1 .ap_227
    s_waitcnt vmcnt(3)
    s_bitcmp1_b64 s[14:15], 54
    s_cbranch_scc0 1
    s_waitcnt vmcnt(2)
    s_cmpk_ge_u32 s8, 1799
    s_cbranch_scc1 .ap_227
    s_waitcnt vmcnt(1)
.ap_227:
    s_add_u32 s63, s69, 311296
    buffer_load_dwordx4 v[248:251], v2, s[44:47], s63 offen nt
    s_sub_u32 s56, s65, 27
    s_lshl3_add_u32 s56, s56, s3
    s_cmp_ge_u32 s56, 11
    s_cbranch_scc1 .cpf_228
    s_getpc_b64 s[8:9]
.Lcpf_pc:
    s_cmp_ge_u32 s56, 6
    s_mov_b32 s57, .Lcpf_pc-.Ltail_ar
    s_cselect_b32 s57, .Lcpf_pc-.Ltail_bc+6144, s57
    s_lshl_b32 s56, s56, 10
    s_sub_u32 s56, s57, s56
    s_sub_u32 s8, s8, s56
    s_subb_u32 s9, s9, 0
    v_mov_b32 v41, s9
    v_add_co_u32 v40, vcc, s8, v2
    s_nop 1
    v_addc_co_u32 v41, vcc, 0, v41, vcc
    global_load_dwordx4 v[32:35], v[40:41], off
.cpf_228:
    s_memrealtime s[8:9]
    s_waitcnt vmcnt(8)
    s_waitcnt lgkmcnt(0)
    s_sub_u32 s8, s8, s30
    s_cmpk_ge_u32 s8, 1970
    s_cbranch_scc1 .ap_229
    s_waitcnt vmcnt(5)
    s_cmpk_ge_u32 s8, 1905
    s_cbranch_scc1 .ap_229
    s_waitcnt vmcnt(3)
    s_bitcmp1_b64 s[14:15], 55
    s_cbranch_scc0 1
    s_waitcnt vmcnt(2)
    s_cmpk_ge_u32 s8, 1830
    s_cbranch_scc1 .ap_229
    s_waitcnt vmcnt(1)
.ap_229:
    s_add_u32 s63, s69, 319488
    buffer_load_dwordx4 v[252:255], v2, s[44:47], s63 offen nt
    s_memrealtime s[8:9]
    s_waitcnt vmcnt(8)
    s_waitcnt lgkmcnt(0)
    s_sub_u32 s8, s8, s30
    s_cmpk_ge_u32 s8, 2001
    s_cbranch_scc1 .ap_230
    s_waitcnt vmcnt(5)
    s_cmpk_ge_u32 s8, 1936
    s_cbranch_scc1 .ap_230
    s_waitcnt vmcnt(3)
    s_bitcmp1_b64 s[14:15], 56
    s_cbranch_scc0 1
    s_waitcnt vmcnt(2)
    s_cmpk_ge_u32 s8, 1861
    s_cbranch_scc1 .ap_230
    s_waitcnt vmcnt(1)
.ap_230:
    s_add_u32 s63, s69, 393216
    buffer_load_dwordx4 v[36:39], v2, s[44:47], s63 offen nt
    s_memrealtime s[8:9]
    s_waitcnt vmcnt(8)
    s_waitcnt lgkmcnt(0)
    s_sub_u32 s8, s8, s30
    s_cmpk_ge_u32 s8, 2032
    s_cbranch_scc1 .ap_231
    s_waitcnt vmcnt(5)
    s_cmpk_ge_u32 s8, 1967
    s_cbranch_scc1 .ap_231
    s_waitcnt vmcnt(3)
    s_bitcmp1_b64 s[14:15], 57
    s_cbranch_scc0 1
    s_waitcnt vmcnt(2)
    s_cmpk_ge_u32 s8, 1892
    s_cbranch_scc1 .ap_231
    s_waitcnt vmcnt(1)
.ap_231:
    s_add_u32 s63, s69, 401408
    buffer_load_dwordx4 v[44:47], v2, s[44:47], s63 offen nt
    s_memrealtime s[8:9]
    s_waitcnt vmcnt(8)
    s_waitcnt lgkmcnt(0)
    s_sub_u32 s8, s8, s30
    s_cmpk_ge_u32 s8, 2063
    s_cbranch_scc1 .ap_232
    s_waitcnt vmcnt(5)
    s_cmpk_ge_u32 s8, 1998
    s_cbranch_scc1 .ap_232
    s_waitcnt vmcnt(3)
    s_bitcmp1_b64 s[14:15], 58
    s_cbranch_scc0 1
    s_waitcnt vmcnt(2)
    s_cmpk_ge_u32 s8, 1923
    s_cbranch_scc1 .ap_232
    s_waitcnt vmcnt(1)
.ap_232:
    s_add_u32 s63, s69, 409600
    buffer_load_dwordx4 v[52:55], v2, s[44:47], s63 offen nt
    s_waitcnt vmcnt(5)
    s_branch .gpc_234
.gp_233:
    buffer_load_dwordx4 v[24:27], v9, s[36:39], s59 offen offset:0 sc1
    s_waitcnt vmcnt(0)
.gpc_234:
    v_cmp_eq_u32 vcc, s34, v26
    v_cmp_eq_u32 s[56:57], s34, v27
    s_and_b64 vcc, vcc, s[56:57]
    s_cmp_eq_u64 vcc, exec
    s_nop 2
    s_cbranch_scc1 .gpd_235
    s_sub_u32 s35, s35, 1
    s_cbranch_scc1 .Lexit
    s_sleep 1
    s_branch .gp_233
.gpd_235:
    s_lshr_b64 s[88:89], s[88:89], s1
    s_and_b32 s88, s88, 0xff
    s_cmp_eq_u32 s88, 32
    s_cselect_b32 s0, 0xac000, 0
    v_mov_b32 v16, v24
    s_nop 1
    v_max_f32_dpp v16, v16, v16 quad_perm:[2,3,0,1] row_mask:0xf bank_mask:0xf
    v_sub_f32 v17, v24, v16
    v_sub_f32 v18, v14, v16
    v_mul_f32 v17, 0x3fb8aa3b, v17
    v_mul_f32 v18, 0x3fb8aa3b, v18
    v_exp_f32 v17, v17
    v_exp_f32 v18, v18
    v_mul_f32 v17, v17, v25
    s_nop 1
    v_add_f32_dpp v17, v17, v17 quad_perm:[2,3,0,1] row_mask:0xf bank_mask:0xf
    v_rcp_f32 v19, v17
    s_nop 0
    v_fma_f32 v15, -v17, v19, 1.0
    v_fma_f32 v19, v15, v19, v19
    v_mul_f32 v18, v18, v19
    v_mul_f32 v10, v10, v18
    v_mul_f32 v11, v11, v18
    v_mul_f32 v12, v12, v18
    v_mul_f32 v13, v13, v18
    v_mov_b32_dpp v112, v10 quad_perm:[2,3,0,1] row_mask:0xf bank_mask:0xf
    v_mov_b32_dpp v113, v11 quad_perm:[2,3,0,1] row_mask:0xf bank_mask:0xf
    v_mov_b32_dpp v114, v12 quad_perm:[2,3,0,1] row_mask:0xf bank_mask:0xf
    v_mov_b32_dpp v115, v13 quad_perm:[2,3,0,1] row_mask:0xf bank_mask:0xf
    v_cvt_pk_bf16_f32 v96, v10, v112
    v_cvt_pk_bf16_f32 v100, v11, v113
    v_cvt_pk_bf16_f32 v104, v12, v114
    v_cvt_pk_bf16_f32 v108, v13, v115
    v_mov_b32_dpp v97, v96 row_ror:12 row_mask:0xf bank_mask:0xf
    v_mov_b32_dpp v101, v100 row_ror:12 row_mask:0xf bank_mask:0xf
    v_mov_b32_dpp v105, v104 row_ror:12 row_mask:0xf bank_mask:0xf
    v_mov_b32_dpp v109, v108 row_ror:12 row_mask:0xf bank_mask:0xf
    v_mov_b32_dpp v98, v96 row_ror:8 row_mask:0xf bank_mask:0xf
    v_mov_b32_dpp v102, v100 row_ror:8 row_mask:0xf bank_mask:0xf
    v_mov_b32_dpp v106, v104 row_ror:8 row_mask:0xf bank_mask:0xf
    v_mov_b32_dpp v110, v108 row_ror:8 row_mask:0xf bank_mask:0xf
    v_mov_b32_dpp v99, v96 row_ror:4 row_mask:0xf bank_mask:0xf
    v_mov_b32_dpp v103, v100 row_ror:4 row_mask:0xf bank_mask:0xf
    v_mov_b32_dpp v107, v104 row_ror:4 row_mask:0xf bank_mask:0xf
    v_mov_b32_dpp v111, v108 row_ror:4 row_mask:0xf bank_mask:0xf
    v_mov_b32_dpp v96, v96 row_shr:3 row_mask:0xf bank_mask:0x2
    v_mov_b32_dpp v97, v97 row_shr:3 row_mask:0xf bank_mask:0x2
    v_mov_b32_dpp v98, v98 row_shr:3 row_mask:0xf bank_mask:0x2
    v_mov_b32_dpp v99, v99 row_shr:3 row_mask:0xf bank_mask:0x2
    v_mov_b32_dpp v100, v100 row_shr:3 row_mask:0xf bank_mask:0x2
    v_mov_b32_dpp v101, v101 row_shr:3 row_mask:0xf bank_mask:0x2
    v_mov_b32_dpp v102, v102 row_shr:3 row_mask:0xf bank_mask:0x2
    v_mov_b32_dpp v103, v103 row_shr:3 row_mask:0xf bank_mask:0x2
    v_mov_b32_dpp v104, v104 row_shr:3 row_mask:0xf bank_mask:0x2
    v_mov_b32_dpp v105, v105 row_shr:3 row_mask:0xf bank_mask:0x2
    v_mov_b32_dpp v106, v106 row_shr:3 row_mask:0xf bank_mask:0x2
    v_mov_b32_dpp v107, v107 row_shr:3 row_mask:0xf bank_mask:0x2
    v_mov_b32_dpp v108, v108 row_shr:3 row_mask:0xf bank_mask:0x2
    v_mov_b32_dpp v109, v109 row_shr:3 row_mask:0xf bank_mask:0x2
    v_mov_b32_dpp v110, v110 row_shr:3 row_mask:0xf bank_mask:0x2
    v_mov_b32_dpp v111, v111 row_shr:3 row_mask:0xf bank_mask:0x2
    s_memrealtime s[8:9]
    s_waitcnt lgkmcnt(0)
    s_sub_u32 s8, s8, s30
    s_cmpk_ge_u32 s8, 2094
    s_cbranch_scc1 .ap_236
    s_waitcnt vmcnt(5)
    s_cmpk_ge_u32 s8, 2029
    s_cbranch_scc1 .ap_236
    s_waitcnt vmcnt(3)
    s_bitcmp1_b64 s[14:15], 59
    s_cbranch_scc0 1
    s_waitcnt vmcnt(2)
    s_cmpk_ge_u32 s8, 1954
    s_cbranch_scc1 .ap_236
    s_waitcnt vmcnt(1)
.ap_236:
    s_add_u32 s63, s69, 417792
    buffer_load_dwordx4 v[60:63], v2, s[44:47], s63 offen nt
    s_lshl_b32 s60, s3, 10
    s_add_u32 s60, s60, 132096
    v_lshlrev_b32 v10, 5, v0
    v_add_u32 v10, s60, v10
    v_lshrrev_b32 v11, 5, v0
    v_lshlrev_b32 v11, 13, v11
    v_and_b32 v12, 31, v0
    v_lshl_add_u32 v11, v12, 4, v11
    v_add_u32 v9, 132096, v2
    v_mov_b32 v15, s34
    s_memrealtime s[8:9]
    s_waitcnt lgkmcnt(0)
    s_sub_u32 s8, s8, s30
    s_cmpk_ge_u32 s8, 2125
    s_cbranch_scc1 .ap_237
    s_waitcnt vmcnt(5)
    s_cmpk_ge_u32 s8, 2060
    s_cbranch_scc1 .ap_237
    s_waitcnt vmcnt(3)
    s_bitcmp1_b64 s[14:15], 60
    s_cbranch_scc0 1
    s_waitcnt vmcnt(2)
    s_cmpk_ge_u32 s8, 1985
    s_cbranch_scc1 .ap_237
    s_waitcnt vmcnt(1)
.ap_237:
    s_add_u32 s63, s69, 425984
    buffer_load_dwordx4 v[68:71], v2, s[44:47], s63 offen nt
    v_perm_b32 v112, v164, v160, s94
    v_perm_b32 v113, v172, v168, s94
    v_perm_b32 v114, v180, v176, s94
    v_perm_b32 v115, v188, v184, s94
    s_nop 1
    v_mfma_f32_16x16x32_bf16 v[128:131], v[96:99], v[112:115], 0
    v_perm_b32 v116, v164, v160, s95
    v_perm_b32 v117, v172, v168, s95
    v_perm_b32 v118, v180, v176, s95
    v_perm_b32 v119, v188, v184, s95
    s_nop 1
    v_mfma_f32_16x16x32_bf16 v[132:135], v[96:99], v[116:119], 0
    v_perm_b32 v120, v165, v161, s94
    v_perm_b32 v121, v173, v169, s94
    v_perm_b32 v122, v181, v177, s94
    v_perm_b32 v123, v189, v185, s94
    s_nop 1
    v_mfma_f32_16x16x32_bf16 v[136:139], v[96:99], v[120:123], 0
    v_perm_b32 v124, v165, v161, s95
    v_perm_b32 v125, v173, v169, s95
    v_perm_b32 v126, v181, v177, s95
    v_perm_b32 v127, v189, v185, s95
    s_nop 1
    v_mfma_f32_16x16x32_bf16 v[140:143], v[96:99], v[124:127], 0
    v_perm_b32 v112, v166, v162, s94
    v_perm_b32 v113, v174, v170, s94
    v_perm_b32 v114, v182, v178, s94
    v_perm_b32 v115, v190, v186, s94
    s_nop 1
    v_mfma_f32_16x16x32_bf16 v[144:147], v[96:99], v[112:115], 0
    v_perm_b32 v116, v166, v162, s95
    v_perm_b32 v117, v174, v170, s95
    v_perm_b32 v118, v182, v178, s95
    v_perm_b32 v119, v190, v186, s95
    s_nop 1
    v_mfma_f32_16x16x32_bf16 v[148:151], v[96:99], v[116:119], 0
    v_perm_b32 v120, v167, v163, s94
    v_perm_b32 v121, v175, v171, s94
    v_perm_b32 v122, v183, v179, s94
    v_perm_b32 v123, v191, v187, s94
    s_nop 1
    v_mfma_f32_16x16x32_bf16 v[152:155], v[96:99], v[120:123], 0
    v_perm_b32 v124, v167, v163, s95
    v_perm_b32 v125, v175, v171, s95
    v_perm_b32 v126, v183, v179, s95
    v_perm_b32 v127, v191, v187, s95
    s_nop 1
    v_mfma_f32_16x16x32_bf16 v[156:159], v[96:99], v[124:127], 0
    s_memrealtime s[8:9]
    s_waitcnt lgkmcnt(0)
    s_sub_u32 s8, s8, s30
    s_cmpk_ge_u32 s8, 2156
    s_nop 3
    s_cbranch_scc1 .ap_238
    s_waitcnt vmcnt(5)
    s_cmpk_ge_u32 s8, 2091
    s_cbranch_scc1 .ap_238
    s_waitcnt vmcnt(3)
    s_bitcmp1_b64 s[14:15], 61
    s_cbranch_scc0 1
    s_waitcnt vmcnt(2)
    s_cmpk_ge_u32 s8, 2016
    s_cbranch_scc1 .ap_238
    s_waitcnt vmcnt(1)
.ap_238:
    s_add_u32 s63, s69, 434176
    buffer_load_dwordx4 v[76:79], v2, s[44:47], s63 offen nt
    v_perm_b32 v112, v196, v192, s94
    v_perm_b32 v113, v204, v200, s94
    v_perm_b32 v114, v212, v208, s94
    v_perm_b32 v115, v220, v216, s94
    s_nop 1
    v_mfma_f32_16x16x32_bf16 v[128:131], v[100:103], v[112:115], v[128:131]
    v_perm_b32 v116, v196, v192, s95
    v_perm_b32 v117, v204, v200, s95
    v_perm_b32 v118, v212, v208, s95
    v_perm_b32 v119, v220, v216, s95
    s_nop 1
    v_mfma_f32_16x16x32_bf16 v[132:135], v[100:103], v[116:119], v[132:135]
    v_perm_b32 v120, v197, v193, s94
    v_perm_b32 v121, v205, v201, s94
    v_perm_b32 v122, v213, v209, s94
    v_perm_b32 v123, v221, v217, s94
    s_nop 1
    v_mfma_f32_16x16x32_bf16 v[136:139], v[100:103], v[120:123], v[136:139]
    v_perm_b32 v124, v197, v193, s95
    v_perm_b32 v125, v205, v201, s95
    v_perm_b32 v126, v213, v209, s95
    v_perm_b32 v127, v221, v217, s95
    s_nop 1
    v_mfma_f32_16x16x32_bf16 v[140:143], v[100:103], v[124:127], v[140:143]
    v_perm_b32 v112, v198, v194, s94
    v_perm_b32 v113, v206, v202, s94
    v_perm_b32 v114, v214, v210, s94
    v_perm_b32 v115, v222, v218, s94
    s_nop 1
    v_mfma_f32_16x16x32_bf16 v[144:147], v[100:103], v[112:115], v[144:147]
    v_perm_b32 v116, v198, v194, s95
    v_perm_b32 v117, v206, v202, s95
    v_perm_b32 v118, v214, v210, s95
    v_perm_b32 v119, v222, v218, s95
    s_nop 1
    v_mfma_f32_16x16x32_bf16 v[148:151], v[100:103], v[116:119], v[148:151]
    v_perm_b32 v120, v199, v195, s94
    v_perm_b32 v121, v207, v203, s94
    v_perm_b32 v122, v215, v211, s94
    v_perm_b32 v123, v223, v219, s94
    s_nop 1
    v_mfma_f32_16x16x32_bf16 v[152:155], v[100:103], v[120:123], v[152:155]
    v_perm_b32 v124, v199, v195, s95
    v_perm_b32 v125, v207, v203, s95
    v_perm_b32 v126, v215, v211, s95
    v_perm_b32 v127, v223, v219, s95
    s_nop 1
    v_mfma_f32_16x16x32_bf16 v[156:159], v[100:103], v[124:127], v[156:159]
    s_memrealtime s[8:9]
    s_waitcnt lgkmcnt(0)
    s_sub_u32 s8, s8, s30
    s_cmpk_ge_u32 s8, 2187
    s_nop 3
    s_cbranch_scc1 .ap_239
    s_waitcnt vmcnt(5)
    s_cmpk_ge_u32 s8, 2122
    s_cbranch_scc1 .ap_239
    s_waitcnt vmcnt(3)
    s_bitcmp1_b64 s[14:15], 62
    s_cbranch_scc0 1
    s_waitcnt vmcnt(2)
    s_cmpk_ge_u32 s8, 2047
    s_cbranch_scc1 .ap_239
    s_waitcnt vmcnt(1)
.ap_239:
    s_add_u32 s63, s69, 442368
    buffer_load_dwordx4 v[84:87], v2, s[44:47], s63 offen nt
    s_waitcnt vmcnt(7)
    v_perm_b32 v112, v228, v224, s94
    v_perm_b32 v113, v236, v232, s94
    v_perm_b32 v114, v244, v240, s94
    v_perm_b32 v115, v252, v248, s94
    s_nop 1
    v_mfma_f32_16x16x32_bf16 v[128:131], v[104:107], v[112:115], v[128:131]
    v_perm_b32 v116, v228, v224, s95
    v_perm_b32 v117, v236, v232, s95
    v_perm_b32 v118, v244, v240, s95
    v_perm_b32 v119, v252, v248, s95
    s_nop 1
    v_mfma_f32_16x16x32_bf16 v[132:135], v[104:107], v[116:119], v[132:135]
    v_perm_b32 v120, v229, v225, s94
    v_perm_b32 v121, v237, v233, s94
    v_perm_b32 v122, v245, v241, s94
    v_perm_b32 v123, v253, v249, s94
    s_nop 1
    v_mfma_f32_16x16x32_bf16 v[136:139], v[104:107], v[120:123], v[136:139]
    v_perm_b32 v124, v229, v225, s95
    v_perm_b32 v125, v237, v233, s95
    v_perm_b32 v126, v245, v241, s95
    v_perm_b32 v127, v253, v249, s95
    s_nop 1
    v_mfma_f32_16x16x32_bf16 v[140:143], v[104:107], v[124:127], v[140:143]
    v_perm_b32 v112, v230, v226, s94
    v_perm_b32 v113, v238, v234, s94
    v_perm_b32 v114, v246, v242, s94
    v_perm_b32 v115, v254, v250, s94
    s_nop 1
    v_mfma_f32_16x16x32_bf16 v[144:147], v[104:107], v[112:115], v[144:147]
    v_perm_b32 v116, v230, v226, s95
    v_perm_b32 v117, v238, v234, s95
    v_perm_b32 v118, v246, v242, s95
    v_perm_b32 v119, v254, v250, s95
    s_nop 1
    v_mfma_f32_16x16x32_bf16 v[148:151], v[104:107], v[116:119], v[148:151]
    v_perm_b32 v120, v231, v227, s94
    v_perm_b32 v121, v239, v235, s94
    v_perm_b32 v122, v247, v243, s94
    v_perm_b32 v123, v255, v251, s94
    s_nop 1
    v_mfma_f32_16x16x32_bf16 v[152:155], v[104:107], v[120:123], v[152:155]
    v_perm_b32 v124, v231, v227, s95
    v_perm_b32 v125, v239, v235, s95
    v_perm_b32 v126, v247, v243, s95
    v_perm_b32 v127, v255, v251, s95
    s_nop 1
    v_mfma_f32_16x16x32_bf16 v[156:159], v[104:107], v[124:127], v[156:159]
    s_memrealtime s[8:9]
    s_waitcnt lgkmcnt(0)
    s_sub_u32 s8, s8, s30
    s_cmpk_ge_u32 s8, 2218
    s_nop 3
    s_cbranch_scc1 .ap_240
    s_waitcnt vmcnt(5)
    s_cmpk_ge_u32 s8, 2153
    s_cbranch_scc1 .ap_240
    s_waitcnt vmcnt(3)
    s_bitcmp1_b64 s[14:15], 63
    s_cbranch_scc0 1
    s_waitcnt vmcnt(2)
    s_cmpk_ge_u32 s8, 2078
    s_cbranch_scc1 .ap_240
    s_waitcnt vmcnt(1)
.ap_240:
    s_add_u32 s63, s69, 450560
    buffer_load_dwordx4 v[92:95], v2, s[44:47], s63 offen nt
    s_setprio 0
    s_waitcnt vmcnt(6)
    v_perm_b32 v160, v44, v36, s94
    v_perm_b32 v164, v44, v36, s95
    v_perm_b32 v168, v45, v37, s94
    v_perm_b32 v172, v45, v37, s95
    v_perm_b32 v176, v46, v38, s94
    v_perm_b32 v180, v46, v38, s95
    v_perm_b32 v184, v47, v39, s94
    v_perm_b32 v188, v47, v39, s95
    s_waitcnt vmcnt(4)
    v_perm_b32 v161, v60, v52, s94
    v_perm_b32 v165, v60, v52, s95
    v_perm_b32 v169, v61, v53, s94
    v_perm_b32 v173, v61, v53, s95
    v_perm_b32 v177, v62, v54, s94
    v_perm_b32 v181, v62, v54, s95
    v_perm_b32 v185, v63, v55, s94
    v_perm_b32 v189, v63, v55, s95
    v_mfma_f32_16x16x16_bf16 v[128:131], v[108:109], v[160:161], v[128:131]
    v_mfma_f32_16x16x16_bf16 v[132:135], v[108:109], v[164:165], v[132:135]
    v_mfma_f32_16x16x16_bf16 v[136:139], v[108:109], v[168:169], v[136:139]
    v_mfma_f32_16x16x16_bf16 v[140:143], v[108:109], v[172:173], v[140:143]
    v_mfma_f32_16x16x16_bf16 v[144:147], v[108:109], v[176:177], v[144:147]
    v_mfma_f32_16x16x16_bf16 v[148:151], v[108:109], v[180:181], v[148:151]
    v_mfma_f32_16x16x16_bf16 v[152:155], v[108:109], v[184:185], v[152:155]
    v_mfma_f32_16x16x16_bf16 v[156:159], v[108:109], v[188:189], v[156:159]
    s_waitcnt vmcnt(2)
    v_perm_b32 v162, v76, v68, s94
    v_perm_b32 v166, v76, v68, s95
    v_perm_b32 v170, v77, v69, s94
    v_perm_b32 v174, v77, v69, s95
    v_perm_b32 v178, v78, v70, s94
    v_perm_b32 v182, v78, v70, s95
    v_perm_b32 v186, v79, v71, s94
    v_perm_b32 v190, v79, v71, s95
    s_lshl4_add_u32 s59, s67, s66
    s_lshl1_add_u32 s59, s59, s68
    s_lshl_b32 s59, s59, 9
    s_add_u32 s59, s59, 0x210000
    s_mov_b32 s60, 0x07060503
    s_mov_b32 s61, 0x07060502
    s_mov_b32 s62, 0x07060501
.Ltail_n:
    s_waitcnt vmcnt(0)
    v_perm_b32 v163, v92, v84, s94
    v_perm_b32 v167, v92, v84, s95
    v_perm_b32 v171, v93, v85, s94
    v_perm_b32 v175, v93, v85, s95
    v_perm_b32 v179, v94, v86, s94
    v_perm_b32 v183, v94, v86, s95
    v_perm_b32 v187, v95, v87, s94
    v_perm_b32 v191, v95, v87, s95
    v_mfma_f32_16x16x16_bf16 v[128:131], v[110:111], v[162:163], v[128:131]
    v_mfma_f32_16x16x16_bf16 v[132:135], v[110:111], v[166:167], v[132:135]
    v_mfma_f32_16x16x16_bf16 v[136:139], v[110:111], v[170:171], v[136:139]
    v_mfma_f32_16x16x16_bf16 v[140:143], v[110:111], v[174:175], v[140:143]
    v_mfma_f32_16x16x16_bf16 v[144:147], v[110:111], v[178:179], v[144:147]
    v_mfma_f32_16x16x16_bf16 v[148:151], v[110:111], v[182:183], v[148:151]
    v_mfma_f32_16x16x16_bf16 v[152:155], v[110:111], v[186:187], v[152:155]
    v_mfma_f32_16x16x16_bf16 v[156:159], v[110:111], v[190:191], v[156:159]
    s_mov_b64 exec, 0xffffffff
    s_nop 0
    ds_write2_b32 v10, v128, v132 offset0:0 offset1:1
    s_nop 0
    ds_write2_b32 v10, v136, v140 offset0:2 offset1:3
    s_nop 0
    ds_write2_b32 v10, v144, v148 offset0:4 offset1:5
    s_nop 0
    ds_write2_b32 v10, v152, v156 offset0:6 offset1:7
    s_mov_b64 exec, -1
    s_waitcnt lgkmcnt(0)
    s_barrier
    s_cmp_lg_u32 s3, 7
    s_cbranch_scc1 .opub_241
    ds_read_b128 v[196:199], v9 offset:0
    ds_read_b128 v[200:203], v9 offset:1024
    ds_read_b128 v[204:207], v9 offset:2048
    ds_read_b128 v[208:211], v9 offset:3072
    ds_read_b128 v[212:215], v9 offset:4096
    ds_read_b128 v[216:219], v9 offset:5120
    ds_read_b128 v[220:223], v9 offset:6144
    ds_read_b128 v[224:227], v9 offset:7168
    s_waitcnt lgkmcnt(6)
    v_pk_add_f32 v[196:197], v[196:197], v[200:201]
    v_pk_add_f32 v[198:199], v[198:199], v[202:203]
    s_waitcnt lgkmcnt(4)
    v_pk_add_f32 v[204:205], v[204:205], v[208:209]
    v_pk_add_f32 v[206:207], v[206:207], v[210:211]
    v_pk_add_f32 v[196:197], v[196:197], v[204:205]
    v_pk_add_f32 v[198:199], v[198:199], v[206:207]
    s_waitcnt lgkmcnt(2)
    v_pk_add_f32 v[212:213], v[212:213], v[216:217]
    v_pk_add_f32 v[214:215], v[214:215], v[218:219]
    s_waitcnt lgkmcnt(0)
    v_pk_add_f32 v[220:221], v[220:221], v[224:225]
    v_pk_add_f32 v[222:223], v[222:223], v[226:227]
    v_pk_add_f32 v[212:213], v[212:213], v[220:221]
    v_pk_add_f32 v[214:215], v[214:215], v[222:223]
    v_pk_add_f32 v[196:197], v[196:197], v[212:213]
    v_pk_add_f32 v[198:199], v[198:199], v[214:215]
    v_perm_b32 v12, v196, v199, s60
    v_perm_b32 v13, v197, v199, s61
    v_perm_b32 v14, v198, v199, s62
    s_add_u32 s57, s59, 0xac000
    buffer_store_dwordx4 v[12:15], v11, s[36:39], s57 offen
    buffer_store_dwordx4 v[12:15], v11, s[36:39], s59 offen sc1
.opub_241:
.Lexit:
.Lend:
s_endpgm
.section .rodata,"a"
.p2align 6
.amdhsa_kernel adaLN_cond__sliding_block_cached__moe_arch_mod__decode_kernel
  .amdhsa_next_free_vgpr 256
  .amdhsa_next_free_sgpr 102
  .amdhsa_accum_offset 256
  .amdhsa_group_segment_fixed_size 0
  .amdhsa_kernarg_size 120
  .amdhsa_user_sgpr_count 2
  .amdhsa_user_sgpr_kernarg_segment_ptr 1
  .amdhsa_system_sgpr_workgroup_id_x 1
.end_amdhsa_kernel
```

```asm
; @launch grid=(256,1,1) block=(512,1,1) lds=159360
.amdgcn_target "amdgcn-amd-amdhsa--gfx950"
.text
.globl adaLN_cond__sliding_block_cached__moe_arch_mod__decode_kernel
.p2align 8
.type adaLN_cond__sliding_block_cached__moe_arch_mod__decode_kernel,@function
adaLN_cond__sliding_block_cached__moe_arch_mod__decode_kernel:
    s_cmp_ge_u32 s2, 256
    s_cbranch_scc1 .Lend
    s_load_dwordx16 s[4:19], s[0:1], 0
    s_load_dwordx8 s[20:27], s[0:1], 64
    s_load_dwordx4 s[28:31], s[0:1], 96
    s_load_dwordx2 s[32:33], s[0:1], 112
    s_memrealtime s[70:71]
    v_lshrrev_b32 v1, 6, v0
    v_and_b32 v0, 63, v0
    v_readfirstlane_b32 s3, v1
    s_mov_b32 s35, 0x3ffff
    s_mov_b32 s98, 0xbfb8aa3b
    s_mov_b32 s94, 0x05040100
    s_mov_b32 s95, 0x07060302
    s_mov_b32 s96, 0xaaaaaaaa
    s_mov_b32 s97, 0xaaaaaaaa
    s_and_b32 s64, s2, 7
    s_lshr_b32 s65, s2, 3
    s_and_b32 s66, s65, 7
    s_lshr_b32 s67, s2, 7
    s_lshl1_add_u32 s67, s64, s67
    s_bfe_u32 s68, s2, 0x10006
    s_lshl4_add_u32 s69, s66, s67
    s_lshl_b32 s69, s69, 21
    s_lshl_b32 s56, s68, 16
    s_add_u32 s69, s69, s56
    s_lshl_b32 s56, s3, 10
    s_add_u32 s69, s69, s56
    s_add_u32 s69, s69, 0x180000
    v_bfe_u32 v1, v0, 2, 2
    v_lshrrev_b32 v2, 4, v0
    v_lshl_add_u32 v1, v1, 2, v2
    v_and_b32 v2, 3, v0
    v_lshl_add_u32 v1, v1, 2, v2
    v_lshlrev_b32 v1, 4, v1
    v_lshlrev_b32 v2, 4, v0
    v_lshlrev_b32 v3, 3, v0
    v_and_b32 v4, 31, v0
    v_lshlrev_b32 v4, 2, v4
    v_add_u32 v4, 1024, v4
    v_lshlrev_b32 v5, 1, v4
    s_waitcnt lgkmcnt(0)
    s_load_dword s34, s[32:33], 0
    s_sub_u32 s99, s2, 216
    s_cmp_ge_u32 s99, 18
    s_cbranch_scc1 .Lmcf_no
    s_mul_i32 s58, s3, 1152
    s_mov_b32 s52, s24
    s_and_b32 s53, s25, 0xffff
    s_mov_b32 s54, 0x2400
    s_mov_b32 s55, 0x00020000
    buffer_load_dwordx2 v[246:247], v3, s[52:55], s58 offen
    buffer_load_dwordx2 v[248:249], v3, s[52:55], s58 offen offset:512
    buffer_load_dword v250, v4, s[52:55], s58 offen
    s_mov_b32 s48, s26
    s_and_b32 s49, s27, 0xffff
    s_mov_b32 s50, 0x3cc000
    s_mov_b32 s51, 0x00020000
    v_bfe_u32 v12, v0, 4, 1
    s_and_b32 s56, s3, 3
    s_lshl_b32 s56, s56, 1
    v_or_b32 v12, s56, v12
    v_and_b32 v19, 7, v0
    v_xor_b32 v12, v12, v19
    v_lshrrev_b32 v19, 3, v0
    v_mul_u32_u24 v19, 6912, v19
    v_lshl_add_u32 v19, v12, 4, v19
    s_mul_i32 s57, s3, 55296
    s_lshl_b32 s59, s99, 7
    s_add_u32 s57, s57, s59
    s_lshl_b32 s100, s3, 10
    s_add_u32 m0, s100, 0
    s_add_u32 s56, s57, 0
    buffer_load_dwordx4 v19, s[48:51], s56 offen nt lds
    s_add_u32 m0, s100, 8192
    s_add_u32 s56, s57, 442368
    buffer_load_dwordx4 v19, s[48:51], s56 offen nt lds
    s_add_u32 m0, s100, 16384
    s_add_u32 s56, s57, 884736
    buffer_load_dwordx4 v19, s[48:51], s56 offen nt lds
    s_add_u32 m0, s100, 24576
    s_add_u32 s56, s57, 1327104
    buffer_load_dwordx4 v19, s[48:51], s56 offen nt lds
    s_add_u32 m0, s100, 32768
    s_add_u32 s56, s57, 1769472
    buffer_load_dwordx4 v19, s[48:51], s56 offen nt lds
    s_add_u32 m0, s100, 40960
    s_add_u32 s56, s57, 2211840
    buffer_load_dwordx4 v19, s[48:51], s56 offen nt lds
    s_add_u32 m0, s100, 49152
    s_add_u32 s56, s57, 2654208
    buffer_load_dwordx4 v19, s[48:51], s56 offen nt lds
    s_add_u32 m0, s100, 57344
    s_add_u32 s56, s57, 3096576
    buffer_load_dwordx4 v19, s[48:51], s56 offen nt lds
    s_add_u32 m0, s100, 65536
    s_add_u32 s56, s57, 3538944
    buffer_load_dwordx4 v19, s[48:51], s56 offen nt lds
.Lmcf_no:
    s_mov_b32 s40, s6
    s_and_b32 s41, s7, 0xffff
    s_mov_b32 s42, 0x10000000
    s_mov_b32 s43, 0x00020000
    s_add_u32 s63, s69, 0
    buffer_load_dwordx4 v[32:35], v1, s[40:43], s63 offen nt
    s_add_u32 s63, s69, 8192
    buffer_load_dwordx4 v[36:39], v1, s[40:43], s63 offen nt
    s_add_u32 s63, s69, 16384
    buffer_load_dwordx4 v[64:67], v1, s[40:43], s63 offen nt
    s_add_u32 s63, s69, 24576
    buffer_load_dwordx4 v[68:71], v1, s[40:43], s63 offen nt
    s_mov_b32 s44, s8
    s_and_b32 s45, s9, 0xffff
    s_mov_b32 s46, 0x10000000
    s_mov_b32 s47, 0x00020000
    s_mov_b32 s36, s32
    s_and_b32 s37, s33, 0xffff
    s_mov_b32 s38, 0x40000000
    s_mov_b32 s39, 0x00020000
    s_lshl3_add_u32 s56, s3, s2
    s_cmp_lt_u32 s56, 8
    s_cbranch_scc0 .Let_no
    s_lshl_b32 s56, s2, 7
    s_add_u32 s56, s56, 0x400
    v_mov_b32 v7, s70
    s_mov_b64 exec, 1
    buffer_store_dword v7, v2, s[36:39], s56 offen sc1
    s_mov_b64 exec, -1
.Let_no:
    s_mov_b32 s52, s30
    s_and_b32 s53, s31, 0xffff
    s_mov_b32 s54, 0x100
    s_mov_b32 s55, 0x00020000
    s_mov_b64 s[6:7], s[30:31]
    s_getreg_b32 s1, hwreg(HW_REG_XCC_ID)
    s_and_b32 s1, s1, 7
    s_lshl_b32 s1, s1, 3
    s_lshl_b32 s0, s64, 5
    s_cmp_lg_u32 s3, 0
    s_cbranch_scc1 .Lxa_no
    s_lshl_b64 s[56:57], 1, s1
    v_mov_b32 v8, s56
    v_mov_b32 v9, s57
    s_mov_b64 exec, 1
    buffer_atomic_add_x2 v[8:9], v2, s[52:55], s0 offen sc1
    v_mov_b32 v8, 0
    v_mov_b32 v9, 159232
    ds_write_b32 v9, v8
    s_waitcnt lgkmcnt(0)
    s_mov_b64 exec, -1
.Lxa_no:
    s_barrier
    s_cmp_lt_u32 s3, 4
    s_cbranch_scc1 1
    s_setprio 1
.Lresume:
    s_cmp_lt_u32 s65, 9
    s_cbranch_scc1 .Le_a
    s_sub_u32 s56, 3, s64
    s_and_b32 s56, s56, 7
    s_lshl1_add_u32 s56, s56, 9
    s_sub_u32 s56, s65, s56
    s_cselect_b32 s57, 18, 0
    s_add_u32 s56, s56, s57
    s_sub_u32 s101, s56, 2
    s_cmp_ge_u32 s56, 5
    s_addc_u32 s101, s101, 0
    s_sub_u32 s99, s56, 5
    s_min_u32 s99, s99, 7
    s_cmp_lt_u32 s65, 27
    s_cbranch_scc1 .Lrole_bc
    s_mov_b32 s101, 3
    s_sub_u32 s99, s65, 27
    s_cmp_ge_u32 s65, 31
    s_cselect_b32 s56, 2, 9
.Lrole_bc:
    s_lshl3_add_u32 s99, s99, s64
    s_sub_u32 s56, s56, 2
    s_cmp_lt_u32 s56, 7
    s_cbranch_scc1 .Le_q
    s_cmp_lt_u32 s99, 18
    s_cbranch_scc1 .Le_mc
    s_cmp_lt_u32 s99, 54
    s_mov_b32 s14, 0xfdff7fdf
    s_cselect_b32 s14, 0x6b5ad6b5, s14
    s_mov_b32 s15, 0xff7fdff7
    s_cselect_b32 s15, 0x5ad6b5ad, s15
    s_cselect_b32 s30, -30, 0
    s_add_u32 s30, s30, 0
    s_add_u32 s30, s30, s70
    s_sub_u32 s56, s65, 9
    s_lshr_b32 s56, s56, 1
    s_add_u32 s56, s56, s64
    s_and_b32 s56, s56, 7
    s_cmp_eq_u32 s56, 3
    s_cselect_b32 s56, -30, 0
    s_cmp_lt_u32 s99, 54
    s_cselect_b32 s56, 0, s56
    s_add_u32 s30, s30, s56
    s_waitcnt vmcnt(3)
    s_bitcmp1_b64 s[14:15], 4
    s_cbranch_scc0 1
    s_waitcnt vmcnt(2)
    s_add_u32 s63, s69, 32768
    buffer_load_dwordx4 v[96:99], v1, s[40:43], s63 offen nt
    s_memrealtime s[8:9]
    s_waitcnt lgkmcnt(0)
    s_sub_u32 s8, s8, s30
    s_cmpk_ge_u32 s8, 290
    s_cbranch_scc1 .ap_1
    s_waitcnt vmcnt(4)
    s_cmpk_ge_u32 s8, 225
    s_cbranch_scc1 .ap_1
    s_waitcnt vmcnt(3)
    s_bitcmp1_b64 s[14:15], 5
    s_cbranch_scc0 1
    s_waitcnt vmcnt(2)
    s_cmpk_ge_u32 s8, 150
    s_cbranch_scc1 .ap_1
    s_waitcnt vmcnt(1)
.ap_1:
    s_add_u32 s63, s69, 40960
    buffer_load_dwordx4 v[100:103], v1, s[40:43], s63 offen nt
    s_memrealtime s[8:9]
    s_waitcnt lgkmcnt(0)
    s_sub_u32 s8, s8, s30
    s_cmpk_ge_u32 s8, 315
    s_cbranch_scc1 .ap_2
    s_waitcnt vmcnt(5)
    s_cmpk_ge_u32 s8, 250
    s_cbranch_scc1 .ap_2
    s_waitcnt vmcnt(3)
    s_bitcmp1_b64 s[14:15], 6
    s_cbranch_scc0 1
    s_waitcnt vmcnt(2)
    s_cmpk_ge_u32 s8, 175
    s_cbranch_scc1 .ap_2
    s_waitcnt vmcnt(1)
.ap_2:
    s_add_u32 s63, s69, 49152
    buffer_load_dwordx4 v[128:131], v1, s[40:43], s63 offen nt
    s_memrealtime s[8:9]
    s_waitcnt lgkmcnt(0)
    s_sub_u32 s8, s8, s30
    s_cmpk_ge_u32 s8, 340
    s_cbranch_scc1 .ap_3
    s_waitcnt vmcnt(5)
    s_cmpk_ge_u32 s8, 275
    s_cbranch_scc1 .ap_3
    s_waitcnt vmcnt(3)
    s_bitcmp1_b64 s[14:15], 7
    s_cbranch_scc0 1
    s_waitcnt vmcnt(2)
    s_cmpk_ge_u32 s8, 200
    s_cbranch_scc1 .ap_3
    s_waitcnt vmcnt(1)
.ap_3:
    s_add_u32 s63, s69, 57344
    buffer_load_dwordx4 v[132:135], v1, s[40:43], s63 offen nt
    s_memrealtime s[8:9]
    s_waitcnt lgkmcnt(0)
    s_sub_u32 s8, s8, s30
    s_cmpk_ge_u32 s8, 365
    s_cbranch_scc1 .ap_4
    s_waitcnt vmcnt(5)
    s_cmpk_ge_u32 s8, 300
    s_cbranch_scc1 .ap_4
    s_waitcnt vmcnt(3)
    s_bitcmp1_b64 s[14:15], 8
    s_cbranch_scc0 1
    s_waitcnt vmcnt(2)
    s_cmpk_ge_u32 s8, 225
    s_cbranch_scc1 .ap_4
    s_waitcnt vmcnt(1)
.ap_4:
    s_add_u32 s63, s69, 131072
    buffer_load_dwordx4 v[40:43], v1, s[40:43], s63 offen nt
    s_memrealtime s[8:9]
    s_waitcnt lgkmcnt(0)
    s_sub_u32 s8, s8, s30
    s_cmpk_ge_u32 s8, 390
    s_cbranch_scc1 .ap_5
    s_waitcnt vmcnt(5)
    s_cmpk_ge_u32 s8, 325
    s_cbranch_scc1 .ap_5
    s_waitcnt vmcnt(3)
    s_bitcmp1_b64 s[14:15], 9
    s_cbranch_scc0 1
    s_waitcnt vmcnt(2)
    s_cmpk_ge_u32 s8, 250
    s_cbranch_scc1 .ap_5
    s_waitcnt vmcnt(1)
.ap_5:
    s_add_u32 s63, s69, 139264
    buffer_load_dwordx4 v[44:47], v1, s[40:43], s63 offen nt
    s_waitcnt lgkmcnt(0)
    s_add_u32 s34, s34, 1
    s_cmp_lt_u32 s99, 54
    s_cbranch_scc1 .Le_mr
    s_sub_u32 s57, s65, 9
    s_bitcmp1_b32 s57, 0
    s_cselect_b32 s48, s20, s18
    s_cselect_b32 s49, s21, s19
    s_cselect_b32 s33, 36, 0
    s_and_b32 s49, s49, 0xffff
    s_mov_b32 s50, 0x510000
    s_mov_b32 s51, 0x00020000
    s_mov_b32 s52, s22
    s_and_b32 s53, s23, 0xffff
    s_mov_b32 s54, 0x510000
    s_mov_b32 s55, 0x00020000
    s_lshr_b32 s57, s57, 1
    s_lshl_b32 s57, s57, 7
    s_mul_i32 s101, s64, 1152
    s_add_u32 s101, s101, s57
    s_mul_i32 s56, s3, 73728
    s_add_u32 s101, s101, s56
    s_mul_i32 s56, s64, 72
    s_add_u32 s33, s33, s56
    s_add_u32 s33, s33, s3
    s_mul_i32 s33, s33, 9216
    s_add_u32 s33, s33, s57
    s_bfe_u32 s56, s101, 0x30007
    s_cmp_eq_u32 s56, 3
    s_cselect_b32 s100, 1, 0
    v_bfe_u32 v12, v0, 4, 1
    s_and_b32 s56, s3, 3
    s_lshl_b32 s56, s56, 1
    v_or_b32 v12, s56, v12
    v_and_b32 v6, 7, v0
    v_xor_b32 v12, v12, v6
    v_lshrrev_b32 v6, 3, v0
    v_mul_u32_u24 v6, 9216, v6
    v_lshl_add_u32 v6, v12, 4, v6
    v_bfe_u32 v12, v0, 4, 1
    s_and_b32 s56, s3, 1
    s_lshl_b32 s56, s56, 2
    v_lshl_or_b32 v12, v12, 1, s56
    v_and_b32 v13, 7, v0
    v_xor_b32 v12, v12, v13
    v_lshrrev_b32 v13, 3, v0
    v_mul_u32_u24 v13, 1152, v13
    v_lshl_add_u32 v31, v12, 4, v13
    s_lshl_b32 s32, s3, 10
    s_memrealtime s[8:9]
    s_waitcnt vmcnt(8)
    s_waitcnt lgkmcnt(0)
    s_sub_u32 s8, s8, s30
    s_cmpk_ge_u32 s8, 436
    s_cbranch_scc1 .ap_6
    s_waitcnt vmcnt(5)
    s_cmpk_ge_u32 s8, 371
    s_cbranch_scc1 .ap_6
    s_waitcnt vmcnt(3)
    s_bitcmp1_b64 s[14:15], 10
    s_cbranch_scc0 1
    s_waitcnt vmcnt(2)
    s_cmpk_ge_u32 s8, 296
    s_cbranch_scc1 .ap_6
    s_waitcnt vmcnt(1)
.ap_6:
    s_add_u32 s63, s69, 147456
    buffer_load_dwordx4 v[72:75], v1, s[40:43], s63 offen nt
    s_cmp_eq_u32 s100, 0
    s_cbranch_scc1 .ls_7
    s_add_u32 m0, s32, 0
    s_add_u32 s56, s101, 0
    buffer_load_dwordx4 v6, s[48:51], s56 offen nt lds
.ls_7:
    s_memrealtime s[8:9]
    s_waitcnt vmcnt(8)
    s_waitcnt lgkmcnt(0)
    s_sub_u32 s8, s8, s30
    s_cmpk_ge_u32 s8, 482
    s_cbranch_scc1 .ap_8
    s_waitcnt vmcnt(5)
    s_cmpk_ge_u32 s8, 417
    s_cbranch_scc1 .ap_8
    s_waitcnt vmcnt(3)
    s_bitcmp1_b64 s[14:15], 11
    s_cbranch_scc0 1
    s_waitcnt vmcnt(2)
    s_cmpk_ge_u32 s8, 342
    s_cbranch_scc1 .ap_8
    s_waitcnt vmcnt(1)
.ap_8:
    s_add_u32 s63, s69, 155648
    buffer_load_dwordx4 v[76:79], v1, s[40:43], s63 offen nt
    s_memrealtime s[8:9]
    s_waitcnt vmcnt(8)
    s_waitcnt lgkmcnt(0)
    s_sub_u32 s8, s8, s30
    s_cmpk_ge_u32 s8, 528
    s_cbranch_scc1 .ap_9
    s_waitcnt vmcnt(5)
    s_cmpk_ge_u32 s8, 463
    s_cbranch_scc1 .ap_9
    s_waitcnt vmcnt(3)
    s_bitcmp1_b64 s[14:15], 12
    s_cbranch_scc0 1
    s_waitcnt vmcnt(2)
    s_cmpk_ge_u32 s8, 388
    s_cbranch_scc1 .ap_9
    s_waitcnt vmcnt(1)
.ap_9:
    s_add_u32 s63, s69, 163840
    buffer_load_dwordx4 v[104:107], v1, s[40:43], s63 offen nt
    s_memrealtime s[8:9]
    s_waitcnt vmcnt(8)
    s_waitcnt lgkmcnt(0)
    s_sub_u32 s8, s8, s30
    s_cmpk_ge_u32 s8, 574
    s_cbranch_scc1 .ap_10
    s_waitcnt vmcnt(5)
    s_cmpk_ge_u32 s8, 509
    s_cbranch_scc1 .ap_10
    s_waitcnt vmcnt(3)
    s_bitcmp1_b64 s[14:15], 13
    s_cbranch_scc0 1
    s_waitcnt vmcnt(2)
    s_cmpk_ge_u32 s8, 434
    s_cbranch_scc1 .ap_10
    s_waitcnt vmcnt(1)
.ap_10:
    s_add_u32 s63, s69, 172032
    buffer_load_dwordx4 v[108:111], v1, s[40:43], s63 offen nt
    s_cmp_eq_u32 s100, 0
    s_cbranch_scc1 .ls_11
    s_add_u32 m0, s32, 8192
    s_add_u32 s56, s101, 589824
    buffer_load_dwordx4 v6, s[48:51], s56 offen nt lds
.ls_11:
    s_memrealtime s[8:9]
    s_waitcnt vmcnt(8)
    s_waitcnt lgkmcnt(0)
    s_sub_u32 s8, s8, s30
    s_cmpk_ge_u32 s8, 620
    s_cbranch_scc1 .ap_12
    s_waitcnt vmcnt(5)
    s_cmpk_ge_u32 s8, 555
    s_cbranch_scc1 .ap_12
    s_waitcnt vmcnt(3)
    s_bitcmp1_b64 s[14:15], 14
    s_cbranch_scc0 1
    s_waitcnt vmcnt(2)
    s_cmpk_ge_u32 s8, 480
    s_cbranch_scc1 .ap_12
    s_waitcnt vmcnt(1)
.ap_12:
    s_add_u32 s63, s69, 180224
    buffer_load_dwordx4 v[136:139], v1, s[40:43], s63 offen nt
    s_memrealtime s[8:9]
    s_waitcnt vmcnt(8)
    s_waitcnt lgkmcnt(0)
    s_sub_u32 s8, s8, s30
    s_cmpk_ge_u32 s8, 666
    s_cbranch_scc1 .ap_13
    s_waitcnt vmcnt(5)
    s_cmpk_ge_u32 s8, 601
    s_cbranch_scc1 .ap_13
    s_waitcnt vmcnt(3)
    s_bitcmp1_b64 s[14:15], 15
    s_cbranch_scc0 1
    s_waitcnt vmcnt(2)
    s_cmpk_ge_u32 s8, 526
    s_cbranch_scc1 .ap_13
    s_waitcnt vmcnt(1)
.ap_13:
    s_add_u32 s63, s69, 188416
    buffer_load_dwordx4 v[140:143], v1, s[40:43], s63 offen nt
    s_memrealtime s[8:9]
    s_waitcnt vmcnt(8)
    s_waitcnt lgkmcnt(0)
    s_sub_u32 s8, s8, s30
    s_cmpk_ge_u32 s8, 712
    s_cbranch_scc1 .ap_14
    s_waitcnt vmcnt(5)
    s_cmpk_ge_u32 s8, 647
    s_cbranch_scc1 .ap_14
    s_waitcnt vmcnt(3)
    s_bitcmp1_b64 s[14:15], 16
    s_cbranch_scc0 1
    s_waitcnt vmcnt(2)
    s_cmpk_ge_u32 s8, 572
    s_cbranch_scc1 .ap_14
    s_waitcnt vmcnt(1)
.ap_14:
    s_add_u32 s63, s69, 262144
    buffer_load_dwordx4 v[48:51], v1, s[40:43], s63 offen nt
    s_cmp_eq_u32 s100, 0
    s_cbranch_scc1 .ls_15
    s_add_u32 m0, s32, 16384
    s_add_u32 s56, s101, 1179648
    buffer_load_dwordx4 v6, s[48:51], s56 offen nt lds
.ls_15:
    s_memrealtime s[8:9]
    s_waitcnt vmcnt(8)
    s_waitcnt lgkmcnt(0)
    s_sub_u32 s8, s8, s30
    s_cmpk_ge_u32 s8, 758
    s_cbranch_scc1 .ap_16
    s_waitcnt vmcnt(5)
    s_cmpk_ge_u32 s8, 693
    s_cbranch_scc1 .ap_16
    s_waitcnt vmcnt(3)
    s_bitcmp1_b64 s[14:15], 17
    s_cbranch_scc0 1
    s_waitcnt vmcnt(2)
    s_cmpk_ge_u32 s8, 618
    s_cbranch_scc1 .ap_16
    s_waitcnt vmcnt(1)
.ap_16:
    s_add_u32 s63, s69, 270336
    buffer_load_dwordx4 v[52:55], v1, s[40:43], s63 offen nt
    s_memrealtime s[8:9]
    s_waitcnt vmcnt(8)
    s_waitcnt lgkmcnt(0)
    s_sub_u32 s8, s8, s30
    s_cmpk_ge_u32 s8, 804
    s_cbranch_scc1 .ap_17
    s_waitcnt vmcnt(5)
    s_cmpk_ge_u32 s8, 739
    s_cbranch_scc1 .ap_17
    s_waitcnt vmcnt(3)
    s_bitcmp1_b64 s[14:15], 18
    s_cbranch_scc0 1
    s_waitcnt vmcnt(2)
    s_cmpk_ge_u32 s8, 664
    s_cbranch_scc1 .ap_17
    s_waitcnt vmcnt(1)
.ap_17:
    s_add_u32 s63, s69, 278528
    buffer_load_dwordx4 v[80:83], v1, s[40:43], s63 offen nt
    v_and_b32 v157, 7, v0
    v_lshlrev_b32 v157, 7, v157
    s_mov_b32 s63, 0x400
    buffer_load_dword v156, v157, s[36:39], s63 offen
    s_memrealtime s[8:9]
    s_waitcnt vmcnt(9)
    s_waitcnt lgkmcnt(0)
    s_sub_u32 s8, s8, s30
    s_cmpk_ge_u32 s8, 850
    s_cbranch_scc1 .ap_18
    s_waitcnt vmcnt(6)
    s_cmpk_ge_u32 s8, 785
    s_cbranch_scc1 .ap_18
    s_waitcnt vmcnt(4)
    s_bitcmp1_b64 s[14:15], 19
    s_cbranch_scc0 1
    s_waitcnt vmcnt(3)
    s_cmpk_ge_u32 s8, 710
    s_cbranch_scc1 .ap_18
    s_waitcnt vmcnt(2)
.ap_18:
    s_add_u32 s63, s69, 286720
    buffer_load_dwordx4 v[84:87], v1, s[40:43], s63 offen nt
    s_cmp_eq_u32 s100, 0
    s_cbranch_scc1 .ls_19
    s_add_u32 m0, s32, 24576
    s_add_u32 s56, s101, 1769472
    buffer_load_dwordx4 v6, s[48:51], s56 offen nt lds
.ls_19:
    s_memrealtime s[8:9]
    s_waitcnt vmcnt(9)
    s_waitcnt lgkmcnt(0)
    s_sub_u32 s8, s8, s30
    s_cmpk_ge_u32 s8, 895
    s_cbranch_scc1 .ap_20
    s_waitcnt vmcnt(6)
    s_cmpk_ge_u32 s8, 830
    s_cbranch_scc1 .ap_20
    s_waitcnt vmcnt(4)
    s_bitcmp1_b64 s[14:15], 20
    s_cbranch_scc0 1
    s_waitcnt vmcnt(3)
    s_cmpk_ge_u32 s8, 755
    s_cbranch_scc1 .ap_20
    s_waitcnt vmcnt(2)
.ap_20:
    s_add_u32 s63, s69, 294912
    buffer_load_dwordx4 v[112:115], v1, s[40:43], s63 offen nt
    s_memrealtime s[8:9]
    s_waitcnt vmcnt(9)
    s_waitcnt lgkmcnt(0)
    s_sub_u32 s8, s8, s30
    s_cmpk_ge_u32 s8, 940
    s_cbranch_scc1 .ap_21
    s_waitcnt vmcnt(6)
    s_cmpk_ge_u32 s8, 875
    s_cbranch_scc1 .ap_21
    s_waitcnt vmcnt(4)
    s_bitcmp1_b64 s[14:15], 21
    s_cbranch_scc0 1
    s_waitcnt vmcnt(3)
    s_cmpk_ge_u32 s8, 800
    s_cbranch_scc1 .ap_21
    s_waitcnt vmcnt(1)
.ap_21:
    s_add_u32 s63, s69, 303104
    buffer_load_dwordx4 v[116:119], v1, s[40:43], s63 offen nt
    s_memrealtime s[8:9]
    s_waitcnt vmcnt(9)
    s_waitcnt lgkmcnt(0)
    s_sub_u32 s8, s8, s30
    s_cmpk_ge_u32 s8, 985
    s_cbranch_scc1 .ap_22
    s_waitcnt vmcnt(6)
    s_cmpk_ge_u32 s8, 920
    s_cbranch_scc1 .ap_22
    s_waitcnt vmcnt(4)
    s_bitcmp1_b64 s[14:15], 22
    s_cbranch_scc0 1
    s_waitcnt vmcnt(2)
    s_cmpk_ge_u32 s8, 845
    s_cbranch_scc1 .ap_22
    s_waitcnt vmcnt(1)
.ap_22:
    s_add_u32 s63, s69, 311296
    buffer_load_dwordx4 v[144:147], v1, s[40:43], s63 offen nt
    s_waitcnt vmcnt(4)
    s_sub_u32 s63, s70, 300
    v_subrev_u32 v156, s63, v156
    v_mov_b32 v157, 600
    v_cmp_lt_u32 s[8:9], v156, v157
    v_add_u32_dpp v156, v156, v156 quad_perm:[1,0,3,2] row_mask:0xf bank_mask:0xf
    s_nop 1
    v_add_u32_dpp v156, v156, v156 quad_perm:[2,3,0,1] row_mask:0xf bank_mask:0xf
    s_nop 1
    v_add_u32_dpp v156, v156, v156 row_ror:4 row_mask:0xf bank_mask:0xf
    s_nop 0
    v_readfirstlane_b32 s63, v156
    s_cmp_eq_u64 s[8:9], -1
    s_nop 3
    s_cbranch_scc0 .et_23
    s_lshr_b32 s63, s63, 3
    s_sub_u32 s63, s63, 300
    s_add_u32 s30, s30, s63
.et_23:
    s_cmp_eq_u32 s100, 0
    s_cbranch_scc1 .ls_24
    s_add_u32 m0, s32, 32768
    s_add_u32 s56, s101, 2359296
    buffer_load_dwordx4 v6, s[48:51], s56 offen nt lds
.ls_24:
    s_memrealtime s[8:9]
    s_waitcnt lgkmcnt(0)
    s_sub_u32 s8, s8, s30
    s_cmpk_ge_u32 s8, 1030
    s_cbranch_scc1 .ap_25
    s_waitcnt vmcnt(4)
    s_cmpk_ge_u32 s8, 965
    s_cbranch_scc1 .ap_25
    s_waitcnt vmcnt(3)
    s_bitcmp1_b64 s[14:15], 23
    s_cbranch_scc0 1
    s_waitcnt vmcnt(2)
    s_cmpk_ge_u32 s8, 890
    s_cbranch_scc1 .ap_25
    s_waitcnt vmcnt(1)
.ap_25:
    s_add_u32 s63, s69, 319488
    buffer_load_dwordx4 v[148:151], v1, s[40:43], s63 offen nt
    s_memrealtime s[8:9]
    s_waitcnt lgkmcnt(0)
    s_sub_u32 s8, s8, s30
    s_cmpk_ge_u32 s8, 1075
    s_cbranch_scc1 .ap_26
    s_waitcnt vmcnt(5)
    s_cmpk_ge_u32 s8, 1010
    s_cbranch_scc1 .ap_26
    s_waitcnt vmcnt(3)
    s_bitcmp1_b64 s[14:15], 24
    s_cbranch_scc0 1
    s_waitcnt vmcnt(2)
    s_cmpk_ge_u32 s8, 935
    s_cbranch_scc1 .ap_26
    s_waitcnt vmcnt(1)
.ap_26:
    s_add_u32 s63, s69, 393216
    buffer_load_dwordx4 v[56:59], v1, s[40:43], s63 offen nt
    s_memrealtime s[8:9]
    s_waitcnt lgkmcnt(0)
    s_sub_u32 s8, s8, s30
    s_cmpk_ge_u32 s8, 1120
    s_cbranch_scc1 .ap_27
    s_waitcnt vmcnt(5)
    s_cmpk_ge_u32 s8, 1055
    s_cbranch_scc1 .ap_27
    s_waitcnt vmcnt(3)
    s_bitcmp1_b64 s[14:15], 25
    s_cbranch_scc0 1
    s_waitcnt vmcnt(2)
    s_cmpk_ge_u32 s8, 980
    s_cbranch_scc1 .ap_27
    s_waitcnt vmcnt(1)
.ap_27:
    s_add_u32 s63, s69, 401408
    buffer_load_dwordx4 v[60:63], v1, s[40:43], s63 offen nt
    s_branch .Latt_bc
.Le_mr:
    s_mul_i32 s58, s3, 1152
    s_mov_b32 s52, s24
    s_and_b32 s53, s25, 0xffff
    s_mov_b32 s54, 0x2400
    s_mov_b32 s55, 0x00020000
    buffer_load_dwordx2 v[246:247], v3, s[52:55], s58 offen
    buffer_load_dwordx2 v[248:249], v3, s[52:55], s58 offen offset:512
    buffer_load_dword v250, v4, s[52:55], s58 offen
    s_mov_b32 s48, s26
    s_and_b32 s49, s27, 0xffff
    s_mov_b32 s50, 0x3cc000
    s_mov_b32 s51, 0x00020000
    v_bfe_u32 v12, v0, 4, 1
    s_and_b32 s56, s3, 3
    s_lshl_b32 s56, s56, 1
    v_or_b32 v12, s56, v12
    v_and_b32 v19, 7, v0
    v_xor_b32 v12, v12, v19
    v_lshrrev_b32 v19, 3, v0
    v_mul_u32_u24 v19, 6912, v19
    v_lshl_add_u32 v19, v12, 4, v19
    s_mul_i32 s57, s3, 55296
    s_lshl_b32 s59, s99, 7
    s_add_u32 s57, s57, s59
    s_lshl_b32 s100, s3, 10
    s_add_u32 m0, s100, 0
    s_add_u32 s56, s57, 0
    buffer_load_dwordx4 v19, s[48:51], s56 offen nt lds
    s_add_u32 m0, s100, 8192
    s_add_u32 s56, s57, 442368
    buffer_load_dwordx4 v19, s[48:51], s56 offen nt lds
    s_add_u32 m0, s100, 16384
    s_add_u32 s56, s57, 884736
    buffer_load_dwordx4 v19, s[48:51], s56 offen nt lds
    s_add_u32 m0, s100, 24576
    s_add_u32 s56, s57, 1327104
    buffer_load_dwordx4 v19, s[48:51], s56 offen nt lds
    s_add_u32 m0, s100, 32768
    s_add_u32 s56, s57, 1769472
    buffer_load_dwordx4 v19, s[48:51], s56 offen nt lds
    s_add_u32 m0, s100, 40960
    s_add_u32 s56, s57, 2211840
    buffer_load_dwordx4 v19, s[48:51], s56 offen nt lds
    s_add_u32 m0, s100, 49152
    s_add_u32 s56, s57, 2654208
    buffer_load_dwordx4 v19, s[48:51], s56 offen nt lds
    s_add_u32 m0, s100, 57344
    s_add_u32 s56, s57, 3096576
    buffer_load_dwordx4 v19, s[48:51], s56 offen nt lds
    s_add_u32 m0, s100, 65536
    s_add_u32 s56, s57, 3538944
    buffer_load_dwordx4 v19, s[48:51], s56 offen nt lds
    v_bfe_u32 v16, v0, 1, 3
    v_mul_u32_u24 v16, 1312, v16
    v_lshrrev_b32 v12, 4, v0
    v_lshl_add_u32 v16, v12, 5, v16
    v_and_b32 v12, 1, v0
    v_lshl_add_u32 v16, v12, 4, v16
    v_add_u32 v16, 147456, v16
    s_mul_i32 s56, s3, 1312
    s_add_u32 s56, s56, 147456
    v_add_u32 v17, s56, v3
    v_add_u32 v18, s56, v4
    v_lshrrev_b32 v12, 4, v0
    v_bfe_u32 v13, v0, 1, 1
    v_lshl_add_u32 v12, v12, 1, v13
    v_bfe_u32 v13, v0, 2, 2
    v_lshl_add_u32 v20, v12, 3, v13
    v_lshlrev_b32 v20, 7, v20
    v_and_b32 v12, 3, v12
    v_lshrrev_b32 v13, 1, v13
    v_lshl_add_u32 v12, v12, 1, v13
    v_xor_b32 v12, s3, v12
    v_lshl_add_u32 v20, v12, 4, v20
    v_and_b32 v12, 1, v0
    v_lshl_add_u32 v20, v12, 3, v20
    v_bfe_u32 v23, v0, 1, 3
    v_mul_u32_u24 v23, 144, v23
    v_bfe_u32 v12, v0, 4, 1
    v_lshl_add_u32 v23, v12, 3, v23
    v_lshrrev_b32 v12, 5, v0
    v_lshl_add_u32 v23, v12, 2, v23
    v_and_b32 v12, 1, v0
    v_lshl_add_u32 v23, v12, 1, v23
    s_lshl_b32 s56, s3, 4
    s_add_u32 s56, s56, 157952
    v_add_u32 v23, s56, v23
    v_and_b32 v24, 15, v0
    v_lshlrev_b32 v24, 3, v24
    s_mul_i32 s56, s3, 144
    s_add_u32 s56, s56, 157952
    v_add_u32 v24, s56, v24
    v_add_u32 v21, 32768, v20
    s_lshl_b32 s100, s3, 10
    v_lshrrev_b32 v12, 4, v0
    v_mul_u32_u24 v12, 18432, v12
    v_and_b32 v13, 15, v0
    v_lshl_add_u32 v22, v13, 4, v12
    s_mul_i32 s57, s99, 57
    s_lshr_b32 s57, s57, 9
    s_mul_i32 s58, s57, 9
    s_sub_u32 s58, s99, s58
    s_mul_i32 s59, s57, 36864
    s_lshl_b32 s58, s58, 8
    s_add_u32 s59, s59, s58
    s_mul_i32 s58, s3, 2304
    s_add_u32 s59, s59, s58
    s_add_u32 s59, s59, 0x3000
    s_mov_b32 s58, 0
    s_cmp_eq_u32 s57, 1
    s_cselect_b32 s58, 1.0, s58
    s_cmp_eq_u32 s57, 4
    s_cselect_b32 s58, 1.0, s58
    s_waitcnt vmcnt(9)
    v_lshlrev_b32 v236, 16, v246
    v_and_b32 v237, 0xffff0000, v246
    v_max_f32 v236, 0xc2ae0000, v236
    v_min_f32 v242, 0x43000000, v236
    v_mul_f32 v238, 0xbfb8aa3b, v242
    v_fma_f32 v240, v242, s98, -v238
    v_fmac_f32 v240, 0xb2a57060, v242
    v_exp_f32 v238, v238
    v_mul_f32 v240, 0x3f317218, v240
    v_fmac_f32 v238, v238, v240
    v_add_f32 v238, 1.0, v238
    v_rcp_f32 v240, v238
    s_nop 0
    v_mul_f32 v242, v236, v240
    v_fma_f32 v238, -v242, v238, v236
    v_fma_f32 v236, v238, v240, v242
    v_max_f32 v237, 0xc2ae0000, v237
    v_min_f32 v243, 0x43000000, v237
    v_mul_f32 v239, 0xbfb8aa3b, v243
    v_fma_f32 v241, v243, s98, -v239
    v_fmac_f32 v241, 0xb2a57060, v243
    v_exp_f32 v239, v239
    v_mul_f32 v241, 0x3f317218, v241
    v_fmac_f32 v239, v239, v241
    v_add_f32 v239, 1.0, v239
    v_rcp_f32 v241, v239
    s_nop 0
    v_mul_f32 v243, v237, v241
    v_fma_f32 v239, -v243, v239, v237
    v_fma_f32 v237, v239, v241, v243
    v_cvt_pk_bf16_f32 v246, v236, v237
    v_lshlrev_b32 v236, 16, v247
    v_and_b32 v237, 0xffff0000, v247
    v_max_f32 v236, 0xc2ae0000, v236
    v_min_f32 v242, 0x43000000, v236
    v_mul_f32 v238, 0xbfb8aa3b, v242
    v_fma_f32 v240, v242, s98, -v238
    v_fmac_f32 v240, 0xb2a57060, v242
    v_exp_f32 v238, v238
    v_mul_f32 v240, 0x3f317218, v240
    v_fmac_f32 v238, v238, v240
    v_add_f32 v238, 1.0, v238
    v_rcp_f32 v240, v238
    s_nop 0
    v_mul_f32 v242, v236, v240
    v_fma_f32 v238, -v242, v238, v236
    v_fma_f32 v236, v238, v240, v242
    v_max_f32 v237, 0xc2ae0000, v237
    v_min_f32 v243, 0x43000000, v237
    v_mul_f32 v239, 0xbfb8aa3b, v243
    v_fma_f32 v241, v243, s98, -v239
    v_fmac_f32 v241, 0xb2a57060, v243
    v_exp_f32 v239, v239
    v_mul_f32 v241, 0x3f317218, v241
    v_fmac_f32 v239, v239, v241
    v_add_f32 v239, 1.0, v239
    v_rcp_f32 v241, v239
    s_nop 0
    v_mul_f32 v243, v237, v241
    v_fma_f32 v239, -v243, v239, v237
    v_fma_f32 v237, v239, v241, v243
    v_cvt_pk_bf16_f32 v247, v236, v237
    v_lshlrev_b32 v236, 16, v248
    v_and_b32 v237, 0xffff0000, v248
    v_max_f32 v236, 0xc2ae0000, v236
    v_min_f32 v242, 0x43000000, v236
    v_mul_f32 v238, 0xbfb8aa3b, v242
    v_fma_f32 v240, v242, s98, -v238
    v_fmac_f32 v240, 0xb2a57060, v242
    v_exp_f32 v238, v238
    v_mul_f32 v240, 0x3f317218, v240
    v_fmac_f32 v238, v238, v240
    v_add_f32 v238, 1.0, v238
    v_rcp_f32 v240, v238
    s_nop 0
    v_mul_f32 v242, v236, v240
    v_fma_f32 v238, -v242, v238, v236
    v_fma_f32 v236, v238, v240, v242
    v_max_f32 v237, 0xc2ae0000, v237
    v_min_f32 v243, 0x43000000, v237
    v_mul_f32 v239, 0xbfb8aa3b, v243
    v_fma_f32 v241, v243, s98, -v239
    v_fmac_f32 v241, 0xb2a57060, v243
    v_exp_f32 v239, v239
    v_mul_f32 v241, 0x3f317218, v241
    v_fmac_f32 v239, v239, v241
    v_add_f32 v239, 1.0, v239
    v_rcp_f32 v241, v239
    s_nop 0
    v_mul_f32 v243, v237, v241
    v_fma_f32 v239, -v243, v239, v237
    v_fma_f32 v237, v239, v241, v243
    v_cvt_pk_bf16_f32 v248, v236, v237
    v_lshlrev_b32 v236, 16, v249
    v_and_b32 v237, 0xffff0000, v249
    v_max_f32 v236, 0xc2ae0000, v236
    v_min_f32 v242, 0x43000000, v236
    v_mul_f32 v238, 0xbfb8aa3b, v242
    v_fma_f32 v240, v242, s98, -v238
    v_fmac_f32 v240, 0xb2a57060, v242
    v_exp_f32 v238, v238
    v_mul_f32 v240, 0x3f317218, v240
    v_fmac_f32 v238, v238, v240
    v_add_f32 v238, 1.0, v238
    v_rcp_f32 v240, v238
    s_nop 0
    v_mul_f32 v242, v236, v240
    v_fma_f32 v238, -v242, v238, v236
    v_fma_f32 v236, v238, v240, v242
    v_max_f32 v237, 0xc2ae0000, v237
    v_min_f32 v243, 0x43000000, v237
    v_mul_f32 v239, 0xbfb8aa3b, v243
    v_fma_f32 v241, v243, s98, -v239
    v_fmac_f32 v241, 0xb2a57060, v243
    v_exp_f32 v239, v239
    v_mul_f32 v241, 0x3f317218, v241
    v_fmac_f32 v239, v239, v241
    v_add_f32 v239, 1.0, v239
    v_rcp_f32 v241, v239
    s_nop 0
    v_mul_f32 v243, v237, v241
    v_fma_f32 v239, -v243, v239, v237
    v_fma_f32 v237, v239, v241, v243
    v_cvt_pk_bf16_f32 v249, v236, v237
    v_lshlrev_b32 v236, 16, v250
    v_and_b32 v237, 0xffff0000, v250
    v_max_f32 v236, 0xc2ae0000, v236
    v_min_f32 v242, 0x43000000, v236
    v_mul_f32 v238, 0xbfb8aa3b, v242
    v_fma_f32 v240, v242, s98, -v238
    v_fmac_f32 v240, 0xb2a57060, v242
    v_exp_f32 v238, v238
    v_mul_f32 v240, 0x3f317218, v240
    v_fmac_f32 v238, v238, v240
    v_add_f32 v238, 1.0, v238
    v_rcp_f32 v240, v238
    s_nop 0
    v_mul_f32 v242, v236, v240
    v_fma_f32 v238, -v242, v238, v236
    v_fma_f32 v236, v238, v240, v242
    v_max_f32 v237, 0xc2ae0000, v237
    v_min_f32 v243, 0x43000000, v237
    v_mul_f32 v239, 0xbfb8aa3b, v243
    v_fma_f32 v241, v243, s98, -v239
    v_fmac_f32 v241, 0xb2a57060, v243
    v_exp_f32 v239, v239
    v_mul_f32 v241, 0x3f317218, v241
    v_fmac_f32 v239, v239, v241
    v_add_f32 v239, 1.0, v239
    v_rcp_f32 v241, v239
    s_nop 0
    v_mul_f32 v243, v237, v241
    v_fma_f32 v239, -v243, v239, v237
    v_fma_f32 v237, v239, v241, v243
    v_cvt_pk_bf16_f32 v250, v236, v237
    ds_write_b64 v17, v[246:247]
    ds_write_b64 v17, v[248:249] offset:512
    ds_write_b32 v18, v250
    s_waitcnt vmcnt(3)
    s_add_u32 s63, s69, 147456
    buffer_load_dwordx4 v[72:75], v1, s[40:43], s63 offen nt
    s_waitcnt vmcnt(3)
    s_add_u32 s63, s69, 155648
    buffer_load_dwordx4 v[76:79], v1, s[40:43], s63 offen nt
    s_waitcnt vmcnt(3)
    s_add_u32 s63, s69, 163840
    buffer_load_dwordx4 v[104:107], v1, s[40:43], s63 offen nt
    s_waitcnt vmcnt(3)
    s_add_u32 s63, s69, 172032
    buffer_load_dwordx4 v[108:111], v1, s[40:43], s63 offen nt
    s_waitcnt vmcnt(3)
    s_add_u32 s63, s69, 180224
    buffer_load_dwordx4 v[136:139], v1, s[40:43], s63 offen nt
    s_waitcnt vmcnt(3)
    s_add_u32 s63, s69, 188416
    buffer_load_dwordx4 v[140:143], v1, s[40:43], s63 offen nt
    s_waitcnt vmcnt(3)
    s_add_u32 s63, s69, 262144
    buffer_load_dwordx4 v[48:51], v1, s[40:43], s63 offen nt
    s_waitcnt vmcnt(3)
    s_add_u32 s63, s69, 270336
    buffer_load_dwordx4 v[52:55], v1, s[40:43], s63 offen nt
    s_waitcnt lgkmcnt(0)
    s_barrier
    ds_read_b64_tr_b16 v[160:161], v20 offset:0
    ds_read_b64_tr_b16 v[162:163], v20 offset:512
    ds_read_b64_tr_b16 v[164:165], v20 offset:8192
    ds_read_b64_tr_b16 v[166:167], v20 offset:8704
    ds_read_b64_tr_b16 v[168:169], v20 offset:16384
    ds_read_b64_tr_b16 v[170:171], v20 offset:16896
    ds_read_b64_tr_b16 v[172:173], v20 offset:24576
    ds_read_b64_tr_b16 v[174:175], v20 offset:25088
    ds_read_b64_tr_b16 v[176:177], v21 offset:0
    ds_read_b64_tr_b16 v[178:179], v21 offset:512
    ds_read_b64_tr_b16 v[180:181], v21 offset:8192
    ds_read_b64_tr_b16 v[182:183], v21 offset:8704
    ds_read_b64_tr_b16 v[184:185], v21 offset:16384
    ds_read_b64_tr_b16 v[186:187], v21 offset:16896
    ds_read_b64_tr_b16 v[188:189], v21 offset:24576
    ds_read_b64_tr_b16 v[190:191], v21 offset:25088
    ds_read_b64_tr_b16 v[192:193], v21 offset:32768
    ds_read_b64_tr_b16 v[194:195], v21 offset:33280
    ds_read_b128 v[196:199], v16 offset:0
    ds_read_b128 v[200:203], v16 offset:128
    ds_read_b128 v[204:207], v16 offset:256
    ds_read_b128 v[208:211], v16 offset:384
    ds_read_b128 v[212:215], v16 offset:512
    ds_read_b128 v[216:219], v16 offset:640
    ds_read_b128 v[220:223], v16 offset:768
    ds_read_b128 v[224:227], v16 offset:896
    ds_read_b128 v[228:231], v16 offset:1024
    s_waitcnt lgkmcnt(8)
    v_mfma_f32_16x16x32_bf16 v[232:235], v[160:163], v[196:199], 0
    s_waitcnt lgkmcnt(7)
    v_mfma_f32_16x16x32_bf16 v[232:235], v[164:167], v[200:203], v[232:235]
    s_waitcnt lgkmcnt(6)
    v_mfma_f32_16x16x32_bf16 v[232:235], v[168:171], v[204:207], v[232:235]
    s_waitcnt lgkmcnt(5)
    v_mfma_f32_16x16x32_bf16 v[232:235], v[172:175], v[208:211], v[232:235]
    s_waitcnt lgkmcnt(4)
    v_mfma_f32_16x16x32_bf16 v[232:235], v[176:179], v[212:215], v[232:235]
    s_waitcnt lgkmcnt(3)
    v_mfma_f32_16x16x32_bf16 v[232:235], v[180:183], v[216:219], v[232:235]
    s_waitcnt lgkmcnt(2)
    v_mfma_f32_16x16x32_bf16 v[232:235], v[184:187], v[220:223], v[232:235]
    s_waitcnt lgkmcnt(1)
    v_mfma_f32_16x16x32_bf16 v[232:235], v[188:191], v[224:227], v[232:235]
    s_waitcnt lgkmcnt(0)
    v_mfma_f32_16x16x32_bf16 v[232:235], v[192:195], v[228:231], v[232:235]
    s_nop 7
    v_permlane32_swap_b32 v232, v234
    v_permlane32_swap_b32 v233, v235
    v_cndmask_b32 v233, v233, v234, s[96:97]
    v_cndmask_b32 v232, v232, v235, s[96:97]
    s_nop 1
    v_add_f32_dpp v236, v233, v232 quad_perm:[1,0,3,2] row_mask:0xf bank_mask:0xf
    v_cvt_pk_bf16_f32 v236, 0, v236
    v_add_f32 v236, s58, v236
    v_cvt_pk_bf16_f32 v236, v236, v236
    ds_write_b16 v23, v236
    v_mov_b32 v243, s34
    s_waitcnt lgkmcnt(0)
    s_barrier
    ds_read2_b32 v[244:245], v24 offset1:1
    v_mov_b32 v241, s34
    s_waitcnt lgkmcnt(0)
    v_mov_b32 v240, v244
    v_mov_b32 v242, v245
    s_mov_b64 exec, 0xffff
    buffer_store_dwordx4 v[240:243], v22, s[36:39], s59 offen sc1
    s_mov_b64 exec, -1
    s_nop 0
    s_branch .Le_m2
.Le_mc:
    v_bfe_u32 v16, v0, 1, 3
    v_mul_u32_u24 v16, 1312, v16
    v_lshrrev_b32 v12, 4, v0
    v_lshl_add_u32 v16, v12, 5, v16
    v_and_b32 v12, 1, v0
    v_lshl_add_u32 v16, v12, 4, v16
    v_add_u32 v16, 147456, v16
    s_mul_i32 s56, s3, 1312
    s_add_u32 s56, s56, 147456
    v_add_u32 v17, s56, v3
    v_add_u32 v18, s56, v4
    v_lshrrev_b32 v12, 4, v0
    v_bfe_u32 v13, v0, 1, 1
    v_lshl_add_u32 v12, v12, 1, v13
    v_bfe_u32 v13, v0, 2, 2
    v_lshl_add_u32 v20, v12, 3, v13
    v_lshlrev_b32 v20, 7, v20
    v_and_b32 v12, 3, v12
    v_lshrrev_b32 v13, 1, v13
    v_lshl_add_u32 v12, v12, 1, v13
    v_xor_b32 v12, s3, v12
    v_lshl_add_u32 v20, v12, 4, v20
    v_and_b32 v12, 1, v0
    v_lshl_add_u32 v20, v12, 3, v20
    v_bfe_u32 v23, v0, 1, 3
    v_mul_u32_u24 v23, 144, v23
    v_bfe_u32 v12, v0, 4, 1
    v_lshl_add_u32 v23, v12, 3, v23
    v_lshrrev_b32 v12, 5, v0
    v_lshl_add_u32 v23, v12, 2, v23
    v_and_b32 v12, 1, v0
    v_lshl_add_u32 v23, v12, 1, v23
    s_lshl_b32 s56, s3, 4
    s_add_u32 s56, s56, 157952
    v_add_u32 v23, s56, v23
    v_and_b32 v24, 15, v0
    v_lshlrev_b32 v24, 3, v24
    s_mul_i32 s56, s3, 144
    s_add_u32 s56, s56, 157952
    v_add_u32 v24, s56, v24
    v_add_u32 v21, 32768, v20
    s_lshl_b32 s100, s3, 10
    s_waitcnt lgkmcnt(0)
    s_add_u32 s34, s34, 1
    v_lshrrev_b32 v12, 4, v0
    v_mul_u32_u24 v12, 18432, v12
    v_and_b32 v13, 15, v0
    v_lshl_add_u32 v22, v13, 4, v12
    s_mul_i32 s57, s99, 57
    s_lshr_b32 s57, s57, 9
    s_mul_i32 s58, s57, 9
    s_sub_u32 s58, s99, s58
    s_mul_i32 s59, s57, 36864
    s_lshl_b32 s58, s58, 8
    s_add_u32 s59, s59, s58
    s_mul_i32 s58, s3, 2304
    s_add_u32 s59, s59, s58
    s_add_u32 s59, s59, 0x3000
    s_mov_b32 s58, 0
    s_cmp_eq_u32 s57, 1
    s_cselect_b32 s58, 1.0, s58
    s_cmp_eq_u32 s57, 4
    s_cselect_b32 s58, 1.0, s58
    s_waitcnt vmcnt(13)
    v_lshlrev_b32 v236, 16, v246
    v_and_b32 v237, 0xffff0000, v246
    v_max_f32 v236, 0xc2ae0000, v236
    v_min_f32 v242, 0x43000000, v236
    v_mul_f32 v238, 0xbfb8aa3b, v242
    v_fma_f32 v240, v242, s98, -v238
    v_fmac_f32 v240, 0xb2a57060, v242
    v_exp_f32 v238, v238
    v_mul_f32 v240, 0x3f317218, v240
    v_fmac_f32 v238, v238, v240
    v_add_f32 v238, 1.0, v238
    v_rcp_f32 v240, v238
    s_nop 0
    v_mul_f32 v242, v236, v240
    v_fma_f32 v238, -v242, v238, v236
    v_fma_f32 v236, v238, v240, v242
    v_max_f32 v237, 0xc2ae0000, v237
    v_min_f32 v243, 0x43000000, v237
    v_mul_f32 v239, 0xbfb8aa3b, v243
    v_fma_f32 v241, v243, s98, -v239
    v_fmac_f32 v241, 0xb2a57060, v243
    v_exp_f32 v239, v239
    v_mul_f32 v241, 0x3f317218, v241
    v_fmac_f32 v239, v239, v241
    v_add_f32 v239, 1.0, v239
    v_rcp_f32 v241, v239
    s_nop 0
    v_mul_f32 v243, v237, v241
    v_fma_f32 v239, -v243, v239, v237
    v_fma_f32 v237, v239, v241, v243
    v_cvt_pk_bf16_f32 v246, v236, v237
    v_lshlrev_b32 v236, 16, v247
    v_and_b32 v237, 0xffff0000, v247
    v_max_f32 v236, 0xc2ae0000, v236
    v_min_f32 v242, 0x43000000, v236
    v_mul_f32 v238, 0xbfb8aa3b, v242
    v_fma_f32 v240, v242, s98, -v238
    v_fmac_f32 v240, 0xb2a57060, v242
    v_exp_f32 v238, v238
    v_mul_f32 v240, 0x3f317218, v240
    v_fmac_f32 v238, v238, v240
    v_add_f32 v238, 1.0, v238
    v_rcp_f32 v240, v238
    s_nop 0
    v_mul_f32 v242, v236, v240
    v_fma_f32 v238, -v242, v238, v236
    v_fma_f32 v236, v238, v240, v242
    v_max_f32 v237, 0xc2ae0000, v237
    v_min_f32 v243, 0x43000000, v237
    v_mul_f32 v239, 0xbfb8aa3b, v243
    v_fma_f32 v241, v243, s98, -v239
    v_fmac_f32 v241, 0xb2a57060, v243
    v_exp_f32 v239, v239
    v_mul_f32 v241, 0x3f317218, v241
    v_fmac_f32 v239, v239, v241
    v_add_f32 v239, 1.0, v239
    v_rcp_f32 v241, v239
    s_nop 0
    v_mul_f32 v243, v237, v241
    v_fma_f32 v239, -v243, v239, v237
    v_fma_f32 v237, v239, v241, v243
    v_cvt_pk_bf16_f32 v247, v236, v237
    v_lshlrev_b32 v236, 16, v248
    v_and_b32 v237, 0xffff0000, v248
    v_max_f32 v236, 0xc2ae0000, v236
    v_min_f32 v242, 0x43000000, v236
    v_mul_f32 v238, 0xbfb8aa3b, v242
    v_fma_f32 v240, v242, s98, -v238
    v_fmac_f32 v240, 0xb2a57060, v242
    v_exp_f32 v238, v238
    v_mul_f32 v240, 0x3f317218, v240
    v_fmac_f32 v238, v238, v240
    v_add_f32 v238, 1.0, v238
    v_rcp_f32 v240, v238
    s_nop 0
    v_mul_f32 v242, v236, v240
    v_fma_f32 v238, -v242, v238, v236
    v_fma_f32 v236, v238, v240, v242
    v_max_f32 v237, 0xc2ae0000, v237
    v_min_f32 v243, 0x43000000, v237
    v_mul_f32 v239, 0xbfb8aa3b, v243
    v_fma_f32 v241, v243, s98, -v239
    v_fmac_f32 v241, 0xb2a57060, v243
    v_exp_f32 v239, v239
    v_mul_f32 v241, 0x3f317218, v241
    v_fmac_f32 v239, v239, v241
    v_add_f32 v239, 1.0, v239
    v_rcp_f32 v241, v239
    s_nop 0
    v_mul_f32 v243, v237, v241
    v_fma_f32 v239, -v243, v239, v237
    v_fma_f32 v237, v239, v241, v243
    v_cvt_pk_bf16_f32 v248, v236, v237
    v_lshlrev_b32 v236, 16, v249
    v_and_b32 v237, 0xffff0000, v249
    v_max_f32 v236, 0xc2ae0000, v236
    v_min_f32 v242, 0x43000000, v236
    v_mul_f32 v238, 0xbfb8aa3b, v242
    v_fma_f32 v240, v242, s98, -v238
    v_fmac_f32 v240, 0xb2a57060, v242
    v_exp_f32 v238, v238
    v_mul_f32 v240, 0x3f317218, v240
    v_fmac_f32 v238, v238, v240
    v_add_f32 v238, 1.0, v238
    v_rcp_f32 v240, v238
    s_nop 0
    v_mul_f32 v242, v236, v240
    v_fma_f32 v238, -v242, v238, v236
    v_fma_f32 v236, v238, v240, v242
    v_max_f32 v237, 0xc2ae0000, v237
    v_min_f32 v243, 0x43000000, v237
    v_mul_f32 v239, 0xbfb8aa3b, v243
    v_fma_f32 v241, v243, s98, -v239
    v_fmac_f32 v241, 0xb2a57060, v243
    v_exp_f32 v239, v239
    v_mul_f32 v241, 0x3f317218, v241
    v_fmac_f32 v239, v239, v241
    v_add_f32 v239, 1.0, v239
    v_rcp_f32 v241, v239
    s_nop 0
    v_mul_f32 v243, v237, v241
    v_fma_f32 v239, -v243, v239, v237
    v_fma_f32 v237, v239, v241, v243
    v_cvt_pk_bf16_f32 v249, v236, v237
    v_lshlrev_b32 v236, 16, v250
    v_and_b32 v237, 0xffff0000, v250
    v_max_f32 v236, 0xc2ae0000, v236
    v_min_f32 v242, 0x43000000, v236
    v_mul_f32 v238, 0xbfb8aa3b, v242
    v_fma_f32 v240, v242, s98, -v238
    v_fmac_f32 v240, 0xb2a57060, v242
    v_exp_f32 v238, v238
    v_mul_f32 v240, 0x3f317218, v240
    v_fmac_f32 v238, v238, v240
    v_add_f32 v238, 1.0, v238
    v_rcp_f32 v240, v238
    s_nop 0
    v_mul_f32 v242, v236, v240
    v_fma_f32 v238, -v242, v238, v236
    v_fma_f32 v236, v238, v240, v242
    v_max_f32 v237, 0xc2ae0000, v237
    v_min_f32 v243, 0x43000000, v237
    v_mul_f32 v239, 0xbfb8aa3b, v243
    v_fma_f32 v241, v243, s98, -v239
    v_fmac_f32 v241, 0xb2a57060, v243
    v_exp_f32 v239, v239
    v_mul_f32 v241, 0x3f317218, v241
    v_fmac_f32 v239, v239, v241
    v_add_f32 v239, 1.0, v239
    v_rcp_f32 v241, v239
    s_nop 0
    v_mul_f32 v243, v237, v241
    v_fma_f32 v239, -v243, v239, v237
    v_fma_f32 v237, v239, v241, v243
    v_cvt_pk_bf16_f32 v250, v236, v237
    ds_write_b64 v17, v[246:247]
    ds_write_b64 v17, v[248:249] offset:512
    ds_write_b32 v18, v250
    s_waitcnt vmcnt(4)
    s_waitcnt lgkmcnt(0)
    s_barrier
    ds_read_b64_tr_b16 v[160:161], v20 offset:0
    ds_read_b64_tr_b16 v[162:163], v20 offset:512
    ds_read_b64_tr_b16 v[164:165], v20 offset:8192
    ds_read_b64_tr_b16 v[166:167], v20 offset:8704
    ds_read_b64_tr_b16 v[168:169], v20 offset:16384
    ds_read_b64_tr_b16 v[170:171], v20 offset:16896
    ds_read_b64_tr_b16 v[172:173], v20 offset:24576
    ds_read_b64_tr_b16 v[174:175], v20 offset:25088
    ds_read_b64_tr_b16 v[176:177], v21 offset:0
    ds_read_b64_tr_b16 v[178:179], v21 offset:512
    ds_read_b64_tr_b16 v[180:181], v21 offset:8192
    ds_read_b64_tr_b16 v[182:183], v21 offset:8704
    ds_read_b64_tr_b16 v[184:185], v21 offset:16384
    ds_read_b64_tr_b16 v[186:187], v21 offset:16896
    ds_read_b64_tr_b16 v[188:189], v21 offset:24576
    ds_read_b64_tr_b16 v[190:191], v21 offset:25088
    ds_read_b64_tr_b16 v[192:193], v21 offset:32768
    ds_read_b64_tr_b16 v[194:195], v21 offset:33280
    ds_read_b128 v[196:199], v16 offset:0
    ds_read_b128 v[200:203], v16 offset:128
    ds_read_b128 v[204:207], v16 offset:256
    ds_read_b128 v[208:211], v16 offset:384
    ds_read_b128 v[212:215], v16 offset:512
    ds_read_b128 v[216:219], v16 offset:640
    ds_read_b128 v[220:223], v16 offset:768
    ds_read_b128 v[224:227], v16 offset:896
    ds_read_b128 v[228:231], v16 offset:1024
    s_waitcnt lgkmcnt(8)
    v_mfma_f32_16x16x32_bf16 v[232:235], v[160:163], v[196:199], 0
    s_waitcnt lgkmcnt(7)
    v_mfma_f32_16x16x32_bf16 v[232:235], v[164:167], v[200:203], v[232:235]
    s_waitcnt lgkmcnt(6)
    v_mfma_f32_16x16x32_bf16 v[232:235], v[168:171], v[204:207], v[232:235]
    s_waitcnt lgkmcnt(5)
    v_mfma_f32_16x16x32_bf16 v[232:235], v[172:175], v[208:211], v[232:235]
    s_waitcnt lgkmcnt(4)
    v_mfma_f32_16x16x32_bf16 v[232:235], v[176:179], v[212:215], v[232:235]
    s_waitcnt lgkmcnt(3)
    v_mfma_f32_16x16x32_bf16 v[232:235], v[180:183], v[216:219], v[232:235]
    s_waitcnt lgkmcnt(2)
    v_mfma_f32_16x16x32_bf16 v[232:235], v[184:187], v[220:223], v[232:235]
    s_waitcnt lgkmcnt(1)
    v_mfma_f32_16x16x32_bf16 v[232:235], v[188:191], v[224:227], v[232:235]
    s_waitcnt lgkmcnt(0)
    v_mfma_f32_16x16x32_bf16 v[232:235], v[192:195], v[228:231], v[232:235]
    s_nop 7
    v_permlane32_swap_b32 v232, v234
    v_permlane32_swap_b32 v233, v235
    v_cndmask_b32 v233, v233, v234, s[96:97]
    v_cndmask_b32 v232, v232, v235, s[96:97]
    s_nop 1
    v_add_f32_dpp v236, v233, v232 quad_perm:[1,0,3,2] row_mask:0xf bank_mask:0xf
    v_cvt_pk_bf16_f32 v236, 0, v236
    v_add_f32 v236, s58, v236
    v_cvt_pk_bf16_f32 v236, v236, v236
    ds_write_b16 v23, v236
    v_mov_b32 v243, s34
    s_waitcnt lgkmcnt(0)
    s_barrier
    ds_read2_b32 v[244:245], v24 offset1:1
    v_mov_b32 v241, s34
    s_waitcnt lgkmcnt(0)
    v_mov_b32 v240, v244
    v_mov_b32 v242, v245
    s_mov_b64 exec, 0xffffffff
    buffer_store_dwordx4 v[240:243], v22, s[36:39], s59 offen sc1
    s_mov_b64 exec, -1
    s_mov_b32 s14, 0x6b5ad6b5
    s_mov_b32 s15, 0x5ad6b5ad
    s_add_u32 s30, s70, -30
    s_waitcnt vmcnt(3)
    s_add_u32 s63, s69, 32768
    buffer_load_dwordx4 v[96:99], v1, s[40:43], s63 offen nt
    s_waitcnt vmcnt(3)
    s_add_u32 s63, s69, 40960
    buffer_load_dwordx4 v[100:103], v1, s[40:43], s63 offen nt
    s_waitcnt vmcnt(3)
    s_add_u32 s63, s69, 49152
    buffer_load_dwordx4 v[128:131], v1, s[40:43], s63 offen nt
    s_waitcnt vmcnt(3)
    s_add_u32 s63, s69, 57344
    buffer_load_dwordx4 v[132:135], v1, s[40:43], s63 offen nt
    s_waitcnt vmcnt(3)
    s_add_u32 s63, s69, 131072
    buffer_load_dwordx4 v[40:43], v1, s[40:43], s63 offen nt
    s_waitcnt vmcnt(3)
    s_add_u32 s63, s69, 139264
    buffer_load_dwordx4 v[44:47], v1, s[40:43], s63 offen nt
    s_waitcnt vmcnt(3)
    s_add_u32 s63, s69, 147456
    buffer_load_dwordx4 v[72:75], v1, s[40:43], s63 offen nt
    s_waitcnt vmcnt(3)
    s_add_u32 s63, s69, 155648
    buffer_load_dwordx4 v[76:79], v1, s[40:43], s63 offen nt
    s_waitcnt vmcnt(3)
    s_add_u32 s63, s69, 163840
    buffer_load_dwordx4 v[104:107], v1, s[40:43], s63 offen nt
    s_waitcnt vmcnt(3)
    s_add_u32 s63, s69, 172032
    buffer_load_dwordx4 v[108:111], v1, s[40:43], s63 offen nt
    s_waitcnt vmcnt(3)
    s_add_u32 s63, s69, 180224
    buffer_load_dwordx4 v[136:139], v1, s[40:43], s63 offen nt
    s_waitcnt vmcnt(3)
    s_add_u32 s63, s69, 188416
    buffer_load_dwordx4 v[140:143], v1, s[40:43], s63 offen nt
    s_waitcnt vmcnt(3)
    s_add_u32 s63, s69, 262144
    buffer_load_dwordx4 v[48:51], v1, s[40:43], s63 offen nt
    s_waitcnt vmcnt(3)
    s_add_u32 s63, s69, 270336
    buffer_load_dwordx4 v[52:55], v1, s[40:43], s63 offen nt
.Le_m2:
    s_waitcnt vmcnt(3)
    s_bitcmp1_b64 s[14:15], 18
    s_cbranch_scc0 1
    s_waitcnt vmcnt(2)
    s_add_u32 s63, s69, 278528
    buffer_load_dwordx4 v[80:83], v1, s[40:43], s63 offen nt
    v_and_b32 v157, 7, v0
    v_lshlrev_b32 v157, 7, v157
    s_mov_b32 s63, 0x400
    buffer_load_dword v156, v157, s[36:39], s63 offen
    s_memrealtime s[8:9]
    s_waitcnt lgkmcnt(0)
    s_sub_u32 s8, s8, s30
    s_cmpk_ge_u32 s8, 850
    s_cbranch_scc1 .ap_28
    s_waitcnt vmcnt(5)
    s_cmpk_ge_u32 s8, 785
    s_cbranch_scc1 .ap_28
    s_waitcnt vmcnt(4)
    s_bitcmp1_b64 s[14:15], 19
    s_cbranch_scc0 1
    s_waitcnt vmcnt(3)
    s_cmpk_ge_u32 s8, 710
    s_cbranch_scc1 .ap_28
    s_waitcnt vmcnt(2)
.ap_28:
    s_add_u32 s63, s69, 286720
    buffer_load_dwordx4 v[84:87], v1, s[40:43], s63 offen nt
    s_memrealtime s[8:9]
    s_waitcnt lgkmcnt(0)
    s_sub_u32 s8, s8, s30
    s_cmpk_ge_u32 s8, 895
    s_cbranch_scc1 .ap_29
    s_waitcnt vmcnt(6)
    s_cmpk_ge_u32 s8, 830
    s_cbranch_scc1 .ap_29
    s_waitcnt vmcnt(4)
    s_bitcmp1_b64 s[14:15], 20
    s_cbranch_scc0 1
    s_waitcnt vmcnt(3)
    s_cmpk_ge_u32 s8, 755
    s_cbranch_scc1 .ap_29
    s_waitcnt vmcnt(2)
.ap_29:
    s_add_u32 s63, s69, 294912
    buffer_load_dwordx4 v[112:115], v1, s[40:43], s63 offen nt
    s_memrealtime s[8:9]
    s_waitcnt lgkmcnt(0)
    s_sub_u32 s8, s8, s30
    s_cmpk_ge_u32 s8, 940
    s_cbranch_scc1 .ap_30
    s_waitcnt vmcnt(6)
    s_cmpk_ge_u32 s8, 875
    s_cbranch_scc1 .ap_30
    s_waitcnt vmcnt(4)
    s_bitcmp1_b64 s[14:15], 21
    s_cbranch_scc0 1
    s_waitcnt vmcnt(3)
    s_cmpk_ge_u32 s8, 800
    s_cbranch_scc1 .ap_30
    s_waitcnt vmcnt(1)
.ap_30:
    s_add_u32 s63, s69, 303104
    buffer_load_dwordx4 v[116:119], v1, s[40:43], s63 offen nt
    s_memrealtime s[8:9]
    s_waitcnt lgkmcnt(0)
    s_sub_u32 s8, s8, s30
    s_cmpk_ge_u32 s8, 985
    s_cbranch_scc1 .ap_31
    s_waitcnt vmcnt(6)
    s_cmpk_ge_u32 s8, 920
    s_cbranch_scc1 .ap_31
    s_waitcnt vmcnt(4)
    s_bitcmp1_b64 s[14:15], 22
    s_cbranch_scc0 1
    s_waitcnt vmcnt(2)
    s_cmpk_ge_u32 s8, 845
    s_cbranch_scc1 .ap_31
    s_waitcnt vmcnt(1)
.ap_31:
    s_add_u32 s63, s69, 311296
    buffer_load_dwordx4 v[144:147], v1, s[40:43], s63 offen nt
    s_waitcnt vmcnt(4)
    s_sub_u32 s63, s70, 300
    v_subrev_u32 v156, s63, v156
    v_mov_b32 v157, 600
    v_cmp_lt_u32 s[8:9], v156, v157
    v_add_u32_dpp v156, v156, v156 quad_perm:[1,0,3,2] row_mask:0xf bank_mask:0xf
    s_nop 1
    v_add_u32_dpp v156, v156, v156 quad_perm:[2,3,0,1] row_mask:0xf bank_mask:0xf
    s_nop 1
    v_add_u32_dpp v156, v156, v156 row_ror:4 row_mask:0xf bank_mask:0xf
    s_nop 0
    v_readfirstlane_b32 s63, v156
    s_cmp_eq_u64 s[8:9], -1
    s_nop 3
    s_cbranch_scc0 .et_32
    s_lshr_b32 s63, s63, 3
    s_sub_u32 s63, s63, 300
    s_add_u32 s30, s30, s63
.et_32:
    s_memrealtime s[8:9]
    s_waitcnt lgkmcnt(0)
    s_sub_u32 s8, s8, s30
    s_cmpk_ge_u32 s8, 1030
    s_cbranch_scc1 .ap_33
    s_waitcnt vmcnt(4)
    s_cmpk_ge_u32 s8, 965
    s_cbranch_scc1 .ap_33
    s_waitcnt vmcnt(3)
    s_bitcmp1_b64 s[14:15], 23
    s_cbranch_scc0 1
    s_waitcnt vmcnt(2)
    s_cmpk_ge_u32 s8, 890
    s_cbranch_scc1 .ap_33
    s_waitcnt vmcnt(1)
.ap_33:
    s_add_u32 s63, s69, 319488
    buffer_load_dwordx4 v[148:151], v1, s[40:43], s63 offen nt
    s_memrealtime s[8:9]
    s_waitcnt lgkmcnt(0)
    s_sub_u32 s8, s8, s30
    s_cmpk_ge_u32 s8, 1075
    s_cbranch_scc1 .ap_34
    s_waitcnt vmcnt(5)
    s_cmpk_ge_u32 s8, 1010
    s_cbranch_scc1 .ap_34
    s_waitcnt vmcnt(3)
    s_bitcmp1_b64 s[14:15], 24
    s_cbranch_scc0 1
    s_waitcnt vmcnt(2)
    s_cmpk_ge_u32 s8, 935
    s_cbranch_scc1 .ap_34
    s_waitcnt vmcnt(1)
.ap_34:
    s_add_u32 s63, s69, 393216
    buffer_load_dwordx4 v[56:59], v1, s[40:43], s63 offen nt
    s_memrealtime s[8:9]
    s_waitcnt lgkmcnt(0)
    s_sub_u32 s8, s8, s30
    s_cmpk_ge_u32 s8, 1120
    s_cbranch_scc1 .ap_35
    s_waitcnt vmcnt(5)
    s_cmpk_ge_u32 s8, 1055
    s_cbranch_scc1 .ap_35
    s_waitcnt vmcnt(3)
    s_bitcmp1_b64 s[14:15], 25
    s_cbranch_scc0 1
    s_waitcnt vmcnt(2)
    s_cmpk_ge_u32 s8, 980
    s_cbranch_scc1 .ap_35
    s_waitcnt vmcnt(1)
.ap_35:
    s_add_u32 s63, s69, 401408
    buffer_load_dwordx4 v[60:63], v1, s[40:43], s63 offen nt
    s_cmp_lt_u32 s2, 216
    s_cbranch_scc1 .Latt_bc
    s_branch .Latt_n
.Le_q:
    s_cmp_ge_u32 s65, 27
    s_mov_b32 s14, 0x94a5294a
    s_cselect_b32 s14, 0x0, s14
    s_mov_b32 s15, 0xa5294a52
    s_cselect_b32 s15, 0x0, s15
    s_cselect_b32 s30, -30, 0
    s_add_u32 s30, s30, 0
    s_add_u32 s30, s30, s70
    s_mul_i32 s58, s3, 1152
    s_mov_b32 s52, s4
    s_and_b32 s53, s5, 0xffff
    s_mov_b32 s54, 0x2400
    s_mov_b32 s55, 0x00020000
    buffer_load_dwordx2 v[246:247], v3, s[52:55], s58 offen
    buffer_load_dwordx2 v[248:249], v3, s[52:55], s58 offen offset:512
    buffer_load_dword v250, v4, s[52:55], s58 offen
    s_mov_b32 s48, s10
    s_and_b32 s49, s11, 0xffff
    s_mov_b32 s50, 0x480000
    s_mov_b32 s51, 0x00020000
    v_bfe_u32 v12, v0, 4, 1
    s_and_b32 s56, s3, 3
    s_lshl_b32 s56, s56, 1
    v_or_b32 v12, s56, v12
    v_and_b32 v19, 7, v0
    v_xor_b32 v12, v12, v19
    v_lshrrev_b32 v19, 3, v0
    v_mul_u32_u24 v19, 8192, v19
    v_lshl_add_u32 v19, v12, 4, v19
    s_lshl3_add_u32 s101, s64, s101
    s_lshl_b32 s99, s3, 16
    s_lshl_b32 s59, s101, 7
    s_add_u32 s99, s99, s59
    s_lshl_b32 s100, s3, 10
    s_add_u32 m0, s100, 0
    s_add_u32 s56, s99, 0
    buffer_load_dwordx4 v19, s[48:51], s56 offen nt lds
    s_add_u32 s63, s69, 32768
    buffer_load_dwordx4 v[96:99], v1, s[40:43], s63 offen nt
    v_bfe_u32 v16, v0, 1, 3
    v_mul_u32_u24 v16, 1312, v16
    v_lshrrev_b32 v12, 4, v0
    v_lshl_add_u32 v16, v12, 5, v16
    v_and_b32 v12, 1, v0
    v_lshl_add_u32 v16, v12, 4, v16
    v_add_u32 v16, 147456, v16
    s_mul_i32 s56, s3, 1312
    s_add_u32 s56, s56, 147456
    v_add_u32 v17, s56, v3
    v_add_u32 v18, s56, v4
    v_lshrrev_b32 v12, 4, v0
    v_bfe_u32 v13, v0, 1, 1
    v_lshl_add_u32 v12, v12, 1, v13
    v_bfe_u32 v13, v0, 2, 2
    v_lshl_add_u32 v20, v12, 3, v13
    v_lshlrev_b32 v20, 7, v20
    v_and_b32 v12, 3, v12
    v_lshrrev_b32 v13, 1, v13
    v_lshl_add_u32 v12, v12, 1, v13
    v_xor_b32 v12, s3, v12
    v_lshl_add_u32 v20, v12, 4, v20
    v_and_b32 v12, 1, v0
    v_lshl_add_u32 v20, v12, 3, v20
    v_bfe_u32 v23, v0, 1, 3
    v_mul_u32_u24 v23, 144, v23
    v_bfe_u32 v12, v0, 4, 1
    v_lshl_add_u32 v23, v12, 3, v23
    v_lshrrev_b32 v12, 5, v0
    v_lshl_add_u32 v23, v12, 2, v23
    v_and_b32 v12, 1, v0
    v_lshl_add_u32 v23, v12, 1, v23
    s_lshl_b32 s56, s3, 4
    s_add_u32 s56, s56, 157952
    v_add_u32 v23, s56, v23
    v_and_b32 v24, 15, v0
    v_lshlrev_b32 v24, 3, v24
    s_mul_i32 s56, s3, 144
    s_add_u32 s56, s56, 157952
    v_add_u32 v24, s56, v24
    v_add_u32 v21, 32768, v20
    s_lshl_b32 s100, s3, 10
    s_waitcnt lgkmcnt(0)
    s_add_u32 s34, s34, 1
    s_lshl_b32 s101, s101, 8
    s_lshl_b32 s58, s3, 14
    s_add_u32 s101, s101, s58
    s_add_u32 s101, s101, 0x40000
    s_and_b32 s58, s64, 1
    s_mul_i32 s58, s58, 18432
    s_mul_i32 s59, s3, 2304
    s_add_u32 s58, s58, s59
    s_add_u32 s58, s58, 0x3000
    s_add_u32 s59, s58, 36864
    s_waitcnt vmcnt(5)
    s_add_u32 m0, s100, 8192
    s_add_u32 s56, s99, 524288
    buffer_load_dwordx4 v19, s[48:51], s56 offen nt lds
    s_waitcnt vmcnt(5)
    s_add_u32 s63, s69, 40960
    buffer_load_dwordx4 v[100:103], v1, s[40:43], s63 offen nt
    s_waitcnt vmcnt(5)
    s_add_u32 m0, s100, 16384
    s_add_u32 s56, s99, 1048576
    buffer_load_dwordx4 v19, s[48:51], s56 offen nt lds
    s_waitcnt vmcnt(5)
    s_add_u32 s63, s69, 49152
    buffer_load_dwordx4 v[128:131], v1, s[40:43], s63 offen nt
    v_lshlrev_b32 v236, 16, v246
    v_and_b32 v237, 0xffff0000, v246
    v_lshlrev_b32 v238, 16, v247
    v_and_b32 v239, 0xffff0000, v247
    v_lshlrev_b32 v240, 16, v248
    v_and_b32 v241, 0xffff0000, v248
    v_lshlrev_b32 v242, 16, v249
    v_and_b32 v243, 0xffff0000, v249
    v_lshlrev_b32 v244, 16, v250
    v_and_b32 v245, 0xffff0000, v250
    s_mov_b32 s56, 0x3f803f80
    v_dot2_f32_bf16 v10, v246, s56, 0
    v_dot2_f32_bf16 v11, v246, v246, 0
    v_dot2_f32_bf16 v10, v247, s56, v10
    v_dot2_f32_bf16 v11, v247, v247, v11
    v_dot2_f32_bf16 v10, v248, s56, v10
    v_dot2_f32_bf16 v11, v248, v248, v11
    v_dot2_f32_bf16 v10, v249, s56, v10
    v_dot2_f32_bf16 v11, v249, v249, v11
    s_mov_b64 exec, 0xffffffff
    v_dot2_f32_bf16 v10, v250, s56, v10
    v_dot2_f32_bf16 v11, v250, v250, v11
    s_mov_b64 exec, -1
    s_nop 1
    v_permlane32_swap_b32 v10, v11
    v_add_f32 v10, v10, v11
    v_mov_b32 v12, v10
    s_nop 1
    v_permlane16_swap_b32 v12, v10
    v_add_f32 v10, v12, v10
    s_nop 1
    v_add_f32_dpp v10, v10, v10 row_ror:8 row_mask:0xf bank_mask:0xf
    s_nop 1
    v_add_f32_dpp v10, v10, v10 row_ror:4 row_mask:0xf bank_mask:0xf
    s_nop 1
    v_add_f32_dpp v10, v10, v10 quad_perm:[2,3,0,1] row_mask:0xf bank_mask:0xf
    s_nop 1
    v_add_f32_dpp v10, v10, v10 quad_perm:[1,0,3,2] row_mask:0xf bank_mask:0xf
    v_mul_f32 v10, 0x3ae38e39, v10
    s_nop 0
    v_readlane_b32 s56, v10, 0
    v_readlane_b32 s57, v10, 32
    s_nop 0
    v_mov_b32 v10, s56
    v_fma_f32 v11, -v10, v10, s57
    v_max_f32 v11, 0, v11
    v_cvt_pk_bf16_f32 v13, 0, v11
    v_cvt_pk_bf16_f32 v11, 0, -v10
    v_cvt_pk_bf16_f32 v10, 0, -v10
    v_add_f32 v13, 0x3727c5ac, v13
    v_pk_add_f32 v[236:237], v[236:237], v[10:11]
    v_pk_add_f32 v[238:239], v[238:239], v[10:11]
    v_pk_add_f32 v[240:241], v[240:241], v[10:11]
    v_cvt_pk_bf16_f32 v13, 0, v13
    v_pk_add_f32 v[242:243], v[242:243], v[10:11]
    v_pk_add_f32 v[244:245], v[244:245], v[10:11]
    v_cvt_pk_bf16_f32 v236, 0, v236
    v_sqrt_f32 v13, v13
    v_cvt_pk_bf16_f32 v237, 0, v237
    v_cvt_pk_bf16_f32 v238, 0, v238
    v_cvt_pk_bf16_f32 v239, 0, v239
    v_cvt_pk_bf16_f32 v13, 0, v13
    v_cvt_pk_bf16_f32 v240, 0, v240
    v_cvt_pk_bf16_f32 v241, 0, v241
    v_cvt_pk_bf16_f32 v242, 0, v242
    v_rcp_f32 v12, v13
    v_cvt_pk_bf16_f32 v243, 0, v243
    v_cvt_pk_bf16_f32 v244, 0, v244
    v_cvt_pk_bf16_f32 v245, 0, v245
    v_mov_b32 v13, v12
    v_pk_mul_f32 v[236:237], v[236:237], v[12:13]
    v_pk_mul_f32 v[238:239], v[238:239], v[12:13]
    v_pk_mul_f32 v[240:241], v[240:241], v[12:13]
    v_pk_mul_f32 v[242:243], v[242:243], v[12:13]
    v_pk_mul_f32 v[244:245], v[244:245], v[12:13]
    v_cvt_pk_bf16_f32 v236, 0, v236
    v_cvt_pk_bf16_f32 v237, 0, v237
    v_cvt_pk_bf16_f32 v238, 0, v238
    v_cvt_pk_bf16_f32 v239, 0, v239
    v_cvt_pk_bf16_f32 v240, 0, v240
    v_cvt_pk_bf16_f32 v241, 0, v241
    v_cvt_pk_bf16_f32 v242, 0, v242
    v_cvt_pk_bf16_f32 v243, 0, v243
    v_cvt_pk_bf16_f32 v244, 0, v244
    v_cvt_pk_bf16_f32 v245, 0, v245
    s_waitcnt vmcnt(5)
    s_add_u32 m0, s100, 24576
    s_add_u32 s56, s99, 1572864
    buffer_load_dwordx4 v19, s[48:51], s56 offen nt lds
    s_waitcnt vmcnt(5)
    s_add_u32 s63, s69, 57344
    buffer_load_dwordx4 v[132:135], v1, s[40:43], s63 offen nt
    s_waitcnt vmcnt(5)
    s_add_u32 m0, s100, 32768
    s_add_u32 s56, s99, 2097152
    buffer_load_dwordx4 v19, s[48:51], s56 offen nt lds
    s_waitcnt vmcnt(5)
    s_add_u32 s63, s69, 131072
    buffer_load_dwordx4 v[40:43], v1, s[40:43], s63 offen nt
    s_waitcnt vmcnt(5)
    s_add_u32 m0, s100, 40960
    s_add_u32 s56, s99, 2621440
    buffer_load_dwordx4 v19, s[48:51], s56 offen nt lds
    s_waitcnt vmcnt(5)
    s_add_u32 s63, s69, 139264
    buffer_load_dwordx4 v[44:47], v1, s[40:43], s63 offen nt
    s_waitcnt vmcnt(5)
    s_add_u32 m0, s100, 49152
    s_add_u32 s56, s99, 3145728
    buffer_load_dwordx4 v19, s[48:51], s56 offen nt lds
    s_waitcnt vmcnt(5)
    s_add_u32 s63, s69, 147456
    buffer_load_dwordx4 v[72:75], v1, s[40:43], s63 offen nt
    s_waitcnt vmcnt(5)
    s_add_u32 m0, s100, 57344
    s_add_u32 s56, s99, 3670016
    buffer_load_dwordx4 v19, s[48:51], s56 offen nt lds
    s_waitcnt vmcnt(5)
    s_add_u32 s63, s69, 155648
    buffer_load_dwordx4 v[76:79], v1, s[40:43], s63 offen nt
    buffer_load_dwordx4 v[196:199], v2, s[36:39], s58 offen offset:0 sc1
    buffer_load_dwordx4 v[200:203], v2, s[36:39], s58 offen offset:1024 sc1
    buffer_load_dwordx2 v[204:205], v5, s[36:39], s58 offen offset:0 sc1
    buffer_load_dwordx4 v[206:209], v2, s[36:39], s59 offen offset:0 sc1
    buffer_load_dwordx4 v[210:213], v2, s[36:39], s59 offen offset:1024 sc1
    buffer_load_dwordx2 v[214:215], v5, s[36:39], s59 offen offset:0 sc1
    s_waitcnt vmcnt(11)
    s_add_u32 m0, s100, 65536
    s_add_u32 s56, s99, 4194304
    buffer_load_dwordx4 v19, s[48:51], s56 offen nt lds
    s_waitcnt vmcnt(11)
    s_add_u32 s63, s69, 163840
    buffer_load_dwordx4 v[104:107], v1, s[40:43], s63 offen nt
    s_waitcnt vmcnt(11)
    s_add_u32 s63, s69, 172032
    buffer_load_dwordx4 v[108:111], v1, s[40:43], s63 offen nt
    s_waitcnt vmcnt(11)
    s_add_u32 s63, s69, 180224
    buffer_load_dwordx4 v[136:139], v1, s[40:43], s63 offen nt
    s_waitcnt vmcnt(4)
    s_branch .gpc_37
.gp_36:
    buffer_load_dwordx4 v[196:199], v2, s[36:39], s58 offen offset:0 sc1
    buffer_load_dwordx4 v[200:203], v2, s[36:39], s58 offen offset:1024 sc1
    buffer_load_dwordx2 v[204:205], v5, s[36:39], s58 offen offset:0 sc1
    buffer_load_dwordx4 v[206:209], v2, s[36:39], s59 offen offset:0 sc1
    buffer_load_dwordx4 v[210:213], v2, s[36:39], s59 offen offset:1024 sc1
    buffer_load_dwordx2 v[214:215], v5, s[36:39], s59 offen offset:0 sc1
    s_waitcnt vmcnt(0)
.gpc_37:
    v_min_u32 v10, v197, v199
    v_max_u32 v11, v197, v199
    v_min3_u32 v10, v10, v201, v203
    v_max3_u32 v11, v11, v201, v203
    v_min3_u32 v10, v10, v205, v207
    v_max3_u32 v11, v11, v205, v207
    v_min3_u32 v10, v10, v209, v211
    v_max3_u32 v11, v11, v209, v211
    v_min3_u32 v10, v10, v213, v215
    v_max3_u32 v11, v11, v213, v215
    v_cmp_eq_u32 vcc, s34, v10
    v_cmp_eq_u32 s[56:57], s34, v11
    s_and_b64 vcc, vcc, s[56:57]
    s_cmp_eq_u64 vcc, exec
    s_nop 2
    s_cbranch_scc1 .gpd_38
    s_sub_u32 s35, s35, 1
    s_cbranch_scc1 .Lexit
    s_branch .gp_36
.gpd_38:
    v_and_b32 v207, 0xffff0000, v206
    v_lshlrev_b32 v206, 16, v206
    v_and_b32 v209, 0xffff0000, v208
    v_lshlrev_b32 v208, 16, v208
    v_and_b32 v211, 0xffff0000, v210
    v_lshlrev_b32 v210, 16, v210
    v_and_b32 v213, 0xffff0000, v212
    v_lshlrev_b32 v212, 16, v212
    v_and_b32 v215, 0xffff0000, v214
    v_lshlrev_b32 v214, 16, v214
    v_and_b32 v197, 0xffff0000, v196
    v_lshlrev_b32 v196, 16, v196
    v_and_b32 v199, 0xffff0000, v198
    v_lshlrev_b32 v198, 16, v198
    v_and_b32 v201, 0xffff0000, v200
    v_lshlrev_b32 v200, 16, v200
    v_and_b32 v203, 0xffff0000, v202
    v_lshlrev_b32 v202, 16, v202
    v_and_b32 v205, 0xffff0000, v204
    v_lshlrev_b32 v204, 16, v204
    v_pk_mul_f32 v[236:237], v[236:237], v[206:207]
    v_pk_mul_f32 v[238:239], v[238:239], v[208:209]
    v_pk_mul_f32 v[240:241], v[240:241], v[210:211]
    v_pk_mul_f32 v[242:243], v[242:243], v[212:213]
    v_pk_mul_f32 v[244:245], v[244:245], v[214:215]
    v_cvt_pk_bf16_f32 v236, 0, v236
    v_cvt_pk_bf16_f32 v237, 0, v237
    v_cvt_pk_bf16_f32 v238, 0, v238
    v_cvt_pk_bf16_f32 v239, 0, v239
    v_cvt_pk_bf16_f32 v240, 0, v240
    v_cvt_pk_bf16_f32 v241, 0, v241
    v_cvt_pk_bf16_f32 v242, 0, v242
    v_cvt_pk_bf16_f32 v243, 0, v243
    v_cvt_pk_bf16_f32 v244, 0, v244
    v_cvt_pk_bf16_f32 v245, 0, v245
    v_pk_add_f32 v[236:237], v[236:237], v[196:197]
    v_pk_add_f32 v[238:239], v[238:239], v[198:199]
    v_pk_add_f32 v[240:241], v[240:241], v[200:201]
    v_pk_add_f32 v[242:243], v[242:243], v[202:203]
    v_pk_add_f32 v[244:245], v[244:245], v[204:205]
    v_cvt_pk_bf16_f32 v246, v236, v237
    v_cvt_pk_bf16_f32 v247, v238, v239
    v_cvt_pk_bf16_f32 v248, v240, v241
    v_cvt_pk_bf16_f32 v249, v242, v243
    v_cvt_pk_bf16_f32 v250, v244, v245
    ds_write_b64 v17, v[246:247]
    ds_write_b64 v17, v[248:249] offset:512
    ds_write_b32 v18, v250
    s_add_u32 s63, s69, 188416
    buffer_load_dwordx4 v[140:143], v1, s[40:43], s63 offen nt
    s_add_u32 s63, s69, 262144
    buffer_load_dwordx4 v[48:51], v1, s[40:43], s63 offen nt
    s_add_u32 s63, s69, 270336
    buffer_load_dwordx4 v[52:55], v1, s[40:43], s63 offen nt
    s_add_u32 s63, s69, 278528
    buffer_load_dwordx4 v[80:83], v1, s[40:43], s63 offen nt
    v_and_b32 v157, 7, v0
    v_lshlrev_b32 v157, 7, v157
    s_mov_b32 s63, 0x400
    buffer_load_dword v156, v157, s[36:39], s63 offen
    s_waitcnt vmcnt(8)
    s_waitcnt lgkmcnt(0)
    s_barrier
    ds_read_b64_tr_b16 v[160:161], v20 offset:0
    ds_read_b64_tr_b16 v[162:163], v20 offset:512
    ds_read_b64_tr_b16 v[164:165], v20 offset:8192
    ds_read_b64_tr_b16 v[166:167], v20 offset:8704
    ds_read_b64_tr_b16 v[168:169], v20 offset:16384
    ds_read_b64_tr_b16 v[170:171], v20 offset:16896
    ds_read_b64_tr_b16 v[172:173], v20 offset:24576
    ds_read_b64_tr_b16 v[174:175], v20 offset:25088
    ds_read_b64_tr_b16 v[176:177], v21 offset:0
    ds_read_b64_tr_b16 v[178:179], v21 offset:512
    ds_read_b64_tr_b16 v[180:181], v21 offset:8192
    ds_read_b64_tr_b16 v[182:183], v21 offset:8704
    ds_read_b64_tr_b16 v[184:185], v21 offset:16384
    ds_read_b64_tr_b16 v[186:187], v21 offset:16896
    ds_read_b64_tr_b16 v[188:189], v21 offset:24576
    ds_read_b64_tr_b16 v[190:191], v21 offset:25088
    ds_read_b64_tr_b16 v[192:193], v21 offset:32768
    ds_read_b64_tr_b16 v[194:195], v21 offset:33280
    s_waitcnt lgkmcnt(0)
    ds_read_b128 v[196:199], v16 offset:0
    ds_read_b128 v[200:203], v16 offset:128
    ds_read_b128 v[204:207], v16 offset:256
    ds_read_b128 v[208:211], v16 offset:384
    ds_read_b128 v[212:215], v16 offset:512
    ds_read_b128 v[216:219], v16 offset:640
    ds_read_b128 v[220:223], v16 offset:768
    ds_read_b128 v[224:227], v16 offset:896
    ds_read_b128 v[228:231], v16 offset:1024
    s_waitcnt lgkmcnt(8)
    v_mfma_f32_16x16x32_bf16 v[232:235], v[160:163], v[196:199], 0
    s_waitcnt lgkmcnt(7)
    v_mfma_f32_16x16x32_bf16 v[232:235], v[164:167], v[200:203], v[232:235]
    s_waitcnt lgkmcnt(6)
    v_mfma_f32_16x16x32_bf16 v[232:235], v[168:171], v[204:207], v[232:235]
    s_waitcnt lgkmcnt(5)
    v_mfma_f32_16x16x32_bf16 v[232:235], v[172:175], v[208:211], v[232:235]
    s_waitcnt lgkmcnt(4)
    v_mfma_f32_16x16x32_bf16 v[232:235], v[176:179], v[212:215], v[232:235]
    s_waitcnt lgkmcnt(3)
    v_mfma_f32_16x16x32_bf16 v[232:235], v[180:183], v[216:219], v[232:235]
    s_waitcnt lgkmcnt(2)
    v_mfma_f32_16x16x32_bf16 v[232:235], v[184:187], v[220:223], v[232:235]
    s_waitcnt lgkmcnt(1)
    v_mfma_f32_16x16x32_bf16 v[232:235], v[188:191], v[224:227], v[232:235]
    s_waitcnt lgkmcnt(0)
    v_mfma_f32_16x16x32_bf16 v[232:235], v[192:195], v[228:231], v[232:235]
    s_nop 7
    v_permlane32_swap_b32 v232, v234
    v_permlane32_swap_b32 v233, v235
    v_cndmask_b32 v233, v233, v234, s[96:97]
    v_cndmask_b32 v232, v232, v235, s[96:97]
    s_nop 1
    v_add_f32_dpp v236, v233, v232 quad_perm:[1,0,3,2] row_mask:0xf bank_mask:0xf
    v_cvt_pk_bf16_f32 v236, v236, v236
    ds_write_b16 v23, v236
    v_mov_b32 v243, s34
    s_waitcnt lgkmcnt(0)
    s_barrier
    ds_read2_b32 v[244:245], v24 offset1:1
    v_mov_b32 v241, s34
    s_waitcnt lgkmcnt(0)
    v_mov_b32 v240, v244
    v_mov_b32 v242, v245
    s_mov_b64 exec, 0xffff
    buffer_store_dwordx4 v[240:243], v2, s[36:39], s101 offen sc1
    s_mov_b64 exec, -1
.Lq_done:
    s_memrealtime s[8:9]
    s_waitcnt lgkmcnt(0)
    s_sub_u32 s8, s8, s30
    s_cmpk_ge_u32 s8, 850
    s_cbranch_scc1 .ap_39
    s_waitcnt vmcnt(6)
    s_cmpk_ge_u32 s8, 785
    s_cbranch_scc1 .ap_39
    s_waitcnt vmcnt(4)
    s_bitcmp1_b64 s[14:15], 19
    s_cbranch_scc0 1
    s_waitcnt vmcnt(3)
    s_cmpk_ge_u32 s8, 710
    s_cbranch_scc1 .ap_39
    s_waitcnt vmcnt(2)
.ap_39:
    s_add_u32 s63, s69, 286720
    buffer_load_dwordx4 v[84:87], v1, s[40:43], s63 offen nt
    s_memrealtime s[8:9]
    s_waitcnt lgkmcnt(0)
    s_sub_u32 s8, s8, s30
    s_cmpk_ge_u32 s8, 895
    s_cbranch_scc1 .ap_40
    s_waitcnt vmcnt(6)
    s_cmpk_ge_u32 s8, 830
    s_cbranch_scc1 .ap_40
    s_waitcnt vmcnt(4)
    s_bitcmp1_b64 s[14:15], 20
    s_cbranch_scc0 1
    s_waitcnt vmcnt(3)
    s_cmpk_ge_u32 s8, 755
    s_cbranch_scc1 .ap_40
    s_waitcnt vmcnt(2)
.ap_40:
    s_add_u32 s63, s69, 294912
    buffer_load_dwordx4 v[112:115], v1, s[40:43], s63 offen nt
    s_memrealtime s[8:9]
    s_waitcnt vmcnt(9)
    s_waitcnt lgkmcnt(0)
    s_sub_u32 s8, s8, s30
    s_cmpk_ge_u32 s8, 940
    s_cbranch_scc1 .ap_41
    s_waitcnt vmcnt(6)
    s_cmpk_ge_u32 s8, 875
    s_cbranch_scc1 .ap_41
    s_waitcnt vmcnt(4)
    s_bitcmp1_b64 s[14:15], 21
    s_cbranch_scc0 1
    s_waitcnt vmcnt(3)
    s_cmpk_ge_u32 s8, 800
    s_cbranch_scc1 .ap_41
    s_waitcnt vmcnt(1)
.ap_41:
    s_add_u32 s63, s69, 303104
    buffer_load_dwordx4 v[116:119], v1, s[40:43], s63 offen nt
    s_memrealtime s[8:9]
    s_waitcnt vmcnt(9)
    s_waitcnt lgkmcnt(0)
    s_sub_u32 s8, s8, s30
    s_cmpk_ge_u32 s8, 985
    s_cbranch_scc1 .ap_42
    s_waitcnt vmcnt(6)
    s_cmpk_ge_u32 s8, 920
    s_cbranch_scc1 .ap_42
    s_waitcnt vmcnt(4)
    s_bitcmp1_b64 s[14:15], 22
    s_cbranch_scc0 1
    s_waitcnt vmcnt(2)
    s_cmpk_ge_u32 s8, 845
    s_cbranch_scc1 .ap_42
    s_waitcnt vmcnt(1)
.ap_42:
    s_add_u32 s63, s69, 311296
    buffer_load_dwordx4 v[144:147], v1, s[40:43], s63 offen nt
    s_waitcnt vmcnt(4)
    s_sub_u32 s63, s70, 300
    v_subrev_u32 v156, s63, v156
    v_mov_b32 v157, 600
    v_cmp_lt_u32 s[8:9], v156, v157
    v_add_u32_dpp v156, v156, v156 quad_perm:[1,0,3,2] row_mask:0xf bank_mask:0xf
    s_nop 1
    v_add_u32_dpp v156, v156, v156 quad_perm:[2,3,0,1] row_mask:0xf bank_mask:0xf
    s_nop 1
    v_add_u32_dpp v156, v156, v156 row_ror:4 row_mask:0xf bank_mask:0xf
    s_nop 0
    v_readfirstlane_b32 s63, v156
    s_cmp_eq_u64 s[8:9], -1
    s_nop 3
    s_cbranch_scc0 .et_43
    s_lshr_b32 s63, s63, 3
    s_sub_u32 s63, s63, 300
    s_add_u32 s30, s30, s63
.et_43:
    s_memrealtime s[8:9]
    s_waitcnt lgkmcnt(0)
    s_sub_u32 s8, s8, s30
    s_cmpk_ge_u32 s8, 1030
    s_cbranch_scc1 .ap_44
    s_waitcnt vmcnt(4)
    s_cmpk_ge_u32 s8, 965
    s_cbranch_scc1 .ap_44
    s_waitcnt vmcnt(3)
    s_bitcmp1_b64 s[14:15], 23
    s_cbranch_scc0 1
    s_waitcnt vmcnt(2)
    s_cmpk_ge_u32 s8, 890
    s_cbranch_scc1 .ap_44
    s_waitcnt vmcnt(1)
.ap_44:
    s_add_u32 s63, s69, 319488
    buffer_load_dwordx4 v[148:151], v1, s[40:43], s63 offen nt
    s_memrealtime s[8:9]
    s_waitcnt lgkmcnt(0)
    s_sub_u32 s8, s8, s30
    s_cmpk_ge_u32 s8, 1075
    s_cbranch_scc1 .ap_45
    s_waitcnt vmcnt(5)
    s_cmpk_ge_u32 s8, 1010
    s_cbranch_scc1 .ap_45
    s_waitcnt vmcnt(3)
    s_bitcmp1_b64 s[14:15], 24
    s_cbranch_scc0 1
    s_waitcnt vmcnt(2)
    s_cmpk_ge_u32 s8, 935
    s_cbranch_scc1 .ap_45
    s_waitcnt vmcnt(1)
.ap_45:
    s_add_u32 s63, s69, 393216
    buffer_load_dwordx4 v[56:59], v1, s[40:43], s63 offen nt
    s_memrealtime s[8:9]
    s_waitcnt lgkmcnt(0)
    s_sub_u32 s8, s8, s30
    s_cmpk_ge_u32 s8, 1120
    s_cbranch_scc1 .ap_46
    s_waitcnt vmcnt(5)
    s_cmpk_ge_u32 s8, 1055
    s_cbranch_scc1 .ap_46
    s_waitcnt vmcnt(3)
    s_bitcmp1_b64 s[14:15], 25
    s_cbranch_scc0 1
    s_waitcnt vmcnt(2)
    s_cmpk_ge_u32 s8, 980
    s_cbranch_scc1 .ap_46
    s_waitcnt vmcnt(1)
.ap_46:
    s_add_u32 s63, s69, 401408
    buffer_load_dwordx4 v[60:63], v1, s[40:43], s63 offen nt
    s_cmp_lt_u32 s2, 216
    s_cbranch_scc1 .Latt_bc
    s_branch .Latt_n
.Le_a:
    s_mov_b32 s14, 0x6ddb76dd
    s_mov_b32 s15, 0xdb76ddb7
    s_add_u32 s30, s70, -50
    s_mov_b32 s48, s12
    s_and_b32 s49, s13, 0xffff
    s_mov_b32 s50, 0x480000
    s_mov_b32 s51, 0x00020000
    v_bfe_u32 v12, v0, 4, 1
    s_and_b32 s56, s3, 1
    s_lshl_b32 s56, s56, 2
    v_lshl_or_b32 v12, v12, 1, s56
    v_and_b32 v13, 7, v0
    v_xor_b32 v12, v12, v13
    v_lshrrev_b32 v13, 3, v0
    v_mul_u32_u24 v13, 1152, v13
    v_lshl_add_u32 v6, v12, 4, v13
    s_lshl_b32 s101, s64, 6
    s_add_u32 s101, s101, s3
    s_mul_i32 s101, s101, 9216
    s_lshl_b32 s56, s65, 7
    s_add_u32 s101, s101, s56
    s_lshl_b32 s100, s3, 10
    s_waitcnt vmcnt(3)
    s_add_u32 m0, s100, 0
    s_add_u32 s56, s101, 0
    buffer_load_dwordx4 v6, s[48:51], s56 offen nt lds
    s_waitcnt vmcnt(3)
    s_bitcmp1_b64 s[14:15], 4
    s_cbranch_scc0 1
    s_waitcnt vmcnt(2)
    s_add_u32 s63, s69, 32768
    buffer_load_dwordx4 v[96:99], v1, s[40:43], s63 offen nt
    s_waitcnt vmcnt(3)
    s_add_u32 m0, s100, 8192
    s_add_u32 s56, s101, 73728
    buffer_load_dwordx4 v6, s[48:51], s56 offen nt lds
    s_waitcnt vmcnt(3)
    s_bitcmp1_b64 s[14:15], 5
    s_cbranch_scc0 1
    s_waitcnt vmcnt(2)
    s_add_u32 s63, s69, 40960
    buffer_load_dwordx4 v[100:103], v1, s[40:43], s63 offen nt
    s_waitcnt vmcnt(3)
    s_bitcmp1_b64 s[14:15], 6
    s_cbranch_scc0 1
    s_waitcnt vmcnt(2)
    s_add_u32 s63, s69, 49152
    buffer_load_dwordx4 v[128:131], v1, s[40:43], s63 offen nt
    s_waitcnt vmcnt(3)
    s_bitcmp1_b64 s[14:15], 7
    s_cbranch_scc0 1
    s_waitcnt vmcnt(2)
    s_add_u32 s63, s69, 57344
    buffer_load_dwordx4 v[132:135], v1, s[40:43], s63 offen nt
    s_waitcnt vmcnt(3)
    s_add_u32 m0, s100, 16384
    s_add_u32 s56, s101, 147456
    buffer_load_dwordx4 v6, s[48:51], s56 offen nt lds
    s_waitcnt vmcnt(3)
    s_bitcmp1_b64 s[14:15], 8
    s_cbranch_scc0 1
    s_waitcnt vmcnt(2)
    s_add_u32 s63, s69, 131072
    buffer_load_dwordx4 v[40:43], v1, s[40:43], s63 offen nt
    s_waitcnt vmcnt(3)
    s_bitcmp1_b64 s[14:15], 9
    s_cbranch_scc0 1
    s_waitcnt vmcnt(2)
    s_add_u32 s63, s69, 139264
    buffer_load_dwordx4 v[44:47], v1, s[40:43], s63 offen nt
    s_memrealtime s[8:9]
    s_waitcnt lgkmcnt(0)
    s_sub_u32 s8, s8, s30
    s_cmpk_ge_u32 s8, 436
    s_cbranch_scc1 .ap_47
    s_waitcnt vmcnt(4)
    s_cmpk_ge_u32 s8, 371
    s_cbranch_scc1 .ap_47
    s_waitcnt vmcnt(3)
    s_bitcmp1_b64 s[14:15], 10
    s_cbranch_scc0 1
    s_waitcnt vmcnt(2)
    s_cmpk_ge_u32 s8, 296
    s_cbranch_scc1 .ap_47
    s_waitcnt vmcnt(1)
.ap_47:
    s_add_u32 s63, s69, 147456
    buffer_load_dwordx4 v[72:75], v1, s[40:43], s63 offen nt
    s_waitcnt vmcnt(3)
    s_add_u32 m0, s100, 24576
    s_add_u32 s56, s101, 221184
    buffer_load_dwordx4 v6, s[48:51], s56 offen nt lds
    s_memrealtime s[8:9]
    s_waitcnt lgkmcnt(0)
    s_sub_u32 s8, s8, s30
    s_cmpk_ge_u32 s8, 482
    s_cbranch_scc1 .ap_48
    s_waitcnt vmcnt(4)
    s_cmpk_ge_u32 s8, 417
    s_cbranch_scc1 .ap_48
    s_waitcnt vmcnt(3)
    s_bitcmp1_b64 s[14:15], 11
    s_cbranch_scc0 1
    s_waitcnt vmcnt(2)
    s_cmpk_ge_u32 s8, 342
    s_cbranch_scc1 .ap_48
    s_waitcnt vmcnt(1)
.ap_48:
    s_add_u32 s63, s69, 155648
    buffer_load_dwordx4 v[76:79], v1, s[40:43], s63 offen nt
    s_waitcnt lgkmcnt(0)
    s_add_u32 s34, s34, 1
    s_memrealtime s[8:9]
    s_waitcnt lgkmcnt(0)
    s_sub_u32 s8, s8, s30
    s_cmpk_ge_u32 s8, 528
    s_cbranch_scc1 .ap_49
    s_waitcnt vmcnt(5)
    s_cmpk_ge_u32 s8, 463
    s_cbranch_scc1 .ap_49
    s_waitcnt vmcnt(3)
    s_bitcmp1_b64 s[14:15], 12
    s_cbranch_scc0 1
    s_waitcnt vmcnt(2)
    s_cmpk_ge_u32 s8, 388
    s_cbranch_scc1 .ap_49
    s_waitcnt vmcnt(1)
.ap_49:
    s_add_u32 s63, s69, 163840
    buffer_load_dwordx4 v[104:107], v1, s[40:43], s63 offen nt
    s_memrealtime s[8:9]
    s_waitcnt lgkmcnt(0)
    s_sub_u32 s8, s8, s30
    s_cmpk_ge_u32 s8, 574
    s_cbranch_scc1 .ap_50
    s_waitcnt vmcnt(5)
    s_cmpk_ge_u32 s8, 509
    s_cbranch_scc1 .ap_50
    s_waitcnt vmcnt(3)
    s_bitcmp1_b64 s[14:15], 13
    s_cbranch_scc0 1
    s_waitcnt vmcnt(2)
    s_cmpk_ge_u32 s8, 434
    s_cbranch_scc1 .ap_50
    s_waitcnt vmcnt(1)
.ap_50:
    s_add_u32 s63, s69, 172032
    buffer_load_dwordx4 v[108:111], v1, s[40:43], s63 offen nt
    s_waitcnt vmcnt(3)
    s_add_u32 m0, s100, 32768
    s_add_u32 s56, s101, 294912
    buffer_load_dwordx4 v6, s[48:51], s56 offen nt lds
    s_memrealtime s[8:9]
    s_waitcnt lgkmcnt(0)
    s_sub_u32 s8, s8, s30
    s_cmpk_ge_u32 s8, 620
    s_cbranch_scc1 .ap_51
    s_waitcnt vmcnt(4)
    s_cmpk_ge_u32 s8, 555
    s_cbranch_scc1 .ap_51
    s_waitcnt vmcnt(3)
    s_bitcmp1_b64 s[14:15], 14
    s_cbranch_scc0 1
    s_waitcnt vmcnt(2)
    s_cmpk_ge_u32 s8, 480
    s_cbranch_scc1 .ap_51
    s_waitcnt vmcnt(1)
.ap_51:
    s_add_u32 s63, s69, 180224
    buffer_load_dwordx4 v[136:139], v1, s[40:43], s63 offen nt
    s_memrealtime s[8:9]
    s_waitcnt lgkmcnt(0)
    s_sub_u32 s8, s8, s30
    s_cmpk_ge_u32 s8, 666
    s_cbranch_scc1 .ap_52
    s_waitcnt vmcnt(5)
    s_cmpk_ge_u32 s8, 601
    s_cbranch_scc1 .ap_52
    s_waitcnt vmcnt(3)
    s_bitcmp1_b64 s[14:15], 15
    s_cbranch_scc0 1
    s_waitcnt vmcnt(2)
    s_cmpk_ge_u32 s8, 526
    s_cbranch_scc1 .ap_52
    s_waitcnt vmcnt(1)
.ap_52:
    s_add_u32 s63, s69, 188416
    buffer_load_dwordx4 v[140:143], v1, s[40:43], s63 offen nt
    s_memrealtime s[8:9]
    s_waitcnt lgkmcnt(0)
    s_sub_u32 s8, s8, s30
    s_cmpk_ge_u32 s8, 712
    s_cbranch_scc1 .ap_53
    s_waitcnt vmcnt(5)
    s_cmpk_ge_u32 s8, 647
    s_cbranch_scc1 .ap_53
    s_waitcnt vmcnt(3)
    s_bitcmp1_b64 s[14:15], 16
    s_cbranch_scc0 1
    s_waitcnt vmcnt(2)
    s_cmpk_ge_u32 s8, 572
    s_cbranch_scc1 .ap_53
    s_waitcnt vmcnt(1)
.ap_53:
    s_add_u32 s63, s69, 262144
    buffer_load_dwordx4 v[48:51], v1, s[40:43], s63 offen nt
    s_waitcnt vmcnt(3)
    s_add_u32 m0, s100, 40960
    s_add_u32 s56, s101, 368640
    buffer_load_dwordx4 v6, s[48:51], s56 offen nt lds
    s_memrealtime s[8:9]
    s_waitcnt lgkmcnt(0)
    s_sub_u32 s8, s8, s30
    s_cmpk_ge_u32 s8, 758
    s_cbranch_scc1 .ap_54
    s_waitcnt vmcnt(4)
    s_cmpk_ge_u32 s8, 693
    s_cbranch_scc1 .ap_54
    s_waitcnt vmcnt(3)
    s_bitcmp1_b64 s[14:15], 17
    s_cbranch_scc0 1
    s_waitcnt vmcnt(2)
    s_cmpk_ge_u32 s8, 618
    s_cbranch_scc1 .ap_54
    s_waitcnt vmcnt(1)
.ap_54:
    s_add_u32 s63, s69, 270336
    buffer_load_dwordx4 v[52:55], v1, s[40:43], s63 offen nt
    s_memrealtime s[8:9]
    s_waitcnt lgkmcnt(0)
    s_sub_u32 s8, s8, s30
    s_cmpk_ge_u32 s8, 804
    s_cbranch_scc1 .ap_55
    s_waitcnt vmcnt(5)
    s_cmpk_ge_u32 s8, 739
    s_cbranch_scc1 .ap_55
    s_waitcnt vmcnt(3)
    s_bitcmp1_b64 s[14:15], 18
    s_cbranch_scc0 1
    s_waitcnt vmcnt(2)
    s_cmpk_ge_u32 s8, 664
    s_cbranch_scc1 .ap_55
    s_waitcnt vmcnt(1)
.ap_55:
    s_add_u32 s63, s69, 278528
    buffer_load_dwordx4 v[80:83], v1, s[40:43], s63 offen nt
    v_and_b32 v157, 7, v0
    v_lshlrev_b32 v157, 7, v157
    s_mov_b32 s63, 0x400
    buffer_load_dword v156, v157, s[36:39], s63 offen
    s_memrealtime s[8:9]
    s_waitcnt lgkmcnt(0)
    s_sub_u32 s8, s8, s30
    s_cmpk_ge_u32 s8, 850
    s_cbranch_scc1 .ap_56
    s_waitcnt vmcnt(6)
    s_cmpk_ge_u32 s8, 785
    s_cbranch_scc1 .ap_56
    s_waitcnt vmcnt(4)
    s_bitcmp1_b64 s[14:15], 19
    s_cbranch_scc0 1
    s_waitcnt vmcnt(3)
    s_cmpk_ge_u32 s8, 710
    s_cbranch_scc1 .ap_56
    s_waitcnt vmcnt(2)
.ap_56:
    s_add_u32 s63, s69, 286720
    buffer_load_dwordx4 v[84:87], v1, s[40:43], s63 offen nt
    s_waitcnt vmcnt(4)
    s_add_u32 m0, s100, 49152
    s_add_u32 s56, s101, 442368
    buffer_load_dwordx4 v6, s[48:51], s56 offen nt lds
    s_memrealtime s[8:9]
    s_waitcnt lgkmcnt(0)
    s_sub_u32 s8, s8, s30
    s_cmpk_ge_u32 s8, 895
    s_cbranch_scc1 .ap_57
    s_waitcnt vmcnt(5)
    s_cmpk_ge_u32 s8, 830
    s_cbranch_scc1 .ap_57
    s_waitcnt vmcnt(4)
    s_bitcmp1_b64 s[14:15], 20
    s_cbranch_scc0 1
    s_waitcnt vmcnt(3)
    s_cmpk_ge_u32 s8, 755
    s_cbranch_scc1 .ap_57
    s_waitcnt vmcnt(1)
.ap_57:
    s_add_u32 s63, s69, 294912
    buffer_load_dwordx4 v[112:115], v1, s[40:43], s63 offen nt
    s_memrealtime s[8:9]
    s_waitcnt lgkmcnt(0)
    s_sub_u32 s8, s8, s30
    s_cmpk_ge_u32 s8, 940
    s_cbranch_scc1 .ap_58
    s_waitcnt vmcnt(6)
    s_cmpk_ge_u32 s8, 875
    s_cbranch_scc1 .ap_58
    s_waitcnt vmcnt(4)
    s_bitcmp1_b64 s[14:15], 21
    s_cbranch_scc0 1
    s_waitcnt vmcnt(2)
    s_cmpk_ge_u32 s8, 800
    s_cbranch_scc1 .ap_58
    s_waitcnt vmcnt(1)
.ap_58:
    s_add_u32 s63, s69, 303104
    buffer_load_dwordx4 v[116:119], v1, s[40:43], s63 offen nt
    s_memrealtime s[8:9]
    s_waitcnt lgkmcnt(0)
    s_sub_u32 s8, s8, s30
    s_cmpk_ge_u32 s8, 985
    s_cbranch_scc1 .ap_59
    s_waitcnt vmcnt(6)
    s_cmpk_ge_u32 s8, 920
    s_cbranch_scc1 .ap_59
    s_waitcnt vmcnt(3)
    s_bitcmp1_b64 s[14:15], 22
    s_cbranch_scc0 1
    s_waitcnt vmcnt(2)
    s_cmpk_ge_u32 s8, 845
    s_cbranch_scc1 .ap_59
    s_waitcnt vmcnt(1)
.ap_59:
    s_add_u32 s63, s69, 311296
    buffer_load_dwordx4 v[144:147], v1, s[40:43], s63 offen nt
    s_waitcnt vmcnt(5)
    s_sub_u32 s63, s70, 300
    v_subrev_u32 v156, s63, v156
    v_mov_b32 v157, 600
    v_cmp_lt_u32 s[8:9], v156, v157
    v_add_u32_dpp v156, v156, v156 quad_perm:[1,0,3,2] row_mask:0xf bank_mask:0xf
    s_nop 1
    v_add_u32_dpp v156, v156, v156 quad_perm:[2,3,0,1] row_mask:0xf bank_mask:0xf
    s_nop 1
    v_add_u32_dpp v156, v156, v156 row_ror:4 row_mask:0xf bank_mask:0xf
    s_nop 0
    v_readfirstlane_b32 s63, v156
    s_cmp_eq_u64 s[8:9], -1
    s_nop 3
    s_cbranch_scc0 .et_60
    s_lshr_b32 s63, s63, 3
    s_sub_u32 s63, s63, 300
    s_add_u32 s30, s30, s63
.et_60:
    s_waitcnt vmcnt(3)
    s_add_u32 m0, s100, 57344
    s_add_u32 s56, s101, 516096
    buffer_load_dwordx4 v6, s[48:51], s56 offen nt lds
    s_memrealtime s[8:9]
    s_waitcnt lgkmcnt(0)
    s_sub_u32 s8, s8, s30
    s_cmpk_ge_u32 s8, 1030
    s_cbranch_scc1 .ap_61
    s_waitcnt vmcnt(4)
    s_cmpk_ge_u32 s8, 965
    s_cbranch_scc1 .ap_61
    s_waitcnt vmcnt(3)
    s_bitcmp1_b64 s[14:15], 23
    s_cbranch_scc0 1
    s_waitcnt vmcnt(2)
    s_cmpk_ge_u32 s8, 890
    s_cbranch_scc1 .ap_61
    s_waitcnt vmcnt(1)
.ap_61:
    s_add_u32 s63, s69, 319488
    buffer_load_dwordx4 v[148:151], v1, s[40:43], s63 offen nt
    s_memrealtime s[8:9]
    s_waitcnt lgkmcnt(0)
    s_sub_u32 s8, s8, s30
    s_cmpk_ge_u32 s8, 1075
    s_cbranch_scc1 .ap_62
    s_waitcnt vmcnt(5)
    s_cmpk_ge_u32 s8, 1010
    s_cbranch_scc1 .ap_62
    s_waitcnt vmcnt(3)
    s_bitcmp1_b64 s[14:15], 24
    s_cbranch_scc0 1
    s_waitcnt vmcnt(2)
    s_cmpk_ge_u32 s8, 935
    s_cbranch_scc1 .ap_62
    s_waitcnt vmcnt(1)
.ap_62:
    s_add_u32 s63, s69, 393216
    buffer_load_dwordx4 v[56:59], v1, s[40:43], s63 offen nt
    s_memrealtime s[8:9]
    s_waitcnt lgkmcnt(0)
    s_sub_u32 s8, s8, s30
    s_cmpk_ge_u32 s8, 1120
    s_cbranch_scc1 .ap_63
    s_waitcnt vmcnt(5)
    s_cmpk_ge_u32 s8, 1055
    s_cbranch_scc1 .ap_63
    s_waitcnt vmcnt(3)
    s_bitcmp1_b64 s[14:15], 25
    s_cbranch_scc0 1
    s_waitcnt vmcnt(2)
    s_cmpk_ge_u32 s8, 980
    s_cbranch_scc1 .ap_63
    s_waitcnt vmcnt(1)
.ap_63:
    s_add_u32 s63, s69, 401408
    buffer_load_dwordx4 v[60:63], v1, s[40:43], s63 offen nt
.Latt_ar:
    v_and_b32 v8, 1, v0
    v_lshlrev_b32 v8, 8, v8
    v_and_b32 v9, 0x3c, v0
    v_lshl_add_u32 v9, v9, 2, v8
    v_lshlrev_b32 v7, 1, v9
    v_and_b32 v9, 0x3c, v0
    v_lshrrev_b32 v8, 4, v8
    v_and_b32 v9, 2, v0
    v_lshl_add_u32 v9, v9, 6, v8
    s_lshl_b32 s58, s66, 14
    s_lshl_b32 s59, s67, 10
    s_add_u32 s58, s58, s59
    s_add_u32 s58, s58, 0x40000
    s_lshl4_add_u32 s59, s66, s67
    s_lshl_b32 s59, s59, 8
    s_add_u32 s59, s59, 0x200000
    s_memrealtime s[8:9]
    s_waitcnt vmcnt(8)
    s_waitcnt lgkmcnt(0)
    s_sub_u32 s8, s8, s30
    s_cmpk_ge_u32 s8, 1147
    s_cbranch_scc1 .ap_64
    s_waitcnt vmcnt(5)
    s_cmpk_ge_u32 s8, 1082
    s_cbranch_scc1 .ap_64
    s_waitcnt vmcnt(3)
    s_bitcmp1_b64 s[14:15], 26
    s_cbranch_scc0 1
    s_waitcnt vmcnt(2)
    s_cmpk_ge_u32 s8, 1007
    s_cbranch_scc1 .ap_64
    s_waitcnt vmcnt(1)
.ap_64:
    s_add_u32 s63, s69, 409600
    buffer_load_dwordx4 v[88:91], v1, s[40:43], s63 offen nt
    s_memrealtime s[8:9]
    s_waitcnt vmcnt(8)
    s_waitcnt lgkmcnt(0)
    s_sub_u32 s8, s8, s30
    s_cmpk_ge_u32 s8, 1174
    s_cbranch_scc1 .ap_65
    s_waitcnt vmcnt(5)
    s_cmpk_ge_u32 s8, 1109
    s_cbranch_scc1 .ap_65
    s_waitcnt vmcnt(3)
    s_bitcmp1_b64 s[14:15], 27
    s_cbranch_scc0 1
    s_waitcnt vmcnt(2)
    s_cmpk_ge_u32 s8, 1034
    s_cbranch_scc1 .ap_65
    s_waitcnt vmcnt(1)
.ap_65:
    s_add_u32 s63, s69, 417792
    buffer_load_dwordx4 v[92:95], v1, s[40:43], s63 offen nt
    s_memrealtime s[8:9]
    s_waitcnt vmcnt(8)
    s_waitcnt lgkmcnt(0)
    s_sub_u32 s8, s8, s30
    s_cmpk_ge_u32 s8, 1201
    s_cbranch_scc1 .ap_66
    s_waitcnt vmcnt(5)
    s_cmpk_ge_u32 s8, 1136
    s_cbranch_scc1 .ap_66
    s_waitcnt vmcnt(3)
    s_bitcmp1_b64 s[14:15], 28
    s_cbranch_scc0 1
    s_waitcnt vmcnt(2)
    s_cmpk_ge_u32 s8, 1061
    s_cbranch_scc1 .ap_66
    s_waitcnt vmcnt(1)
.ap_66:
    s_add_u32 s63, s69, 425984
    buffer_load_dwordx4 v[120:123], v1, s[40:43], s63 offen nt
    s_memrealtime s[8:9]
    s_waitcnt vmcnt(8)
    s_waitcnt lgkmcnt(0)
    s_sub_u32 s8, s8, s30
    s_cmpk_ge_u32 s8, 1228
    s_cbranch_scc1 .ap_67
    s_waitcnt vmcnt(5)
    s_cmpk_ge_u32 s8, 1163
    s_cbranch_scc1 .ap_67
    s_waitcnt vmcnt(3)
    s_bitcmp1_b64 s[14:15], 29
    s_cbranch_scc0 1
    s_waitcnt vmcnt(2)
    s_cmpk_ge_u32 s8, 1088
    s_cbranch_scc1 .ap_67
    s_waitcnt vmcnt(1)
.ap_67:
    s_add_u32 s63, s69, 434176
    buffer_load_dwordx4 v[124:127], v1, s[40:43], s63 offen nt
    s_memrealtime s[8:9]
    s_waitcnt vmcnt(8)
    s_waitcnt lgkmcnt(0)
    s_sub_u32 s8, s8, s30
    s_cmpk_ge_u32 s8, 1255
    s_cbranch_scc1 .ap_68
    s_waitcnt vmcnt(5)
    s_cmpk_ge_u32 s8, 1190
    s_cbranch_scc1 .ap_68
    s_waitcnt vmcnt(3)
    s_bitcmp1_b64 s[14:15], 30
    s_cbranch_scc0 1
    s_waitcnt vmcnt(2)
    s_cmpk_ge_u32 s8, 1115
    s_cbranch_scc1 .ap_68
    s_waitcnt vmcnt(1)
.ap_68:
    s_add_u32 s63, s69, 442368
    buffer_load_dwordx4 v[152:155], v1, s[40:43], s63 offen nt
    s_memrealtime s[8:9]
    s_waitcnt vmcnt(8)
    s_waitcnt lgkmcnt(0)
    s_sub_u32 s8, s8, s30
    s_cmpk_ge_u32 s8, 1282
    s_cbranch_scc1 .ap_69
    s_waitcnt vmcnt(5)
    s_cmpk_ge_u32 s8, 1217
    s_cbranch_scc1 .ap_69
    s_waitcnt vmcnt(3)
    s_bitcmp1_b64 s[14:15], 31
    s_cbranch_scc0 1
    s_waitcnt vmcnt(2)
    s_cmpk_ge_u32 s8, 1142
    s_cbranch_scc1 .ap_69
    s_waitcnt vmcnt(1)
.ap_69:
    s_add_u32 s63, s69, 450560
    buffer_load_dwordx4 v[156:159], v1, s[40:43], s63 offen nt
    buffer_load_dwordx4 v[16:19], v7, s[36:39], s58 offen offset:0 sc1
    buffer_load_dwordx4 v[20:23], v7, s[36:39], s58 offen offset:16 sc1
    s_memrealtime s[8:9]
    s_waitcnt vmcnt(8)
    s_waitcnt lgkmcnt(0)
    s_sub_u32 s8, s8, s30
    s_cmpk_ge_u32 s8, 1309
    s_cbranch_scc1 .ap_70
    s_waitcnt vmcnt(5)
    s_cmpk_ge_u32 s8, 1244
    s_cbranch_scc1 .ap_70
    s_waitcnt vmcnt(3)
    s_bitcmp1_b64 s[14:15], 32
    s_cbranch_scc0 1
    s_waitcnt vmcnt(2)
    s_cmpk_ge_u32 s8, 1169
    s_cbranch_scc1 .ap_70
    s_waitcnt vmcnt(1)
.ap_70:
    s_add_u32 s63, s69, 0
    buffer_load_dwordx4 v[160:163], v2, s[44:47], s63 offen nt
    s_memrealtime s[8:9]
    s_waitcnt vmcnt(8)
    s_waitcnt lgkmcnt(0)
    s_sub_u32 s8, s8, s30
    s_cmpk_ge_u32 s8, 1336
    s_cbranch_scc1 .ap_71
    s_waitcnt vmcnt(5)
    s_cmpk_ge_u32 s8, 1271
    s_cbranch_scc1 .ap_71
    s_waitcnt vmcnt(3)
    s_bitcmp1_b64 s[14:15], 33
    s_cbranch_scc0 1
    s_waitcnt vmcnt(2)
    s_cmpk_ge_u32 s8, 1196
    s_cbranch_scc1 .ap_71
    s_waitcnt vmcnt(1)
.ap_71:
    s_add_u32 s63, s69, 8192
    buffer_load_dwordx4 v[164:167], v2, s[44:47], s63 offen nt
    s_memrealtime s[8:9]
    s_waitcnt vmcnt(8)
    s_waitcnt lgkmcnt(0)
    s_sub_u32 s8, s8, s30
    s_cmpk_ge_u32 s8, 1363
    s_cbranch_scc1 .ap_72
    s_waitcnt vmcnt(5)
    s_cmpk_ge_u32 s8, 1298
    s_cbranch_scc1 .ap_72
    s_waitcnt vmcnt(3)
    s_bitcmp1_b64 s[14:15], 34
    s_cbranch_scc0 1
    s_waitcnt vmcnt(2)
    s_cmpk_ge_u32 s8, 1223
    s_cbranch_scc1 .ap_72
    s_waitcnt vmcnt(1)
.ap_72:
    s_add_u32 s63, s69, 16384
    buffer_load_dwordx4 v[168:171], v2, s[44:47], s63 offen nt
    s_waitcnt vmcnt(3)
    s_branch .gpc_74
.gp_73:
    buffer_load_dwordx4 v[16:19], v7, s[36:39], s58 offen offset:0 sc1
    buffer_load_dwordx4 v[20:23], v7, s[36:39], s58 offen offset:16 sc1
    s_waitcnt vmcnt(0)
.gpc_74:
    v_min_u32 v10, v17, v19
    v_max_u32 v11, v17, v19
    v_min3_u32 v10, v10, v21, v23
    v_max3_u32 v11, v11, v21, v23
    v_cmp_eq_u32 vcc, s34, v10
    v_cmp_eq_u32 s[56:57], s34, v11
    s_and_b64 vcc, vcc, s[56:57]
    s_cmp_eq_u64 vcc, exec
    s_nop 2
    s_cbranch_scc1 .gpd_75
    s_sub_u32 s35, s35, 1
    s_cbranch_scc1 .Lexit
    s_sleep 1
    s_branch .gp_73
.gpd_75:
    s_mov_b32 vcc_lo, 0xcccccccc
    s_mov_b32 vcc_hi, 0xcccccccc
    v_cndmask_b32_e64 v24, v16, 0, vcc
    v_cndmask_b32_e64 v25, v18, 0, vcc
    v_cndmask_b32_e64 v26, v20, 0, vcc
    v_cndmask_b32_e64 v27, v22, 0, vcc
    v_cndmask_b32_e32 v28, 0, v16, vcc
    v_cndmask_b32_e32 v29, 0, v18, vcc
    v_cndmask_b32_e32 v30, 0, v20, vcc
    v_cndmask_b32_e32 v31, 0, v22, vcc
    v_mfma_f32_16x16x32_bf16 v[16:19], v[32:35], v[24:27], 0
    v_mfma_f32_16x16x32_bf16 v[32:35], v[40:43], v[24:27], 0
    v_mfma_f32_16x16x32_bf16 v[16:19], v[36:39], v[28:31], v[16:19]
    v_mfma_f32_16x16x32_bf16 v[40:43], v[48:51], v[24:27], 0
    v_mfma_f32_16x16x32_bf16 v[32:35], v[44:47], v[28:31], v[32:35]
    v_mfma_f32_16x16x32_bf16 v[48:51], v[56:59], v[24:27], 0
    v_mfma_f32_16x16x32_bf16 v[40:43], v[52:55], v[28:31], v[40:43]
    v_mfma_f32_16x16x32_bf16 v[56:59], v[64:67], v[24:27], 0
    v_mfma_f32_16x16x32_bf16 v[48:51], v[60:63], v[28:31], v[48:51]
    s_nop 1
    v_add_f32_dpp v10, v17, v16 row_ror:12 row_mask:0xf bank_mask:0x1
    s_memrealtime s[8:9]
    s_waitcnt lgkmcnt(0)
    s_sub_u32 s8, s8, s30
    s_cmpk_ge_u32 s8, 1390
    s_nop 0
    s_cbranch_scc1 .ap_76
    s_waitcnt vmcnt(3)
    s_cmpk_ge_u32 s8, 1325
    s_cbranch_scc1 .ap_76
    s_waitcnt vmcnt(3)
    s_bitcmp1_b64 s[14:15], 35
    s_cbranch_scc0 1
    s_waitcnt vmcnt(2)
    s_cmpk_ge_u32 s8, 1250
    s_cbranch_scc1 .ap_76
    s_waitcnt vmcnt(1)
.ap_76:
    s_add_u32 s63, s69, 24576
    buffer_load_dwordx4 v[172:175], v2, s[44:47], s63 offen nt
    v_mfma_f32_16x16x32_bf16 v[64:67], v[72:75], v[24:27], 0
    v_mfma_f32_16x16x32_bf16 v[56:59], v[68:71], v[28:31], v[56:59]
    v_add_f32_dpp v11, v33, v32 row_ror:12 row_mask:0xf bank_mask:0x1
    v_add_f32_dpp v10, v18, v10 row_ror:8 row_mask:0xf bank_mask:0x1
    v_mfma_f32_16x16x32_bf16 v[72:75], v[80:83], v[24:27], 0
    v_mfma_f32_16x16x32_bf16 v[64:67], v[76:79], v[28:31], v[64:67]
    v_add_f32_dpp v12, v41, v40 row_ror:12 row_mask:0xf bank_mask:0x1
    v_add_f32_dpp v11, v34, v11 row_ror:8 row_mask:0xf bank_mask:0x1
    v_add_f32_dpp v10, v19, v10 row_ror:4 row_mask:0xf bank_mask:0x1
    v_mfma_f32_16x16x32_bf16 v[80:83], v[88:91], v[24:27], 0
    v_mfma_f32_16x16x32_bf16 v[72:75], v[84:87], v[28:31], v[72:75]
    v_add_f32_dpp v13, v49, v48 row_ror:12 row_mask:0xf bank_mask:0x1
    v_add_f32_dpp v12, v42, v12 row_ror:8 row_mask:0xf bank_mask:0x1
    v_add_f32_dpp v11, v35, v11 row_ror:4 row_mask:0xf bank_mask:0x1
    v_mfma_f32_16x16x32_bf16 v[88:91], v[96:99], v[24:27], 0
    v_mfma_f32_16x16x32_bf16 v[80:83], v[92:95], v[28:31], v[80:83]
    v_add_f32_dpp v10, v58, v57 row_ror:12 row_mask:0xf bank_mask:0x2
    v_add_f32_dpp v13, v50, v13 row_ror:8 row_mask:0xf bank_mask:0x1
    v_add_f32_dpp v12, v43, v12 row_ror:4 row_mask:0xf bank_mask:0x1
    s_memrealtime s[8:9]
    s_waitcnt lgkmcnt(0)
    s_sub_u32 s8, s8, s30
    s_cmpk_ge_u32 s8, 1417
    s_nop 0
    s_cbranch_scc1 .ap_77
    s_waitcnt vmcnt(4)
    s_cmpk_ge_u32 s8, 1352
    s_cbranch_scc1 .ap_77
    s_waitcnt vmcnt(3)
    s_bitcmp1_b64 s[14:15], 36
    s_cbranch_scc0 1
    s_waitcnt vmcnt(2)
    s_cmpk_ge_u32 s8, 1277
    s_cbranch_scc1 .ap_77
    s_waitcnt vmcnt(1)
.ap_77:
    s_add_u32 s63, s69, 32768
    buffer_load_dwordx4 v[176:179], v2, s[44:47], s63 offen nt
    v_mfma_f32_16x16x32_bf16 v[96:99], v[104:107], v[24:27], 0
    v_mfma_f32_16x16x32_bf16 v[88:91], v[100:103], v[28:31], v[88:91]
    v_add_f32_dpp v11, v66, v65 row_ror:12 row_mask:0xf bank_mask:0x2
    v_add_f32_dpp v10, v59, v10 row_ror:8 row_mask:0xf bank_mask:0x2
    v_add_f32_dpp v13, v51, v13 row_ror:4 row_mask:0xf bank_mask:0x1
    v_mfma_f32_16x16x32_bf16 v[104:107], v[112:115], v[24:27], 0
    v_mfma_f32_16x16x32_bf16 v[96:99], v[108:111], v[28:31], v[96:99]
    v_add_f32_dpp v12, v74, v73 row_ror:12 row_mask:0xf bank_mask:0x2
    v_add_f32_dpp v11, v67, v11 row_ror:8 row_mask:0xf bank_mask:0x2
    v_add_f32_dpp v10, v56, v10 row_ror:4 row_mask:0xf bank_mask:0x2
    v_mfma_f32_16x16x32_bf16 v[112:115], v[120:123], v[24:27], 0
    v_mfma_f32_16x16x32_bf16 v[104:107], v[116:119], v[28:31], v[104:107]
    v_add_f32_dpp v13, v82, v81 row_ror:12 row_mask:0xf bank_mask:0x2
    v_add_f32_dpp v12, v75, v12 row_ror:8 row_mask:0xf bank_mask:0x2
    v_add_f32_dpp v11, v64, v11 row_ror:4 row_mask:0xf bank_mask:0x2
    v_mfma_f32_16x16x32_bf16 v[120:123], v[128:131], v[24:27], 0
    v_mfma_f32_16x16x32_bf16 v[112:115], v[124:127], v[28:31], v[112:115]
    v_add_f32_dpp v10, v91, v90 row_ror:12 row_mask:0xf bank_mask:0x4
    v_add_f32_dpp v13, v83, v13 row_ror:8 row_mask:0xf bank_mask:0x2
    v_add_f32_dpp v12, v72, v12 row_ror:4 row_mask:0xf bank_mask:0x2
    s_memrealtime s[8:9]
    s_waitcnt lgkmcnt(0)
    s_sub_u32 s8, s8, s30
    s_cmpk_ge_u32 s8, 1444
    s_nop 0
    s_cbranch_scc1 .ap_78
    s_waitcnt vmcnt(5)
    s_cmpk_ge_u32 s8, 1379
    s_cbranch_scc1 .ap_78
    s_waitcnt vmcnt(3)
    s_bitcmp1_b64 s[14:15], 37
    s_cbranch_scc0 1
    s_waitcnt vmcnt(2)
    s_cmpk_ge_u32 s8, 1304
    s_cbranch_scc1 .ap_78
    s_waitcnt vmcnt(1)
.ap_78:
    s_add_u32 s63, s69, 40960
    buffer_load_dwordx4 v[180:183], v2, s[44:47], s63 offen nt
    v_mfma_f32_16x16x32_bf16 v[128:131], v[136:139], v[24:27], 0
    v_mfma_f32_16x16x32_bf16 v[120:123], v[132:135], v[28:31], v[120:123]
    v_add_f32_dpp v11, v99, v98 row_ror:12 row_mask:0xf bank_mask:0x4
    v_add_f32_dpp v10, v88, v10 row_ror:8 row_mask:0xf bank_mask:0x4
    v_add_f32_dpp v13, v80, v13 row_ror:4 row_mask:0xf bank_mask:0x2
    v_mfma_f32_16x16x32_bf16 v[136:139], v[144:147], v[24:27], 0
    v_mfma_f32_16x16x32_bf16 v[128:131], v[140:143], v[28:31], v[128:131]
    v_add_f32_dpp v12, v107, v106 row_ror:12 row_mask:0xf bank_mask:0x4
    v_add_f32_dpp v11, v96, v11 row_ror:8 row_mask:0xf bank_mask:0x4
    v_add_f32_dpp v10, v89, v10 row_ror:4 row_mask:0xf bank_mask:0x4
    v_mfma_f32_16x16x32_bf16 v[144:147], v[152:155], v[24:27], 0
    v_mfma_f32_16x16x32_bf16 v[136:139], v[148:151], v[28:31], v[136:139]
    v_add_f32_dpp v13, v115, v114 row_ror:12 row_mask:0xf bank_mask:0x4
    v_add_f32_dpp v12, v104, v12 row_ror:8 row_mask:0xf bank_mask:0x4
    v_add_f32_dpp v11, v97, v11 row_ror:4 row_mask:0xf bank_mask:0x4
    v_mfma_f32_16x16x32_bf16 v[144:147], v[156:159], v[28:31], v[144:147]
    v_add_f32_dpp v10, v120, v123 row_ror:12 row_mask:0xf bank_mask:0x8
    v_add_f32_dpp v13, v112, v13 row_ror:8 row_mask:0xf bank_mask:0x4
    v_add_f32_dpp v12, v105, v12 row_ror:4 row_mask:0xf bank_mask:0x4
    s_memrealtime s[8:9]
    s_waitcnt lgkmcnt(0)
    s_sub_u32 s8, s8, s30
    s_cmpk_ge_u32 s8, 1471
    s_nop 0
    s_cbranch_scc1 .ap_79
    s_waitcnt vmcnt(5)
    s_cmpk_ge_u32 s8, 1406
    s_cbranch_scc1 .ap_79
    s_waitcnt vmcnt(3)
    s_bitcmp1_b64 s[14:15], 38
    s_cbranch_scc0 1
    s_waitcnt vmcnt(2)
    s_cmpk_ge_u32 s8, 1331
    s_cbranch_scc1 .ap_79
    s_waitcnt vmcnt(1)
.ap_79:
    s_add_u32 s63, s69, 49152
    buffer_load_dwordx4 v[184:187], v2, s[44:47], s63 offen nt
    v_add_f32_dpp v11, v128, v131 row_ror:12 row_mask:0xf bank_mask:0x8
    v_add_f32_dpp v10, v121, v10 row_ror:8 row_mask:0xf bank_mask:0x8
    v_add_f32_dpp v13, v113, v13 row_ror:4 row_mask:0xf bank_mask:0x4
    v_add_f32_dpp v12, v136, v139 row_ror:12 row_mask:0xf bank_mask:0x8
    v_add_f32_dpp v11, v129, v11 row_ror:8 row_mask:0xf bank_mask:0x8
    v_add_f32_dpp v10, v122, v10 row_ror:4 row_mask:0xf bank_mask:0x8
    v_add_f32_dpp v13, v144, v147 row_ror:12 row_mask:0xf bank_mask:0x8
    v_add_f32_dpp v12, v137, v12 row_ror:8 row_mask:0xf bank_mask:0x8
    v_add_f32_dpp v11, v130, v11 row_ror:4 row_mask:0xf bank_mask:0x8
    v_add_f32_dpp v13, v145, v13 row_ror:8 row_mask:0xf bank_mask:0x8
    v_add_f32_dpp v12, v138, v12 row_ror:4 row_mask:0xf bank_mask:0x8
    s_memrealtime s[8:9]
    s_waitcnt lgkmcnt(0)
    s_sub_u32 s8, s8, s30
    s_cmpk_ge_u32 s8, 1498
    s_cbranch_scc1 .ap_80
    s_waitcnt vmcnt(5)
    s_cmpk_ge_u32 s8, 1433
    s_cbranch_scc1 .ap_80
    s_waitcnt vmcnt(3)
    s_bitcmp1_b64 s[14:15], 39
    s_cbranch_scc0 1
    s_waitcnt vmcnt(2)
    s_cmpk_ge_u32 s8, 1358
    s_cbranch_scc1 .ap_80
    s_waitcnt vmcnt(1)
.ap_80:
    s_add_u32 s63, s69, 57344
    buffer_load_dwordx4 v[188:191], v2, s[44:47], s63 offen nt
    v_add_f32_dpp v13, v146, v13 row_ror:4 row_mask:0xf bank_mask:0x8
    s_mov_b32 s60, 0x3db504f3
    s_mov_b32 s61, 0x3db504f3
    v_cvt_pk_bf16_f32 v10, 0, v10
    v_cvt_pk_bf16_f32 v11, 0, v11
    v_cvt_pk_bf16_f32 v12, 0, v12
    v_cvt_pk_bf16_f32 v13, 0, v13
    v_pk_mul_f32 v[10:11], v[10:11], s[60:61]
    v_pk_mul_f32 v[12:13], v[12:13], s[60:61]
    v_cvt_pk_bf16_f32 v10, 0, v10
    v_cvt_pk_bf16_f32 v11, 0, v11
    v_cvt_pk_bf16_f32 v12, 0, v12
    v_cvt_pk_bf16_f32 v13, 0, v13
    v_max_f32 v14, v10, v11
    v_max3_f32 v14, v14, v12, v13
    s_mov_b32 s60, 0x3fb8aa3b
    v_mov_b32 v22, s34
    v_mov_b32 v23, s34
    v_max_f32_dpp v14, v14, v14 quad_perm:[2,3,0,1] row_mask:0xf bank_mask:0xf
    s_nop 1
    v_max_f32_dpp v14, v14, v14 row_ror:4 row_mask:0xf bank_mask:0xf
    s_nop 1
    v_max_f32_dpp v14, v14, v14 row_ror:8 row_mask:0xf bank_mask:0xf
    v_mov_b32 v15, v14
    s_nop 1
    v_permlane16_swap_b32 v15, v14
    v_max_f32 v14, v15, v14
    v_mov_b32 v15, v14
    s_nop 1
    v_permlane32_swap_b32 v15, v14
    v_max_f32 v14, v15, v14
    v_mul_f32 v15, 0xbfb8aa3b, v14
    v_fma_f32 v10, v10, s60, v15
    v_fma_f32 v11, v11, s60, v15
    v_fma_f32 v12, v12, s60, v15
    v_fma_f32 v13, v13, s60, v15
    v_exp_f32 v10, v10
    v_exp_f32 v11, v11
    v_exp_f32 v12, v12
    v_exp_f32 v13, v13
    v_mov_b32 v20, v14
    v_pk_add_f32 v[16:17], v[10:11], v[12:13]
    v_add_f32 v21, v16, v17
    s_lshl3_add_u32 s60, s68, s3
    s_lshl_b32 s60, s60, 5
    s_add_u32 s60, s60, s59
    v_add_f32_dpp v21, v21, v21 quad_perm:[2,3,0,1] row_mask:0xf bank_mask:0xf
    s_nop 1
    v_add_f32_dpp v21, v21, v21 row_ror:4 row_mask:0xf bank_mask:0xf
    s_nop 1
    v_add_f32_dpp v21, v21, v21 row_ror:8 row_mask:0xf bank_mask:0xf
    v_mov_b32 v15, v21
    s_nop 1
    v_permlane16_swap_b32 v15, v21
    v_add_f32 v21, v15, v21
    v_mov_b32 v15, v21
    s_nop 1
    v_permlane32_swap_b32 v15, v21
    v_add_f32 v21, v15, v21
    s_lshl_b32 s60, s3, 4
    s_add_u32 s60, s60, 159104
    v_add_u32 v16, s60, v3
    v_mov_b32 v17, 159232
    v_mov_b32 v18, 1
    s_mov_b64 exec, 3
    ds_write_b64 v16, v[20:21]
    s_mov_b64 exec, 1
    s_waitcnt lgkmcnt(0)
    ds_add_rtn_u32 v18, v17, v18
    s_mov_b64 exec, -1
    v_and_b32 v16, 0x78, v3
    v_add_u32 v16, 159104, v16
    s_waitcnt lgkmcnt(0)
    v_readfirstlane_b32 s60, v18
    s_cmp_lg_u32 s60, 7
    s_nop 3
    s_cbranch_scc1 .ml_81
    ds_read_b64 v[18:19], v16
    s_lshl_b32 s60, s68, 7
    s_add_u32 s60, s60, s59
    s_waitcnt lgkmcnt(0)
    v_mov_b32 v20, v18
    s_nop 1
    v_max_f32_dpp v20, v20, v20 quad_perm:[2,3,0,1] row_mask:0xf bank_mask:0xf
    s_nop 1
    v_max_f32_dpp v20, v20, v20 row_ror:4 row_mask:0xf bank_mask:0xf
    s_nop 1
    v_max_f32_dpp v20, v20, v20 row_ror:8 row_mask:0xf bank_mask:0xf
    v_sub_f32 v18, v18, v20
    v_mul_f32 v18, 0x3fb8aa3b, v18
    v_exp_f32 v18, v18
    s_nop 0
    v_mul_f32 v21, v18, v19
    s_nop 1
    v_add_f32_dpp v21, v21, v21 quad_perm:[2,3,0,1] row_mask:0xf bank_mask:0xf
    s_nop 1
    v_add_f32_dpp v21, v21, v21 row_ror:4 row_mask:0xf bank_mask:0xf
    s_nop 1
    v_add_f32_dpp v21, v21, v21 row_ror:8 row_mask:0xf bank_mask:0xf
    s_mov_b64 exec, 0xff
    buffer_store_dwordx4 v[20:23], v2, s[36:39], s60 offen sc1
    s_mov_b64 exec, -1
.ml_81:
    s_memrealtime s[8:9]
    s_waitcnt lgkmcnt(0)
    s_sub_u32 s8, s8, s30
    s_cmpk_ge_u32 s8, 1525
    s_cbranch_scc1 .ap_82
    s_waitcnt vmcnt(5)
    s_cmpk_ge_u32 s8, 1460
    s_cbranch_scc1 .ap_82
    s_waitcnt vmcnt(3)
    s_bitcmp1_b64 s[14:15], 40
    s_cbranch_scc0 1
    s_waitcnt vmcnt(2)
    s_cmpk_ge_u32 s8, 1385
    s_cbranch_scc1 .ap_82
    s_waitcnt vmcnt(1)
.ap_82:
    s_add_u32 s63, s69, 131072
    buffer_load_dwordx4 v[192:195], v2, s[44:47], s63 offen nt
    s_memrealtime s[8:9]
    s_waitcnt vmcnt(8)
    s_waitcnt lgkmcnt(0)
    s_sub_u32 s8, s8, s30
    s_cmpk_ge_u32 s8, 1552
    s_cbranch_scc1 .ap_83
    s_waitcnt vmcnt(5)
    s_cmpk_ge_u32 s8, 1487
    s_cbranch_scc1 .ap_83
    s_waitcnt vmcnt(3)
    s_bitcmp1_b64 s[14:15], 41
    s_cbranch_scc0 1
    s_waitcnt vmcnt(2)
    s_cmpk_ge_u32 s8, 1412
    s_cbranch_scc1 .ap_83
    s_waitcnt vmcnt(1)
.ap_83:
    s_add_u32 s63, s69, 139264
    buffer_load_dwordx4 v[196:199], v2, s[44:47], s63 offen nt
    s_memrealtime s[8:9]
    s_waitcnt vmcnt(8)
    s_waitcnt lgkmcnt(0)
    s_sub_u32 s8, s8, s30
    s_cmpk_ge_u32 s8, 1579
    s_cbranch_scc1 .ap_84
    s_waitcnt vmcnt(5)
    s_cmpk_ge_u32 s8, 1514
    s_cbranch_scc1 .ap_84
    s_waitcnt vmcnt(3)
    s_bitcmp1_b64 s[14:15], 42
    s_cbranch_scc0 1
    s_waitcnt vmcnt(2)
    s_cmpk_ge_u32 s8, 1439
    s_cbranch_scc1 .ap_84
    s_waitcnt vmcnt(1)
.ap_84:
    s_add_u32 s63, s69, 147456
    buffer_load_dwordx4 v[200:203], v2, s[44:47], s63 offen nt
    s_memrealtime s[8:9]
    s_waitcnt vmcnt(8)
    s_waitcnt lgkmcnt(0)
    s_sub_u32 s8, s8, s30
    s_cmpk_ge_u32 s8, 1606
    s_cbranch_scc1 .ap_85
    s_waitcnt vmcnt(5)
    s_cmpk_ge_u32 s8, 1541
    s_cbranch_scc1 .ap_85
    s_waitcnt vmcnt(3)
    s_bitcmp1_b64 s[14:15], 43
    s_cbranch_scc0 1
    s_waitcnt vmcnt(2)
    s_cmpk_ge_u32 s8, 1466
    s_cbranch_scc1 .ap_85
    s_waitcnt vmcnt(1)
.ap_85:
    s_add_u32 s63, s69, 155648
    buffer_load_dwordx4 v[204:207], v2, s[44:47], s63 offen nt
    s_memrealtime s[8:9]
    s_waitcnt vmcnt(8)
    s_waitcnt lgkmcnt(0)
    s_sub_u32 s8, s8, s30
    s_cmpk_ge_u32 s8, 1633
    s_cbranch_scc1 .ap_86
    s_waitcnt vmcnt(5)
    s_cmpk_ge_u32 s8, 1568
    s_cbranch_scc1 .ap_86
    s_waitcnt vmcnt(3)
    s_bitcmp1_b64 s[14:15], 44
    s_cbranch_scc0 1
    s_waitcnt vmcnt(2)
    s_cmpk_ge_u32 s8, 1493
    s_cbranch_scc1 .ap_86
    s_waitcnt vmcnt(1)
.ap_86:
    s_add_u32 s63, s69, 163840
    buffer_load_dwordx4 v[208:211], v2, s[44:47], s63 offen nt
    v_and_b32 v16, 15, v0
    v_lshrrev_b32 v17, 4, v0
    v_lshl_add_u32 v16, v16, 2, v17
    v_lshlrev_b32 v31, 1, v16
    s_lshl_b32 s56, s65, 7
    v_add_u32 v31, s56, v31
    v_and_b32 v6, -4, v31
    v_lshlrev_b32 v6, 1, v6
    s_mul_i32 s56, s3, 1152
    s_mov_b32 s52, s4
    s_and_b32 s53, s5, 0xffff
    s_mov_b32 s54, 0x2400
    s_mov_b32 s55, 0x00020000
    buffer_load_ushort v29, v31, s[52:55], s56 offen
    s_mul_i32 s101, s3, 2304
    s_add_u32 s101, s101, 0x15000
    s_add_u32 s99, s101, 36864
    s_add_u32 s100, s101, 73728
    s_add_u32 s33, s101, 110592
    buffer_load_dwordx2 v[72:73], v6, s[36:39], s101 offen offset:0
    s_cmp_lg_u32 s3, s64
    s_cbranch_scc1 .rin_87
    buffer_load_dwordx4 v[32:35], v2, s[36:39], s99 offen offset:0
    buffer_load_dwordx4 v[40:43], v2, s[36:39], s99 offen offset:1024
    buffer_load_dwordx2 v[48:49], v5, s[36:39], s99 offen offset:0
    buffer_load_dwordx4 v[56:59], v2, s[36:39], s100 offen offset:0
    buffer_load_dwordx4 v[64:67], v2, s[36:39], s100 offen offset:1024
    buffer_load_dwordx2 v[50:51], v5, s[36:39], s100 offen offset:0
    buffer_load_dwordx2 v[74:75], v6, s[36:39], s99 offen offset:0
    buffer_load_dwordx2 v[80:81], v6, s[36:39], s100 offen offset:0
    buffer_load_dwordx2 v[82:83], v6, s[36:39], s33 offen offset:0
    s_mov_b32 s48, s16
    s_and_b32 s49, s17, 0xffff
    s_mov_b32 s50, 0x480
    s_mov_b32 s51, 0x00020000
    buffer_load_dwordx2 v[88:89], v3, s[48:51], 0 offen
    buffer_load_dwordx2 v[90:91], v3, s[48:51], 0 offen offset:512
    buffer_load_dword v30, v4, s[48:51], 0 offen
    s_mov_b32 s48, s28
    s_and_b32 s49, s29, 0xffff
    s_mov_b32 s50, 0x2400
    s_mov_b32 s51, 0x00020000
    buffer_load_ushort v17, v31, s[48:51], s56 offen nt
.rin_87:
    s_memrealtime s[8:9]
    s_waitcnt vmcnt(10)
    s_waitcnt lgkmcnt(0)
    s_sub_u32 s8, s8, s30
    s_cmpk_ge_u32 s8, 1660
    s_cbranch_scc1 .ap_88
    s_waitcnt vmcnt(7)
    s_cmpk_ge_u32 s8, 1595
    s_cbranch_scc1 .ap_88
    s_waitcnt vmcnt(5)
    s_bitcmp1_b64 s[14:15], 45
    s_cbranch_scc0 1
    s_waitcnt vmcnt(4)
    s_cmpk_ge_u32 s8, 1520
    s_cbranch_scc1 .ap_88
    s_waitcnt vmcnt(3)
.ap_88:
    s_add_u32 s63, s69, 172032
    buffer_load_dwordx4 v[212:215], v2, s[44:47], s63 offen nt
    s_memrealtime s[8:9]
    s_waitcnt vmcnt(10)
    s_waitcnt lgkmcnt(0)
    s_sub_u32 s8, s8, s30
    s_cmpk_ge_u32 s8, 1691
    s_cbranch_scc1 .ap_89
    s_waitcnt vmcnt(7)
    s_cmpk_ge_u32 s8, 1626
    s_cbranch_scc1 .ap_89
    s_waitcnt vmcnt(5)
    s_bitcmp1_b64 s[14:15], 46
    s_cbranch_scc0 1
    s_waitcnt vmcnt(4)
    s_cmpk_ge_u32 s8, 1551
    s_cbranch_scc1 .ap_89
    s_waitcnt vmcnt(3)
.ap_89:
    s_add_u32 s63, s69, 180224
    buffer_load_dwordx4 v[216:219], v2, s[44:47], s63 offen nt
    s_memrealtime s[8:9]
    s_waitcnt vmcnt(10)
    s_waitcnt lgkmcnt(0)
    s_sub_u32 s8, s8, s30
    s_cmpk_ge_u32 s8, 1722
    s_cbranch_scc1 .ap_90
    s_waitcnt vmcnt(7)
    s_cmpk_ge_u32 s8, 1657
    s_cbranch_scc1 .ap_90
    s_waitcnt vmcnt(5)
    s_bitcmp1_b64 s[14:15], 47
    s_cbranch_scc0 1
    s_waitcnt vmcnt(4)
    s_cmpk_ge_u32 s8, 1582
    s_cbranch_scc1 .ap_90
    s_waitcnt vmcnt(1)
.ap_90:
    s_add_u32 s63, s69, 188416
    buffer_load_dwordx4 v[220:223], v2, s[44:47], s63 offen nt
    s_memrealtime s[8:9]
    s_waitcnt vmcnt(10)
    s_waitcnt lgkmcnt(0)
    s_sub_u32 s8, s8, s30
    s_cmpk_ge_u32 s8, 1753
    s_cbranch_scc1 .ap_91
    s_waitcnt vmcnt(7)
    s_cmpk_ge_u32 s8, 1688
    s_cbranch_scc1 .ap_91
    s_waitcnt vmcnt(5)
    s_bitcmp1_b64 s[14:15], 48
    s_cbranch_scc0 1
    s_waitcnt vmcnt(2)
    s_cmpk_ge_u32 s8, 1613
    s_cbranch_scc1 .ap_91
    s_waitcnt vmcnt(1)
.ap_91:
    s_add_u32 s63, s69, 262144
    buffer_load_dwordx4 v[224:227], v2, s[44:47], s63 offen nt
    s_memrealtime s[8:9]
    s_waitcnt vmcnt(10)
    s_waitcnt lgkmcnt(0)
    s_sub_u32 s8, s8, s30
    s_cmpk_ge_u32 s8, 1784
    s_cbranch_scc1 .ap_92
    s_waitcnt vmcnt(7)
    s_cmpk_ge_u32 s8, 1719
    s_cbranch_scc1 .ap_92
    s_waitcnt vmcnt(3)
    s_bitcmp1_b64 s[14:15], 49
    s_cbranch_scc0 1
    s_waitcnt vmcnt(2)
    s_cmpk_ge_u32 s8, 1644
    s_cbranch_scc1 .ap_92
    s_waitcnt vmcnt(1)
.ap_92:
    s_add_u32 s63, s69, 270336
    buffer_load_dwordx4 v[228:231], v2, s[44:47], s63 offen nt
    s_memrealtime s[8:9]
    s_waitcnt vmcnt(10)
    s_waitcnt lgkmcnt(0)
    s_sub_u32 s8, s8, s30
    s_cmpk_ge_u32 s8, 1815
    s_cbranch_scc1 .ap_93
    s_waitcnt vmcnt(7)
    s_cmpk_ge_u32 s8, 1750
    s_cbranch_scc1 .ap_93
    s_waitcnt vmcnt(3)
    s_bitcmp1_b64 s[14:15], 50
    s_cbranch_scc0 1
    s_waitcnt vmcnt(2)
    s_cmpk_ge_u32 s8, 1675
    s_cbranch_scc1 .ap_93
    s_waitcnt vmcnt(1)
.ap_93:
    s_add_u32 s63, s69, 278528
    buffer_load_dwordx4 v[232:235], v2, s[44:47], s63 offen nt
    s_memrealtime s[8:9]
    s_waitcnt vmcnt(10)
    s_waitcnt lgkmcnt(0)
    s_sub_u32 s8, s8, s30
    s_cmpk_ge_u32 s8, 1846
    s_cbranch_scc1 .ap_94
    s_waitcnt vmcnt(5)
    s_cmpk_ge_u32 s8, 1781
    s_cbranch_scc1 .ap_94
    s_waitcnt vmcnt(3)
    s_bitcmp1_b64 s[14:15], 51
    s_cbranch_scc0 1
    s_waitcnt vmcnt(2)
    s_cmpk_ge_u32 s8, 1706
    s_cbranch_scc1 .ap_94
    s_waitcnt vmcnt(1)
.ap_94:
    s_add_u32 s63, s69, 286720
    buffer_load_dwordx4 v[236:239], v2, s[44:47], s63 offen nt
    s_memrealtime s[8:9]
    s_waitcnt vmcnt(10)
    s_waitcnt lgkmcnt(0)
    s_sub_u32 s8, s8, s30
    s_cmpk_ge_u32 s8, 1877
    s_cbranch_scc1 .ap_95
    s_waitcnt vmcnt(5)
    s_cmpk_ge_u32 s8, 1812
    s_cbranch_scc1 .ap_95
    s_waitcnt vmcnt(3)
    s_bitcmp1_b64 s[14:15], 52
    s_cbranch_scc0 1
    s_waitcnt vmcnt(2)
    s_cmpk_ge_u32 s8, 1737
    s_cbranch_scc1 .ap_95
    s_waitcnt vmcnt(1)
.ap_95:
    s_add_u32 s63, s69, 294912
    buffer_load_dwordx4 v[240:243], v2, s[44:47], s63 offen nt
    s_memrealtime s[8:9]
    s_waitcnt vmcnt(10)
    s_waitcnt lgkmcnt(0)
    s_sub_u32 s8, s8, s30
    s_cmpk_ge_u32 s8, 1908
    s_cbranch_scc1 .ap_96
    s_waitcnt vmcnt(5)
    s_cmpk_ge_u32 s8, 1843
    s_cbranch_scc1 .ap_96
    s_waitcnt vmcnt(3)
    s_bitcmp1_b64 s[14:15], 53
    s_cbranch_scc0 1
    s_waitcnt vmcnt(2)
    s_cmpk_ge_u32 s8, 1768
    s_cbranch_scc1 .ap_96
    s_waitcnt vmcnt(1)
.ap_96:
    s_add_u32 s63, s69, 303104
    buffer_load_dwordx4 v[244:247], v2, s[44:47], s63 offen nt
    s_load_dwordx2 s[88:89], s[6:7], s0
    buffer_load_dwordx4 v[24:27], v9, s[36:39], s59 offen offset:0 sc1
    s_memrealtime s[8:9]
    s_waitcnt vmcnt(8)
    s_waitcnt lgkmcnt(0)
    s_sub_u32 s8, s8, s30
    s_cmpk_ge_u32 s8, 1939
    s_cbranch_scc1 .ap_97
    s_waitcnt vmcnt(5)
    s_cmpk_ge_u32 s8, 1874
    s_cbranch_scc1 .ap_97
    s_waitcnt vmcnt(3)
    s_bitcmp1_b64 s[14:15], 54
    s_cbranch_scc0 1
    s_waitcnt vmcnt(2)
    s_cmpk_ge_u32 s8, 1799
    s_cbranch_scc1 .ap_97
    s_waitcnt vmcnt(1)
.ap_97:
    s_add_u32 s63, s69, 311296
    buffer_load_dwordx4 v[248:251], v2, s[44:47], s63 offen nt
    s_memrealtime s[8:9]
    s_waitcnt vmcnt(8)
    s_waitcnt lgkmcnt(0)
    s_sub_u32 s8, s8, s30
    s_cmpk_ge_u32 s8, 1970
    s_cbranch_scc1 .ap_98
    s_waitcnt vmcnt(5)
    s_cmpk_ge_u32 s8, 1905
    s_cbranch_scc1 .ap_98
    s_waitcnt vmcnt(3)
    s_bitcmp1_b64 s[14:15], 55
    s_cbranch_scc0 1
    s_waitcnt vmcnt(2)
    s_cmpk_ge_u32 s8, 1830
    s_cbranch_scc1 .ap_98
    s_waitcnt vmcnt(1)
.ap_98:
    s_add_u32 s63, s69, 319488
    buffer_load_dwordx4 v[252:255], v2, s[44:47], s63 offen nt
    s_memrealtime s[8:9]
    s_waitcnt vmcnt(8)
    s_waitcnt lgkmcnt(0)
    s_sub_u32 s8, s8, s30
    s_cmpk_ge_u32 s8, 2001
    s_cbranch_scc1 .ap_99
    s_waitcnt vmcnt(5)
    s_cmpk_ge_u32 s8, 1936
    s_cbranch_scc1 .ap_99
    s_waitcnt vmcnt(3)
    s_bitcmp1_b64 s[14:15], 56
    s_cbranch_scc0 1
    s_waitcnt vmcnt(2)
    s_cmpk_ge_u32 s8, 1861
    s_cbranch_scc1 .ap_99
    s_waitcnt vmcnt(1)
.ap_99:
    s_add_u32 s63, s69, 393216
    buffer_load_dwordx4 v[36:39], v2, s[44:47], s63 offen nt
    s_memrealtime s[8:9]
    s_waitcnt vmcnt(8)
    s_waitcnt lgkmcnt(0)
    s_sub_u32 s8, s8, s30
    s_cmpk_ge_u32 s8, 2032
    s_cbranch_scc1 .ap_100
    s_waitcnt vmcnt(5)
    s_cmpk_ge_u32 s8, 1967
    s_cbranch_scc1 .ap_100
    s_waitcnt vmcnt(3)
    s_bitcmp1_b64 s[14:15], 57
    s_cbranch_scc0 1
    s_waitcnt vmcnt(2)
    s_cmpk_ge_u32 s8, 1892
    s_cbranch_scc1 .ap_100
    s_waitcnt vmcnt(1)
.ap_100:
    s_add_u32 s63, s69, 401408
    buffer_load_dwordx4 v[44:47], v2, s[44:47], s63 offen nt
    s_memrealtime s[8:9]
    s_waitcnt vmcnt(8)
    s_waitcnt lgkmcnt(0)
    s_sub_u32 s8, s8, s30
    s_cmpk_ge_u32 s8, 2063
    s_cbranch_scc1 .ap_101
    s_waitcnt vmcnt(5)
    s_cmpk_ge_u32 s8, 1998
    s_cbranch_scc1 .ap_101
    s_waitcnt vmcnt(3)
    s_bitcmp1_b64 s[14:15], 58
    s_cbranch_scc0 1
    s_waitcnt vmcnt(2)
    s_cmpk_ge_u32 s8, 1923
    s_cbranch_scc1 .ap_101
    s_waitcnt vmcnt(1)
.ap_101:
    s_add_u32 s63, s69, 409600
    buffer_load_dwordx4 v[52:55], v2, s[44:47], s63 offen nt
    s_waitcnt vmcnt(5)
    s_branch .gpc_103
.gp_102:
    buffer_load_dwordx4 v[24:27], v9, s[36:39], s59 offen offset:0 sc1
    s_waitcnt vmcnt(0)
.gpc_103:
    v_cmp_eq_u32 vcc, s34, v26
    v_cmp_eq_u32 s[56:57], s34, v27
    s_and_b64 vcc, vcc, s[56:57]
    s_cmp_eq_u64 vcc, exec
    s_nop 2
    s_cbranch_scc1 .gpd_104
    s_sub_u32 s35, s35, 1
    s_cbranch_scc1 .Lexit
    s_sleep 1
    s_branch .gp_102
.gpd_104:
    s_lshr_b64 s[88:89], s[88:89], s1
    s_and_b32 s88, s88, 0xff
    s_cmp_eq_u32 s88, 32
    s_cselect_b32 s0, 0xac000, 0
    v_mov_b32 v16, v24
    s_nop 1
    v_max_f32_dpp v16, v16, v16 quad_perm:[2,3,0,1] row_mask:0xf bank_mask:0xf
    v_sub_f32 v17, v24, v16
    v_sub_f32 v18, v14, v16
    v_mul_f32 v17, 0x3fb8aa3b, v17
    v_mul_f32 v18, 0x3fb8aa3b, v18
    v_exp_f32 v17, v17
    v_exp_f32 v18, v18
    v_mul_f32 v17, v17, v25
    s_nop 1
    v_add_f32_dpp v17, v17, v17 quad_perm:[2,3,0,1] row_mask:0xf bank_mask:0xf
    v_rcp_f32 v19, v17
    s_nop 0
    v_fma_f32 v15, -v17, v19, 1.0
    v_fma_f32 v19, v15, v19, v19
    v_mul_f32 v18, v18, v19
    v_mul_f32 v10, v10, v18
    v_mul_f32 v11, v11, v18
    v_mul_f32 v12, v12, v18
    v_mul_f32 v13, v13, v18
    v_mov_b32_dpp v112, v10 quad_perm:[2,3,0,1] row_mask:0xf bank_mask:0xf
    v_mov_b32_dpp v113, v11 quad_perm:[2,3,0,1] row_mask:0xf bank_mask:0xf
    v_mov_b32_dpp v114, v12 quad_perm:[2,3,0,1] row_mask:0xf bank_mask:0xf
    v_mov_b32_dpp v115, v13 quad_perm:[2,3,0,1] row_mask:0xf bank_mask:0xf
    v_cvt_pk_bf16_f32 v96, v10, v112
    v_cvt_pk_bf16_f32 v100, v11, v113
    v_cvt_pk_bf16_f32 v104, v12, v114
    v_cvt_pk_bf16_f32 v108, v13, v115
    v_mov_b32_dpp v97, v96 row_ror:12 row_mask:0xf bank_mask:0xf
    v_mov_b32_dpp v101, v100 row_ror:12 row_mask:0xf bank_mask:0xf
    v_mov_b32_dpp v105, v104 row_ror:12 row_mask:0xf bank_mask:0xf
    v_mov_b32_dpp v109, v108 row_ror:12 row_mask:0xf bank_mask:0xf
    v_mov_b32_dpp v98, v96 row_ror:8 row_mask:0xf bank_mask:0xf
    v_mov_b32_dpp v102, v100 row_ror:8 row_mask:0xf bank_mask:0xf
    v_mov_b32_dpp v106, v104 row_ror:8 row_mask:0xf bank_mask:0xf
    v_mov_b32_dpp v110, v108 row_ror:8 row_mask:0xf bank_mask:0xf
    v_mov_b32_dpp v99, v96 row_ror:4 row_mask:0xf bank_mask:0xf
    v_mov_b32_dpp v103, v100 row_ror:4 row_mask:0xf bank_mask:0xf
    v_mov_b32_dpp v107, v104 row_ror:4 row_mask:0xf bank_mask:0xf
    v_mov_b32_dpp v111, v108 row_ror:4 row_mask:0xf bank_mask:0xf
    v_mov_b32_dpp v96, v96 row_shr:3 row_mask:0xf bank_mask:0x2
    v_mov_b32_dpp v97, v97 row_shr:3 row_mask:0xf bank_mask:0x2
    v_mov_b32_dpp v98, v98 row_shr:3 row_mask:0xf bank_mask:0x2
    v_mov_b32_dpp v99, v99 row_shr:3 row_mask:0xf bank_mask:0x2
    v_mov_b32_dpp v100, v100 row_shr:3 row_mask:0xf bank_mask:0x2
    v_mov_b32_dpp v101, v101 row_shr:3 row_mask:0xf bank_mask:0x2
    v_mov_b32_dpp v102, v102 row_shr:3 row_mask:0xf bank_mask:0x2
    v_mov_b32_dpp v103, v103 row_shr:3 row_mask:0xf bank_mask:0x2
    v_mov_b32_dpp v104, v104 row_shr:3 row_mask:0xf bank_mask:0x2
    v_mov_b32_dpp v105, v105 row_shr:3 row_mask:0xf bank_mask:0x2
    v_mov_b32_dpp v106, v106 row_shr:3 row_mask:0xf bank_mask:0x2
    v_mov_b32_dpp v107, v107 row_shr:3 row_mask:0xf bank_mask:0x2
    v_mov_b32_dpp v108, v108 row_shr:3 row_mask:0xf bank_mask:0x2
    v_mov_b32_dpp v109, v109 row_shr:3 row_mask:0xf bank_mask:0x2
    v_mov_b32_dpp v110, v110 row_shr:3 row_mask:0xf bank_mask:0x2
    v_mov_b32_dpp v111, v111 row_shr:3 row_mask:0xf bank_mask:0x2
    s_memrealtime s[8:9]
    s_waitcnt lgkmcnt(0)
    s_sub_u32 s8, s8, s30
    s_cmpk_ge_u32 s8, 2094
    s_cbranch_scc1 .ap_105
    s_waitcnt vmcnt(5)
    s_cmpk_ge_u32 s8, 2029
    s_cbranch_scc1 .ap_105
    s_waitcnt vmcnt(3)
    s_bitcmp1_b64 s[14:15], 59
    s_cbranch_scc0 1
    s_waitcnt vmcnt(2)
    s_cmpk_ge_u32 s8, 1954
    s_cbranch_scc1 .ap_105
    s_waitcnt vmcnt(1)
.ap_105:
    s_add_u32 s63, s69, 417792
    buffer_load_dwordx4 v[60:63], v2, s[44:47], s63 offen nt
    s_lshl_b32 s60, s3, 10
    s_add_u32 s60, s60, 132096
    v_lshlrev_b32 v10, 5, v0
    v_add_u32 v10, s60, v10
    v_lshrrev_b32 v11, 5, v0
    v_lshlrev_b32 v11, 13, v11
    v_and_b32 v12, 31, v0
    v_lshl_add_u32 v11, v12, 4, v11
    v_add_u32 v9, 132096, v2
    v_mov_b32 v15, s34
    v_lshrrev_b32 v25, 4, v0
    v_bfe_u32 v26, v0, 2, 2
    v_lshl_add_u32 v16, v25, 3, v26
    v_lshlrev_b32 v16, 7, v16
    v_and_b32 v25, 1, v25
    v_lshrrev_b32 v26, 1, v26
    v_lshl_add_u32 v25, v25, 1, v26
    s_and_b32 s56, s3, 1
    s_lshl_b32 s56, s56, 1
    v_xor_b32 v25, s56, v25
    v_and_b32 v26, 3, v0
    v_lshl_add_u32 v16, v26, 3, v16
    s_lshr_b32 s56, s3, 1
    s_mul_i32 s56, s56, 16384
    v_add_u32 v16, s56, v16
    v_xor_b32 v26, 1, v25
    v_lshl_add_u32 v17, v26, 5, v16
    v_lshl_add_u32 v16, v25, 5, v16
    v_bfe_u32 v25, v0, 1, 3
    v_mul_u32_u24 v19, 1312, v25
    v_mul_u32_u24 v20, 272, v25
    v_and_b32 v25, 48, v0
    s_lshr_b32 s56, s3, 1
    s_mul_i32 s57, s56, 256
    s_add_u32 s57, s57, 147456
    v_add3_u32 v19, v19, v25, s57
    s_mul_i32 s56, s56, 2176
    s_and_b32 s57, s3, 1
    s_lshl_b32 s57, s57, 7
    s_add_u32 s56, s56, s57
    s_add_u32 s56, s56, 122880
    v_add3_u32 v20, v20, v25, s56
    v_and_b32 v25, 1, v0
    v_lshl_add_u32 v20, v25, 6, v20
    v_and_b32 v25, 15, v0
    s_mul_i32 s56, s3, 272
    s_add_u32 s56, s56, 122880
    v_lshl_add_u32 v21, v25, 4, s56
    s_mul_i32 s56, s3, 1312
    s_add_u32 s56, s56, 147456
    v_add_u32 v18, s56, v3
    v_add_u32 v7, 16384, v11
    s_nop 1
    s_branch .gpc_107
.gp_106:
    buffer_load_dwordx2 v[72:73], v6, s[36:39], s101 offen offset:0 sc1
    s_waitcnt vmcnt(0)
.gpc_107:
    v_cmp_eq_u32 vcc, s34, v73
    s_cmp_eq_u64 vcc, exec
    s_nop 3
    s_cbranch_scc1 .gpd_108
    s_sub_u32 s35, s35, 1
    s_cbranch_scc1 .Lexit
    s_sleep 2
    s_branch .gp_106
.gpd_108:
    v_lshlrev_b32 v23, 16, v72
    v_and_b32 v72, 0xffff0000, v72
    s_mov_b32 vcc_lo, 0xffff0000
    s_mov_b32 vcc_hi, 0xffff0000
    v_cndmask_b32 v23, v23, v72, vcc
    v_lshlrev_b32 v29, 16, v29
    s_memrealtime s[8:9]
    s_waitcnt lgkmcnt(0)
    s_sub_u32 s8, s8, s30
    s_cmpk_ge_u32 s8, 2125
    s_cbranch_scc1 .ap_109
    s_waitcnt vmcnt(5)
    s_cmpk_ge_u32 s8, 2060
    s_cbranch_scc1 .ap_109
    s_waitcnt vmcnt(3)
    s_bitcmp1_b64 s[14:15], 60
    s_cbranch_scc0 1
    s_waitcnt vmcnt(2)
    s_cmpk_ge_u32 s8, 1985
    s_cbranch_scc1 .ap_109
    s_waitcnt vmcnt(1)
.ap_109:
    s_add_u32 s63, s69, 425984
    buffer_load_dwordx4 v[68:71], v2, s[44:47], s63 offen nt
    v_perm_b32 v112, v164, v160, s94
    v_perm_b32 v113, v172, v168, s94
    v_perm_b32 v114, v180, v176, s94
    v_perm_b32 v115, v188, v184, s94
    s_nop 1
    v_mfma_f32_16x16x32_bf16 v[128:131], v[96:99], v[112:115], 0
    v_perm_b32 v116, v164, v160, s95
    v_perm_b32 v117, v172, v168, s95
    v_perm_b32 v118, v180, v176, s95
    v_perm_b32 v119, v188, v184, s95
    s_nop 1
    v_mfma_f32_16x16x32_bf16 v[132:135], v[96:99], v[116:119], 0
    v_perm_b32 v120, v165, v161, s94
    v_perm_b32 v121, v173, v169, s94
    v_perm_b32 v122, v181, v177, s94
    v_perm_b32 v123, v189, v185, s94
    s_nop 1
    v_mfma_f32_16x16x32_bf16 v[136:139], v[96:99], v[120:123], 0
    v_perm_b32 v124, v165, v161, s95
    v_perm_b32 v125, v173, v169, s95
    v_perm_b32 v126, v181, v177, s95
    v_perm_b32 v127, v189, v185, s95
    s_nop 1
    v_mfma_f32_16x16x32_bf16 v[140:143], v[96:99], v[124:127], 0
    v_perm_b32 v112, v166, v162, s94
    v_perm_b32 v113, v174, v170, s94
    v_perm_b32 v114, v182, v178, s94
    v_perm_b32 v115, v190, v186, s94
    s_nop 1
    v_mfma_f32_16x16x32_bf16 v[144:147], v[96:99], v[112:115], 0
    v_perm_b32 v116, v166, v162, s95
    v_perm_b32 v117, v174, v170, s95
    v_perm_b32 v118, v182, v178, s95
    v_perm_b32 v119, v190, v186, s95
    s_nop 1
    v_mfma_f32_16x16x32_bf16 v[148:151], v[96:99], v[116:119], 0
    v_perm_b32 v120, v167, v163, s94
    v_perm_b32 v121, v175, v171, s94
    v_perm_b32 v122, v183, v179, s94
    v_perm_b32 v123, v191, v187, s94
    s_nop 1
    v_mfma_f32_16x16x32_bf16 v[152:155], v[96:99], v[120:123], 0
    v_perm_b32 v124, v167, v163, s95
    v_perm_b32 v125, v175, v171, s95
    v_perm_b32 v126, v183, v179, s95
    v_perm_b32 v127, v191, v187, s95
    s_nop 1
    v_mfma_f32_16x16x32_bf16 v[156:159], v[96:99], v[124:127], 0
    s_memrealtime s[8:9]
    s_waitcnt lgkmcnt(0)
    s_sub_u32 s8, s8, s30
    s_cmpk_ge_u32 s8, 2156
    s_nop 3
    s_cbranch_scc1 .ap_110
    s_waitcnt vmcnt(5)
    s_cmpk_ge_u32 s8, 2091
    s_cbranch_scc1 .ap_110
    s_waitcnt vmcnt(3)
    s_bitcmp1_b64 s[14:15], 61
    s_cbranch_scc0 1
    s_waitcnt vmcnt(2)
    s_cmpk_ge_u32 s8, 2016
    s_cbranch_scc1 .ap_110
    s_waitcnt vmcnt(1)
.ap_110:
    s_add_u32 s63, s69, 434176
    buffer_load_dwordx4 v[76:79], v2, s[44:47], s63 offen nt
    v_perm_b32 v112, v196, v192, s94
    v_perm_b32 v113, v204, v200, s94
    v_perm_b32 v114, v212, v208, s94
    v_perm_b32 v115, v220, v216, s94
    s_nop 1
    v_mfma_f32_16x16x32_bf16 v[128:131], v[100:103], v[112:115], v[128:131]
    v_perm_b32 v116, v196, v192, s95
    v_perm_b32 v117, v204, v200, s95
    v_perm_b32 v118, v212, v208, s95
    v_perm_b32 v119, v220, v216, s95
    s_nop 1
    v_mfma_f32_16x16x32_bf16 v[132:135], v[100:103], v[116:119], v[132:135]
    v_perm_b32 v120, v197, v193, s94
    v_perm_b32 v121, v205, v201, s94
    v_perm_b32 v122, v213, v209, s94
    v_perm_b32 v123, v221, v217, s94
    s_nop 1
    v_mfma_f32_16x16x32_bf16 v[136:139], v[100:103], v[120:123], v[136:139]
    v_perm_b32 v124, v197, v193, s95
    v_perm_b32 v125, v205, v201, s95
    v_perm_b32 v126, v213, v209, s95
    v_perm_b32 v127, v221, v217, s95
    s_nop 1
    v_mfma_f32_16x16x32_bf16 v[140:143], v[100:103], v[124:127], v[140:143]
    v_perm_b32 v112, v198, v194, s94
    v_perm_b32 v113, v206, v202, s94
    v_perm_b32 v114, v214, v210, s94
    v_perm_b32 v115, v222, v218, s94
    s_nop 1
    v_mfma_f32_16x16x32_bf16 v[144:147], v[100:103], v[112:115], v[144:147]
    v_perm_b32 v116, v198, v194, s95
    v_perm_b32 v117, v206, v202, s95
    v_perm_b32 v118, v214, v210, s95
    v_perm_b32 v119, v222, v218, s95
    s_nop 1
    v_mfma_f32_16x16x32_bf16 v[148:151], v[100:103], v[116:119], v[148:151]
    v_perm_b32 v120, v199, v195, s94
    v_perm_b32 v121, v207, v203, s94
    v_perm_b32 v122, v215, v211, s94
    v_perm_b32 v123, v223, v219, s94
    s_nop 1
    v_mfma_f32_16x16x32_bf16 v[152:155], v[100:103], v[120:123], v[152:155]
    v_perm_b32 v124, v199, v195, s95
    v_perm_b32 v125, v207, v203, s95
    v_perm_b32 v126, v215, v211, s95
    v_perm_b32 v127, v223, v219, s95
    s_nop 1
    v_mfma_f32_16x16x32_bf16 v[156:159], v[100:103], v[124:127], v[156:159]
    s_memrealtime s[8:9]
    s_waitcnt lgkmcnt(0)
    s_sub_u32 s8, s8, s30
    s_cmpk_ge_u32 s8, 2187
    s_nop 3
    s_cbranch_scc1 .ap_111
    s_waitcnt vmcnt(5)
    s_cmpk_ge_u32 s8, 2122
    s_cbranch_scc1 .ap_111
    s_waitcnt vmcnt(3)
    s_bitcmp1_b64 s[14:15], 62
    s_cbranch_scc0 1
    s_waitcnt vmcnt(2)
    s_cmpk_ge_u32 s8, 2047
    s_cbranch_scc1 .ap_111
    s_waitcnt vmcnt(1)
.ap_111:
    s_add_u32 s63, s69, 442368
    buffer_load_dwordx4 v[84:87], v2, s[44:47], s63 offen nt
    s_waitcnt vmcnt(7)
    v_perm_b32 v112, v228, v224, s94
    v_perm_b32 v113, v236, v232, s94
    v_perm_b32 v114, v244, v240, s94
    v_perm_b32 v115, v252, v248, s94
    s_nop 1
    v_mfma_f32_16x16x32_bf16 v[128:131], v[104:107], v[112:115], v[128:131]
    v_perm_b32 v116, v228, v224, s95
    v_perm_b32 v117, v236, v232, s95
    v_perm_b32 v118, v244, v240, s95
    v_perm_b32 v119, v252, v248, s95
    s_nop 1
    v_mfma_f32_16x16x32_bf16 v[132:135], v[104:107], v[116:119], v[132:135]
    v_perm_b32 v120, v229, v225, s94
    v_perm_b32 v121, v237, v233, s94
    v_perm_b32 v122, v245, v241, s94
    v_perm_b32 v123, v253, v249, s94
    s_nop 1
    v_mfma_f32_16x16x32_bf16 v[136:139], v[104:107], v[120:123], v[136:139]
    v_perm_b32 v124, v229, v225, s95
    v_perm_b32 v125, v237, v233, s95
    v_perm_b32 v126, v245, v241, s95
    v_perm_b32 v127, v253, v249, s95
    s_nop 1
    v_mfma_f32_16x16x32_bf16 v[140:143], v[104:107], v[124:127], v[140:143]
    v_perm_b32 v112, v230, v226, s94
    v_perm_b32 v113, v238, v234, s94
    v_perm_b32 v114, v246, v242, s94
    v_perm_b32 v115, v254, v250, s94
    s_nop 1
    v_mfma_f32_16x16x32_bf16 v[144:147], v[104:107], v[112:115], v[144:147]
    v_perm_b32 v116, v230, v226, s95
    v_perm_b32 v117, v238, v234, s95
    v_perm_b32 v118, v246, v242, s95
    v_perm_b32 v119, v254, v250, s95
    s_nop 1
    v_mfma_f32_16x16x32_bf16 v[148:151], v[104:107], v[116:119], v[148:151]
    v_perm_b32 v120, v231, v227, s94
    v_perm_b32 v121, v239, v235, s94
    v_perm_b32 v122, v247, v243, s94
    v_perm_b32 v123, v255, v251, s94
    s_nop 1
    v_mfma_f32_16x16x32_bf16 v[152:155], v[104:107], v[120:123], v[152:155]
    v_perm_b32 v124, v231, v227, s95
    v_perm_b32 v125, v239, v235, s95
    v_perm_b32 v126, v247, v243, s95
    v_perm_b32 v127, v255, v251, s95
    s_nop 1
    v_mfma_f32_16x16x32_bf16 v[156:159], v[104:107], v[124:127], v[156:159]
    s_memrealtime s[8:9]
    s_waitcnt lgkmcnt(0)
    s_sub_u32 s8, s8, s30
    s_cmpk_ge_u32 s8, 2218
    s_nop 3
    s_cbranch_scc1 .ap_112
    s_waitcnt vmcnt(5)
    s_cmpk_ge_u32 s8, 2153
    s_cbranch_scc1 .ap_112
    s_waitcnt vmcnt(3)
    s_bitcmp1_b64 s[14:15], 63
    s_cbranch_scc0 1
    s_waitcnt vmcnt(2)
    s_cmpk_ge_u32 s8, 2078
    s_cbranch_scc1 .ap_112
    s_waitcnt vmcnt(1)
.ap_112:
    s_add_u32 s63, s69, 450560
    buffer_load_dwordx4 v[92:95], v2, s[44:47], s63 offen nt
    s_setprio 0
    s_waitcnt vmcnt(6)
    v_perm_b32 v160, v44, v36, s94
    v_perm_b32 v164, v44, v36, s95
    v_perm_b32 v168, v45, v37, s94
    v_perm_b32 v172, v45, v37, s95
    v_perm_b32 v176, v46, v38, s94
    v_perm_b32 v180, v46, v38, s95
    v_perm_b32 v184, v47, v39, s94
    v_perm_b32 v188, v47, v39, s95
    s_waitcnt vmcnt(4)
    v_perm_b32 v161, v60, v52, s94
    v_perm_b32 v165, v60, v52, s95
    v_perm_b32 v169, v61, v53, s94
    v_perm_b32 v173, v61, v53, s95
    v_perm_b32 v177, v62, v54, s94
    v_perm_b32 v181, v62, v54, s95
    v_perm_b32 v185, v63, v55, s94
    v_perm_b32 v189, v63, v55, s95
    v_mfma_f32_16x16x16_bf16 v[128:131], v[108:109], v[160:161], v[128:131]
    v_mfma_f32_16x16x16_bf16 v[132:135], v[108:109], v[164:165], v[132:135]
    v_mfma_f32_16x16x16_bf16 v[136:139], v[108:109], v[168:169], v[136:139]
    v_mfma_f32_16x16x16_bf16 v[140:143], v[108:109], v[172:173], v[140:143]
    v_mfma_f32_16x16x16_bf16 v[144:147], v[108:109], v[176:177], v[144:147]
    v_mfma_f32_16x16x16_bf16 v[148:151], v[108:109], v[180:181], v[148:151]
    v_mfma_f32_16x16x16_bf16 v[152:155], v[108:109], v[184:185], v[152:155]
    v_mfma_f32_16x16x16_bf16 v[156:159], v[108:109], v[188:189], v[156:159]
    s_waitcnt vmcnt(2)
    v_perm_b32 v162, v76, v68, s94
    v_perm_b32 v166, v76, v68, s95
    v_perm_b32 v170, v77, v69, s94
    v_perm_b32 v174, v77, v69, s95
    v_perm_b32 v178, v78, v70, s94
    v_perm_b32 v182, v78, v70, s95
    v_perm_b32 v186, v79, v71, s94
    v_perm_b32 v190, v79, v71, s95
    s_lshl4_add_u32 s59, s67, s66
    s_lshl1_add_u32 s59, s59, s68
    s_lshl_b32 s59, s59, 9
    s_add_u32 s59, s59, 0x210000
    s_mov_b32 s60, 0x07060503
    s_mov_b32 s61, 0x07060502
    s_mov_b32 s62, 0x07060501
.Ltail_ar:
    s_waitcnt vmcnt(0)
    v_perm_b32 v163, v92, v84, s94
    v_perm_b32 v167, v92, v84, s95
    v_perm_b32 v171, v93, v85, s94
    v_perm_b32 v175, v93, v85, s95
    v_perm_b32 v179, v94, v86, s94
    v_perm_b32 v183, v94, v86, s95
    v_perm_b32 v187, v95, v87, s94
    v_perm_b32 v191, v95, v87, s95
    v_mfma_f32_16x16x16_bf16 v[128:131], v[110:111], v[162:163], v[128:131]
    v_mfma_f32_16x16x16_bf16 v[132:135], v[110:111], v[166:167], v[132:135]
    v_mfma_f32_16x16x16_bf16 v[136:139], v[110:111], v[170:171], v[136:139]
    v_mfma_f32_16x16x16_bf16 v[140:143], v[110:111], v[174:175], v[140:143]
    v_mfma_f32_16x16x16_bf16 v[144:147], v[110:111], v[178:179], v[144:147]
    v_mfma_f32_16x16x16_bf16 v[148:151], v[110:111], v[182:183], v[148:151]
    v_mfma_f32_16x16x16_bf16 v[152:155], v[110:111], v[186:187], v[152:155]
    v_mfma_f32_16x16x16_bf16 v[156:159], v[110:111], v[190:191], v[156:159]
    s_mov_b64 exec, 0xffffffff
    s_nop 0
    ds_write2_b32 v10, v128, v132 offset0:0 offset1:1
    s_nop 0
    ds_write2_b32 v10, v136, v140 offset0:2 offset1:3
    s_nop 0
    ds_write2_b32 v10, v144, v148 offset0:4 offset1:5
    s_nop 0
    ds_write2_b32 v10, v152, v156 offset0:6 offset1:7
    s_mov_b64 exec, -1
    s_waitcnt lgkmcnt(0)
    s_barrier
    s_cmp_lg_u32 s3, 7
    s_cbranch_scc1 .opub_113
    ds_read_b128 v[196:199], v9 offset:0
    ds_read_b128 v[200:203], v9 offset:1024
    ds_read_b128 v[204:207], v9 offset:2048
    ds_read_b128 v[208:211], v9 offset:3072
    ds_read_b128 v[212:215], v9 offset:4096
    ds_read_b128 v[216:219], v9 offset:5120
    ds_read_b128 v[220:223], v9 offset:6144
    ds_read_b128 v[224:227], v9 offset:7168
    s_waitcnt lgkmcnt(6)
    v_pk_add_f32 v[196:197], v[196:197], v[200:201]
    v_pk_add_f32 v[198:199], v[198:199], v[202:203]
    s_waitcnt lgkmcnt(4)
    v_pk_add_f32 v[204:205], v[204:205], v[208:209]
    v_pk_add_f32 v[206:207], v[206:207], v[210:211]
    v_pk_add_f32 v[196:197], v[196:197], v[204:205]
    v_pk_add_f32 v[198:199], v[198:199], v[206:207]
    s_waitcnt lgkmcnt(2)
    v_pk_add_f32 v[212:213], v[212:213], v[216:217]
    v_pk_add_f32 v[214:215], v[214:215], v[218:219]
    s_waitcnt lgkmcnt(0)
    v_pk_add_f32 v[220:221], v[220:221], v[224:225]
    v_pk_add_f32 v[222:223], v[222:223], v[226:227]
    v_pk_add_f32 v[212:213], v[212:213], v[220:221]
    v_pk_add_f32 v[214:215], v[214:215], v[222:223]
    v_pk_add_f32 v[196:197], v[196:197], v[212:213]
    v_pk_add_f32 v[198:199], v[198:199], v[214:215]
    v_perm_b32 v12, v196, v199, s60
    v_perm_b32 v13, v197, v199, s61
    v_perm_b32 v14, v198, v199, s62
    s_add_u32 s57, s59, 0xac000
    buffer_store_dwordx4 v[12:15], v11, s[36:39], s57 offen
    buffer_store_dwordx4 v[12:15], v11, s[36:39], s59 offen sc1
.opub_113:
    ds_read_b64_tr_b16 v[160:161], v16 offset:0
    ds_read_b64_tr_b16 v[162:163], v16 offset:512
    ds_read_b64_tr_b16 v[176:177], v17 offset:0
    ds_read_b64_tr_b16 v[178:179], v17 offset:512
    ds_read_b64_tr_b16 v[164:165], v16 offset:4096
    ds_read_b64_tr_b16 v[166:167], v16 offset:4608
    ds_read_b64_tr_b16 v[180:181], v17 offset:4096
    ds_read_b64_tr_b16 v[182:183], v17 offset:4608
    ds_read_b64_tr_b16 v[168:169], v16 offset:8192
    ds_read_b64_tr_b16 v[170:171], v16 offset:8704
    ds_read_b64_tr_b16 v[184:185], v17 offset:8192
    ds_read_b64_tr_b16 v[186:187], v17 offset:8704
    ds_read_b64_tr_b16 v[172:173], v16 offset:12288
    ds_read_b64_tr_b16 v[174:175], v16 offset:12800
    ds_read_b64_tr_b16 v[188:189], v17 offset:12288
    ds_read_b64_tr_b16 v[190:191], v17 offset:12800
    s_lshl_b32 s59, s64, 5
    s_add_u32 s59, s59, s3
    s_lshl_b32 s59, s59, 10
    s_add_u32 s59, s59, 0x210000
    s_mov_b32 s60, 0x04000c0c
    s_mov_b32 s61, 0x0706000c
    v_mov_b32 v143, s34
    s_mul_i32 s40, s3, 9
    s_add_u32 s40, s40, s65
    s_lshl_b32 s40, s40, 11
    s_add_u32 s41, s40, 0x368000
    s_lshl_b32 s63, s64, 8
    s_add_u32 s63, s63, s41
    s_mul_i32 s101, s64, 18432
    s_mul_i32 s56, s3, 2304
    s_add_u32 s101, s101, s56
    s_add_u32 s101, s101, 0x250000
    s_lshl_b32 s42, s65, 8
    s_add_u32 s42, s42, s101
    v_mov_b32 v253, s34
    v_mov_b32 v255, s34
    s_add_u32 s58, s59, s0
    s_mov_b32 s32, 0
    s_mov_b64 s[88:89], exec
    s_mov_b64 s[90:91], exec
    s_mov_b64 s[92:93], exec
    s_mov_b64 s[56:57], exec
.mp_114:
    s_mov_b64 exec, s[88:89]
    buffer_load_dwordx4 v[192:195], v11, s[36:39], s58 offen offset:0 sc1
    s_mov_b64 exec, s[90:91]
    buffer_load_dwordx4 v[196:199], v11, s[36:39], s58 offen offset:512 sc1
    s_mov_b64 exec, s[92:93]
    buffer_load_dwordx4 v[200:203], v7, s[36:39], s58 offen offset:0 sc1
    s_mov_b64 exec, s[56:57]
    buffer_load_dwordx4 v[204:207], v7, s[36:39], s58 offen offset:512 sc1
    s_mov_b64 exec, -1
    s_sub_u32 s35, s35, 1
    s_cbranch_scc1 .Lexit
    s_add_u32 s32, s32, 1
    s_cmp_eq_u32 s32, 64
    s_cselect_b32 s58, s59, s58
    s_waitcnt vmcnt(0)
.mpj_115:
    v_cmp_ne_u32 s[88:89], s34, v195
    v_cmp_ne_u32 s[90:91], s34, v199
    v_cmp_ne_u32 s[92:93], s34, v203
    v_cmp_ne_u32 s[56:57], s34, v207
    s_or_b64 vcc, s[88:89], s[90:91]
    s_or_b64 vcc, vcc, s[92:93]
    s_or_b64 vcc, vcc, s[56:57]
    s_cbranch_scc1 .mp_114
    v_perm_b32 v195, v192, v193, s60
    v_perm_b32 v199, v196, v197, s60
    v_perm_b32 v203, v200, v201, s60
    v_perm_b32 v207, v204, v205, s60
    v_perm_b32 v195, v195, v194, s61
    v_perm_b32 v199, v199, v198, s61
    v_perm_b32 v203, v203, v202, s61
    v_perm_b32 v207, v207, v206, s61
    v_pk_add_f32 v[192:193], v[192:193], v[196:197]
    v_pk_add_f32 v[194:195], v[194:195], v[198:199]
    v_pk_add_f32 v[200:201], v[200:201], v[204:205]
    v_pk_add_f32 v[202:203], v[202:203], v[206:207]
    v_cvt_pk_bf16_f32 v192, v192, v193
    v_cvt_pk_bf16_f32 v193, v194, v195
    v_cvt_pk_bf16_f32 v200, v200, v201
    v_cvt_pk_bf16_f32 v201, v202, v203
    ds_write_b64 v18, v[192:193]
    ds_write_b64 v18, v[200:201] offset:512
    s_waitcnt lgkmcnt(0)
    s_barrier
    ds_read_b128 v[224:227], v19 offset:0
    ds_read_b128 v[228:231], v19 offset:64
    ds_read_b128 v[232:235], v19 offset:128
    ds_read_b128 v[236:239], v19 offset:192
    s_waitcnt lgkmcnt(3)
    v_mfma_f32_16x16x32_bf16 v[132:135], v[160:163], v[224:227], 0
    v_mfma_f32_16x16x32_bf16 v[136:139], v[176:179], v[224:227], 0
    s_waitcnt lgkmcnt(2)
    v_mfma_f32_16x16x32_bf16 v[132:135], v[164:167], v[228:231], v[132:135]
    v_mfma_f32_16x16x32_bf16 v[136:139], v[180:183], v[228:231], v[136:139]
    s_waitcnt lgkmcnt(1)
    v_mfma_f32_16x16x32_bf16 v[132:135], v[168:171], v[232:235], v[132:135]
    v_mfma_f32_16x16x32_bf16 v[136:139], v[184:187], v[232:235], v[136:139]
    s_waitcnt lgkmcnt(0)
    v_mfma_f32_16x16x32_bf16 v[132:135], v[172:175], v[236:239], v[132:135]
    v_mfma_f32_16x16x32_bf16 v[136:139], v[188:191], v[236:239], v[136:139]
    s_nop 7
    v_cndmask_b32 v132, v132, v136, s[96:97]
    v_cndmask_b32 v133, v133, v137, s[96:97]
    v_cndmask_b32 v134, v134, v138, s[96:97]
    v_cndmask_b32 v135, v135, v139, s[96:97]
    ds_write_b128 v20, v[132:135]
    s_waitcnt lgkmcnt(0)
    s_barrier
    ds_read_b128 v[224:227], v21 offset:0
    ds_read_b128 v[228:231], v21 offset:2176
    ds_read_b128 v[232:235], v21 offset:4352
    ds_read_b128 v[236:239], v21 offset:6528
    s_mov_b32 s60, 0x07060503
    s_mov_b32 s61, 0x07060502
    s_mov_b32 s62, 0x07060501
    s_waitcnt lgkmcnt(2)
    v_pk_add_f32 v[224:225], v[224:225], v[228:229]
    v_pk_add_f32 v[226:227], v[226:227], v[230:231]
    s_waitcnt lgkmcnt(0)
    v_pk_add_f32 v[232:233], v[232:233], v[236:237]
    v_pk_add_f32 v[234:235], v[234:235], v[238:239]
    v_pk_add_f32 v[224:225], v[224:225], v[232:233]
    v_pk_add_f32 v[226:227], v[226:227], v[234:235]
    v_perm_b32 v140, v224, v227, s60
    v_perm_b32 v141, v225, v227, s61
    v_perm_b32 v142, v226, v227, s62
    s_mov_b64 exec, 0xffff
    buffer_store_dwordx4 v[140:143], v2, s[36:39], s63 offen sc1
    s_mov_b64 exec, -1
    s_barrier
    s_mov_b32 s60, 0x04000c0c
    s_mov_b32 s61, 0x0706000c
    s_mov_b64 s[88:89], exec
    s_mov_b64 s[90:91], exec
.mp_118:
    s_mov_b64 exec, s[88:89]
    buffer_load_dwordx4 v[108:111], v2, s[36:39], s41 offen offset:0 sc1
    s_mov_b64 exec, s[90:91]
    buffer_load_dwordx4 v[112:115], v2, s[36:39], s41 offen offset:1024 sc1
    s_mov_b64 exec, -1
    s_sub_u32 s35, s35, 1
    s_cbranch_scc1 .Lexit
    s_waitcnt vmcnt(0)
.mpj_119:
    v_cmp_ne_u32 s[88:89], s34, v111
    v_cmp_ne_u32 s[90:91], s34, v115
    s_or_b64 vcc, s[88:89], s[90:91]
    s_cbranch_scc1 .mp_118
    v_perm_b32 v111, v108, v109, s60
    v_perm_b32 v115, v112, v113, s60
    v_perm_b32 v111, v111, v110, s61
    v_perm_b32 v115, v115, v114, s61
    v_pk_add_f32 v[248:249], v[108:109], v[112:113]
    v_pk_add_f32 v[250:251], v[110:111], v[114:115]
    s_nop 1
    v_permlane32_swap_b32 v248, v250
    v_permlane32_swap_b32 v249, v251
    v_pk_add_f32 v[248:249], v[248:249], v[250:251]
    s_nop 1
    v_permlane16_swap_b32 v248, v249
    v_add_f32 v248, v248, v249
    v_cvt_pk_bf16_f32 v248, 0, v248
    v_mul_f32 v248, v248, v23
    v_cvt_pk_bf16_f32 v248, 0, v248
    v_add_f32 v249, v248, v29
    v_add_f32 v248, v248, v29
    v_mov_b32 v24, v248
    s_nop 0
    v_permlane16_swap_b32 v248, v249
    v_cvt_pk_bf16_f32 v252, v248, v249
    v_cvt_pk_bf16_f32 v254, v248, v249
    s_nop 1
    v_permlane32_swap_b32 v252, v254
    s_mov_b64 exec, 0xffff
    s_add_u32 s57, s42, 0xac000
    buffer_store_dwordx4 v[252:255], v2, s[36:39], s57 offen
    buffer_store_dwordx4 v[252:255], v2, s[36:39], s42 offen sc1
    s_mov_b64 exec, -1
    s_cmp_eq_u32 s3, s64
    s_cbranch_scc1 .r2_122
    s_branch .Lexit
.r2_122:
    v_cvt_pk_bf16_f32 v24, 0, v24
    s_nop 1
    s_branch .gpc_124
.gp_123:
    buffer_load_dwordx4 v[32:35], v2, s[36:39], s99 offen offset:0 sc1
    buffer_load_dwordx4 v[40:43], v2, s[36:39], s99 offen offset:1024 sc1
    buffer_load_dwordx2 v[48:49], v5, s[36:39], s99 offen offset:0 sc1
    buffer_load_dwordx4 v[56:59], v2, s[36:39], s100 offen offset:0 sc1
    buffer_load_dwordx4 v[64:67], v2, s[36:39], s100 offen offset:1024 sc1
    buffer_load_dwordx2 v[50:51], v5, s[36:39], s100 offen offset:0 sc1
    buffer_load_dwordx2 v[74:75], v6, s[36:39], s99 offen offset:0 sc1
    buffer_load_dwordx2 v[80:81], v6, s[36:39], s100 offen offset:0 sc1
    buffer_load_dwordx2 v[82:83], v6, s[36:39], s33 offen offset:0 sc1
    s_waitcnt vmcnt(0)
.gpc_124:
    v_min3_u32 v25, v33, v35, v41
    v_max3_u32 v26, v33, v35, v41
    v_min3_u32 v25, v25, v43, v49
    v_max3_u32 v26, v26, v43, v49
    v_min3_u32 v25, v25, v57, v59
    v_max3_u32 v26, v26, v57, v59
    v_min3_u32 v25, v25, v65, v67
    v_max3_u32 v26, v26, v65, v67
    v_min3_u32 v25, v25, v51, v75
    v_max3_u32 v26, v26, v51, v75
    v_min3_u32 v25, v25, v81, v83
    v_max3_u32 v26, v26, v81, v83
    v_cmp_eq_u32 vcc, s34, v25
    v_cmp_eq_u32 s[56:57], s34, v26
    s_and_b64 vcc, vcc, s[56:57]
    s_cmp_eq_u64 vcc, exec
    s_nop 2
    s_cbranch_scc1 .gpd_125
    s_sub_u32 s35, s35, 1
    s_cbranch_scc1 .Lexit
    s_sleep 2
    s_branch .gp_123
.gpd_125:
    v_lshlrev_b32 v160, 16, v32
    v_and_b32 v161, 0xffff0000, v32
    v_lshlrev_b32 v170, 16, v56
    v_and_b32 v171, 0xffff0000, v56
    v_lshlrev_b32 v162, 16, v34
    v_and_b32 v163, 0xffff0000, v34
    v_lshlrev_b32 v172, 16, v58
    v_and_b32 v173, 0xffff0000, v58
    v_lshlrev_b32 v164, 16, v40
    v_and_b32 v165, 0xffff0000, v40
    v_lshlrev_b32 v174, 16, v64
    v_and_b32 v175, 0xffff0000, v64
    v_lshlrev_b32 v166, 16, v42
    v_and_b32 v167, 0xffff0000, v42
    v_lshlrev_b32 v176, 16, v66
    v_and_b32 v177, 0xffff0000, v66
    v_lshlrev_b32 v168, 16, v48
    v_and_b32 v169, 0xffff0000, v48
    v_lshlrev_b32 v178, 16, v50
    v_and_b32 v179, 0xffff0000, v50
    v_lshlrev_b32 v75, 16, v74
    v_and_b32 v74, 0xffff0000, v74
    s_mov_b32 vcc_lo, 0xffff0000
    s_mov_b32 vcc_hi, 0xffff0000
    v_cndmask_b32 v75, v75, v74, vcc
    v_lshlrev_b32 v81, 16, v80
    v_and_b32 v80, 0xffff0000, v80
    s_mov_b32 vcc_lo, 0xffff0000
    s_mov_b32 vcc_hi, 0xffff0000
    v_cndmask_b32 v81, v81, v80, vcc
    v_lshlrev_b32 v83, 16, v82
    v_and_b32 v82, 0xffff0000, v82
    s_mov_b32 vcc_lo, 0xffff0000
    s_mov_b32 vcc_hi, 0xffff0000
    v_cndmask_b32 v83, v83, v82, vcc
    s_waitcnt vmcnt(0)
    s_add_u32 s58, s101, s0
    s_mov_b32 s32, 0
    s_mov_b64 s[88:89], exec
    s_mov_b64 s[90:91], exec
    s_mov_b64 s[92:93], exec
.mp_126:
    s_mov_b64 exec, s[88:89]
    buffer_load_dwordx4 v[180:183], v2, s[36:39], s58 offen offset:0 sc1
    s_mov_b64 exec, s[90:91]
    buffer_load_dwordx4 v[184:187], v2, s[36:39], s58 offen offset:1024 sc1
    s_mov_b64 exec, s[92:93]
    buffer_load_dwordx2 v[188:189], v5, s[36:39], s58 offen offset:0 sc1
    s_mov_b64 exec, -1
    s_sub_u32 s35, s35, 1
    s_cbranch_scc1 .Lexit
    s_add_u32 s32, s32, 1
    s_cmp_eq_u32 s32, 64
    s_cselect_b32 s58, s101, s58
    s_waitcnt vmcnt(0)
.mpj_127:
    v_cmp_ne_u32 s[88:89], s34, v181
    v_cmp_ne_u32 vcc, s34, v183
    s_or_b64 s[88:89], s[88:89], vcc
    v_cmp_ne_u32 s[90:91], s34, v185
    v_cmp_ne_u32 vcc, s34, v187
    s_or_b64 s[90:91], s[90:91], vcc
    v_cmp_ne_u32 s[92:93], s34, v189
    s_or_b64 vcc, s[88:89], s[90:91]
    s_or_b64 vcc, vcc, s[92:93]
    s_cbranch_scc1 .mp_126
    s_mov_b32 s56, 0x3f803f80
    v_dot2_f32_bf16 v200, v180, s56, 0
    v_dot2_f32_bf16 v201, v180, v180, 0
    v_dot2_f32_bf16 v200, v182, s56, v200
    v_dot2_f32_bf16 v201, v182, v182, v201
    v_dot2_f32_bf16 v200, v184, s56, v200
    v_dot2_f32_bf16 v201, v184, v184, v201
    v_dot2_f32_bf16 v200, v186, s56, v200
    v_dot2_f32_bf16 v201, v186, v186, v201
    s_mov_b64 exec, 0xffffffff
    v_dot2_f32_bf16 v200, v188, s56, v200
    v_dot2_f32_bf16 v201, v188, v188, v201
    s_mov_b64 exec, -1
    s_nop 1
    v_permlane32_swap_b32 v200, v201
    v_add_f32 v200, v200, v201
    v_mov_b32 v202, v200
    s_nop 1
    v_permlane16_swap_b32 v202, v200
    v_add_f32 v200, v202, v200
    v_lshlrev_b32 v190, 16, v180
    v_and_b32 v191, 0xffff0000, v180
    v_add_f32_dpp v200, v200, v200 row_ror:8 row_mask:0xf bank_mask:0xf
    v_lshlrev_b32 v192, 16, v182
    v_and_b32 v193, 0xffff0000, v182
    v_add_f32_dpp v200, v200, v200 row_ror:4 row_mask:0xf bank_mask:0xf
    v_lshlrev_b32 v194, 16, v184
    v_and_b32 v195, 0xffff0000, v184
    v_add_f32_dpp v200, v200, v200 quad_perm:[2,3,0,1] row_mask:0xf bank_mask:0xf
    v_lshlrev_b32 v196, 16, v186
    v_and_b32 v197, 0xffff0000, v186
    v_add_f32_dpp v200, v200, v200 quad_perm:[1,0,3,2] row_mask:0xf bank_mask:0xf
    v_mul_f32 v200, 0x3ae38e39, v200
    v_lshlrev_b32 v198, 16, v188
    v_and_b32 v199, 0xffff0000, v188
    v_readlane_b32 s56, v200, 0
    v_readlane_b32 s57, v200, 32
    s_nop 0
    v_mov_b32 v200, s56
    v_fma_f32 v201, -v200, v200, s57
    v_max_f32 v201, 0, v201
    v_cvt_pk_bf16_f32 v203, 0, v201
    v_cvt_pk_bf16_f32 v201, 0, -v200
    v_cvt_pk_bf16_f32 v200, 0, -v200
    v_add_f32 v203, 0x3727c5ac, v203
    v_pk_add_f32 v[190:191], v[190:191], v[200:201]
    v_pk_add_f32 v[192:193], v[192:193], v[200:201]
    v_pk_add_f32 v[194:195], v[194:195], v[200:201]
    v_cvt_pk_bf16_f32 v203, 0, v203
    v_pk_add_f32 v[196:197], v[196:197], v[200:201]
    v_pk_add_f32 v[198:199], v[198:199], v[200:201]
    v_cvt_pk_bf16_f32 v190, 0, v190
    v_sqrt_f32 v203, v203
    v_cvt_pk_bf16_f32 v191, 0, v191
    v_cvt_pk_bf16_f32 v192, 0, v192
    v_cvt_pk_bf16_f32 v193, 0, v193
    v_cvt_pk_bf16_f32 v203, 0, v203
    v_cvt_pk_bf16_f32 v194, 0, v194
    v_cvt_pk_bf16_f32 v195, 0, v195
    v_cvt_pk_bf16_f32 v196, 0, v196
    v_rcp_f32 v202, v203
    v_cvt_pk_bf16_f32 v197, 0, v197
    v_cvt_pk_bf16_f32 v198, 0, v198
    v_cvt_pk_bf16_f32 v199, 0, v199
    v_mov_b32 v203, v202
    v_pk_mul_f32 v[190:191], v[190:191], v[202:203]
    v_pk_mul_f32 v[192:193], v[192:193], v[202:203]
    v_pk_mul_f32 v[194:195], v[194:195], v[202:203]
    v_pk_mul_f32 v[196:197], v[196:197], v[202:203]
    v_pk_mul_f32 v[198:199], v[198:199], v[202:203]
    v_cvt_pk_bf16_f32 v190, 0, v190
    v_cvt_pk_bf16_f32 v191, 0, v191
    v_cvt_pk_bf16_f32 v192, 0, v192
    v_cvt_pk_bf16_f32 v193, 0, v193
    v_cvt_pk_bf16_f32 v194, 0, v194
    v_cvt_pk_bf16_f32 v195, 0, v195
    v_cvt_pk_bf16_f32 v196, 0, v196
    v_cvt_pk_bf16_f32 v197, 0, v197
    v_cvt_pk_bf16_f32 v198, 0, v198
    v_cvt_pk_bf16_f32 v199, 0, v199
    v_pk_mul_f32 v[190:191], v[190:191], v[170:171]
    v_pk_mul_f32 v[192:193], v[192:193], v[172:173]
    v_pk_mul_f32 v[194:195], v[194:195], v[174:175]
    v_pk_mul_f32 v[196:197], v[196:197], v[176:177]
    v_pk_mul_f32 v[198:199], v[198:199], v[178:179]
    v_cvt_pk_bf16_f32 v190, 0, v190
    v_cvt_pk_bf16_f32 v191, 0, v191
    v_cvt_pk_bf16_f32 v192, 0, v192
    v_cvt_pk_bf16_f32 v193, 0, v193
    v_cvt_pk_bf16_f32 v194, 0, v194
    v_cvt_pk_bf16_f32 v195, 0, v195
    v_cvt_pk_bf16_f32 v196, 0, v196
    v_cvt_pk_bf16_f32 v197, 0, v197
    v_cvt_pk_bf16_f32 v198, 0, v198
    v_cvt_pk_bf16_f32 v199, 0, v199
    v_pk_add_f32 v[190:191], v[190:191], v[160:161]
    v_pk_add_f32 v[192:193], v[192:193], v[162:163]
    v_pk_add_f32 v[194:195], v[194:195], v[164:165]
    v_pk_add_f32 v[196:197], v[196:197], v[166:167]
    v_pk_add_f32 v[198:199], v[198:199], v[168:169]
    v_cvt_pk_bf16_f32 v206, v190, v191
    v_cvt_pk_bf16_f32 v207, v192, v193
    v_cvt_pk_bf16_f32 v208, v194, v195
    v_cvt_pk_bf16_f32 v209, v196, v197
    v_cvt_pk_bf16_f32 v210, v198, v199
    v_dot2_f32_bf16 v14, v206, v88, 0
    v_dot2_f32_bf16 v14, v207, v89, v14
    v_dot2_f32_bf16 v14, v208, v90, v14
    v_dot2_f32_bf16 v14, v209, v91, v14
    s_mov_b64 exec, 0xffffffff
    v_dot2_f32_bf16 v14, v210, v30, v14
    s_mov_b64 exec, -1
    s_nop 1
    v_mov_b32 v15, v14
    s_nop 1
    v_permlane32_swap_b32 v15, v14
    v_add_f32 v14, v15, v14
    v_mov_b32 v15, v14
    s_nop 1
    v_permlane16_swap_b32 v15, v14
    v_add_f32 v14, v15, v14
    s_nop 1
    v_add_f32_dpp v14, v14, v14 row_ror:8 row_mask:0xf bank_mask:0xf
    s_nop 1
    v_add_f32_dpp v14, v14, v14 row_ror:4 row_mask:0xf bank_mask:0xf
    s_nop 1
    v_add_f32_dpp v14, v14, v14 quad_perm:[2,3,0,1] row_mask:0xf bank_mask:0xf
    s_nop 1
    v_add_f32_dpp v14, v14, v14 quad_perm:[1,0,3,2] row_mask:0xf bank_mask:0xf
    v_cvt_pk_bf16_f32 v14, 0, v14
    v_max_f32 v14, 0xc2ae0000, v14
    v_min_f32 v14, 0x43000000, v14
    v_mul_f32 v15, 0xbfb8aa3b, v14
    v_fma_f32 v16, v14, s98, -v15
    v_fmac_f32 v16, 0xb2a57060, v14
    v_exp_f32 v15, v15
    v_mul_f32 v16, 0x3f317218, v16
    v_fmac_f32 v15, v15, v16
    v_add_f32 v15, 1.0, v15
    v_rcp_f32 v16, v15
    s_nop 0
    v_fma_f32 v15, -v15, v16, 1.0
    v_fma_f32 v14, v15, v16, v16
    v_cvt_pk_bf16_f32 v14, 0, v14
    v_add_f32 v17, v24, v200
    v_cvt_pk_bf16_f32 v17, 0, v17
    v_mul_f32 v17, v17, v202
    v_cvt_pk_bf16_f32 v17, 0, v17
    v_mul_f32 v17, v17, v81
    v_cvt_pk_bf16_f32 v17, 0, v17
    v_add_f32 v17, v17, v75
    v_cvt_pk_bf16_f32 v17, 0, v17
    s_lshl_b32 s59, s40, 1
    s_add_u32 s58, s59, 0x38c000
    s_mov_b32 s60, 0x04000c0c
    s_mov_b32 s61, 0x0706000c
    s_mov_b32 s48, s28
    s_and_b32 s49, s29, 0xffff
    s_mov_b32 s50, 0x2400
    s_mov_b32 s51, 0x00020000
    s_mul_i32 s63, s3, 1152
    s_mov_b64 s[88:89], exec
    s_mov_b64 s[90:91], exec
    s_mov_b64 s[92:93], exec
    s_mov_b64 s[56:57], exec
.mp_130:
    s_mov_b64 exec, s[88:89]
    buffer_load_dwordx4 v[96:99], v2, s[36:39], s58 offen offset:0 sc1
    s_mov_b64 exec, s[90:91]
    buffer_load_dwordx4 v[100:103], v2, s[36:39], s58 offen offset:1024 sc1
    s_mov_b64 exec, s[92:93]
    buffer_load_dwordx4 v[104:107], v2, s[36:39], s58 offen offset:2048 sc1
    s_mov_b64 exec, s[56:57]
    buffer_load_dwordx4 v[108:111], v2, s[36:39], s58 offen offset:3072 sc1
    s_mov_b64 exec, -1
    s_sub_u32 s35, s35, 1
    s_cbranch_scc1 .Lexit
    s_waitcnt vmcnt(0)
.mpj_131:
    v_cmp_ne_u32 s[88:89], s34, v99
    v_cmp_ne_u32 s[90:91], s34, v103
    v_cmp_ne_u32 s[92:93], s34, v107
    v_cmp_ne_u32 s[56:57], s34, v111
    s_or_b64 vcc, s[88:89], s[90:91]
    s_or_b64 vcc, vcc, s[92:93]
    s_or_b64 vcc, vcc, s[56:57]
    s_cbranch_scc1 .mp_130
    v_perm_b32 v99, v96, v97, s60
    v_perm_b32 v103, v100, v101, s60
    v_perm_b32 v107, v104, v105, s60
    v_perm_b32 v111, v108, v109, s60
    v_perm_b32 v99, v99, v98, s61
    v_perm_b32 v103, v103, v102, s61
    v_perm_b32 v107, v107, v106, s61
    v_perm_b32 v111, v111, v110, s61
    v_pk_add_f32 v[96:97], v[96:97], v[100:101]
    v_pk_add_f32 v[98:99], v[98:99], v[102:103]
    v_pk_add_f32 v[248:249], v[104:105], v[108:109]
    v_pk_add_f32 v[250:251], v[106:107], v[110:111]
    v_pk_add_f32 v[248:249], v[248:249], v[96:97]
    v_pk_add_f32 v[250:251], v[250:251], v[98:99]
    s_nop 1
    v_permlane32_swap_b32 v248, v250
    v_permlane32_swap_b32 v249, v251
    v_pk_add_f32 v[248:249], v[248:249], v[250:251]
    s_nop 1
    v_permlane16_swap_b32 v248, v249
    v_add_f32 v248, v248, v249
    v_cvt_pk_bf16_f32 v248, 0, v248
    v_mul_f32 v248, v248, v14
    v_cvt_pk_bf16_f32 v248, 0, v248
    v_add_f32 v248, v248, v17
    v_cvt_pk_bf16_f32 v248, 0, v248
    v_mul_f32 v248, v248, v83
    v_cvt_pk_bf16_f32 v248, 0, v248
    v_add_f32 v248, v248, v24
    v_cvt_pk_bf16_f32 v248, v248, v248
    buffer_store_short v248, v31, s[48:51], s63 offen
    s_cmp_lg_u32 s2, 0
    s_cbranch_scc1 .Lexit
    v_mov_b32 v13, s34
    s_mov_b64 exec, 1
    buffer_store_dword v13, v2, s[36:39], 0 offen
    s_mov_b64 exec, -1
    s_branch .Lexit
.Latt_bc:
    v_and_b32 v8, 1, v0
    v_lshlrev_b32 v8, 8, v8
    v_and_b32 v9, 0x3c, v0
    v_lshl_add_u32 v9, v9, 2, v8
    v_lshlrev_b32 v7, 1, v9
    v_and_b32 v9, 0x3c, v0
    v_lshrrev_b32 v8, 4, v8
    v_and_b32 v9, 2, v0
    v_lshl_add_u32 v9, v9, 6, v8
    s_lshl_b32 s58, s66, 14
    s_lshl_b32 s59, s67, 10
    s_add_u32 s58, s58, s59
    s_add_u32 s58, s58, 0x40000
    s_lshl4_add_u32 s59, s66, s67
    s_lshl_b32 s59, s59, 8
    s_add_u32 s59, s59, 0x200000
    s_memrealtime s[8:9]
    s_waitcnt vmcnt(8)
    s_waitcnt lgkmcnt(0)
    s_sub_u32 s8, s8, s30
    s_cmpk_ge_u32 s8, 1147
    s_cbranch_scc1 .ap_134
    s_waitcnt vmcnt(5)
    s_cmpk_ge_u32 s8, 1082
    s_cbranch_scc1 .ap_134
    s_waitcnt vmcnt(3)
    s_bitcmp1_b64 s[14:15], 26
    s_cbranch_scc0 1
    s_waitcnt vmcnt(2)
    s_cmpk_ge_u32 s8, 1007
    s_cbranch_scc1 .ap_134
    s_waitcnt vmcnt(1)
.ap_134:
    s_add_u32 s63, s69, 409600
    buffer_load_dwordx4 v[88:91], v1, s[40:43], s63 offen nt
    s_memrealtime s[8:9]
    s_waitcnt vmcnt(8)
    s_waitcnt lgkmcnt(0)
    s_sub_u32 s8, s8, s30
    s_cmpk_ge_u32 s8, 1174
    s_cbranch_scc1 .ap_135
    s_waitcnt vmcnt(5)
    s_cmpk_ge_u32 s8, 1109
    s_cbranch_scc1 .ap_135
    s_waitcnt vmcnt(3)
    s_bitcmp1_b64 s[14:15], 27
    s_cbranch_scc0 1
    s_waitcnt vmcnt(2)
    s_cmpk_ge_u32 s8, 1034
    s_cbranch_scc1 .ap_135
    s_waitcnt vmcnt(1)
.ap_135:
    s_add_u32 s63, s69, 417792
    buffer_load_dwordx4 v[92:95], v1, s[40:43], s63 offen nt
    s_memrealtime s[8:9]
    s_waitcnt vmcnt(8)
    s_waitcnt lgkmcnt(0)
    s_sub_u32 s8, s8, s30
    s_cmpk_ge_u32 s8, 1201
    s_cbranch_scc1 .ap_136
    s_waitcnt vmcnt(5)
    s_cmpk_ge_u32 s8, 1136
    s_cbranch_scc1 .ap_136
    s_waitcnt vmcnt(3)
    s_bitcmp1_b64 s[14:15], 28
    s_cbranch_scc0 1
    s_waitcnt vmcnt(2)
    s_cmpk_ge_u32 s8, 1061
    s_cbranch_scc1 .ap_136
    s_waitcnt vmcnt(1)
.ap_136:
    s_add_u32 s63, s69, 425984
    buffer_load_dwordx4 v[120:123], v1, s[40:43], s63 offen nt
    s_memrealtime s[8:9]
    s_waitcnt vmcnt(8)
    s_waitcnt lgkmcnt(0)
    s_sub_u32 s8, s8, s30
    s_cmpk_ge_u32 s8, 1228
    s_cbranch_scc1 .ap_137
    s_waitcnt vmcnt(5)
    s_cmpk_ge_u32 s8, 1163
    s_cbranch_scc1 .ap_137
    s_waitcnt vmcnt(3)
    s_bitcmp1_b64 s[14:15], 29
    s_cbranch_scc0 1
    s_waitcnt vmcnt(2)
    s_cmpk_ge_u32 s8, 1088
    s_cbranch_scc1 .ap_137
    s_waitcnt vmcnt(1)
.ap_137:
    s_add_u32 s63, s69, 434176
    buffer_load_dwordx4 v[124:127], v1, s[40:43], s63 offen nt
    s_memrealtime s[8:9]
    s_waitcnt vmcnt(8)
    s_waitcnt lgkmcnt(0)
    s_sub_u32 s8, s8, s30
    s_cmpk_ge_u32 s8, 1255
    s_cbranch_scc1 .ap_138
    s_waitcnt vmcnt(5)
    s_cmpk_ge_u32 s8, 1190
    s_cbranch_scc1 .ap_138
    s_waitcnt vmcnt(3)
    s_bitcmp1_b64 s[14:15], 30
    s_cbranch_scc0 1
    s_waitcnt vmcnt(2)
    s_cmpk_ge_u32 s8, 1115
    s_cbranch_scc1 .ap_138
    s_waitcnt vmcnt(1)
.ap_138:
    s_add_u32 s63, s69, 442368
    buffer_load_dwordx4 v[152:155], v1, s[40:43], s63 offen nt
    s_memrealtime s[8:9]
    s_waitcnt vmcnt(8)
    s_waitcnt lgkmcnt(0)
    s_sub_u32 s8, s8, s30
    s_cmpk_ge_u32 s8, 1282
    s_cbranch_scc1 .ap_139
    s_waitcnt vmcnt(5)
    s_cmpk_ge_u32 s8, 1217
    s_cbranch_scc1 .ap_139
    s_waitcnt vmcnt(3)
    s_bitcmp1_b64 s[14:15], 31
    s_cbranch_scc0 1
    s_waitcnt vmcnt(2)
    s_cmpk_ge_u32 s8, 1142
    s_cbranch_scc1 .ap_139
    s_waitcnt vmcnt(1)
.ap_139:
    s_add_u32 s63, s69, 450560
    buffer_load_dwordx4 v[156:159], v1, s[40:43], s63 offen nt
    buffer_load_dwordx4 v[16:19], v7, s[36:39], s58 offen offset:0 sc1
    buffer_load_dwordx4 v[20:23], v7, s[36:39], s58 offen offset:16 sc1
    s_memrealtime s[8:9]
    s_waitcnt vmcnt(8)
    s_waitcnt lgkmcnt(0)
    s_sub_u32 s8, s8, s30
    s_cmpk_ge_u32 s8, 1309
    s_cbranch_scc1 .ap_140
    s_waitcnt vmcnt(5)
    s_cmpk_ge_u32 s8, 1244
    s_cbranch_scc1 .ap_140
    s_waitcnt vmcnt(3)
    s_bitcmp1_b64 s[14:15], 32
    s_cbranch_scc0 1
    s_waitcnt vmcnt(2)
    s_cmpk_ge_u32 s8, 1169
    s_cbranch_scc1 .ap_140
    s_waitcnt vmcnt(1)
.ap_140:
    s_add_u32 s63, s69, 0
    buffer_load_dwordx4 v[160:163], v2, s[44:47], s63 offen nt
    s_memrealtime s[8:9]
    s_waitcnt vmcnt(8)
    s_waitcnt lgkmcnt(0)
    s_sub_u32 s8, s8, s30
    s_cmpk_ge_u32 s8, 1336
    s_cbranch_scc1 .ap_141
    s_waitcnt vmcnt(5)
    s_cmpk_ge_u32 s8, 1271
    s_cbranch_scc1 .ap_141
    s_waitcnt vmcnt(3)
    s_bitcmp1_b64 s[14:15], 33
    s_cbranch_scc0 1
    s_waitcnt vmcnt(2)
    s_cmpk_ge_u32 s8, 1196
    s_cbranch_scc1 .ap_141
    s_waitcnt vmcnt(1)
.ap_141:
    s_add_u32 s63, s69, 8192
    buffer_load_dwordx4 v[164:167], v2, s[44:47], s63 offen nt
    s_memrealtime s[8:9]
    s_waitcnt vmcnt(8)
    s_waitcnt lgkmcnt(0)
    s_sub_u32 s8, s8, s30
    s_cmpk_ge_u32 s8, 1363
    s_cbranch_scc1 .ap_142
    s_waitcnt vmcnt(5)
    s_cmpk_ge_u32 s8, 1298
    s_cbranch_scc1 .ap_142
    s_waitcnt vmcnt(3)
    s_bitcmp1_b64 s[14:15], 34
    s_cbranch_scc0 1
    s_waitcnt vmcnt(2)
    s_cmpk_ge_u32 s8, 1223
    s_cbranch_scc1 .ap_142
    s_waitcnt vmcnt(1)
.ap_142:
    s_add_u32 s63, s69, 16384
    buffer_load_dwordx4 v[168:171], v2, s[44:47], s63 offen nt
    s_waitcnt vmcnt(3)
    s_branch .gpc_144
.gp_143:
    buffer_load_dwordx4 v[16:19], v7, s[36:39], s58 offen offset:0 sc1
    buffer_load_dwordx4 v[20:23], v7, s[36:39], s58 offen offset:16 sc1
    s_waitcnt vmcnt(0)
.gpc_144:
    v_min_u32 v10, v17, v19
    v_max_u32 v11, v17, v19
    v_min3_u32 v10, v10, v21, v23
    v_max3_u32 v11, v11, v21, v23
    v_cmp_eq_u32 vcc, s34, v10
    v_cmp_eq_u32 s[56:57], s34, v11
    s_and_b64 vcc, vcc, s[56:57]
    s_cmp_eq_u64 vcc, exec
    s_nop 2
    s_cbranch_scc1 .gpd_145
    s_sub_u32 s35, s35, 1
    s_cbranch_scc1 .Lexit
    s_sleep 1
    s_branch .gp_143
.gpd_145:
    s_mov_b32 vcc_lo, 0xcccccccc
    s_mov_b32 vcc_hi, 0xcccccccc
    v_cndmask_b32_e64 v24, v16, 0, vcc
    v_cndmask_b32_e64 v25, v18, 0, vcc
    v_cndmask_b32_e64 v26, v20, 0, vcc
    v_cndmask_b32_e64 v27, v22, 0, vcc
    v_cndmask_b32_e32 v28, 0, v16, vcc
    v_cndmask_b32_e32 v29, 0, v18, vcc
    v_cndmask_b32_e32 v30, 0, v20, vcc
    v_cndmask_b32_e32 v31, 0, v22, vcc
    v_mfma_f32_16x16x32_bf16 v[16:19], v[32:35], v[24:27], 0
    v_mfma_f32_16x16x32_bf16 v[32:35], v[40:43], v[24:27], 0
    v_mfma_f32_16x16x32_bf16 v[16:19], v[36:39], v[28:31], v[16:19]
    v_mfma_f32_16x16x32_bf16 v[40:43], v[48:51], v[24:27], 0
    v_mfma_f32_16x16x32_bf16 v[32:35], v[44:47], v[28:31], v[32:35]
    v_mfma_f32_16x16x32_bf16 v[48:51], v[56:59], v[24:27], 0
    v_mfma_f32_16x16x32_bf16 v[40:43], v[52:55], v[28:31], v[40:43]
    v_mfma_f32_16x16x32_bf16 v[56:59], v[64:67], v[24:27], 0
    v_mfma_f32_16x16x32_bf16 v[48:51], v[60:63], v[28:31], v[48:51]
    s_nop 1
    v_add_f32_dpp v10, v17, v16 row_ror:12 row_mask:0xf bank_mask:0x1
    s_memrealtime s[8:9]
    s_waitcnt lgkmcnt(0)
    s_sub_u32 s8, s8, s30
    s_cmpk_ge_u32 s8, 1390
    s_nop 0
    s_cbranch_scc1 .ap_146
    s_waitcnt vmcnt(3)
    s_cmpk_ge_u32 s8, 1325
    s_cbranch_scc1 .ap_146
    s_waitcnt vmcnt(3)
    s_bitcmp1_b64 s[14:15], 35
    s_cbranch_scc0 1
    s_waitcnt vmcnt(2)
    s_cmpk_ge_u32 s8, 1250
    s_cbranch_scc1 .ap_146
    s_waitcnt vmcnt(1)
.ap_146:
    s_add_u32 s63, s69, 24576
    buffer_load_dwordx4 v[172:175], v2, s[44:47], s63 offen nt
    v_mfma_f32_16x16x32_bf16 v[64:67], v[72:75], v[24:27], 0
    v_mfma_f32_16x16x32_bf16 v[56:59], v[68:71], v[28:31], v[56:59]
    v_add_f32_dpp v11, v33, v32 row_ror:12 row_mask:0xf bank_mask:0x1
    v_add_f32_dpp v10, v18, v10 row_ror:8 row_mask:0xf bank_mask:0x1
    v_mfma_f32_16x16x32_bf16 v[72:75], v[80:83], v[24:27], 0
    v_mfma_f32_16x16x32_bf16 v[64:67], v[76:79], v[28:31], v[64:67]
    v_add_f32_dpp v12, v41, v40 row_ror:12 row_mask:0xf bank_mask:0x1
    v_add_f32_dpp v11, v34, v11 row_ror:8 row_mask:0xf bank_mask:0x1
    v_add_f32_dpp v10, v19, v10 row_ror:4 row_mask:0xf bank_mask:0x1
    v_mfma_f32_16x16x32_bf16 v[80:83], v[88:91], v[24:27], 0
    v_mfma_f32_16x16x32_bf16 v[72:75], v[84:87], v[28:31], v[72:75]
    v_add_f32_dpp v13, v49, v48 row_ror:12 row_mask:0xf bank_mask:0x1
    v_add_f32_dpp v12, v42, v12 row_ror:8 row_mask:0xf bank_mask:0x1
    v_add_f32_dpp v11, v35, v11 row_ror:4 row_mask:0xf bank_mask:0x1
    v_mfma_f32_16x16x32_bf16 v[88:91], v[96:99], v[24:27], 0
    v_mfma_f32_16x16x32_bf16 v[80:83], v[92:95], v[28:31], v[80:83]
    v_add_f32_dpp v10, v58, v57 row_ror:12 row_mask:0xf bank_mask:0x2
    v_add_f32_dpp v13, v50, v13 row_ror:8 row_mask:0xf bank_mask:0x1
    v_add_f32_dpp v12, v43, v12 row_ror:4 row_mask:0xf bank_mask:0x1
    s_memrealtime s[8:9]
    s_waitcnt lgkmcnt(0)
    s_sub_u32 s8, s8, s30
    s_cmpk_ge_u32 s8, 1417
    s_nop 0
    s_cbranch_scc1 .ap_147
    s_waitcnt vmcnt(4)
    s_cmpk_ge_u32 s8, 1352
    s_cbranch_scc1 .ap_147
    s_waitcnt vmcnt(3)
    s_bitcmp1_b64 s[14:15], 36
    s_cbranch_scc0 1
    s_waitcnt vmcnt(2)
    s_cmpk_ge_u32 s8, 1277
    s_cbranch_scc1 .ap_147
    s_waitcnt vmcnt(1)
.ap_147:
    s_add_u32 s63, s69, 32768
    buffer_load_dwordx4 v[176:179], v2, s[44:47], s63 offen nt
    v_mfma_f32_16x16x32_bf16 v[96:99], v[104:107], v[24:27], 0
    v_mfma_f32_16x16x32_bf16 v[88:91], v[100:103], v[28:31], v[88:91]
    v_add_f32_dpp v11, v66, v65 row_ror:12 row_mask:0xf bank_mask:0x2
    v_add_f32_dpp v10, v59, v10 row_ror:8 row_mask:0xf bank_mask:0x2
    v_add_f32_dpp v13, v51, v13 row_ror:4 row_mask:0xf bank_mask:0x1
    v_mfma_f32_16x16x32_bf16 v[104:107], v[112:115], v[24:27], 0
    v_mfma_f32_16x16x32_bf16 v[96:99], v[108:111], v[28:31], v[96:99]
    v_add_f32_dpp v12, v74, v73 row_ror:12 row_mask:0xf bank_mask:0x2
    v_add_f32_dpp v11, v67, v11 row_ror:8 row_mask:0xf bank_mask:0x2
    v_add_f32_dpp v10, v56, v10 row_ror:4 row_mask:0xf bank_mask:0x2
    v_mfma_f32_16x16x32_bf16 v[112:115], v[120:123], v[24:27], 0
    v_mfma_f32_16x16x32_bf16 v[104:107], v[116:119], v[28:31], v[104:107]
    v_add_f32_dpp v13, v82, v81 row_ror:12 row_mask:0xf bank_mask:0x2
    v_add_f32_dpp v12, v75, v12 row_ror:8 row_mask:0xf bank_mask:0x2
    v_add_f32_dpp v11, v64, v11 row_ror:4 row_mask:0xf bank_mask:0x2
    v_mfma_f32_16x16x32_bf16 v[120:123], v[128:131], v[24:27], 0
    v_mfma_f32_16x16x32_bf16 v[112:115], v[124:127], v[28:31], v[112:115]
    v_add_f32_dpp v10, v91, v90 row_ror:12 row_mask:0xf bank_mask:0x4
    v_add_f32_dpp v13, v83, v13 row_ror:8 row_mask:0xf bank_mask:0x2
    v_add_f32_dpp v12, v72, v12 row_ror:4 row_mask:0xf bank_mask:0x2
    s_memrealtime s[8:9]
    s_waitcnt lgkmcnt(0)
    s_sub_u32 s8, s8, s30
    s_cmpk_ge_u32 s8, 1444
    s_nop 0
    s_cbranch_scc1 .ap_148
    s_waitcnt vmcnt(5)
    s_cmpk_ge_u32 s8, 1379
    s_cbranch_scc1 .ap_148
    s_waitcnt vmcnt(3)
    s_bitcmp1_b64 s[14:15], 37
    s_cbranch_scc0 1
    s_waitcnt vmcnt(2)
    s_cmpk_ge_u32 s8, 1304
    s_cbranch_scc1 .ap_148
    s_waitcnt vmcnt(1)
.ap_148:
    s_add_u32 s63, s69, 40960
    buffer_load_dwordx4 v[180:183], v2, s[44:47], s63 offen nt
    v_mfma_f32_16x16x32_bf16 v[128:131], v[136:139], v[24:27], 0
    v_mfma_f32_16x16x32_bf16 v[120:123], v[132:135], v[28:31], v[120:123]
    v_add_f32_dpp v11, v99, v98 row_ror:12 row_mask:0xf bank_mask:0x4
    v_add_f32_dpp v10, v88, v10 row_ror:8 row_mask:0xf bank_mask:0x4
    v_add_f32_dpp v13, v80, v13 row_ror:4 row_mask:0xf bank_mask:0x2
    v_mfma_f32_16x16x32_bf16 v[136:139], v[144:147], v[24:27], 0
    v_mfma_f32_16x16x32_bf16 v[128:131], v[140:143], v[28:31], v[128:131]
    v_add_f32_dpp v12, v107, v106 row_ror:12 row_mask:0xf bank_mask:0x4
    v_add_f32_dpp v11, v96, v11 row_ror:8 row_mask:0xf bank_mask:0x4
    v_add_f32_dpp v10, v89, v10 row_ror:4 row_mask:0xf bank_mask:0x4
    v_mfma_f32_16x16x32_bf16 v[144:147], v[152:155], v[24:27], 0
    v_mfma_f32_16x16x32_bf16 v[136:139], v[148:151], v[28:31], v[136:139]
    v_add_f32_dpp v13, v115, v114 row_ror:12 row_mask:0xf bank_mask:0x4
    v_add_f32_dpp v12, v104, v12 row_ror:8 row_mask:0xf bank_mask:0x4
    v_add_f32_dpp v11, v97, v11 row_ror:4 row_mask:0xf bank_mask:0x4
    v_mfma_f32_16x16x32_bf16 v[144:147], v[156:159], v[28:31], v[144:147]
    v_add_f32_dpp v10, v120, v123 row_ror:12 row_mask:0xf bank_mask:0x8
    v_add_f32_dpp v13, v112, v13 row_ror:8 row_mask:0xf bank_mask:0x4
    v_add_f32_dpp v12, v105, v12 row_ror:4 row_mask:0xf bank_mask:0x4
    s_memrealtime s[8:9]
    s_waitcnt lgkmcnt(0)
    s_sub_u32 s8, s8, s30
    s_cmpk_ge_u32 s8, 1471
    s_nop 0
    s_cbranch_scc1 .ap_149
    s_waitcnt vmcnt(5)
    s_cmpk_ge_u32 s8, 1406
    s_cbranch_scc1 .ap_149
    s_waitcnt vmcnt(3)
    s_bitcmp1_b64 s[14:15], 38
    s_cbranch_scc0 1
    s_waitcnt vmcnt(2)
    s_cmpk_ge_u32 s8, 1331
    s_cbranch_scc1 .ap_149
    s_waitcnt vmcnt(1)
.ap_149:
    s_add_u32 s63, s69, 49152
    buffer_load_dwordx4 v[184:187], v2, s[44:47], s63 offen nt
    v_add_f32_dpp v11, v128, v131 row_ror:12 row_mask:0xf bank_mask:0x8
    v_add_f32_dpp v10, v121, v10 row_ror:8 row_mask:0xf bank_mask:0x8
    v_add_f32_dpp v13, v113, v13 row_ror:4 row_mask:0xf bank_mask:0x4
    v_add_f32_dpp v12, v136, v139 row_ror:12 row_mask:0xf bank_mask:0x8
    v_add_f32_dpp v11, v129, v11 row_ror:8 row_mask:0xf bank_mask:0x8
    v_add_f32_dpp v10, v122, v10 row_ror:4 row_mask:0xf bank_mask:0x8
    v_add_f32_dpp v13, v144, v147 row_ror:12 row_mask:0xf bank_mask:0x8
    v_add_f32_dpp v12, v137, v12 row_ror:8 row_mask:0xf bank_mask:0x8
    v_add_f32_dpp v11, v130, v11 row_ror:4 row_mask:0xf bank_mask:0x8
    v_add_f32_dpp v13, v145, v13 row_ror:8 row_mask:0xf bank_mask:0x8
    v_add_f32_dpp v12, v138, v12 row_ror:4 row_mask:0xf bank_mask:0x8
    s_memrealtime s[8:9]
    s_waitcnt lgkmcnt(0)
    s_sub_u32 s8, s8, s30
    s_cmpk_ge_u32 s8, 1498
    s_cbranch_scc1 .ap_150
    s_waitcnt vmcnt(5)
    s_cmpk_ge_u32 s8, 1433
    s_cbranch_scc1 .ap_150
    s_waitcnt vmcnt(3)
    s_bitcmp1_b64 s[14:15], 39
    s_cbranch_scc0 1
    s_waitcnt vmcnt(2)
    s_cmpk_ge_u32 s8, 1358
    s_cbranch_scc1 .ap_150
    s_waitcnt vmcnt(1)
.ap_150:
    s_add_u32 s63, s69, 57344
    buffer_load_dwordx4 v[188:191], v2, s[44:47], s63 offen nt
    v_add_f32_dpp v13, v146, v13 row_ror:4 row_mask:0xf bank_mask:0x8
    s_mov_b32 s60, 0x3db504f3
    s_mov_b32 s61, 0x3db504f3
    v_cvt_pk_bf16_f32 v10, 0, v10
    v_cvt_pk_bf16_f32 v11, 0, v11
    v_cvt_pk_bf16_f32 v12, 0, v12
    v_cvt_pk_bf16_f32 v13, 0, v13
    v_pk_mul_f32 v[10:11], v[10:11], s[60:61]
    v_pk_mul_f32 v[12:13], v[12:13], s[60:61]
    v_cvt_pk_bf16_f32 v10, 0, v10
    v_cvt_pk_bf16_f32 v11, 0, v11
    v_cvt_pk_bf16_f32 v12, 0, v12
    v_cvt_pk_bf16_f32 v13, 0, v13
    v_max_f32 v14, v10, v11
    v_max3_f32 v14, v14, v12, v13
    s_mov_b32 s60, 0x3fb8aa3b
    v_mov_b32 v22, s34
    v_mov_b32 v23, s34
    v_max_f32_dpp v14, v14, v14 quad_perm:[2,3,0,1] row_mask:0xf bank_mask:0xf
    s_nop 1
    v_max_f32_dpp v14, v14, v14 row_ror:4 row_mask:0xf bank_mask:0xf
    s_nop 1
    v_max_f32_dpp v14, v14, v14 row_ror:8 row_mask:0xf bank_mask:0xf
    v_mov_b32 v15, v14
    s_nop 1
    v_permlane16_swap_b32 v15, v14
    v_max_f32 v14, v15, v14
    v_mov_b32 v15, v14
    s_nop 1
    v_permlane32_swap_b32 v15, v14
    v_max_f32 v14, v15, v14
    v_mul_f32 v15, 0xbfb8aa3b, v14
    v_fma_f32 v10, v10, s60, v15
    v_fma_f32 v11, v11, s60, v15
    v_fma_f32 v12, v12, s60, v15
    v_fma_f32 v13, v13, s60, v15
    v_exp_f32 v10, v10
    v_exp_f32 v11, v11
    v_exp_f32 v12, v12
    v_exp_f32 v13, v13
    v_mov_b32 v20, v14
    v_pk_add_f32 v[16:17], v[10:11], v[12:13]
    v_add_f32 v21, v16, v17
    s_lshl3_add_u32 s60, s68, s3
    s_lshl_b32 s60, s60, 5
    s_add_u32 s60, s60, s59
    v_add_f32_dpp v21, v21, v21 quad_perm:[2,3,0,1] row_mask:0xf bank_mask:0xf
    s_nop 1
    v_add_f32_dpp v21, v21, v21 row_ror:4 row_mask:0xf bank_mask:0xf
    s_nop 1
    v_add_f32_dpp v21, v21, v21 row_ror:8 row_mask:0xf bank_mask:0xf
    v_mov_b32 v15, v21
    s_nop 1
    v_permlane16_swap_b32 v15, v21
    v_add_f32 v21, v15, v21
    v_mov_b32 v15, v21
    s_nop 1
    v_permlane32_swap_b32 v15, v21
    v_add_f32 v21, v15, v21
    s_lshl_b32 s60, s3, 4
    s_add_u32 s60, s60, 159104
    v_add_u32 v16, s60, v3
    v_mov_b32 v17, 159232
    v_mov_b32 v18, 1
    s_mov_b64 exec, 3
    ds_write_b64 v16, v[20:21]
    s_mov_b64 exec, 1
    s_waitcnt lgkmcnt(0)
    ds_add_rtn_u32 v18, v17, v18
    s_mov_b64 exec, -1
    v_and_b32 v16, 0x78, v3
    v_add_u32 v16, 159104, v16
    s_waitcnt lgkmcnt(0)
    v_readfirstlane_b32 s60, v18
    s_cmp_lg_u32 s60, 7
    s_nop 3
    s_cbranch_scc1 .ml_151
    ds_read_b64 v[18:19], v16
    s_lshl_b32 s60, s68, 7
    s_add_u32 s60, s60, s59
    s_waitcnt lgkmcnt(0)
    v_mov_b32 v20, v18
    s_nop 1
    v_max_f32_dpp v20, v20, v20 quad_perm:[2,3,0,1] row_mask:0xf bank_mask:0xf
    s_nop 1
    v_max_f32_dpp v20, v20, v20 row_ror:4 row_mask:0xf bank_mask:0xf
    s_nop 1
    v_max_f32_dpp v20, v20, v20 row_ror:8 row_mask:0xf bank_mask:0xf
    v_sub_f32 v18, v18, v20
    v_mul_f32 v18, 0x3fb8aa3b, v18
    v_exp_f32 v18, v18
    s_nop 0
    v_mul_f32 v21, v18, v19
    s_nop 1
    v_add_f32_dpp v21, v21, v21 quad_perm:[2,3,0,1] row_mask:0xf bank_mask:0xf
    s_nop 1
    v_add_f32_dpp v21, v21, v21 row_ror:4 row_mask:0xf bank_mask:0xf
    s_nop 1
    v_add_f32_dpp v21, v21, v21 row_ror:8 row_mask:0xf bank_mask:0xf
    s_mov_b64 exec, 0xff
    buffer_store_dwordx4 v[20:23], v2, s[36:39], s60 offen sc1
    s_mov_b64 exec, -1
.ml_151:
    s_memrealtime s[8:9]
    s_waitcnt lgkmcnt(0)
    s_sub_u32 s8, s8, s30
    s_cmpk_ge_u32 s8, 1525
    s_cbranch_scc1 .ap_152
    s_waitcnt vmcnt(5)
    s_cmpk_ge_u32 s8, 1460
    s_cbranch_scc1 .ap_152
    s_waitcnt vmcnt(3)
    s_bitcmp1_b64 s[14:15], 40
    s_cbranch_scc0 1
    s_waitcnt vmcnt(2)
    s_cmpk_ge_u32 s8, 1385
    s_cbranch_scc1 .ap_152
    s_waitcnt vmcnt(1)
.ap_152:
    s_add_u32 s63, s69, 131072
    buffer_load_dwordx4 v[192:195], v2, s[44:47], s63 offen nt
    s_sub_u32 s57, s65, 9
    s_bitcmp1_b32 s57, 0
    s_cselect_b32 s48, s20, s18
    s_cselect_b32 s49, s21, s19
    s_cselect_b32 s33, 36, 0
    s_and_b32 s49, s49, 0xffff
    s_mov_b32 s50, 0x510000
    s_mov_b32 s51, 0x00020000
    s_mov_b32 s52, s22
    s_and_b32 s53, s23, 0xffff
    s_mov_b32 s54, 0x510000
    s_mov_b32 s55, 0x00020000
    s_lshr_b32 s57, s57, 1
    s_lshl_b32 s57, s57, 7
    s_mul_i32 s101, s64, 1152
    s_add_u32 s101, s101, s57
    s_mul_i32 s56, s3, 73728
    s_add_u32 s101, s101, s56
    s_mul_i32 s56, s64, 72
    s_add_u32 s33, s33, s56
    s_add_u32 s33, s33, s3
    s_mul_i32 s33, s33, 9216
    s_add_u32 s33, s33, s57
    s_bfe_u32 s56, s101, 0x30007
    s_cmp_eq_u32 s56, 3
    s_cselect_b32 s43, 1, 0
    v_bfe_u32 v16, v0, 4, 1
    s_and_b32 s56, s3, 3
    s_lshl_b32 s56, s56, 1
    v_or_b32 v16, s56, v16
    v_and_b32 v6, 7, v0
    v_xor_b32 v16, v16, v6
    v_lshrrev_b32 v6, 3, v0
    v_mul_u32_u24 v6, 9216, v6
    v_lshl_add_u32 v6, v16, 4, v6
    v_bfe_u32 v16, v0, 4, 1
    s_and_b32 s56, s3, 1
    s_lshl_b32 s56, s56, 2
    v_lshl_or_b32 v16, v16, 1, s56
    v_and_b32 v17, 7, v0
    v_xor_b32 v16, v16, v17
    v_lshrrev_b32 v17, 3, v0
    v_mul_u32_u24 v17, 1152, v17
    v_lshl_add_u32 v31, v16, 4, v17
    s_memrealtime s[8:9]
    s_waitcnt vmcnt(8)
    s_waitcnt lgkmcnt(0)
    s_sub_u32 s8, s8, s30
    s_cmpk_ge_u32 s8, 1552
    s_cbranch_scc1 .ap_153
    s_waitcnt vmcnt(5)
    s_cmpk_ge_u32 s8, 1487
    s_cbranch_scc1 .ap_153
    s_waitcnt vmcnt(3)
    s_bitcmp1_b64 s[14:15], 41
    s_cbranch_scc0 1
    s_waitcnt vmcnt(2)
    s_cmpk_ge_u32 s8, 1412
    s_cbranch_scc1 .ap_153
    s_waitcnt vmcnt(1)
.ap_153:
    s_add_u32 s63, s69, 139264
    buffer_load_dwordx4 v[196:199], v2, s[44:47], s63 offen nt
    s_memrealtime s[8:9]
    s_waitcnt vmcnt(8)
    s_waitcnt lgkmcnt(0)
    s_sub_u32 s8, s8, s30
    s_cmpk_ge_u32 s8, 1579
    s_cbranch_scc1 .ap_154
    s_waitcnt vmcnt(5)
    s_cmpk_ge_u32 s8, 1514
    s_cbranch_scc1 .ap_154
    s_waitcnt vmcnt(3)
    s_bitcmp1_b64 s[14:15], 42
    s_cbranch_scc0 1
    s_waitcnt vmcnt(2)
    s_cmpk_ge_u32 s8, 1439
    s_cbranch_scc1 .ap_154
    s_waitcnt vmcnt(1)
.ap_154:
    s_add_u32 s63, s69, 147456
    buffer_load_dwordx4 v[200:203], v2, s[44:47], s63 offen nt
    s_memrealtime s[8:9]
    s_waitcnt vmcnt(8)
    s_waitcnt lgkmcnt(0)
    s_sub_u32 s8, s8, s30
    s_cmpk_ge_u32 s8, 1606
    s_cbranch_scc1 .ap_155
    s_waitcnt vmcnt(5)
    s_cmpk_ge_u32 s8, 1541
    s_cbranch_scc1 .ap_155
    s_waitcnt vmcnt(3)
    s_bitcmp1_b64 s[14:15], 43
    s_cbranch_scc0 1
    s_waitcnt vmcnt(2)
    s_cmpk_ge_u32 s8, 1466
    s_cbranch_scc1 .ap_155
    s_waitcnt vmcnt(1)
.ap_155:
    s_add_u32 s63, s69, 155648
    buffer_load_dwordx4 v[204:207], v2, s[44:47], s63 offen nt
    s_memrealtime s[8:9]
    s_waitcnt vmcnt(8)
    s_waitcnt lgkmcnt(0)
    s_sub_u32 s8, s8, s30
    s_cmpk_ge_u32 s8, 1633
    s_cbranch_scc1 .ap_156
    s_waitcnt vmcnt(5)
    s_cmpk_ge_u32 s8, 1568
    s_cbranch_scc1 .ap_156
    s_waitcnt vmcnt(3)
    s_bitcmp1_b64 s[14:15], 44
    s_cbranch_scc0 1
    s_waitcnt vmcnt(2)
    s_cmpk_ge_u32 s8, 1493
    s_cbranch_scc1 .ap_156
    s_waitcnt vmcnt(1)
.ap_156:
    s_add_u32 s63, s69, 163840
    buffer_load_dwordx4 v[208:211], v2, s[44:47], s63 offen nt
    s_memrealtime s[8:9]
    s_waitcnt vmcnt(8)
    s_waitcnt lgkmcnt(0)
    s_sub_u32 s8, s8, s30
    s_cmpk_ge_u32 s8, 1660
    s_cbranch_scc1 .ap_157
    s_waitcnt vmcnt(5)
    s_cmpk_ge_u32 s8, 1595
    s_cbranch_scc1 .ap_157
    s_waitcnt vmcnt(3)
    s_bitcmp1_b64 s[14:15], 45
    s_cbranch_scc0 1
    s_waitcnt vmcnt(2)
    s_cmpk_ge_u32 s8, 1520
    s_cbranch_scc1 .ap_157
    s_waitcnt vmcnt(1)
.ap_157:
    s_add_u32 s63, s69, 172032
    buffer_load_dwordx4 v[212:215], v2, s[44:47], s63 offen nt
    s_memrealtime s[8:9]
    s_waitcnt vmcnt(8)
    s_waitcnt lgkmcnt(0)
    s_sub_u32 s8, s8, s30
    s_cmpk_ge_u32 s8, 1691
    s_cbranch_scc1 .ap_158
    s_waitcnt vmcnt(5)
    s_cmpk_ge_u32 s8, 1626
    s_cbranch_scc1 .ap_158
    s_waitcnt vmcnt(3)
    s_bitcmp1_b64 s[14:15], 46
    s_cbranch_scc0 1
    s_waitcnt vmcnt(2)
    s_cmpk_ge_u32 s8, 1551
    s_cbranch_scc1 .ap_158
    s_waitcnt vmcnt(1)
.ap_158:
    s_add_u32 s63, s69, 180224
    buffer_load_dwordx4 v[216:219], v2, s[44:47], s63 offen nt
    s_memrealtime s[8:9]
    s_waitcnt vmcnt(8)
    s_waitcnt lgkmcnt(0)
    s_sub_u32 s8, s8, s30
    s_cmpk_ge_u32 s8, 1722
    s_cbranch_scc1 .ap_159
    s_waitcnt vmcnt(5)
    s_cmpk_ge_u32 s8, 1657
    s_cbranch_scc1 .ap_159
    s_waitcnt vmcnt(3)
    s_bitcmp1_b64 s[14:15], 47
    s_cbranch_scc0 1
    s_waitcnt vmcnt(2)
    s_cmpk_ge_u32 s8, 1582
    s_cbranch_scc1 .ap_159
    s_waitcnt vmcnt(1)
.ap_159:
    s_add_u32 s63, s69, 188416
    buffer_load_dwordx4 v[220:223], v2, s[44:47], s63 offen nt
    s_mul_i32 s99, s3, 2304
    s_add_u32 s99, s99, 0x1e000
    buffer_load_dwordx4 v[32:35], v2, s[36:39], s99 offen offset:0
    buffer_load_dwordx4 v[40:43], v2, s[36:39], s99 offen offset:1024
    buffer_load_dwordx2 v[48:49], v5, s[36:39], s99 offen offset:0
    s_memrealtime s[8:9]
    s_waitcnt vmcnt(11)
    s_waitcnt lgkmcnt(0)
    s_sub_u32 s8, s8, s30
    s_cmpk_ge_u32 s8, 1753
    s_cbranch_scc1 .ap_160
    s_waitcnt vmcnt(8)
    s_cmpk_ge_u32 s8, 1688
    s_cbranch_scc1 .ap_160
    s_waitcnt vmcnt(6)
    s_bitcmp1_b64 s[14:15], 48
    s_cbranch_scc0 1
    s_waitcnt vmcnt(5)
    s_cmpk_ge_u32 s8, 1613
    s_cbranch_scc1 .ap_160
    s_waitcnt vmcnt(4)
.ap_160:
    s_add_u32 s63, s69, 262144
    buffer_load_dwordx4 v[224:227], v2, s[44:47], s63 offen nt
    s_memrealtime s[8:9]
    s_waitcnt vmcnt(11)
    s_waitcnt lgkmcnt(0)
    s_sub_u32 s8, s8, s30
    s_cmpk_ge_u32 s8, 1784
    s_cbranch_scc1 .ap_161
    s_waitcnt vmcnt(8)
    s_cmpk_ge_u32 s8, 1719
    s_cbranch_scc1 .ap_161
    s_waitcnt vmcnt(6)
    s_bitcmp1_b64 s[14:15], 49
    s_cbranch_scc0 1
    s_waitcnt vmcnt(5)
    s_cmpk_ge_u32 s8, 1644
    s_cbranch_scc1 .ap_161
    s_waitcnt vmcnt(4)
.ap_161:
    s_add_u32 s63, s69, 270336
    buffer_load_dwordx4 v[228:231], v2, s[44:47], s63 offen nt
    s_mul_i32 s100, s3, 2304
    s_add_u32 s100, s100, 0x27000
    buffer_load_dwordx4 v[56:59], v2, s[36:39], s100 offen offset:0
    buffer_load_dwordx4 v[64:67], v2, s[36:39], s100 offen offset:1024
    buffer_load_dwordx2 v[50:51], v5, s[36:39], s100 offen offset:0
    s_memrealtime s[8:9]
    s_waitcnt vmcnt(14)
    s_waitcnt lgkmcnt(0)
    s_sub_u32 s8, s8, s30
    s_cmpk_ge_u32 s8, 1815
    s_cbranch_scc1 .ap_162
    s_waitcnt vmcnt(11)
    s_cmpk_ge_u32 s8, 1750
    s_cbranch_scc1 .ap_162
    s_waitcnt vmcnt(9)
    s_bitcmp1_b64 s[14:15], 50
    s_cbranch_scc0 1
    s_waitcnt vmcnt(8)
    s_cmpk_ge_u32 s8, 1675
    s_cbranch_scc1 .ap_162
    s_waitcnt vmcnt(4)
.ap_162:
    s_add_u32 s63, s69, 278528
    buffer_load_dwordx4 v[232:235], v2, s[44:47], s63 offen nt
    s_memrealtime s[8:9]
    s_waitcnt vmcnt(14)
    s_waitcnt lgkmcnt(0)
    s_sub_u32 s8, s8, s30
    s_cmpk_ge_u32 s8, 1846
    s_cbranch_scc1 .ap_163
    s_waitcnt vmcnt(11)
    s_cmpk_ge_u32 s8, 1781
    s_cbranch_scc1 .ap_163
    s_waitcnt vmcnt(9)
    s_bitcmp1_b64 s[14:15], 51
    s_cbranch_scc0 1
    s_waitcnt vmcnt(5)
    s_cmpk_ge_u32 s8, 1706
    s_cbranch_scc1 .ap_163
    s_waitcnt vmcnt(4)
.ap_163:
    s_add_u32 s63, s69, 286720
    buffer_load_dwordx4 v[236:239], v2, s[44:47], s63 offen nt
    s_memrealtime s[8:9]
    s_waitcnt vmcnt(14)
    s_waitcnt lgkmcnt(0)
    s_sub_u32 s8, s8, s30
    s_cmpk_ge_u32 s8, 1877
    s_cbranch_scc1 .ap_164
    s_waitcnt vmcnt(11)
    s_cmpk_ge_u32 s8, 1812
    s_cbranch_scc1 .ap_164
    s_waitcnt vmcnt(6)
    s_bitcmp1_b64 s[14:15], 52
    s_cbranch_scc0 1
    s_waitcnt vmcnt(5)
    s_cmpk_ge_u32 s8, 1737
    s_cbranch_scc1 .ap_164
    s_waitcnt vmcnt(1)
.ap_164:
    s_add_u32 s63, s69, 294912
    buffer_load_dwordx4 v[240:243], v2, s[44:47], s63 offen nt
    s_memrealtime s[8:9]
    s_waitcnt vmcnt(14)
    s_waitcnt lgkmcnt(0)
    s_sub_u32 s8, s8, s30
    s_cmpk_ge_u32 s8, 1908
    s_cbranch_scc1 .ap_165
    s_waitcnt vmcnt(11)
    s_cmpk_ge_u32 s8, 1843
    s_cbranch_scc1 .ap_165
    s_waitcnt vmcnt(6)
    s_bitcmp1_b64 s[14:15], 53
    s_cbranch_scc0 1
    s_waitcnt vmcnt(2)
    s_cmpk_ge_u32 s8, 1768
    s_cbranch_scc1 .ap_165
    s_waitcnt vmcnt(1)
.ap_165:
    s_add_u32 s63, s69, 303104
    buffer_load_dwordx4 v[244:247], v2, s[44:47], s63 offen nt
    s_load_dwordx2 s[88:89], s[6:7], s0
    buffer_load_dwordx4 v[24:27], v9, s[36:39], s59 offen offset:0 sc1
    s_memrealtime s[8:9]
    s_waitcnt vmcnt(14)
    s_waitcnt lgkmcnt(0)
    s_sub_u32 s8, s8, s30
    s_cmpk_ge_u32 s8, 1939
    s_cbranch_scc1 .ap_166
    s_waitcnt vmcnt(8)
    s_cmpk_ge_u32 s8, 1874
    s_cbranch_scc1 .ap_166
    s_waitcnt vmcnt(3)
    s_bitcmp1_b64 s[14:15], 54
    s_cbranch_scc0 1
    s_waitcnt vmcnt(2)
    s_cmpk_ge_u32 s8, 1799
    s_cbranch_scc1 .ap_166
    s_waitcnt vmcnt(1)
.ap_166:
    s_add_u32 s63, s69, 311296
    buffer_load_dwordx4 v[248:251], v2, s[44:47], s63 offen nt
    s_memrealtime s[8:9]
    s_waitcnt vmcnt(14)
    s_waitcnt lgkmcnt(0)
    s_sub_u32 s8, s8, s30
    s_cmpk_ge_u32 s8, 1970
    s_cbranch_scc1 .ap_167
    s_waitcnt vmcnt(5)
    s_cmpk_ge_u32 s8, 1905
    s_cbranch_scc1 .ap_167
    s_waitcnt vmcnt(3)
    s_bitcmp1_b64 s[14:15], 55
    s_cbranch_scc0 1
    s_waitcnt vmcnt(2)
    s_cmpk_ge_u32 s8, 1830
    s_cbranch_scc1 .ap_167
    s_waitcnt vmcnt(1)
.ap_167:
    s_add_u32 s63, s69, 319488
    buffer_load_dwordx4 v[252:255], v2, s[44:47], s63 offen nt
    s_memrealtime s[8:9]
    s_waitcnt vmcnt(11)
    s_waitcnt lgkmcnt(0)
    s_sub_u32 s8, s8, s30
    s_cmpk_ge_u32 s8, 2001
    s_cbranch_scc1 .ap_168
    s_waitcnt vmcnt(5)
    s_cmpk_ge_u32 s8, 1936
    s_cbranch_scc1 .ap_168
    s_waitcnt vmcnt(3)
    s_bitcmp1_b64 s[14:15], 56
    s_cbranch_scc0 1
    s_waitcnt vmcnt(2)
    s_cmpk_ge_u32 s8, 1861
    s_cbranch_scc1 .ap_168
    s_waitcnt vmcnt(1)
.ap_168:
    s_add_u32 s63, s69, 393216
    buffer_load_dwordx4 v[36:39], v2, s[44:47], s63 offen nt
    s_memrealtime s[8:9]
    s_waitcnt vmcnt(11)
    s_waitcnt lgkmcnt(0)
    s_sub_u32 s8, s8, s30
    s_cmpk_ge_u32 s8, 2032
    s_cbranch_scc1 .ap_169
    s_waitcnt vmcnt(5)
    s_cmpk_ge_u32 s8, 1967
    s_cbranch_scc1 .ap_169
    s_waitcnt vmcnt(3)
    s_bitcmp1_b64 s[14:15], 57
    s_cbranch_scc0 1
    s_waitcnt vmcnt(2)
    s_cmpk_ge_u32 s8, 1892
    s_cbranch_scc1 .ap_169
    s_waitcnt vmcnt(1)
.ap_169:
    s_add_u32 s63, s69, 401408
    buffer_load_dwordx4 v[44:47], v2, s[44:47], s63 offen nt
    s_memrealtime s[8:9]
    s_waitcnt vmcnt(8)
    s_waitcnt lgkmcnt(0)
    s_sub_u32 s8, s8, s30
    s_cmpk_ge_u32 s8, 2063
    s_cbranch_scc1 .ap_170
    s_waitcnt vmcnt(5)
    s_cmpk_ge_u32 s8, 1998
    s_cbranch_scc1 .ap_170
    s_waitcnt vmcnt(3)
    s_bitcmp1_b64 s[14:15], 58
    s_cbranch_scc0 1
    s_waitcnt vmcnt(2)
    s_cmpk_ge_u32 s8, 1923
    s_cbranch_scc1 .ap_170
    s_waitcnt vmcnt(1)
.ap_170:
    s_add_u32 s63, s69, 409600
    buffer_load_dwordx4 v[52:55], v2, s[44:47], s63 offen nt
    s_waitcnt vmcnt(5)
    s_branch .gpc_172
.gp_171:
    buffer_load_dwordx4 v[24:27], v9, s[36:39], s59 offen offset:0 sc1
    s_waitcnt vmcnt(0)
.gpc_172:
    v_cmp_eq_u32 vcc, s34, v26
    v_cmp_eq_u32 s[56:57], s34, v27
    s_and_b64 vcc, vcc, s[56:57]
    s_cmp_eq_u64 vcc, exec
    s_nop 2
    s_cbranch_scc1 .gpd_173
    s_sub_u32 s35, s35, 1
    s_cbranch_scc1 .Lexit
    s_sleep 1
    s_branch .gp_171
.gpd_173:
    s_lshr_b64 s[88:89], s[88:89], s1
    s_and_b32 s88, s88, 0xff
    s_cmp_eq_u32 s88, 32
    s_cselect_b32 s0, 0xac000, 0
    v_mov_b32 v16, v24
    s_nop 1
    v_max_f32_dpp v16, v16, v16 quad_perm:[2,3,0,1] row_mask:0xf bank_mask:0xf
    v_sub_f32 v17, v24, v16
    v_sub_f32 v18, v14, v16
    v_mul_f32 v17, 0x3fb8aa3b, v17
    v_mul_f32 v18, 0x3fb8aa3b, v18
    v_exp_f32 v17, v17
    v_exp_f32 v18, v18
    v_mul_f32 v17, v17, v25
    s_nop 1
    v_add_f32_dpp v17, v17, v17 quad_perm:[2,3,0,1] row_mask:0xf bank_mask:0xf
    v_rcp_f32 v19, v17
    s_nop 0
    v_fma_f32 v15, -v17, v19, 1.0
    v_fma_f32 v19, v15, v19, v19
    v_mul_f32 v18, v18, v19
    v_mul_f32 v10, v10, v18
    v_mul_f32 v11, v11, v18
    v_mul_f32 v12, v12, v18
    v_mul_f32 v13, v13, v18
    v_mov_b32_dpp v112, v10 quad_perm:[2,3,0,1] row_mask:0xf bank_mask:0xf
    v_mov_b32_dpp v113, v11 quad_perm:[2,3,0,1] row_mask:0xf bank_mask:0xf
    v_mov_b32_dpp v114, v12 quad_perm:[2,3,0,1] row_mask:0xf bank_mask:0xf
    v_mov_b32_dpp v115, v13 quad_perm:[2,3,0,1] row_mask:0xf bank_mask:0xf
    v_cvt_pk_bf16_f32 v96, v10, v112
    v_cvt_pk_bf16_f32 v100, v11, v113
    v_cvt_pk_bf16_f32 v104, v12, v114
    v_cvt_pk_bf16_f32 v108, v13, v115
    v_mov_b32_dpp v97, v96 row_ror:12 row_mask:0xf bank_mask:0xf
    v_mov_b32_dpp v101, v100 row_ror:12 row_mask:0xf bank_mask:0xf
    v_mov_b32_dpp v105, v104 row_ror:12 row_mask:0xf bank_mask:0xf
    v_mov_b32_dpp v109, v108 row_ror:12 row_mask:0xf bank_mask:0xf
    v_mov_b32_dpp v98, v96 row_ror:8 row_mask:0xf bank_mask:0xf
    v_mov_b32_dpp v102, v100 row_ror:8 row_mask:0xf bank_mask:0xf
    v_mov_b32_dpp v106, v104 row_ror:8 row_mask:0xf bank_mask:0xf
    v_mov_b32_dpp v110, v108 row_ror:8 row_mask:0xf bank_mask:0xf
    v_mov_b32_dpp v99, v96 row_ror:4 row_mask:0xf bank_mask:0xf
    v_mov_b32_dpp v103, v100 row_ror:4 row_mask:0xf bank_mask:0xf
    v_mov_b32_dpp v107, v104 row_ror:4 row_mask:0xf bank_mask:0xf
    v_mov_b32_dpp v111, v108 row_ror:4 row_mask:0xf bank_mask:0xf
    v_mov_b32_dpp v96, v96 row_shr:3 row_mask:0xf bank_mask:0x2
    v_mov_b32_dpp v97, v97 row_shr:3 row_mask:0xf bank_mask:0x2
    v_mov_b32_dpp v98, v98 row_shr:3 row_mask:0xf bank_mask:0x2
    v_mov_b32_dpp v99, v99 row_shr:3 row_mask:0xf bank_mask:0x2
    v_mov_b32_dpp v100, v100 row_shr:3 row_mask:0xf bank_mask:0x2
    v_mov_b32_dpp v101, v101 row_shr:3 row_mask:0xf bank_mask:0x2
    v_mov_b32_dpp v102, v102 row_shr:3 row_mask:0xf bank_mask:0x2
    v_mov_b32_dpp v103, v103 row_shr:3 row_mask:0xf bank_mask:0x2
    v_mov_b32_dpp v104, v104 row_shr:3 row_mask:0xf bank_mask:0x2
    v_mov_b32_dpp v105, v105 row_shr:3 row_mask:0xf bank_mask:0x2
    v_mov_b32_dpp v106, v106 row_shr:3 row_mask:0xf bank_mask:0x2
    v_mov_b32_dpp v107, v107 row_shr:3 row_mask:0xf bank_mask:0x2
    v_mov_b32_dpp v108, v108 row_shr:3 row_mask:0xf bank_mask:0x2
    v_mov_b32_dpp v109, v109 row_shr:3 row_mask:0xf bank_mask:0x2
    v_mov_b32_dpp v110, v110 row_shr:3 row_mask:0xf bank_mask:0x2
    v_mov_b32_dpp v111, v111 row_shr:3 row_mask:0xf bank_mask:0x2
    s_memrealtime s[8:9]
    s_waitcnt lgkmcnt(0)
    s_sub_u32 s8, s8, s30
    s_cmpk_ge_u32 s8, 2094
    s_cbranch_scc1 .ap_174
    s_waitcnt vmcnt(5)
    s_cmpk_ge_u32 s8, 2029
    s_cbranch_scc1 .ap_174
    s_waitcnt vmcnt(3)
    s_bitcmp1_b64 s[14:15], 59
    s_cbranch_scc0 1
    s_waitcnt vmcnt(2)
    s_cmpk_ge_u32 s8, 1954
    s_cbranch_scc1 .ap_174
    s_waitcnt vmcnt(1)
.ap_174:
    s_add_u32 s63, s69, 417792
    buffer_load_dwordx4 v[60:63], v2, s[44:47], s63 offen nt
    s_lshl_b32 s60, s3, 10
    s_add_u32 s60, s60, 132096
    v_lshlrev_b32 v10, 5, v0
    v_add_u32 v10, s60, v10
    v_lshrrev_b32 v11, 5, v0
    v_lshlrev_b32 v11, 13, v11
    v_and_b32 v12, 31, v0
    v_lshl_add_u32 v11, v12, 4, v11
    v_add_u32 v9, 132096, v2
    v_mov_b32 v15, s34
    v_mov_b32 v13, 110592
    s_mov_b32 s1, s43
    v_bfe_u32 v16, v0, 1, 3
    v_mul_u32_u24 v16, 1312, v16
    v_lshrrev_b32 v7, 4, v0
    v_lshl_add_u32 v16, v7, 5, v16
    v_and_b32 v7, 1, v0
    v_lshl_add_u32 v16, v7, 4, v16
    v_add_u32 v16, 147456, v16
    s_mul_i32 s56, s3, 1312
    s_add_u32 s56, s56, 147456
    v_add_u32 v17, s56, v3
    v_add_u32 v18, s56, v4
    v_lshrrev_b32 v7, 4, v0
    v_bfe_u32 v8, v0, 1, 1
    v_lshl_add_u32 v7, v7, 1, v8
    v_bfe_u32 v8, v0, 2, 2
    v_lshl_add_u32 v19, v7, 3, v8
    v_lshlrev_b32 v19, 7, v19
    v_and_b32 v7, 3, v7
    v_lshrrev_b32 v8, 1, v8
    v_lshl_add_u32 v7, v7, 1, v8
    v_xor_b32 v7, s3, v7
    v_lshl_add_u32 v19, v7, 4, v19
    v_and_b32 v7, 1, v0
    v_lshl_add_u32 v19, v7, 3, v19
    v_add_u32 v20, 32768, v19
    v_lshrrev_b32 v7, 4, v0
    v_bfe_u32 v8, v0, 2, 2
    v_lshl_add_u32 v21, v7, 3, v8
    v_lshlrev_b32 v21, 7, v21
    v_and_b32 v7, 1, v7
    v_lshrrev_b32 v8, 1, v8
    v_lshl_add_u32 v7, v7, 1, v8
    s_and_b32 s56, s3, 1
    s_lshl_b32 s56, s56, 1
    v_xor_b32 v7, s56, v7
    v_and_b32 v8, 3, v0
    v_lshl_add_u32 v21, v8, 3, v21
    s_lshr_b32 s56, s3, 1
    s_mul_i32 s56, s56, 12288
    s_add_u32 s56, s56, 73728
    v_add_u32 v21, s56, v21
    v_xor_b32 v8, 1, v7
    v_lshl_add_u32 v22, v8, 5, v21
    v_lshl_add_u32 v21, v7, 5, v21
    v_bfe_u32 v7, v0, 1, 3
    v_mul_u32_u24 v23, 1312, v7
    v_mul_u32_u24 v24, 272, v7
    v_and_b32 v7, 48, v0
    s_lshr_b32 s56, s3, 1
    s_mul_i32 s57, s56, 192
    s_add_u32 s57, s57, 110592
    v_add3_u32 v23, v23, v7, s57
    s_mul_i32 s56, s56, 2176
    s_and_b32 s57, s3, 1
    s_lshl_b32 s57, s57, 7
    s_add_u32 s56, s56, s57
    s_add_u32 s56, s56, 122880
    v_add3_u32 v24, v24, v7, s56
    v_and_b32 v7, 1, v0
    v_lshl_add_u32 v24, v7, 6, v24
    v_and_b32 v7, 15, v0
    s_mul_i32 s56, s3, 272
    s_add_u32 s56, s56, 122880
    v_lshl_add_u32 v25, v7, 4, s56
    v_bfe_u32 v26, v0, 1, 4
    v_lshlrev_b32 v26, 4, v26
    s_mul_i32 s56, s3, 72
    v_add_u32 v7, s56, v0
    v_lshrrev_b32 v8, 4, v7
    v_lshlrev_b32 v27, 9, v8
    v_and_b32 v29, 15, v7
    v_lshl_add_u32 v27, v29, 4, v27
    v_and_b32 v29, 7, v7
    v_mul_u32_u24 v29, 1312, v29
    v_and_b32 v7, -8, v7
    v_add3_u32 v29, v29, v7, v13
    v_and_b32 v7, 7, v0
    v_add3_u32 v7, v7, s56, 64
    v_lshrrev_b32 v8, 4, v7
    v_lshlrev_b32 v28, 9, v8
    v_and_b32 v30, 15, v7
    v_lshl_add_u32 v28, v30, 4, v28
    v_and_b32 v30, 7, v7
    v_mul_u32_u24 v30, 1312, v30
    v_and_b32 v7, -8, v7
    v_add3_u32 v30, v30, v7, v13
    s_memrealtime s[8:9]
    s_waitcnt lgkmcnt(0)
    s_sub_u32 s8, s8, s30
    s_cmpk_ge_u32 s8, 2125
    s_cbranch_scc1 .ap_175
    s_waitcnt vmcnt(5)
    s_cmpk_ge_u32 s8, 2060
    s_cbranch_scc1 .ap_175
    s_waitcnt vmcnt(3)
    s_bitcmp1_b64 s[14:15], 60
    s_cbranch_scc0 1
    s_waitcnt vmcnt(2)
    s_cmpk_ge_u32 s8, 1985
    s_cbranch_scc1 .ap_175
    s_waitcnt vmcnt(1)
.ap_175:
    s_add_u32 s63, s69, 425984
    buffer_load_dwordx4 v[68:71], v2, s[44:47], s63 offen nt
    v_perm_b32 v112, v164, v160, s94
    v_perm_b32 v113, v172, v168, s94
    v_perm_b32 v114, v180, v176, s94
    v_perm_b32 v115, v188, v184, s94
    s_nop 1
    v_mfma_f32_16x16x32_bf16 v[128:131], v[96:99], v[112:115], 0
    v_perm_b32 v116, v164, v160, s95
    v_perm_b32 v117, v172, v168, s95
    v_perm_b32 v118, v180, v176, s95
    v_perm_b32 v119, v188, v184, s95
    s_nop 1
    v_mfma_f32_16x16x32_bf16 v[132:135], v[96:99], v[116:119], 0
    v_perm_b32 v120, v165, v161, s94
    v_perm_b32 v121, v173, v169, s94
    v_perm_b32 v122, v181, v177, s94
    v_perm_b32 v123, v189, v185, s94
    s_nop 1
    v_mfma_f32_16x16x32_bf16 v[136:139], v[96:99], v[120:123], 0
    v_perm_b32 v124, v165, v161, s95
    v_perm_b32 v125, v173, v169, s95
    v_perm_b32 v126, v181, v177, s95
    v_perm_b32 v127, v189, v185, s95
    s_nop 1
    v_mfma_f32_16x16x32_bf16 v[140:143], v[96:99], v[124:127], 0
    v_perm_b32 v112, v166, v162, s94
    v_perm_b32 v113, v174, v170, s94
    v_perm_b32 v114, v182, v178, s94
    v_perm_b32 v115, v190, v186, s94
    s_nop 1
    v_mfma_f32_16x16x32_bf16 v[144:147], v[96:99], v[112:115], 0
    v_perm_b32 v116, v166, v162, s95
    v_perm_b32 v117, v174, v170, s95
    v_perm_b32 v118, v182, v178, s95
    v_perm_b32 v119, v190, v186, s95
    s_nop 1
    v_mfma_f32_16x16x32_bf16 v[148:151], v[96:99], v[116:119], 0
    v_perm_b32 v120, v167, v163, s94
    v_perm_b32 v121, v175, v171, s94
    v_perm_b32 v122, v183, v179, s94
    v_perm_b32 v123, v191, v187, s94
    s_nop 1
    v_mfma_f32_16x16x32_bf16 v[152:155], v[96:99], v[120:123], 0
    v_perm_b32 v124, v167, v163, s95
    v_perm_b32 v125, v175, v171, s95
    v_perm_b32 v126, v183, v179, s95
    v_perm_b32 v127, v191, v187, s95
    s_nop 1
    v_mfma_f32_16x16x32_bf16 v[156:159], v[96:99], v[124:127], 0
    s_memrealtime s[8:9]
    s_waitcnt lgkmcnt(0)
    s_sub_u32 s8, s8, s30
    s_cmpk_ge_u32 s8, 2156
    s_nop 3
    s_cbranch_scc1 .ap_176
    s_waitcnt vmcnt(5)
    s_cmpk_ge_u32 s8, 2091
    s_cbranch_scc1 .ap_176
    s_waitcnt vmcnt(3)
    s_bitcmp1_b64 s[14:15], 61
    s_cbranch_scc0 1
    s_waitcnt vmcnt(2)
    s_cmpk_ge_u32 s8, 2016
    s_cbranch_scc1 .ap_176
    s_waitcnt vmcnt(1)
.ap_176:
    s_add_u32 s63, s69, 434176
    buffer_load_dwordx4 v[76:79], v2, s[44:47], s63 offen nt
    v_perm_b32 v112, v196, v192, s94
    v_perm_b32 v113, v204, v200, s94
    v_perm_b32 v114, v212, v208, s94
    v_perm_b32 v115, v220, v216, s94
    s_nop 1
    v_mfma_f32_16x16x32_bf16 v[128:131], v[100:103], v[112:115], v[128:131]
    v_perm_b32 v116, v196, v192, s95
    v_perm_b32 v117, v204, v200, s95
    v_perm_b32 v118, v212, v208, s95
    v_perm_b32 v119, v220, v216, s95
    s_nop 1
    v_mfma_f32_16x16x32_bf16 v[132:135], v[100:103], v[116:119], v[132:135]
    v_perm_b32 v120, v197, v193, s94
    v_perm_b32 v121, v205, v201, s94
    v_perm_b32 v122, v213, v209, s94
    v_perm_b32 v123, v221, v217, s94
    s_nop 1
    v_mfma_f32_16x16x32_bf16 v[136:139], v[100:103], v[120:123], v[136:139]
    v_perm_b32 v124, v197, v193, s95
    v_perm_b32 v125, v205, v201, s95
    v_perm_b32 v126, v213, v209, s95
    v_perm_b32 v127, v221, v217, s95
    s_nop 1
    v_mfma_f32_16x16x32_bf16 v[140:143], v[100:103], v[124:127], v[140:143]
    v_perm_b32 v112, v198, v194, s94
    v_perm_b32 v113, v206, v202, s94
    v_perm_b32 v114, v214, v210, s94
    v_perm_b32 v115, v222, v218, s94
    s_nop 1
    v_mfma_f32_16x16x32_bf16 v[144:147], v[100:103], v[112:115], v[144:147]
    v_perm_b32 v116, v198, v194, s95
    v_perm_b32 v117, v206, v202, s95
    v_perm_b32 v118, v214, v210, s95
    v_perm_b32 v119, v222, v218, s95
    s_nop 1
    v_mfma_f32_16x16x32_bf16 v[148:151], v[100:103], v[116:119], v[148:151]
    v_perm_b32 v120, v199, v195, s94
    v_perm_b32 v121, v207, v203, s94
    v_perm_b32 v122, v215, v211, s94
    v_perm_b32 v123, v223, v219, s94
    s_nop 1
    v_mfma_f32_16x16x32_bf16 v[152:155], v[100:103], v[120:123], v[152:155]
    v_perm_b32 v124, v199, v195, s95
    v_perm_b32 v125, v207, v203, s95
    v_perm_b32 v126, v215, v211, s95
    v_perm_b32 v127, v223, v219, s95
    s_nop 1
    v_mfma_f32_16x16x32_bf16 v[156:159], v[100:103], v[124:127], v[156:159]
    s_memrealtime s[8:9]
    s_waitcnt lgkmcnt(0)
    s_sub_u32 s8, s8, s30
    s_cmpk_ge_u32 s8, 2187
    s_nop 3
    s_cbranch_scc1 .ap_177
    s_waitcnt vmcnt(5)
    s_cmpk_ge_u32 s8, 2122
    s_cbranch_scc1 .ap_177
    s_waitcnt vmcnt(3)
    s_bitcmp1_b64 s[14:15], 62
    s_cbranch_scc0 1
    s_waitcnt vmcnt(2)
    s_cmpk_ge_u32 s8, 2047
    s_cbranch_scc1 .ap_177
    s_waitcnt vmcnt(1)
.ap_177:
    s_add_u32 s63, s69, 442368
    buffer_load_dwordx4 v[84:87], v2, s[44:47], s63 offen nt
    s_waitcnt vmcnt(7)
    v_perm_b32 v112, v228, v224, s94
    v_perm_b32 v113, v236, v232, s94
    v_perm_b32 v114, v244, v240, s94
    v_perm_b32 v115, v252, v248, s94
    s_nop 1
    v_mfma_f32_16x16x32_bf16 v[128:131], v[104:107], v[112:115], v[128:131]
    v_perm_b32 v116, v228, v224, s95
    v_perm_b32 v117, v236, v232, s95
    v_perm_b32 v118, v244, v240, s95
    v_perm_b32 v119, v252, v248, s95
    s_nop 1
    v_mfma_f32_16x16x32_bf16 v[132:135], v[104:107], v[116:119], v[132:135]
    v_perm_b32 v120, v229, v225, s94
    v_perm_b32 v121, v237, v233, s94
    v_perm_b32 v122, v245, v241, s94
    v_perm_b32 v123, v253, v249, s94
    s_nop 1
    v_mfma_f32_16x16x32_bf16 v[136:139], v[104:107], v[120:123], v[136:139]
    v_perm_b32 v124, v229, v225, s95
    v_perm_b32 v125, v237, v233, s95
    v_perm_b32 v126, v245, v241, s95
    v_perm_b32 v127, v253, v249, s95
    s_nop 1
    v_mfma_f32_16x16x32_bf16 v[140:143], v[104:107], v[124:127], v[140:143]
    v_perm_b32 v112, v230, v226, s94
    v_perm_b32 v113, v238, v234, s94
    v_perm_b32 v114, v246, v242, s94
    v_perm_b32 v115, v254, v250, s94
    s_nop 1
    v_mfma_f32_16x16x32_bf16 v[144:147], v[104:107], v[112:115], v[144:147]
    v_perm_b32 v116, v230, v226, s95
    v_perm_b32 v117, v238, v234, s95
    v_perm_b32 v118, v246, v242, s95
    v_perm_b32 v119, v254, v250, s95
    s_nop 1
    v_mfma_f32_16x16x32_bf16 v[148:151], v[104:107], v[116:119], v[148:151]
    v_perm_b32 v120, v231, v227, s94
    v_perm_b32 v121, v239, v235, s94
    v_perm_b32 v122, v247, v243, s94
    v_perm_b32 v123, v255, v251, s94
    s_nop 1
    v_mfma_f32_16x16x32_bf16 v[152:155], v[104:107], v[120:123], v[152:155]
    v_perm_b32 v124, v231, v227, s95
    v_perm_b32 v125, v239, v235, s95
    v_perm_b32 v126, v247, v243, s95
    v_perm_b32 v127, v255, v251, s95
    s_nop 1
    v_mfma_f32_16x16x32_bf16 v[156:159], v[104:107], v[124:127], v[156:159]
    s_memrealtime s[8:9]
    s_waitcnt lgkmcnt(0)
    s_sub_u32 s8, s8, s30
    s_cmpk_ge_u32 s8, 2218
    s_nop 3
    s_cbranch_scc1 .ap_178
    s_waitcnt vmcnt(5)
    s_cmpk_ge_u32 s8, 2153
    s_cbranch_scc1 .ap_178
    s_waitcnt vmcnt(3)
    s_bitcmp1_b64 s[14:15], 63
    s_cbranch_scc0 1
    s_waitcnt vmcnt(2)
    s_cmpk_ge_u32 s8, 2078
    s_cbranch_scc1 .ap_178
    s_waitcnt vmcnt(1)
.ap_178:
    s_add_u32 s63, s69, 450560
    buffer_load_dwordx4 v[92:95], v2, s[44:47], s63 offen nt
    s_setprio 0
    s_waitcnt vmcnt(6)
    v_perm_b32 v160, v44, v36, s94
    v_perm_b32 v164, v44, v36, s95
    v_perm_b32 v168, v45, v37, s94
    v_perm_b32 v172, v45, v37, s95
    v_perm_b32 v176, v46, v38, s94
    v_perm_b32 v180, v46, v38, s95
    v_perm_b32 v184, v47, v39, s94
    v_perm_b32 v188, v47, v39, s95
    s_waitcnt vmcnt(4)
    v_perm_b32 v161, v60, v52, s94
    v_perm_b32 v165, v60, v52, s95
    v_perm_b32 v169, v61, v53, s94
    v_perm_b32 v173, v61, v53, s95
    v_perm_b32 v177, v62, v54, s94
    v_perm_b32 v181, v62, v54, s95
    v_perm_b32 v185, v63, v55, s94
    v_perm_b32 v189, v63, v55, s95
    v_mfma_f32_16x16x16_bf16 v[128:131], v[108:109], v[160:161], v[128:131]
    v_mfma_f32_16x16x16_bf16 v[132:135], v[108:109], v[164:165], v[132:135]
    v_mfma_f32_16x16x16_bf16 v[136:139], v[108:109], v[168:169], v[136:139]
    v_mfma_f32_16x16x16_bf16 v[140:143], v[108:109], v[172:173], v[140:143]
    v_mfma_f32_16x16x16_bf16 v[144:147], v[108:109], v[176:177], v[144:147]
    v_mfma_f32_16x16x16_bf16 v[148:151], v[108:109], v[180:181], v[148:151]
    v_mfma_f32_16x16x16_bf16 v[152:155], v[108:109], v[184:185], v[152:155]
    v_mfma_f32_16x16x16_bf16 v[156:159], v[108:109], v[188:189], v[156:159]
    s_waitcnt vmcnt(2)
    v_perm_b32 v162, v76, v68, s94
    v_perm_b32 v166, v76, v68, s95
    v_perm_b32 v170, v77, v69, s94
    v_perm_b32 v174, v77, v69, s95
    v_perm_b32 v178, v78, v70, s94
    v_perm_b32 v182, v78, v70, s95
    v_perm_b32 v186, v79, v71, s94
    v_perm_b32 v190, v79, v71, s95
    s_lshl4_add_u32 s59, s67, s66
    s_lshl1_add_u32 s59, s59, s68
    s_lshl_b32 s59, s59, 9
    s_add_u32 s59, s59, 0x210000
    s_mov_b32 s60, 0x07060503
    s_mov_b32 s61, 0x07060502
    s_mov_b32 s62, 0x07060501
.Ltail_bc:
    s_waitcnt vmcnt(0)
    v_perm_b32 v163, v92, v84, s94
    v_perm_b32 v167, v92, v84, s95
    v_perm_b32 v171, v93, v85, s94
    v_perm_b32 v175, v93, v85, s95
    v_perm_b32 v179, v94, v86, s94
    v_perm_b32 v183, v94, v86, s95
    v_perm_b32 v187, v95, v87, s94
    v_perm_b32 v191, v95, v87, s95
    v_mfma_f32_16x16x16_bf16 v[128:131], v[110:111], v[162:163], v[128:131]
    v_mfma_f32_16x16x16_bf16 v[132:135], v[110:111], v[166:167], v[132:135]
    v_mfma_f32_16x16x16_bf16 v[136:139], v[110:111], v[170:171], v[136:139]
    v_mfma_f32_16x16x16_bf16 v[140:143], v[110:111], v[174:175], v[140:143]
    v_mfma_f32_16x16x16_bf16 v[144:147], v[110:111], v[178:179], v[144:147]
    v_mfma_f32_16x16x16_bf16 v[148:151], v[110:111], v[182:183], v[148:151]
    v_mfma_f32_16x16x16_bf16 v[152:155], v[110:111], v[186:187], v[152:155]
    v_mfma_f32_16x16x16_bf16 v[156:159], v[110:111], v[190:191], v[156:159]
    s_mov_b64 exec, 0xffffffff
    s_nop 0
    ds_write2_b32 v10, v128, v132 offset0:0 offset1:1
    s_nop 0
    ds_write2_b32 v10, v136, v140 offset0:2 offset1:3
    s_nop 0
    ds_write2_b32 v10, v144, v148 offset0:4 offset1:5
    s_nop 0
    ds_write2_b32 v10, v152, v156 offset0:6 offset1:7
    s_mov_b64 exec, -1
    s_lshl_b32 s32, s3, 10
    s_add_u32 m0, s32, 40960
    s_add_u32 s56, s101, 2949120
    buffer_load_dwordx4 v6, s[48:51], s56 offen nt lds
    s_add_u32 m0, s32, 49152
    s_add_u32 s56, s101, 3538944
    buffer_load_dwordx4 v6, s[48:51], s56 offen nt lds
    s_add_u32 m0, s32, 57344
    s_add_u32 s56, s101, 4128768
    buffer_load_dwordx4 v6, s[48:51], s56 offen nt lds
    s_waitcnt lgkmcnt(0)
    s_barrier
    s_cmp_lg_u32 s3, 7
    s_cbranch_scc1 .opub_179
    ds_read_b128 v[196:199], v9 offset:0
    ds_read_b128 v[200:203], v9 offset:1024
    ds_read_b128 v[204:207], v9 offset:2048
    ds_read_b128 v[208:211], v9 offset:3072
    ds_read_b128 v[212:215], v9 offset:4096
    ds_read_b128 v[216:219], v9 offset:5120
    ds_read_b128 v[220:223], v9 offset:6144
    ds_read_b128 v[224:227], v9 offset:7168
    s_waitcnt lgkmcnt(6)
    v_pk_add_f32 v[196:197], v[196:197], v[200:201]
    v_pk_add_f32 v[198:199], v[198:199], v[202:203]
    s_waitcnt lgkmcnt(4)
    v_pk_add_f32 v[204:205], v[204:205], v[208:209]
    v_pk_add_f32 v[206:207], v[206:207], v[210:211]
    v_pk_add_f32 v[196:197], v[196:197], v[204:205]
    v_pk_add_f32 v[198:199], v[198:199], v[206:207]
    s_waitcnt lgkmcnt(2)
    v_pk_add_f32 v[212:213], v[212:213], v[216:217]
    v_pk_add_f32 v[214:215], v[214:215], v[218:219]
    s_waitcnt lgkmcnt(0)
    v_pk_add_f32 v[220:221], v[220:221], v[224:225]
    v_pk_add_f32 v[222:223], v[222:223], v[226:227]
    v_pk_add_f32 v[212:213], v[212:213], v[220:221]
    v_pk_add_f32 v[214:215], v[214:215], v[222:223]
    v_pk_add_f32 v[196:197], v[196:197], v[212:213]
    v_pk_add_f32 v[198:199], v[198:199], v[214:215]
    v_perm_b32 v12, v196, v199, s60
    v_perm_b32 v13, v197, v199, s61
    v_perm_b32 v14, v198, v199, s62
    s_add_u32 s57, s59, 0xac000
    buffer_store_dwordx4 v[12:15], v11, s[36:39], s57 offen
    buffer_store_dwordx4 v[12:15], v11, s[36:39], s59 offen sc1
.opub_179:
    s_barrier
    s_bitcmp1_b32 s1, 0
    s_cbranch_scc1 .lt_180
    s_lshl_b32 s32, s3, 10
    s_add_u32 m0, s32, 0
    s_add_u32 s56, s101, 0
    buffer_load_dwordx4 v6, s[48:51], s56 offen nt lds
    s_add_u32 m0, s32, 8192
    s_add_u32 s56, s101, 589824
    buffer_load_dwordx4 v6, s[48:51], s56 offen nt lds
    s_add_u32 m0, s32, 16384
    s_add_u32 s56, s101, 1179648
    buffer_load_dwordx4 v6, s[48:51], s56 offen nt lds
    s_add_u32 m0, s32, 24576
    s_add_u32 s56, s101, 1769472
    buffer_load_dwordx4 v6, s[48:51], s56 offen nt lds
    s_add_u32 m0, s32, 32768
    s_add_u32 s56, s101, 2359296
    buffer_load_dwordx4 v6, s[48:51], s56 offen nt lds
.lt_180:
    s_lshl_b32 s32, s3, 10
    s_add_u32 m0, s32, 65536
    s_add_u32 s56, s101, 4718592
    buffer_load_dwordx4 v6, s[48:51], s56 offen nt lds
    s_add_u32 m0, s32, 73728
    s_add_u32 s56, s33, 0
    buffer_load_dwordx4 v31, s[52:55], s56 offen nt lds
    s_add_u32 m0, s32, 81920
    s_add_u32 s56, s33, 73728
    buffer_load_dwordx4 v31, s[52:55], s56 offen nt lds
    s_add_u32 m0, s32, 90112
    s_add_u32 s56, s33, 147456
    buffer_load_dwordx4 v31, s[52:55], s56 offen nt lds
    s_add_u32 m0, s32, 98304
    s_add_u32 s56, s33, 221184
    buffer_load_dwordx4 v31, s[52:55], s56 offen nt lds
    s_cmp_ge_u32 s3, 4
    s_cbranch_scc1 .nod_181
    s_add_u32 m0, s32, 106496
    s_add_u32 s56, s33, 294912
    buffer_load_dwordx4 v31, s[52:55], s56 offen nt lds
.nod_181:
    s_branch .gpc_183
.gp_182:
    buffer_load_dwordx4 v[32:35], v2, s[36:39], s99 offen offset:0 sc1
    buffer_load_dwordx4 v[40:43], v2, s[36:39], s99 offen offset:1024 sc1
    buffer_load_dwordx2 v[48:49], v5, s[36:39], s99 offen offset:0 sc1
    buffer_load_dwordx4 v[56:59], v2, s[36:39], s100 offen offset:0 sc1
    buffer_load_dwordx4 v[64:67], v2, s[36:39], s100 offen offset:1024 sc1
    buffer_load_dwordx2 v[50:51], v5, s[36:39], s100 offen offset:0 sc1
    s_waitcnt vmcnt(0)
.gpc_183:
    v_min_u32 v7, v33, v35
    v_max_u32 v8, v33, v35
    v_min3_u32 v7, v7, v41, v43
    v_max3_u32 v8, v8, v41, v43
    v_min3_u32 v7, v7, v49, v57
    v_max3_u32 v8, v8, v49, v57
    v_min3_u32 v7, v7, v59, v65
    v_max3_u32 v8, v8, v59, v65
    v_min3_u32 v7, v7, v67, v51
    v_max3_u32 v8, v8, v67, v51
    v_cmp_eq_u32 vcc, s34, v7
    v_cmp_eq_u32 s[56:57], s34, v8
    s_and_b64 vcc, vcc, s[56:57]
    s_cmp_eq_u64 vcc, exec
    s_nop 2
    s_cbranch_scc1 .gpd_184
    s_sub_u32 s35, s35, 1
    s_cbranch_scc1 .Lexit
    s_sleep 2
    s_branch .gp_182
.gpd_184:
    v_lshlrev_b32 v230, 16, v32
    v_and_b32 v231, 0xffff0000, v32
    v_lshlrev_b32 v240, 16, v56
    v_and_b32 v241, 0xffff0000, v56
    v_lshlrev_b32 v232, 16, v34
    v_and_b32 v233, 0xffff0000, v34
    v_lshlrev_b32 v242, 16, v58
    v_and_b32 v243, 0xffff0000, v58
    v_lshlrev_b32 v234, 16, v40
    v_and_b32 v235, 0xffff0000, v40
    v_lshlrev_b32 v244, 16, v64
    v_and_b32 v245, 0xffff0000, v64
    v_lshlrev_b32 v236, 16, v42
    v_and_b32 v237, 0xffff0000, v42
    v_lshlrev_b32 v246, 16, v66
    v_and_b32 v247, 0xffff0000, v66
    v_lshlrev_b32 v238, 16, v48
    v_and_b32 v239, 0xffff0000, v48
    v_lshlrev_b32 v248, 16, v50
    v_and_b32 v249, 0xffff0000, v50
    s_sub_u32 s63, s65, 9
    s_mul_i32 s42, s64, 18432
    s_mul_i32 s56, s3, 2304
    s_add_u32 s42, s42, s56
    s_add_u32 s42, s42, 0x250000
    s_mul_i32 s41, s64, 36864
    s_add_u32 s41, s41, 0x274000
    s_lshr_b32 s57, s63, 1
    s_lshl3_add_u32 s40, s57, s3
    s_and_b32 s63, s63, 1
    s_lshl1_add_u32 s40, s40, s63
    s_lshl_b32 s40, s40, 8
    s_add_u32 s40, s40, s41
    s_mul_i32 s56, s63, 18432
    s_add_u32 s41, s41, s56
    s_mul_i32 s43, s3, 9
    s_add_u32 s43, s43, s57
    s_lshl3_add_u32 s43, s43, s64
    s_lshl1_add_u32 s43, s43, s63
    s_lshl_b32 s43, s43, 8
    s_add_u32 s43, s43, 0x38c000
    v_mov_b32 v143, s34
    s_add_u32 s57, s40, 0xac000
    s_mov_b64 exec, 0xffff
    buffer_load_dwordx4 v[80:83], v2, s[36:39], s57 offen offset:0
    s_mov_b64 exec, -1
    s_waitcnt vmcnt(5)
    s_barrier
    ds_read_b64_tr_b16 v[160:161], v19 offset:0
    ds_read_b64_tr_b16 v[162:163], v19 offset:512
    ds_read_b64_tr_b16 v[164:165], v19 offset:8192
    ds_read_b64_tr_b16 v[166:167], v19 offset:8704
    ds_read_b64_tr_b16 v[168:169], v19 offset:16384
    ds_read_b64_tr_b16 v[170:171], v19 offset:16896
    ds_read_b64_tr_b16 v[172:173], v19 offset:24576
    ds_read_b64_tr_b16 v[174:175], v19 offset:25088
    ds_read_b64_tr_b16 v[176:177], v20 offset:0
    ds_read_b64_tr_b16 v[178:179], v20 offset:512
    ds_read_b64_tr_b16 v[180:181], v20 offset:8192
    ds_read_b64_tr_b16 v[182:183], v20 offset:8704
    ds_read_b64_tr_b16 v[184:185], v20 offset:16384
    ds_read_b64_tr_b16 v[186:187], v20 offset:16896
    ds_read_b64_tr_b16 v[188:189], v20 offset:24576
    ds_read_b64_tr_b16 v[190:191], v20 offset:25088
    ds_read_b64_tr_b16 v[192:193], v20 offset:32768
    ds_read_b64_tr_b16 v[194:195], v20 offset:33280
.Lbc_x:
    s_add_u32 s58, s42, s0
    s_mov_b32 s32, 0
    s_mov_b64 s[88:89], exec
    s_mov_b64 s[90:91], exec
    s_mov_b64 s[92:93], exec
.mp_185:
    s_mov_b64 exec, s[88:89]
    buffer_load_dwordx4 v[144:147], v2, s[36:39], s58 offen offset:0 sc1
    s_mov_b64 exec, s[90:91]
    buffer_load_dwordx4 v[148:151], v2, s[36:39], s58 offen offset:1024 sc1
    s_mov_b64 exec, s[92:93]
    buffer_load_dwordx2 v[152:153], v5, s[36:39], s58 offen offset:0 sc1
    s_mov_b64 exec, -1
    s_sub_u32 s35, s35, 1
    s_cbranch_scc1 .Lexit
    s_add_u32 s32, s32, 1
    s_cmp_eq_u32 s32, 64
    s_cselect_b32 s58, s42, s58
    s_waitcnt vmcnt(0)
.mpj_186:
    v_cmp_ne_u32 s[88:89], s34, v145
    v_cmp_ne_u32 vcc, s34, v147
    s_or_b64 s[88:89], s[88:89], vcc
    v_cmp_ne_u32 s[90:91], s34, v149
    v_cmp_ne_u32 vcc, s34, v151
    s_or_b64 s[90:91], s[90:91], vcc
    v_cmp_ne_u32 s[92:93], s34, v153
    s_or_b64 vcc, s[88:89], s[90:91]
    s_or_b64 vcc, vcc, s[92:93]
    s_cbranch_scc1 .mp_185
    s_mov_b32 s56, 0x3f803f80
    v_dot2_f32_bf16 v250, v144, s56, 0
    v_dot2_f32_bf16 v251, v144, v144, 0
    v_dot2_f32_bf16 v250, v146, s56, v250
    v_dot2_f32_bf16 v251, v146, v146, v251
    v_dot2_f32_bf16 v250, v148, s56, v250
    v_dot2_f32_bf16 v251, v148, v148, v251
    v_dot2_f32_bf16 v250, v150, s56, v250
    v_dot2_f32_bf16 v251, v150, v150, v251
    s_mov_b64 exec, 0xffffffff
    v_dot2_f32_bf16 v250, v152, s56, v250
    v_dot2_f32_bf16 v251, v152, v152, v251
    s_mov_b64 exec, -1
    s_nop 1
    v_permlane32_swap_b32 v250, v251
    v_add_f32 v250, v250, v251
    v_mov_b32 v252, v250
    s_nop 1
    v_permlane16_swap_b32 v252, v250
    v_add_f32 v250, v252, v250
    v_lshlrev_b32 v220, 16, v144
    v_and_b32 v221, 0xffff0000, v144
    v_add_f32_dpp v250, v250, v250 row_ror:8 row_mask:0xf bank_mask:0xf
    v_lshlrev_b32 v222, 16, v146
    v_and_b32 v223, 0xffff0000, v146
    v_add_f32_dpp v250, v250, v250 row_ror:4 row_mask:0xf bank_mask:0xf
    v_lshlrev_b32 v224, 16, v148
    v_and_b32 v225, 0xffff0000, v148
    v_add_f32_dpp v250, v250, v250 quad_perm:[2,3,0,1] row_mask:0xf bank_mask:0xf
    v_lshlrev_b32 v226, 16, v150
    v_and_b32 v227, 0xffff0000, v150
    v_add_f32_dpp v250, v250, v250 quad_perm:[1,0,3,2] row_mask:0xf bank_mask:0xf
    v_mul_f32 v250, 0x3ae38e39, v250
    v_lshlrev_b32 v228, 16, v152
    v_and_b32 v229, 0xffff0000, v152
    v_readlane_b32 s56, v250, 0
    v_readlane_b32 s57, v250, 32
    s_nop 0
    v_mov_b32 v250, s56
    v_fma_f32 v251, -v250, v250, s57
    v_max_f32 v251, 0, v251
    v_add_f32 v251, 0x3727c5ac, v251
    v_rsq_f32 v252, v251
    s_nop 0
    v_mul_f32 v251, -v250, v252
    v_mul_f32 v250, -v250, v252
    v_mov_b32 v253, v252
    v_pk_fma_f32 v[220:221], v[220:221], v[252:253], v[250:251]
    v_pk_fma_f32 v[222:223], v[222:223], v[252:253], v[250:251]
    v_pk_fma_f32 v[224:225], v[224:225], v[252:253], v[250:251]
    v_pk_fma_f32 v[226:227], v[226:227], v[252:253], v[250:251]
    v_pk_fma_f32 v[228:229], v[228:229], v[252:253], v[250:251]
    v_pk_fma_f32 v[220:221], v[220:221], v[240:241], v[230:231]
    v_pk_fma_f32 v[222:223], v[222:223], v[242:243], v[232:233]
    v_pk_fma_f32 v[224:225], v[224:225], v[244:245], v[234:235]
    v_pk_fma_f32 v[226:227], v[226:227], v[246:247], v[236:237]
    v_pk_fma_f32 v[228:229], v[228:229], v[248:249], v[238:239]
    v_cvt_pk_bf16_f32 v154, v220, v221
    v_cvt_pk_bf16_f32 v155, v222, v223
    v_cvt_pk_bf16_f32 v156, v224, v225
    v_cvt_pk_bf16_f32 v157, v226, v227
    v_cvt_pk_bf16_f32 v158, v228, v229
    ds_write_b64 v17, v[154:155]
    ds_write_b64 v17, v[156:157] offset:512
    ds_write_b32 v18, v158
    s_waitcnt lgkmcnt(0)
    s_barrier
    ds_read_b128 v[96:99], v16 offset:0
    ds_read_b128 v[100:103], v16 offset:128
    ds_read_b128 v[104:107], v16 offset:256
    ds_read_b128 v[108:111], v16 offset:384
    ds_read_b128 v[112:115], v16 offset:512
    ds_read_b128 v[116:119], v16 offset:640
    ds_read_b128 v[120:123], v16 offset:768
    ds_read_b128 v[124:127], v16 offset:896
    ds_read_b128 v[128:131], v16 offset:1024
    s_waitcnt lgkmcnt(8)
    v_mfma_f32_16x16x32_bf16 v[132:135], v[160:163], v[96:99], 0
    s_waitcnt lgkmcnt(7)
    v_mfma_f32_16x16x32_bf16 v[132:135], v[164:167], v[100:103], v[132:135]
    s_waitcnt lgkmcnt(6)
    v_mfma_f32_16x16x32_bf16 v[132:135], v[168:171], v[104:107], v[132:135]
    s_waitcnt lgkmcnt(5)
    v_mfma_f32_16x16x32_bf16 v[132:135], v[172:175], v[108:111], v[132:135]
    s_waitcnt lgkmcnt(4)
    v_mfma_f32_16x16x32_bf16 v[132:135], v[176:179], v[112:115], v[132:135]
    s_waitcnt lgkmcnt(3)
    v_mfma_f32_16x16x32_bf16 v[132:135], v[180:183], v[116:119], v[132:135]
    s_waitcnt lgkmcnt(2)
    v_mfma_f32_16x16x32_bf16 v[132:135], v[184:187], v[120:123], v[132:135]
    s_waitcnt lgkmcnt(1)
    v_mfma_f32_16x16x32_bf16 v[132:135], v[188:191], v[124:127], v[132:135]
    s_waitcnt lgkmcnt(0)
    v_mfma_f32_16x16x32_bf16 v[132:135], v[192:195], v[128:131], v[132:135]
    s_cmp_lg_u32 s63, 0
    s_nop 6
    v_permlane32_swap_b32 v132, v134
    v_permlane32_swap_b32 v133, v135
    v_cndmask_b32 v133, v133, v134, s[96:97]
    v_cndmask_b32 v132, v132, v135, s[96:97]
    s_nop 1
    v_add_f32_dpp v12, v133, v132 quad_perm:[1,0,3,2] row_mask:0xf bank_mask:0xf
    s_nop 1
    s_cbranch_scc1 .up_189
    v_mul_f32 v7, 0xbfb8aa3b, v12
    v_exp_f32 v7, v7
    s_nop 0
    v_add_f32 v7, 1.0, v7
    v_rcp_f32 v7, v7
    s_nop 0
    v_mul_f32 v12, v12, v7
.up_189:
    s_nop 1
    v_mov_b32_dpp v137, v12 quad_perm:[0,0,2,2] row_mask:0xf bank_mask:0xf
    v_mov_b32_dpp v139, v12 quad_perm:[1,1,3,3] row_mask:0xf bank_mask:0xf
    v_cvt_pk_bf16_f32 v136, v137, v139
    v_cvt_pk_bf16_f32 v138, v137, v139
    v_mov_b32 v137, s34
    v_mov_b32 v139, s34
    v_permlane32_swap_b32 v136, v138
    s_mov_b64 exec, 0x55555555
    s_add_u32 s57, s40, 0xac000
    buffer_store_dwordx4 v[136:139], v26, s[36:39], s57 offen
    s_cmp_lg_u32 s0, 0
    s_cbranch_scc1 2
    buffer_store_dwordx4 v[136:139], v26, s[36:39], s40 offen sc1
    s_mov_b64 exec, -1
    s_barrier
    ds_read_b64_tr_b16 v[196:197], v21 offset:0
    ds_read_b64_tr_b16 v[198:199], v21 offset:512
    ds_read_b64_tr_b16 v[208:209], v22 offset:0
    ds_read_b64_tr_b16 v[210:211], v22 offset:512
    ds_read_b64_tr_b16 v[200:201], v21 offset:4096
    ds_read_b64_tr_b16 v[202:203], v21 offset:4608
    ds_read_b64_tr_b16 v[212:213], v22 offset:4096
    ds_read_b64_tr_b16 v[214:215], v22 offset:4608
    ds_read_b64_tr_b16 v[204:205], v21 offset:8192
    ds_read_b64_tr_b16 v[206:207], v21 offset:8704
    ds_read_b64_tr_b16 v[216:217], v22 offset:8192
    ds_read_b64_tr_b16 v[218:219], v22 offset:8704
    s_add_u32 s58, s41, s0
    s_mov_b32 s32, 0
    s_mov_b64 s[88:89], exec
    s_mov_b64 s[90:91], exec
    s_and_b64 s[92:93], exec, 0xff
    s_and_b64 s[56:57], exec, 0xff
.mp_190:
    s_mov_b64 exec, s[88:89]
    buffer_load_dwordx4 v[160:163], v27, s[36:39], s58 offen offset:0 sc1
    s_mov_b64 exec, s[90:91]
    buffer_load_dwordx4 v[164:167], v27, s[36:39], s58 offen offset:256 sc1
    s_mov_b64 exec, s[92:93]
    buffer_load_dwordx4 v[168:171], v28, s[36:39], s58 offen offset:0 sc1
    s_mov_b64 exec, s[56:57]
    buffer_load_dwordx4 v[172:175], v28, s[36:39], s58 offen offset:256 sc1
    s_mov_b64 exec, -1
    s_sub_u32 s35, s35, 1
    s_cbranch_scc1 .Lexit
    s_add_u32 s32, s32, 1
    s_cmp_eq_u32 s32, 64
    s_cselect_b32 s58, s41, s58
    s_cbranch_scc0 .mpi_192
    s_mov_b64 exec, 0x55555555
    buffer_store_dwordx4 v[136:139], v26, s[36:39], s40 offen sc1
    s_mov_b64 exec, -1
.mpi_192:
    s_waitcnt vmcnt(0)
.mpj_191:
    v_cmp_ne_u32 s[88:89], s34, v161
    v_cmp_ne_u32 vcc, s34, v163
    s_or_b64 s[88:89], s[88:89], vcc
    v_cmp_ne_u32 s[90:91], s34, v165
    v_cmp_ne_u32 vcc, s34, v167
    s_or_b64 s[90:91], s[90:91], vcc
    v_cmp_ne_u32 s[92:93], s34, v169
    v_cmp_ne_u32 vcc, s34, v171
    s_or_b64 s[92:93], s[92:93], vcc
    s_and_b64 s[92:93], s[92:93], 0xff
    v_cmp_ne_u32 s[56:57], s34, v173
    v_cmp_ne_u32 vcc, s34, v175
    s_or_b64 s[56:57], s[56:57], vcc
    s_and_b64 s[56:57], s[56:57], 0xff
    s_or_b64 vcc, s[88:89], s[90:91]
    s_or_b64 vcc, vcc, s[92:93]
    s_or_b64 vcc, vcc, s[56:57]
    s_cbranch_scc1 .mp_190
    v_and_b32 v161, 0xffff0000, v160
    v_lshlrev_b32 v160, 16, v160
    v_and_b32 v163, 0xffff0000, v162
    v_lshlrev_b32 v162, 16, v162
    v_and_b32 v165, 0xffff0000, v164
    v_lshlrev_b32 v164, 16, v164
    v_and_b32 v167, 0xffff0000, v166
    v_lshlrev_b32 v166, 16, v166
    v_and_b32 v169, 0xffff0000, v168
    v_lshlrev_b32 v168, 16, v168
    v_and_b32 v171, 0xffff0000, v170
    v_lshlrev_b32 v170, 16, v170
    v_and_b32 v173, 0xffff0000, v172
    v_lshlrev_b32 v172, 16, v172
    v_and_b32 v175, 0xffff0000, v174
    v_lshlrev_b32 v174, 16, v174
    v_pk_mul_f32 v[160:161], v[160:161], v[164:165]
    v_pk_mul_f32 v[162:163], v[162:163], v[166:167]
    v_pk_mul_f32 v[168:169], v[168:169], v[172:173]
    v_pk_mul_f32 v[170:171], v[170:171], v[174:175]
    v_cvt_pk_bf16_f32 v160, v160, v161
    v_cvt_pk_bf16_f32 v161, v162, v163
    v_cvt_pk_bf16_f32 v168, v168, v169
    v_cvt_pk_bf16_f32 v169, v170, v171
    ds_write_b64 v29, v[160:161]
    s_mov_b64 exec, 0xff
    ds_write_b64 v30, v[168:169]
    s_mov_b64 exec, -1
    s_mov_b64 exec, 0x55555555
    buffer_store_dwordx4 v[136:139], v26, s[36:39], s40 offen sc1
    s_mov_b64 exec, -1
    s_waitcnt lgkmcnt(0)
    s_barrier
    s_cmp_ge_u32 s3, 6
    s_cbranch_scc1 .tg_194
    ds_read_b128 v[96:99], v23 offset:0
    ds_read_b128 v[100:103], v23 offset:64
    ds_read_b128 v[104:107], v23 offset:128
    s_waitcnt lgkmcnt(2)
    v_mfma_f32_16x16x32_bf16 v[132:135], v[196:199], v[96:99], 0
    v_mfma_f32_16x16x32_bf16 v[136:139], v[208:211], v[96:99], 0
    s_waitcnt lgkmcnt(1)
    v_mfma_f32_16x16x32_bf16 v[132:135], v[200:203], v[100:103], v[132:135]
    v_mfma_f32_16x16x32_bf16 v[136:139], v[212:215], v[100:103], v[136:139]
    s_waitcnt lgkmcnt(0)
    v_mfma_f32_16x16x32_bf16 v[132:135], v[204:207], v[104:107], v[132:135]
    v_mfma_f32_16x16x32_bf16 v[136:139], v[216:219], v[104:107], v[136:139]
    s_nop 7
    v_cndmask_b32 v132, v132, v136, s[96:97]
    v_cndmask_b32 v133, v133, v137, s[96:97]
    v_cndmask_b32 v134, v134, v138, s[96:97]
    v_cndmask_b32 v135, v135, v139, s[96:97]
    ds_write_b128 v24, v[132:135]
    s_waitcnt lgkmcnt(0)
.tg_194:
    s_barrier
    ds_read_b128 v[112:115], v25 offset:0
    ds_read_b128 v[116:119], v25 offset:2176
    ds_read_b128 v[120:123], v25 offset:4352
    s_mov_b32 s60, 0x07060503
    s_mov_b32 s61, 0x07060502
    s_mov_b32 s62, 0x07060501
    s_waitcnt lgkmcnt(1)
    v_pk_add_f32 v[112:113], v[112:113], v[116:117]
    v_pk_add_f32 v[114:115], v[114:115], v[118:119]
    s_waitcnt lgkmcnt(0)
    v_pk_add_f32 v[112:113], v[112:113], v[120:121]
    v_pk_add_f32 v[114:115], v[114:115], v[122:123]
    v_perm_b32 v140, v112, v115, s60
    v_perm_b32 v141, v113, v115, s61
    v_perm_b32 v142, v114, v115, s62
    s_mov_b64 exec, 0xffff
    buffer_store_dwordx4 v[140:143], v2, s[36:39], s43 offen sc1
    s_mov_b64 exec, -1
    s_nop 0
    s_branch .Lexit
.Latt_n:
    v_and_b32 v8, 1, v0
    v_lshlrev_b32 v8, 8, v8
    v_and_b32 v9, 0x3c, v0
    v_lshl_add_u32 v9, v9, 2, v8
    v_lshlrev_b32 v7, 1, v9
    v_and_b32 v9, 0x3c, v0
    v_lshrrev_b32 v8, 4, v8
    v_and_b32 v9, 2, v0
    v_lshl_add_u32 v9, v9, 6, v8
    s_lshl_b32 s58, s66, 14
    s_lshl_b32 s59, s67, 10
    s_add_u32 s58, s58, s59
    s_add_u32 s58, s58, 0x40000
    s_lshl4_add_u32 s59, s66, s67
    s_lshl_b32 s59, s59, 8
    s_add_u32 s59, s59, 0x200000
    s_memrealtime s[8:9]
    s_waitcnt vmcnt(8)
    s_waitcnt lgkmcnt(0)
    s_sub_u32 s8, s8, s30
    s_cmpk_ge_u32 s8, 1147
    s_cbranch_scc1 .ap_195
    s_waitcnt vmcnt(5)
    s_cmpk_ge_u32 s8, 1082
    s_cbranch_scc1 .ap_195
    s_waitcnt vmcnt(3)
    s_bitcmp1_b64 s[14:15], 26
    s_cbranch_scc0 1
    s_waitcnt vmcnt(2)
    s_cmpk_ge_u32 s8, 1007
    s_cbranch_scc1 .ap_195
    s_waitcnt vmcnt(1)
.ap_195:
    s_add_u32 s63, s69, 409600
    buffer_load_dwordx4 v[88:91], v1, s[40:43], s63 offen nt
    s_memrealtime s[8:9]
    s_waitcnt vmcnt(8)
    s_waitcnt lgkmcnt(0)
    s_sub_u32 s8, s8, s30
    s_cmpk_ge_u32 s8, 1174
    s_cbranch_scc1 .ap_196
    s_waitcnt vmcnt(5)
    s_cmpk_ge_u32 s8, 1109
    s_cbranch_scc1 .ap_196
    s_waitcnt vmcnt(3)
    s_bitcmp1_b64 s[14:15], 27
    s_cbranch_scc0 1
    s_waitcnt vmcnt(2)
    s_cmpk_ge_u32 s8, 1034
    s_cbranch_scc1 .ap_196
    s_waitcnt vmcnt(1)
.ap_196:
    s_add_u32 s63, s69, 417792
    buffer_load_dwordx4 v[92:95], v1, s[40:43], s63 offen nt
    s_memrealtime s[8:9]
    s_waitcnt vmcnt(8)
    s_waitcnt lgkmcnt(0)
    s_sub_u32 s8, s8, s30
    s_cmpk_ge_u32 s8, 1201
    s_cbranch_scc1 .ap_197
    s_waitcnt vmcnt(5)
    s_cmpk_ge_u32 s8, 1136
    s_cbranch_scc1 .ap_197
    s_waitcnt vmcnt(3)
    s_bitcmp1_b64 s[14:15], 28
    s_cbranch_scc0 1
    s_waitcnt vmcnt(2)
    s_cmpk_ge_u32 s8, 1061
    s_cbranch_scc1 .ap_197
    s_waitcnt vmcnt(1)
.ap_197:
    s_add_u32 s63, s69, 425984
    buffer_load_dwordx4 v[120:123], v1, s[40:43], s63 offen nt
    s_memrealtime s[8:9]
    s_waitcnt vmcnt(8)
    s_waitcnt lgkmcnt(0)
    s_sub_u32 s8, s8, s30
    s_cmpk_ge_u32 s8, 1228
    s_cbranch_scc1 .ap_198
    s_waitcnt vmcnt(5)
    s_cmpk_ge_u32 s8, 1163
    s_cbranch_scc1 .ap_198
    s_waitcnt vmcnt(3)
    s_bitcmp1_b64 s[14:15], 29
    s_cbranch_scc0 1
    s_waitcnt vmcnt(2)
    s_cmpk_ge_u32 s8, 1088
    s_cbranch_scc1 .ap_198
    s_waitcnt vmcnt(1)
.ap_198:
    s_add_u32 s63, s69, 434176
    buffer_load_dwordx4 v[124:127], v1, s[40:43], s63 offen nt
    s_memrealtime s[8:9]
    s_waitcnt vmcnt(8)
    s_waitcnt lgkmcnt(0)
    s_sub_u32 s8, s8, s30
    s_cmpk_ge_u32 s8, 1255
    s_cbranch_scc1 .ap_199
    s_waitcnt vmcnt(5)
    s_cmpk_ge_u32 s8, 1190
    s_cbranch_scc1 .ap_199
    s_waitcnt vmcnt(3)
    s_bitcmp1_b64 s[14:15], 30
    s_cbranch_scc0 1
    s_waitcnt vmcnt(2)
    s_cmpk_ge_u32 s8, 1115
    s_cbranch_scc1 .ap_199
    s_waitcnt vmcnt(1)
.ap_199:
    s_add_u32 s63, s69, 442368
    buffer_load_dwordx4 v[152:155], v1, s[40:43], s63 offen nt
    s_memrealtime s[8:9]
    s_waitcnt vmcnt(8)
    s_waitcnt lgkmcnt(0)
    s_sub_u32 s8, s8, s30
    s_cmpk_ge_u32 s8, 1282
    s_cbranch_scc1 .ap_200
    s_waitcnt vmcnt(5)
    s_cmpk_ge_u32 s8, 1217
    s_cbranch_scc1 .ap_200
    s_waitcnt vmcnt(3)
    s_bitcmp1_b64 s[14:15], 31
    s_cbranch_scc0 1
    s_waitcnt vmcnt(2)
    s_cmpk_ge_u32 s8, 1142
    s_cbranch_scc1 .ap_200
    s_waitcnt vmcnt(1)
.ap_200:
    s_add_u32 s63, s69, 450560
    buffer_load_dwordx4 v[156:159], v1, s[40:43], s63 offen nt
    buffer_load_dwordx4 v[16:19], v7, s[36:39], s58 offen offset:0 sc1
    buffer_load_dwordx4 v[20:23], v7, s[36:39], s58 offen offset:16 sc1
    s_memrealtime s[8:9]
    s_waitcnt vmcnt(8)
    s_waitcnt lgkmcnt(0)
    s_sub_u32 s8, s8, s30
    s_cmpk_ge_u32 s8, 1309
    s_cbranch_scc1 .ap_201
    s_waitcnt vmcnt(5)
    s_cmpk_ge_u32 s8, 1244
    s_cbranch_scc1 .ap_201
    s_waitcnt vmcnt(3)
    s_bitcmp1_b64 s[14:15], 32
    s_cbranch_scc0 1
    s_waitcnt vmcnt(2)
    s_cmpk_ge_u32 s8, 1169
    s_cbranch_scc1 .ap_201
    s_waitcnt vmcnt(1)
.ap_201:
    s_add_u32 s63, s69, 0
    buffer_load_dwordx4 v[160:163], v2, s[44:47], s63 offen nt
    s_memrealtime s[8:9]
    s_waitcnt vmcnt(8)
    s_waitcnt lgkmcnt(0)
    s_sub_u32 s8, s8, s30
    s_cmpk_ge_u32 s8, 1336
    s_cbranch_scc1 .ap_202
    s_waitcnt vmcnt(5)
    s_cmpk_ge_u32 s8, 1271
    s_cbranch_scc1 .ap_202
    s_waitcnt vmcnt(3)
    s_bitcmp1_b64 s[14:15], 33
    s_cbranch_scc0 1
    s_waitcnt vmcnt(2)
    s_cmpk_ge_u32 s8, 1196
    s_cbranch_scc1 .ap_202
    s_waitcnt vmcnt(1)
.ap_202:
    s_add_u32 s63, s69, 8192
    buffer_load_dwordx4 v[164:167], v2, s[44:47], s63 offen nt
    s_memrealtime s[8:9]
    s_waitcnt vmcnt(8)
    s_waitcnt lgkmcnt(0)
    s_sub_u32 s8, s8, s30
    s_cmpk_ge_u32 s8, 1363
    s_cbranch_scc1 .ap_203
    s_waitcnt vmcnt(5)
    s_cmpk_ge_u32 s8, 1298
    s_cbranch_scc1 .ap_203
    s_waitcnt vmcnt(3)
    s_bitcmp1_b64 s[14:15], 34
    s_cbranch_scc0 1
    s_waitcnt vmcnt(2)
    s_cmpk_ge_u32 s8, 1223
    s_cbranch_scc1 .ap_203
    s_waitcnt vmcnt(1)
.ap_203:
    s_add_u32 s63, s69, 16384
    buffer_load_dwordx4 v[168:171], v2, s[44:47], s63 offen nt
    s_waitcnt vmcnt(3)
    s_branch .gpc_205
.gp_204:
    buffer_load_dwordx4 v[16:19], v7, s[36:39], s58 offen offset:0 sc1
    buffer_load_dwordx4 v[20:23], v7, s[36:39], s58 offen offset:16 sc1
    s_waitcnt vmcnt(0)
.gpc_205:
    v_min_u32 v10, v17, v19
    v_max_u32 v11, v17, v19
    v_min3_u32 v10, v10, v21, v23
    v_max3_u32 v11, v11, v21, v23
    v_cmp_eq_u32 vcc, s34, v10
    v_cmp_eq_u32 s[56:57], s34, v11
    s_and_b64 vcc, vcc, s[56:57]
    s_cmp_eq_u64 vcc, exec
    s_nop 2
    s_cbranch_scc1 .gpd_206
    s_sub_u32 s35, s35, 1
    s_cbranch_scc1 .Lexit
    s_sleep 1
    s_branch .gp_204
.gpd_206:
    s_mov_b32 vcc_lo, 0xcccccccc
    s_mov_b32 vcc_hi, 0xcccccccc
    v_cndmask_b32_e64 v24, v16, 0, vcc
    v_cndmask_b32_e64 v25, v18, 0, vcc
    v_cndmask_b32_e64 v26, v20, 0, vcc
    v_cndmask_b32_e64 v27, v22, 0, vcc
    v_cndmask_b32_e32 v28, 0, v16, vcc
    v_cndmask_b32_e32 v29, 0, v18, vcc
    v_cndmask_b32_e32 v30, 0, v20, vcc
    v_cndmask_b32_e32 v31, 0, v22, vcc
    v_mfma_f32_16x16x32_bf16 v[16:19], v[32:35], v[24:27], 0
    v_mfma_f32_16x16x32_bf16 v[32:35], v[40:43], v[24:27], 0
    v_mfma_f32_16x16x32_bf16 v[16:19], v[36:39], v[28:31], v[16:19]
    v_mfma_f32_16x16x32_bf16 v[40:43], v[48:51], v[24:27], 0
    v_mfma_f32_16x16x32_bf16 v[32:35], v[44:47], v[28:31], v[32:35]
    v_mfma_f32_16x16x32_bf16 v[48:51], v[56:59], v[24:27], 0
    v_mfma_f32_16x16x32_bf16 v[40:43], v[52:55], v[28:31], v[40:43]
    v_mfma_f32_16x16x32_bf16 v[56:59], v[64:67], v[24:27], 0
    v_mfma_f32_16x16x32_bf16 v[48:51], v[60:63], v[28:31], v[48:51]
    s_nop 1
    v_add_f32_dpp v10, v17, v16 row_ror:12 row_mask:0xf bank_mask:0x1
    s_memrealtime s[8:9]
    s_waitcnt lgkmcnt(0)
    s_sub_u32 s8, s8, s30
    s_cmpk_ge_u32 s8, 1390
    s_nop 0
    s_cbranch_scc1 .ap_207
    s_waitcnt vmcnt(3)
    s_cmpk_ge_u32 s8, 1325
    s_cbranch_scc1 .ap_207
    s_waitcnt vmcnt(3)
    s_bitcmp1_b64 s[14:15], 35
    s_cbranch_scc0 1
    s_waitcnt vmcnt(2)
    s_cmpk_ge_u32 s8, 1250
    s_cbranch_scc1 .ap_207
    s_waitcnt vmcnt(1)
.ap_207:
    s_add_u32 s63, s69, 24576
    buffer_load_dwordx4 v[172:175], v2, s[44:47], s63 offen nt
    v_mfma_f32_16x16x32_bf16 v[64:67], v[72:75], v[24:27], 0
    v_mfma_f32_16x16x32_bf16 v[56:59], v[68:71], v[28:31], v[56:59]
    v_add_f32_dpp v11, v33, v32 row_ror:12 row_mask:0xf bank_mask:0x1
    v_add_f32_dpp v10, v18, v10 row_ror:8 row_mask:0xf bank_mask:0x1
    v_mfma_f32_16x16x32_bf16 v[72:75], v[80:83], v[24:27], 0
    v_mfma_f32_16x16x32_bf16 v[64:67], v[76:79], v[28:31], v[64:67]
    v_add_f32_dpp v12, v41, v40 row_ror:12 row_mask:0xf bank_mask:0x1
    v_add_f32_dpp v11, v34, v11 row_ror:8 row_mask:0xf bank_mask:0x1
    v_add_f32_dpp v10, v19, v10 row_ror:4 row_mask:0xf bank_mask:0x1
    v_mfma_f32_16x16x32_bf16 v[80:83], v[88:91], v[24:27], 0
    v_mfma_f32_16x16x32_bf16 v[72:75], v[84:87], v[28:31], v[72:75]
    v_add_f32_dpp v13, v49, v48 row_ror:12 row_mask:0xf bank_mask:0x1
    v_add_f32_dpp v12, v42, v12 row_ror:8 row_mask:0xf bank_mask:0x1
    v_add_f32_dpp v11, v35, v11 row_ror:4 row_mask:0xf bank_mask:0x1
    v_mfma_f32_16x16x32_bf16 v[88:91], v[96:99], v[24:27], 0
    v_mfma_f32_16x16x32_bf16 v[80:83], v[92:95], v[28:31], v[80:83]
    v_add_f32_dpp v10, v58, v57 row_ror:12 row_mask:0xf bank_mask:0x2
    v_add_f32_dpp v13, v50, v13 row_ror:8 row_mask:0xf bank_mask:0x1
    v_add_f32_dpp v12, v43, v12 row_ror:4 row_mask:0xf bank_mask:0x1
    s_memrealtime s[8:9]
    s_waitcnt lgkmcnt(0)
    s_sub_u32 s8, s8, s30
    s_cmpk_ge_u32 s8, 1417
    s_nop 0
    s_cbranch_scc1 .ap_208
    s_waitcnt vmcnt(4)
    s_cmpk_ge_u32 s8, 1352
    s_cbranch_scc1 .ap_208
    s_waitcnt vmcnt(3)
    s_bitcmp1_b64 s[14:15], 36
    s_cbranch_scc0 1
    s_waitcnt vmcnt(2)
    s_cmpk_ge_u32 s8, 1277
    s_cbranch_scc1 .ap_208
    s_waitcnt vmcnt(1)
.ap_208:
    s_add_u32 s63, s69, 32768
    buffer_load_dwordx4 v[176:179], v2, s[44:47], s63 offen nt
    v_mfma_f32_16x16x32_bf16 v[96:99], v[104:107], v[24:27], 0
    v_mfma_f32_16x16x32_bf16 v[88:91], v[100:103], v[28:31], v[88:91]
    v_add_f32_dpp v11, v66, v65 row_ror:12 row_mask:0xf bank_mask:0x2
    v_add_f32_dpp v10, v59, v10 row_ror:8 row_mask:0xf bank_mask:0x2
    v_add_f32_dpp v13, v51, v13 row_ror:4 row_mask:0xf bank_mask:0x1
    v_mfma_f32_16x16x32_bf16 v[104:107], v[112:115], v[24:27], 0
    v_mfma_f32_16x16x32_bf16 v[96:99], v[108:111], v[28:31], v[96:99]
    v_add_f32_dpp v12, v74, v73 row_ror:12 row_mask:0xf bank_mask:0x2
    v_add_f32_dpp v11, v67, v11 row_ror:8 row_mask:0xf bank_mask:0x2
    v_add_f32_dpp v10, v56, v10 row_ror:4 row_mask:0xf bank_mask:0x2
    v_mfma_f32_16x16x32_bf16 v[112:115], v[120:123], v[24:27], 0
    v_mfma_f32_16x16x32_bf16 v[104:107], v[116:119], v[28:31], v[104:107]
    v_add_f32_dpp v13, v82, v81 row_ror:12 row_mask:0xf bank_mask:0x2
    v_add_f32_dpp v12, v75, v12 row_ror:8 row_mask:0xf bank_mask:0x2
    v_add_f32_dpp v11, v64, v11 row_ror:4 row_mask:0xf bank_mask:0x2
    v_mfma_f32_16x16x32_bf16 v[120:123], v[128:131], v[24:27], 0
    v_mfma_f32_16x16x32_bf16 v[112:115], v[124:127], v[28:31], v[112:115]
    v_add_f32_dpp v10, v91, v90 row_ror:12 row_mask:0xf bank_mask:0x4
    v_add_f32_dpp v13, v83, v13 row_ror:8 row_mask:0xf bank_mask:0x2
    v_add_f32_dpp v12, v72, v12 row_ror:4 row_mask:0xf bank_mask:0x2
    s_memrealtime s[8:9]
    s_waitcnt lgkmcnt(0)
    s_sub_u32 s8, s8, s30
    s_cmpk_ge_u32 s8, 1444
    s_nop 0
    s_cbranch_scc1 .ap_209
    s_waitcnt vmcnt(5)
    s_cmpk_ge_u32 s8, 1379
    s_cbranch_scc1 .ap_209
    s_waitcnt vmcnt(3)
    s_bitcmp1_b64 s[14:15], 37
    s_cbranch_scc0 1
    s_waitcnt vmcnt(2)
    s_cmpk_ge_u32 s8, 1304
    s_cbranch_scc1 .ap_209
    s_waitcnt vmcnt(1)
.ap_209:
    s_add_u32 s63, s69, 40960
    buffer_load_dwordx4 v[180:183], v2, s[44:47], s63 offen nt
    v_mfma_f32_16x16x32_bf16 v[128:131], v[136:139], v[24:27], 0
    v_mfma_f32_16x16x32_bf16 v[120:123], v[132:135], v[28:31], v[120:123]
    v_add_f32_dpp v11, v99, v98 row_ror:12 row_mask:0xf bank_mask:0x4
    v_add_f32_dpp v10, v88, v10 row_ror:8 row_mask:0xf bank_mask:0x4
    v_add_f32_dpp v13, v80, v13 row_ror:4 row_mask:0xf bank_mask:0x2
    v_mfma_f32_16x16x32_bf16 v[136:139], v[144:147], v[24:27], 0
    v_mfma_f32_16x16x32_bf16 v[128:131], v[140:143], v[28:31], v[128:131]
    v_add_f32_dpp v12, v107, v106 row_ror:12 row_mask:0xf bank_mask:0x4
    v_add_f32_dpp v11, v96, v11 row_ror:8 row_mask:0xf bank_mask:0x4
    v_add_f32_dpp v10, v89, v10 row_ror:4 row_mask:0xf bank_mask:0x4
    v_mfma_f32_16x16x32_bf16 v[144:147], v[152:155], v[24:27], 0
    v_mfma_f32_16x16x32_bf16 v[136:139], v[148:151], v[28:31], v[136:139]
    v_add_f32_dpp v13, v115, v114 row_ror:12 row_mask:0xf bank_mask:0x4
    v_add_f32_dpp v12, v104, v12 row_ror:8 row_mask:0xf bank_mask:0x4
    v_add_f32_dpp v11, v97, v11 row_ror:4 row_mask:0xf bank_mask:0x4
    v_mfma_f32_16x16x32_bf16 v[144:147], v[156:159], v[28:31], v[144:147]
    v_add_f32_dpp v10, v120, v123 row_ror:12 row_mask:0xf bank_mask:0x8
    v_add_f32_dpp v13, v112, v13 row_ror:8 row_mask:0xf bank_mask:0x4
    v_add_f32_dpp v12, v105, v12 row_ror:4 row_mask:0xf bank_mask:0x4
    s_memrealtime s[8:9]
    s_waitcnt lgkmcnt(0)
    s_sub_u32 s8, s8, s30
    s_cmpk_ge_u32 s8, 1471
    s_nop 0
    s_cbranch_scc1 .ap_210
    s_waitcnt vmcnt(5)
    s_cmpk_ge_u32 s8, 1406
    s_cbranch_scc1 .ap_210
    s_waitcnt vmcnt(3)
    s_bitcmp1_b64 s[14:15], 38
    s_cbranch_scc0 1
    s_waitcnt vmcnt(2)
    s_cmpk_ge_u32 s8, 1331
    s_cbranch_scc1 .ap_210
    s_waitcnt vmcnt(1)
.ap_210:
    s_add_u32 s63, s69, 49152
    buffer_load_dwordx4 v[184:187], v2, s[44:47], s63 offen nt
    v_add_f32_dpp v11, v128, v131 row_ror:12 row_mask:0xf bank_mask:0x8
    v_add_f32_dpp v10, v121, v10 row_ror:8 row_mask:0xf bank_mask:0x8
    v_add_f32_dpp v13, v113, v13 row_ror:4 row_mask:0xf bank_mask:0x4
    v_add_f32_dpp v12, v136, v139 row_ror:12 row_mask:0xf bank_mask:0x8
    v_add_f32_dpp v11, v129, v11 row_ror:8 row_mask:0xf bank_mask:0x8
    v_add_f32_dpp v10, v122, v10 row_ror:4 row_mask:0xf bank_mask:0x8
    v_add_f32_dpp v13, v144, v147 row_ror:12 row_mask:0xf bank_mask:0x8
    v_add_f32_dpp v12, v137, v12 row_ror:8 row_mask:0xf bank_mask:0x8
    v_add_f32_dpp v11, v130, v11 row_ror:4 row_mask:0xf bank_mask:0x8
    v_add_f32_dpp v13, v145, v13 row_ror:8 row_mask:0xf bank_mask:0x8
    v_add_f32_dpp v12, v138, v12 row_ror:4 row_mask:0xf bank_mask:0x8
    s_memrealtime s[8:9]
    s_waitcnt lgkmcnt(0)
    s_sub_u32 s8, s8, s30
    s_cmpk_ge_u32 s8, 1498
    s_cbranch_scc1 .ap_211
    s_waitcnt vmcnt(5)
    s_cmpk_ge_u32 s8, 1433
    s_cbranch_scc1 .ap_211
    s_waitcnt vmcnt(3)
    s_bitcmp1_b64 s[14:15], 39
    s_cbranch_scc0 1
    s_waitcnt vmcnt(2)
    s_cmpk_ge_u32 s8, 1358
    s_cbranch_scc1 .ap_211
    s_waitcnt vmcnt(1)
.ap_211:
    s_add_u32 s63, s69, 57344
    buffer_load_dwordx4 v[188:191], v2, s[44:47], s63 offen nt
    v_add_f32_dpp v13, v146, v13 row_ror:4 row_mask:0xf bank_mask:0x8
    s_mov_b32 s60, 0x3db504f3
    s_mov_b32 s61, 0x3db504f3
    v_cvt_pk_bf16_f32 v10, 0, v10
    v_cvt_pk_bf16_f32 v11, 0, v11
    v_cvt_pk_bf16_f32 v12, 0, v12
    v_cvt_pk_bf16_f32 v13, 0, v13
    v_pk_mul_f32 v[10:11], v[10:11], s[60:61]
    v_pk_mul_f32 v[12:13], v[12:13], s[60:61]
    v_cvt_pk_bf16_f32 v10, 0, v10
    v_cvt_pk_bf16_f32 v11, 0, v11
    v_cvt_pk_bf16_f32 v12, 0, v12
    v_cvt_pk_bf16_f32 v13, 0, v13
    v_max_f32 v14, v10, v11
    v_max3_f32 v14, v14, v12, v13
    s_mov_b32 s60, 0x3fb8aa3b
    v_mov_b32 v22, s34
    v_mov_b32 v23, s34
    v_max_f32_dpp v14, v14, v14 quad_perm:[2,3,0,1] row_mask:0xf bank_mask:0xf
    s_nop 1
    v_max_f32_dpp v14, v14, v14 row_ror:4 row_mask:0xf bank_mask:0xf
    s_nop 1
    v_max_f32_dpp v14, v14, v14 row_ror:8 row_mask:0xf bank_mask:0xf
    v_mov_b32 v15, v14
    s_nop 1
    v_permlane16_swap_b32 v15, v14
    v_max_f32 v14, v15, v14
    v_mov_b32 v15, v14
    s_nop 1
    v_permlane32_swap_b32 v15, v14
    v_max_f32 v14, v15, v14
    v_mul_f32 v15, 0xbfb8aa3b, v14
    v_fma_f32 v10, v10, s60, v15
    v_fma_f32 v11, v11, s60, v15
    v_fma_f32 v12, v12, s60, v15
    v_fma_f32 v13, v13, s60, v15
    v_exp_f32 v10, v10
    v_exp_f32 v11, v11
    v_exp_f32 v12, v12
    v_exp_f32 v13, v13
    v_mov_b32 v20, v14
    v_pk_add_f32 v[16:17], v[10:11], v[12:13]
    v_add_f32 v21, v16, v17
    s_lshl3_add_u32 s60, s68, s3
    s_lshl_b32 s60, s60, 5
    s_add_u32 s60, s60, s59
    v_add_f32_dpp v21, v21, v21 quad_perm:[2,3,0,1] row_mask:0xf bank_mask:0xf
    s_nop 1
    v_add_f32_dpp v21, v21, v21 row_ror:4 row_mask:0xf bank_mask:0xf
    s_nop 1
    v_add_f32_dpp v21, v21, v21 row_ror:8 row_mask:0xf bank_mask:0xf
    v_mov_b32 v15, v21
    s_nop 1
    v_permlane16_swap_b32 v15, v21
    v_add_f32 v21, v15, v21
    v_mov_b32 v15, v21
    s_nop 1
    v_permlane32_swap_b32 v15, v21
    v_add_f32 v21, v15, v21
    s_lshl_b32 s60, s3, 4
    s_add_u32 s60, s60, 159104
    v_add_u32 v16, s60, v3
    v_mov_b32 v17, 159232
    v_mov_b32 v18, 1
    s_mov_b64 exec, 3
    ds_write_b64 v16, v[20:21]
    s_mov_b64 exec, 1
    s_waitcnt lgkmcnt(0)
    ds_add_rtn_u32 v18, v17, v18
    s_mov_b64 exec, -1
    v_and_b32 v16, 0x78, v3
    v_add_u32 v16, 159104, v16
    s_waitcnt lgkmcnt(0)
    v_readfirstlane_b32 s60, v18
    s_cmp_lg_u32 s60, 7
    s_nop 3
    s_cbranch_scc1 .ml_212
    ds_read_b64 v[18:19], v16
    s_lshl_b32 s60, s68, 7
    s_add_u32 s60, s60, s59
    s_waitcnt lgkmcnt(0)
    v_mov_b32 v20, v18
    s_nop 1
    v_max_f32_dpp v20, v20, v20 quad_perm:[2,3,0,1] row_mask:0xf bank_mask:0xf
    s_nop 1
    v_max_f32_dpp v20, v20, v20 row_ror:4 row_mask:0xf bank_mask:0xf
    s_nop 1
    v_max_f32_dpp v20, v20, v20 row_ror:8 row_mask:0xf bank_mask:0xf
    v_sub_f32 v18, v18, v20
    v_mul_f32 v18, 0x3fb8aa3b, v18
    v_exp_f32 v18, v18
    s_nop 0
    v_mul_f32 v21, v18, v19
    s_nop 1
    v_add_f32_dpp v21, v21, v21 quad_perm:[2,3,0,1] row_mask:0xf bank_mask:0xf
    s_nop 1
    v_add_f32_dpp v21, v21, v21 row_ror:4 row_mask:0xf bank_mask:0xf
    s_nop 1
    v_add_f32_dpp v21, v21, v21 row_ror:8 row_mask:0xf bank_mask:0xf
    s_mov_b64 exec, 0xff
    buffer_store_dwordx4 v[20:23], v2, s[36:39], s60 offen sc1
    s_mov_b64 exec, -1
.ml_212:
    s_memrealtime s[8:9]
    s_waitcnt lgkmcnt(0)
    s_sub_u32 s8, s8, s30
    s_cmpk_ge_u32 s8, 1525
    s_cbranch_scc1 .ap_213
    s_waitcnt vmcnt(5)
    s_cmpk_ge_u32 s8, 1460
    s_cbranch_scc1 .ap_213
    s_waitcnt vmcnt(3)
    s_bitcmp1_b64 s[14:15], 40
    s_cbranch_scc0 1
    s_waitcnt vmcnt(2)
    s_cmpk_ge_u32 s8, 1385
    s_cbranch_scc1 .ap_213
    s_waitcnt vmcnt(1)
.ap_213:
    s_add_u32 s63, s69, 131072
    buffer_load_dwordx4 v[192:195], v2, s[44:47], s63 offen nt
    s_memrealtime s[8:9]
    s_waitcnt vmcnt(8)
    s_waitcnt lgkmcnt(0)
    s_sub_u32 s8, s8, s30
    s_cmpk_ge_u32 s8, 1552
    s_cbranch_scc1 .ap_214
    s_waitcnt vmcnt(5)
    s_cmpk_ge_u32 s8, 1487
    s_cbranch_scc1 .ap_214
    s_waitcnt vmcnt(3)
    s_bitcmp1_b64 s[14:15], 41
    s_cbranch_scc0 1
    s_waitcnt vmcnt(2)
    s_cmpk_ge_u32 s8, 1412
    s_cbranch_scc1 .ap_214
    s_waitcnt vmcnt(1)
.ap_214:
    s_add_u32 s63, s69, 139264
    buffer_load_dwordx4 v[196:199], v2, s[44:47], s63 offen nt
    s_memrealtime s[8:9]
    s_waitcnt vmcnt(8)
    s_waitcnt lgkmcnt(0)
    s_sub_u32 s8, s8, s30
    s_cmpk_ge_u32 s8, 1579
    s_cbranch_scc1 .ap_215
    s_waitcnt vmcnt(5)
    s_cmpk_ge_u32 s8, 1514
    s_cbranch_scc1 .ap_215
    s_waitcnt vmcnt(3)
    s_bitcmp1_b64 s[14:15], 42
    s_cbranch_scc0 1
    s_waitcnt vmcnt(2)
    s_cmpk_ge_u32 s8, 1439
    s_cbranch_scc1 .ap_215
    s_waitcnt vmcnt(1)
.ap_215:
    s_add_u32 s63, s69, 147456
    buffer_load_dwordx4 v[200:203], v2, s[44:47], s63 offen nt
    s_memrealtime s[8:9]
    s_waitcnt vmcnt(8)
    s_waitcnt lgkmcnt(0)
    s_sub_u32 s8, s8, s30
    s_cmpk_ge_u32 s8, 1606
    s_cbranch_scc1 .ap_216
    s_waitcnt vmcnt(5)
    s_cmpk_ge_u32 s8, 1541
    s_cbranch_scc1 .ap_216
    s_waitcnt vmcnt(3)
    s_bitcmp1_b64 s[14:15], 43
    s_cbranch_scc0 1
    s_waitcnt vmcnt(2)
    s_cmpk_ge_u32 s8, 1466
    s_cbranch_scc1 .ap_216
    s_waitcnt vmcnt(1)
.ap_216:
    s_add_u32 s63, s69, 155648
    buffer_load_dwordx4 v[204:207], v2, s[44:47], s63 offen nt
    s_memrealtime s[8:9]
    s_waitcnt vmcnt(8)
    s_waitcnt lgkmcnt(0)
    s_sub_u32 s8, s8, s30
    s_cmpk_ge_u32 s8, 1633
    s_cbranch_scc1 .ap_217
    s_waitcnt vmcnt(5)
    s_cmpk_ge_u32 s8, 1568
    s_cbranch_scc1 .ap_217
    s_waitcnt vmcnt(3)
    s_bitcmp1_b64 s[14:15], 44
    s_cbranch_scc0 1
    s_waitcnt vmcnt(2)
    s_cmpk_ge_u32 s8, 1493
    s_cbranch_scc1 .ap_217
    s_waitcnt vmcnt(1)
.ap_217:
    s_add_u32 s63, s69, 163840
    buffer_load_dwordx4 v[208:211], v2, s[44:47], s63 offen nt
    s_memrealtime s[8:9]
    s_waitcnt vmcnt(8)
    s_waitcnt lgkmcnt(0)
    s_sub_u32 s8, s8, s30
    s_cmpk_ge_u32 s8, 1660
    s_cbranch_scc1 .ap_218
    s_waitcnt vmcnt(5)
    s_cmpk_ge_u32 s8, 1595
    s_cbranch_scc1 .ap_218
    s_waitcnt vmcnt(3)
    s_bitcmp1_b64 s[14:15], 45
    s_cbranch_scc0 1
    s_waitcnt vmcnt(2)
    s_cmpk_ge_u32 s8, 1520
    s_cbranch_scc1 .ap_218
    s_waitcnt vmcnt(1)
.ap_218:
    s_add_u32 s63, s69, 172032
    buffer_load_dwordx4 v[212:215], v2, s[44:47], s63 offen nt
    s_memrealtime s[8:9]
    s_waitcnt vmcnt(8)
    s_waitcnt lgkmcnt(0)
    s_sub_u32 s8, s8, s30
    s_cmpk_ge_u32 s8, 1691
    s_cbranch_scc1 .ap_219
    s_waitcnt vmcnt(5)
    s_cmpk_ge_u32 s8, 1626
    s_cbranch_scc1 .ap_219
    s_waitcnt vmcnt(3)
    s_bitcmp1_b64 s[14:15], 46
    s_cbranch_scc0 1
    s_waitcnt vmcnt(2)
    s_cmpk_ge_u32 s8, 1551
    s_cbranch_scc1 .ap_219
    s_waitcnt vmcnt(1)
.ap_219:
    s_add_u32 s63, s69, 180224
    buffer_load_dwordx4 v[216:219], v2, s[44:47], s63 offen nt
    s_memrealtime s[8:9]
    s_waitcnt vmcnt(8)
    s_waitcnt lgkmcnt(0)
    s_sub_u32 s8, s8, s30
    s_cmpk_ge_u32 s8, 1722
    s_cbranch_scc1 .ap_220
    s_waitcnt vmcnt(5)
    s_cmpk_ge_u32 s8, 1657
    s_cbranch_scc1 .ap_220
    s_waitcnt vmcnt(3)
    s_bitcmp1_b64 s[14:15], 47
    s_cbranch_scc0 1
    s_waitcnt vmcnt(2)
    s_cmpk_ge_u32 s8, 1582
    s_cbranch_scc1 .ap_220
    s_waitcnt vmcnt(1)
.ap_220:
    s_add_u32 s63, s69, 188416
    buffer_load_dwordx4 v[220:223], v2, s[44:47], s63 offen nt
    s_memrealtime s[8:9]
    s_waitcnt vmcnt(8)
    s_waitcnt lgkmcnt(0)
    s_sub_u32 s8, s8, s30
    s_cmpk_ge_u32 s8, 1753
    s_cbranch_scc1 .ap_221
    s_waitcnt vmcnt(5)
    s_cmpk_ge_u32 s8, 1688
    s_cbranch_scc1 .ap_221
    s_waitcnt vmcnt(3)
    s_bitcmp1_b64 s[14:15], 48
    s_cbranch_scc0 1
    s_waitcnt vmcnt(2)
    s_cmpk_ge_u32 s8, 1613
    s_cbranch_scc1 .ap_221
    s_waitcnt vmcnt(1)
.ap_221:
    s_add_u32 s63, s69, 262144
    buffer_load_dwordx4 v[224:227], v2, s[44:47], s63 offen nt
    s_memrealtime s[8:9]
    s_waitcnt vmcnt(8)
    s_waitcnt lgkmcnt(0)
    s_sub_u32 s8, s8, s30
    s_cmpk_ge_u32 s8, 1784
    s_cbranch_scc1 .ap_222
    s_waitcnt vmcnt(5)
    s_cmpk_ge_u32 s8, 1719
    s_cbranch_scc1 .ap_222
    s_waitcnt vmcnt(3)
    s_bitcmp1_b64 s[14:15], 49
    s_cbranch_scc0 1
    s_waitcnt vmcnt(2)
    s_cmpk_ge_u32 s8, 1644
    s_cbranch_scc1 .ap_222
    s_waitcnt vmcnt(1)
.ap_222:
    s_add_u32 s63, s69, 270336
    buffer_load_dwordx4 v[228:231], v2, s[44:47], s63 offen nt
    s_memrealtime s[8:9]
    s_waitcnt vmcnt(8)
    s_waitcnt lgkmcnt(0)
    s_sub_u32 s8, s8, s30
    s_cmpk_ge_u32 s8, 1815
    s_cbranch_scc1 .ap_223
    s_waitcnt vmcnt(5)
    s_cmpk_ge_u32 s8, 1750
    s_cbranch_scc1 .ap_223
    s_waitcnt vmcnt(3)
    s_bitcmp1_b64 s[14:15], 50
    s_cbranch_scc0 1
    s_waitcnt vmcnt(2)
    s_cmpk_ge_u32 s8, 1675
    s_cbranch_scc1 .ap_223
    s_waitcnt vmcnt(1)
.ap_223:
    s_add_u32 s63, s69, 278528
    buffer_load_dwordx4 v[232:235], v2, s[44:47], s63 offen nt
    s_memrealtime s[8:9]
    s_waitcnt vmcnt(8)
    s_waitcnt lgkmcnt(0)
    s_sub_u32 s8, s8, s30
    s_cmpk_ge_u32 s8, 1846
    s_cbranch_scc1 .ap_224
    s_waitcnt vmcnt(5)
    s_cmpk_ge_u32 s8, 1781
    s_cbranch_scc1 .ap_224
    s_waitcnt vmcnt(3)
    s_bitcmp1_b64 s[14:15], 51
    s_cbranch_scc0 1
    s_waitcnt vmcnt(2)
    s_cmpk_ge_u32 s8, 1706
    s_cbranch_scc1 .ap_224
    s_waitcnt vmcnt(1)
.ap_224:
    s_add_u32 s63, s69, 286720
    buffer_load_dwordx4 v[236:239], v2, s[44:47], s63 offen nt
    s_memrealtime s[8:9]
    s_waitcnt vmcnt(8)
    s_waitcnt lgkmcnt(0)
    s_sub_u32 s8, s8, s30
    s_cmpk_ge_u32 s8, 1877
    s_cbranch_scc1 .ap_225
    s_waitcnt vmcnt(5)
    s_cmpk_ge_u32 s8, 1812
    s_cbranch_scc1 .ap_225
    s_waitcnt vmcnt(3)
    s_bitcmp1_b64 s[14:15], 52
    s_cbranch_scc0 1
    s_waitcnt vmcnt(2)
    s_cmpk_ge_u32 s8, 1737
    s_cbranch_scc1 .ap_225
    s_waitcnt vmcnt(1)
.ap_225:
    s_add_u32 s63, s69, 294912
    buffer_load_dwordx4 v[240:243], v2, s[44:47], s63 offen nt
    s_memrealtime s[8:9]
    s_waitcnt vmcnt(8)
    s_waitcnt lgkmcnt(0)
    s_sub_u32 s8, s8, s30
    s_cmpk_ge_u32 s8, 1908
    s_cbranch_scc1 .ap_226
    s_waitcnt vmcnt(5)
    s_cmpk_ge_u32 s8, 1843
    s_cbranch_scc1 .ap_226
    s_waitcnt vmcnt(3)
    s_bitcmp1_b64 s[14:15], 53
    s_cbranch_scc0 1
    s_waitcnt vmcnt(2)
    s_cmpk_ge_u32 s8, 1768
    s_cbranch_scc1 .ap_226
    s_waitcnt vmcnt(1)
.ap_226:
    s_add_u32 s63, s69, 303104
    buffer_load_dwordx4 v[244:247], v2, s[44:47], s63 offen nt
    s_load_dwordx2 s[88:89], s[6:7], s0
    buffer_load_dwordx4 v[24:27], v9, s[36:39], s59 offen offset:0 sc1
    s_memrealtime s[8:9]
    s_waitcnt vmcnt(8)
    s_waitcnt lgkmcnt(0)
    s_sub_u32 s8, s8, s30
    s_cmpk_ge_u32 s8, 1939
    s_cbranch_scc1 .ap_227
    s_waitcnt vmcnt(5)
    s_cmpk_ge_u32 s8, 1874
    s_cbranch_scc1 .ap_227
    s_waitcnt vmcnt(3)
    s_bitcmp1_b64 s[14:15], 54
    s_cbranch_scc0 1
    s_waitcnt vmcnt(2)
    s_cmpk_ge_u32 s8, 1799
    s_cbranch_scc1 .ap_227
    s_waitcnt vmcnt(1)
.ap_227:
    s_add_u32 s63, s69, 311296
    buffer_load_dwordx4 v[248:251], v2, s[44:47], s63 offen nt
    s_sub_u32 s56, s65, 27
    s_lshl3_add_u32 s56, s56, s3
    s_cmp_ge_u32 s56, 11
    s_cbranch_scc1 .cpf_228
    s_getpc_b64 s[8:9]
.Lcpf_pc:
    s_cmp_ge_u32 s56, 6
    s_mov_b32 s57, .Lcpf_pc-.Ltail_ar
    s_cselect_b32 s57, .Lcpf_pc-.Ltail_bc+6144, s57
    s_lshl_b32 s56, s56, 10
    s_sub_u32 s56, s57, s56
    s_sub_u32 s8, s8, s56
    s_subb_u32 s9, s9, 0
    v_mov_b32 v41, s9
    v_add_co_u32 v40, vcc, s8, v2
    s_nop 1
    v_addc_co_u32 v41, vcc, 0, v41, vcc
    global_load_dwordx4 v[32:35], v[40:41], off
.cpf_228:
    s_memrealtime s[8:9]
    s_waitcnt vmcnt(8)
    s_waitcnt lgkmcnt(0)
    s_sub_u32 s8, s8, s30
    s_cmpk_ge_u32 s8, 1970
    s_cbranch_scc1 .ap_229
    s_waitcnt vmcnt(5)
    s_cmpk_ge_u32 s8, 1905
    s_cbranch_scc1 .ap_229
    s_waitcnt vmcnt(3)
    s_bitcmp1_b64 s[14:15], 55
    s_cbranch_scc0 1
    s_waitcnt vmcnt(2)
    s_cmpk_ge_u32 s8, 1830
    s_cbranch_scc1 .ap_229
    s_waitcnt vmcnt(1)
.ap_229:
    s_add_u32 s63, s69, 319488
    buffer_load_dwordx4 v[252:255], v2, s[44:47], s63 offen nt
    s_memrealtime s[8:9]
    s_waitcnt vmcnt(8)
    s_waitcnt lgkmcnt(0)
    s_sub_u32 s8, s8, s30
    s_cmpk_ge_u32 s8, 2001
    s_cbranch_scc1 .ap_230
    s_waitcnt vmcnt(5)
    s_cmpk_ge_u32 s8, 1936
    s_cbranch_scc1 .ap_230
    s_waitcnt vmcnt(3)
    s_bitcmp1_b64 s[14:15], 56
    s_cbranch_scc0 1
    s_waitcnt vmcnt(2)
    s_cmpk_ge_u32 s8, 1861
    s_cbranch_scc1 .ap_230
    s_waitcnt vmcnt(1)
.ap_230:
    s_add_u32 s63, s69, 393216
    buffer_load_dwordx4 v[36:39], v2, s[44:47], s63 offen nt
    s_memrealtime s[8:9]
    s_waitcnt vmcnt(8)
    s_waitcnt lgkmcnt(0)
    s_sub_u32 s8, s8, s30
    s_cmpk_ge_u32 s8, 2032
    s_cbranch_scc1 .ap_231
    s_waitcnt vmcnt(5)
    s_cmpk_ge_u32 s8, 1967
    s_cbranch_scc1 .ap_231
    s_waitcnt vmcnt(3)
    s_bitcmp1_b64 s[14:15], 57
    s_cbranch_scc0 1
    s_waitcnt vmcnt(2)
    s_cmpk_ge_u32 s8, 1892
    s_cbranch_scc1 .ap_231
    s_waitcnt vmcnt(1)
.ap_231:
    s_add_u32 s63, s69, 401408
    buffer_load_dwordx4 v[44:47], v2, s[44:47], s63 offen nt
    s_memrealtime s[8:9]
    s_waitcnt vmcnt(8)
    s_waitcnt lgkmcnt(0)
    s_sub_u32 s8, s8, s30
    s_cmpk_ge_u32 s8, 2063
    s_cbranch_scc1 .ap_232
    s_waitcnt vmcnt(5)
    s_cmpk_ge_u32 s8, 1998
    s_cbranch_scc1 .ap_232
    s_waitcnt vmcnt(3)
    s_bitcmp1_b64 s[14:15], 58
    s_cbranch_scc0 1
    s_waitcnt vmcnt(2)
    s_cmpk_ge_u32 s8, 1923
    s_cbranch_scc1 .ap_232
    s_waitcnt vmcnt(1)
.ap_232:
    s_add_u32 s63, s69, 409600
    buffer_load_dwordx4 v[52:55], v2, s[44:47], s63 offen nt
    s_waitcnt vmcnt(5)
    s_branch .gpc_234
.gp_233:
    buffer_load_dwordx4 v[24:27], v9, s[36:39], s59 offen offset:0 sc1
    s_waitcnt vmcnt(0)
.gpc_234:
    v_cmp_eq_u32 vcc, s34, v26
    v_cmp_eq_u32 s[56:57], s34, v27
    s_and_b64 vcc, vcc, s[56:57]
    s_cmp_eq_u64 vcc, exec
    s_nop 2
    s_cbranch_scc1 .gpd_235
    s_sub_u32 s35, s35, 1
    s_cbranch_scc1 .Lexit
    s_sleep 1
    s_branch .gp_233
.gpd_235:
    s_lshr_b64 s[88:89], s[88:89], s1
    s_and_b32 s88, s88, 0xff
    s_cmp_eq_u32 s88, 32
    s_cselect_b32 s0, 0xac000, 0
    v_mov_b32 v16, v24
    s_nop 1
    v_max_f32_dpp v16, v16, v16 quad_perm:[2,3,0,1] row_mask:0xf bank_mask:0xf
    v_sub_f32 v17, v24, v16
    v_sub_f32 v18, v14, v16
    v_mul_f32 v17, 0x3fb8aa3b, v17
    v_mul_f32 v18, 0x3fb8aa3b, v18
    v_exp_f32 v17, v17
    v_exp_f32 v18, v18
    v_mul_f32 v17, v17, v25
    s_nop 1
    v_add_f32_dpp v17, v17, v17 quad_perm:[2,3,0,1] row_mask:0xf bank_mask:0xf
    v_rcp_f32 v19, v17
    s_nop 0
    v_fma_f32 v15, -v17, v19, 1.0
    v_fma_f32 v19, v15, v19, v19
    v_mul_f32 v18, v18, v19
    v_mul_f32 v10, v10, v18
    v_mul_f32 v11, v11, v18
    v_mul_f32 v12, v12, v18
    v_mul_f32 v13, v13, v18
    v_mov_b32_dpp v112, v10 quad_perm:[2,3,0,1] row_mask:0xf bank_mask:0xf
    v_mov_b32_dpp v113, v11 quad_perm:[2,3,0,1] row_mask:0xf bank_mask:0xf
    v_mov_b32_dpp v114, v12 quad_perm:[2,3,0,1] row_mask:0xf bank_mask:0xf
    v_mov_b32_dpp v115, v13 quad_perm:[2,3,0,1] row_mask:0xf bank_mask:0xf
    v_cvt_pk_bf16_f32 v96, v10, v112
    v_cvt_pk_bf16_f32 v100, v11, v113
    v_cvt_pk_bf16_f32 v104, v12, v114
    v_cvt_pk_bf16_f32 v108, v13, v115
    v_mov_b32_dpp v97, v96 row_ror:12 row_mask:0xf bank_mask:0xf
    v_mov_b32_dpp v101, v100 row_ror:12 row_mask:0xf bank_mask:0xf
    v_mov_b32_dpp v105, v104 row_ror:12 row_mask:0xf bank_mask:0xf
    v_mov_b32_dpp v109, v108 row_ror:12 row_mask:0xf bank_mask:0xf
    v_mov_b32_dpp v98, v96 row_ror:8 row_mask:0xf bank_mask:0xf
    v_mov_b32_dpp v102, v100 row_ror:8 row_mask:0xf bank_mask:0xf
    v_mov_b32_dpp v106, v104 row_ror:8 row_mask:0xf bank_mask:0xf
    v_mov_b32_dpp v110, v108 row_ror:8 row_mask:0xf bank_mask:0xf
    v_mov_b32_dpp v99, v96 row_ror:4 row_mask:0xf bank_mask:0xf
    v_mov_b32_dpp v103, v100 row_ror:4 row_mask:0xf bank_mask:0xf
    v_mov_b32_dpp v107, v104 row_ror:4 row_mask:0xf bank_mask:0xf
    v_mov_b32_dpp v111, v108 row_ror:4 row_mask:0xf bank_mask:0xf
    v_mov_b32_dpp v96, v96 row_shr:3 row_mask:0xf bank_mask:0x2
    v_mov_b32_dpp v97, v97 row_shr:3 row_mask:0xf bank_mask:0x2
    v_mov_b32_dpp v98, v98 row_shr:3 row_mask:0xf bank_mask:0x2
    v_mov_b32_dpp v99, v99 row_shr:3 row_mask:0xf bank_mask:0x2
    v_mov_b32_dpp v100, v100 row_shr:3 row_mask:0xf bank_mask:0x2
    v_mov_b32_dpp v101, v101 row_shr:3 row_mask:0xf bank_mask:0x2
    v_mov_b32_dpp v102, v102 row_shr:3 row_mask:0xf bank_mask:0x2
    v_mov_b32_dpp v103, v103 row_shr:3 row_mask:0xf bank_mask:0x2
    v_mov_b32_dpp v104, v104 row_shr:3 row_mask:0xf bank_mask:0x2
    v_mov_b32_dpp v105, v105 row_shr:3 row_mask:0xf bank_mask:0x2
    v_mov_b32_dpp v106, v106 row_shr:3 row_mask:0xf bank_mask:0x2
    v_mov_b32_dpp v107, v107 row_shr:3 row_mask:0xf bank_mask:0x2
    v_mov_b32_dpp v108, v108 row_shr:3 row_mask:0xf bank_mask:0x2
    v_mov_b32_dpp v109, v109 row_shr:3 row_mask:0xf bank_mask:0x2
    v_mov_b32_dpp v110, v110 row_shr:3 row_mask:0xf bank_mask:0x2
    v_mov_b32_dpp v111, v111 row_shr:3 row_mask:0xf bank_mask:0x2
    s_memrealtime s[8:9]
    s_waitcnt lgkmcnt(0)
    s_sub_u32 s8, s8, s30
    s_cmpk_ge_u32 s8, 2094
    s_cbranch_scc1 .ap_236
    s_waitcnt vmcnt(5)
    s_cmpk_ge_u32 s8, 2029
    s_cbranch_scc1 .ap_236
    s_waitcnt vmcnt(3)
    s_bitcmp1_b64 s[14:15], 59
    s_cbranch_scc0 1
    s_waitcnt vmcnt(2)
    s_cmpk_ge_u32 s8, 1954
    s_cbranch_scc1 .ap_236
    s_waitcnt vmcnt(1)
.ap_236:
    s_add_u32 s63, s69, 417792
    buffer_load_dwordx4 v[60:63], v2, s[44:47], s63 offen nt
    s_lshl_b32 s60, s3, 10
    s_add_u32 s60, s60, 132096
    v_lshlrev_b32 v10, 5, v0
    v_add_u32 v10, s60, v10
    v_lshrrev_b32 v11, 5, v0
    v_lshlrev_b32 v11, 13, v11
    v_and_b32 v12, 31, v0
    v_lshl_add_u32 v11, v12, 4, v11
    v_add_u32 v9, 132096, v2
    v_mov_b32 v15, s34
    s_memrealtime s[8:9]
    s_waitcnt lgkmcnt(0)
    s_sub_u32 s8, s8, s30
    s_cmpk_ge_u32 s8, 2125
    s_cbranch_scc1 .ap_237
    s_waitcnt vmcnt(5)
    s_cmpk_ge_u32 s8, 2060
    s_cbranch_scc1 .ap_237
    s_waitcnt vmcnt(3)
    s_bitcmp1_b64 s[14:15], 60
    s_cbranch_scc0 1
    s_waitcnt vmcnt(2)
    s_cmpk_ge_u32 s8, 1985
    s_cbranch_scc1 .ap_237
    s_waitcnt vmcnt(1)
.ap_237:
    s_add_u32 s63, s69, 425984
    buffer_load_dwordx4 v[68:71], v2, s[44:47], s63 offen nt
    v_perm_b32 v112, v164, v160, s94
    v_perm_b32 v113, v172, v168, s94
    v_perm_b32 v114, v180, v176, s94
    v_perm_b32 v115, v188, v184, s94
    s_nop 1
    v_mfma_f32_16x16x32_bf16 v[128:131], v[96:99], v[112:115], 0
    v_perm_b32 v116, v164, v160, s95
    v_perm_b32 v117, v172, v168, s95
    v_perm_b32 v118, v180, v176, s95
    v_perm_b32 v119, v188, v184, s95
    s_nop 1
    v_mfma_f32_16x16x32_bf16 v[132:135], v[96:99], v[116:119], 0
    v_perm_b32 v120, v165, v161, s94
    v_perm_b32 v121, v173, v169, s94
    v_perm_b32 v122, v181, v177, s94
    v_perm_b32 v123, v189, v185, s94
    s_nop 1
    v_mfma_f32_16x16x32_bf16 v[136:139], v[96:99], v[120:123], 0
    v_perm_b32 v124, v165, v161, s95
    v_perm_b32 v125, v173, v169, s95
    v_perm_b32 v126, v181, v177, s95
    v_perm_b32 v127, v189, v185, s95
    s_nop 1
    v_mfma_f32_16x16x32_bf16 v[140:143], v[96:99], v[124:127], 0
    v_perm_b32 v112, v166, v162, s94
    v_perm_b32 v113, v174, v170, s94
    v_perm_b32 v114, v182, v178, s94
    v_perm_b32 v115, v190, v186, s94
    s_nop 1
    v_mfma_f32_16x16x32_bf16 v[144:147], v[96:99], v[112:115], 0
    v_perm_b32 v116, v166, v162, s95
    v_perm_b32 v117, v174, v170, s95
    v_perm_b32 v118, v182, v178, s95
    v_perm_b32 v119, v190, v186, s95
    s_nop 1
    v_mfma_f32_16x16x32_bf16 v[148:151], v[96:99], v[116:119], 0
    v_perm_b32 v120, v167, v163, s94
    v_perm_b32 v121, v175, v171, s94
    v_perm_b32 v122, v183, v179, s94
    v_perm_b32 v123, v191, v187, s94
    s_nop 1
    v_mfma_f32_16x16x32_bf16 v[152:155], v[96:99], v[120:123], 0
    v_perm_b32 v124, v167, v163, s95
    v_perm_b32 v125, v175, v171, s95
    v_perm_b32 v126, v183, v179, s95
    v_perm_b32 v127, v191, v187, s95
    s_nop 1
    v_mfma_f32_16x16x32_bf16 v[156:159], v[96:99], v[124:127], 0
    s_memrealtime s[8:9]
    s_waitcnt lgkmcnt(0)
    s_sub_u32 s8, s8, s30
    s_cmpk_ge_u32 s8, 2156
    s_nop 3
    s_cbranch_scc1 .ap_238
    s_waitcnt vmcnt(5)
    s_cmpk_ge_u32 s8, 2091
    s_cbranch_scc1 .ap_238
    s_waitcnt vmcnt(3)
    s_bitcmp1_b64 s[14:15], 61
    s_cbranch_scc0 1
    s_waitcnt vmcnt(2)
    s_cmpk_ge_u32 s8, 2016
    s_cbranch_scc1 .ap_238
    s_waitcnt vmcnt(1)
.ap_238:
    s_add_u32 s63, s69, 434176
    buffer_load_dwordx4 v[76:79], v2, s[44:47], s63 offen nt
    v_perm_b32 v112, v196, v192, s94
    v_perm_b32 v113, v204, v200, s94
    v_perm_b32 v114, v212, v208, s94
    v_perm_b32 v115, v220, v216, s94
    s_nop 1
    v_mfma_f32_16x16x32_bf16 v[128:131], v[100:103], v[112:115], v[128:131]
    v_perm_b32 v116, v196, v192, s95
    v_perm_b32 v117, v204, v200, s95
    v_perm_b32 v118, v212, v208, s95
    v_perm_b32 v119, v220, v216, s95
    s_nop 1
    v_mfma_f32_16x16x32_bf16 v[132:135], v[100:103], v[116:119], v[132:135]
    v_perm_b32 v120, v197, v193, s94
    v_perm_b32 v121, v205, v201, s94
    v_perm_b32 v122, v213, v209, s94
    v_perm_b32 v123, v221, v217, s94
    s_nop 1
    v_mfma_f32_16x16x32_bf16 v[136:139], v[100:103], v[120:123], v[136:139]
    v_perm_b32 v124, v197, v193, s95
    v_perm_b32 v125, v205, v201, s95
    v_perm_b32 v126, v213, v209, s95
    v_perm_b32 v127, v221, v217, s95
    s_nop 1
    v_mfma_f32_16x16x32_bf16 v[140:143], v[100:103], v[124:127], v[140:143]
    v_perm_b32 v112, v198, v194, s94
    v_perm_b32 v113, v206, v202, s94
    v_perm_b32 v114, v214, v210, s94
    v_perm_b32 v115, v222, v218, s94
    s_nop 1
    v_mfma_f32_16x16x32_bf16 v[144:147], v[100:103], v[112:115], v[144:147]
    v_perm_b32 v116, v198, v194, s95
    v_perm_b32 v117, v206, v202, s95
    v_perm_b32 v118, v214, v210, s95
    v_perm_b32 v119, v222, v218, s95
    s_nop 1
    v_mfma_f32_16x16x32_bf16 v[148:151], v[100:103], v[116:119], v[148:151]
    v_perm_b32 v120, v199, v195, s94
    v_perm_b32 v121, v207, v203, s94
    v_perm_b32 v122, v215, v211, s94
    v_perm_b32 v123, v223, v219, s94
    s_nop 1
    v_mfma_f32_16x16x32_bf16 v[152:155], v[100:103], v[120:123], v[152:155]
    v_perm_b32 v124, v199, v195, s95
    v_perm_b32 v125, v207, v203, s95
    v_perm_b32 v126, v215, v211, s95
    v_perm_b32 v127, v223, v219, s95
    s_nop 1
    v_mfma_f32_16x16x32_bf16 v[156:159], v[100:103], v[124:127], v[156:159]
    s_memrealtime s[8:9]
    s_waitcnt lgkmcnt(0)
    s_sub_u32 s8, s8, s30
    s_cmpk_ge_u32 s8, 2187
    s_nop 3
    s_cbranch_scc1 .ap_239
    s_waitcnt vmcnt(5)
    s_cmpk_ge_u32 s8, 2122
    s_cbranch_scc1 .ap_239
    s_waitcnt vmcnt(3)
    s_bitcmp1_b64 s[14:15], 62
    s_cbranch_scc0 1
    s_waitcnt vmcnt(2)
    s_cmpk_ge_u32 s8, 2047
    s_cbranch_scc1 .ap_239
    s_waitcnt vmcnt(1)
.ap_239:
    s_add_u32 s63, s69, 442368
    buffer_load_dwordx4 v[84:87], v2, s[44:47], s63 offen nt
    s_waitcnt vmcnt(7)
    v_perm_b32 v112, v228, v224, s94
    v_perm_b32 v113, v236, v232, s94
    v_perm_b32 v114, v244, v240, s94
    v_perm_b32 v115, v252, v248, s94
    s_nop 1
    v_mfma_f32_16x16x32_bf16 v[128:131], v[104:107], v[112:115], v[128:131]
    v_perm_b32 v116, v228, v224, s95
    v_perm_b32 v117, v236, v232, s95
    v_perm_b32 v118, v244, v240, s95
    v_perm_b32 v119, v252, v248, s95
    s_nop 1
    v_mfma_f32_16x16x32_bf16 v[132:135], v[104:107], v[116:119], v[132:135]
    v_perm_b32 v120, v229, v225, s94
    v_perm_b32 v121, v237, v233, s94
    v_perm_b32 v122, v245, v241, s94
    v_perm_b32 v123, v253, v249, s94
    s_nop 1
    v_mfma_f32_16x16x32_bf16 v[136:139], v[104:107], v[120:123], v[136:139]
    v_perm_b32 v124, v229, v225, s95
    v_perm_b32 v125, v237, v233, s95
    v_perm_b32 v126, v245, v241, s95
    v_perm_b32 v127, v253, v249, s95
    s_nop 1
    v_mfma_f32_16x16x32_bf16 v[140:143], v[104:107], v[124:127], v[140:143]
    v_perm_b32 v112, v230, v226, s94
    v_perm_b32 v113, v238, v234, s94
    v_perm_b32 v114, v246, v242, s94
    v_perm_b32 v115, v254, v250, s94
    s_nop 1
    v_mfma_f32_16x16x32_bf16 v[144:147], v[104:107], v[112:115], v[144:147]
    v_perm_b32 v116, v230, v226, s95
    v_perm_b32 v117, v238, v234, s95
    v_perm_b32 v118, v246, v242, s95
    v_perm_b32 v119, v254, v250, s95
    s_nop 1
    v_mfma_f32_16x16x32_bf16 v[148:151], v[104:107], v[116:119], v[148:151]
    v_perm_b32 v120, v231, v227, s94
    v_perm_b32 v121, v239, v235, s94
    v_perm_b32 v122, v247, v243, s94
    v_perm_b32 v123, v255, v251, s94
    s_nop 1
    v_mfma_f32_16x16x32_bf16 v[152:155], v[104:107], v[120:123], v[152:155]
    v_perm_b32 v124, v231, v227, s95
    v_perm_b32 v125, v239, v235, s95
    v_perm_b32 v126, v247, v243, s95
    v_perm_b32 v127, v255, v251, s95
    s_nop 1
    v_mfma_f32_16x16x32_bf16 v[156:159], v[104:107], v[124:127], v[156:159]
    s_memrealtime s[8:9]
    s_waitcnt lgkmcnt(0)
    s_sub_u32 s8, s8, s30
    s_cmpk_ge_u32 s8, 2218
    s_nop 3
    s_cbranch_scc1 .ap_240
    s_waitcnt vmcnt(5)
    s_cmpk_ge_u32 s8, 2153
    s_cbranch_scc1 .ap_240
    s_waitcnt vmcnt(3)
    s_bitcmp1_b64 s[14:15], 63
    s_cbranch_scc0 1
    s_waitcnt vmcnt(2)
    s_cmpk_ge_u32 s8, 2078
    s_cbranch_scc1 .ap_240
    s_waitcnt vmcnt(1)
.ap_240:
    s_add_u32 s63, s69, 450560
    buffer_load_dwordx4 v[92:95], v2, s[44:47], s63 offen nt
    s_setprio 0
    s_waitcnt vmcnt(6)
    v_perm_b32 v160, v44, v36, s94
    v_perm_b32 v164, v44, v36, s95
    v_perm_b32 v168, v45, v37, s94
    v_perm_b32 v172, v45, v37, s95
    v_perm_b32 v176, v46, v38, s94
    v_perm_b32 v180, v46, v38, s95
    v_perm_b32 v184, v47, v39, s94
    v_perm_b32 v188, v47, v39, s95
    s_waitcnt vmcnt(4)
    v_perm_b32 v161, v60, v52, s94
    v_perm_b32 v165, v60, v52, s95
    v_perm_b32 v169, v61, v53, s94
    v_perm_b32 v173, v61, v53, s95
    v_perm_b32 v177, v62, v54, s94
    v_perm_b32 v181, v62, v54, s95
    v_perm_b32 v185, v63, v55, s94
    v_perm_b32 v189, v63, v55, s95
    v_mfma_f32_16x16x16_bf16 v[128:131], v[108:109], v[160:161], v[128:131]
    v_mfma_f32_16x16x16_bf16 v[132:135], v[108:109], v[164:165], v[132:135]
    v_mfma_f32_16x16x16_bf16 v[136:139], v[108:109], v[168:169], v[136:139]
    v_mfma_f32_16x16x16_bf16 v[140:143], v[108:109], v[172:173], v[140:143]
    v_mfma_f32_16x16x16_bf16 v[144:147], v[108:109], v[176:177], v[144:147]
    v_mfma_f32_16x16x16_bf16 v[148:151], v[108:109], v[180:181], v[148:151]
    v_mfma_f32_16x16x16_bf16 v[152:155], v[108:109], v[184:185], v[152:155]
    v_mfma_f32_16x16x16_bf16 v[156:159], v[108:109], v[188:189], v[156:159]
    s_waitcnt vmcnt(2)
    v_perm_b32 v162, v76, v68, s94
    v_perm_b32 v166, v76, v68, s95
    v_perm_b32 v170, v77, v69, s94
    v_perm_b32 v174, v77, v69, s95
    v_perm_b32 v178, v78, v70, s94
    v_perm_b32 v182, v78, v70, s95
    v_perm_b32 v186, v79, v71, s94
    v_perm_b32 v190, v79, v71, s95
    s_lshl4_add_u32 s59, s67, s66
    s_lshl1_add_u32 s59, s59, s68
    s_lshl_b32 s59, s59, 9
    s_add_u32 s59, s59, 0x210000
    s_mov_b32 s60, 0x07060503
    s_mov_b32 s61, 0x07060502
    s_mov_b32 s62, 0x07060501
.Ltail_n:
    s_waitcnt vmcnt(0)
    v_perm_b32 v163, v92, v84, s94
    v_perm_b32 v167, v92, v84, s95
    v_perm_b32 v171, v93, v85, s94
    v_perm_b32 v175, v93, v85, s95
    v_perm_b32 v179, v94, v86, s94
    v_perm_b32 v183, v94, v86, s95
    v_perm_b32 v187, v95, v87, s94
    v_perm_b32 v191, v95, v87, s95
    v_mfma_f32_16x16x16_bf16 v[128:131], v[110:111], v[162:163], v[128:131]
    v_mfma_f32_16x16x16_bf16 v[132:135], v[110:111], v[166:167], v[132:135]
    v_mfma_f32_16x16x16_bf16 v[136:139], v[110:111], v[170:171], v[136:139]
    v_mfma_f32_16x16x16_bf16 v[140:143], v[110:111], v[174:175], v[140:143]
    v_mfma_f32_16x16x16_bf16 v[144:147], v[110:111], v[178:179], v[144:147]
    v_mfma_f32_16x16x16_bf16 v[148:151], v[110:111], v[182:183], v[148:151]
    v_mfma_f32_16x16x16_bf16 v[152:155], v[110:111], v[186:187], v[152:155]
    v_mfma_f32_16x16x16_bf16 v[156:159], v[110:111], v[190:191], v[156:159]
    s_mov_b64 exec, 0xffffffff
    s_nop 0
    ds_write2_b32 v10, v128, v132 offset0:0 offset1:1
    s_nop 0
    ds_write2_b32 v10, v136, v140 offset0:2 offset1:3
    s_nop 0
    ds_write2_b32 v10, v144, v148 offset0:4 offset1:5
    s_nop 0
    ds_write2_b32 v10, v152, v156 offset0:6 offset1:7
    s_mov_b64 exec, -1
    s_waitcnt lgkmcnt(0)
    s_barrier
    s_cmp_lg_u32 s3, 7
    s_cbranch_scc1 .opub_241
    ds_read_b128 v[196:199], v9 offset:0
    ds_read_b128 v[200:203], v9 offset:1024
    ds_read_b128 v[204:207], v9 offset:2048
    ds_read_b128 v[208:211], v9 offset:3072
    ds_read_b128 v[212:215], v9 offset:4096
    ds_read_b128 v[216:219], v9 offset:5120
    ds_read_b128 v[220:223], v9 offset:6144
    ds_read_b128 v[224:227], v9 offset:7168
    s_waitcnt lgkmcnt(6)
    v_pk_add_f32 v[196:197], v[196:197], v[200:201]
    v_pk_add_f32 v[198:199], v[198:199], v[202:203]
    s_waitcnt lgkmcnt(4)
    v_pk_add_f32 v[204:205], v[204:205], v[208:209]
    v_pk_add_f32 v[206:207], v[206:207], v[210:211]
    v_pk_add_f32 v[196:197], v[196:197], v[204:205]
    v_pk_add_f32 v[198:199], v[198:199], v[206:207]
    s_waitcnt lgkmcnt(2)
    v_pk_add_f32 v[212:213], v[212:213], v[216:217]
    v_pk_add_f32 v[214:215], v[214:215], v[218:219]
    s_waitcnt lgkmcnt(0)
    v_pk_add_f32 v[220:221], v[220:221], v[224:225]
    v_pk_add_f32 v[222:223], v[222:223], v[226:227]
    v_pk_add_f32 v[212:213], v[212:213], v[220:221]
    v_pk_add_f32 v[214:215], v[214:215], v[222:223]
    v_pk_add_f32 v[196:197], v[196:197], v[212:213]
    v_pk_add_f32 v[198:199], v[198:199], v[214:215]
    v_perm_b32 v12, v196, v199, s60
    v_perm_b32 v13, v197, v199, s61
    v_perm_b32 v14, v198, v199, s62
    s_add_u32 s57, s59, 0xac000
    buffer_store_dwordx4 v[12:15], v11, s[36:39], s57 offen
    buffer_store_dwordx4 v[12:15], v11, s[36:39], s59 offen sc1
.opub_241:
.Lexit:
.Lend:
s_endpgm
.section .rodata,"a"
.p2align 6
.amdhsa_kernel adaLN_cond__sliding_block_cached__moe_arch_mod__decode_kernel
  .amdhsa_next_free_vgpr 256
  .amdhsa_next_free_sgpr 102
  .amdhsa_accum_offset 256
  .amdhsa_group_segment_fixed_size 0
  .amdhsa_kernarg_size 120
  .amdhsa_user_sgpr_count 2
  .amdhsa_user_sgpr_kernarg_segment_ptr 1
  .amdhsa_system_sgpr_workgroup_id_x 1
.end_amdhsa_kernel
```

```asm
; @launch grid=(256,1,1) block=(512,1,1) lds=159360
.amdgcn_target "amdgcn-amd-amdhsa--gfx950"
.text
.globl adaLN_cond__sliding_block_cached__moe_arch_mod__decode_kernel
.p2align 8
.type adaLN_cond__sliding_block_cached__moe_arch_mod__decode_kernel,@function
adaLN_cond__sliding_block_cached__moe_arch_mod__decode_kernel:
    s_cmp_ge_u32 s2, 256
    s_cbranch_scc1 .Lend
    s_load_dwordx16 s[4:19], s[0:1], 0
    s_load_dwordx8 s[20:27], s[0:1], 64
    s_load_dwordx4 s[28:31], s[0:1], 96
    s_load_dwordx2 s[32:33], s[0:1], 112
    s_memrealtime s[70:71]
    v_lshrrev_b32 v1, 6, v0
    v_and_b32 v0, 63, v0
    v_readfirstlane_b32 s3, v1
    s_mov_b32 s35, 0x3ffff
    s_mov_b32 s98, 0xbfb8aa3b
    s_mov_b32 s94, 0x05040100
    s_mov_b32 s95, 0x07060302
    s_mov_b32 s96, 0xaaaaaaaa
    s_mov_b32 s97, 0xaaaaaaaa
    s_and_b32 s64, s2, 7
    s_lshr_b32 s65, s2, 3
    s_and_b32 s66, s65, 7
    s_lshr_b32 s67, s2, 7
    s_lshl1_add_u32 s67, s64, s67
    s_bfe_u32 s68, s2, 0x10006
    s_lshl4_add_u32 s69, s66, s67
    s_lshl_b32 s69, s69, 21
    s_lshl_b32 s56, s68, 16
    s_add_u32 s69, s69, s56
    s_lshl_b32 s56, s3, 10
    s_add_u32 s69, s69, s56
    s_add_u32 s69, s69, 0x180000
    v_bfe_u32 v1, v0, 2, 2
    v_lshrrev_b32 v2, 4, v0
    v_lshl_add_u32 v1, v1, 2, v2
    v_and_b32 v2, 3, v0
    v_lshl_add_u32 v1, v1, 2, v2
    v_lshlrev_b32 v1, 4, v1
    v_lshlrev_b32 v2, 4, v0
    v_lshlrev_b32 v3, 3, v0
    v_and_b32 v4, 31, v0
    v_lshlrev_b32 v4, 2, v4
    v_add_u32 v4, 1024, v4
    v_lshlrev_b32 v5, 1, v4
    s_waitcnt lgkmcnt(0)
    s_load_dword s34, s[32:33], 0
    s_sub_u32 s99, s2, 216
    s_cmp_ge_u32 s99, 18
    s_cbranch_scc1 .Lmcf_no
    s_mul_i32 s58, s3, 1152
    s_mov_b32 s52, s24
    s_and_b32 s53, s25, 0xffff
    s_mov_b32 s54, 0x2400
    s_mov_b32 s55, 0x00020000
    buffer_load_dwordx2 v[246:247], v3, s[52:55], s58 offen
    buffer_load_dwordx2 v[248:249], v3, s[52:55], s58 offen offset:512
    buffer_load_dword v250, v4, s[52:55], s58 offen
    s_mov_b32 s48, s26
    s_and_b32 s49, s27, 0xffff
    s_mov_b32 s50, 0x3cc000
    s_mov_b32 s51, 0x00020000
    v_bfe_u32 v12, v0, 4, 1
    s_and_b32 s56, s3, 3
    s_lshl_b32 s56, s56, 1
    v_or_b32 v12, s56, v12
    v_and_b32 v19, 7, v0
    v_xor_b32 v12, v12, v19
    v_lshrrev_b32 v19, 3, v0
    v_mul_u32_u24 v19, 6912, v19
    v_lshl_add_u32 v19, v12, 4, v19
    s_mul_i32 s57, s3, 55296
    s_lshl_b32 s59, s99, 7
    s_add_u32 s57, s57, s59
    s_lshl_b32 s100, s3, 10
    s_add_u32 m0, s100, 0
    s_add_u32 s56, s57, 0
    buffer_load_dwordx4 v19, s[48:51], s56 offen nt lds
    s_add_u32 m0, s100, 8192
    s_add_u32 s56, s57, 442368
    buffer_load_dwordx4 v19, s[48:51], s56 offen nt lds
    s_add_u32 m0, s100, 16384
    s_add_u32 s56, s57, 884736
    buffer_load_dwordx4 v19, s[48:51], s56 offen nt lds
    s_add_u32 m0, s100, 24576
    s_add_u32 s56, s57, 1327104
    buffer_load_dwordx4 v19, s[48:51], s56 offen nt lds
    s_add_u32 m0, s100, 32768
    s_add_u32 s56, s57, 1769472
    buffer_load_dwordx4 v19, s[48:51], s56 offen nt lds
    s_add_u32 m0, s100, 40960
    s_add_u32 s56, s57, 2211840
    buffer_load_dwordx4 v19, s[48:51], s56 offen nt lds
    s_add_u32 m0, s100, 49152
    s_add_u32 s56, s57, 2654208
    buffer_load_dwordx4 v19, s[48:51], s56 offen nt lds
    s_add_u32 m0, s100, 57344
    s_add_u32 s56, s57, 3096576
    buffer_load_dwordx4 v19, s[48:51], s56 offen nt lds
    s_add_u32 m0, s100, 65536
    s_add_u32 s56, s57, 3538944
    buffer_load_dwordx4 v19, s[48:51], s56 offen nt lds
.Lmcf_no:
    s_mov_b32 s40, s6
    s_and_b32 s41, s7, 0xffff
    s_mov_b32 s42, 0x10000000
    s_mov_b32 s43, 0x00020000
    s_add_u32 s63, s69, 0
    buffer_load_dwordx4 v[32:35], v1, s[40:43], s63 offen nt
    s_add_u32 s63, s69, 8192
    buffer_load_dwordx4 v[36:39], v1, s[40:43], s63 offen nt
    s_add_u32 s63, s69, 16384
    buffer_load_dwordx4 v[64:67], v1, s[40:43], s63 offen nt
    s_add_u32 s63, s69, 24576
    buffer_load_dwordx4 v[68:71], v1, s[40:43], s63 offen nt
    s_mov_b32 s44, s8
    s_and_b32 s45, s9, 0xffff
    s_mov_b32 s46, 0x10000000
    s_mov_b32 s47, 0x00020000
    s_mov_b32 s36, s32
    s_and_b32 s37, s33, 0xffff
    s_mov_b32 s38, 0x40000000
    s_mov_b32 s39, 0x00020000
    s_lshl3_add_u32 s56, s3, s2
    s_cmp_lt_u32 s56, 8
    s_cbranch_scc0 .Let_no
    s_lshl_b32 s56, s2, 7
    s_add_u32 s56, s56, 0x400
    v_mov_b32 v7, s70
    s_mov_b64 exec, 1
    buffer_store_dword v7, v2, s[36:39], s56 offen sc1
    s_mov_b64 exec, -1
.Let_no:
    s_mov_b32 s52, s30
    s_and_b32 s53, s31, 0xffff
    s_mov_b32 s54, 0x100
    s_mov_b32 s55, 0x00020000
    s_mov_b64 s[6:7], s[30:31]
    s_getreg_b32 s1, hwreg(HW_REG_XCC_ID)
    s_and_b32 s1, s1, 7
    s_lshl_b32 s1, s1, 3
    s_lshl_b32 s0, s64, 5
    s_cmp_lg_u32 s3, 0
    s_cbranch_scc1 .Lxa_no
    s_lshl_b64 s[56:57], 1, s1
    v_mov_b32 v8, s56
    v_mov_b32 v9, s57
    s_mov_b64 exec, 1
    buffer_atomic_add_x2 v[8:9], v2, s[52:55], s0 offen sc1
    v_mov_b32 v8, 0
    v_mov_b32 v9, 159232
    ds_write_b32 v9, v8
    s_waitcnt lgkmcnt(0)
    s_mov_b64 exec, -1
.Lxa_no:
    s_barrier
    s_cmp_lt_u32 s3, 4
    s_cbranch_scc1 1
    s_setprio 1
.Lresume:
    s_cmp_lt_u32 s65, 9
    s_cbranch_scc1 .Le_a
    s_sub_u32 s56, 3, s64
    s_and_b32 s56, s56, 7
    s_lshl1_add_u32 s56, s56, 9
    s_sub_u32 s56, s65, s56
    s_cselect_b32 s57, 18, 0
    s_add_u32 s56, s56, s57
    s_sub_u32 s101, s56, 2
    s_cmp_ge_u32 s56, 5
    s_addc_u32 s101, s101, 0
    s_sub_u32 s99, s56, 5
    s_min_u32 s99, s99, 7
    s_cmp_lt_u32 s65, 27
    s_cbranch_scc1 .Lrole_bc
    s_mov_b32 s101, 3
    s_sub_u32 s99, s65, 27
    s_cmp_ge_u32 s65, 31
    s_cselect_b32 s56, 2, 9
.Lrole_bc:
    s_lshl3_add_u32 s99, s99, s64
    s_sub_u32 s56, s56, 2
    s_cmp_lt_u32 s56, 7
    s_cbranch_scc1 .Le_q
    s_cmp_lt_u32 s99, 18
    s_cbranch_scc1 .Le_mc
    s_cmp_lt_u32 s99, 54
    s_mov_b32 s14, 0xfdff7fdf
    s_cselect_b32 s14, 0x6b5ad6b5, s14
    s_mov_b32 s15, 0xff7fdff7
    s_cselect_b32 s15, 0x5ad6b5ad, s15
    s_cselect_b32 s30, -30, 0
    s_add_u32 s30, s30, 0
    s_add_u32 s30, s30, s70
    s_sub_u32 s56, s65, 9
    s_lshr_b32 s56, s56, 1
    s_add_u32 s56, s56, s64
    s_and_b32 s56, s56, 7
    s_cmp_eq_u32 s56, 3
    s_cselect_b32 s56, -30, 0
    s_cmp_lt_u32 s99, 54
    s_cselect_b32 s56, 0, s56
    s_add_u32 s30, s30, s56
    s_waitcnt vmcnt(3)
    s_bitcmp1_b64 s[14:15], 4
    s_cbranch_scc0 1
    s_waitcnt vmcnt(2)
    s_add_u32 s63, s69, 32768
    buffer_load_dwordx4 v[96:99], v1, s[40:43], s63 offen nt
    s_memrealtime s[8:9]
    s_waitcnt lgkmcnt(0)
    s_sub_u32 s8, s8, s30
    s_cmpk_ge_u32 s8, 290
    s_cbranch_scc1 .ap_1
    s_waitcnt vmcnt(4)
    s_cmpk_ge_u32 s8, 225
    s_cbranch_scc1 .ap_1
    s_waitcnt vmcnt(3)
    s_bitcmp1_b64 s[14:15], 5
    s_cbranch_scc0 1
    s_waitcnt vmcnt(2)
    s_cmpk_ge_u32 s8, 150
    s_cbranch_scc1 .ap_1
    s_waitcnt vmcnt(1)
.ap_1:
    s_add_u32 s63, s69, 40960
    buffer_load_dwordx4 v[100:103], v1, s[40:43], s63 offen nt
    s_memrealtime s[8:9]
    s_waitcnt lgkmcnt(0)
    s_sub_u32 s8, s8, s30
    s_cmpk_ge_u32 s8, 315
    s_cbranch_scc1 .ap_2
    s_waitcnt vmcnt(5)
    s_cmpk_ge_u32 s8, 250
    s_cbranch_scc1 .ap_2
    s_waitcnt vmcnt(3)
    s_bitcmp1_b64 s[14:15], 6
    s_cbranch_scc0 1
    s_waitcnt vmcnt(2)
    s_cmpk_ge_u32 s8, 175
    s_cbranch_scc1 .ap_2
    s_waitcnt vmcnt(1)
.ap_2:
    s_add_u32 s63, s69, 49152
    buffer_load_dwordx4 v[128:131], v1, s[40:43], s63 offen nt
    s_memrealtime s[8:9]
    s_waitcnt lgkmcnt(0)
    s_sub_u32 s8, s8, s30
    s_cmpk_ge_u32 s8, 340
    s_cbranch_scc1 .ap_3
    s_waitcnt vmcnt(5)
    s_cmpk_ge_u32 s8, 275
    s_cbranch_scc1 .ap_3
    s_waitcnt vmcnt(3)
    s_bitcmp1_b64 s[14:15], 7
    s_cbranch_scc0 1
    s_waitcnt vmcnt(2)
    s_cmpk_ge_u32 s8, 200
    s_cbranch_scc1 .ap_3
    s_waitcnt vmcnt(1)
.ap_3:
    s_add_u32 s63, s69, 57344
    buffer_load_dwordx4 v[132:135], v1, s[40:43], s63 offen nt
    s_memrealtime s[8:9]
    s_waitcnt lgkmcnt(0)
    s_sub_u32 s8, s8, s30
    s_cmpk_ge_u32 s8, 365
    s_cbranch_scc1 .ap_4
    s_waitcnt vmcnt(5)
    s_cmpk_ge_u32 s8, 300
    s_cbranch_scc1 .ap_4
    s_waitcnt vmcnt(3)
    s_bitcmp1_b64 s[14:15], 8
    s_cbranch_scc0 1
    s_waitcnt vmcnt(2)
    s_cmpk_ge_u32 s8, 225
    s_cbranch_scc1 .ap_4
    s_waitcnt vmcnt(1)
.ap_4:
    s_add_u32 s63, s69, 131072
    buffer_load_dwordx4 v[40:43], v1, s[40:43], s63 offen nt
    s_memrealtime s[8:9]
    s_waitcnt lgkmcnt(0)
    s_sub_u32 s8, s8, s30
    s_cmpk_ge_u32 s8, 390
    s_cbranch_scc1 .ap_5
    s_waitcnt vmcnt(5)
    s_cmpk_ge_u32 s8, 325
    s_cbranch_scc1 .ap_5
    s_waitcnt vmcnt(3)
    s_bitcmp1_b64 s[14:15], 9
    s_cbranch_scc0 1
    s_waitcnt vmcnt(2)
    s_cmpk_ge_u32 s8, 250
    s_cbranch_scc1 .ap_5
    s_waitcnt vmcnt(1)
.ap_5:
    s_add_u32 s63, s69, 139264
    buffer_load_dwordx4 v[44:47], v1, s[40:43], s63 offen nt
    s_waitcnt lgkmcnt(0)
    s_add_u32 s34, s34, 1
    s_cmp_lt_u32 s99, 54
    s_cbranch_scc1 .Le_mr
    s_sub_u32 s57, s65, 9
    s_bitcmp1_b32 s57, 0
    s_cselect_b32 s48, s20, s18
    s_cselect_b32 s49, s21, s19
    s_cselect_b32 s33, 36, 0
    s_and_b32 s49, s49, 0xffff
    s_mov_b32 s50, 0x510000
    s_mov_b32 s51, 0x00020000
    s_mov_b32 s52, s22
    s_and_b32 s53, s23, 0xffff
    s_mov_b32 s54, 0x510000
    s_mov_b32 s55, 0x00020000
    s_lshr_b32 s57, s57, 1
    s_lshl_b32 s57, s57, 7
    s_mul_i32 s101, s64, 1152
    s_add_u32 s101, s101, s57
    s_mul_i32 s56, s3, 73728
    s_add_u32 s101, s101, s56
    s_mul_i32 s56, s64, 72
    s_add_u32 s33, s33, s56
    s_add_u32 s33, s33, s3
    s_mul_i32 s33, s33, 9216
    s_add_u32 s33, s33, s57
    s_bfe_u32 s56, s101, 0x30007
    s_cmp_eq_u32 s56, 3
    s_cselect_b32 s100, 1, 0
    v_bfe_u32 v12, v0, 4, 1
    s_and_b32 s56, s3, 3
    s_lshl_b32 s56, s56, 1
    v_or_b32 v12, s56, v12
    v_and_b32 v6, 7, v0
    v_xor_b32 v12, v12, v6
    v_lshrrev_b32 v6, 3, v0
    v_mul_u32_u24 v6, 9216, v6
    v_lshl_add_u32 v6, v12, 4, v6
    v_bfe_u32 v12, v0, 4, 1
    s_and_b32 s56, s3, 1
    s_lshl_b32 s56, s56, 2
    v_lshl_or_b32 v12, v12, 1, s56
    v_and_b32 v13, 7, v0
    v_xor_b32 v12, v12, v13
    v_lshrrev_b32 v13, 3, v0
    v_mul_u32_u24 v13, 1152, v13
    v_lshl_add_u32 v31, v12, 4, v13
    s_lshl_b32 s32, s3, 10
    s_memrealtime s[8:9]
    s_waitcnt vmcnt(8)
    s_waitcnt lgkmcnt(0)
    s_sub_u32 s8, s8, s30
    s_cmpk_ge_u32 s8, 436
    s_cbranch_scc1 .ap_6
    s_waitcnt vmcnt(5)
    s_cmpk_ge_u32 s8, 371
    s_cbranch_scc1 .ap_6
    s_waitcnt vmcnt(3)
    s_bitcmp1_b64 s[14:15], 10
    s_cbranch_scc0 1
    s_waitcnt vmcnt(2)
    s_cmpk_ge_u32 s8, 296
    s_cbranch_scc1 .ap_6
    s_waitcnt vmcnt(1)
.ap_6:
    s_add_u32 s63, s69, 147456
    buffer_load_dwordx4 v[72:75], v1, s[40:43], s63 offen nt
    s_cmp_eq_u32 s100, 0
    s_cbranch_scc1 .ls_7
    s_add_u32 m0, s32, 0
    s_add_u32 s56, s101, 0
    buffer_load_dwordx4 v6, s[48:51], s56 offen nt lds
.ls_7:
    s_memrealtime s[8:9]
    s_waitcnt vmcnt(8)
    s_waitcnt lgkmcnt(0)
    s_sub_u32 s8, s8, s30
    s_cmpk_ge_u32 s8, 482
    s_cbranch_scc1 .ap_8
    s_waitcnt vmcnt(5)
    s_cmpk_ge_u32 s8, 417
    s_cbranch_scc1 .ap_8
    s_waitcnt vmcnt(3)
    s_bitcmp1_b64 s[14:15], 11
    s_cbranch_scc0 1
    s_waitcnt vmcnt(2)
    s_cmpk_ge_u32 s8, 342
    s_cbranch_scc1 .ap_8
    s_waitcnt vmcnt(1)
.ap_8:
    s_add_u32 s63, s69, 155648
    buffer_load_dwordx4 v[76:79], v1, s[40:43], s63 offen nt
    s_memrealtime s[8:9]
    s_waitcnt vmcnt(8)
    s_waitcnt lgkmcnt(0)
    s_sub_u32 s8, s8, s30
    s_cmpk_ge_u32 s8, 528
    s_cbranch_scc1 .ap_9
    s_waitcnt vmcnt(5)
    s_cmpk_ge_u32 s8, 463
    s_cbranch_scc1 .ap_9
    s_waitcnt vmcnt(3)
    s_bitcmp1_b64 s[14:15], 12
    s_cbranch_scc0 1
    s_waitcnt vmcnt(2)
    s_cmpk_ge_u32 s8, 388
    s_cbranch_scc1 .ap_9
    s_waitcnt vmcnt(1)
.ap_9:
    s_add_u32 s63, s69, 163840
    buffer_load_dwordx4 v[104:107], v1, s[40:43], s63 offen nt
    s_memrealtime s[8:9]
    s_waitcnt vmcnt(8)
    s_waitcnt lgkmcnt(0)
    s_sub_u32 s8, s8, s30
    s_cmpk_ge_u32 s8, 574
    s_cbranch_scc1 .ap_10
    s_waitcnt vmcnt(5)
    s_cmpk_ge_u32 s8, 509
    s_cbranch_scc1 .ap_10
    s_waitcnt vmcnt(3)
    s_bitcmp1_b64 s[14:15], 13
    s_cbranch_scc0 1
    s_waitcnt vmcnt(2)
    s_cmpk_ge_u32 s8, 434
    s_cbranch_scc1 .ap_10
    s_waitcnt vmcnt(1)
.ap_10:
    s_add_u32 s63, s69, 172032
    buffer_load_dwordx4 v[108:111], v1, s[40:43], s63 offen nt
    s_cmp_eq_u32 s100, 0
    s_cbranch_scc1 .ls_11
    s_add_u32 m0, s32, 8192
    s_add_u32 s56, s101, 589824
    buffer_load_dwordx4 v6, s[48:51], s56 offen nt lds
.ls_11:
    s_memrealtime s[8:9]
    s_waitcnt vmcnt(8)
    s_waitcnt lgkmcnt(0)
    s_sub_u32 s8, s8, s30
    s_cmpk_ge_u32 s8, 620
    s_cbranch_scc1 .ap_12
    s_waitcnt vmcnt(5)
    s_cmpk_ge_u32 s8, 555
    s_cbranch_scc1 .ap_12
    s_waitcnt vmcnt(3)
    s_bitcmp1_b64 s[14:15], 14
    s_cbranch_scc0 1
    s_waitcnt vmcnt(2)
    s_cmpk_ge_u32 s8, 480
    s_cbranch_scc1 .ap_12
    s_waitcnt vmcnt(1)
.ap_12:
    s_add_u32 s63, s69, 180224
    buffer_load_dwordx4 v[136:139], v1, s[40:43], s63 offen nt
    s_memrealtime s[8:9]
    s_waitcnt vmcnt(8)
    s_waitcnt lgkmcnt(0)
    s_sub_u32 s8, s8, s30
    s_cmpk_ge_u32 s8, 666
    s_cbranch_scc1 .ap_13
    s_waitcnt vmcnt(5)
    s_cmpk_ge_u32 s8, 601
    s_cbranch_scc1 .ap_13
    s_waitcnt vmcnt(3)
    s_bitcmp1_b64 s[14:15], 15
    s_cbranch_scc0 1
    s_waitcnt vmcnt(2)
    s_cmpk_ge_u32 s8, 526
    s_cbranch_scc1 .ap_13
    s_waitcnt vmcnt(1)
.ap_13:
    s_add_u32 s63, s69, 188416
    buffer_load_dwordx4 v[140:143], v1, s[40:43], s63 offen nt
    s_memrealtime s[8:9]
    s_waitcnt vmcnt(8)
    s_waitcnt lgkmcnt(0)
    s_sub_u32 s8, s8, s30
    s_cmpk_ge_u32 s8, 712
    s_cbranch_scc1 .ap_14
    s_waitcnt vmcnt(5)
    s_cmpk_ge_u32 s8, 647
    s_cbranch_scc1 .ap_14
    s_waitcnt vmcnt(3)
    s_bitcmp1_b64 s[14:15], 16
    s_cbranch_scc0 1
    s_waitcnt vmcnt(2)
    s_cmpk_ge_u32 s8, 572
    s_cbranch_scc1 .ap_14
    s_waitcnt vmcnt(1)
.ap_14:
    s_add_u32 s63, s69, 262144
    buffer_load_dwordx4 v[48:51], v1, s[40:43], s63 offen nt
    s_cmp_eq_u32 s100, 0
    s_cbranch_scc1 .ls_15
    s_add_u32 m0, s32, 16384
    s_add_u32 s56, s101, 1179648
    buffer_load_dwordx4 v6, s[48:51], s56 offen nt lds
.ls_15:
    s_memrealtime s[8:9]
    s_waitcnt vmcnt(8)
    s_waitcnt lgkmcnt(0)
    s_sub_u32 s8, s8, s30
    s_cmpk_ge_u32 s8, 758
    s_cbranch_scc1 .ap_16
    s_waitcnt vmcnt(5)
    s_cmpk_ge_u32 s8, 693
    s_cbranch_scc1 .ap_16
    s_waitcnt vmcnt(3)
    s_bitcmp1_b64 s[14:15], 17
    s_cbranch_scc0 1
    s_waitcnt vmcnt(2)
    s_cmpk_ge_u32 s8, 618
    s_cbranch_scc1 .ap_16
    s_waitcnt vmcnt(1)
.ap_16:
    s_add_u32 s63, s69, 270336
    buffer_load_dwordx4 v[52:55], v1, s[40:43], s63 offen nt
    s_memrealtime s[8:9]
    s_waitcnt vmcnt(8)
    s_waitcnt lgkmcnt(0)
    s_sub_u32 s8, s8, s30
    s_cmpk_ge_u32 s8, 804
    s_cbranch_scc1 .ap_17
    s_waitcnt vmcnt(5)
    s_cmpk_ge_u32 s8, 739
    s_cbranch_scc1 .ap_17
    s_waitcnt vmcnt(3)
    s_bitcmp1_b64 s[14:15], 18
    s_cbranch_scc0 1
    s_waitcnt vmcnt(2)
    s_cmpk_ge_u32 s8, 664
    s_cbranch_scc1 .ap_17
    s_waitcnt vmcnt(1)
.ap_17:
    s_add_u32 s63, s69, 278528
    buffer_load_dwordx4 v[80:83], v1, s[40:43], s63 offen nt
    v_and_b32 v157, 7, v0
    v_lshlrev_b32 v157, 7, v157
    s_mov_b32 s63, 0x400
    buffer_load_dword v156, v157, s[36:39], s63 offen
    s_memrealtime s[8:9]
    s_waitcnt vmcnt(9)
    s_waitcnt lgkmcnt(0)
    s_sub_u32 s8, s8, s30
    s_cmpk_ge_u32 s8, 850
    s_cbranch_scc1 .ap_18
    s_waitcnt vmcnt(6)
    s_cmpk_ge_u32 s8, 785
    s_cbranch_scc1 .ap_18
    s_waitcnt vmcnt(4)
    s_bitcmp1_b64 s[14:15], 19
    s_cbranch_scc0 1
    s_waitcnt vmcnt(3)
    s_cmpk_ge_u32 s8, 710
    s_cbranch_scc1 .ap_18
    s_waitcnt vmcnt(2)
.ap_18:
    s_add_u32 s63, s69, 286720
    buffer_load_dwordx4 v[84:87], v1, s[40:43], s63 offen nt
    s_cmp_eq_u32 s100, 0
    s_cbranch_scc1 .ls_19
    s_add_u32 m0, s32, 24576
    s_add_u32 s56, s101, 1769472
    buffer_load_dwordx4 v6, s[48:51], s56 offen nt lds
.ls_19:
    s_memrealtime s[8:9]
    s_waitcnt vmcnt(9)
    s_waitcnt lgkmcnt(0)
    s_sub_u32 s8, s8, s30
    s_cmpk_ge_u32 s8, 895
    s_cbranch_scc1 .ap_20
    s_waitcnt vmcnt(6)
    s_cmpk_ge_u32 s8, 830
    s_cbranch_scc1 .ap_20
    s_waitcnt vmcnt(4)
    s_bitcmp1_b64 s[14:15], 20
    s_cbranch_scc0 1
    s_waitcnt vmcnt(3)
    s_cmpk_ge_u32 s8, 755
    s_cbranch_scc1 .ap_20
    s_waitcnt vmcnt(2)
.ap_20:
    s_add_u32 s63, s69, 294912
    buffer_load_dwordx4 v[112:115], v1, s[40:43], s63 offen nt
    s_memrealtime s[8:9]
    s_waitcnt vmcnt(9)
    s_waitcnt lgkmcnt(0)
    s_sub_u32 s8, s8, s30
    s_cmpk_ge_u32 s8, 940
    s_cbranch_scc1 .ap_21
    s_waitcnt vmcnt(6)
    s_cmpk_ge_u32 s8, 875
    s_cbranch_scc1 .ap_21
    s_waitcnt vmcnt(4)
    s_bitcmp1_b64 s[14:15], 21
    s_cbranch_scc0 1
    s_waitcnt vmcnt(3)
    s_cmpk_ge_u32 s8, 800
    s_cbranch_scc1 .ap_21
    s_waitcnt vmcnt(1)
.ap_21:
    s_add_u32 s63, s69, 303104
    buffer_load_dwordx4 v[116:119], v1, s[40:43], s63 offen nt
    s_memrealtime s[8:9]
    s_waitcnt vmcnt(9)
    s_waitcnt lgkmcnt(0)
    s_sub_u32 s8, s8, s30
    s_cmpk_ge_u32 s8, 985
    s_cbranch_scc1 .ap_22
    s_waitcnt vmcnt(6)
    s_cmpk_ge_u32 s8, 920
    s_cbranch_scc1 .ap_22
    s_waitcnt vmcnt(4)
    s_bitcmp1_b64 s[14:15], 22
    s_cbranch_scc0 1
    s_waitcnt vmcnt(2)
    s_cmpk_ge_u32 s8, 845
    s_cbranch_scc1 .ap_22
    s_waitcnt vmcnt(1)
.ap_22:
    s_add_u32 s63, s69, 311296
    buffer_load_dwordx4 v[144:147], v1, s[40:43], s63 offen nt
    s_waitcnt vmcnt(4)
    s_sub_u32 s63, s70, 300
    v_subrev_u32 v156, s63, v156
    v_mov_b32 v157, 600
    v_cmp_lt_u32 s[8:9], v156, v157
    v_add_u32_dpp v156, v156, v156 quad_perm:[1,0,3,2] row_mask:0xf bank_mask:0xf
    s_nop 1
    v_add_u32_dpp v156, v156, v156 quad_perm:[2,3,0,1] row_mask:0xf bank_mask:0xf
    s_nop 1
    v_add_u32_dpp v156, v156, v156 row_ror:4 row_mask:0xf bank_mask:0xf
    s_nop 0
    v_readfirstlane_b32 s63, v156
    s_cmp_eq_u64 s[8:9], -1
    s_nop 3
    s_cbranch_scc0 .et_23
    s_lshr_b32 s63, s63, 3
    s_sub_u32 s63, s63, 300
    s_add_u32 s30, s30, s63
.et_23:
    s_cmp_eq_u32 s100, 0
    s_cbranch_scc1 .ls_24
    s_add_u32 m0, s32, 32768
    s_add_u32 s56, s101, 2359296
    buffer_load_dwordx4 v6, s[48:51], s56 offen nt lds
.ls_24:
    s_memrealtime s[8:9]
    s_waitcnt lgkmcnt(0)
    s_sub_u32 s8, s8, s30
    s_cmpk_ge_u32 s8, 1030
    s_cbranch_scc1 .ap_25
    s_waitcnt vmcnt(4)
    s_cmpk_ge_u32 s8, 965
    s_cbranch_scc1 .ap_25
    s_waitcnt vmcnt(3)
    s_bitcmp1_b64 s[14:15], 23
    s_cbranch_scc0 1
    s_waitcnt vmcnt(2)
    s_cmpk_ge_u32 s8, 890
    s_cbranch_scc1 .ap_25
    s_waitcnt vmcnt(1)
.ap_25:
    s_add_u32 s63, s69, 319488
    buffer_load_dwordx4 v[148:151], v1, s[40:43], s63 offen nt
    s_memrealtime s[8:9]
    s_waitcnt lgkmcnt(0)
    s_sub_u32 s8, s8, s30
    s_cmpk_ge_u32 s8, 1075
    s_cbranch_scc1 .ap_26
    s_waitcnt vmcnt(5)
    s_cmpk_ge_u32 s8, 1010
    s_cbranch_scc1 .ap_26
    s_waitcnt vmcnt(3)
    s_bitcmp1_b64 s[14:15], 24
    s_cbranch_scc0 1
    s_waitcnt vmcnt(2)
    s_cmpk_ge_u32 s8, 935
    s_cbranch_scc1 .ap_26
    s_waitcnt vmcnt(1)
.ap_26:
    s_add_u32 s63, s69, 393216
    buffer_load_dwordx4 v[56:59], v1, s[40:43], s63 offen nt
    s_memrealtime s[8:9]
    s_waitcnt lgkmcnt(0)
    s_sub_u32 s8, s8, s30
    s_cmpk_ge_u32 s8, 1120
    s_cbranch_scc1 .ap_27
    s_waitcnt vmcnt(5)
    s_cmpk_ge_u32 s8, 1055
    s_cbranch_scc1 .ap_27
    s_waitcnt vmcnt(3)
    s_bitcmp1_b64 s[14:15], 25
    s_cbranch_scc0 1
    s_waitcnt vmcnt(2)
    s_cmpk_ge_u32 s8, 980
    s_cbranch_scc1 .ap_27
    s_waitcnt vmcnt(1)
.ap_27:
    s_add_u32 s63, s69, 401408
    buffer_load_dwordx4 v[60:63], v1, s[40:43], s63 offen nt
    s_branch .Latt_bc
.Le_mr:
    s_mul_i32 s58, s3, 1152
    s_mov_b32 s52, s24
    s_and_b32 s53, s25, 0xffff
    s_mov_b32 s54, 0x2400
    s_mov_b32 s55, 0x00020000
    buffer_load_dwordx2 v[246:247], v3, s[52:55], s58 offen
    buffer_load_dwordx2 v[248:249], v3, s[52:55], s58 offen offset:512
    buffer_load_dword v250, v4, s[52:55], s58 offen
    s_mov_b32 s48, s26
    s_and_b32 s49, s27, 0xffff
    s_mov_b32 s50, 0x3cc000
    s_mov_b32 s51, 0x00020000
    v_bfe_u32 v12, v0, 4, 1
    s_and_b32 s56, s3, 3
    s_lshl_b32 s56, s56, 1
    v_or_b32 v12, s56, v12
    v_and_b32 v19, 7, v0
    v_xor_b32 v12, v12, v19
    v_lshrrev_b32 v19, 3, v0
    v_mul_u32_u24 v19, 6912, v19
    v_lshl_add_u32 v19, v12, 4, v19
    s_mul_i32 s57, s3, 55296
    s_lshl_b32 s59, s99, 7
    s_add_u32 s57, s57, s59
    s_lshl_b32 s100, s3, 10
    s_add_u32 m0, s100, 0
    s_add_u32 s56, s57, 0
    buffer_load_dwordx4 v19, s[48:51], s56 offen nt lds
    s_add_u32 m0, s100, 8192
    s_add_u32 s56, s57, 442368
    buffer_load_dwordx4 v19, s[48:51], s56 offen nt lds
    s_add_u32 m0, s100, 16384
    s_add_u32 s56, s57, 884736
    buffer_load_dwordx4 v19, s[48:51], s56 offen nt lds
    s_add_u32 m0, s100, 24576
    s_add_u32 s56, s57, 1327104
    buffer_load_dwordx4 v19, s[48:51], s56 offen nt lds
    s_add_u32 m0, s100, 32768
    s_add_u32 s56, s57, 1769472
    buffer_load_dwordx4 v19, s[48:51], s56 offen nt lds
    s_add_u32 m0, s100, 40960
    s_add_u32 s56, s57, 2211840
    buffer_load_dwordx4 v19, s[48:51], s56 offen nt lds
    s_add_u32 m0, s100, 49152
    s_add_u32 s56, s57, 2654208
    buffer_load_dwordx4 v19, s[48:51], s56 offen nt lds
    s_add_u32 m0, s100, 57344
    s_add_u32 s56, s57, 3096576
    buffer_load_dwordx4 v19, s[48:51], s56 offen nt lds
    s_add_u32 m0, s100, 65536
    s_add_u32 s56, s57, 3538944
    buffer_load_dwordx4 v19, s[48:51], s56 offen nt lds
    v_bfe_u32 v16, v0, 1, 3
    v_mul_u32_u24 v16, 1312, v16
    v_lshrrev_b32 v12, 4, v0
    v_lshl_add_u32 v16, v12, 5, v16
    v_and_b32 v12, 1, v0
    v_lshl_add_u32 v16, v12, 4, v16
    v_add_u32 v16, 147456, v16
    s_mul_i32 s56, s3, 1312
    s_add_u32 s56, s56, 147456
    v_add_u32 v17, s56, v3
    v_add_u32 v18, s56, v4
    v_lshrrev_b32 v12, 4, v0
    v_bfe_u32 v13, v0, 1, 1
    v_lshl_add_u32 v12, v12, 1, v13
    v_bfe_u32 v13, v0, 2, 2
    v_lshl_add_u32 v20, v12, 3, v13
    v_lshlrev_b32 v20, 7, v20
    v_and_b32 v12, 3, v12
    v_lshrrev_b32 v13, 1, v13
    v_lshl_add_u32 v12, v12, 1, v13
    v_xor_b32 v12, s3, v12
    v_lshl_add_u32 v20, v12, 4, v20
    v_and_b32 v12, 1, v0
    v_lshl_add_u32 v20, v12, 3, v20
    v_bfe_u32 v23, v0, 1, 3
    v_mul_u32_u24 v23, 144, v23
    v_bfe_u32 v12, v0, 4, 1
    v_lshl_add_u32 v23, v12, 3, v23
    v_lshrrev_b32 v12, 5, v0
    v_lshl_add_u32 v23, v12, 2, v23
    v_and_b32 v12, 1, v0
    v_lshl_add_u32 v23, v12, 1, v23
    s_lshl_b32 s56, s3, 4
    s_add_u32 s56, s56, 157952
    v_add_u32 v23, s56, v23
    v_and_b32 v24, 15, v0
    v_lshlrev_b32 v24, 3, v24
    s_mul_i32 s56, s3, 144
    s_add_u32 s56, s56, 157952
    v_add_u32 v24, s56, v24
    v_add_u32 v21, 32768, v20
    s_lshl_b32 s100, s3, 10
    v_lshrrev_b32 v12, 4, v0
    v_mul_u32_u24 v12, 18432, v12
    v_and_b32 v13, 15, v0
    v_lshl_add_u32 v22, v13, 4, v12
    s_mul_i32 s57, s99, 57
    s_lshr_b32 s57, s57, 9
    s_mul_i32 s58, s57, 9
    s_sub_u32 s58, s99, s58
    s_mul_i32 s59, s57, 36864
    s_lshl_b32 s58, s58, 8
    s_add_u32 s59, s59, s58
    s_mul_i32 s58, s3, 2304
    s_add_u32 s59, s59, s58
    s_add_u32 s59, s59, 0x3000
    s_mov_b32 s58, 0
    s_cmp_eq_u32 s57, 1
    s_cselect_b32 s58, 1.0, s58
    s_cmp_eq_u32 s57, 4
    s_cselect_b32 s58, 1.0, s58
    s_waitcnt vmcnt(9)
    v_lshlrev_b32 v236, 16, v246
    v_and_b32 v237, 0xffff0000, v246
    v_max_f32 v236, 0xc2ae0000, v236
    v_min_f32 v242, 0x43000000, v236
    v_mul_f32 v238, 0xbfb8aa3b, v242
    v_fma_f32 v240, v242, s98, -v238
    v_fmac_f32 v240, 0xb2a57060, v242
    v_exp_f32 v238, v238
    v_mul_f32 v240, 0x3f317218, v240
    v_fmac_f32 v238, v238, v240
    v_add_f32 v238, 1.0, v238
    v_rcp_f32 v240, v238
    s_nop 0
    v_mul_f32 v242, v236, v240
    v_fma_f32 v238, -v242, v238, v236
    v_fma_f32 v236, v238, v240, v242
    v_max_f32 v237, 0xc2ae0000, v237
    v_min_f32 v243, 0x43000000, v237
    v_mul_f32 v239, 0xbfb8aa3b, v243
    v_fma_f32 v241, v243, s98, -v239
    v_fmac_f32 v241, 0xb2a57060, v243
    v_exp_f32 v239, v239
    v_mul_f32 v241, 0x3f317218, v241
    v_fmac_f32 v239, v239, v241
    v_add_f32 v239, 1.0, v239
    v_rcp_f32 v241, v239
    s_nop 0
    v_mul_f32 v243, v237, v241
    v_fma_f32 v239, -v243, v239, v237
    v_fma_f32 v237, v239, v241, v243
    v_cvt_pk_bf16_f32 v246, v236, v237
    v_lshlrev_b32 v236, 16, v247
    v_and_b32 v237, 0xffff0000, v247
    v_max_f32 v236, 0xc2ae0000, v236
    v_min_f32 v242, 0x43000000, v236
    v_mul_f32 v238, 0xbfb8aa3b, v242
    v_fma_f32 v240, v242, s98, -v238
    v_fmac_f32 v240, 0xb2a57060, v242
    v_exp_f32 v238, v238
    v_mul_f32 v240, 0x3f317218, v240
    v_fmac_f32 v238, v238, v240
    v_add_f32 v238, 1.0, v238
    v_rcp_f32 v240, v238
    s_nop 0
    v_mul_f32 v242, v236, v240
    v_fma_f32 v238, -v242, v238, v236
    v_fma_f32 v236, v238, v240, v242
    v_max_f32 v237, 0xc2ae0000, v237
    v_min_f32 v243, 0x43000000, v237
    v_mul_f32 v239, 0xbfb8aa3b, v243
    v_fma_f32 v241, v243, s98, -v239
    v_fmac_f32 v241, 0xb2a57060, v243
    v_exp_f32 v239, v239
    v_mul_f32 v241, 0x3f317218, v241
    v_fmac_f32 v239, v239, v241
    v_add_f32 v239, 1.0, v239
    v_rcp_f32 v241, v239
    s_nop 0
    v_mul_f32 v243, v237, v241
    v_fma_f32 v239, -v243, v239, v237
    v_fma_f32 v237, v239, v241, v243
    v_cvt_pk_bf16_f32 v247, v236, v237
    v_lshlrev_b32 v236, 16, v248
    v_and_b32 v237, 0xffff0000, v248
    v_max_f32 v236, 0xc2ae0000, v236
    v_min_f32 v242, 0x43000000, v236
    v_mul_f32 v238, 0xbfb8aa3b, v242
    v_fma_f32 v240, v242, s98, -v238
    v_fmac_f32 v240, 0xb2a57060, v242
    v_exp_f32 v238, v238
    v_mul_f32 v240, 0x3f317218, v240
    v_fmac_f32 v238, v238, v240
    v_add_f32 v238, 1.0, v238
    v_rcp_f32 v240, v238
    s_nop 0
    v_mul_f32 v242, v236, v240
    v_fma_f32 v238, -v242, v238, v236
    v_fma_f32 v236, v238, v240, v242
    v_max_f32 v237, 0xc2ae0000, v237
    v_min_f32 v243, 0x43000000, v237
    v_mul_f32 v239, 0xbfb8aa3b, v243
    v_fma_f32 v241, v243, s98, -v239
    v_fmac_f32 v241, 0xb2a57060, v243
    v_exp_f32 v239, v239
    v_mul_f32 v241, 0x3f317218, v241
    v_fmac_f32 v239, v239, v241
    v_add_f32 v239, 1.0, v239
    v_rcp_f32 v241, v239
    s_nop 0
    v_mul_f32 v243, v237, v241
    v_fma_f32 v239, -v243, v239, v237
    v_fma_f32 v237, v239, v241, v243
    v_cvt_pk_bf16_f32 v248, v236, v237
    v_lshlrev_b32 v236, 16, v249
    v_and_b32 v237, 0xffff0000, v249
    v_max_f32 v236, 0xc2ae0000, v236
    v_min_f32 v242, 0x43000000, v236
    v_mul_f32 v238, 0xbfb8aa3b, v242
    v_fma_f32 v240, v242, s98, -v238
    v_fmac_f32 v240, 0xb2a57060, v242
    v_exp_f32 v238, v238
    v_mul_f32 v240, 0x3f317218, v240
    v_fmac_f32 v238, v238, v240
    v_add_f32 v238, 1.0, v238
    v_rcp_f32 v240, v238
    s_nop 0
    v_mul_f32 v242, v236, v240
    v_fma_f32 v238, -v242, v238, v236
    v_fma_f32 v236, v238, v240, v242
    v_max_f32 v237, 0xc2ae0000, v237
    v_min_f32 v243, 0x43000000, v237
    v_mul_f32 v239, 0xbfb8aa3b, v243
    v_fma_f32 v241, v243, s98, -v239
    v_fmac_f32 v241, 0xb2a57060, v243
    v_exp_f32 v239, v239
    v_mul_f32 v241, 0x3f317218, v241
    v_fmac_f32 v239, v239, v241
    v_add_f32 v239, 1.0, v239
    v_rcp_f32 v241, v239
    s_nop 0
    v_mul_f32 v243, v237, v241
    v_fma_f32 v239, -v243, v239, v237
    v_fma_f32 v237, v239, v241, v243
    v_cvt_pk_bf16_f32 v249, v236, v237
    v_lshlrev_b32 v236, 16, v250
    v_and_b32 v237, 0xffff0000, v250
    v_max_f32 v236, 0xc2ae0000, v236
    v_min_f32 v242, 0x43000000, v236
    v_mul_f32 v238, 0xbfb8aa3b, v242
    v_fma_f32 v240, v242, s98, -v238
    v_fmac_f32 v240, 0xb2a57060, v242
    v_exp_f32 v238, v238
    v_mul_f32 v240, 0x3f317218, v240
    v_fmac_f32 v238, v238, v240
    v_add_f32 v238, 1.0, v238
    v_rcp_f32 v240, v238
    s_nop 0
    v_mul_f32 v242, v236, v240
    v_fma_f32 v238, -v242, v238, v236
    v_fma_f32 v236, v238, v240, v242
    v_max_f32 v237, 0xc2ae0000, v237
    v_min_f32 v243, 0x43000000, v237
    v_mul_f32 v239, 0xbfb8aa3b, v243
    v_fma_f32 v241, v243, s98, -v239
    v_fmac_f32 v241, 0xb2a57060, v243
    v_exp_f32 v239, v239
    v_mul_f32 v241, 0x3f317218, v241
    v_fmac_f32 v239, v239, v241
    v_add_f32 v239, 1.0, v239
    v_rcp_f32 v241, v239
    s_nop 0
    v_mul_f32 v243, v237, v241
    v_fma_f32 v239, -v243, v239, v237
    v_fma_f32 v237, v239, v241, v243
    v_cvt_pk_bf16_f32 v250, v236, v237
    ds_write_b64 v17, v[246:247]
    ds_write_b64 v17, v[248:249] offset:512
    ds_write_b32 v18, v250
    s_waitcnt vmcnt(3)
    s_add_u32 s63, s69, 147456
    buffer_load_dwordx4 v[72:75], v1, s[40:43], s63 offen nt
    s_waitcnt vmcnt(3)
    s_add_u32 s63, s69, 155648
    buffer_load_dwordx4 v[76:79], v1, s[40:43], s63 offen nt
    s_waitcnt vmcnt(3)
    s_add_u32 s63, s69, 163840
    buffer_load_dwordx4 v[104:107], v1, s[40:43], s63 offen nt
    s_waitcnt vmcnt(3)
    s_add_u32 s63, s69, 172032
    buffer_load_dwordx4 v[108:111], v1, s[40:43], s63 offen nt
    s_waitcnt vmcnt(3)
    s_add_u32 s63, s69, 180224
    buffer_load_dwordx4 v[136:139], v1, s[40:43], s63 offen nt
    s_waitcnt vmcnt(3)
    s_add_u32 s63, s69, 188416
    buffer_load_dwordx4 v[140:143], v1, s[40:43], s63 offen nt
    s_waitcnt vmcnt(3)
    s_add_u32 s63, s69, 262144
    buffer_load_dwordx4 v[48:51], v1, s[40:43], s63 offen nt
    s_waitcnt vmcnt(3)
    s_add_u32 s63, s69, 270336
    buffer_load_dwordx4 v[52:55], v1, s[40:43], s63 offen nt
    s_waitcnt lgkmcnt(0)
    s_barrier
    ds_read_b64_tr_b16 v[160:161], v20 offset:0
    ds_read_b64_tr_b16 v[162:163], v20 offset:512
    ds_read_b64_tr_b16 v[164:165], v20 offset:8192
    ds_read_b64_tr_b16 v[166:167], v20 offset:8704
    ds_read_b64_tr_b16 v[168:169], v20 offset:16384
    ds_read_b64_tr_b16 v[170:171], v20 offset:16896
    ds_read_b64_tr_b16 v[172:173], v20 offset:24576
    ds_read_b64_tr_b16 v[174:175], v20 offset:25088
    ds_read_b64_tr_b16 v[176:177], v21 offset:0
    ds_read_b64_tr_b16 v[178:179], v21 offset:512
    ds_read_b64_tr_b16 v[180:181], v21 offset:8192
    ds_read_b64_tr_b16 v[182:183], v21 offset:8704
    ds_read_b64_tr_b16 v[184:185], v21 offset:16384
    ds_read_b64_tr_b16 v[186:187], v21 offset:16896
    ds_read_b64_tr_b16 v[188:189], v21 offset:24576
    ds_read_b64_tr_b16 v[190:191], v21 offset:25088
    ds_read_b64_tr_b16 v[192:193], v21 offset:32768
    ds_read_b64_tr_b16 v[194:195], v21 offset:33280
    ds_read_b128 v[196:199], v16 offset:0
    ds_read_b128 v[200:203], v16 offset:128
    ds_read_b128 v[204:207], v16 offset:256
    ds_read_b128 v[208:211], v16 offset:384
    ds_read_b128 v[212:215], v16 offset:512
    ds_read_b128 v[216:219], v16 offset:640
    ds_read_b128 v[220:223], v16 offset:768
    ds_read_b128 v[224:227], v16 offset:896
    ds_read_b128 v[228:231], v16 offset:1024
    s_waitcnt lgkmcnt(8)
    v_mfma_f32_16x16x32_bf16 v[232:235], v[160:163], v[196:199], 0
    s_waitcnt lgkmcnt(7)
    v_mfma_f32_16x16x32_bf16 v[232:235], v[164:167], v[200:203], v[232:235]
    s_waitcnt lgkmcnt(6)
    v_mfma_f32_16x16x32_bf16 v[232:235], v[168:171], v[204:207], v[232:235]
    s_waitcnt lgkmcnt(5)
    v_mfma_f32_16x16x32_bf16 v[232:235], v[172:175], v[208:211], v[232:235]
    s_waitcnt lgkmcnt(4)
    v_mfma_f32_16x16x32_bf16 v[232:235], v[176:179], v[212:215], v[232:235]
    s_waitcnt lgkmcnt(3)
    v_mfma_f32_16x16x32_bf16 v[232:235], v[180:183], v[216:219], v[232:235]
    s_waitcnt lgkmcnt(2)
    v_mfma_f32_16x16x32_bf16 v[232:235], v[184:187], v[220:223], v[232:235]
    s_waitcnt lgkmcnt(1)
    v_mfma_f32_16x16x32_bf16 v[232:235], v[188:191], v[224:227], v[232:235]
    s_waitcnt lgkmcnt(0)
    v_mfma_f32_16x16x32_bf16 v[232:235], v[192:195], v[228:231], v[232:235]
    s_nop 7
    v_permlane32_swap_b32 v232, v234
    v_permlane32_swap_b32 v233, v235
    v_cndmask_b32 v233, v233, v234, s[96:97]
    v_cndmask_b32 v232, v232, v235, s[96:97]
    s_nop 1
    v_add_f32_dpp v236, v233, v232 quad_perm:[1,0,3,2] row_mask:0xf bank_mask:0xf
    v_cvt_pk_bf16_f32 v236, 0, v236
    v_add_f32 v236, s58, v236
    v_cvt_pk_bf16_f32 v236, v236, v236
    ds_write_b16 v23, v236
    v_mov_b32 v243, s34
    s_waitcnt lgkmcnt(0)
    s_barrier
    ds_read2_b32 v[244:245], v24 offset1:1
    v_mov_b32 v241, s34
    s_waitcnt lgkmcnt(0)
    v_mov_b32 v240, v244
    v_mov_b32 v242, v245
    s_mov_b64 exec, 0xffff
    buffer_store_dwordx4 v[240:243], v22, s[36:39], s59 offen sc1
    s_mov_b64 exec, -1
    s_nop 0
    s_branch .Le_m2
.Le_mc:
    v_bfe_u32 v16, v0, 1, 3
    v_mul_u32_u24 v16, 1312, v16
    v_lshrrev_b32 v12, 4, v0
    v_lshl_add_u32 v16, v12, 5, v16
    v_and_b32 v12, 1, v0
    v_lshl_add_u32 v16, v12, 4, v16
    v_add_u32 v16, 147456, v16
    s_mul_i32 s56, s3, 1312
    s_add_u32 s56, s56, 147456
    v_add_u32 v17, s56, v3
    v_add_u32 v18, s56, v4
    v_lshrrev_b32 v12, 4, v0
    v_bfe_u32 v13, v0, 1, 1
    v_lshl_add_u32 v12, v12, 1, v13
    v_bfe_u32 v13, v0, 2, 2
    v_lshl_add_u32 v20, v12, 3, v13
    v_lshlrev_b32 v20, 7, v20
    v_and_b32 v12, 3, v12
    v_lshrrev_b32 v13, 1, v13
    v_lshl_add_u32 v12, v12, 1, v13
    v_xor_b32 v12, s3, v12
    v_lshl_add_u32 v20, v12, 4, v20
    v_and_b32 v12, 1, v0
    v_lshl_add_u32 v20, v12, 3, v20
    v_bfe_u32 v23, v0, 1, 3
    v_mul_u32_u24 v23, 144, v23
    v_bfe_u32 v12, v0, 4, 1
    v_lshl_add_u32 v23, v12, 3, v23
    v_lshrrev_b32 v12, 5, v0
    v_lshl_add_u32 v23, v12, 2, v23
    v_and_b32 v12, 1, v0
    v_lshl_add_u32 v23, v12, 1, v23
    s_lshl_b32 s56, s3, 4
    s_add_u32 s56, s56, 157952
    v_add_u32 v23, s56, v23
    v_and_b32 v24, 15, v0
    v_lshlrev_b32 v24, 3, v24
    s_mul_i32 s56, s3, 144
    s_add_u32 s56, s56, 157952
    v_add_u32 v24, s56, v24
    v_add_u32 v21, 32768, v20
    s_lshl_b32 s100, s3, 10
    s_waitcnt lgkmcnt(0)
    s_add_u32 s34, s34, 1
    v_lshrrev_b32 v12, 4, v0
    v_mul_u32_u24 v12, 18432, v12
    v_and_b32 v13, 15, v0
    v_lshl_add_u32 v22, v13, 4, v12
    s_mul_i32 s57, s99, 57
    s_lshr_b32 s57, s57, 9
    s_mul_i32 s58, s57, 9
    s_sub_u32 s58, s99, s58
    s_mul_i32 s59, s57, 36864
    s_lshl_b32 s58, s58, 8
    s_add_u32 s59, s59, s58
    s_mul_i32 s58, s3, 2304
    s_add_u32 s59, s59, s58
    s_add_u32 s59, s59, 0x3000
    s_mov_b32 s58, 0
    s_cmp_eq_u32 s57, 1
    s_cselect_b32 s58, 1.0, s58
    s_cmp_eq_u32 s57, 4
    s_cselect_b32 s58, 1.0, s58
    s_waitcnt vmcnt(13)
    v_lshlrev_b32 v236, 16, v246
    v_and_b32 v237, 0xffff0000, v246
    v_max_f32 v236, 0xc2ae0000, v236
    v_min_f32 v242, 0x43000000, v236
    v_mul_f32 v238, 0xbfb8aa3b, v242
    v_fma_f32 v240, v242, s98, -v238
    v_fmac_f32 v240, 0xb2a57060, v242
    v_exp_f32 v238, v238
    v_mul_f32 v240, 0x3f317218, v240
    v_fmac_f32 v238, v238, v240
    v_add_f32 v238, 1.0, v238
    v_rcp_f32 v240, v238
    s_nop 0
    v_mul_f32 v242, v236, v240
    v_fma_f32 v238, -v242, v238, v236
    v_fma_f32 v236, v238, v240, v242
    v_max_f32 v237, 0xc2ae0000, v237
    v_min_f32 v243, 0x43000000, v237
    v_mul_f32 v239, 0xbfb8aa3b, v243
    v_fma_f32 v241, v243, s98, -v239
    v_fmac_f32 v241, 0xb2a57060, v243
    v_exp_f32 v239, v239
    v_mul_f32 v241, 0x3f317218, v241
    v_fmac_f32 v239, v239, v241
    v_add_f32 v239, 1.0, v239
    v_rcp_f32 v241, v239
    s_nop 0
    v_mul_f32 v243, v237, v241
    v_fma_f32 v239, -v243, v239, v237
    v_fma_f32 v237, v239, v241, v243
    v_cvt_pk_bf16_f32 v246, v236, v237
    v_lshlrev_b32 v236, 16, v247
    v_and_b32 v237, 0xffff0000, v247
    v_max_f32 v236, 0xc2ae0000, v236
    v_min_f32 v242, 0x43000000, v236
    v_mul_f32 v238, 0xbfb8aa3b, v242
    v_fma_f32 v240, v242, s98, -v238
    v_fmac_f32 v240, 0xb2a57060, v242
    v_exp_f32 v238, v238
    v_mul_f32 v240, 0x3f317218, v240
    v_fmac_f32 v238, v238, v240
    v_add_f32 v238, 1.0, v238
    v_rcp_f32 v240, v238
    s_nop 0
    v_mul_f32 v242, v236, v240
    v_fma_f32 v238, -v242, v238, v236
    v_fma_f32 v236, v238, v240, v242
    v_max_f32 v237, 0xc2ae0000, v237
    v_min_f32 v243, 0x43000000, v237
    v_mul_f32 v239, 0xbfb8aa3b, v243
    v_fma_f32 v241, v243, s98, -v239
    v_fmac_f32 v241, 0xb2a57060, v243
    v_exp_f32 v239, v239
    v_mul_f32 v241, 0x3f317218, v241
    v_fmac_f32 v239, v239, v241
    v_add_f32 v239, 1.0, v239
    v_rcp_f32 v241, v239
    s_nop 0
    v_mul_f32 v243, v237, v241
    v_fma_f32 v239, -v243, v239, v237
    v_fma_f32 v237, v239, v241, v243
    v_cvt_pk_bf16_f32 v247, v236, v237
    v_lshlrev_b32 v236, 16, v248
    v_and_b32 v237, 0xffff0000, v248
    v_max_f32 v236, 0xc2ae0000, v236
    v_min_f32 v242, 0x43000000, v236
    v_mul_f32 v238, 0xbfb8aa3b, v242
    v_fma_f32 v240, v242, s98, -v238
    v_fmac_f32 v240, 0xb2a57060, v242
    v_exp_f32 v238, v238
    v_mul_f32 v240, 0x3f317218, v240
    v_fmac_f32 v238, v238, v240
    v_add_f32 v238, 1.0, v238
    v_rcp_f32 v240, v238
    s_nop 0
    v_mul_f32 v242, v236, v240
    v_fma_f32 v238, -v242, v238, v236
    v_fma_f32 v236, v238, v240, v242
    v_max_f32 v237, 0xc2ae0000, v237
    v_min_f32 v243, 0x43000000, v237
    v_mul_f32 v239, 0xbfb8aa3b, v243
    v_fma_f32 v241, v243, s98, -v239
    v_fmac_f32 v241, 0xb2a57060, v243
    v_exp_f32 v239, v239
    v_mul_f32 v241, 0x3f317218, v241
    v_fmac_f32 v239, v239, v241
    v_add_f32 v239, 1.0, v239
    v_rcp_f32 v241, v239
    s_nop 0
    v_mul_f32 v243, v237, v241
    v_fma_f32 v239, -v243, v239, v237
    v_fma_f32 v237, v239, v241, v243
    v_cvt_pk_bf16_f32 v248, v236, v237
    v_lshlrev_b32 v236, 16, v249
    v_and_b32 v237, 0xffff0000, v249
    v_max_f32 v236, 0xc2ae0000, v236
    v_min_f32 v242, 0x43000000, v236
    v_mul_f32 v238, 0xbfb8aa3b, v242
    v_fma_f32 v240, v242, s98, -v238
    v_fmac_f32 v240, 0xb2a57060, v242
    v_exp_f32 v238, v238
    v_mul_f32 v240, 0x3f317218, v240
    v_fmac_f32 v238, v238, v240
    v_add_f32 v238, 1.0, v238
    v_rcp_f32 v240, v238
    s_nop 0
    v_mul_f32 v242, v236, v240
    v_fma_f32 v238, -v242, v238, v236
    v_fma_f32 v236, v238, v240, v242
    v_max_f32 v237, 0xc2ae0000, v237
    v_min_f32 v243, 0x43000000, v237
    v_mul_f32 v239, 0xbfb8aa3b, v243
    v_fma_f32 v241, v243, s98, -v239
    v_fmac_f32 v241, 0xb2a57060, v243
    v_exp_f32 v239, v239
    v_mul_f32 v241, 0x3f317218, v241
    v_fmac_f32 v239, v239, v241
    v_add_f32 v239, 1.0, v239
    v_rcp_f32 v241, v239
    s_nop 0
    v_mul_f32 v243, v237, v241
    v_fma_f32 v239, -v243, v239, v237
    v_fma_f32 v237, v239, v241, v243
    v_cvt_pk_bf16_f32 v249, v236, v237
    v_lshlrev_b32 v236, 16, v250
    v_and_b32 v237, 0xffff0000, v250
    v_max_f32 v236, 0xc2ae0000, v236
    v_min_f32 v242, 0x43000000, v236
    v_mul_f32 v238, 0xbfb8aa3b, v242
    v_fma_f32 v240, v242, s98, -v238
    v_fmac_f32 v240, 0xb2a57060, v242
    v_exp_f32 v238, v238
    v_mul_f32 v240, 0x3f317218, v240
    v_fmac_f32 v238, v238, v240
    v_add_f32 v238, 1.0, v238
    v_rcp_f32 v240, v238
    s_nop 0
    v_mul_f32 v242, v236, v240
    v_fma_f32 v238, -v242, v238, v236
    v_fma_f32 v236, v238, v240, v242
    v_max_f32 v237, 0xc2ae0000, v237
    v_min_f32 v243, 0x43000000, v237
    v_mul_f32 v239, 0xbfb8aa3b, v243
    v_fma_f32 v241, v243, s98, -v239
    v_fmac_f32 v241, 0xb2a57060, v243
    v_exp_f32 v239, v239
    v_mul_f32 v241, 0x3f317218, v241
    v_fmac_f32 v239, v239, v241
    v_add_f32 v239, 1.0, v239
    v_rcp_f32 v241, v239
    s_nop 0
    v_mul_f32 v243, v237, v241
    v_fma_f32 v239, -v243, v239, v237
    v_fma_f32 v237, v239, v241, v243
    v_cvt_pk_bf16_f32 v250, v236, v237
    ds_write_b64 v17, v[246:247]
    ds_write_b64 v17, v[248:249] offset:512
    ds_write_b32 v18, v250
    s_waitcnt vmcnt(4)
    s_waitcnt lgkmcnt(0)
    s_barrier
    ds_read_b64_tr_b16 v[160:161], v20 offset:0
    ds_read_b64_tr_b16 v[162:163], v20 offset:512
    ds_read_b64_tr_b16 v[164:165], v20 offset:8192
    ds_read_b64_tr_b16 v[166:167], v20 offset:8704
    ds_read_b64_tr_b16 v[168:169], v20 offset:16384
    ds_read_b64_tr_b16 v[170:171], v20 offset:16896
    ds_read_b64_tr_b16 v[172:173], v20 offset:24576
    ds_read_b64_tr_b16 v[174:175], v20 offset:25088
    ds_read_b64_tr_b16 v[176:177], v21 offset:0
    ds_read_b64_tr_b16 v[178:179], v21 offset:512
    ds_read_b64_tr_b16 v[180:181], v21 offset:8192
    ds_read_b64_tr_b16 v[182:183], v21 offset:8704
    ds_read_b64_tr_b16 v[184:185], v21 offset:16384
    ds_read_b64_tr_b16 v[186:187], v21 offset:16896
    ds_read_b64_tr_b16 v[188:189], v21 offset:24576
    ds_read_b64_tr_b16 v[190:191], v21 offset:25088
    ds_read_b64_tr_b16 v[192:193], v21 offset:32768
    ds_read_b64_tr_b16 v[194:195], v21 offset:33280
    ds_read_b128 v[196:199], v16 offset:0
    ds_read_b128 v[200:203], v16 offset:128
    ds_read_b128 v[204:207], v16 offset:256
    ds_read_b128 v[208:211], v16 offset:384
    ds_read_b128 v[212:215], v16 offset:512
    ds_read_b128 v[216:219], v16 offset:640
    ds_read_b128 v[220:223], v16 offset:768
    ds_read_b128 v[224:227], v16 offset:896
    ds_read_b128 v[228:231], v16 offset:1024
    s_waitcnt lgkmcnt(8)
    v_mfma_f32_16x16x32_bf16 v[232:235], v[160:163], v[196:199], 0
    s_waitcnt lgkmcnt(7)
    v_mfma_f32_16x16x32_bf16 v[232:235], v[164:167], v[200:203], v[232:235]
    s_waitcnt lgkmcnt(6)
    v_mfma_f32_16x16x32_bf16 v[232:235], v[168:171], v[204:207], v[232:235]
    s_waitcnt lgkmcnt(5)
    v_mfma_f32_16x16x32_bf16 v[232:235], v[172:175], v[208:211], v[232:235]
    s_waitcnt lgkmcnt(4)
    v_mfma_f32_16x16x32_bf16 v[232:235], v[176:179], v[212:215], v[232:235]
    s_waitcnt lgkmcnt(3)
    v_mfma_f32_16x16x32_bf16 v[232:235], v[180:183], v[216:219], v[232:235]
    s_waitcnt lgkmcnt(2)
    v_mfma_f32_16x16x32_bf16 v[232:235], v[184:187], v[220:223], v[232:235]
    s_waitcnt lgkmcnt(1)
    v_mfma_f32_16x16x32_bf16 v[232:235], v[188:191], v[224:227], v[232:235]
    s_waitcnt lgkmcnt(0)
    v_mfma_f32_16x16x32_bf16 v[232:235], v[192:195], v[228:231], v[232:235]
    s_nop 7
    v_permlane32_swap_b32 v232, v234
    v_permlane32_swap_b32 v233, v235
    v_cndmask_b32 v233, v233, v234, s[96:97]
    v_cndmask_b32 v232, v232, v235, s[96:97]
    s_nop 1
    v_add_f32_dpp v236, v233, v232 quad_perm:[1,0,3,2] row_mask:0xf bank_mask:0xf
    v_cvt_pk_bf16_f32 v236, 0, v236
    v_add_f32 v236, s58, v236
    v_cvt_pk_bf16_f32 v236, v236, v236
    ds_write_b16 v23, v236
    v_mov_b32 v243, s34
    s_waitcnt lgkmcnt(0)
    s_barrier
    ds_read2_b32 v[244:245], v24 offset1:1
    v_mov_b32 v241, s34
    s_waitcnt lgkmcnt(0)
    v_mov_b32 v240, v244
    v_mov_b32 v242, v245
    s_mov_b64 exec, 0xffffffff
    buffer_store_dwordx4 v[240:243], v22, s[36:39], s59 offen sc1
    s_mov_b64 exec, -1
    s_mov_b32 s14, 0x6b5ad6b5
    s_mov_b32 s15, 0x5ad6b5ad
    s_add_u32 s30, s70, -30
    s_waitcnt vmcnt(3)
    s_add_u32 s63, s69, 32768
    buffer_load_dwordx4 v[96:99], v1, s[40:43], s63 offen nt
    s_waitcnt vmcnt(3)
    s_add_u32 s63, s69, 40960
    buffer_load_dwordx4 v[100:103], v1, s[40:43], s63 offen nt
    s_waitcnt vmcnt(3)
    s_add_u32 s63, s69, 49152
    buffer_load_dwordx4 v[128:131], v1, s[40:43], s63 offen nt
    s_waitcnt vmcnt(3)
    s_add_u32 s63, s69, 57344
    buffer_load_dwordx4 v[132:135], v1, s[40:43], s63 offen nt
    s_waitcnt vmcnt(3)
    s_add_u32 s63, s69, 131072
    buffer_load_dwordx4 v[40:43], v1, s[40:43], s63 offen nt
    s_waitcnt vmcnt(3)
    s_add_u32 s63, s69, 139264
    buffer_load_dwordx4 v[44:47], v1, s[40:43], s63 offen nt
    s_waitcnt vmcnt(3)
    s_add_u32 s63, s69, 147456
    buffer_load_dwordx4 v[72:75], v1, s[40:43], s63 offen nt
    s_waitcnt vmcnt(3)
    s_add_u32 s63, s69, 155648
    buffer_load_dwordx4 v[76:79], v1, s[40:43], s63 offen nt
    s_waitcnt vmcnt(3)
    s_add_u32 s63, s69, 163840
    buffer_load_dwordx4 v[104:107], v1, s[40:43], s63 offen nt
    s_waitcnt vmcnt(3)
    s_add_u32 s63, s69, 172032
    buffer_load_dwordx4 v[108:111], v1, s[40:43], s63 offen nt
    s_waitcnt vmcnt(3)
    s_add_u32 s63, s69, 180224
    buffer_load_dwordx4 v[136:139], v1, s[40:43], s63 offen nt
    s_waitcnt vmcnt(3)
    s_add_u32 s63, s69, 188416
    buffer_load_dwordx4 v[140:143], v1, s[40:43], s63 offen nt
    s_waitcnt vmcnt(3)
    s_add_u32 s63, s69, 262144
    buffer_load_dwordx4 v[48:51], v1, s[40:43], s63 offen nt
    s_waitcnt vmcnt(3)
    s_add_u32 s63, s69, 270336
    buffer_load_dwordx4 v[52:55], v1, s[40:43], s63 offen nt
.Le_m2:
    s_waitcnt vmcnt(3)
    s_bitcmp1_b64 s[14:15], 18
    s_cbranch_scc0 1
    s_waitcnt vmcnt(2)
    s_add_u32 s63, s69, 278528
    buffer_load_dwordx4 v[80:83], v1, s[40:43], s63 offen nt
    v_and_b32 v157, 7, v0
    v_lshlrev_b32 v157, 7, v157
    s_mov_b32 s63, 0x400
    buffer_load_dword v156, v157, s[36:39], s63 offen
    s_memrealtime s[8:9]
    s_waitcnt lgkmcnt(0)
    s_sub_u32 s8, s8, s30
    s_cmpk_ge_u32 s8, 850
    s_cbranch_scc1 .ap_28
    s_waitcnt vmcnt(5)
    s_cmpk_ge_u32 s8, 785
    s_cbranch_scc1 .ap_28
    s_waitcnt vmcnt(4)
    s_bitcmp1_b64 s[14:15], 19
    s_cbranch_scc0 1
    s_waitcnt vmcnt(3)
    s_cmpk_ge_u32 s8, 710
    s_cbranch_scc1 .ap_28
    s_waitcnt vmcnt(2)
.ap_28:
    s_add_u32 s63, s69, 286720
    buffer_load_dwordx4 v[84:87], v1, s[40:43], s63 offen nt
    s_memrealtime s[8:9]
    s_waitcnt lgkmcnt(0)
    s_sub_u32 s8, s8, s30
    s_cmpk_ge_u32 s8, 895
    s_cbranch_scc1 .ap_29
    s_waitcnt vmcnt(6)
    s_cmpk_ge_u32 s8, 830
    s_cbranch_scc1 .ap_29
    s_waitcnt vmcnt(4)
    s_bitcmp1_b64 s[14:15], 20
    s_cbranch_scc0 1
    s_waitcnt vmcnt(3)
    s_cmpk_ge_u32 s8, 755
    s_cbranch_scc1 .ap_29
    s_waitcnt vmcnt(2)
.ap_29:
    s_add_u32 s63, s69, 294912
    buffer_load_dwordx4 v[112:115], v1, s[40:43], s63 offen nt
    s_memrealtime s[8:9]
    s_waitcnt lgkmcnt(0)
    s_sub_u32 s8, s8, s30
    s_cmpk_ge_u32 s8, 940
    s_cbranch_scc1 .ap_30
    s_waitcnt vmcnt(6)
    s_cmpk_ge_u32 s8, 875
    s_cbranch_scc1 .ap_30
    s_waitcnt vmcnt(4)
    s_bitcmp1_b64 s[14:15], 21
    s_cbranch_scc0 1
    s_waitcnt vmcnt(3)
    s_cmpk_ge_u32 s8, 800
    s_cbranch_scc1 .ap_30
    s_waitcnt vmcnt(1)
.ap_30:
    s_add_u32 s63, s69, 303104
    buffer_load_dwordx4 v[116:119], v1, s[40:43], s63 offen nt
    s_memrealtime s[8:9]
    s_waitcnt lgkmcnt(0)
    s_sub_u32 s8, s8, s30
    s_cmpk_ge_u32 s8, 985
    s_cbranch_scc1 .ap_31
    s_waitcnt vmcnt(6)
    s_cmpk_ge_u32 s8, 920
    s_cbranch_scc1 .ap_31
    s_waitcnt vmcnt(4)
    s_bitcmp1_b64 s[14:15], 22
    s_cbranch_scc0 1
    s_waitcnt vmcnt(2)
    s_cmpk_ge_u32 s8, 845
    s_cbranch_scc1 .ap_31
    s_waitcnt vmcnt(1)
.ap_31:
    s_add_u32 s63, s69, 311296
    buffer_load_dwordx4 v[144:147], v1, s[40:43], s63 offen nt
    s_waitcnt vmcnt(4)
    s_sub_u32 s63, s70, 300
    v_subrev_u32 v156, s63, v156
    v_mov_b32 v157, 600
    v_cmp_lt_u32 s[8:9], v156, v157
    v_add_u32_dpp v156, v156, v156 quad_perm:[1,0,3,2] row_mask:0xf bank_mask:0xf
    s_nop 1
    v_add_u32_dpp v156, v156, v156 quad_perm:[2,3,0,1] row_mask:0xf bank_mask:0xf
    s_nop 1
    v_add_u32_dpp v156, v156, v156 row_ror:4 row_mask:0xf bank_mask:0xf
    s_nop 0
    v_readfirstlane_b32 s63, v156
    s_cmp_eq_u64 s[8:9], -1
    s_nop 3
    s_cbranch_scc0 .et_32
    s_lshr_b32 s63, s63, 3
    s_sub_u32 s63, s63, 300
    s_add_u32 s30, s30, s63
.et_32:
    s_memrealtime s[8:9]
    s_waitcnt lgkmcnt(0)
    s_sub_u32 s8, s8, s30
    s_cmpk_ge_u32 s8, 1030
    s_cbranch_scc1 .ap_33
    s_waitcnt vmcnt(4)
    s_cmpk_ge_u32 s8, 965
    s_cbranch_scc1 .ap_33
    s_waitcnt vmcnt(3)
    s_bitcmp1_b64 s[14:15], 23
    s_cbranch_scc0 1
    s_waitcnt vmcnt(2)
    s_cmpk_ge_u32 s8, 890
    s_cbranch_scc1 .ap_33
    s_waitcnt vmcnt(1)
.ap_33:
    s_add_u32 s63, s69, 319488
    buffer_load_dwordx4 v[148:151], v1, s[40:43], s63 offen nt
    s_memrealtime s[8:9]
    s_waitcnt lgkmcnt(0)
    s_sub_u32 s8, s8, s30
    s_cmpk_ge_u32 s8, 1075
    s_cbranch_scc1 .ap_34
    s_waitcnt vmcnt(5)
    s_cmpk_ge_u32 s8, 1010
    s_cbranch_scc1 .ap_34
    s_waitcnt vmcnt(3)
    s_bitcmp1_b64 s[14:15], 24
    s_cbranch_scc0 1
    s_waitcnt vmcnt(2)
    s_cmpk_ge_u32 s8, 935
    s_cbranch_scc1 .ap_34
    s_waitcnt vmcnt(1)
.ap_34:
    s_add_u32 s63, s69, 393216
    buffer_load_dwordx4 v[56:59], v1, s[40:43], s63 offen nt
    s_memrealtime s[8:9]
    s_waitcnt lgkmcnt(0)
    s_sub_u32 s8, s8, s30
    s_cmpk_ge_u32 s8, 1120
    s_cbranch_scc1 .ap_35
    s_waitcnt vmcnt(5)
    s_cmpk_ge_u32 s8, 1055
    s_cbranch_scc1 .ap_35
    s_waitcnt vmcnt(3)
    s_bitcmp1_b64 s[14:15], 25
    s_cbranch_scc0 1
    s_waitcnt vmcnt(2)
    s_cmpk_ge_u32 s8, 980
    s_cbranch_scc1 .ap_35
    s_waitcnt vmcnt(1)
.ap_35:
    s_add_u32 s63, s69, 401408
    buffer_load_dwordx4 v[60:63], v1, s[40:43], s63 offen nt
    s_mov_b32 s24, 0
    s_cmp_lt_u32 s2, 216
    s_cbranch_scc1 .Latt_bc
    s_branch .Latt_n
.Le_q:
    s_cmp_ge_u32 s65, 27
    s_mov_b32 s14, 0x94a5294a
    s_cselect_b32 s14, 0x0, s14
    s_mov_b32 s15, 0xa5294a52
    s_cselect_b32 s15, 0x0, s15
    s_cselect_b32 s30, -30, 0
    s_add_u32 s30, s30, 0
    s_add_u32 s30, s30, s70
    s_mul_i32 s58, s3, 1152
    s_mov_b32 s52, s4
    s_and_b32 s53, s5, 0xffff
    s_mov_b32 s54, 0x2400
    s_mov_b32 s55, 0x00020000
    buffer_load_dwordx2 v[246:247], v3, s[52:55], s58 offen
    buffer_load_dwordx2 v[248:249], v3, s[52:55], s58 offen offset:512
    buffer_load_dword v250, v4, s[52:55], s58 offen
    s_mov_b32 s48, s10
    s_and_b32 s49, s11, 0xffff
    s_mov_b32 s50, 0x480000
    s_mov_b32 s51, 0x00020000
    v_bfe_u32 v12, v0, 4, 1
    s_and_b32 s56, s3, 3
    s_lshl_b32 s56, s56, 1
    v_or_b32 v12, s56, v12
    v_and_b32 v19, 7, v0
    v_xor_b32 v12, v12, v19
    v_lshrrev_b32 v19, 3, v0
    v_mul_u32_u24 v19, 8192, v19
    v_lshl_add_u32 v19, v12, 4, v19
    s_lshl3_add_u32 s101, s64, s101
    s_lshl_b32 s99, s3, 16
    s_lshl_b32 s59, s101, 7
    s_add_u32 s99, s99, s59
    s_lshl_b32 s100, s3, 10
    s_add_u32 m0, s100, 0
    s_add_u32 s56, s99, 0
    buffer_load_dwordx4 v19, s[48:51], s56 offen nt lds
    s_add_u32 s63, s69, 32768
    buffer_load_dwordx4 v[96:99], v1, s[40:43], s63 offen nt
    v_bfe_u32 v16, v0, 1, 3
    v_mul_u32_u24 v16, 1312, v16
    v_lshrrev_b32 v12, 4, v0
    v_lshl_add_u32 v16, v12, 5, v16
    v_and_b32 v12, 1, v0
    v_lshl_add_u32 v16, v12, 4, v16
    v_add_u32 v16, 147456, v16
    s_mul_i32 s56, s3, 1312
    s_add_u32 s56, s56, 147456
    v_add_u32 v17, s56, v3
    v_add_u32 v18, s56, v4
    v_lshrrev_b32 v12, 4, v0
    v_bfe_u32 v13, v0, 1, 1
    v_lshl_add_u32 v12, v12, 1, v13
    v_bfe_u32 v13, v0, 2, 2
    v_lshl_add_u32 v20, v12, 3, v13
    v_lshlrev_b32 v20, 7, v20
    v_and_b32 v12, 3, v12
    v_lshrrev_b32 v13, 1, v13
    v_lshl_add_u32 v12, v12, 1, v13
    v_xor_b32 v12, s3, v12
    v_lshl_add_u32 v20, v12, 4, v20
    v_and_b32 v12, 1, v0
    v_lshl_add_u32 v20, v12, 3, v20
    v_bfe_u32 v23, v0, 1, 3
    v_mul_u32_u24 v23, 144, v23
    v_bfe_u32 v12, v0, 4, 1
    v_lshl_add_u32 v23, v12, 3, v23
    v_lshrrev_b32 v12, 5, v0
    v_lshl_add_u32 v23, v12, 2, v23
    v_and_b32 v12, 1, v0
    v_lshl_add_u32 v23, v12, 1, v23
    s_lshl_b32 s56, s3, 4
    s_add_u32 s56, s56, 157952
    v_add_u32 v23, s56, v23
    v_and_b32 v24, 15, v0
    v_lshlrev_b32 v24, 3, v24
    s_mul_i32 s56, s3, 144
    s_add_u32 s56, s56, 157952
    v_add_u32 v24, s56, v24
    v_add_u32 v21, 32768, v20
    s_lshl_b32 s100, s3, 10
    s_waitcnt lgkmcnt(0)
    s_add_u32 s34, s34, 1
    s_lshl_b32 s101, s101, 8
    s_lshl_b32 s58, s3, 14
    s_add_u32 s101, s101, s58
    s_add_u32 s101, s101, 0x40000
    s_and_b32 s58, s64, 1
    s_mul_i32 s58, s58, 18432
    s_mul_i32 s59, s3, 2304
    s_add_u32 s58, s58, s59
    s_add_u32 s58, s58, 0x3000
    s_add_u32 s59, s58, 36864
    s_waitcnt vmcnt(5)
    s_add_u32 m0, s100, 8192
    s_add_u32 s56, s99, 524288
    buffer_load_dwordx4 v19, s[48:51], s56 offen nt lds
    s_waitcnt vmcnt(5)
    s_add_u32 s63, s69, 40960
    buffer_load_dwordx4 v[100:103], v1, s[40:43], s63 offen nt
    s_waitcnt vmcnt(5)
    s_add_u32 m0, s100, 16384
    s_add_u32 s56, s99, 1048576
    buffer_load_dwordx4 v19, s[48:51], s56 offen nt lds
    s_waitcnt vmcnt(5)
    s_add_u32 s63, s69, 49152
    buffer_load_dwordx4 v[128:131], v1, s[40:43], s63 offen nt
    v_lshlrev_b32 v236, 16, v246
    v_and_b32 v237, 0xffff0000, v246
    v_lshlrev_b32 v238, 16, v247
    v_and_b32 v239, 0xffff0000, v247
    v_lshlrev_b32 v240, 16, v248
    v_and_b32 v241, 0xffff0000, v248
    v_lshlrev_b32 v242, 16, v249
    v_and_b32 v243, 0xffff0000, v249
    v_lshlrev_b32 v244, 16, v250
    v_and_b32 v245, 0xffff0000, v250
    s_mov_b32 s56, 0x3f803f80
    v_dot2_f32_bf16 v10, v246, s56, 0
    v_dot2_f32_bf16 v11, v246, v246, 0
    v_dot2_f32_bf16 v10, v247, s56, v10
    v_dot2_f32_bf16 v11, v247, v247, v11
    v_dot2_f32_bf16 v10, v248, s56, v10
    v_dot2_f32_bf16 v11, v248, v248, v11
    v_dot2_f32_bf16 v10, v249, s56, v10
    v_dot2_f32_bf16 v11, v249, v249, v11
    s_mov_b64 exec, 0xffffffff
    v_dot2_f32_bf16 v10, v250, s56, v10
    v_dot2_f32_bf16 v11, v250, v250, v11
    s_mov_b64 exec, -1
    s_nop 1
    v_permlane32_swap_b32 v10, v11
    v_add_f32 v10, v10, v11
    v_mov_b32 v12, v10
    s_nop 1
    v_permlane16_swap_b32 v12, v10
    v_add_f32 v10, v12, v10
    s_nop 1
    v_add_f32_dpp v10, v10, v10 row_ror:8 row_mask:0xf bank_mask:0xf
    s_nop 1
    v_add_f32_dpp v10, v10, v10 row_ror:4 row_mask:0xf bank_mask:0xf
    s_nop 1
    v_add_f32_dpp v10, v10, v10 quad_perm:[2,3,0,1] row_mask:0xf bank_mask:0xf
    s_nop 1
    v_add_f32_dpp v10, v10, v10 quad_perm:[1,0,3,2] row_mask:0xf bank_mask:0xf
    v_mul_f32 v10, 0x3ae38e39, v10
    s_nop 0
    v_readlane_b32 s56, v10, 0
    v_readlane_b32 s57, v10, 32
    s_nop 0
    v_mov_b32 v10, s56
    v_fma_f32 v11, -v10, v10, s57
    v_max_f32 v11, 0, v11
    v_cvt_pk_bf16_f32 v13, 0, v11
    v_cvt_pk_bf16_f32 v11, 0, -v10
    v_cvt_pk_bf16_f32 v10, 0, -v10
    v_add_f32 v13, 0x3727c5ac, v13
    v_pk_add_f32 v[236:237], v[236:237], v[10:11]
    v_pk_add_f32 v[238:239], v[238:239], v[10:11]
    v_pk_add_f32 v[240:241], v[240:241], v[10:11]
    v_cvt_pk_bf16_f32 v13, 0, v13
    v_pk_add_f32 v[242:243], v[242:243], v[10:11]
    v_pk_add_f32 v[244:245], v[244:245], v[10:11]
    v_cvt_pk_bf16_f32 v236, 0, v236
    v_sqrt_f32 v13, v13
    v_cvt_pk_bf16_f32 v237, 0, v237
    v_cvt_pk_bf16_f32 v238, 0, v238
    v_cvt_pk_bf16_f32 v239, 0, v239
    v_cvt_pk_bf16_f32 v13, 0, v13
    v_cvt_pk_bf16_f32 v240, 0, v240
    v_cvt_pk_bf16_f32 v241, 0, v241
    v_cvt_pk_bf16_f32 v242, 0, v242
    v_rcp_f32 v12, v13
    v_cvt_pk_bf16_f32 v243, 0, v243
    v_cvt_pk_bf16_f32 v244, 0, v244
    v_cvt_pk_bf16_f32 v245, 0, v245
    v_mov_b32 v13, v12
    v_pk_mul_f32 v[236:237], v[236:237], v[12:13]
    v_pk_mul_f32 v[238:239], v[238:239], v[12:13]
    v_pk_mul_f32 v[240:241], v[240:241], v[12:13]
    v_pk_mul_f32 v[242:243], v[242:243], v[12:13]
    v_pk_mul_f32 v[244:245], v[244:245], v[12:13]
    v_cvt_pk_bf16_f32 v236, 0, v236
    v_cvt_pk_bf16_f32 v237, 0, v237
    v_cvt_pk_bf16_f32 v238, 0, v238
    v_cvt_pk_bf16_f32 v239, 0, v239
    v_cvt_pk_bf16_f32 v240, 0, v240
    v_cvt_pk_bf16_f32 v241, 0, v241
    v_cvt_pk_bf16_f32 v242, 0, v242
    v_cvt_pk_bf16_f32 v243, 0, v243
    v_cvt_pk_bf16_f32 v244, 0, v244
    v_cvt_pk_bf16_f32 v245, 0, v245
    s_waitcnt vmcnt(5)
    s_add_u32 m0, s100, 24576
    s_add_u32 s56, s99, 1572864
    buffer_load_dwordx4 v19, s[48:51], s56 offen nt lds
    s_waitcnt vmcnt(5)
    s_add_u32 s63, s69, 57344
    buffer_load_dwordx4 v[132:135], v1, s[40:43], s63 offen nt
    s_waitcnt vmcnt(5)
    s_add_u32 m0, s100, 32768
    s_add_u32 s56, s99, 2097152
    buffer_load_dwordx4 v19, s[48:51], s56 offen nt lds
    s_waitcnt vmcnt(5)
    s_add_u32 s63, s69, 131072
    buffer_load_dwordx4 v[40:43], v1, s[40:43], s63 offen nt
    s_waitcnt vmcnt(5)
    s_add_u32 m0, s100, 40960
    s_add_u32 s56, s99, 2621440
    buffer_load_dwordx4 v19, s[48:51], s56 offen nt lds
    s_waitcnt vmcnt(5)
    s_add_u32 s63, s69, 139264
    buffer_load_dwordx4 v[44:47], v1, s[40:43], s63 offen nt
    s_waitcnt vmcnt(5)
    s_add_u32 m0, s100, 49152
    s_add_u32 s56, s99, 3145728
    buffer_load_dwordx4 v19, s[48:51], s56 offen nt lds
    s_waitcnt vmcnt(5)
    s_add_u32 s63, s69, 147456
    buffer_load_dwordx4 v[72:75], v1, s[40:43], s63 offen nt
    s_waitcnt vmcnt(5)
    s_add_u32 m0, s100, 57344
    s_add_u32 s56, s99, 3670016
    buffer_load_dwordx4 v19, s[48:51], s56 offen nt lds
    s_waitcnt vmcnt(5)
    s_add_u32 s63, s69, 155648
    buffer_load_dwordx4 v[76:79], v1, s[40:43], s63 offen nt
    buffer_load_dwordx4 v[196:199], v2, s[36:39], s58 offen offset:0 sc1
    buffer_load_dwordx4 v[200:203], v2, s[36:39], s58 offen offset:1024 sc1
    buffer_load_dwordx2 v[204:205], v5, s[36:39], s58 offen offset:0 sc1
    buffer_load_dwordx4 v[206:209], v2, s[36:39], s59 offen offset:0 sc1
    buffer_load_dwordx4 v[210:213], v2, s[36:39], s59 offen offset:1024 sc1
    buffer_load_dwordx2 v[214:215], v5, s[36:39], s59 offen offset:0 sc1
    s_waitcnt vmcnt(11)
    s_add_u32 m0, s100, 65536
    s_add_u32 s56, s99, 4194304
    buffer_load_dwordx4 v19, s[48:51], s56 offen nt lds
    s_waitcnt vmcnt(11)
    s_add_u32 s63, s69, 163840
    buffer_load_dwordx4 v[104:107], v1, s[40:43], s63 offen nt
    s_waitcnt vmcnt(11)
    s_add_u32 s63, s69, 172032
    buffer_load_dwordx4 v[108:111], v1, s[40:43], s63 offen nt
    s_waitcnt vmcnt(11)
    s_add_u32 s63, s69, 180224
    buffer_load_dwordx4 v[136:139], v1, s[40:43], s63 offen nt
    s_waitcnt vmcnt(4)
    s_branch .gpc_37
.gp_36:
    buffer_load_dwordx4 v[196:199], v2, s[36:39], s58 offen offset:0 sc1
    buffer_load_dwordx4 v[200:203], v2, s[36:39], s58 offen offset:1024 sc1
    buffer_load_dwordx2 v[204:205], v5, s[36:39], s58 offen offset:0 sc1
    buffer_load_dwordx4 v[206:209], v2, s[36:39], s59 offen offset:0 sc1
    buffer_load_dwordx4 v[210:213], v2, s[36:39], s59 offen offset:1024 sc1
    buffer_load_dwordx2 v[214:215], v5, s[36:39], s59 offen offset:0 sc1
    s_waitcnt vmcnt(0)
.gpc_37:
    v_min_u32 v10, v197, v199
    v_max_u32 v11, v197, v199
    v_min3_u32 v10, v10, v201, v203
    v_max3_u32 v11, v11, v201, v203
    v_min3_u32 v10, v10, v205, v207
    v_max3_u32 v11, v11, v205, v207
    v_min3_u32 v10, v10, v209, v211
    v_max3_u32 v11, v11, v209, v211
    v_min3_u32 v10, v10, v213, v215
    v_max3_u32 v11, v11, v213, v215
    v_cmp_eq_u32 vcc, s34, v10
    v_cmp_eq_u32 s[56:57], s34, v11
    s_and_b64 vcc, vcc, s[56:57]
    s_cmp_eq_u64 vcc, exec
    s_nop 2
    s_cbranch_scc1 .gpd_38
    s_sub_u32 s35, s35, 1
    s_cbranch_scc1 .Lexit
    s_branch .gp_36
.gpd_38:
    v_and_b32 v207, 0xffff0000, v206
    v_lshlrev_b32 v206, 16, v206
    v_and_b32 v209, 0xffff0000, v208
    v_lshlrev_b32 v208, 16, v208
    v_and_b32 v211, 0xffff0000, v210
    v_lshlrev_b32 v210, 16, v210
    v_and_b32 v213, 0xffff0000, v212
    v_lshlrev_b32 v212, 16, v212
    v_and_b32 v215, 0xffff0000, v214
    v_lshlrev_b32 v214, 16, v214
    v_and_b32 v197, 0xffff0000, v196
    v_lshlrev_b32 v196, 16, v196
    v_and_b32 v199, 0xffff0000, v198
    v_lshlrev_b32 v198, 16, v198
    v_and_b32 v201, 0xffff0000, v200
    v_lshlrev_b32 v200, 16, v200
    v_and_b32 v203, 0xffff0000, v202
    v_lshlrev_b32 v202, 16, v202
    v_and_b32 v205, 0xffff0000, v204
    v_lshlrev_b32 v204, 16, v204
    v_pk_mul_f32 v[236:237], v[236:237], v[206:207]
    v_pk_mul_f32 v[238:239], v[238:239], v[208:209]
    v_pk_mul_f32 v[240:241], v[240:241], v[210:211]
    v_pk_mul_f32 v[242:243], v[242:243], v[212:213]
    v_pk_mul_f32 v[244:245], v[244:245], v[214:215]
    v_cvt_pk_bf16_f32 v236, 0, v236
    v_cvt_pk_bf16_f32 v237, 0, v237
    v_cvt_pk_bf16_f32 v238, 0, v238
    v_cvt_pk_bf16_f32 v239, 0, v239
    v_cvt_pk_bf16_f32 v240, 0, v240
    v_cvt_pk_bf16_f32 v241, 0, v241
    v_cvt_pk_bf16_f32 v242, 0, v242
    v_cvt_pk_bf16_f32 v243, 0, v243
    v_cvt_pk_bf16_f32 v244, 0, v244
    v_cvt_pk_bf16_f32 v245, 0, v245
    v_pk_add_f32 v[236:237], v[236:237], v[196:197]
    v_pk_add_f32 v[238:239], v[238:239], v[198:199]
    v_pk_add_f32 v[240:241], v[240:241], v[200:201]
    v_pk_add_f32 v[242:243], v[242:243], v[202:203]
    v_pk_add_f32 v[244:245], v[244:245], v[204:205]
    v_cvt_pk_bf16_f32 v246, v236, v237
    v_cvt_pk_bf16_f32 v247, v238, v239
    v_cvt_pk_bf16_f32 v248, v240, v241
    v_cvt_pk_bf16_f32 v249, v242, v243
    v_cvt_pk_bf16_f32 v250, v244, v245
    ds_write_b64 v17, v[246:247]
    ds_write_b64 v17, v[248:249] offset:512
    ds_write_b32 v18, v250
    s_add_u32 s63, s69, 188416
    buffer_load_dwordx4 v[140:143], v1, s[40:43], s63 offen nt
    s_add_u32 s63, s69, 262144
    buffer_load_dwordx4 v[48:51], v1, s[40:43], s63 offen nt
    s_add_u32 s63, s69, 270336
    buffer_load_dwordx4 v[52:55], v1, s[40:43], s63 offen nt
    s_add_u32 s63, s69, 278528
    buffer_load_dwordx4 v[80:83], v1, s[40:43], s63 offen nt
    v_and_b32 v157, 7, v0
    v_lshlrev_b32 v157, 7, v157
    s_mov_b32 s63, 0x400
    buffer_load_dword v156, v157, s[36:39], s63 offen
    s_waitcnt vmcnt(8)
    s_waitcnt lgkmcnt(0)
    s_barrier
    ds_read_b64_tr_b16 v[160:161], v20 offset:0
    ds_read_b64_tr_b16 v[162:163], v20 offset:512
    ds_read_b64_tr_b16 v[164:165], v20 offset:8192
    ds_read_b64_tr_b16 v[166:167], v20 offset:8704
    ds_read_b64_tr_b16 v[168:169], v20 offset:16384
    ds_read_b64_tr_b16 v[170:171], v20 offset:16896
    ds_read_b64_tr_b16 v[172:173], v20 offset:24576
    ds_read_b64_tr_b16 v[174:175], v20 offset:25088
    ds_read_b64_tr_b16 v[176:177], v21 offset:0
    ds_read_b64_tr_b16 v[178:179], v21 offset:512
    ds_read_b64_tr_b16 v[180:181], v21 offset:8192
    ds_read_b64_tr_b16 v[182:183], v21 offset:8704
    ds_read_b64_tr_b16 v[184:185], v21 offset:16384
    ds_read_b64_tr_b16 v[186:187], v21 offset:16896
    ds_read_b64_tr_b16 v[188:189], v21 offset:24576
    ds_read_b64_tr_b16 v[190:191], v21 offset:25088
    ds_read_b64_tr_b16 v[192:193], v21 offset:32768
    ds_read_b64_tr_b16 v[194:195], v21 offset:33280
    s_waitcnt lgkmcnt(0)
    ds_read_b128 v[196:199], v16 offset:0
    ds_read_b128 v[200:203], v16 offset:128
    ds_read_b128 v[204:207], v16 offset:256
    ds_read_b128 v[208:211], v16 offset:384
    ds_read_b128 v[212:215], v16 offset:512
    ds_read_b128 v[216:219], v16 offset:640
    ds_read_b128 v[220:223], v16 offset:768
    ds_read_b128 v[224:227], v16 offset:896
    ds_read_b128 v[228:231], v16 offset:1024
    s_waitcnt lgkmcnt(8)
    v_mfma_f32_16x16x32_bf16 v[232:235], v[160:163], v[196:199], 0
    s_waitcnt lgkmcnt(7)
    v_mfma_f32_16x16x32_bf16 v[232:235], v[164:167], v[200:203], v[232:235]
    s_waitcnt lgkmcnt(6)
    v_mfma_f32_16x16x32_bf16 v[232:235], v[168:171], v[204:207], v[232:235]
    s_waitcnt lgkmcnt(5)
    v_mfma_f32_16x16x32_bf16 v[232:235], v[172:175], v[208:211], v[232:235]
    s_waitcnt lgkmcnt(4)
    v_mfma_f32_16x16x32_bf16 v[232:235], v[176:179], v[212:215], v[232:235]
    s_waitcnt lgkmcnt(3)
    v_mfma_f32_16x16x32_bf16 v[232:235], v[180:183], v[216:219], v[232:235]
    s_waitcnt lgkmcnt(2)
    v_mfma_f32_16x16x32_bf16 v[232:235], v[184:187], v[220:223], v[232:235]
    s_waitcnt lgkmcnt(1)
    v_mfma_f32_16x16x32_bf16 v[232:235], v[188:191], v[224:227], v[232:235]
    s_waitcnt lgkmcnt(0)
    v_mfma_f32_16x16x32_bf16 v[232:235], v[192:195], v[228:231], v[232:235]
    s_nop 7
    v_permlane32_swap_b32 v232, v234
    v_permlane32_swap_b32 v233, v235
    v_cndmask_b32 v233, v233, v234, s[96:97]
    v_cndmask_b32 v232, v232, v235, s[96:97]
    s_nop 1
    v_add_f32_dpp v236, v233, v232 quad_perm:[1,0,3,2] row_mask:0xf bank_mask:0xf
    v_cvt_pk_bf16_f32 v236, v236, v236
    ds_write_b16 v23, v236
    v_mov_b32 v243, s34
    s_waitcnt lgkmcnt(0)
    s_barrier
    ds_read2_b32 v[244:245], v24 offset1:1
    v_mov_b32 v241, s34
    s_waitcnt lgkmcnt(0)
    v_mov_b32 v240, v244
    v_mov_b32 v242, v245
    s_mov_b64 exec, 0xffff
    buffer_store_dwordx4 v[240:243], v2, s[36:39], s101 offen sc1
    s_mov_b64 exec, -1
.Lq_done:
    s_memrealtime s[8:9]
    s_waitcnt lgkmcnt(0)
    s_sub_u32 s8, s8, s30
    s_cmpk_ge_u32 s8, 850
    s_cbranch_scc1 .ap_39
    s_waitcnt vmcnt(6)
    s_cmpk_ge_u32 s8, 785
    s_cbranch_scc1 .ap_39
    s_waitcnt vmcnt(4)
    s_bitcmp1_b64 s[14:15], 19
    s_cbranch_scc0 1
    s_waitcnt vmcnt(3)
    s_cmpk_ge_u32 s8, 710
    s_cbranch_scc1 .ap_39
    s_waitcnt vmcnt(2)
.ap_39:
    s_add_u32 s63, s69, 286720
    buffer_load_dwordx4 v[84:87], v1, s[40:43], s63 offen nt
    s_memrealtime s[8:9]
    s_waitcnt lgkmcnt(0)
    s_sub_u32 s8, s8, s30
    s_cmpk_ge_u32 s8, 895
    s_cbranch_scc1 .ap_40
    s_waitcnt vmcnt(6)
    s_cmpk_ge_u32 s8, 830
    s_cbranch_scc1 .ap_40
    s_waitcnt vmcnt(4)
    s_bitcmp1_b64 s[14:15], 20
    s_cbranch_scc0 1
    s_waitcnt vmcnt(3)
    s_cmpk_ge_u32 s8, 755
    s_cbranch_scc1 .ap_40
    s_waitcnt vmcnt(2)
.ap_40:
    s_add_u32 s63, s69, 294912
    buffer_load_dwordx4 v[112:115], v1, s[40:43], s63 offen nt
    s_memrealtime s[8:9]
    s_waitcnt vmcnt(9)
    s_waitcnt lgkmcnt(0)
    s_sub_u32 s8, s8, s30
    s_cmpk_ge_u32 s8, 940
    s_cbranch_scc1 .ap_41
    s_waitcnt vmcnt(6)
    s_cmpk_ge_u32 s8, 875
    s_cbranch_scc1 .ap_41
    s_waitcnt vmcnt(4)
    s_bitcmp1_b64 s[14:15], 21
    s_cbranch_scc0 1
    s_waitcnt vmcnt(3)
    s_cmpk_ge_u32 s8, 800
    s_cbranch_scc1 .ap_41
    s_waitcnt vmcnt(1)
.ap_41:
    s_add_u32 s63, s69, 303104
    buffer_load_dwordx4 v[116:119], v1, s[40:43], s63 offen nt
    s_memrealtime s[8:9]
    s_waitcnt vmcnt(9)
    s_waitcnt lgkmcnt(0)
    s_sub_u32 s8, s8, s30
    s_cmpk_ge_u32 s8, 985
    s_cbranch_scc1 .ap_42
    s_waitcnt vmcnt(6)
    s_cmpk_ge_u32 s8, 920
    s_cbranch_scc1 .ap_42
    s_waitcnt vmcnt(4)
    s_bitcmp1_b64 s[14:15], 22
    s_cbranch_scc0 1
    s_waitcnt vmcnt(2)
    s_cmpk_ge_u32 s8, 845
    s_cbranch_scc1 .ap_42
    s_waitcnt vmcnt(1)
.ap_42:
    s_add_u32 s63, s69, 311296
    buffer_load_dwordx4 v[144:147], v1, s[40:43], s63 offen nt
    s_waitcnt vmcnt(4)
    s_sub_u32 s63, s70, 300
    v_subrev_u32 v156, s63, v156
    v_mov_b32 v157, 600
    v_cmp_lt_u32 s[8:9], v156, v157
    v_add_u32_dpp v156, v156, v156 quad_perm:[1,0,3,2] row_mask:0xf bank_mask:0xf
    s_nop 1
    v_add_u32_dpp v156, v156, v156 quad_perm:[2,3,0,1] row_mask:0xf bank_mask:0xf
    s_nop 1
    v_add_u32_dpp v156, v156, v156 row_ror:4 row_mask:0xf bank_mask:0xf
    s_nop 0
    v_readfirstlane_b32 s63, v156
    s_cmp_eq_u64 s[8:9], -1
    s_nop 3
    s_cbranch_scc0 .et_43
    s_lshr_b32 s63, s63, 3
    s_sub_u32 s63, s63, 300
    s_add_u32 s30, s30, s63
.et_43:
    s_memrealtime s[8:9]
    s_waitcnt lgkmcnt(0)
    s_sub_u32 s8, s8, s30
    s_cmpk_ge_u32 s8, 1030
    s_cbranch_scc1 .ap_44
    s_waitcnt vmcnt(4)
    s_cmpk_ge_u32 s8, 965
    s_cbranch_scc1 .ap_44
    s_waitcnt vmcnt(3)
    s_bitcmp1_b64 s[14:15], 23
    s_cbranch_scc0 1
    s_waitcnt vmcnt(2)
    s_cmpk_ge_u32 s8, 890
    s_cbranch_scc1 .ap_44
    s_waitcnt vmcnt(1)
.ap_44:
    s_add_u32 s63, s69, 319488
    buffer_load_dwordx4 v[148:151], v1, s[40:43], s63 offen nt
    s_memrealtime s[8:9]
    s_waitcnt lgkmcnt(0)
    s_sub_u32 s8, s8, s30
    s_cmpk_ge_u32 s8, 1075
    s_cbranch_scc1 .ap_45
    s_waitcnt vmcnt(5)
    s_cmpk_ge_u32 s8, 1010
    s_cbranch_scc1 .ap_45
    s_waitcnt vmcnt(3)
    s_bitcmp1_b64 s[14:15], 24
    s_cbranch_scc0 1
    s_waitcnt vmcnt(2)
    s_cmpk_ge_u32 s8, 935
    s_cbranch_scc1 .ap_45
    s_waitcnt vmcnt(1)
.ap_45:
    s_add_u32 s63, s69, 393216
    buffer_load_dwordx4 v[56:59], v1, s[40:43], s63 offen nt
    s_memrealtime s[8:9]
    s_waitcnt lgkmcnt(0)
    s_sub_u32 s8, s8, s30
    s_cmpk_ge_u32 s8, 1120
    s_cbranch_scc1 .ap_46
    s_waitcnt vmcnt(5)
    s_cmpk_ge_u32 s8, 1055
    s_cbranch_scc1 .ap_46
    s_waitcnt vmcnt(3)
    s_bitcmp1_b64 s[14:15], 25
    s_cbranch_scc0 1
    s_waitcnt vmcnt(2)
    s_cmpk_ge_u32 s8, 980
    s_cbranch_scc1 .ap_46
    s_waitcnt vmcnt(1)
.ap_46:
    s_add_u32 s63, s69, 401408
    buffer_load_dwordx4 v[60:63], v1, s[40:43], s63 offen nt
    s_mov_b32 s24, 0
    s_cmp_lt_u32 s2, 216
    s_cbranch_scc1 .Latt_bc
    s_branch .Latt_n
.Le_a:
    s_mov_b32 s14, 0x6ddb76dd
    s_mov_b32 s15, 0xdb76ddb7
    s_add_u32 s30, s70, -50
    s_mov_b32 s48, s12
    s_and_b32 s49, s13, 0xffff
    s_mov_b32 s50, 0x480000
    s_mov_b32 s51, 0x00020000
    v_bfe_u32 v12, v0, 4, 1
    s_and_b32 s56, s3, 1
    s_lshl_b32 s56, s56, 2
    v_lshl_or_b32 v12, v12, 1, s56
    v_and_b32 v13, 7, v0
    v_xor_b32 v12, v12, v13
    v_lshrrev_b32 v13, 3, v0
    v_mul_u32_u24 v13, 1152, v13
    v_lshl_add_u32 v6, v12, 4, v13
    s_lshl_b32 s101, s64, 6
    s_add_u32 s101, s101, s3
    s_mul_i32 s101, s101, 9216
    s_lshl_b32 s56, s65, 7
    s_add_u32 s101, s101, s56
    s_lshl_b32 s100, s3, 10
    s_waitcnt vmcnt(3)
    s_add_u32 m0, s100, 0
    s_add_u32 s56, s101, 0
    buffer_load_dwordx4 v6, s[48:51], s56 offen nt lds
    s_waitcnt vmcnt(3)
    s_bitcmp1_b64 s[14:15], 4
    s_cbranch_scc0 1
    s_waitcnt vmcnt(2)
    s_add_u32 s63, s69, 32768
    buffer_load_dwordx4 v[96:99], v1, s[40:43], s63 offen nt
    s_waitcnt vmcnt(3)
    s_add_u32 m0, s100, 8192
    s_add_u32 s56, s101, 73728
    buffer_load_dwordx4 v6, s[48:51], s56 offen nt lds
    s_waitcnt vmcnt(3)
    s_bitcmp1_b64 s[14:15], 5
    s_cbranch_scc0 1
    s_waitcnt vmcnt(2)
    s_add_u32 s63, s69, 40960
    buffer_load_dwordx4 v[100:103], v1, s[40:43], s63 offen nt
    s_waitcnt vmcnt(3)
    s_bitcmp1_b64 s[14:15], 6
    s_cbranch_scc0 1
    s_waitcnt vmcnt(2)
    s_add_u32 s63, s69, 49152
    buffer_load_dwordx4 v[128:131], v1, s[40:43], s63 offen nt
    s_waitcnt vmcnt(3)
    s_bitcmp1_b64 s[14:15], 7
    s_cbranch_scc0 1
    s_waitcnt vmcnt(2)
    s_add_u32 s63, s69, 57344
    buffer_load_dwordx4 v[132:135], v1, s[40:43], s63 offen nt
    s_waitcnt vmcnt(3)
    s_add_u32 m0, s100, 16384
    s_add_u32 s56, s101, 147456
    buffer_load_dwordx4 v6, s[48:51], s56 offen nt lds
    s_waitcnt vmcnt(3)
    s_bitcmp1_b64 s[14:15], 8
    s_cbranch_scc0 1
    s_waitcnt vmcnt(2)
    s_add_u32 s63, s69, 131072
    buffer_load_dwordx4 v[40:43], v1, s[40:43], s63 offen nt
    s_waitcnt vmcnt(3)
    s_bitcmp1_b64 s[14:15], 9
    s_cbranch_scc0 1
    s_waitcnt vmcnt(2)
    s_add_u32 s63, s69, 139264
    buffer_load_dwordx4 v[44:47], v1, s[40:43], s63 offen nt
    s_memrealtime s[8:9]
    s_waitcnt lgkmcnt(0)
    s_sub_u32 s8, s8, s30
    s_cmpk_ge_u32 s8, 436
    s_cbranch_scc1 .ap_47
    s_waitcnt vmcnt(4)
    s_cmpk_ge_u32 s8, 371
    s_cbranch_scc1 .ap_47
    s_waitcnt vmcnt(3)
    s_bitcmp1_b64 s[14:15], 10
    s_cbranch_scc0 1
    s_waitcnt vmcnt(2)
    s_cmpk_ge_u32 s8, 296
    s_cbranch_scc1 .ap_47
    s_waitcnt vmcnt(1)
.ap_47:
    s_add_u32 s63, s69, 147456
    buffer_load_dwordx4 v[72:75], v1, s[40:43], s63 offen nt
    s_waitcnt vmcnt(3)
    s_add_u32 m0, s100, 24576
    s_add_u32 s56, s101, 221184
    buffer_load_dwordx4 v6, s[48:51], s56 offen nt lds
    s_memrealtime s[8:9]
    s_waitcnt lgkmcnt(0)
    s_sub_u32 s8, s8, s30
    s_cmpk_ge_u32 s8, 482
    s_cbranch_scc1 .ap_48
    s_waitcnt vmcnt(4)
    s_cmpk_ge_u32 s8, 417
    s_cbranch_scc1 .ap_48
    s_waitcnt vmcnt(3)
    s_bitcmp1_b64 s[14:15], 11
    s_cbranch_scc0 1
    s_waitcnt vmcnt(2)
    s_cmpk_ge_u32 s8, 342
    s_cbranch_scc1 .ap_48
    s_waitcnt vmcnt(1)
.ap_48:
    s_add_u32 s63, s69, 155648
    buffer_load_dwordx4 v[76:79], v1, s[40:43], s63 offen nt
    s_waitcnt lgkmcnt(0)
    s_add_u32 s34, s34, 1
    s_memrealtime s[8:9]
    s_waitcnt lgkmcnt(0)
    s_sub_u32 s8, s8, s30
    s_cmpk_ge_u32 s8, 528
    s_cbranch_scc1 .ap_49
    s_waitcnt vmcnt(5)
    s_cmpk_ge_u32 s8, 463
    s_cbranch_scc1 .ap_49
    s_waitcnt vmcnt(3)
    s_bitcmp1_b64 s[14:15], 12
    s_cbranch_scc0 1
    s_waitcnt vmcnt(2)
    s_cmpk_ge_u32 s8, 388
    s_cbranch_scc1 .ap_49
    s_waitcnt vmcnt(1)
.ap_49:
    s_add_u32 s63, s69, 163840
    buffer_load_dwordx4 v[104:107], v1, s[40:43], s63 offen nt
    s_memrealtime s[8:9]
    s_waitcnt lgkmcnt(0)
    s_sub_u32 s8, s8, s30
    s_cmpk_ge_u32 s8, 574
    s_cbranch_scc1 .ap_50
    s_waitcnt vmcnt(5)
    s_cmpk_ge_u32 s8, 509
    s_cbranch_scc1 .ap_50
    s_waitcnt vmcnt(3)
    s_bitcmp1_b64 s[14:15], 13
    s_cbranch_scc0 1
    s_waitcnt vmcnt(2)
    s_cmpk_ge_u32 s8, 434
    s_cbranch_scc1 .ap_50
    s_waitcnt vmcnt(1)
.ap_50:
    s_add_u32 s63, s69, 172032
    buffer_load_dwordx4 v[108:111], v1, s[40:43], s63 offen nt
    s_waitcnt vmcnt(3)
    s_add_u32 m0, s100, 32768
    s_add_u32 s56, s101, 294912
    buffer_load_dwordx4 v6, s[48:51], s56 offen nt lds
    s_memrealtime s[8:9]
    s_waitcnt lgkmcnt(0)
    s_sub_u32 s8, s8, s30
    s_cmpk_ge_u32 s8, 620
    s_cbranch_scc1 .ap_51
    s_waitcnt vmcnt(4)
    s_cmpk_ge_u32 s8, 555
    s_cbranch_scc1 .ap_51
    s_waitcnt vmcnt(3)
    s_bitcmp1_b64 s[14:15], 14
    s_cbranch_scc0 1
    s_waitcnt vmcnt(2)
    s_cmpk_ge_u32 s8, 480
    s_cbranch_scc1 .ap_51
    s_waitcnt vmcnt(1)
.ap_51:
    s_add_u32 s63, s69, 180224
    buffer_load_dwordx4 v[136:139], v1, s[40:43], s63 offen nt
    s_memrealtime s[8:9]
    s_waitcnt lgkmcnt(0)
    s_sub_u32 s8, s8, s30
    s_cmpk_ge_u32 s8, 666
    s_cbranch_scc1 .ap_52
    s_waitcnt vmcnt(5)
    s_cmpk_ge_u32 s8, 601
    s_cbranch_scc1 .ap_52
    s_waitcnt vmcnt(3)
    s_bitcmp1_b64 s[14:15], 15
    s_cbranch_scc0 1
    s_waitcnt vmcnt(2)
    s_cmpk_ge_u32 s8, 526
    s_cbranch_scc1 .ap_52
    s_waitcnt vmcnt(1)
.ap_52:
    s_add_u32 s63, s69, 188416
    buffer_load_dwordx4 v[140:143], v1, s[40:43], s63 offen nt
    s_memrealtime s[8:9]
    s_waitcnt lgkmcnt(0)
    s_sub_u32 s8, s8, s30
    s_cmpk_ge_u32 s8, 712
    s_cbranch_scc1 .ap_53
    s_waitcnt vmcnt(5)
    s_cmpk_ge_u32 s8, 647
    s_cbranch_scc1 .ap_53
    s_waitcnt vmcnt(3)
    s_bitcmp1_b64 s[14:15], 16
    s_cbranch_scc0 1
    s_waitcnt vmcnt(2)
    s_cmpk_ge_u32 s8, 572
    s_cbranch_scc1 .ap_53
    s_waitcnt vmcnt(1)
.ap_53:
    s_add_u32 s63, s69, 262144
    buffer_load_dwordx4 v[48:51], v1, s[40:43], s63 offen nt
    s_waitcnt vmcnt(3)
    s_add_u32 m0, s100, 40960
    s_add_u32 s56, s101, 368640
    buffer_load_dwordx4 v6, s[48:51], s56 offen nt lds
    s_memrealtime s[8:9]
    s_waitcnt lgkmcnt(0)
    s_sub_u32 s8, s8, s30
    s_cmpk_ge_u32 s8, 758
    s_cbranch_scc1 .ap_54
    s_waitcnt vmcnt(4)
    s_cmpk_ge_u32 s8, 693
    s_cbranch_scc1 .ap_54
    s_waitcnt vmcnt(3)
    s_bitcmp1_b64 s[14:15], 17
    s_cbranch_scc0 1
    s_waitcnt vmcnt(2)
    s_cmpk_ge_u32 s8, 618
    s_cbranch_scc1 .ap_54
    s_waitcnt vmcnt(1)
.ap_54:
    s_add_u32 s63, s69, 270336
    buffer_load_dwordx4 v[52:55], v1, s[40:43], s63 offen nt
    s_memrealtime s[8:9]
    s_waitcnt lgkmcnt(0)
    s_sub_u32 s8, s8, s30
    s_cmpk_ge_u32 s8, 804
    s_cbranch_scc1 .ap_55
    s_waitcnt vmcnt(5)
    s_cmpk_ge_u32 s8, 739
    s_cbranch_scc1 .ap_55
    s_waitcnt vmcnt(3)
    s_bitcmp1_b64 s[14:15], 18
    s_cbranch_scc0 1
    s_waitcnt vmcnt(2)
    s_cmpk_ge_u32 s8, 664
    s_cbranch_scc1 .ap_55
    s_waitcnt vmcnt(1)
.ap_55:
    s_add_u32 s63, s69, 278528
    buffer_load_dwordx4 v[80:83], v1, s[40:43], s63 offen nt
    v_and_b32 v157, 7, v0
    v_lshlrev_b32 v157, 7, v157
    s_mov_b32 s63, 0x400
    buffer_load_dword v156, v157, s[36:39], s63 offen
    s_memrealtime s[8:9]
    s_waitcnt lgkmcnt(0)
    s_sub_u32 s8, s8, s30
    s_cmpk_ge_u32 s8, 850
    s_cbranch_scc1 .ap_56
    s_waitcnt vmcnt(6)
    s_cmpk_ge_u32 s8, 785
    s_cbranch_scc1 .ap_56
    s_waitcnt vmcnt(4)
    s_bitcmp1_b64 s[14:15], 19
    s_cbranch_scc0 1
    s_waitcnt vmcnt(3)
    s_cmpk_ge_u32 s8, 710
    s_cbranch_scc1 .ap_56
    s_waitcnt vmcnt(2)
.ap_56:
    s_add_u32 s63, s69, 286720
    buffer_load_dwordx4 v[84:87], v1, s[40:43], s63 offen nt
    s_waitcnt vmcnt(4)
    s_add_u32 m0, s100, 49152
    s_add_u32 s56, s101, 442368
    buffer_load_dwordx4 v6, s[48:51], s56 offen nt lds
    s_memrealtime s[8:9]
    s_waitcnt lgkmcnt(0)
    s_sub_u32 s8, s8, s30
    s_cmpk_ge_u32 s8, 895
    s_cbranch_scc1 .ap_57
    s_waitcnt vmcnt(5)
    s_cmpk_ge_u32 s8, 830
    s_cbranch_scc1 .ap_57
    s_waitcnt vmcnt(4)
    s_bitcmp1_b64 s[14:15], 20
    s_cbranch_scc0 1
    s_waitcnt vmcnt(3)
    s_cmpk_ge_u32 s8, 755
    s_cbranch_scc1 .ap_57
    s_waitcnt vmcnt(1)
.ap_57:
    s_add_u32 s63, s69, 294912
    buffer_load_dwordx4 v[112:115], v1, s[40:43], s63 offen nt
    s_memrealtime s[8:9]
    s_waitcnt lgkmcnt(0)
    s_sub_u32 s8, s8, s30
    s_cmpk_ge_u32 s8, 940
    s_cbranch_scc1 .ap_58
    s_waitcnt vmcnt(6)
    s_cmpk_ge_u32 s8, 875
    s_cbranch_scc1 .ap_58
    s_waitcnt vmcnt(4)
    s_bitcmp1_b64 s[14:15], 21
    s_cbranch_scc0 1
    s_waitcnt vmcnt(2)
    s_cmpk_ge_u32 s8, 800
    s_cbranch_scc1 .ap_58
    s_waitcnt vmcnt(1)
.ap_58:
    s_add_u32 s63, s69, 303104
    buffer_load_dwordx4 v[116:119], v1, s[40:43], s63 offen nt
    s_memrealtime s[8:9]
    s_waitcnt lgkmcnt(0)
    s_sub_u32 s8, s8, s30
    s_cmpk_ge_u32 s8, 985
    s_cbranch_scc1 .ap_59
    s_waitcnt vmcnt(6)
    s_cmpk_ge_u32 s8, 920
    s_cbranch_scc1 .ap_59
    s_waitcnt vmcnt(3)
    s_bitcmp1_b64 s[14:15], 22
    s_cbranch_scc0 1
    s_waitcnt vmcnt(2)
    s_cmpk_ge_u32 s8, 845
    s_cbranch_scc1 .ap_59
    s_waitcnt vmcnt(1)
.ap_59:
    s_add_u32 s63, s69, 311296
    buffer_load_dwordx4 v[144:147], v1, s[40:43], s63 offen nt
    s_waitcnt vmcnt(5)
    s_sub_u32 s63, s70, 300
    v_subrev_u32 v156, s63, v156
    v_mov_b32 v157, 600
    v_cmp_lt_u32 s[8:9], v156, v157
    v_add_u32_dpp v156, v156, v156 quad_perm:[1,0,3,2] row_mask:0xf bank_mask:0xf
    s_nop 1
    v_add_u32_dpp v156, v156, v156 quad_perm:[2,3,0,1] row_mask:0xf bank_mask:0xf
    s_nop 1
    v_add_u32_dpp v156, v156, v156 row_ror:4 row_mask:0xf bank_mask:0xf
    s_nop 0
    v_readfirstlane_b32 s63, v156
    s_cmp_eq_u64 s[8:9], -1
    s_nop 3
    s_cbranch_scc0 .et_60
    s_lshr_b32 s63, s63, 3
    s_sub_u32 s63, s63, 300
    s_add_u32 s30, s30, s63
.et_60:
    s_waitcnt vmcnt(3)
    s_add_u32 m0, s100, 57344
    s_add_u32 s56, s101, 516096
    buffer_load_dwordx4 v6, s[48:51], s56 offen nt lds
    s_memrealtime s[8:9]
    s_waitcnt lgkmcnt(0)
    s_sub_u32 s8, s8, s30
    s_cmpk_ge_u32 s8, 1030
    s_cbranch_scc1 .ap_61
    s_waitcnt vmcnt(4)
    s_cmpk_ge_u32 s8, 965
    s_cbranch_scc1 .ap_61
    s_waitcnt vmcnt(3)
    s_bitcmp1_b64 s[14:15], 23
    s_cbranch_scc0 1
    s_waitcnt vmcnt(2)
    s_cmpk_ge_u32 s8, 890
    s_cbranch_scc1 .ap_61
    s_waitcnt vmcnt(1)
.ap_61:
    s_add_u32 s63, s69, 319488
    buffer_load_dwordx4 v[148:151], v1, s[40:43], s63 offen nt
    s_memrealtime s[8:9]
    s_waitcnt lgkmcnt(0)
    s_sub_u32 s8, s8, s30
    s_cmpk_ge_u32 s8, 1075
    s_cbranch_scc1 .ap_62
    s_waitcnt vmcnt(5)
    s_cmpk_ge_u32 s8, 1010
    s_cbranch_scc1 .ap_62
    s_waitcnt vmcnt(3)
    s_bitcmp1_b64 s[14:15], 24
    s_cbranch_scc0 1
    s_waitcnt vmcnt(2)
    s_cmpk_ge_u32 s8, 935
    s_cbranch_scc1 .ap_62
    s_waitcnt vmcnt(1)
.ap_62:
    s_add_u32 s63, s69, 393216
    buffer_load_dwordx4 v[56:59], v1, s[40:43], s63 offen nt
    s_memrealtime s[8:9]
    s_waitcnt lgkmcnt(0)
    s_sub_u32 s8, s8, s30
    s_cmpk_ge_u32 s8, 1120
    s_cbranch_scc1 .ap_63
    s_waitcnt vmcnt(5)
    s_cmpk_ge_u32 s8, 1055
    s_cbranch_scc1 .ap_63
    s_waitcnt vmcnt(3)
    s_bitcmp1_b64 s[14:15], 25
    s_cbranch_scc0 1
    s_waitcnt vmcnt(2)
    s_cmpk_ge_u32 s8, 980
    s_cbranch_scc1 .ap_63
    s_waitcnt vmcnt(1)
.ap_63:
    s_add_u32 s63, s69, 401408
    buffer_load_dwordx4 v[60:63], v1, s[40:43], s63 offen nt
.Latt_ar:
    v_and_b32 v8, 1, v0
    v_lshlrev_b32 v8, 8, v8
    v_and_b32 v9, 0x3c, v0
    v_lshl_add_u32 v9, v9, 2, v8
    v_lshlrev_b32 v7, 1, v9
    v_and_b32 v9, 0x3c, v0
    v_lshrrev_b32 v8, 4, v8
    v_and_b32 v9, 2, v0
    v_lshl_add_u32 v9, v9, 6, v8
    s_lshl_b32 s58, s66, 14
    s_lshl_b32 s59, s67, 10
    s_add_u32 s58, s58, s59
    s_add_u32 s58, s58, 0x40000
    s_lshl4_add_u32 s59, s66, s67
    s_lshl_b32 s59, s59, 8
    s_add_u32 s59, s59, 0x200000
    s_memrealtime s[8:9]
    s_waitcnt vmcnt(8)
    s_waitcnt lgkmcnt(0)
    s_sub_u32 s8, s8, s30
    s_cmpk_ge_u32 s8, 1147
    s_cbranch_scc1 .ap_64
    s_waitcnt vmcnt(5)
    s_cmpk_ge_u32 s8, 1082
    s_cbranch_scc1 .ap_64
    s_waitcnt vmcnt(3)
    s_bitcmp1_b64 s[14:15], 26
    s_cbranch_scc0 1
    s_waitcnt vmcnt(2)
    s_cmpk_ge_u32 s8, 1007
    s_cbranch_scc1 .ap_64
    s_waitcnt vmcnt(1)
.ap_64:
    s_add_u32 s63, s69, 409600
    buffer_load_dwordx4 v[88:91], v1, s[40:43], s63 offen nt
    s_memrealtime s[8:9]
    s_waitcnt vmcnt(8)
    s_waitcnt lgkmcnt(0)
    s_sub_u32 s8, s8, s30
    s_cmpk_ge_u32 s8, 1174
    s_cbranch_scc1 .ap_65
    s_waitcnt vmcnt(5)
    s_cmpk_ge_u32 s8, 1109
    s_cbranch_scc1 .ap_65
    s_waitcnt vmcnt(3)
    s_bitcmp1_b64 s[14:15], 27
    s_cbranch_scc0 1
    s_waitcnt vmcnt(2)
    s_cmpk_ge_u32 s8, 1034
    s_cbranch_scc1 .ap_65
    s_waitcnt vmcnt(1)
.ap_65:
    s_add_u32 s63, s69, 417792
    buffer_load_dwordx4 v[92:95], v1, s[40:43], s63 offen nt
    s_memrealtime s[8:9]
    s_waitcnt vmcnt(8)
    s_waitcnt lgkmcnt(0)
    s_sub_u32 s8, s8, s30
    s_cmpk_ge_u32 s8, 1201
    s_cbranch_scc1 .ap_66
    s_waitcnt vmcnt(5)
    s_cmpk_ge_u32 s8, 1136
    s_cbranch_scc1 .ap_66
    s_waitcnt vmcnt(3)
    s_bitcmp1_b64 s[14:15], 28
    s_cbranch_scc0 1
    s_waitcnt vmcnt(2)
    s_cmpk_ge_u32 s8, 1061
    s_cbranch_scc1 .ap_66
    s_waitcnt vmcnt(1)
.ap_66:
    s_add_u32 s63, s69, 425984
    buffer_load_dwordx4 v[120:123], v1, s[40:43], s63 offen nt
    s_memrealtime s[8:9]
    s_waitcnt vmcnt(8)
    s_waitcnt lgkmcnt(0)
    s_sub_u32 s8, s8, s30
    s_cmpk_ge_u32 s8, 1228
    s_cbranch_scc1 .ap_67
    s_waitcnt vmcnt(5)
    s_cmpk_ge_u32 s8, 1163
    s_cbranch_scc1 .ap_67
    s_waitcnt vmcnt(3)
    s_bitcmp1_b64 s[14:15], 29
    s_cbranch_scc0 1
    s_waitcnt vmcnt(2)
    s_cmpk_ge_u32 s8, 1088
    s_cbranch_scc1 .ap_67
    s_waitcnt vmcnt(1)
.ap_67:
    s_add_u32 s63, s69, 434176
    buffer_load_dwordx4 v[124:127], v1, s[40:43], s63 offen nt
    s_memrealtime s[8:9]
    s_waitcnt vmcnt(8)
    s_waitcnt lgkmcnt(0)
    s_sub_u32 s8, s8, s30
    s_cmpk_ge_u32 s8, 1255
    s_cbranch_scc1 .ap_68
    s_waitcnt vmcnt(5)
    s_cmpk_ge_u32 s8, 1190
    s_cbranch_scc1 .ap_68
    s_waitcnt vmcnt(3)
    s_bitcmp1_b64 s[14:15], 30
    s_cbranch_scc0 1
    s_waitcnt vmcnt(2)
    s_cmpk_ge_u32 s8, 1115
    s_cbranch_scc1 .ap_68
    s_waitcnt vmcnt(1)
.ap_68:
    s_add_u32 s63, s69, 442368
    buffer_load_dwordx4 v[152:155], v1, s[40:43], s63 offen nt
    s_memrealtime s[8:9]
    s_waitcnt vmcnt(8)
    s_waitcnt lgkmcnt(0)
    s_sub_u32 s8, s8, s30
    s_cmpk_ge_u32 s8, 1282
    s_cbranch_scc1 .ap_69
    s_waitcnt vmcnt(5)
    s_cmpk_ge_u32 s8, 1217
    s_cbranch_scc1 .ap_69
    s_waitcnt vmcnt(3)
    s_bitcmp1_b64 s[14:15], 31
    s_cbranch_scc0 1
    s_waitcnt vmcnt(2)
    s_cmpk_ge_u32 s8, 1142
    s_cbranch_scc1 .ap_69
    s_waitcnt vmcnt(1)
.ap_69:
    s_add_u32 s63, s69, 450560
    buffer_load_dwordx4 v[156:159], v1, s[40:43], s63 offen nt
    buffer_load_dwordx4 v[16:19], v7, s[36:39], s58 offen offset:0 sc1
    buffer_load_dwordx4 v[20:23], v7, s[36:39], s58 offen offset:16 sc1
    s_memrealtime s[8:9]
    s_waitcnt vmcnt(8)
    s_waitcnt lgkmcnt(0)
    s_sub_u32 s8, s8, s30
    s_cmpk_ge_u32 s8, 1309
    s_cbranch_scc1 .ap_70
    s_waitcnt vmcnt(5)
    s_cmpk_ge_u32 s8, 1244
    s_cbranch_scc1 .ap_70
    s_waitcnt vmcnt(3)
    s_bitcmp1_b64 s[14:15], 32
    s_cbranch_scc0 1
    s_waitcnt vmcnt(2)
    s_cmpk_ge_u32 s8, 1169
    s_cbranch_scc1 .ap_70
    s_waitcnt vmcnt(1)
.ap_70:
    s_add_u32 s63, s69, 0
    buffer_load_dwordx4 v[160:163], v2, s[44:47], s63 offen nt
    s_memrealtime s[8:9]
    s_waitcnt vmcnt(8)
    s_waitcnt lgkmcnt(0)
    s_sub_u32 s8, s8, s30
    s_cmpk_ge_u32 s8, 1336
    s_cbranch_scc1 .ap_71
    s_waitcnt vmcnt(5)
    s_cmpk_ge_u32 s8, 1271
    s_cbranch_scc1 .ap_71
    s_waitcnt vmcnt(3)
    s_bitcmp1_b64 s[14:15], 33
    s_cbranch_scc0 1
    s_waitcnt vmcnt(2)
    s_cmpk_ge_u32 s8, 1196
    s_cbranch_scc1 .ap_71
    s_waitcnt vmcnt(1)
.ap_71:
    s_add_u32 s63, s69, 8192
    buffer_load_dwordx4 v[164:167], v2, s[44:47], s63 offen nt
    s_memrealtime s[8:9]
    s_waitcnt vmcnt(8)
    s_waitcnt lgkmcnt(0)
    s_sub_u32 s8, s8, s30
    s_cmpk_ge_u32 s8, 1363
    s_cbranch_scc1 .ap_72
    s_waitcnt vmcnt(5)
    s_cmpk_ge_u32 s8, 1298
    s_cbranch_scc1 .ap_72
    s_waitcnt vmcnt(3)
    s_bitcmp1_b64 s[14:15], 34
    s_cbranch_scc0 1
    s_waitcnt vmcnt(2)
    s_cmpk_ge_u32 s8, 1223
    s_cbranch_scc1 .ap_72
    s_waitcnt vmcnt(1)
.ap_72:
    s_add_u32 s63, s69, 16384
    buffer_load_dwordx4 v[168:171], v2, s[44:47], s63 offen nt
    s_waitcnt vmcnt(3)
    s_branch .gpc_74
.gp_73:
    buffer_load_dwordx4 v[16:19], v7, s[36:39], s58 offen offset:0 sc1
    buffer_load_dwordx4 v[20:23], v7, s[36:39], s58 offen offset:16 sc1
    s_waitcnt vmcnt(0)
.gpc_74:
    v_min_u32 v10, v17, v19
    v_max_u32 v11, v17, v19
    v_min3_u32 v10, v10, v21, v23
    v_max3_u32 v11, v11, v21, v23
    v_cmp_eq_u32 vcc, s34, v10
    v_cmp_eq_u32 s[56:57], s34, v11
    s_and_b64 vcc, vcc, s[56:57]
    s_cmp_eq_u64 vcc, exec
    s_nop 2
    s_cbranch_scc1 .gpd_75
    s_sub_u32 s35, s35, 1
    s_cbranch_scc1 .Lexit
    s_sleep 1
    s_branch .gp_73
.gpd_75:
    s_mov_b32 vcc_lo, 0xcccccccc
    s_mov_b32 vcc_hi, 0xcccccccc
    v_cndmask_b32_e64 v24, v16, 0, vcc
    v_cndmask_b32_e64 v25, v18, 0, vcc
    v_cndmask_b32_e64 v26, v20, 0, vcc
    v_cndmask_b32_e64 v27, v22, 0, vcc
    v_cndmask_b32_e32 v28, 0, v16, vcc
    v_cndmask_b32_e32 v29, 0, v18, vcc
    v_cndmask_b32_e32 v30, 0, v20, vcc
    v_cndmask_b32_e32 v31, 0, v22, vcc
    v_mfma_f32_16x16x32_bf16 v[16:19], v[32:35], v[24:27], 0
    v_mfma_f32_16x16x32_bf16 v[32:35], v[40:43], v[24:27], 0
    v_mfma_f32_16x16x32_bf16 v[16:19], v[36:39], v[28:31], v[16:19]
    v_mfma_f32_16x16x32_bf16 v[40:43], v[48:51], v[24:27], 0
    v_mfma_f32_16x16x32_bf16 v[32:35], v[44:47], v[28:31], v[32:35]
    v_mfma_f32_16x16x32_bf16 v[48:51], v[56:59], v[24:27], 0
    v_mfma_f32_16x16x32_bf16 v[40:43], v[52:55], v[28:31], v[40:43]
    v_mfma_f32_16x16x32_bf16 v[56:59], v[64:67], v[24:27], 0
    v_mfma_f32_16x16x32_bf16 v[48:51], v[60:63], v[28:31], v[48:51]
    s_nop 1
    v_add_f32_dpp v10, v17, v16 row_ror:12 row_mask:0xf bank_mask:0x1
    s_memrealtime s[8:9]
    s_waitcnt lgkmcnt(0)
    s_sub_u32 s8, s8, s30
    s_cmpk_ge_u32 s8, 1390
    s_nop 0
    s_cbranch_scc1 .ap_76
    s_waitcnt vmcnt(3)
    s_cmpk_ge_u32 s8, 1325
    s_cbranch_scc1 .ap_76
    s_waitcnt vmcnt(3)
    s_bitcmp1_b64 s[14:15], 35
    s_cbranch_scc0 1
    s_waitcnt vmcnt(2)
    s_cmpk_ge_u32 s8, 1250
    s_cbranch_scc1 .ap_76
    s_waitcnt vmcnt(1)
.ap_76:
    s_add_u32 s63, s69, 24576
    buffer_load_dwordx4 v[172:175], v2, s[44:47], s63 offen nt
    v_mfma_f32_16x16x32_bf16 v[64:67], v[72:75], v[24:27], 0
    v_mfma_f32_16x16x32_bf16 v[56:59], v[68:71], v[28:31], v[56:59]
    v_add_f32_dpp v11, v33, v32 row_ror:12 row_mask:0xf bank_mask:0x1
    v_add_f32_dpp v10, v18, v10 row_ror:8 row_mask:0xf bank_mask:0x1
    v_mfma_f32_16x16x32_bf16 v[72:75], v[80:83], v[24:27], 0
    v_mfma_f32_16x16x32_bf16 v[64:67], v[76:79], v[28:31], v[64:67]
    v_add_f32_dpp v12, v41, v40 row_ror:12 row_mask:0xf bank_mask:0x1
    v_add_f32_dpp v11, v34, v11 row_ror:8 row_mask:0xf bank_mask:0x1
    v_add_f32_dpp v10, v19, v10 row_ror:4 row_mask:0xf bank_mask:0x1
    v_mfma_f32_16x16x32_bf16 v[80:83], v[88:91], v[24:27], 0
    v_mfma_f32_16x16x32_bf16 v[72:75], v[84:87], v[28:31], v[72:75]
    v_add_f32_dpp v13, v49, v48 row_ror:12 row_mask:0xf bank_mask:0x1
    v_add_f32_dpp v12, v42, v12 row_ror:8 row_mask:0xf bank_mask:0x1
    v_add_f32_dpp v11, v35, v11 row_ror:4 row_mask:0xf bank_mask:0x1
    v_mfma_f32_16x16x32_bf16 v[88:91], v[96:99], v[24:27], 0
    v_mfma_f32_16x16x32_bf16 v[80:83], v[92:95], v[28:31], v[80:83]
    v_add_f32_dpp v10, v58, v57 row_ror:12 row_mask:0xf bank_mask:0x2
    v_add_f32_dpp v13, v50, v13 row_ror:8 row_mask:0xf bank_mask:0x1
    v_add_f32_dpp v12, v43, v12 row_ror:4 row_mask:0xf bank_mask:0x1
    s_memrealtime s[8:9]
    s_waitcnt lgkmcnt(0)
    s_sub_u32 s8, s8, s30
    s_cmpk_ge_u32 s8, 1417
    s_nop 0
    s_cbranch_scc1 .ap_77
    s_waitcnt vmcnt(4)
    s_cmpk_ge_u32 s8, 1352
    s_cbranch_scc1 .ap_77
    s_waitcnt vmcnt(3)
    s_bitcmp1_b64 s[14:15], 36
    s_cbranch_scc0 1
    s_waitcnt vmcnt(2)
    s_cmpk_ge_u32 s8, 1277
    s_cbranch_scc1 .ap_77
    s_waitcnt vmcnt(1)
.ap_77:
    s_add_u32 s63, s69, 32768
    buffer_load_dwordx4 v[176:179], v2, s[44:47], s63 offen nt
    v_mfma_f32_16x16x32_bf16 v[96:99], v[104:107], v[24:27], 0
    v_mfma_f32_16x16x32_bf16 v[88:91], v[100:103], v[28:31], v[88:91]
    v_add_f32_dpp v11, v66, v65 row_ror:12 row_mask:0xf bank_mask:0x2
    v_add_f32_dpp v10, v59, v10 row_ror:8 row_mask:0xf bank_mask:0x2
    v_add_f32_dpp v13, v51, v13 row_ror:4 row_mask:0xf bank_mask:0x1
    v_mfma_f32_16x16x32_bf16 v[104:107], v[112:115], v[24:27], 0
    v_mfma_f32_16x16x32_bf16 v[96:99], v[108:111], v[28:31], v[96:99]
    v_add_f32_dpp v12, v74, v73 row_ror:12 row_mask:0xf bank_mask:0x2
    v_add_f32_dpp v11, v67, v11 row_ror:8 row_mask:0xf bank_mask:0x2
    v_add_f32_dpp v10, v56, v10 row_ror:4 row_mask:0xf bank_mask:0x2
    v_mfma_f32_16x16x32_bf16 v[112:115], v[120:123], v[24:27], 0
    v_mfma_f32_16x16x32_bf16 v[104:107], v[116:119], v[28:31], v[104:107]
    v_add_f32_dpp v13, v82, v81 row_ror:12 row_mask:0xf bank_mask:0x2
    v_add_f32_dpp v12, v75, v12 row_ror:8 row_mask:0xf bank_mask:0x2
    v_add_f32_dpp v11, v64, v11 row_ror:4 row_mask:0xf bank_mask:0x2
    v_mfma_f32_16x16x32_bf16 v[120:123], v[128:131], v[24:27], 0
    v_mfma_f32_16x16x32_bf16 v[112:115], v[124:127], v[28:31], v[112:115]
    v_add_f32_dpp v10, v91, v90 row_ror:12 row_mask:0xf bank_mask:0x4
    v_add_f32_dpp v13, v83, v13 row_ror:8 row_mask:0xf bank_mask:0x2
    v_add_f32_dpp v12, v72, v12 row_ror:4 row_mask:0xf bank_mask:0x2
    s_memrealtime s[8:9]
    s_waitcnt lgkmcnt(0)
    s_sub_u32 s8, s8, s30
    s_cmpk_ge_u32 s8, 1444
    s_nop 0
    s_cbranch_scc1 .ap_78
    s_waitcnt vmcnt(5)
    s_cmpk_ge_u32 s8, 1379
    s_cbranch_scc1 .ap_78
    s_waitcnt vmcnt(3)
    s_bitcmp1_b64 s[14:15], 37
    s_cbranch_scc0 1
    s_waitcnt vmcnt(2)
    s_cmpk_ge_u32 s8, 1304
    s_cbranch_scc1 .ap_78
    s_waitcnt vmcnt(1)
.ap_78:
    s_add_u32 s63, s69, 40960
    buffer_load_dwordx4 v[180:183], v2, s[44:47], s63 offen nt
    v_mfma_f32_16x16x32_bf16 v[128:131], v[136:139], v[24:27], 0
    v_mfma_f32_16x16x32_bf16 v[120:123], v[132:135], v[28:31], v[120:123]
    v_add_f32_dpp v11, v99, v98 row_ror:12 row_mask:0xf bank_mask:0x4
    v_add_f32_dpp v10, v88, v10 row_ror:8 row_mask:0xf bank_mask:0x4
    v_add_f32_dpp v13, v80, v13 row_ror:4 row_mask:0xf bank_mask:0x2
    v_mfma_f32_16x16x32_bf16 v[136:139], v[144:147], v[24:27], 0
    v_mfma_f32_16x16x32_bf16 v[128:131], v[140:143], v[28:31], v[128:131]
    v_add_f32_dpp v12, v107, v106 row_ror:12 row_mask:0xf bank_mask:0x4
    v_add_f32_dpp v11, v96, v11 row_ror:8 row_mask:0xf bank_mask:0x4
    v_add_f32_dpp v10, v89, v10 row_ror:4 row_mask:0xf bank_mask:0x4
    v_mfma_f32_16x16x32_bf16 v[144:147], v[152:155], v[24:27], 0
    v_mfma_f32_16x16x32_bf16 v[136:139], v[148:151], v[28:31], v[136:139]
    v_add_f32_dpp v13, v115, v114 row_ror:12 row_mask:0xf bank_mask:0x4
    v_add_f32_dpp v12, v104, v12 row_ror:8 row_mask:0xf bank_mask:0x4
    v_add_f32_dpp v11, v97, v11 row_ror:4 row_mask:0xf bank_mask:0x4
    v_mfma_f32_16x16x32_bf16 v[144:147], v[156:159], v[28:31], v[144:147]
    v_add_f32_dpp v10, v120, v123 row_ror:12 row_mask:0xf bank_mask:0x8
    v_add_f32_dpp v13, v112, v13 row_ror:8 row_mask:0xf bank_mask:0x4
    v_add_f32_dpp v12, v105, v12 row_ror:4 row_mask:0xf bank_mask:0x4
    s_memrealtime s[8:9]
    s_waitcnt lgkmcnt(0)
    s_sub_u32 s8, s8, s30
    s_cmpk_ge_u32 s8, 1471
    s_nop 0
    s_cbranch_scc1 .ap_79
    s_waitcnt vmcnt(5)
    s_cmpk_ge_u32 s8, 1406
    s_cbranch_scc1 .ap_79
    s_waitcnt vmcnt(3)
    s_bitcmp1_b64 s[14:15], 38
    s_cbranch_scc0 1
    s_waitcnt vmcnt(2)
    s_cmpk_ge_u32 s8, 1331
    s_cbranch_scc1 .ap_79
    s_waitcnt vmcnt(1)
.ap_79:
    s_add_u32 s63, s69, 49152
    buffer_load_dwordx4 v[184:187], v2, s[44:47], s63 offen nt
    v_add_f32_dpp v11, v128, v131 row_ror:12 row_mask:0xf bank_mask:0x8
    v_add_f32_dpp v10, v121, v10 row_ror:8 row_mask:0xf bank_mask:0x8
    v_add_f32_dpp v13, v113, v13 row_ror:4 row_mask:0xf bank_mask:0x4
    v_add_f32_dpp v12, v136, v139 row_ror:12 row_mask:0xf bank_mask:0x8
    v_add_f32_dpp v11, v129, v11 row_ror:8 row_mask:0xf bank_mask:0x8
    v_add_f32_dpp v10, v122, v10 row_ror:4 row_mask:0xf bank_mask:0x8
    v_add_f32_dpp v13, v144, v147 row_ror:12 row_mask:0xf bank_mask:0x8
    v_add_f32_dpp v12, v137, v12 row_ror:8 row_mask:0xf bank_mask:0x8
    v_add_f32_dpp v11, v130, v11 row_ror:4 row_mask:0xf bank_mask:0x8
    v_add_f32_dpp v13, v145, v13 row_ror:8 row_mask:0xf bank_mask:0x8
    v_add_f32_dpp v12, v138, v12 row_ror:4 row_mask:0xf bank_mask:0x8
    s_memrealtime s[8:9]
    s_waitcnt lgkmcnt(0)
    s_sub_u32 s8, s8, s30
    s_cmpk_ge_u32 s8, 1498
    s_cbranch_scc1 .ap_80
    s_waitcnt vmcnt(5)
    s_cmpk_ge_u32 s8, 1433
    s_cbranch_scc1 .ap_80
    s_waitcnt vmcnt(3)
    s_bitcmp1_b64 s[14:15], 39
    s_cbranch_scc0 1
    s_waitcnt vmcnt(2)
    s_cmpk_ge_u32 s8, 1358
    s_cbranch_scc1 .ap_80
    s_waitcnt vmcnt(1)
.ap_80:
    s_add_u32 s63, s69, 57344
    buffer_load_dwordx4 v[188:191], v2, s[44:47], s63 offen nt
    v_add_f32_dpp v13, v146, v13 row_ror:4 row_mask:0xf bank_mask:0x8
    s_mov_b32 s60, 0x3db504f3
    s_mov_b32 s61, 0x3db504f3
    v_cvt_pk_bf16_f32 v10, 0, v10
    v_cvt_pk_bf16_f32 v11, 0, v11
    v_cvt_pk_bf16_f32 v12, 0, v12
    v_cvt_pk_bf16_f32 v13, 0, v13
    v_pk_mul_f32 v[10:11], v[10:11], s[60:61]
    v_pk_mul_f32 v[12:13], v[12:13], s[60:61]
    v_cvt_pk_bf16_f32 v10, 0, v10
    v_cvt_pk_bf16_f32 v11, 0, v11
    v_cvt_pk_bf16_f32 v12, 0, v12
    v_cvt_pk_bf16_f32 v13, 0, v13
    v_max_f32 v14, v10, v11
    v_max3_f32 v14, v14, v12, v13
    s_mov_b32 s60, 0x3fb8aa3b
    v_mov_b32 v22, s34
    v_mov_b32 v23, s34
    v_max_f32_dpp v14, v14, v14 quad_perm:[2,3,0,1] row_mask:0xf bank_mask:0xf
    s_nop 1
    v_max_f32_dpp v14, v14, v14 row_ror:4 row_mask:0xf bank_mask:0xf
    s_nop 1
    v_max_f32_dpp v14, v14, v14 row_ror:8 row_mask:0xf bank_mask:0xf
    v_mov_b32 v15, v14
    s_nop 1
    v_permlane16_swap_b32 v15, v14
    v_max_f32 v14, v15, v14
    v_mov_b32 v15, v14
    s_nop 1
    v_permlane32_swap_b32 v15, v14
    v_max_f32 v14, v15, v14
    v_mul_f32 v15, 0xbfb8aa3b, v14
    v_fma_f32 v10, v10, s60, v15
    v_fma_f32 v11, v11, s60, v15
    v_fma_f32 v12, v12, s60, v15
    v_fma_f32 v13, v13, s60, v15
    v_exp_f32 v10, v10
    v_exp_f32 v11, v11
    v_exp_f32 v12, v12
    v_exp_f32 v13, v13
    v_mov_b32 v20, v14
    v_pk_add_f32 v[16:17], v[10:11], v[12:13]
    v_add_f32 v21, v16, v17
    s_lshl3_add_u32 s60, s68, s3
    s_lshl_b32 s60, s60, 5
    s_add_u32 s60, s60, s59
    v_add_f32_dpp v21, v21, v21 quad_perm:[2,3,0,1] row_mask:0xf bank_mask:0xf
    s_nop 1
    v_add_f32_dpp v21, v21, v21 row_ror:4 row_mask:0xf bank_mask:0xf
    s_nop 1
    v_add_f32_dpp v21, v21, v21 row_ror:8 row_mask:0xf bank_mask:0xf
    v_mov_b32 v15, v21
    s_nop 1
    v_permlane16_swap_b32 v15, v21
    v_add_f32 v21, v15, v21
    v_mov_b32 v15, v21
    s_nop 1
    v_permlane32_swap_b32 v15, v21
    v_add_f32 v21, v15, v21
    s_lshl_b32 s60, s3, 4
    s_add_u32 s60, s60, 159104
    v_add_u32 v16, s60, v3
    v_mov_b32 v17, 159232
    v_mov_b32 v18, 1
    s_mov_b64 exec, 3
    ds_write_b64 v16, v[20:21]
    s_mov_b64 exec, 1
    s_waitcnt lgkmcnt(0)
    ds_add_rtn_u32 v18, v17, v18
    s_mov_b64 exec, -1
    v_and_b32 v16, 0x78, v3
    v_add_u32 v16, 159104, v16
    s_waitcnt lgkmcnt(0)
    v_readfirstlane_b32 s60, v18
    s_cmp_lg_u32 s60, 7
    s_nop 3
    s_cbranch_scc1 .ml_81
    ds_read_b64 v[18:19], v16
    s_lshl_b32 s60, s68, 7
    s_add_u32 s60, s60, s59
    s_waitcnt lgkmcnt(0)
    v_mov_b32 v20, v18
    s_nop 1
    v_max_f32_dpp v20, v20, v20 quad_perm:[2,3,0,1] row_mask:0xf bank_mask:0xf
    s_nop 1
    v_max_f32_dpp v20, v20, v20 row_ror:4 row_mask:0xf bank_mask:0xf
    s_nop 1
    v_max_f32_dpp v20, v20, v20 row_ror:8 row_mask:0xf bank_mask:0xf
    v_sub_f32 v18, v18, v20
    v_mul_f32 v18, 0x3fb8aa3b, v18
    v_exp_f32 v18, v18
    s_nop 0
    v_mul_f32 v21, v18, v19
    s_nop 1
    v_add_f32_dpp v21, v21, v21 quad_perm:[2,3,0,1] row_mask:0xf bank_mask:0xf
    s_nop 1
    v_add_f32_dpp v21, v21, v21 row_ror:4 row_mask:0xf bank_mask:0xf
    s_nop 1
    v_add_f32_dpp v21, v21, v21 row_ror:8 row_mask:0xf bank_mask:0xf
    s_mov_b64 exec, 0xff
    buffer_store_dwordx4 v[20:23], v2, s[36:39], s60 offen sc1
    s_mov_b64 exec, -1
.ml_81:
    s_memrealtime s[8:9]
    s_waitcnt lgkmcnt(0)
    s_sub_u32 s8, s8, s30
    s_cmpk_ge_u32 s8, 1525
    s_cbranch_scc1 .ap_82
    s_waitcnt vmcnt(5)
    s_cmpk_ge_u32 s8, 1460
    s_cbranch_scc1 .ap_82
    s_waitcnt vmcnt(3)
    s_bitcmp1_b64 s[14:15], 40
    s_cbranch_scc0 1
    s_waitcnt vmcnt(2)
    s_cmpk_ge_u32 s8, 1385
    s_cbranch_scc1 .ap_82
    s_waitcnt vmcnt(1)
.ap_82:
    s_add_u32 s63, s69, 131072
    buffer_load_dwordx4 v[192:195], v2, s[44:47], s63 offen nt
    s_memrealtime s[8:9]
    s_waitcnt vmcnt(8)
    s_waitcnt lgkmcnt(0)
    s_sub_u32 s8, s8, s30
    s_cmpk_ge_u32 s8, 1552
    s_cbranch_scc1 .ap_83
    s_waitcnt vmcnt(5)
    s_cmpk_ge_u32 s8, 1487
    s_cbranch_scc1 .ap_83
    s_waitcnt vmcnt(3)
    s_bitcmp1_b64 s[14:15], 41
    s_cbranch_scc0 1
    s_waitcnt vmcnt(2)
    s_cmpk_ge_u32 s8, 1412
    s_cbranch_scc1 .ap_83
    s_waitcnt vmcnt(1)
.ap_83:
    s_add_u32 s63, s69, 139264
    buffer_load_dwordx4 v[196:199], v2, s[44:47], s63 offen nt
    s_memrealtime s[8:9]
    s_waitcnt vmcnt(8)
    s_waitcnt lgkmcnt(0)
    s_sub_u32 s8, s8, s30
    s_cmpk_ge_u32 s8, 1579
    s_cbranch_scc1 .ap_84
    s_waitcnt vmcnt(5)
    s_cmpk_ge_u32 s8, 1514
    s_cbranch_scc1 .ap_84
    s_waitcnt vmcnt(3)
    s_bitcmp1_b64 s[14:15], 42
    s_cbranch_scc0 1
    s_waitcnt vmcnt(2)
    s_cmpk_ge_u32 s8, 1439
    s_cbranch_scc1 .ap_84
    s_waitcnt vmcnt(1)
.ap_84:
    s_add_u32 s63, s69, 147456
    buffer_load_dwordx4 v[200:203], v2, s[44:47], s63 offen nt
    s_memrealtime s[8:9]
    s_waitcnt vmcnt(8)
    s_waitcnt lgkmcnt(0)
    s_sub_u32 s8, s8, s30
    s_cmpk_ge_u32 s8, 1606
    s_cbranch_scc1 .ap_85
    s_waitcnt vmcnt(5)
    s_cmpk_ge_u32 s8, 1541
    s_cbranch_scc1 .ap_85
    s_waitcnt vmcnt(3)
    s_bitcmp1_b64 s[14:15], 43
    s_cbranch_scc0 1
    s_waitcnt vmcnt(2)
    s_cmpk_ge_u32 s8, 1466
    s_cbranch_scc1 .ap_85
    s_waitcnt vmcnt(1)
.ap_85:
    s_add_u32 s63, s69, 155648
    buffer_load_dwordx4 v[204:207], v2, s[44:47], s63 offen nt
    s_memrealtime s[8:9]
    s_waitcnt vmcnt(8)
    s_waitcnt lgkmcnt(0)
    s_sub_u32 s8, s8, s30
    s_cmpk_ge_u32 s8, 1633
    s_cbranch_scc1 .ap_86
    s_waitcnt vmcnt(5)
    s_cmpk_ge_u32 s8, 1568
    s_cbranch_scc1 .ap_86
    s_waitcnt vmcnt(3)
    s_bitcmp1_b64 s[14:15], 44
    s_cbranch_scc0 1
    s_waitcnt vmcnt(2)
    s_cmpk_ge_u32 s8, 1493
    s_cbranch_scc1 .ap_86
    s_waitcnt vmcnt(1)
.ap_86:
    s_add_u32 s63, s69, 163840
    buffer_load_dwordx4 v[208:211], v2, s[44:47], s63 offen nt
    v_and_b32 v16, 15, v0
    v_lshrrev_b32 v17, 4, v0
    v_lshl_add_u32 v16, v16, 2, v17
    v_lshlrev_b32 v31, 1, v16
    s_lshl_b32 s56, s65, 7
    v_add_u32 v31, s56, v31
    v_and_b32 v6, -4, v31
    v_lshlrev_b32 v6, 1, v6
    s_mul_i32 s56, s3, 1152
    s_mov_b32 s52, s4
    s_and_b32 s53, s5, 0xffff
    s_mov_b32 s54, 0x2400
    s_mov_b32 s55, 0x00020000
    buffer_load_ushort v29, v31, s[52:55], s56 offen
    s_mul_i32 s101, s3, 2304
    s_add_u32 s101, s101, 0x15000
    s_add_u32 s99, s101, 36864
    s_add_u32 s100, s101, 73728
    s_add_u32 s33, s101, 110592
    buffer_load_dwordx2 v[72:73], v6, s[36:39], s101 offen offset:0
    s_cmp_lg_u32 s3, s64
    s_cbranch_scc1 .rin_87
    buffer_load_dwordx4 v[32:35], v2, s[36:39], s99 offen offset:0
    buffer_load_dwordx4 v[40:43], v2, s[36:39], s99 offen offset:1024
    buffer_load_dwordx2 v[48:49], v5, s[36:39], s99 offen offset:0
    buffer_load_dwordx4 v[56:59], v2, s[36:39], s100 offen offset:0
    buffer_load_dwordx4 v[64:67], v2, s[36:39], s100 offen offset:1024
    buffer_load_dwordx2 v[50:51], v5, s[36:39], s100 offen offset:0
    buffer_load_dwordx2 v[74:75], v6, s[36:39], s99 offen offset:0
    buffer_load_dwordx2 v[80:81], v6, s[36:39], s100 offen offset:0
    buffer_load_dwordx2 v[82:83], v6, s[36:39], s33 offen offset:0
    s_mov_b32 s48, s16
    s_and_b32 s49, s17, 0xffff
    s_mov_b32 s50, 0x480
    s_mov_b32 s51, 0x00020000
    buffer_load_dwordx2 v[88:89], v3, s[48:51], 0 offen
    buffer_load_dwordx2 v[90:91], v3, s[48:51], 0 offen offset:512
    buffer_load_dword v30, v4, s[48:51], 0 offen
    s_mov_b32 s48, s28
    s_and_b32 s49, s29, 0xffff
    s_mov_b32 s50, 0x2400
    s_mov_b32 s51, 0x00020000
    buffer_load_ushort v17, v31, s[48:51], s56 offen nt
.rin_87:
    s_memrealtime s[8:9]
    s_waitcnt vmcnt(10)
    s_waitcnt lgkmcnt(0)
    s_sub_u32 s8, s8, s30
    s_cmpk_ge_u32 s8, 1660
    s_cbranch_scc1 .ap_88
    s_waitcnt vmcnt(7)
    s_cmpk_ge_u32 s8, 1595
    s_cbranch_scc1 .ap_88
    s_waitcnt vmcnt(5)
    s_bitcmp1_b64 s[14:15], 45
    s_cbranch_scc0 1
    s_waitcnt vmcnt(4)
    s_cmpk_ge_u32 s8, 1520
    s_cbranch_scc1 .ap_88
    s_waitcnt vmcnt(3)
.ap_88:
    s_add_u32 s63, s69, 172032
    buffer_load_dwordx4 v[212:215], v2, s[44:47], s63 offen nt
    s_memrealtime s[8:9]
    s_waitcnt vmcnt(10)
    s_waitcnt lgkmcnt(0)
    s_sub_u32 s8, s8, s30
    s_cmpk_ge_u32 s8, 1691
    s_cbranch_scc1 .ap_89
    s_waitcnt vmcnt(7)
    s_cmpk_ge_u32 s8, 1626
    s_cbranch_scc1 .ap_89
    s_waitcnt vmcnt(5)
    s_bitcmp1_b64 s[14:15], 46
    s_cbranch_scc0 1
    s_waitcnt vmcnt(4)
    s_cmpk_ge_u32 s8, 1551
    s_cbranch_scc1 .ap_89
    s_waitcnt vmcnt(3)
.ap_89:
    s_add_u32 s63, s69, 180224
    buffer_load_dwordx4 v[216:219], v2, s[44:47], s63 offen nt
    s_memrealtime s[8:9]
    s_waitcnt vmcnt(10)
    s_waitcnt lgkmcnt(0)
    s_sub_u32 s8, s8, s30
    s_cmpk_ge_u32 s8, 1722
    s_cbranch_scc1 .ap_90
    s_waitcnt vmcnt(7)
    s_cmpk_ge_u32 s8, 1657
    s_cbranch_scc1 .ap_90
    s_waitcnt vmcnt(5)
    s_bitcmp1_b64 s[14:15], 47
    s_cbranch_scc0 1
    s_waitcnt vmcnt(4)
    s_cmpk_ge_u32 s8, 1582
    s_cbranch_scc1 .ap_90
    s_waitcnt vmcnt(1)
.ap_90:
    s_add_u32 s63, s69, 188416
    buffer_load_dwordx4 v[220:223], v2, s[44:47], s63 offen nt
    s_memrealtime s[8:9]
    s_waitcnt vmcnt(10)
    s_waitcnt lgkmcnt(0)
    s_sub_u32 s8, s8, s30
    s_cmpk_ge_u32 s8, 1753
    s_cbranch_scc1 .ap_91
    s_waitcnt vmcnt(7)
    s_cmpk_ge_u32 s8, 1688
    s_cbranch_scc1 .ap_91
    s_waitcnt vmcnt(5)
    s_bitcmp1_b64 s[14:15], 48
    s_cbranch_scc0 1
    s_waitcnt vmcnt(2)
    s_cmpk_ge_u32 s8, 1613
    s_cbranch_scc1 .ap_91
    s_waitcnt vmcnt(1)
.ap_91:
    s_add_u32 s63, s69, 262144
    buffer_load_dwordx4 v[224:227], v2, s[44:47], s63 offen nt
    s_memrealtime s[8:9]
    s_waitcnt vmcnt(10)
    s_waitcnt lgkmcnt(0)
    s_sub_u32 s8, s8, s30
    s_cmpk_ge_u32 s8, 1784
    s_cbranch_scc1 .ap_92
    s_waitcnt vmcnt(7)
    s_cmpk_ge_u32 s8, 1719
    s_cbranch_scc1 .ap_92
    s_waitcnt vmcnt(3)
    s_bitcmp1_b64 s[14:15], 49
    s_cbranch_scc0 1
    s_waitcnt vmcnt(2)
    s_cmpk_ge_u32 s8, 1644
    s_cbranch_scc1 .ap_92
    s_waitcnt vmcnt(1)
.ap_92:
    s_add_u32 s63, s69, 270336
    buffer_load_dwordx4 v[228:231], v2, s[44:47], s63 offen nt
    s_memrealtime s[8:9]
    s_waitcnt vmcnt(10)
    s_waitcnt lgkmcnt(0)
    s_sub_u32 s8, s8, s30
    s_cmpk_ge_u32 s8, 1815
    s_cbranch_scc1 .ap_93
    s_waitcnt vmcnt(7)
    s_cmpk_ge_u32 s8, 1750
    s_cbranch_scc1 .ap_93
    s_waitcnt vmcnt(3)
    s_bitcmp1_b64 s[14:15], 50
    s_cbranch_scc0 1
    s_waitcnt vmcnt(2)
    s_cmpk_ge_u32 s8, 1675
    s_cbranch_scc1 .ap_93
    s_waitcnt vmcnt(1)
.ap_93:
    s_add_u32 s63, s69, 278528
    buffer_load_dwordx4 v[232:235], v2, s[44:47], s63 offen nt
    s_memrealtime s[8:9]
    s_waitcnt vmcnt(10)
    s_waitcnt lgkmcnt(0)
    s_sub_u32 s8, s8, s30
    s_cmpk_ge_u32 s8, 1846
    s_cbranch_scc1 .ap_94
    s_waitcnt vmcnt(5)
    s_cmpk_ge_u32 s8, 1781
    s_cbranch_scc1 .ap_94
    s_waitcnt vmcnt(3)
    s_bitcmp1_b64 s[14:15], 51
    s_cbranch_scc0 1
    s_waitcnt vmcnt(2)
    s_cmpk_ge_u32 s8, 1706
    s_cbranch_scc1 .ap_94
    s_waitcnt vmcnt(1)
.ap_94:
    s_add_u32 s63, s69, 286720
    buffer_load_dwordx4 v[236:239], v2, s[44:47], s63 offen nt
    s_memrealtime s[8:9]
    s_waitcnt vmcnt(10)
    s_waitcnt lgkmcnt(0)
    s_sub_u32 s8, s8, s30
    s_cmpk_ge_u32 s8, 1877
    s_cbranch_scc1 .ap_95
    s_waitcnt vmcnt(5)
    s_cmpk_ge_u32 s8, 1812
    s_cbranch_scc1 .ap_95
    s_waitcnt vmcnt(3)
    s_bitcmp1_b64 s[14:15], 52
    s_cbranch_scc0 1
    s_waitcnt vmcnt(2)
    s_cmpk_ge_u32 s8, 1737
    s_cbranch_scc1 .ap_95
    s_waitcnt vmcnt(1)
.ap_95:
    s_add_u32 s63, s69, 294912
    buffer_load_dwordx4 v[240:243], v2, s[44:47], s63 offen nt
    s_memrealtime s[8:9]
    s_waitcnt vmcnt(10)
    s_waitcnt lgkmcnt(0)
    s_sub_u32 s8, s8, s30
    s_cmpk_ge_u32 s8, 1908
    s_cbranch_scc1 .ap_96
    s_waitcnt vmcnt(5)
    s_cmpk_ge_u32 s8, 1843
    s_cbranch_scc1 .ap_96
    s_waitcnt vmcnt(3)
    s_bitcmp1_b64 s[14:15], 53
    s_cbranch_scc0 1
    s_waitcnt vmcnt(2)
    s_cmpk_ge_u32 s8, 1768
    s_cbranch_scc1 .ap_96
    s_waitcnt vmcnt(1)
.ap_96:
    s_add_u32 s63, s69, 303104
    buffer_load_dwordx4 v[244:247], v2, s[44:47], s63 offen nt
    s_load_dwordx2 s[88:89], s[6:7], s0
    buffer_load_dwordx4 v[24:27], v9, s[36:39], s59 offen offset:0 sc1
    s_memrealtime s[8:9]
    s_waitcnt vmcnt(8)
    s_waitcnt lgkmcnt(0)
    s_sub_u32 s8, s8, s30
    s_cmpk_ge_u32 s8, 1939
    s_cbranch_scc1 .ap_97
    s_waitcnt vmcnt(5)
    s_cmpk_ge_u32 s8, 1874
    s_cbranch_scc1 .ap_97
    s_waitcnt vmcnt(3)
    s_bitcmp1_b64 s[14:15], 54
    s_cbranch_scc0 1
    s_waitcnt vmcnt(2)
    s_cmpk_ge_u32 s8, 1799
    s_cbranch_scc1 .ap_97
    s_waitcnt vmcnt(1)
.ap_97:
    s_add_u32 s63, s69, 311296
    buffer_load_dwordx4 v[248:251], v2, s[44:47], s63 offen nt
    s_memrealtime s[8:9]
    s_waitcnt vmcnt(8)
    s_waitcnt lgkmcnt(0)
    s_sub_u32 s8, s8, s30
    s_cmpk_ge_u32 s8, 1970
    s_cbranch_scc1 .ap_98
    s_waitcnt vmcnt(5)
    s_cmpk_ge_u32 s8, 1905
    s_cbranch_scc1 .ap_98
    s_waitcnt vmcnt(3)
    s_bitcmp1_b64 s[14:15], 55
    s_cbranch_scc0 1
    s_waitcnt vmcnt(2)
    s_cmpk_ge_u32 s8, 1830
    s_cbranch_scc1 .ap_98
    s_waitcnt vmcnt(1)
.ap_98:
    s_add_u32 s63, s69, 319488
    buffer_load_dwordx4 v[252:255], v2, s[44:47], s63 offen nt
    s_memrealtime s[8:9]
    s_waitcnt vmcnt(8)
    s_waitcnt lgkmcnt(0)
    s_sub_u32 s8, s8, s30
    s_cmpk_ge_u32 s8, 2001
    s_cbranch_scc1 .ap_99
    s_waitcnt vmcnt(5)
    s_cmpk_ge_u32 s8, 1936
    s_cbranch_scc1 .ap_99
    s_waitcnt vmcnt(3)
    s_bitcmp1_b64 s[14:15], 56
    s_cbranch_scc0 1
    s_waitcnt vmcnt(2)
    s_cmpk_ge_u32 s8, 1861
    s_cbranch_scc1 .ap_99
    s_waitcnt vmcnt(1)
.ap_99:
    s_add_u32 s63, s69, 393216
    buffer_load_dwordx4 v[36:39], v2, s[44:47], s63 offen nt
    s_memrealtime s[8:9]
    s_waitcnt vmcnt(8)
    s_waitcnt lgkmcnt(0)
    s_sub_u32 s8, s8, s30
    s_cmpk_ge_u32 s8, 2032
    s_cbranch_scc1 .ap_100
    s_waitcnt vmcnt(5)
    s_cmpk_ge_u32 s8, 1967
    s_cbranch_scc1 .ap_100
    s_waitcnt vmcnt(3)
    s_bitcmp1_b64 s[14:15], 57
    s_cbranch_scc0 1
    s_waitcnt vmcnt(2)
    s_cmpk_ge_u32 s8, 1892
    s_cbranch_scc1 .ap_100
    s_waitcnt vmcnt(1)
.ap_100:
    s_add_u32 s63, s69, 401408
    buffer_load_dwordx4 v[44:47], v2, s[44:47], s63 offen nt
    s_memrealtime s[8:9]
    s_waitcnt vmcnt(8)
    s_waitcnt lgkmcnt(0)
    s_sub_u32 s8, s8, s30
    s_cmpk_ge_u32 s8, 2063
    s_cbranch_scc1 .ap_101
    s_waitcnt vmcnt(5)
    s_cmpk_ge_u32 s8, 1998
    s_cbranch_scc1 .ap_101
    s_waitcnt vmcnt(3)
    s_bitcmp1_b64 s[14:15], 58
    s_cbranch_scc0 1
    s_waitcnt vmcnt(2)
    s_cmpk_ge_u32 s8, 1923
    s_cbranch_scc1 .ap_101
    s_waitcnt vmcnt(1)
.ap_101:
    s_add_u32 s63, s69, 409600
    buffer_load_dwordx4 v[52:55], v2, s[44:47], s63 offen nt
    s_waitcnt vmcnt(5)
    s_branch .gpc_103
.gp_102:
    buffer_load_dwordx4 v[24:27], v9, s[36:39], s59 offen offset:0 sc1
    s_waitcnt vmcnt(0)
.gpc_103:
    v_cmp_eq_u32 vcc, s34, v26
    v_cmp_eq_u32 s[56:57], s34, v27
    s_and_b64 vcc, vcc, s[56:57]
    s_cmp_eq_u64 vcc, exec
    s_nop 2
    s_cbranch_scc1 .gpd_104
    s_sub_u32 s35, s35, 1
    s_cbranch_scc1 .Lexit
    s_sleep 1
    s_branch .gp_102
.gpd_104:
    s_lshr_b64 s[88:89], s[88:89], s1
    s_and_b32 s88, s88, 0xff
    s_cmp_eq_u32 s88, 32
    s_cselect_b32 s0, 0xac000, 0
    v_mov_b32 v16, v24
    s_nop 1
    v_max_f32_dpp v16, v16, v16 quad_perm:[2,3,0,1] row_mask:0xf bank_mask:0xf
    v_sub_f32 v17, v24, v16
    v_sub_f32 v18, v14, v16
    v_mul_f32 v17, 0x3fb8aa3b, v17
    v_mul_f32 v18, 0x3fb8aa3b, v18
    v_exp_f32 v17, v17
    v_exp_f32 v18, v18
    v_mul_f32 v17, v17, v25
    s_nop 1
    v_add_f32_dpp v17, v17, v17 quad_perm:[2,3,0,1] row_mask:0xf bank_mask:0xf
    v_rcp_f32 v19, v17
    s_nop 0
    v_fma_f32 v15, -v17, v19, 1.0
    v_fma_f32 v19, v15, v19, v19
    v_mul_f32 v18, v18, v19
    v_mul_f32 v10, v10, v18
    v_mul_f32 v11, v11, v18
    v_mul_f32 v12, v12, v18
    v_mul_f32 v13, v13, v18
    v_mov_b32_dpp v112, v10 quad_perm:[2,3,0,1] row_mask:0xf bank_mask:0xf
    v_mov_b32_dpp v113, v11 quad_perm:[2,3,0,1] row_mask:0xf bank_mask:0xf
    v_mov_b32_dpp v114, v12 quad_perm:[2,3,0,1] row_mask:0xf bank_mask:0xf
    v_mov_b32_dpp v115, v13 quad_perm:[2,3,0,1] row_mask:0xf bank_mask:0xf
    v_cvt_pk_bf16_f32 v96, v10, v112
    v_cvt_pk_bf16_f32 v100, v11, v113
    v_cvt_pk_bf16_f32 v104, v12, v114
    v_cvt_pk_bf16_f32 v108, v13, v115
    v_mov_b32_dpp v97, v96 row_ror:12 row_mask:0xf bank_mask:0xf
    v_mov_b32_dpp v101, v100 row_ror:12 row_mask:0xf bank_mask:0xf
    v_mov_b32_dpp v105, v104 row_ror:12 row_mask:0xf bank_mask:0xf
    v_mov_b32_dpp v109, v108 row_ror:12 row_mask:0xf bank_mask:0xf
    v_mov_b32_dpp v98, v96 row_ror:8 row_mask:0xf bank_mask:0xf
    v_mov_b32_dpp v102, v100 row_ror:8 row_mask:0xf bank_mask:0xf
    v_mov_b32_dpp v106, v104 row_ror:8 row_mask:0xf bank_mask:0xf
    v_mov_b32_dpp v110, v108 row_ror:8 row_mask:0xf bank_mask:0xf
    v_mov_b32_dpp v99, v96 row_ror:4 row_mask:0xf bank_mask:0xf
    v_mov_b32_dpp v103, v100 row_ror:4 row_mask:0xf bank_mask:0xf
    v_mov_b32_dpp v107, v104 row_ror:4 row_mask:0xf bank_mask:0xf
    v_mov_b32_dpp v111, v108 row_ror:4 row_mask:0xf bank_mask:0xf
    v_mov_b32_dpp v96, v96 row_shr:3 row_mask:0xf bank_mask:0x2
    v_mov_b32_dpp v97, v97 row_shr:3 row_mask:0xf bank_mask:0x2
    v_mov_b32_dpp v98, v98 row_shr:3 row_mask:0xf bank_mask:0x2
    v_mov_b32_dpp v99, v99 row_shr:3 row_mask:0xf bank_mask:0x2
    v_mov_b32_dpp v100, v100 row_shr:3 row_mask:0xf bank_mask:0x2
    v_mov_b32_dpp v101, v101 row_shr:3 row_mask:0xf bank_mask:0x2
    v_mov_b32_dpp v102, v102 row_shr:3 row_mask:0xf bank_mask:0x2
    v_mov_b32_dpp v103, v103 row_shr:3 row_mask:0xf bank_mask:0x2
    v_mov_b32_dpp v104, v104 row_shr:3 row_mask:0xf bank_mask:0x2
    v_mov_b32_dpp v105, v105 row_shr:3 row_mask:0xf bank_mask:0x2
    v_mov_b32_dpp v106, v106 row_shr:3 row_mask:0xf bank_mask:0x2
    v_mov_b32_dpp v107, v107 row_shr:3 row_mask:0xf bank_mask:0x2
    v_mov_b32_dpp v108, v108 row_shr:3 row_mask:0xf bank_mask:0x2
    v_mov_b32_dpp v109, v109 row_shr:3 row_mask:0xf bank_mask:0x2
    v_mov_b32_dpp v110, v110 row_shr:3 row_mask:0xf bank_mask:0x2
    v_mov_b32_dpp v111, v111 row_shr:3 row_mask:0xf bank_mask:0x2
    s_memrealtime s[8:9]
    s_waitcnt lgkmcnt(0)
    s_sub_u32 s8, s8, s30
    s_cmpk_ge_u32 s8, 2094
    s_cbranch_scc1 .ap_105
    s_waitcnt vmcnt(5)
    s_cmpk_ge_u32 s8, 2029
    s_cbranch_scc1 .ap_105
    s_waitcnt vmcnt(3)
    s_bitcmp1_b64 s[14:15], 59
    s_cbranch_scc0 1
    s_waitcnt vmcnt(2)
    s_cmpk_ge_u32 s8, 1954
    s_cbranch_scc1 .ap_105
    s_waitcnt vmcnt(1)
.ap_105:
    s_add_u32 s63, s69, 417792
    buffer_load_dwordx4 v[60:63], v2, s[44:47], s63 offen nt
    s_lshl_b32 s60, s3, 10
    s_add_u32 s60, s60, 132096
    v_lshlrev_b32 v10, 5, v0
    v_add_u32 v10, s60, v10
    v_lshrrev_b32 v11, 5, v0
    v_lshlrev_b32 v11, 13, v11
    v_and_b32 v12, 31, v0
    v_lshl_add_u32 v11, v12, 4, v11
    v_add_u32 v9, 132096, v2
    v_mov_b32 v15, s34
    v_lshrrev_b32 v25, 4, v0
    v_bfe_u32 v26, v0, 2, 2
    v_lshl_add_u32 v16, v25, 3, v26
    v_lshlrev_b32 v16, 7, v16
    v_and_b32 v25, 1, v25
    v_lshrrev_b32 v26, 1, v26
    v_lshl_add_u32 v25, v25, 1, v26
    s_and_b32 s56, s3, 1
    s_lshl_b32 s56, s56, 1
    v_xor_b32 v25, s56, v25
    v_and_b32 v26, 3, v0
    v_lshl_add_u32 v16, v26, 3, v16
    s_lshr_b32 s56, s3, 1
    s_mul_i32 s56, s56, 16384
    v_add_u32 v16, s56, v16
    v_xor_b32 v26, 1, v25
    v_lshl_add_u32 v17, v26, 5, v16
    v_lshl_add_u32 v16, v25, 5, v16
    v_bfe_u32 v25, v0, 1, 3
    v_mul_u32_u24 v19, 1312, v25
    v_mul_u32_u24 v20, 272, v25
    v_and_b32 v25, 48, v0
    s_lshr_b32 s56, s3, 1
    s_mul_i32 s57, s56, 256
    s_add_u32 s57, s57, 147456
    v_add3_u32 v19, v19, v25, s57
    s_mul_i32 s56, s56, 2176
    s_and_b32 s57, s3, 1
    s_lshl_b32 s57, s57, 7
    s_add_u32 s56, s56, s57
    s_add_u32 s56, s56, 122880
    v_add3_u32 v20, v20, v25, s56
    v_and_b32 v25, 1, v0
    v_lshl_add_u32 v20, v25, 6, v20
    v_and_b32 v25, 15, v0
    s_mul_i32 s56, s3, 272
    s_add_u32 s56, s56, 122880
    v_lshl_add_u32 v21, v25, 4, s56
    s_mul_i32 s56, s3, 1312
    s_add_u32 s56, s56, 147456
    v_add_u32 v18, s56, v3
    v_add_u32 v7, 16384, v11
    s_nop 1
    s_branch .gpc_107
.gp_106:
    buffer_load_dwordx2 v[72:73], v6, s[36:39], s101 offen offset:0 sc1
    s_waitcnt vmcnt(0)
.gpc_107:
    v_cmp_eq_u32 vcc, s34, v73
    s_cmp_eq_u64 vcc, exec
    s_nop 3
    s_cbranch_scc1 .gpd_108
    s_sub_u32 s35, s35, 1
    s_cbranch_scc1 .Lexit
    s_sleep 2
    s_branch .gp_106
.gpd_108:
    v_lshlrev_b32 v23, 16, v72
    v_and_b32 v72, 0xffff0000, v72
    s_mov_b32 vcc_lo, 0xffff0000
    s_mov_b32 vcc_hi, 0xffff0000
    v_cndmask_b32 v23, v23, v72, vcc
    v_lshlrev_b32 v29, 16, v29
    s_memrealtime s[8:9]
    s_waitcnt lgkmcnt(0)
    s_sub_u32 s8, s8, s30
    s_cmpk_ge_u32 s8, 2125
    s_cbranch_scc1 .ap_109
    s_waitcnt vmcnt(5)
    s_cmpk_ge_u32 s8, 2060
    s_cbranch_scc1 .ap_109
    s_waitcnt vmcnt(3)
    s_bitcmp1_b64 s[14:15], 60
    s_cbranch_scc0 1
    s_waitcnt vmcnt(2)
    s_cmpk_ge_u32 s8, 1985
    s_cbranch_scc1 .ap_109
    s_waitcnt vmcnt(1)
.ap_109:
    s_add_u32 s63, s69, 425984
    buffer_load_dwordx4 v[68:71], v2, s[44:47], s63 offen nt
    v_perm_b32 v112, v164, v160, s94
    v_perm_b32 v113, v172, v168, s94
    v_perm_b32 v114, v180, v176, s94
    v_perm_b32 v115, v188, v184, s94
    s_nop 1
    v_mfma_f32_16x16x32_bf16 v[128:131], v[96:99], v[112:115], 0
    v_perm_b32 v116, v164, v160, s95
    v_perm_b32 v117, v172, v168, s95
    v_perm_b32 v118, v180, v176, s95
    v_perm_b32 v119, v188, v184, s95
    s_nop 1
    v_mfma_f32_16x16x32_bf16 v[132:135], v[96:99], v[116:119], 0
    v_perm_b32 v120, v165, v161, s94
    v_perm_b32 v121, v173, v169, s94
    v_perm_b32 v122, v181, v177, s94
    v_perm_b32 v123, v189, v185, s94
    s_nop 1
    v_mfma_f32_16x16x32_bf16 v[136:139], v[96:99], v[120:123], 0
    v_perm_b32 v124, v165, v161, s95
    v_perm_b32 v125, v173, v169, s95
    v_perm_b32 v126, v181, v177, s95
    v_perm_b32 v127, v189, v185, s95
    s_nop 1
    v_mfma_f32_16x16x32_bf16 v[140:143], v[96:99], v[124:127], 0
    v_perm_b32 v112, v166, v162, s94
    v_perm_b32 v113, v174, v170, s94
    v_perm_b32 v114, v182, v178, s94
    v_perm_b32 v115, v190, v186, s94
    s_nop 1
    v_mfma_f32_16x16x32_bf16 v[144:147], v[96:99], v[112:115], 0
    v_perm_b32 v116, v166, v162, s95
    v_perm_b32 v117, v174, v170, s95
    v_perm_b32 v118, v182, v178, s95
    v_perm_b32 v119, v190, v186, s95
    s_nop 1
    v_mfma_f32_16x16x32_bf16 v[148:151], v[96:99], v[116:119], 0
    v_perm_b32 v120, v167, v163, s94
    v_perm_b32 v121, v175, v171, s94
    v_perm_b32 v122, v183, v179, s94
    v_perm_b32 v123, v191, v187, s94
    s_nop 1
    v_mfma_f32_16x16x32_bf16 v[152:155], v[96:99], v[120:123], 0
    v_perm_b32 v124, v167, v163, s95
    v_perm_b32 v125, v175, v171, s95
    v_perm_b32 v126, v183, v179, s95
    v_perm_b32 v127, v191, v187, s95
    s_nop 1
    v_mfma_f32_16x16x32_bf16 v[156:159], v[96:99], v[124:127], 0
    s_memrealtime s[8:9]
    s_waitcnt lgkmcnt(0)
    s_sub_u32 s8, s8, s30
    s_cmpk_ge_u32 s8, 2156
    s_nop 3
    s_cbranch_scc1 .ap_110
    s_waitcnt vmcnt(5)
    s_cmpk_ge_u32 s8, 2091
    s_cbranch_scc1 .ap_110
    s_waitcnt vmcnt(3)
    s_bitcmp1_b64 s[14:15], 61
    s_cbranch_scc0 1
    s_waitcnt vmcnt(2)
    s_cmpk_ge_u32 s8, 2016
    s_cbranch_scc1 .ap_110
    s_waitcnt vmcnt(1)
.ap_110:
    s_add_u32 s63, s69, 434176
    buffer_load_dwordx4 v[76:79], v2, s[44:47], s63 offen nt
    v_perm_b32 v112, v196, v192, s94
    v_perm_b32 v113, v204, v200, s94
    v_perm_b32 v114, v212, v208, s94
    v_perm_b32 v115, v220, v216, s94
    s_nop 1
    v_mfma_f32_16x16x32_bf16 v[128:131], v[100:103], v[112:115], v[128:131]
    v_perm_b32 v116, v196, v192, s95
    v_perm_b32 v117, v204, v200, s95
    v_perm_b32 v118, v212, v208, s95
    v_perm_b32 v119, v220, v216, s95
    s_nop 1
    v_mfma_f32_16x16x32_bf16 v[132:135], v[100:103], v[116:119], v[132:135]
    v_perm_b32 v120, v197, v193, s94
    v_perm_b32 v121, v205, v201, s94
    v_perm_b32 v122, v213, v209, s94
    v_perm_b32 v123, v221, v217, s94
    s_nop 1
    v_mfma_f32_16x16x32_bf16 v[136:139], v[100:103], v[120:123], v[136:139]
    v_perm_b32 v124, v197, v193, s95
    v_perm_b32 v125, v205, v201, s95
    v_perm_b32 v126, v213, v209, s95
    v_perm_b32 v127, v221, v217, s95
    s_nop 1
    v_mfma_f32_16x16x32_bf16 v[140:143], v[100:103], v[124:127], v[140:143]
    v_perm_b32 v112, v198, v194, s94
    v_perm_b32 v113, v206, v202, s94
    v_perm_b32 v114, v214, v210, s94
    v_perm_b32 v115, v222, v218, s94
    s_nop 1
    v_mfma_f32_16x16x32_bf16 v[144:147], v[100:103], v[112:115], v[144:147]
    v_perm_b32 v116, v198, v194, s95
    v_perm_b32 v117, v206, v202, s95
    v_perm_b32 v118, v214, v210, s95
    v_perm_b32 v119, v222, v218, s95
    s_nop 1
    v_mfma_f32_16x16x32_bf16 v[148:151], v[100:103], v[116:119], v[148:151]
    v_perm_b32 v120, v199, v195, s94
    v_perm_b32 v121, v207, v203, s94
    v_perm_b32 v122, v215, v211, s94
    v_perm_b32 v123, v223, v219, s94
    s_nop 1
    v_mfma_f32_16x16x32_bf16 v[152:155], v[100:103], v[120:123], v[152:155]
    v_perm_b32 v124, v199, v195, s95
    v_perm_b32 v125, v207, v203, s95
    v_perm_b32 v126, v215, v211, s95
    v_perm_b32 v127, v223, v219, s95
    s_nop 1
    v_mfma_f32_16x16x32_bf16 v[156:159], v[100:103], v[124:127], v[156:159]
    s_memrealtime s[8:9]
    s_waitcnt lgkmcnt(0)
    s_sub_u32 s8, s8, s30
    s_cmpk_ge_u32 s8, 2187
    s_nop 3
    s_cbranch_scc1 .ap_111
    s_waitcnt vmcnt(5)
    s_cmpk_ge_u32 s8, 2122
    s_cbranch_scc1 .ap_111
    s_waitcnt vmcnt(3)
    s_bitcmp1_b64 s[14:15], 62
    s_cbranch_scc0 1
    s_waitcnt vmcnt(2)
    s_cmpk_ge_u32 s8, 2047
    s_cbranch_scc1 .ap_111
    s_waitcnt vmcnt(1)
.ap_111:
    s_add_u32 s63, s69, 442368
    buffer_load_dwordx4 v[84:87], v2, s[44:47], s63 offen nt
    s_waitcnt vmcnt(7)
    v_perm_b32 v112, v228, v224, s94
    v_perm_b32 v113, v236, v232, s94
    v_perm_b32 v114, v244, v240, s94
    v_perm_b32 v115, v252, v248, s94
    s_nop 1
    v_mfma_f32_16x16x32_bf16 v[128:131], v[104:107], v[112:115], v[128:131]
    v_perm_b32 v116, v228, v224, s95
    v_perm_b32 v117, v236, v232, s95
    v_perm_b32 v118, v244, v240, s95
    v_perm_b32 v119, v252, v248, s95
    s_nop 1
    v_mfma_f32_16x16x32_bf16 v[132:135], v[104:107], v[116:119], v[132:135]
    v_perm_b32 v120, v229, v225, s94
    v_perm_b32 v121, v237, v233, s94
    v_perm_b32 v122, v245, v241, s94
    v_perm_b32 v123, v253, v249, s94
    s_nop 1
    v_mfma_f32_16x16x32_bf16 v[136:139], v[104:107], v[120:123], v[136:139]
    v_perm_b32 v124, v229, v225, s95
    v_perm_b32 v125, v237, v233, s95
    v_perm_b32 v126, v245, v241, s95
    v_perm_b32 v127, v253, v249, s95
    s_nop 1
    v_mfma_f32_16x16x32_bf16 v[140:143], v[104:107], v[124:127], v[140:143]
    v_perm_b32 v112, v230, v226, s94
    v_perm_b32 v113, v238, v234, s94
    v_perm_b32 v114, v246, v242, s94
    v_perm_b32 v115, v254, v250, s94
    s_nop 1
    v_mfma_f32_16x16x32_bf16 v[144:147], v[104:107], v[112:115], v[144:147]
    v_perm_b32 v116, v230, v226, s95
    v_perm_b32 v117, v238, v234, s95
    v_perm_b32 v118, v246, v242, s95
    v_perm_b32 v119, v254, v250, s95
    s_nop 1
    v_mfma_f32_16x16x32_bf16 v[148:151], v[104:107], v[116:119], v[148:151]
    v_perm_b32 v120, v231, v227, s94
    v_perm_b32 v121, v239, v235, s94
    v_perm_b32 v122, v247, v243, s94
    v_perm_b32 v123, v255, v251, s94
    s_nop 1
    v_mfma_f32_16x16x32_bf16 v[152:155], v[104:107], v[120:123], v[152:155]
    v_perm_b32 v124, v231, v227, s95
    v_perm_b32 v125, v239, v235, s95
    v_perm_b32 v126, v247, v243, s95
    v_perm_b32 v127, v255, v251, s95
    s_nop 1
    v_mfma_f32_16x16x32_bf16 v[156:159], v[104:107], v[124:127], v[156:159]
    s_memrealtime s[8:9]
    s_waitcnt lgkmcnt(0)
    s_sub_u32 s8, s8, s30
    s_cmpk_ge_u32 s8, 2218
    s_nop 3
    s_cbranch_scc1 .ap_112
    s_waitcnt vmcnt(5)
    s_cmpk_ge_u32 s8, 2153
    s_cbranch_scc1 .ap_112
    s_waitcnt vmcnt(3)
    s_bitcmp1_b64 s[14:15], 63
    s_cbranch_scc0 1
    s_waitcnt vmcnt(2)
    s_cmpk_ge_u32 s8, 2078
    s_cbranch_scc1 .ap_112
    s_waitcnt vmcnt(1)
.ap_112:
    s_add_u32 s63, s69, 450560
    buffer_load_dwordx4 v[92:95], v2, s[44:47], s63 offen nt
    s_setprio 0
    s_waitcnt vmcnt(6)
    v_perm_b32 v160, v44, v36, s94
    v_perm_b32 v164, v44, v36, s95
    v_perm_b32 v168, v45, v37, s94
    v_perm_b32 v172, v45, v37, s95
    v_perm_b32 v176, v46, v38, s94
    v_perm_b32 v180, v46, v38, s95
    v_perm_b32 v184, v47, v39, s94
    v_perm_b32 v188, v47, v39, s95
    s_waitcnt vmcnt(4)
    v_perm_b32 v161, v60, v52, s94
    v_perm_b32 v165, v60, v52, s95
    v_perm_b32 v169, v61, v53, s94
    v_perm_b32 v173, v61, v53, s95
    v_perm_b32 v177, v62, v54, s94
    v_perm_b32 v181, v62, v54, s95
    v_perm_b32 v185, v63, v55, s94
    v_perm_b32 v189, v63, v55, s95
    v_mfma_f32_16x16x16_bf16 v[128:131], v[108:109], v[160:161], v[128:131]
    v_mfma_f32_16x16x16_bf16 v[132:135], v[108:109], v[164:165], v[132:135]
    v_mfma_f32_16x16x16_bf16 v[136:139], v[108:109], v[168:169], v[136:139]
    v_mfma_f32_16x16x16_bf16 v[140:143], v[108:109], v[172:173], v[140:143]
    v_mfma_f32_16x16x16_bf16 v[144:147], v[108:109], v[176:177], v[144:147]
    v_mfma_f32_16x16x16_bf16 v[148:151], v[108:109], v[180:181], v[148:151]
    v_mfma_f32_16x16x16_bf16 v[152:155], v[108:109], v[184:185], v[152:155]
    v_mfma_f32_16x16x16_bf16 v[156:159], v[108:109], v[188:189], v[156:159]
    s_waitcnt vmcnt(2)
    v_perm_b32 v162, v76, v68, s94
    v_perm_b32 v166, v76, v68, s95
    v_perm_b32 v170, v77, v69, s94
    v_perm_b32 v174, v77, v69, s95
    v_perm_b32 v178, v78, v70, s94
    v_perm_b32 v182, v78, v70, s95
    v_perm_b32 v186, v79, v71, s94
    v_perm_b32 v190, v79, v71, s95
    s_lshl4_add_u32 s59, s67, s66
    s_lshl1_add_u32 s59, s59, s68
    s_lshl_b32 s59, s59, 9
    s_add_u32 s59, s59, 0x210000
    s_mov_b32 s60, 0x07060503
    s_mov_b32 s61, 0x07060502
    s_mov_b32 s62, 0x07060501
.Ltail_ar:
    s_waitcnt vmcnt(0)
    v_perm_b32 v163, v92, v84, s94
    v_perm_b32 v167, v92, v84, s95
    v_perm_b32 v171, v93, v85, s94
    v_perm_b32 v175, v93, v85, s95
    v_perm_b32 v179, v94, v86, s94
    v_perm_b32 v183, v94, v86, s95
    v_perm_b32 v187, v95, v87, s94
    v_perm_b32 v191, v95, v87, s95
    v_mfma_f32_16x16x16_bf16 v[128:131], v[110:111], v[162:163], v[128:131]
    v_mfma_f32_16x16x16_bf16 v[132:135], v[110:111], v[166:167], v[132:135]
    v_mfma_f32_16x16x16_bf16 v[136:139], v[110:111], v[170:171], v[136:139]
    v_mfma_f32_16x16x16_bf16 v[140:143], v[110:111], v[174:175], v[140:143]
    v_mfma_f32_16x16x16_bf16 v[144:147], v[110:111], v[178:179], v[144:147]
    v_mfma_f32_16x16x16_bf16 v[148:151], v[110:111], v[182:183], v[148:151]
    v_mfma_f32_16x16x16_bf16 v[152:155], v[110:111], v[186:187], v[152:155]
    v_mfma_f32_16x16x16_bf16 v[156:159], v[110:111], v[190:191], v[156:159]
    s_mov_b64 exec, 0xffffffff
    s_nop 0
    ds_write2_b32 v10, v128, v132 offset0:0 offset1:1
    s_nop 0
    ds_write2_b32 v10, v136, v140 offset0:2 offset1:3
    s_nop 0
    ds_write2_b32 v10, v144, v148 offset0:4 offset1:5
    s_nop 0
    ds_write2_b32 v10, v152, v156 offset0:6 offset1:7
    s_mov_b64 exec, -1
    s_waitcnt lgkmcnt(0)
    s_barrier
    s_cmp_lg_u32 s3, 7
    s_cbranch_scc1 .opub_113
    ds_read_b128 v[196:199], v9 offset:0
    ds_read_b128 v[200:203], v9 offset:1024
    ds_read_b128 v[204:207], v9 offset:2048
    ds_read_b128 v[208:211], v9 offset:3072
    ds_read_b128 v[212:215], v9 offset:4096
    ds_read_b128 v[216:219], v9 offset:5120
    ds_read_b128 v[220:223], v9 offset:6144
    ds_read_b128 v[224:227], v9 offset:7168
    s_waitcnt lgkmcnt(6)
    v_pk_add_f32 v[196:197], v[196:197], v[200:201]
    v_pk_add_f32 v[198:199], v[198:199], v[202:203]
    s_waitcnt lgkmcnt(4)
    v_pk_add_f32 v[204:205], v[204:205], v[208:209]
    v_pk_add_f32 v[206:207], v[206:207], v[210:211]
    v_pk_add_f32 v[196:197], v[196:197], v[204:205]
    v_pk_add_f32 v[198:199], v[198:199], v[206:207]
    s_waitcnt lgkmcnt(2)
    v_pk_add_f32 v[212:213], v[212:213], v[216:217]
    v_pk_add_f32 v[214:215], v[214:215], v[218:219]
    s_waitcnt lgkmcnt(0)
    v_pk_add_f32 v[220:221], v[220:221], v[224:225]
    v_pk_add_f32 v[222:223], v[222:223], v[226:227]
    v_pk_add_f32 v[212:213], v[212:213], v[220:221]
    v_pk_add_f32 v[214:215], v[214:215], v[222:223]
    v_pk_add_f32 v[196:197], v[196:197], v[212:213]
    v_pk_add_f32 v[198:199], v[198:199], v[214:215]
    v_perm_b32 v12, v196, v199, s60
    v_perm_b32 v13, v197, v199, s61
    v_perm_b32 v14, v198, v199, s62
    s_add_u32 s57, s59, 0xac000
    buffer_store_dwordx4 v[12:15], v11, s[36:39], s57 offen
    buffer_store_dwordx4 v[12:15], v11, s[36:39], s59 offen sc1
.opub_113:
    ds_read_b64_tr_b16 v[160:161], v16 offset:0
    ds_read_b64_tr_b16 v[162:163], v16 offset:512
    ds_read_b64_tr_b16 v[176:177], v17 offset:0
    ds_read_b64_tr_b16 v[178:179], v17 offset:512
    ds_read_b64_tr_b16 v[164:165], v16 offset:4096
    ds_read_b64_tr_b16 v[166:167], v16 offset:4608
    ds_read_b64_tr_b16 v[180:181], v17 offset:4096
    ds_read_b64_tr_b16 v[182:183], v17 offset:4608
    ds_read_b64_tr_b16 v[168:169], v16 offset:8192
    ds_read_b64_tr_b16 v[170:171], v16 offset:8704
    ds_read_b64_tr_b16 v[184:185], v17 offset:8192
    ds_read_b64_tr_b16 v[186:187], v17 offset:8704
    ds_read_b64_tr_b16 v[172:173], v16 offset:12288
    ds_read_b64_tr_b16 v[174:175], v16 offset:12800
    ds_read_b64_tr_b16 v[188:189], v17 offset:12288
    ds_read_b64_tr_b16 v[190:191], v17 offset:12800
    s_lshl_b32 s59, s64, 5
    s_add_u32 s59, s59, s3
    s_lshl_b32 s59, s59, 10
    s_add_u32 s59, s59, 0x210000
    s_mov_b32 s60, 0x04000c0c
    s_mov_b32 s61, 0x0706000c
    v_mov_b32 v143, s34
    s_mul_i32 s40, s3, 9
    s_add_u32 s40, s40, s65
    s_lshl_b32 s40, s40, 11
    s_add_u32 s41, s40, 0x368000
    s_lshl_b32 s63, s64, 8
    s_add_u32 s63, s63, s41
    s_mul_i32 s101, s64, 18432
    s_mul_i32 s56, s3, 2304
    s_add_u32 s101, s101, s56
    s_add_u32 s101, s101, 0x250000
    s_lshl_b32 s42, s65, 8
    s_add_u32 s42, s42, s101
    v_mov_b32 v253, s34
    v_mov_b32 v255, s34
    s_add_u32 s58, s59, s0
    s_lshl1_add_u32 s59, s59, 0xac000
    s_cmp_eq_u32 s0, 0
    s_cselect_b32 s32, 64, 0
    s_mov_b64 s[88:89], exec
    s_mov_b64 s[90:91], exec
    s_mov_b64 s[92:93], exec
    s_mov_b64 s[56:57], exec
.mp_114:
    s_mov_b64 exec, s[88:89]
    buffer_load_dwordx4 v[192:195], v11, s[36:39], s58 offen offset:0 sc1
    s_mov_b64 exec, s[90:91]
    buffer_load_dwordx4 v[196:199], v11, s[36:39], s58 offen offset:512 sc1
    s_mov_b64 exec, s[92:93]
    buffer_load_dwordx4 v[200:203], v7, s[36:39], s58 offen offset:0 sc1
    s_mov_b64 exec, s[56:57]
    buffer_load_dwordx4 v[204:207], v7, s[36:39], s58 offen offset:512 sc1
    s_mov_b64 exec, -1
    s_sub_u32 s35, s35, 1
    s_cbranch_scc1 .Lexit
    s_sub_u32 vcc_lo, s59, s58
    s_add_u32 s32, s32, 1
    s_cmp_ge_u32 s32, 64
    s_cselect_b32 s58, vcc_lo, s58
    s_waitcnt vmcnt(0)
.mpj_115:
    v_cmp_ne_u32 s[88:89], s34, v195
    v_cmp_ne_u32 s[90:91], s34, v199
    v_cmp_ne_u32 s[92:93], s34, v203
    v_cmp_ne_u32 s[56:57], s34, v207
    s_or_b64 vcc, s[88:89], s[90:91]
    s_or_b64 vcc, vcc, s[92:93]
    s_or_b64 vcc, vcc, s[56:57]
    s_cbranch_scc1 .mp_114
    v_perm_b32 v195, v192, v193, s60
    v_perm_b32 v199, v196, v197, s60
    v_perm_b32 v203, v200, v201, s60
    v_perm_b32 v207, v204, v205, s60
    v_perm_b32 v195, v195, v194, s61
    v_perm_b32 v199, v199, v198, s61
    v_perm_b32 v203, v203, v202, s61
    v_perm_b32 v207, v207, v206, s61
    v_pk_add_f32 v[192:193], v[192:193], v[196:197]
    v_pk_add_f32 v[194:195], v[194:195], v[198:199]
    v_pk_add_f32 v[200:201], v[200:201], v[204:205]
    v_pk_add_f32 v[202:203], v[202:203], v[206:207]
    v_cvt_pk_bf16_f32 v192, v192, v193
    v_cvt_pk_bf16_f32 v193, v194, v195
    v_cvt_pk_bf16_f32 v200, v200, v201
    v_cvt_pk_bf16_f32 v201, v202, v203
    ds_write_b64 v18, v[192:193]
    ds_write_b64 v18, v[200:201] offset:512
    s_waitcnt lgkmcnt(0)
    s_barrier
    ds_read_b128 v[224:227], v19 offset:0
    ds_read_b128 v[228:231], v19 offset:64
    ds_read_b128 v[232:235], v19 offset:128
    ds_read_b128 v[236:239], v19 offset:192
    s_waitcnt lgkmcnt(3)
    v_mfma_f32_16x16x32_bf16 v[132:135], v[160:163], v[224:227], 0
    v_mfma_f32_16x16x32_bf16 v[136:139], v[176:179], v[224:227], 0
    s_waitcnt lgkmcnt(2)
    v_mfma_f32_16x16x32_bf16 v[132:135], v[164:167], v[228:231], v[132:135]
    v_mfma_f32_16x16x32_bf16 v[136:139], v[180:183], v[228:231], v[136:139]
    s_waitcnt lgkmcnt(1)
    v_mfma_f32_16x16x32_bf16 v[132:135], v[168:171], v[232:235], v[132:135]
    v_mfma_f32_16x16x32_bf16 v[136:139], v[184:187], v[232:235], v[136:139]
    s_waitcnt lgkmcnt(0)
    v_mfma_f32_16x16x32_bf16 v[132:135], v[172:175], v[236:239], v[132:135]
    v_mfma_f32_16x16x32_bf16 v[136:139], v[188:191], v[236:239], v[136:139]
    s_nop 7
    v_cndmask_b32 v132, v132, v136, s[96:97]
    v_cndmask_b32 v133, v133, v137, s[96:97]
    v_cndmask_b32 v134, v134, v138, s[96:97]
    v_cndmask_b32 v135, v135, v139, s[96:97]
    ds_write_b128 v20, v[132:135]
    s_waitcnt lgkmcnt(0)
    s_barrier
    ds_read_b128 v[224:227], v21 offset:0
    ds_read_b128 v[228:231], v21 offset:2176
    ds_read_b128 v[232:235], v21 offset:4352
    ds_read_b128 v[236:239], v21 offset:6528
    s_mov_b32 s60, 0x07060503
    s_mov_b32 s61, 0x07060502
    s_mov_b32 s62, 0x07060501
    s_waitcnt lgkmcnt(2)
    v_pk_add_f32 v[224:225], v[224:225], v[228:229]
    v_pk_add_f32 v[226:227], v[226:227], v[230:231]
    s_waitcnt lgkmcnt(0)
    v_pk_add_f32 v[232:233], v[232:233], v[236:237]
    v_pk_add_f32 v[234:235], v[234:235], v[238:239]
    v_pk_add_f32 v[224:225], v[224:225], v[232:233]
    v_pk_add_f32 v[226:227], v[226:227], v[234:235]
    v_perm_b32 v140, v224, v227, s60
    v_perm_b32 v141, v225, v227, s61
    v_perm_b32 v142, v226, v227, s62
    s_mov_b64 exec, 0xffff
    buffer_store_dwordx4 v[140:143], v2, s[36:39], s63 offen sc1
    s_mov_b64 exec, -1
    s_barrier
    s_mov_b32 s60, 0x04000c0c
    s_mov_b32 s61, 0x0706000c
    s_mov_b64 s[88:89], exec
    s_mov_b64 s[90:91], exec
.mp_118:
    s_mov_b64 exec, s[88:89]
    buffer_load_dwordx4 v[108:111], v2, s[36:39], s41 offen offset:0 sc1
    s_mov_b64 exec, s[90:91]
    buffer_load_dwordx4 v[112:115], v2, s[36:39], s41 offen offset:1024 sc1
    s_mov_b64 exec, -1
    s_sub_u32 s35, s35, 1
    s_cbranch_scc1 .Lexit
    s_waitcnt vmcnt(0)
.mpj_119:
    v_cmp_ne_u32 s[88:89], s34, v111
    v_cmp_ne_u32 s[90:91], s34, v115
    s_or_b64 vcc, s[88:89], s[90:91]
    s_cbranch_scc1 .mp_118
    v_perm_b32 v111, v108, v109, s60
    v_perm_b32 v115, v112, v113, s60
    v_perm_b32 v111, v111, v110, s61
    v_perm_b32 v115, v115, v114, s61
    v_pk_add_f32 v[248:249], v[108:109], v[112:113]
    v_pk_add_f32 v[250:251], v[110:111], v[114:115]
    s_nop 1
    v_permlane32_swap_b32 v248, v250
    v_permlane32_swap_b32 v249, v251
    v_pk_add_f32 v[248:249], v[248:249], v[250:251]
    s_nop 1
    v_permlane16_swap_b32 v248, v249
    v_add_f32 v248, v248, v249
    v_cvt_pk_bf16_f32 v248, 0, v248
    v_mul_f32 v248, v248, v23
    v_cvt_pk_bf16_f32 v248, 0, v248
    v_add_f32 v249, v248, v29
    v_add_f32 v248, v248, v29
    v_mov_b32 v24, v248
    s_nop 0
    v_permlane16_swap_b32 v248, v249
    v_cvt_pk_bf16_f32 v252, v248, v249
    v_cvt_pk_bf16_f32 v254, v248, v249
    s_nop 1
    v_permlane32_swap_b32 v252, v254
    s_mov_b64 exec, 0xffff
    s_add_u32 s57, s42, 0xac000
    buffer_store_dwordx4 v[252:255], v2, s[36:39], s57 offen
    s_cmp_lg_u32 s0, 0
    s_cbranch_scc1 2
    buffer_store_dwordx4 v[252:255], v2, s[36:39], s42 offen sc1
    s_mov_b64 exec, -1
    s_cmp_eq_u32 s3, s64
    s_cbranch_scc1 .r2_122
    s_branch .Lexit
.r2_122:
    v_cvt_pk_bf16_f32 v24, 0, v24
    s_nop 1
    s_branch .gpc_124
.gp_123:
    buffer_load_dwordx4 v[32:35], v2, s[36:39], s99 offen offset:0 sc1
    buffer_load_dwordx4 v[40:43], v2, s[36:39], s99 offen offset:1024 sc1
    buffer_load_dwordx2 v[48:49], v5, s[36:39], s99 offen offset:0 sc1
    buffer_load_dwordx4 v[56:59], v2, s[36:39], s100 offen offset:0 sc1
    buffer_load_dwordx4 v[64:67], v2, s[36:39], s100 offen offset:1024 sc1
    buffer_load_dwordx2 v[50:51], v5, s[36:39], s100 offen offset:0 sc1
    buffer_load_dwordx2 v[74:75], v6, s[36:39], s99 offen offset:0 sc1
    buffer_load_dwordx2 v[80:81], v6, s[36:39], s100 offen offset:0 sc1
    buffer_load_dwordx2 v[82:83], v6, s[36:39], s33 offen offset:0 sc1
    s_waitcnt vmcnt(0)
.gpc_124:
    v_min3_u32 v25, v33, v35, v41
    v_max3_u32 v26, v33, v35, v41
    v_min3_u32 v25, v25, v43, v49
    v_max3_u32 v26, v26, v43, v49
    v_min3_u32 v25, v25, v57, v59
    v_max3_u32 v26, v26, v57, v59
    v_min3_u32 v25, v25, v65, v67
    v_max3_u32 v26, v26, v65, v67
    v_min3_u32 v25, v25, v51, v75
    v_max3_u32 v26, v26, v51, v75
    v_min3_u32 v25, v25, v81, v83
    v_max3_u32 v26, v26, v81, v83
    v_cmp_eq_u32 vcc, s34, v25
    v_cmp_eq_u32 s[56:57], s34, v26
    s_and_b64 vcc, vcc, s[56:57]
    s_cmp_eq_u64 vcc, exec
    s_nop 2
    s_cbranch_scc1 .gpd_125
    s_sub_u32 s35, s35, 1
    s_cbranch_scc1 .Lexit
    s_sleep 2
    s_branch .gp_123
.gpd_125:
    v_lshlrev_b32 v160, 16, v32
    v_and_b32 v161, 0xffff0000, v32
    v_lshlrev_b32 v170, 16, v56
    v_and_b32 v171, 0xffff0000, v56
    v_lshlrev_b32 v162, 16, v34
    v_and_b32 v163, 0xffff0000, v34
    v_lshlrev_b32 v172, 16, v58
    v_and_b32 v173, 0xffff0000, v58
    v_lshlrev_b32 v164, 16, v40
    v_and_b32 v165, 0xffff0000, v40
    v_lshlrev_b32 v174, 16, v64
    v_and_b32 v175, 0xffff0000, v64
    v_lshlrev_b32 v166, 16, v42
    v_and_b32 v167, 0xffff0000, v42
    v_lshlrev_b32 v176, 16, v66
    v_and_b32 v177, 0xffff0000, v66
    v_lshlrev_b32 v168, 16, v48
    v_and_b32 v169, 0xffff0000, v48
    v_lshlrev_b32 v178, 16, v50
    v_and_b32 v179, 0xffff0000, v50
    v_lshlrev_b32 v75, 16, v74
    v_and_b32 v74, 0xffff0000, v74
    s_mov_b32 vcc_lo, 0xffff0000
    s_mov_b32 vcc_hi, 0xffff0000
    v_cndmask_b32 v75, v75, v74, vcc
    v_lshlrev_b32 v81, 16, v80
    v_and_b32 v80, 0xffff0000, v80
    s_mov_b32 vcc_lo, 0xffff0000
    s_mov_b32 vcc_hi, 0xffff0000
    v_cndmask_b32 v81, v81, v80, vcc
    v_lshlrev_b32 v83, 16, v82
    v_and_b32 v82, 0xffff0000, v82
    s_mov_b32 vcc_lo, 0xffff0000
    s_mov_b32 vcc_hi, 0xffff0000
    v_cndmask_b32 v83, v83, v82, vcc
    s_waitcnt vmcnt(0)
    s_add_u32 s58, s101, s0
    s_lshl1_add_u32 s101, s101, 0xac000
    s_cmp_eq_u32 s0, 0
    s_cselect_b32 s32, 64, 0
    s_mov_b64 s[88:89], exec
    s_mov_b64 s[90:91], exec
    s_mov_b64 s[92:93], exec
.mp_126:
    s_mov_b64 exec, s[88:89]
    buffer_load_dwordx4 v[180:183], v2, s[36:39], s58 offen offset:0 sc1
    s_mov_b64 exec, s[90:91]
    buffer_load_dwordx4 v[184:187], v2, s[36:39], s58 offen offset:1024 sc1
    s_mov_b64 exec, s[92:93]
    buffer_load_dwordx2 v[188:189], v5, s[36:39], s58 offen offset:0 sc1
    s_mov_b64 exec, -1
    s_sub_u32 s35, s35, 1
    s_cbranch_scc1 .Lexit
    s_sub_u32 vcc_lo, s101, s58
    s_add_u32 s32, s32, 1
    s_cmp_ge_u32 s32, 64
    s_cselect_b32 s58, vcc_lo, s58
    s_waitcnt vmcnt(0)
.mpj_127:
    v_cmp_ne_u32 s[88:89], s34, v181
    v_cmp_ne_u32 vcc, s34, v183
    s_or_b64 s[88:89], s[88:89], vcc
    v_cmp_ne_u32 s[90:91], s34, v185
    v_cmp_ne_u32 vcc, s34, v187
    s_or_b64 s[90:91], s[90:91], vcc
    v_cmp_ne_u32 s[92:93], s34, v189
    s_or_b64 vcc, s[88:89], s[90:91]
    s_or_b64 vcc, vcc, s[92:93]
    s_cbranch_scc1 .mp_126
    s_mov_b32 s56, 0x3f803f80
    v_dot2_f32_bf16 v200, v180, s56, 0
    v_dot2_f32_bf16 v201, v180, v180, 0
    v_dot2_f32_bf16 v200, v182, s56, v200
    v_dot2_f32_bf16 v201, v182, v182, v201
    v_dot2_f32_bf16 v200, v184, s56, v200
    v_dot2_f32_bf16 v201, v184, v184, v201
    v_dot2_f32_bf16 v200, v186, s56, v200
    v_dot2_f32_bf16 v201, v186, v186, v201
    s_mov_b64 exec, 0xffffffff
    v_dot2_f32_bf16 v200, v188, s56, v200
    v_dot2_f32_bf16 v201, v188, v188, v201
    s_mov_b64 exec, -1
    s_nop 1
    v_permlane32_swap_b32 v200, v201
    v_add_f32 v200, v200, v201
    v_mov_b32 v202, v200
    s_nop 1
    v_permlane16_swap_b32 v202, v200
    v_add_f32 v200, v202, v200
    v_lshlrev_b32 v190, 16, v180
    v_and_b32 v191, 0xffff0000, v180
    v_add_f32_dpp v200, v200, v200 row_ror:8 row_mask:0xf bank_mask:0xf
    v_lshlrev_b32 v192, 16, v182
    v_and_b32 v193, 0xffff0000, v182
    v_add_f32_dpp v200, v200, v200 row_ror:4 row_mask:0xf bank_mask:0xf
    v_lshlrev_b32 v194, 16, v184
    v_and_b32 v195, 0xffff0000, v184
    v_add_f32_dpp v200, v200, v200 quad_perm:[2,3,0,1] row_mask:0xf bank_mask:0xf
    v_lshlrev_b32 v196, 16, v186
    v_and_b32 v197, 0xffff0000, v186
    v_add_f32_dpp v200, v200, v200 quad_perm:[1,0,3,2] row_mask:0xf bank_mask:0xf
    v_mul_f32 v200, 0x3ae38e39, v200
    v_lshlrev_b32 v198, 16, v188
    v_and_b32 v199, 0xffff0000, v188
    v_readlane_b32 s56, v200, 0
    v_readlane_b32 s57, v200, 32
    s_nop 0
    v_mov_b32 v200, s56
    v_fma_f32 v201, -v200, v200, s57
    v_max_f32 v201, 0, v201
    v_cvt_pk_bf16_f32 v203, 0, v201
    v_cvt_pk_bf16_f32 v201, 0, -v200
    v_cvt_pk_bf16_f32 v200, 0, -v200
    v_add_f32 v203, 0x3727c5ac, v203
    v_pk_add_f32 v[190:191], v[190:191], v[200:201]
    v_pk_add_f32 v[192:193], v[192:193], v[200:201]
    v_pk_add_f32 v[194:195], v[194:195], v[200:201]
    v_cvt_pk_bf16_f32 v203, 0, v203
    v_pk_add_f32 v[196:197], v[196:197], v[200:201]
    v_pk_add_f32 v[198:199], v[198:199], v[200:201]
    v_cvt_pk_bf16_f32 v190, 0, v190
    v_sqrt_f32 v203, v203
    v_cvt_pk_bf16_f32 v191, 0, v191
    v_cvt_pk_bf16_f32 v192, 0, v192
    v_cvt_pk_bf16_f32 v193, 0, v193
    v_cvt_pk_bf16_f32 v203, 0, v203
    v_cvt_pk_bf16_f32 v194, 0, v194
    v_cvt_pk_bf16_f32 v195, 0, v195
    v_cvt_pk_bf16_f32 v196, 0, v196
    v_rcp_f32 v202, v203
    v_cvt_pk_bf16_f32 v197, 0, v197
    v_cvt_pk_bf16_f32 v198, 0, v198
    v_cvt_pk_bf16_f32 v199, 0, v199
    v_mov_b32 v203, v202
    v_pk_mul_f32 v[190:191], v[190:191], v[202:203]
    v_pk_mul_f32 v[192:193], v[192:193], v[202:203]
    v_pk_mul_f32 v[194:195], v[194:195], v[202:203]
    v_pk_mul_f32 v[196:197], v[196:197], v[202:203]
    v_pk_mul_f32 v[198:199], v[198:199], v[202:203]
    v_cvt_pk_bf16_f32 v190, 0, v190
    v_cvt_pk_bf16_f32 v191, 0, v191
    v_cvt_pk_bf16_f32 v192, 0, v192
    v_cvt_pk_bf16_f32 v193, 0, v193
    v_cvt_pk_bf16_f32 v194, 0, v194
    v_cvt_pk_bf16_f32 v195, 0, v195
    v_cvt_pk_bf16_f32 v196, 0, v196
    v_cvt_pk_bf16_f32 v197, 0, v197
    v_cvt_pk_bf16_f32 v198, 0, v198
    v_cvt_pk_bf16_f32 v199, 0, v199
    v_pk_mul_f32 v[190:191], v[190:191], v[170:171]
    v_pk_mul_f32 v[192:193], v[192:193], v[172:173]
    v_pk_mul_f32 v[194:195], v[194:195], v[174:175]
    v_pk_mul_f32 v[196:197], v[196:197], v[176:177]
    v_pk_mul_f32 v[198:199], v[198:199], v[178:179]
    v_cvt_pk_bf16_f32 v190, 0, v190
    v_cvt_pk_bf16_f32 v191, 0, v191
    v_cvt_pk_bf16_f32 v192, 0, v192
    v_cvt_pk_bf16_f32 v193, 0, v193
    v_cvt_pk_bf16_f32 v194, 0, v194
    v_cvt_pk_bf16_f32 v195, 0, v195
    v_cvt_pk_bf16_f32 v196, 0, v196
    v_cvt_pk_bf16_f32 v197, 0, v197
    v_cvt_pk_bf16_f32 v198, 0, v198
    v_cvt_pk_bf16_f32 v199, 0, v199
    v_pk_add_f32 v[190:191], v[190:191], v[160:161]
    v_pk_add_f32 v[192:193], v[192:193], v[162:163]
    v_pk_add_f32 v[194:195], v[194:195], v[164:165]
    v_pk_add_f32 v[196:197], v[196:197], v[166:167]
    v_pk_add_f32 v[198:199], v[198:199], v[168:169]
    v_cvt_pk_bf16_f32 v206, v190, v191
    v_cvt_pk_bf16_f32 v207, v192, v193
    v_cvt_pk_bf16_f32 v208, v194, v195
    v_cvt_pk_bf16_f32 v209, v196, v197
    v_cvt_pk_bf16_f32 v210, v198, v199
    v_dot2_f32_bf16 v14, v206, v88, 0
    v_dot2_f32_bf16 v14, v207, v89, v14
    v_dot2_f32_bf16 v14, v208, v90, v14
    v_dot2_f32_bf16 v14, v209, v91, v14
    s_mov_b64 exec, 0xffffffff
    v_dot2_f32_bf16 v14, v210, v30, v14
    s_mov_b64 exec, -1
    s_nop 1
    v_mov_b32 v15, v14
    s_nop 1
    v_permlane32_swap_b32 v15, v14
    v_add_f32 v14, v15, v14
    v_mov_b32 v15, v14
    s_nop 1
    v_permlane16_swap_b32 v15, v14
    v_add_f32 v14, v15, v14
    s_nop 1
    v_add_f32_dpp v14, v14, v14 row_ror:8 row_mask:0xf bank_mask:0xf
    s_nop 1
    v_add_f32_dpp v14, v14, v14 row_ror:4 row_mask:0xf bank_mask:0xf
    s_nop 1
    v_add_f32_dpp v14, v14, v14 quad_perm:[2,3,0,1] row_mask:0xf bank_mask:0xf
    s_nop 1
    v_add_f32_dpp v14, v14, v14 quad_perm:[1,0,3,2] row_mask:0xf bank_mask:0xf
    v_cvt_pk_bf16_f32 v14, 0, v14
    v_max_f32 v14, 0xc2ae0000, v14
    v_min_f32 v14, 0x43000000, v14
    v_mul_f32 v15, 0xbfb8aa3b, v14
    v_fma_f32 v16, v14, s98, -v15
    v_fmac_f32 v16, 0xb2a57060, v14
    v_exp_f32 v15, v15
    v_mul_f32 v16, 0x3f317218, v16
    v_fmac_f32 v15, v15, v16
    v_add_f32 v15, 1.0, v15
    v_rcp_f32 v16, v15
    s_nop 0
    v_fma_f32 v15, -v15, v16, 1.0
    v_fma_f32 v14, v15, v16, v16
    v_cvt_pk_bf16_f32 v14, 0, v14
    v_add_f32 v17, v24, v200
    v_cvt_pk_bf16_f32 v17, 0, v17
    v_mul_f32 v17, v17, v202
    v_cvt_pk_bf16_f32 v17, 0, v17
    v_mul_f32 v17, v17, v81
    v_cvt_pk_bf16_f32 v17, 0, v17
    v_add_f32 v17, v17, v75
    v_cvt_pk_bf16_f32 v17, 0, v17
    s_lshl_b32 s59, s40, 1
    s_add_u32 s58, s59, 0x38c000
    s_mov_b32 s60, 0x04000c0c
    s_mov_b32 s61, 0x0706000c
    s_mov_b32 s48, s28
    s_and_b32 s49, s29, 0xffff
    s_mov_b32 s50, 0x2400
    s_mov_b32 s51, 0x00020000
    s_mul_i32 s63, s3, 1152
    s_mov_b64 s[88:89], exec
    s_mov_b64 s[90:91], exec
    s_mov_b64 s[92:93], exec
    s_mov_b64 s[56:57], exec
.mp_130:
    s_mov_b64 exec, s[88:89]
    buffer_load_dwordx4 v[96:99], v2, s[36:39], s58 offen offset:0 sc1
    s_mov_b64 exec, s[90:91]
    buffer_load_dwordx4 v[100:103], v2, s[36:39], s58 offen offset:1024 sc1
    s_mov_b64 exec, s[92:93]
    buffer_load_dwordx4 v[104:107], v2, s[36:39], s58 offen offset:2048 sc1
    s_mov_b64 exec, s[56:57]
    buffer_load_dwordx4 v[108:111], v2, s[36:39], s58 offen offset:3072 sc1
    s_mov_b64 exec, -1
    s_sub_u32 s35, s35, 1
    s_cbranch_scc1 .Lexit
    s_waitcnt vmcnt(0)
.mpj_131:
    v_cmp_ne_u32 s[88:89], s34, v99
    v_cmp_ne_u32 s[90:91], s34, v103
    v_cmp_ne_u32 s[92:93], s34, v107
    v_cmp_ne_u32 s[56:57], s34, v111
    s_or_b64 vcc, s[88:89], s[90:91]
    s_or_b64 vcc, vcc, s[92:93]
    s_or_b64 vcc, vcc, s[56:57]
    s_cbranch_scc1 .mp_130
    v_perm_b32 v99, v96, v97, s60
    v_perm_b32 v103, v100, v101, s60
    v_perm_b32 v107, v104, v105, s60
    v_perm_b32 v111, v108, v109, s60
    v_perm_b32 v99, v99, v98, s61
    v_perm_b32 v103, v103, v102, s61
    v_perm_b32 v107, v107, v106, s61
    v_perm_b32 v111, v111, v110, s61
    v_pk_add_f32 v[96:97], v[96:97], v[100:101]
    v_pk_add_f32 v[98:99], v[98:99], v[102:103]
    v_pk_add_f32 v[248:249], v[104:105], v[108:109]
    v_pk_add_f32 v[250:251], v[106:107], v[110:111]
    v_pk_add_f32 v[248:249], v[248:249], v[96:97]
    v_pk_add_f32 v[250:251], v[250:251], v[98:99]
    s_nop 1
    v_permlane32_swap_b32 v248, v250
    v_permlane32_swap_b32 v249, v251
    v_pk_add_f32 v[248:249], v[248:249], v[250:251]
    s_nop 1
    v_permlane16_swap_b32 v248, v249
    v_add_f32 v248, v248, v249
    v_cvt_pk_bf16_f32 v248, 0, v248
    v_mul_f32 v248, v248, v14
    v_cvt_pk_bf16_f32 v248, 0, v248
    v_add_f32 v248, v248, v17
    v_cvt_pk_bf16_f32 v248, 0, v248
    v_mul_f32 v248, v248, v83
    v_cvt_pk_bf16_f32 v248, 0, v248
    v_add_f32 v248, v248, v24
    v_cvt_pk_bf16_f32 v248, v248, v248
    buffer_store_short v248, v31, s[48:51], s63 offen
    s_cmp_lg_u32 s2, 0
    s_cbranch_scc1 .Lexit
    v_mov_b32 v13, s34
    s_mov_b64 exec, 1
    buffer_store_dword v13, v2, s[36:39], 0 offen
    s_mov_b64 exec, -1
    s_branch .Lexit
.Latt_bc:
    v_and_b32 v8, 1, v0
    v_lshlrev_b32 v8, 8, v8
    v_and_b32 v9, 0x3c, v0
    v_lshl_add_u32 v9, v9, 2, v8
    v_lshlrev_b32 v7, 1, v9
    v_and_b32 v9, 0x3c, v0
    v_lshrrev_b32 v8, 4, v8
    v_and_b32 v9, 2, v0
    v_lshl_add_u32 v9, v9, 6, v8
    s_lshl_b32 s58, s66, 14
    s_lshl_b32 s59, s67, 10
    s_add_u32 s58, s58, s59
    s_add_u32 s58, s58, 0x40000
    s_lshl4_add_u32 s59, s66, s67
    s_lshl_b32 s59, s59, 8
    s_add_u32 s59, s59, 0x200000
    s_memrealtime s[8:9]
    s_waitcnt vmcnt(8)
    s_waitcnt lgkmcnt(0)
    s_sub_u32 s8, s8, s30
    s_cmpk_ge_u32 s8, 1147
    s_cbranch_scc1 .ap_134
    s_waitcnt vmcnt(5)
    s_cmpk_ge_u32 s8, 1082
    s_cbranch_scc1 .ap_134
    s_waitcnt vmcnt(3)
    s_bitcmp1_b64 s[14:15], 26
    s_cbranch_scc0 1
    s_waitcnt vmcnt(2)
    s_cmpk_ge_u32 s8, 1007
    s_cbranch_scc1 .ap_134
    s_waitcnt vmcnt(1)
.ap_134:
    s_add_u32 s63, s69, 409600
    buffer_load_dwordx4 v[88:91], v1, s[40:43], s63 offen nt
    s_memrealtime s[8:9]
    s_waitcnt vmcnt(8)
    s_waitcnt lgkmcnt(0)
    s_sub_u32 s8, s8, s30
    s_cmpk_ge_u32 s8, 1174
    s_cbranch_scc1 .ap_135
    s_waitcnt vmcnt(5)
    s_cmpk_ge_u32 s8, 1109
    s_cbranch_scc1 .ap_135
    s_waitcnt vmcnt(3)
    s_bitcmp1_b64 s[14:15], 27
    s_cbranch_scc0 1
    s_waitcnt vmcnt(2)
    s_cmpk_ge_u32 s8, 1034
    s_cbranch_scc1 .ap_135
    s_waitcnt vmcnt(1)
.ap_135:
    s_add_u32 s63, s69, 417792
    buffer_load_dwordx4 v[92:95], v1, s[40:43], s63 offen nt
    s_memrealtime s[8:9]
    s_waitcnt vmcnt(8)
    s_waitcnt lgkmcnt(0)
    s_sub_u32 s8, s8, s30
    s_cmpk_ge_u32 s8, 1201
    s_cbranch_scc1 .ap_136
    s_waitcnt vmcnt(5)
    s_cmpk_ge_u32 s8, 1136
    s_cbranch_scc1 .ap_136
    s_waitcnt vmcnt(3)
    s_bitcmp1_b64 s[14:15], 28
    s_cbranch_scc0 1
    s_waitcnt vmcnt(2)
    s_cmpk_ge_u32 s8, 1061
    s_cbranch_scc1 .ap_136
    s_waitcnt vmcnt(1)
.ap_136:
    s_add_u32 s63, s69, 425984
    buffer_load_dwordx4 v[120:123], v1, s[40:43], s63 offen nt
    s_memrealtime s[8:9]
    s_waitcnt vmcnt(8)
    s_waitcnt lgkmcnt(0)
    s_sub_u32 s8, s8, s30
    s_cmpk_ge_u32 s8, 1228
    s_cbranch_scc1 .ap_137
    s_waitcnt vmcnt(5)
    s_cmpk_ge_u32 s8, 1163
    s_cbranch_scc1 .ap_137
    s_waitcnt vmcnt(3)
    s_bitcmp1_b64 s[14:15], 29
    s_cbranch_scc0 1
    s_waitcnt vmcnt(2)
    s_cmpk_ge_u32 s8, 1088
    s_cbranch_scc1 .ap_137
    s_waitcnt vmcnt(1)
.ap_137:
    s_add_u32 s63, s69, 434176
    buffer_load_dwordx4 v[124:127], v1, s[40:43], s63 offen nt
    s_memrealtime s[8:9]
    s_waitcnt vmcnt(8)
    s_waitcnt lgkmcnt(0)
    s_sub_u32 s8, s8, s30
    s_cmpk_ge_u32 s8, 1255
    s_cbranch_scc1 .ap_138
    s_waitcnt vmcnt(5)
    s_cmpk_ge_u32 s8, 1190
    s_cbranch_scc1 .ap_138
    s_waitcnt vmcnt(3)
    s_bitcmp1_b64 s[14:15], 30
    s_cbranch_scc0 1
    s_waitcnt vmcnt(2)
    s_cmpk_ge_u32 s8, 1115
    s_cbranch_scc1 .ap_138
    s_waitcnt vmcnt(1)
.ap_138:
    s_add_u32 s63, s69, 442368
    buffer_load_dwordx4 v[152:155], v1, s[40:43], s63 offen nt
    s_memrealtime s[8:9]
    s_waitcnt vmcnt(8)
    s_waitcnt lgkmcnt(0)
    s_sub_u32 s8, s8, s30
    s_cmpk_ge_u32 s8, 1282
    s_cbranch_scc1 .ap_139
    s_waitcnt vmcnt(5)
    s_cmpk_ge_u32 s8, 1217
    s_cbranch_scc1 .ap_139
    s_waitcnt vmcnt(3)
    s_bitcmp1_b64 s[14:15], 31
    s_cbranch_scc0 1
    s_waitcnt vmcnt(2)
    s_cmpk_ge_u32 s8, 1142
    s_cbranch_scc1 .ap_139
    s_waitcnt vmcnt(1)
.ap_139:
    s_add_u32 s63, s69, 450560
    buffer_load_dwordx4 v[156:159], v1, s[40:43], s63 offen nt
    buffer_load_dwordx4 v[16:19], v7, s[36:39], s58 offen offset:0 sc1
    buffer_load_dwordx4 v[20:23], v7, s[36:39], s58 offen offset:16 sc1
    s_memrealtime s[8:9]
    s_waitcnt vmcnt(8)
    s_waitcnt lgkmcnt(0)
    s_sub_u32 s8, s8, s30
    s_cmpk_ge_u32 s8, 1309
    s_cbranch_scc1 .ap_140
    s_waitcnt vmcnt(5)
    s_cmpk_ge_u32 s8, 1244
    s_cbranch_scc1 .ap_140
    s_waitcnt vmcnt(3)
    s_bitcmp1_b64 s[14:15], 32
    s_cbranch_scc0 1
    s_waitcnt vmcnt(2)
    s_cmpk_ge_u32 s8, 1169
    s_cbranch_scc1 .ap_140
    s_waitcnt vmcnt(1)
.ap_140:
    s_add_u32 s63, s69, 0
    buffer_load_dwordx4 v[160:163], v2, s[44:47], s63 offen nt
    s_memrealtime s[8:9]
    s_waitcnt vmcnt(8)
    s_waitcnt lgkmcnt(0)
    s_sub_u32 s8, s8, s30
    s_cmpk_ge_u32 s8, 1336
    s_cbranch_scc1 .ap_141
    s_waitcnt vmcnt(5)
    s_cmpk_ge_u32 s8, 1271
    s_cbranch_scc1 .ap_141
    s_waitcnt vmcnt(3)
    s_bitcmp1_b64 s[14:15], 33
    s_cbranch_scc0 1
    s_waitcnt vmcnt(2)
    s_cmpk_ge_u32 s8, 1196
    s_cbranch_scc1 .ap_141
    s_waitcnt vmcnt(1)
.ap_141:
    s_add_u32 s63, s69, 8192
    buffer_load_dwordx4 v[164:167], v2, s[44:47], s63 offen nt
    s_memrealtime s[8:9]
    s_waitcnt vmcnt(8)
    s_waitcnt lgkmcnt(0)
    s_sub_u32 s8, s8, s30
    s_cmpk_ge_u32 s8, 1363
    s_cbranch_scc1 .ap_142
    s_waitcnt vmcnt(5)
    s_cmpk_ge_u32 s8, 1298
    s_cbranch_scc1 .ap_142
    s_waitcnt vmcnt(3)
    s_bitcmp1_b64 s[14:15], 34
    s_cbranch_scc0 1
    s_waitcnt vmcnt(2)
    s_cmpk_ge_u32 s8, 1223
    s_cbranch_scc1 .ap_142
    s_waitcnt vmcnt(1)
.ap_142:
    s_add_u32 s63, s69, 16384
    buffer_load_dwordx4 v[168:171], v2, s[44:47], s63 offen nt
    s_waitcnt vmcnt(3)
    s_branch .gpc_144
.gp_143:
    buffer_load_dwordx4 v[16:19], v7, s[36:39], s58 offen offset:0 sc1
    buffer_load_dwordx4 v[20:23], v7, s[36:39], s58 offen offset:16 sc1
    s_waitcnt vmcnt(0)
.gpc_144:
    v_min_u32 v10, v17, v19
    v_max_u32 v11, v17, v19
    v_min3_u32 v10, v10, v21, v23
    v_max3_u32 v11, v11, v21, v23
    v_cmp_eq_u32 vcc, s34, v10
    v_cmp_eq_u32 s[56:57], s34, v11
    s_and_b64 vcc, vcc, s[56:57]
    s_cmp_eq_u64 vcc, exec
    s_nop 2
    s_cbranch_scc1 .gpd_145
    s_sub_u32 s35, s35, 1
    s_cbranch_scc1 .Lexit
    s_sleep 1
    s_branch .gp_143
.gpd_145:
    s_mov_b32 vcc_lo, 0xcccccccc
    s_mov_b32 vcc_hi, 0xcccccccc
    v_cndmask_b32_e64 v24, v16, 0, vcc
    v_cndmask_b32_e64 v25, v18, 0, vcc
    v_cndmask_b32_e64 v26, v20, 0, vcc
    v_cndmask_b32_e64 v27, v22, 0, vcc
    v_cndmask_b32_e32 v28, 0, v16, vcc
    v_cndmask_b32_e32 v29, 0, v18, vcc
    v_cndmask_b32_e32 v30, 0, v20, vcc
    v_cndmask_b32_e32 v31, 0, v22, vcc
    v_mfma_f32_16x16x32_bf16 v[16:19], v[32:35], v[24:27], 0
    v_mfma_f32_16x16x32_bf16 v[32:35], v[40:43], v[24:27], 0
    v_mfma_f32_16x16x32_bf16 v[16:19], v[36:39], v[28:31], v[16:19]
    v_mfma_f32_16x16x32_bf16 v[40:43], v[48:51], v[24:27], 0
    v_mfma_f32_16x16x32_bf16 v[32:35], v[44:47], v[28:31], v[32:35]
    v_mfma_f32_16x16x32_bf16 v[48:51], v[56:59], v[24:27], 0
    v_mfma_f32_16x16x32_bf16 v[40:43], v[52:55], v[28:31], v[40:43]
    v_mfma_f32_16x16x32_bf16 v[56:59], v[64:67], v[24:27], 0
    v_mfma_f32_16x16x32_bf16 v[48:51], v[60:63], v[28:31], v[48:51]
    s_nop 1
    v_add_f32_dpp v10, v17, v16 row_ror:12 row_mask:0xf bank_mask:0x1
    s_memrealtime s[8:9]
    s_waitcnt lgkmcnt(0)
    s_sub_u32 s8, s8, s30
    s_cmpk_ge_u32 s8, 1390
    s_nop 0
    s_cbranch_scc1 .ap_146
    s_waitcnt vmcnt(3)
    s_cmpk_ge_u32 s8, 1325
    s_cbranch_scc1 .ap_146
    s_waitcnt vmcnt(3)
    s_bitcmp1_b64 s[14:15], 35
    s_cbranch_scc0 1
    s_waitcnt vmcnt(2)
    s_cmpk_ge_u32 s8, 1250
    s_cbranch_scc1 .ap_146
    s_waitcnt vmcnt(1)
.ap_146:
    s_add_u32 s63, s69, 24576
    buffer_load_dwordx4 v[172:175], v2, s[44:47], s63 offen nt
    v_mfma_f32_16x16x32_bf16 v[64:67], v[72:75], v[24:27], 0
    v_mfma_f32_16x16x32_bf16 v[56:59], v[68:71], v[28:31], v[56:59]
    v_add_f32_dpp v11, v33, v32 row_ror:12 row_mask:0xf bank_mask:0x1
    v_add_f32_dpp v10, v18, v10 row_ror:8 row_mask:0xf bank_mask:0x1
    v_mfma_f32_16x16x32_bf16 v[72:75], v[80:83], v[24:27], 0
    v_mfma_f32_16x16x32_bf16 v[64:67], v[76:79], v[28:31], v[64:67]
    v_add_f32_dpp v12, v41, v40 row_ror:12 row_mask:0xf bank_mask:0x1
    v_add_f32_dpp v11, v34, v11 row_ror:8 row_mask:0xf bank_mask:0x1
    v_add_f32_dpp v10, v19, v10 row_ror:4 row_mask:0xf bank_mask:0x1
    v_mfma_f32_16x16x32_bf16 v[80:83], v[88:91], v[24:27], 0
    v_mfma_f32_16x16x32_bf16 v[72:75], v[84:87], v[28:31], v[72:75]
    v_add_f32_dpp v13, v49, v48 row_ror:12 row_mask:0xf bank_mask:0x1
    v_add_f32_dpp v12, v42, v12 row_ror:8 row_mask:0xf bank_mask:0x1
    v_add_f32_dpp v11, v35, v11 row_ror:4 row_mask:0xf bank_mask:0x1
    v_mfma_f32_16x16x32_bf16 v[88:91], v[96:99], v[24:27], 0
    v_mfma_f32_16x16x32_bf16 v[80:83], v[92:95], v[28:31], v[80:83]
    v_add_f32_dpp v10, v58, v57 row_ror:12 row_mask:0xf bank_mask:0x2
    v_add_f32_dpp v13, v50, v13 row_ror:8 row_mask:0xf bank_mask:0x1
    v_add_f32_dpp v12, v43, v12 row_ror:4 row_mask:0xf bank_mask:0x1
    s_memrealtime s[8:9]
    s_waitcnt lgkmcnt(0)
    s_sub_u32 s8, s8, s30
    s_cmpk_ge_u32 s8, 1417
    s_nop 0
    s_cbranch_scc1 .ap_147
    s_waitcnt vmcnt(4)
    s_cmpk_ge_u32 s8, 1352
    s_cbranch_scc1 .ap_147
    s_waitcnt vmcnt(3)
    s_bitcmp1_b64 s[14:15], 36
    s_cbranch_scc0 1
    s_waitcnt vmcnt(2)
    s_cmpk_ge_u32 s8, 1277
    s_cbranch_scc1 .ap_147
    s_waitcnt vmcnt(1)
.ap_147:
    s_add_u32 s63, s69, 32768
    buffer_load_dwordx4 v[176:179], v2, s[44:47], s63 offen nt
    v_mfma_f32_16x16x32_bf16 v[96:99], v[104:107], v[24:27], 0
    v_mfma_f32_16x16x32_bf16 v[88:91], v[100:103], v[28:31], v[88:91]
    v_add_f32_dpp v11, v66, v65 row_ror:12 row_mask:0xf bank_mask:0x2
    v_add_f32_dpp v10, v59, v10 row_ror:8 row_mask:0xf bank_mask:0x2
    v_add_f32_dpp v13, v51, v13 row_ror:4 row_mask:0xf bank_mask:0x1
    v_mfma_f32_16x16x32_bf16 v[104:107], v[112:115], v[24:27], 0
    v_mfma_f32_16x16x32_bf16 v[96:99], v[108:111], v[28:31], v[96:99]
    v_add_f32_dpp v12, v74, v73 row_ror:12 row_mask:0xf bank_mask:0x2
    v_add_f32_dpp v11, v67, v11 row_ror:8 row_mask:0xf bank_mask:0x2
    v_add_f32_dpp v10, v56, v10 row_ror:4 row_mask:0xf bank_mask:0x2
    v_mfma_f32_16x16x32_bf16 v[112:115], v[120:123], v[24:27], 0
    v_mfma_f32_16x16x32_bf16 v[104:107], v[116:119], v[28:31], v[104:107]
    v_add_f32_dpp v13, v82, v81 row_ror:12 row_mask:0xf bank_mask:0x2
    v_add_f32_dpp v12, v75, v12 row_ror:8 row_mask:0xf bank_mask:0x2
    v_add_f32_dpp v11, v64, v11 row_ror:4 row_mask:0xf bank_mask:0x2
    v_mfma_f32_16x16x32_bf16 v[120:123], v[128:131], v[24:27], 0
    v_mfma_f32_16x16x32_bf16 v[112:115], v[124:127], v[28:31], v[112:115]
    v_add_f32_dpp v10, v91, v90 row_ror:12 row_mask:0xf bank_mask:0x4
    v_add_f32_dpp v13, v83, v13 row_ror:8 row_mask:0xf bank_mask:0x2
    v_add_f32_dpp v12, v72, v12 row_ror:4 row_mask:0xf bank_mask:0x2
    s_memrealtime s[8:9]
    s_waitcnt lgkmcnt(0)
    s_sub_u32 s8, s8, s30
    s_cmpk_ge_u32 s8, 1444
    s_nop 0
    s_cbranch_scc1 .ap_148
    s_waitcnt vmcnt(5)
    s_cmpk_ge_u32 s8, 1379
    s_cbranch_scc1 .ap_148
    s_waitcnt vmcnt(3)
    s_bitcmp1_b64 s[14:15], 37
    s_cbranch_scc0 1
    s_waitcnt vmcnt(2)
    s_cmpk_ge_u32 s8, 1304
    s_cbranch_scc1 .ap_148
    s_waitcnt vmcnt(1)
.ap_148:
    s_add_u32 s63, s69, 40960
    buffer_load_dwordx4 v[180:183], v2, s[44:47], s63 offen nt
    v_mfma_f32_16x16x32_bf16 v[128:131], v[136:139], v[24:27], 0
    v_mfma_f32_16x16x32_bf16 v[120:123], v[132:135], v[28:31], v[120:123]
    v_add_f32_dpp v11, v99, v98 row_ror:12 row_mask:0xf bank_mask:0x4
    v_add_f32_dpp v10, v88, v10 row_ror:8 row_mask:0xf bank_mask:0x4
    v_add_f32_dpp v13, v80, v13 row_ror:4 row_mask:0xf bank_mask:0x2
    v_mfma_f32_16x16x32_bf16 v[136:139], v[144:147], v[24:27], 0
    v_mfma_f32_16x16x32_bf16 v[128:131], v[140:143], v[28:31], v[128:131]
    v_add_f32_dpp v12, v107, v106 row_ror:12 row_mask:0xf bank_mask:0x4
    v_add_f32_dpp v11, v96, v11 row_ror:8 row_mask:0xf bank_mask:0x4
    v_add_f32_dpp v10, v89, v10 row_ror:4 row_mask:0xf bank_mask:0x4
    v_mfma_f32_16x16x32_bf16 v[144:147], v[152:155], v[24:27], 0
    v_mfma_f32_16x16x32_bf16 v[136:139], v[148:151], v[28:31], v[136:139]
    v_add_f32_dpp v13, v115, v114 row_ror:12 row_mask:0xf bank_mask:0x4
    v_add_f32_dpp v12, v104, v12 row_ror:8 row_mask:0xf bank_mask:0x4
    v_add_f32_dpp v11, v97, v11 row_ror:4 row_mask:0xf bank_mask:0x4
    v_mfma_f32_16x16x32_bf16 v[144:147], v[156:159], v[28:31], v[144:147]
    v_add_f32_dpp v10, v120, v123 row_ror:12 row_mask:0xf bank_mask:0x8
    v_add_f32_dpp v13, v112, v13 row_ror:8 row_mask:0xf bank_mask:0x4
    v_add_f32_dpp v12, v105, v12 row_ror:4 row_mask:0xf bank_mask:0x4
    s_memrealtime s[8:9]
    s_waitcnt lgkmcnt(0)
    s_sub_u32 s8, s8, s30
    s_cmpk_ge_u32 s8, 1471
    s_nop 0
    s_cbranch_scc1 .ap_149
    s_waitcnt vmcnt(5)
    s_cmpk_ge_u32 s8, 1406
    s_cbranch_scc1 .ap_149
    s_waitcnt vmcnt(3)
    s_bitcmp1_b64 s[14:15], 38
    s_cbranch_scc0 1
    s_waitcnt vmcnt(2)
    s_cmpk_ge_u32 s8, 1331
    s_cbranch_scc1 .ap_149
    s_waitcnt vmcnt(1)
.ap_149:
    s_add_u32 s63, s69, 49152
    buffer_load_dwordx4 v[184:187], v2, s[44:47], s63 offen nt
    v_add_f32_dpp v11, v128, v131 row_ror:12 row_mask:0xf bank_mask:0x8
    v_add_f32_dpp v10, v121, v10 row_ror:8 row_mask:0xf bank_mask:0x8
    v_add_f32_dpp v13, v113, v13 row_ror:4 row_mask:0xf bank_mask:0x4
    v_add_f32_dpp v12, v136, v139 row_ror:12 row_mask:0xf bank_mask:0x8
    v_add_f32_dpp v11, v129, v11 row_ror:8 row_mask:0xf bank_mask:0x8
    v_add_f32_dpp v10, v122, v10 row_ror:4 row_mask:0xf bank_mask:0x8
    v_add_f32_dpp v13, v144, v147 row_ror:12 row_mask:0xf bank_mask:0x8
    v_add_f32_dpp v12, v137, v12 row_ror:8 row_mask:0xf bank_mask:0x8
    v_add_f32_dpp v11, v130, v11 row_ror:4 row_mask:0xf bank_mask:0x8
    v_add_f32_dpp v13, v145, v13 row_ror:8 row_mask:0xf bank_mask:0x8
    v_add_f32_dpp v12, v138, v12 row_ror:4 row_mask:0xf bank_mask:0x8
    s_memrealtime s[8:9]
    s_waitcnt lgkmcnt(0)
    s_sub_u32 s8, s8, s30
    s_cmpk_ge_u32 s8, 1498
    s_cbranch_scc1 .ap_150
    s_waitcnt vmcnt(5)
    s_cmpk_ge_u32 s8, 1433
    s_cbranch_scc1 .ap_150
    s_waitcnt vmcnt(3)
    s_bitcmp1_b64 s[14:15], 39
    s_cbranch_scc0 1
    s_waitcnt vmcnt(2)
    s_cmpk_ge_u32 s8, 1358
    s_cbranch_scc1 .ap_150
    s_waitcnt vmcnt(1)
.ap_150:
    s_add_u32 s63, s69, 57344
    buffer_load_dwordx4 v[188:191], v2, s[44:47], s63 offen nt
    v_add_f32_dpp v13, v146, v13 row_ror:4 row_mask:0xf bank_mask:0x8
    s_mov_b32 s60, 0x3db504f3
    s_mov_b32 s61, 0x3db504f3
    v_cvt_pk_bf16_f32 v10, 0, v10
    v_cvt_pk_bf16_f32 v11, 0, v11
    v_cvt_pk_bf16_f32 v12, 0, v12
    v_cvt_pk_bf16_f32 v13, 0, v13
    v_pk_mul_f32 v[10:11], v[10:11], s[60:61]
    v_pk_mul_f32 v[12:13], v[12:13], s[60:61]
    v_cvt_pk_bf16_f32 v10, 0, v10
    v_cvt_pk_bf16_f32 v11, 0, v11
    v_cvt_pk_bf16_f32 v12, 0, v12
    v_cvt_pk_bf16_f32 v13, 0, v13
    v_max_f32 v14, v10, v11
    v_max3_f32 v14, v14, v12, v13
    s_mov_b32 s60, 0x3fb8aa3b
    v_mov_b32 v22, s34
    v_mov_b32 v23, s34
    v_max_f32_dpp v14, v14, v14 quad_perm:[2,3,0,1] row_mask:0xf bank_mask:0xf
    s_nop 1
    v_max_f32_dpp v14, v14, v14 row_ror:4 row_mask:0xf bank_mask:0xf
    s_nop 1
    v_max_f32_dpp v14, v14, v14 row_ror:8 row_mask:0xf bank_mask:0xf
    v_mov_b32 v15, v14
    s_nop 1
    v_permlane16_swap_b32 v15, v14
    v_max_f32 v14, v15, v14
    v_mov_b32 v15, v14
    s_nop 1
    v_permlane32_swap_b32 v15, v14
    v_max_f32 v14, v15, v14
    v_mul_f32 v15, 0xbfb8aa3b, v14
    v_fma_f32 v10, v10, s60, v15
    v_fma_f32 v11, v11, s60, v15
    v_fma_f32 v12, v12, s60, v15
    v_fma_f32 v13, v13, s60, v15
    v_exp_f32 v10, v10
    v_exp_f32 v11, v11
    v_exp_f32 v12, v12
    v_exp_f32 v13, v13
    v_mov_b32 v20, v14
    v_pk_add_f32 v[16:17], v[10:11], v[12:13]
    v_add_f32 v21, v16, v17
    s_lshl3_add_u32 s60, s68, s3
    s_lshl_b32 s60, s60, 5
    s_add_u32 s60, s60, s59
    v_add_f32_dpp v21, v21, v21 quad_perm:[2,3,0,1] row_mask:0xf bank_mask:0xf
    s_nop 1
    v_add_f32_dpp v21, v21, v21 row_ror:4 row_mask:0xf bank_mask:0xf
    s_nop 1
    v_add_f32_dpp v21, v21, v21 row_ror:8 row_mask:0xf bank_mask:0xf
    v_mov_b32 v15, v21
    s_nop 1
    v_permlane16_swap_b32 v15, v21
    v_add_f32 v21, v15, v21
    v_mov_b32 v15, v21
    s_nop 1
    v_permlane32_swap_b32 v15, v21
    v_add_f32 v21, v15, v21
    s_lshl_b32 s60, s3, 4
    s_add_u32 s60, s60, 159104
    v_add_u32 v16, s60, v3
    v_mov_b32 v17, 159232
    v_mov_b32 v18, 1
    s_mov_b64 exec, 3
    ds_write_b64 v16, v[20:21]
    s_mov_b64 exec, 1
    s_waitcnt lgkmcnt(0)
    ds_add_rtn_u32 v18, v17, v18
    s_mov_b64 exec, -1
    v_and_b32 v16, 0x78, v3
    v_add_u32 v16, 159104, v16
    s_waitcnt lgkmcnt(0)
    v_readfirstlane_b32 s60, v18
    s_cmp_lg_u32 s60, 7
    s_nop 3
    s_cbranch_scc1 .ml_151
    ds_read_b64 v[18:19], v16
    s_lshl_b32 s60, s68, 7
    s_add_u32 s60, s60, s59
    s_waitcnt lgkmcnt(0)
    v_mov_b32 v20, v18
    s_nop 1
    v_max_f32_dpp v20, v20, v20 quad_perm:[2,3,0,1] row_mask:0xf bank_mask:0xf
    s_nop 1
    v_max_f32_dpp v20, v20, v20 row_ror:4 row_mask:0xf bank_mask:0xf
    s_nop 1
    v_max_f32_dpp v20, v20, v20 row_ror:8 row_mask:0xf bank_mask:0xf
    v_sub_f32 v18, v18, v20
    v_mul_f32 v18, 0x3fb8aa3b, v18
    v_exp_f32 v18, v18
    s_nop 0
    v_mul_f32 v21, v18, v19
    s_nop 1
    v_add_f32_dpp v21, v21, v21 quad_perm:[2,3,0,1] row_mask:0xf bank_mask:0xf
    s_nop 1
    v_add_f32_dpp v21, v21, v21 row_ror:4 row_mask:0xf bank_mask:0xf
    s_nop 1
    v_add_f32_dpp v21, v21, v21 row_ror:8 row_mask:0xf bank_mask:0xf
    s_mov_b64 exec, 0xff
    buffer_store_dwordx4 v[20:23], v2, s[36:39], s60 offen sc1
    s_mov_b64 exec, -1
.ml_151:
    s_memrealtime s[8:9]
    s_waitcnt lgkmcnt(0)
    s_sub_u32 s8, s8, s30
    s_cmpk_ge_u32 s8, 1525
    s_cbranch_scc1 .ap_152
    s_waitcnt vmcnt(5)
    s_cmpk_ge_u32 s8, 1460
    s_cbranch_scc1 .ap_152
    s_waitcnt vmcnt(3)
    s_bitcmp1_b64 s[14:15], 40
    s_cbranch_scc0 1
    s_waitcnt vmcnt(2)
    s_cmpk_ge_u32 s8, 1385
    s_cbranch_scc1 .ap_152
    s_waitcnt vmcnt(1)
.ap_152:
    s_add_u32 s63, s69, 131072
    buffer_load_dwordx4 v[192:195], v2, s[44:47], s63 offen nt
    s_sub_u32 s57, s65, 9
    s_bitcmp1_b32 s57, 0
    s_cselect_b32 s48, s20, s18
    s_cselect_b32 s49, s21, s19
    s_cselect_b32 s33, 36, 0
    s_and_b32 s49, s49, 0xffff
    s_mov_b32 s50, 0x510000
    s_mov_b32 s51, 0x00020000
    s_mov_b32 s52, s22
    s_and_b32 s53, s23, 0xffff
    s_mov_b32 s54, 0x510000
    s_mov_b32 s55, 0x00020000
    s_lshr_b32 s57, s57, 1
    s_lshl_b32 s57, s57, 7
    s_mul_i32 s101, s64, 1152
    s_add_u32 s101, s101, s57
    s_mul_i32 s56, s3, 73728
    s_add_u32 s101, s101, s56
    s_mul_i32 s56, s64, 72
    s_add_u32 s33, s33, s56
    s_add_u32 s33, s33, s3
    s_mul_i32 s33, s33, 9216
    s_add_u32 s33, s33, s57
    s_bfe_u32 s56, s101, 0x30007
    s_cmp_eq_u32 s56, 3
    s_cselect_b32 s43, 1, 0
    v_bfe_u32 v16, v0, 4, 1
    s_and_b32 s56, s3, 3
    s_lshl_b32 s56, s56, 1
    v_or_b32 v16, s56, v16
    v_and_b32 v6, 7, v0
    v_xor_b32 v16, v16, v6
    v_lshrrev_b32 v6, 3, v0
    v_mul_u32_u24 v6, 9216, v6
    v_lshl_add_u32 v6, v16, 4, v6
    v_bfe_u32 v16, v0, 4, 1
    s_and_b32 s56, s3, 1
    s_lshl_b32 s56, s56, 2
    v_lshl_or_b32 v16, v16, 1, s56
    v_and_b32 v17, 7, v0
    v_xor_b32 v16, v16, v17
    v_lshrrev_b32 v17, 3, v0
    v_mul_u32_u24 v17, 1152, v17
    v_lshl_add_u32 v31, v16, 4, v17
    s_memrealtime s[8:9]
    s_waitcnt vmcnt(8)
    s_waitcnt lgkmcnt(0)
    s_sub_u32 s8, s8, s30
    s_cmpk_ge_u32 s8, 1552
    s_cbranch_scc1 .ap_153
    s_waitcnt vmcnt(5)
    s_cmpk_ge_u32 s8, 1487
    s_cbranch_scc1 .ap_153
    s_waitcnt vmcnt(3)
    s_bitcmp1_b64 s[14:15], 41
    s_cbranch_scc0 1
    s_waitcnt vmcnt(2)
    s_cmpk_ge_u32 s8, 1412
    s_cbranch_scc1 .ap_153
    s_waitcnt vmcnt(1)
.ap_153:
    s_add_u32 s63, s69, 139264
    buffer_load_dwordx4 v[196:199], v2, s[44:47], s63 offen nt
    s_memrealtime s[8:9]
    s_waitcnt vmcnt(8)
    s_waitcnt lgkmcnt(0)
    s_sub_u32 s8, s8, s30
    s_cmpk_ge_u32 s8, 1579
    s_cbranch_scc1 .ap_154
    s_waitcnt vmcnt(5)
    s_cmpk_ge_u32 s8, 1514
    s_cbranch_scc1 .ap_154
    s_waitcnt vmcnt(3)
    s_bitcmp1_b64 s[14:15], 42
    s_cbranch_scc0 1
    s_waitcnt vmcnt(2)
    s_cmpk_ge_u32 s8, 1439
    s_cbranch_scc1 .ap_154
    s_waitcnt vmcnt(1)
.ap_154:
    s_add_u32 s63, s69, 147456
    buffer_load_dwordx4 v[200:203], v2, s[44:47], s63 offen nt
    s_memrealtime s[8:9]
    s_waitcnt vmcnt(8)
    s_waitcnt lgkmcnt(0)
    s_sub_u32 s8, s8, s30
    s_cmpk_ge_u32 s8, 1606
    s_cbranch_scc1 .ap_155
    s_waitcnt vmcnt(5)
    s_cmpk_ge_u32 s8, 1541
    s_cbranch_scc1 .ap_155
    s_waitcnt vmcnt(3)
    s_bitcmp1_b64 s[14:15], 43
    s_cbranch_scc0 1
    s_waitcnt vmcnt(2)
    s_cmpk_ge_u32 s8, 1466
    s_cbranch_scc1 .ap_155
    s_waitcnt vmcnt(1)
.ap_155:
    s_add_u32 s63, s69, 155648
    buffer_load_dwordx4 v[204:207], v2, s[44:47], s63 offen nt
    s_memrealtime s[8:9]
    s_waitcnt vmcnt(8)
    s_waitcnt lgkmcnt(0)
    s_sub_u32 s8, s8, s30
    s_cmpk_ge_u32 s8, 1633
    s_cbranch_scc1 .ap_156
    s_waitcnt vmcnt(5)
    s_cmpk_ge_u32 s8, 1568
    s_cbranch_scc1 .ap_156
    s_waitcnt vmcnt(3)
    s_bitcmp1_b64 s[14:15], 44
    s_cbranch_scc0 1
    s_waitcnt vmcnt(2)
    s_cmpk_ge_u32 s8, 1493
    s_cbranch_scc1 .ap_156
    s_waitcnt vmcnt(1)
.ap_156:
    s_add_u32 s63, s69, 163840
    buffer_load_dwordx4 v[208:211], v2, s[44:47], s63 offen nt
    s_memrealtime s[8:9]
    s_waitcnt vmcnt(8)
    s_waitcnt lgkmcnt(0)
    s_sub_u32 s8, s8, s30
    s_cmpk_ge_u32 s8, 1660
    s_cbranch_scc1 .ap_157
    s_waitcnt vmcnt(5)
    s_cmpk_ge_u32 s8, 1595
    s_cbranch_scc1 .ap_157
    s_waitcnt vmcnt(3)
    s_bitcmp1_b64 s[14:15], 45
    s_cbranch_scc0 1
    s_waitcnt vmcnt(2)
    s_cmpk_ge_u32 s8, 1520
    s_cbranch_scc1 .ap_157
    s_waitcnt vmcnt(1)
.ap_157:
    s_add_u32 s63, s69, 172032
    buffer_load_dwordx4 v[212:215], v2, s[44:47], s63 offen nt
    s_memrealtime s[8:9]
    s_waitcnt vmcnt(8)
    s_waitcnt lgkmcnt(0)
    s_sub_u32 s8, s8, s30
    s_cmpk_ge_u32 s8, 1691
    s_cbranch_scc1 .ap_158
    s_waitcnt vmcnt(5)
    s_cmpk_ge_u32 s8, 1626
    s_cbranch_scc1 .ap_158
    s_waitcnt vmcnt(3)
    s_bitcmp1_b64 s[14:15], 46
    s_cbranch_scc0 1
    s_waitcnt vmcnt(2)
    s_cmpk_ge_u32 s8, 1551
    s_cbranch_scc1 .ap_158
    s_waitcnt vmcnt(1)
.ap_158:
    s_add_u32 s63, s69, 180224
    buffer_load_dwordx4 v[216:219], v2, s[44:47], s63 offen nt
    s_memrealtime s[8:9]
    s_waitcnt vmcnt(8)
    s_waitcnt lgkmcnt(0)
    s_sub_u32 s8, s8, s30
    s_cmpk_ge_u32 s8, 1722
    s_cbranch_scc1 .ap_159
    s_waitcnt vmcnt(5)
    s_cmpk_ge_u32 s8, 1657
    s_cbranch_scc1 .ap_159
    s_waitcnt vmcnt(3)
    s_bitcmp1_b64 s[14:15], 47
    s_cbranch_scc0 1
    s_waitcnt vmcnt(2)
    s_cmpk_ge_u32 s8, 1582
    s_cbranch_scc1 .ap_159
    s_waitcnt vmcnt(1)
.ap_159:
    s_add_u32 s63, s69, 188416
    buffer_load_dwordx4 v[220:223], v2, s[44:47], s63 offen nt
    s_mul_i32 s99, s3, 2304
    s_add_u32 s99, s99, 0x1e000
    buffer_load_dwordx4 v[32:35], v2, s[36:39], s99 offen offset:0
    buffer_load_dwordx4 v[40:43], v2, s[36:39], s99 offen offset:1024
    buffer_load_dwordx2 v[48:49], v5, s[36:39], s99 offen offset:0
    s_memrealtime s[8:9]
    s_waitcnt vmcnt(11)
    s_waitcnt lgkmcnt(0)
    s_sub_u32 s8, s8, s30
    s_cmpk_ge_u32 s8, 1753
    s_cbranch_scc1 .ap_160
    s_waitcnt vmcnt(8)
    s_cmpk_ge_u32 s8, 1688
    s_cbranch_scc1 .ap_160
    s_waitcnt vmcnt(6)
    s_bitcmp1_b64 s[14:15], 48
    s_cbranch_scc0 1
    s_waitcnt vmcnt(5)
    s_cmpk_ge_u32 s8, 1613
    s_cbranch_scc1 .ap_160
    s_waitcnt vmcnt(4)
.ap_160:
    s_add_u32 s63, s69, 262144
    buffer_load_dwordx4 v[224:227], v2, s[44:47], s63 offen nt
    s_memrealtime s[8:9]
    s_waitcnt vmcnt(11)
    s_waitcnt lgkmcnt(0)
    s_sub_u32 s8, s8, s30
    s_cmpk_ge_u32 s8, 1784
    s_cbranch_scc1 .ap_161
    s_waitcnt vmcnt(8)
    s_cmpk_ge_u32 s8, 1719
    s_cbranch_scc1 .ap_161
    s_waitcnt vmcnt(6)
    s_bitcmp1_b64 s[14:15], 49
    s_cbranch_scc0 1
    s_waitcnt vmcnt(5)
    s_cmpk_ge_u32 s8, 1644
    s_cbranch_scc1 .ap_161
    s_waitcnt vmcnt(4)
.ap_161:
    s_add_u32 s63, s69, 270336
    buffer_load_dwordx4 v[228:231], v2, s[44:47], s63 offen nt
    s_mul_i32 s100, s3, 2304
    s_add_u32 s100, s100, 0x27000
    buffer_load_dwordx4 v[56:59], v2, s[36:39], s100 offen offset:0
    buffer_load_dwordx4 v[64:67], v2, s[36:39], s100 offen offset:1024
    buffer_load_dwordx2 v[50:51], v5, s[36:39], s100 offen offset:0
    s_memrealtime s[8:9]
    s_waitcnt vmcnt(14)
    s_waitcnt lgkmcnt(0)
    s_sub_u32 s8, s8, s30
    s_cmpk_ge_u32 s8, 1815
    s_cbranch_scc1 .ap_162
    s_waitcnt vmcnt(11)
    s_cmpk_ge_u32 s8, 1750
    s_cbranch_scc1 .ap_162
    s_waitcnt vmcnt(9)
    s_bitcmp1_b64 s[14:15], 50
    s_cbranch_scc0 1
    s_waitcnt vmcnt(8)
    s_cmpk_ge_u32 s8, 1675
    s_cbranch_scc1 .ap_162
    s_waitcnt vmcnt(4)
.ap_162:
    s_add_u32 s63, s69, 278528
    buffer_load_dwordx4 v[232:235], v2, s[44:47], s63 offen nt
    s_memrealtime s[8:9]
    s_waitcnt vmcnt(14)
    s_waitcnt lgkmcnt(0)
    s_sub_u32 s8, s8, s30
    s_cmpk_ge_u32 s8, 1846
    s_cbranch_scc1 .ap_163
    s_waitcnt vmcnt(11)
    s_cmpk_ge_u32 s8, 1781
    s_cbranch_scc1 .ap_163
    s_waitcnt vmcnt(9)
    s_bitcmp1_b64 s[14:15], 51
    s_cbranch_scc0 1
    s_waitcnt vmcnt(5)
    s_cmpk_ge_u32 s8, 1706
    s_cbranch_scc1 .ap_163
    s_waitcnt vmcnt(4)
.ap_163:
    s_add_u32 s63, s69, 286720
    buffer_load_dwordx4 v[236:239], v2, s[44:47], s63 offen nt
    s_memrealtime s[8:9]
    s_waitcnt vmcnt(14)
    s_waitcnt lgkmcnt(0)
    s_sub_u32 s8, s8, s30
    s_cmpk_ge_u32 s8, 1877
    s_cbranch_scc1 .ap_164
    s_waitcnt vmcnt(11)
    s_cmpk_ge_u32 s8, 1812
    s_cbranch_scc1 .ap_164
    s_waitcnt vmcnt(6)
    s_bitcmp1_b64 s[14:15], 52
    s_cbranch_scc0 1
    s_waitcnt vmcnt(5)
    s_cmpk_ge_u32 s8, 1737
    s_cbranch_scc1 .ap_164
    s_waitcnt vmcnt(1)
.ap_164:
    s_add_u32 s63, s69, 294912
    buffer_load_dwordx4 v[240:243], v2, s[44:47], s63 offen nt
    s_memrealtime s[8:9]
    s_waitcnt vmcnt(14)
    s_waitcnt lgkmcnt(0)
    s_sub_u32 s8, s8, s30
    s_cmpk_ge_u32 s8, 1908
    s_cbranch_scc1 .ap_165
    s_waitcnt vmcnt(11)
    s_cmpk_ge_u32 s8, 1843
    s_cbranch_scc1 .ap_165
    s_waitcnt vmcnt(6)
    s_bitcmp1_b64 s[14:15], 53
    s_cbranch_scc0 1
    s_waitcnt vmcnt(2)
    s_cmpk_ge_u32 s8, 1768
    s_cbranch_scc1 .ap_165
    s_waitcnt vmcnt(1)
.ap_165:
    s_add_u32 s63, s69, 303104
    buffer_load_dwordx4 v[244:247], v2, s[44:47], s63 offen nt
    s_load_dwordx2 s[88:89], s[6:7], s0
    buffer_load_dwordx4 v[24:27], v9, s[36:39], s59 offen offset:0 sc1
    s_memrealtime s[8:9]
    s_waitcnt vmcnt(14)
    s_waitcnt lgkmcnt(0)
    s_sub_u32 s8, s8, s30
    s_cmpk_ge_u32 s8, 1939
    s_cbranch_scc1 .ap_166
    s_waitcnt vmcnt(8)
    s_cmpk_ge_u32 s8, 1874
    s_cbranch_scc1 .ap_166
    s_waitcnt vmcnt(3)
    s_bitcmp1_b64 s[14:15], 54
    s_cbranch_scc0 1
    s_waitcnt vmcnt(2)
    s_cmpk_ge_u32 s8, 1799
    s_cbranch_scc1 .ap_166
    s_waitcnt vmcnt(1)
.ap_166:
    s_add_u32 s63, s69, 311296
    buffer_load_dwordx4 v[248:251], v2, s[44:47], s63 offen nt
    s_memrealtime s[8:9]
    s_waitcnt vmcnt(14)
    s_waitcnt lgkmcnt(0)
    s_sub_u32 s8, s8, s30
    s_cmpk_ge_u32 s8, 1970
    s_cbranch_scc1 .ap_167
    s_waitcnt vmcnt(5)
    s_cmpk_ge_u32 s8, 1905
    s_cbranch_scc1 .ap_167
    s_waitcnt vmcnt(3)
    s_bitcmp1_b64 s[14:15], 55
    s_cbranch_scc0 1
    s_waitcnt vmcnt(2)
    s_cmpk_ge_u32 s8, 1830
    s_cbranch_scc1 .ap_167
    s_waitcnt vmcnt(1)
.ap_167:
    s_add_u32 s63, s69, 319488
    buffer_load_dwordx4 v[252:255], v2, s[44:47], s63 offen nt
    s_memrealtime s[8:9]
    s_waitcnt vmcnt(11)
    s_waitcnt lgkmcnt(0)
    s_sub_u32 s8, s8, s30
    s_cmpk_ge_u32 s8, 2001
    s_cbranch_scc1 .ap_168
    s_waitcnt vmcnt(5)
    s_cmpk_ge_u32 s8, 1936
    s_cbranch_scc1 .ap_168
    s_waitcnt vmcnt(3)
    s_bitcmp1_b64 s[14:15], 56
    s_cbranch_scc0 1
    s_waitcnt vmcnt(2)
    s_cmpk_ge_u32 s8, 1861
    s_cbranch_scc1 .ap_168
    s_waitcnt vmcnt(1)
.ap_168:
    s_add_u32 s63, s69, 393216
    buffer_load_dwordx4 v[36:39], v2, s[44:47], s63 offen nt
    s_memrealtime s[8:9]
    s_waitcnt vmcnt(11)
    s_waitcnt lgkmcnt(0)
    s_sub_u32 s8, s8, s30
    s_cmpk_ge_u32 s8, 2032
    s_cbranch_scc1 .ap_169
    s_waitcnt vmcnt(5)
    s_cmpk_ge_u32 s8, 1967
    s_cbranch_scc1 .ap_169
    s_waitcnt vmcnt(3)
    s_bitcmp1_b64 s[14:15], 57
    s_cbranch_scc0 1
    s_waitcnt vmcnt(2)
    s_cmpk_ge_u32 s8, 1892
    s_cbranch_scc1 .ap_169
    s_waitcnt vmcnt(1)
.ap_169:
    s_add_u32 s63, s69, 401408
    buffer_load_dwordx4 v[44:47], v2, s[44:47], s63 offen nt
    s_memrealtime s[8:9]
    s_waitcnt vmcnt(8)
    s_waitcnt lgkmcnt(0)
    s_sub_u32 s8, s8, s30
    s_cmpk_ge_u32 s8, 2063
    s_cbranch_scc1 .ap_170
    s_waitcnt vmcnt(5)
    s_cmpk_ge_u32 s8, 1998
    s_cbranch_scc1 .ap_170
    s_waitcnt vmcnt(3)
    s_bitcmp1_b64 s[14:15], 58
    s_cbranch_scc0 1
    s_waitcnt vmcnt(2)
    s_cmpk_ge_u32 s8, 1923
    s_cbranch_scc1 .ap_170
    s_waitcnt vmcnt(1)
.ap_170:
    s_add_u32 s63, s69, 409600
    buffer_load_dwordx4 v[52:55], v2, s[44:47], s63 offen nt
    s_waitcnt vmcnt(5)
    s_branch .gpc_172
.gp_171:
    buffer_load_dwordx4 v[24:27], v9, s[36:39], s59 offen offset:0 sc1
    s_waitcnt vmcnt(0)
.gpc_172:
    v_cmp_eq_u32 vcc, s34, v26
    v_cmp_eq_u32 s[56:57], s34, v27
    s_and_b64 vcc, vcc, s[56:57]
    s_cmp_eq_u64 vcc, exec
    s_nop 2
    s_cbranch_scc1 .gpd_173
    s_sub_u32 s35, s35, 1
    s_cbranch_scc1 .Lexit
    s_sleep 1
    s_branch .gp_171
.gpd_173:
    s_lshr_b64 s[88:89], s[88:89], s1
    s_and_b32 s88, s88, 0xff
    s_cmp_eq_u32 s88, 32
    s_cselect_b32 s0, 0xac000, 0
    v_mov_b32 v16, v24
    s_nop 1
    v_max_f32_dpp v16, v16, v16 quad_perm:[2,3,0,1] row_mask:0xf bank_mask:0xf
    v_sub_f32 v17, v24, v16
    v_sub_f32 v18, v14, v16
    v_mul_f32 v17, 0x3fb8aa3b, v17
    v_mul_f32 v18, 0x3fb8aa3b, v18
    v_exp_f32 v17, v17
    v_exp_f32 v18, v18
    v_mul_f32 v17, v17, v25
    s_nop 1
    v_add_f32_dpp v17, v17, v17 quad_perm:[2,3,0,1] row_mask:0xf bank_mask:0xf
    v_rcp_f32 v19, v17
    s_nop 0
    v_fma_f32 v15, -v17, v19, 1.0
    v_fma_f32 v19, v15, v19, v19
    v_mul_f32 v18, v18, v19
    v_mul_f32 v10, v10, v18
    v_mul_f32 v11, v11, v18
    v_mul_f32 v12, v12, v18
    v_mul_f32 v13, v13, v18
    v_mov_b32_dpp v112, v10 quad_perm:[2,3,0,1] row_mask:0xf bank_mask:0xf
    v_mov_b32_dpp v113, v11 quad_perm:[2,3,0,1] row_mask:0xf bank_mask:0xf
    v_mov_b32_dpp v114, v12 quad_perm:[2,3,0,1] row_mask:0xf bank_mask:0xf
    v_mov_b32_dpp v115, v13 quad_perm:[2,3,0,1] row_mask:0xf bank_mask:0xf
    v_cvt_pk_bf16_f32 v96, v10, v112
    v_cvt_pk_bf16_f32 v100, v11, v113
    v_cvt_pk_bf16_f32 v104, v12, v114
    v_cvt_pk_bf16_f32 v108, v13, v115
    v_mov_b32_dpp v97, v96 row_ror:12 row_mask:0xf bank_mask:0xf
    v_mov_b32_dpp v101, v100 row_ror:12 row_mask:0xf bank_mask:0xf
    v_mov_b32_dpp v105, v104 row_ror:12 row_mask:0xf bank_mask:0xf
    v_mov_b32_dpp v109, v108 row_ror:12 row_mask:0xf bank_mask:0xf
    v_mov_b32_dpp v98, v96 row_ror:8 row_mask:0xf bank_mask:0xf
    v_mov_b32_dpp v102, v100 row_ror:8 row_mask:0xf bank_mask:0xf
    v_mov_b32_dpp v106, v104 row_ror:8 row_mask:0xf bank_mask:0xf
    v_mov_b32_dpp v110, v108 row_ror:8 row_mask:0xf bank_mask:0xf
    v_mov_b32_dpp v99, v96 row_ror:4 row_mask:0xf bank_mask:0xf
    v_mov_b32_dpp v103, v100 row_ror:4 row_mask:0xf bank_mask:0xf
    v_mov_b32_dpp v107, v104 row_ror:4 row_mask:0xf bank_mask:0xf
    v_mov_b32_dpp v111, v108 row_ror:4 row_mask:0xf bank_mask:0xf
    v_mov_b32_dpp v96, v96 row_shr:3 row_mask:0xf bank_mask:0x2
    v_mov_b32_dpp v97, v97 row_shr:3 row_mask:0xf bank_mask:0x2
    v_mov_b32_dpp v98, v98 row_shr:3 row_mask:0xf bank_mask:0x2
    v_mov_b32_dpp v99, v99 row_shr:3 row_mask:0xf bank_mask:0x2
    v_mov_b32_dpp v100, v100 row_shr:3 row_mask:0xf bank_mask:0x2
    v_mov_b32_dpp v101, v101 row_shr:3 row_mask:0xf bank_mask:0x2
    v_mov_b32_dpp v102, v102 row_shr:3 row_mask:0xf bank_mask:0x2
    v_mov_b32_dpp v103, v103 row_shr:3 row_mask:0xf bank_mask:0x2
    v_mov_b32_dpp v104, v104 row_shr:3 row_mask:0xf bank_mask:0x2
    v_mov_b32_dpp v105, v105 row_shr:3 row_mask:0xf bank_mask:0x2
    v_mov_b32_dpp v106, v106 row_shr:3 row_mask:0xf bank_mask:0x2
    v_mov_b32_dpp v107, v107 row_shr:3 row_mask:0xf bank_mask:0x2
    v_mov_b32_dpp v108, v108 row_shr:3 row_mask:0xf bank_mask:0x2
    v_mov_b32_dpp v109, v109 row_shr:3 row_mask:0xf bank_mask:0x2
    v_mov_b32_dpp v110, v110 row_shr:3 row_mask:0xf bank_mask:0x2
    v_mov_b32_dpp v111, v111 row_shr:3 row_mask:0xf bank_mask:0x2
    s_memrealtime s[8:9]
    s_waitcnt lgkmcnt(0)
    s_sub_u32 s8, s8, s30
    s_cmpk_ge_u32 s8, 2094
    s_cbranch_scc1 .ap_174
    s_waitcnt vmcnt(5)
    s_cmpk_ge_u32 s8, 2029
    s_cbranch_scc1 .ap_174
    s_waitcnt vmcnt(3)
    s_bitcmp1_b64 s[14:15], 59
    s_cbranch_scc0 1
    s_waitcnt vmcnt(2)
    s_cmpk_ge_u32 s8, 1954
    s_cbranch_scc1 .ap_174
    s_waitcnt vmcnt(1)
.ap_174:
    s_add_u32 s63, s69, 417792
    buffer_load_dwordx4 v[60:63], v2, s[44:47], s63 offen nt
    s_lshl_b32 s60, s3, 10
    s_add_u32 s60, s60, 132096
    v_lshlrev_b32 v10, 5, v0
    v_add_u32 v10, s60, v10
    v_lshrrev_b32 v11, 5, v0
    v_lshlrev_b32 v11, 13, v11
    v_and_b32 v12, 31, v0
    v_lshl_add_u32 v11, v12, 4, v11
    v_add_u32 v9, 132096, v2
    v_mov_b32 v15, s34
    v_mov_b32 v13, 110592
    s_mov_b32 s1, s43
    v_bfe_u32 v16, v0, 1, 3
    v_mul_u32_u24 v16, 1312, v16
    v_lshrrev_b32 v7, 4, v0
    v_lshl_add_u32 v16, v7, 5, v16
    v_and_b32 v7, 1, v0
    v_lshl_add_u32 v16, v7, 4, v16
    v_add_u32 v16, 147456, v16
    s_mul_i32 s56, s3, 1312
    s_add_u32 s56, s56, 147456
    v_add_u32 v17, s56, v3
    v_add_u32 v18, s56, v4
    v_lshrrev_b32 v7, 4, v0
    v_bfe_u32 v8, v0, 1, 1
    v_lshl_add_u32 v7, v7, 1, v8
    v_bfe_u32 v8, v0, 2, 2
    v_lshl_add_u32 v19, v7, 3, v8
    v_lshlrev_b32 v19, 7, v19
    v_and_b32 v7, 3, v7
    v_lshrrev_b32 v8, 1, v8
    v_lshl_add_u32 v7, v7, 1, v8
    v_xor_b32 v7, s3, v7
    v_lshl_add_u32 v19, v7, 4, v19
    v_and_b32 v7, 1, v0
    v_lshl_add_u32 v19, v7, 3, v19
    v_add_u32 v20, 32768, v19
    v_lshrrev_b32 v7, 4, v0
    v_bfe_u32 v8, v0, 2, 2
    v_lshl_add_u32 v21, v7, 3, v8
    v_lshlrev_b32 v21, 7, v21
    v_and_b32 v7, 1, v7
    v_lshrrev_b32 v8, 1, v8
    v_lshl_add_u32 v7, v7, 1, v8
    s_and_b32 s56, s3, 1
    s_lshl_b32 s56, s56, 1
    v_xor_b32 v7, s56, v7
    v_and_b32 v8, 3, v0
    v_lshl_add_u32 v21, v8, 3, v21
    s_lshr_b32 s56, s3, 1
    s_mul_i32 s56, s56, 12288
    s_add_u32 s56, s56, 73728
    v_add_u32 v21, s56, v21
    v_xor_b32 v8, 1, v7
    v_lshl_add_u32 v22, v8, 5, v21
    v_lshl_add_u32 v21, v7, 5, v21
    v_bfe_u32 v7, v0, 1, 3
    v_mul_u32_u24 v23, 1312, v7
    v_mul_u32_u24 v24, 272, v7
    v_and_b32 v7, 48, v0
    s_lshr_b32 s56, s3, 1
    s_mul_i32 s57, s56, 192
    s_add_u32 s57, s57, 110592
    v_add3_u32 v23, v23, v7, s57
    s_mul_i32 s56, s56, 2176
    s_and_b32 s57, s3, 1
    s_lshl_b32 s57, s57, 7
    s_add_u32 s56, s56, s57
    s_add_u32 s56, s56, 122880
    v_add3_u32 v24, v24, v7, s56
    v_and_b32 v7, 1, v0
    v_lshl_add_u32 v24, v7, 6, v24
    v_and_b32 v7, 15, v0
    s_mul_i32 s56, s3, 272
    s_add_u32 s56, s56, 122880
    v_lshl_add_u32 v25, v7, 4, s56
    v_bfe_u32 v26, v0, 1, 4
    v_lshlrev_b32 v26, 4, v26
    s_mul_i32 s56, s3, 72
    v_add_u32 v7, s56, v0
    v_lshrrev_b32 v8, 4, v7
    v_lshlrev_b32 v27, 9, v8
    v_and_b32 v29, 15, v7
    v_lshl_add_u32 v27, v29, 4, v27
    v_and_b32 v29, 7, v7
    v_mul_u32_u24 v29, 1312, v29
    v_and_b32 v7, -8, v7
    v_add3_u32 v29, v29, v7, v13
    v_and_b32 v7, 7, v0
    v_add3_u32 v7, v7, s56, 64
    v_lshrrev_b32 v8, 4, v7
    v_lshlrev_b32 v28, 9, v8
    v_and_b32 v30, 15, v7
    v_lshl_add_u32 v28, v30, 4, v28
    v_and_b32 v30, 7, v7
    v_mul_u32_u24 v30, 1312, v30
    v_and_b32 v7, -8, v7
    v_add3_u32 v30, v30, v7, v13
    s_memrealtime s[8:9]
    s_waitcnt lgkmcnt(0)
    s_sub_u32 s8, s8, s30
    s_cmpk_ge_u32 s8, 2125
    s_cbranch_scc1 .ap_175
    s_waitcnt vmcnt(5)
    s_cmpk_ge_u32 s8, 2060
    s_cbranch_scc1 .ap_175
    s_waitcnt vmcnt(3)
    s_bitcmp1_b64 s[14:15], 60
    s_cbranch_scc0 1
    s_waitcnt vmcnt(2)
    s_cmpk_ge_u32 s8, 1985
    s_cbranch_scc1 .ap_175
    s_waitcnt vmcnt(1)
.ap_175:
    s_add_u32 s63, s69, 425984
    buffer_load_dwordx4 v[68:71], v2, s[44:47], s63 offen nt
    v_perm_b32 v112, v164, v160, s94
    v_perm_b32 v113, v172, v168, s94
    v_perm_b32 v114, v180, v176, s94
    v_perm_b32 v115, v188, v184, s94
    s_nop 1
    v_mfma_f32_16x16x32_bf16 v[128:131], v[96:99], v[112:115], 0
    v_perm_b32 v116, v164, v160, s95
    v_perm_b32 v117, v172, v168, s95
    v_perm_b32 v118, v180, v176, s95
    v_perm_b32 v119, v188, v184, s95
    s_nop 1
    v_mfma_f32_16x16x32_bf16 v[132:135], v[96:99], v[116:119], 0
    v_perm_b32 v120, v165, v161, s94
    v_perm_b32 v121, v173, v169, s94
    v_perm_b32 v122, v181, v177, s94
    v_perm_b32 v123, v189, v185, s94
    s_nop 1
    v_mfma_f32_16x16x32_bf16 v[136:139], v[96:99], v[120:123], 0
    v_perm_b32 v124, v165, v161, s95
    v_perm_b32 v125, v173, v169, s95
    v_perm_b32 v126, v181, v177, s95
    v_perm_b32 v127, v189, v185, s95
    s_nop 1
    v_mfma_f32_16x16x32_bf16 v[140:143], v[96:99], v[124:127], 0
    v_perm_b32 v112, v166, v162, s94
    v_perm_b32 v113, v174, v170, s94
    v_perm_b32 v114, v182, v178, s94
    v_perm_b32 v115, v190, v186, s94
    s_nop 1
    v_mfma_f32_16x16x32_bf16 v[144:147], v[96:99], v[112:115], 0
    v_perm_b32 v116, v166, v162, s95
    v_perm_b32 v117, v174, v170, s95
    v_perm_b32 v118, v182, v178, s95
    v_perm_b32 v119, v190, v186, s95
    s_nop 1
    v_mfma_f32_16x16x32_bf16 v[148:151], v[96:99], v[116:119], 0
    v_perm_b32 v120, v167, v163, s94
    v_perm_b32 v121, v175, v171, s94
    v_perm_b32 v122, v183, v179, s94
    v_perm_b32 v123, v191, v187, s94
    s_nop 1
    v_mfma_f32_16x16x32_bf16 v[152:155], v[96:99], v[120:123], 0
    v_perm_b32 v124, v167, v163, s95
    v_perm_b32 v125, v175, v171, s95
    v_perm_b32 v126, v183, v179, s95
    v_perm_b32 v127, v191, v187, s95
    s_nop 1
    v_mfma_f32_16x16x32_bf16 v[156:159], v[96:99], v[124:127], 0
    s_memrealtime s[8:9]
    s_waitcnt lgkmcnt(0)
    s_sub_u32 s8, s8, s30
    s_cmpk_ge_u32 s8, 2156
    s_nop 3
    s_cbranch_scc1 .ap_176
    s_waitcnt vmcnt(5)
    s_cmpk_ge_u32 s8, 2091
    s_cbranch_scc1 .ap_176
    s_waitcnt vmcnt(3)
    s_bitcmp1_b64 s[14:15], 61
    s_cbranch_scc0 1
    s_waitcnt vmcnt(2)
    s_cmpk_ge_u32 s8, 2016
    s_cbranch_scc1 .ap_176
    s_waitcnt vmcnt(1)
.ap_176:
    s_add_u32 s63, s69, 434176
    buffer_load_dwordx4 v[76:79], v2, s[44:47], s63 offen nt
    v_perm_b32 v112, v196, v192, s94
    v_perm_b32 v113, v204, v200, s94
    v_perm_b32 v114, v212, v208, s94
    v_perm_b32 v115, v220, v216, s94
    s_nop 1
    v_mfma_f32_16x16x32_bf16 v[128:131], v[100:103], v[112:115], v[128:131]
    v_perm_b32 v116, v196, v192, s95
    v_perm_b32 v117, v204, v200, s95
    v_perm_b32 v118, v212, v208, s95
    v_perm_b32 v119, v220, v216, s95
    s_nop 1
    v_mfma_f32_16x16x32_bf16 v[132:135], v[100:103], v[116:119], v[132:135]
    v_perm_b32 v120, v197, v193, s94
    v_perm_b32 v121, v205, v201, s94
    v_perm_b32 v122, v213, v209, s94
    v_perm_b32 v123, v221, v217, s94
    s_nop 1
    v_mfma_f32_16x16x32_bf16 v[136:139], v[100:103], v[120:123], v[136:139]
    v_perm_b32 v124, v197, v193, s95
    v_perm_b32 v125, v205, v201, s95
    v_perm_b32 v126, v213, v209, s95
    v_perm_b32 v127, v221, v217, s95
    s_nop 1
    v_mfma_f32_16x16x32_bf16 v[140:143], v[100:103], v[124:127], v[140:143]
    v_perm_b32 v112, v198, v194, s94
    v_perm_b32 v113, v206, v202, s94
    v_perm_b32 v114, v214, v210, s94
    v_perm_b32 v115, v222, v218, s94
    s_nop 1
    v_mfma_f32_16x16x32_bf16 v[144:147], v[100:103], v[112:115], v[144:147]
    v_perm_b32 v116, v198, v194, s95
    v_perm_b32 v117, v206, v202, s95
    v_perm_b32 v118, v214, v210, s95
    v_perm_b32 v119, v222, v218, s95
    s_nop 1
    v_mfma_f32_16x16x32_bf16 v[148:151], v[100:103], v[116:119], v[148:151]
    v_perm_b32 v120, v199, v195, s94
    v_perm_b32 v121, v207, v203, s94
    v_perm_b32 v122, v215, v211, s94
    v_perm_b32 v123, v223, v219, s94
    s_nop 1
    v_mfma_f32_16x16x32_bf16 v[152:155], v[100:103], v[120:123], v[152:155]
    v_perm_b32 v124, v199, v195, s95
    v_perm_b32 v125, v207, v203, s95
    v_perm_b32 v126, v215, v211, s95
    v_perm_b32 v127, v223, v219, s95
    s_nop 1
    v_mfma_f32_16x16x32_bf16 v[156:159], v[100:103], v[124:127], v[156:159]
    s_memrealtime s[8:9]
    s_waitcnt lgkmcnt(0)
    s_sub_u32 s8, s8, s30
    s_cmpk_ge_u32 s8, 2187
    s_nop 3
    s_cbranch_scc1 .ap_177
    s_waitcnt vmcnt(5)
    s_cmpk_ge_u32 s8, 2122
    s_cbranch_scc1 .ap_177
    s_waitcnt vmcnt(3)
    s_bitcmp1_b64 s[14:15], 62
    s_cbranch_scc0 1
    s_waitcnt vmcnt(2)
    s_cmpk_ge_u32 s8, 2047
    s_cbranch_scc1 .ap_177
    s_waitcnt vmcnt(1)
.ap_177:
    s_add_u32 s63, s69, 442368
    buffer_load_dwordx4 v[84:87], v2, s[44:47], s63 offen nt
    s_waitcnt vmcnt(7)
    v_perm_b32 v112, v228, v224, s94
    v_perm_b32 v113, v236, v232, s94
    v_perm_b32 v114, v244, v240, s94
    v_perm_b32 v115, v252, v248, s94
    s_nop 1
    v_mfma_f32_16x16x32_bf16 v[128:131], v[104:107], v[112:115], v[128:131]
    v_perm_b32 v116, v228, v224, s95
    v_perm_b32 v117, v236, v232, s95
    v_perm_b32 v118, v244, v240, s95
    v_perm_b32 v119, v252, v248, s95
    s_nop 1
    v_mfma_f32_16x16x32_bf16 v[132:135], v[104:107], v[116:119], v[132:135]
    v_perm_b32 v120, v229, v225, s94
    v_perm_b32 v121, v237, v233, s94
    v_perm_b32 v122, v245, v241, s94
    v_perm_b32 v123, v253, v249, s94
    s_nop 1
    v_mfma_f32_16x16x32_bf16 v[136:139], v[104:107], v[120:123], v[136:139]
    v_perm_b32 v124, v229, v225, s95
    v_perm_b32 v125, v237, v233, s95
    v_perm_b32 v126, v245, v241, s95
    v_perm_b32 v127, v253, v249, s95
    s_nop 1
    v_mfma_f32_16x16x32_bf16 v[140:143], v[104:107], v[124:127], v[140:143]
    v_perm_b32 v112, v230, v226, s94
    v_perm_b32 v113, v238, v234, s94
    v_perm_b32 v114, v246, v242, s94
    v_perm_b32 v115, v254, v250, s94
    s_nop 1
    v_mfma_f32_16x16x32_bf16 v[144:147], v[104:107], v[112:115], v[144:147]
    v_perm_b32 v116, v230, v226, s95
    v_perm_b32 v117, v238, v234, s95
    v_perm_b32 v118, v246, v242, s95
    v_perm_b32 v119, v254, v250, s95
    s_nop 1
    v_mfma_f32_16x16x32_bf16 v[148:151], v[104:107], v[116:119], v[148:151]
    v_perm_b32 v120, v231, v227, s94
    v_perm_b32 v121, v239, v235, s94
    v_perm_b32 v122, v247, v243, s94
    v_perm_b32 v123, v255, v251, s94
    s_nop 1
    v_mfma_f32_16x16x32_bf16 v[152:155], v[104:107], v[120:123], v[152:155]
    v_perm_b32 v124, v231, v227, s95
    v_perm_b32 v125, v239, v235, s95
    v_perm_b32 v126, v247, v243, s95
    v_perm_b32 v127, v255, v251, s95
    s_nop 1
    v_mfma_f32_16x16x32_bf16 v[156:159], v[104:107], v[124:127], v[156:159]
    s_memrealtime s[8:9]
    s_waitcnt lgkmcnt(0)
    s_sub_u32 s8, s8, s30
    s_cmpk_ge_u32 s8, 2218
    s_nop 3
    s_cbranch_scc1 .ap_178
    s_waitcnt vmcnt(5)
    s_cmpk_ge_u32 s8, 2153
    s_cbranch_scc1 .ap_178
    s_waitcnt vmcnt(3)
    s_bitcmp1_b64 s[14:15], 63
    s_cbranch_scc0 1
    s_waitcnt vmcnt(2)
    s_cmpk_ge_u32 s8, 2078
    s_cbranch_scc1 .ap_178
    s_waitcnt vmcnt(1)
.ap_178:
    s_add_u32 s63, s69, 450560
    buffer_load_dwordx4 v[92:95], v2, s[44:47], s63 offen nt
    s_setprio 0
    s_waitcnt vmcnt(6)
    v_perm_b32 v160, v44, v36, s94
    v_perm_b32 v164, v44, v36, s95
    v_perm_b32 v168, v45, v37, s94
    v_perm_b32 v172, v45, v37, s95
    v_perm_b32 v176, v46, v38, s94
    v_perm_b32 v180, v46, v38, s95
    v_perm_b32 v184, v47, v39, s94
    v_perm_b32 v188, v47, v39, s95
    s_waitcnt vmcnt(4)
    v_perm_b32 v161, v60, v52, s94
    v_perm_b32 v165, v60, v52, s95
    v_perm_b32 v169, v61, v53, s94
    v_perm_b32 v173, v61, v53, s95
    v_perm_b32 v177, v62, v54, s94
    v_perm_b32 v181, v62, v54, s95
    v_perm_b32 v185, v63, v55, s94
    v_perm_b32 v189, v63, v55, s95
    v_mfma_f32_16x16x16_bf16 v[128:131], v[108:109], v[160:161], v[128:131]
    v_mfma_f32_16x16x16_bf16 v[132:135], v[108:109], v[164:165], v[132:135]
    v_mfma_f32_16x16x16_bf16 v[136:139], v[108:109], v[168:169], v[136:139]
    v_mfma_f32_16x16x16_bf16 v[140:143], v[108:109], v[172:173], v[140:143]
    v_mfma_f32_16x16x16_bf16 v[144:147], v[108:109], v[176:177], v[144:147]
    v_mfma_f32_16x16x16_bf16 v[148:151], v[108:109], v[180:181], v[148:151]
    v_mfma_f32_16x16x16_bf16 v[152:155], v[108:109], v[184:185], v[152:155]
    v_mfma_f32_16x16x16_bf16 v[156:159], v[108:109], v[188:189], v[156:159]
    s_waitcnt vmcnt(2)
    v_perm_b32 v162, v76, v68, s94
    v_perm_b32 v166, v76, v68, s95
    v_perm_b32 v170, v77, v69, s94
    v_perm_b32 v174, v77, v69, s95
    v_perm_b32 v178, v78, v70, s94
    v_perm_b32 v182, v78, v70, s95
    v_perm_b32 v186, v79, v71, s94
    v_perm_b32 v190, v79, v71, s95
    s_lshl4_add_u32 s59, s67, s66
    s_lshl1_add_u32 s59, s59, s68
    s_lshl_b32 s59, s59, 9
    s_add_u32 s59, s59, 0x210000
    s_mov_b32 s60, 0x07060503
    s_mov_b32 s61, 0x07060502
    s_mov_b32 s62, 0x07060501
.Ltail_bc:
    s_waitcnt vmcnt(0)
    v_perm_b32 v163, v92, v84, s94
    v_perm_b32 v167, v92, v84, s95
    v_perm_b32 v171, v93, v85, s94
    v_perm_b32 v175, v93, v85, s95
    v_perm_b32 v179, v94, v86, s94
    v_perm_b32 v183, v94, v86, s95
    v_perm_b32 v187, v95, v87, s94
    v_perm_b32 v191, v95, v87, s95
    v_mfma_f32_16x16x16_bf16 v[128:131], v[110:111], v[162:163], v[128:131]
    v_mfma_f32_16x16x16_bf16 v[132:135], v[110:111], v[166:167], v[132:135]
    v_mfma_f32_16x16x16_bf16 v[136:139], v[110:111], v[170:171], v[136:139]
    v_mfma_f32_16x16x16_bf16 v[140:143], v[110:111], v[174:175], v[140:143]
    v_mfma_f32_16x16x16_bf16 v[144:147], v[110:111], v[178:179], v[144:147]
    v_mfma_f32_16x16x16_bf16 v[148:151], v[110:111], v[182:183], v[148:151]
    v_mfma_f32_16x16x16_bf16 v[152:155], v[110:111], v[186:187], v[152:155]
    v_mfma_f32_16x16x16_bf16 v[156:159], v[110:111], v[190:191], v[156:159]
    s_mov_b64 exec, 0xffffffff
    s_nop 0
    ds_write2_b32 v10, v128, v132 offset0:0 offset1:1
    s_nop 0
    ds_write2_b32 v10, v136, v140 offset0:2 offset1:3
    s_nop 0
    ds_write2_b32 v10, v144, v148 offset0:4 offset1:5
    s_nop 0
    ds_write2_b32 v10, v152, v156 offset0:6 offset1:7
    s_mov_b64 exec, -1
    s_lshl_b32 s32, s3, 10
    s_add_u32 m0, s32, 40960
    s_add_u32 s56, s101, 2949120
    buffer_load_dwordx4 v6, s[48:51], s56 offen nt lds
    s_add_u32 m0, s32, 49152
    s_add_u32 s56, s101, 3538944
    buffer_load_dwordx4 v6, s[48:51], s56 offen nt lds
    s_add_u32 m0, s32, 57344
    s_add_u32 s56, s101, 4128768
    buffer_load_dwordx4 v6, s[48:51], s56 offen nt lds
    s_waitcnt lgkmcnt(0)
    s_barrier
    s_cmp_lg_u32 s3, 7
    s_cbranch_scc1 .opub_179
    ds_read_b128 v[196:199], v9 offset:0
    ds_read_b128 v[200:203], v9 offset:1024
    ds_read_b128 v[204:207], v9 offset:2048
    ds_read_b128 v[208:211], v9 offset:3072
    ds_read_b128 v[212:215], v9 offset:4096
    ds_read_b128 v[216:219], v9 offset:5120
    ds_read_b128 v[220:223], v9 offset:6144
    ds_read_b128 v[224:227], v9 offset:7168
    s_waitcnt lgkmcnt(6)
    v_pk_add_f32 v[196:197], v[196:197], v[200:201]
    v_pk_add_f32 v[198:199], v[198:199], v[202:203]
    s_waitcnt lgkmcnt(4)
    v_pk_add_f32 v[204:205], v[204:205], v[208:209]
    v_pk_add_f32 v[206:207], v[206:207], v[210:211]
    v_pk_add_f32 v[196:197], v[196:197], v[204:205]
    v_pk_add_f32 v[198:199], v[198:199], v[206:207]
    s_waitcnt lgkmcnt(2)
    v_pk_add_f32 v[212:213], v[212:213], v[216:217]
    v_pk_add_f32 v[214:215], v[214:215], v[218:219]
    s_waitcnt lgkmcnt(0)
    v_pk_add_f32 v[220:221], v[220:221], v[224:225]
    v_pk_add_f32 v[222:223], v[222:223], v[226:227]
    v_pk_add_f32 v[212:213], v[212:213], v[220:221]
    v_pk_add_f32 v[214:215], v[214:215], v[222:223]
    v_pk_add_f32 v[196:197], v[196:197], v[212:213]
    v_pk_add_f32 v[198:199], v[198:199], v[214:215]
    v_perm_b32 v12, v196, v199, s60
    v_perm_b32 v13, v197, v199, s61
    v_perm_b32 v14, v198, v199, s62
    s_add_u32 s57, s59, 0xac000
    buffer_store_dwordx4 v[12:15], v11, s[36:39], s57 offen
    buffer_store_dwordx4 v[12:15], v11, s[36:39], s59 offen sc1
.opub_179:
    s_barrier
    s_bitcmp1_b32 s1, 0
    s_cbranch_scc1 .lt_180
    s_lshl_b32 s32, s3, 10
    s_add_u32 m0, s32, 0
    s_add_u32 s56, s101, 0
    buffer_load_dwordx4 v6, s[48:51], s56 offen nt lds
    s_add_u32 m0, s32, 8192
    s_add_u32 s56, s101, 589824
    buffer_load_dwordx4 v6, s[48:51], s56 offen nt lds
    s_add_u32 m0, s32, 16384
    s_add_u32 s56, s101, 1179648
    buffer_load_dwordx4 v6, s[48:51], s56 offen nt lds
    s_add_u32 m0, s32, 24576
    s_add_u32 s56, s101, 1769472
    buffer_load_dwordx4 v6, s[48:51], s56 offen nt lds
    s_add_u32 m0, s32, 32768
    s_add_u32 s56, s101, 2359296
    buffer_load_dwordx4 v6, s[48:51], s56 offen nt lds
.lt_180:
    s_lshl_b32 s32, s3, 10
    s_add_u32 m0, s32, 65536
    s_add_u32 s56, s101, 4718592
    buffer_load_dwordx4 v6, s[48:51], s56 offen nt lds
    s_add_u32 m0, s32, 73728
    s_add_u32 s56, s33, 0
    buffer_load_dwordx4 v31, s[52:55], s56 offen nt lds
    s_add_u32 m0, s32, 81920
    s_add_u32 s56, s33, 73728
    buffer_load_dwordx4 v31, s[52:55], s56 offen nt lds
    s_add_u32 m0, s32, 90112
    s_add_u32 s56, s33, 147456
    buffer_load_dwordx4 v31, s[52:55], s56 offen nt lds
    s_add_u32 m0, s32, 98304
    s_add_u32 s56, s33, 221184
    buffer_load_dwordx4 v31, s[52:55], s56 offen nt lds
    s_cmp_ge_u32 s3, 4
    s_cbranch_scc1 .nod_181
    s_add_u32 m0, s32, 106496
    s_add_u32 s56, s33, 294912
    buffer_load_dwordx4 v31, s[52:55], s56 offen nt lds
.nod_181:
    s_branch .gpc_183
.gp_182:
    buffer_load_dwordx4 v[32:35], v2, s[36:39], s99 offen offset:0 sc1
    buffer_load_dwordx4 v[40:43], v2, s[36:39], s99 offen offset:1024 sc1
    buffer_load_dwordx2 v[48:49], v5, s[36:39], s99 offen offset:0 sc1
    buffer_load_dwordx4 v[56:59], v2, s[36:39], s100 offen offset:0 sc1
    buffer_load_dwordx4 v[64:67], v2, s[36:39], s100 offen offset:1024 sc1
    buffer_load_dwordx2 v[50:51], v5, s[36:39], s100 offen offset:0 sc1
    s_waitcnt vmcnt(0)
.gpc_183:
    v_min_u32 v7, v33, v35
    v_max_u32 v8, v33, v35
    v_min3_u32 v7, v7, v41, v43
    v_max3_u32 v8, v8, v41, v43
    v_min3_u32 v7, v7, v49, v57
    v_max3_u32 v8, v8, v49, v57
    v_min3_u32 v7, v7, v59, v65
    v_max3_u32 v8, v8, v59, v65
    v_min3_u32 v7, v7, v67, v51
    v_max3_u32 v8, v8, v67, v51
    v_cmp_eq_u32 vcc, s34, v7
    v_cmp_eq_u32 s[56:57], s34, v8
    s_and_b64 vcc, vcc, s[56:57]
    s_cmp_eq_u64 vcc, exec
    s_nop 2
    s_cbranch_scc1 .gpd_184
    s_sub_u32 s35, s35, 1
    s_cbranch_scc1 .Lexit
    s_sleep 2
    s_branch .gp_182
.gpd_184:
    v_lshlrev_b32 v230, 16, v32
    v_and_b32 v231, 0xffff0000, v32
    v_lshlrev_b32 v240, 16, v56
    v_and_b32 v241, 0xffff0000, v56
    v_lshlrev_b32 v232, 16, v34
    v_and_b32 v233, 0xffff0000, v34
    v_lshlrev_b32 v242, 16, v58
    v_and_b32 v243, 0xffff0000, v58
    v_lshlrev_b32 v234, 16, v40
    v_and_b32 v235, 0xffff0000, v40
    v_lshlrev_b32 v244, 16, v64
    v_and_b32 v245, 0xffff0000, v64
    v_lshlrev_b32 v236, 16, v42
    v_and_b32 v237, 0xffff0000, v42
    v_lshlrev_b32 v246, 16, v66
    v_and_b32 v247, 0xffff0000, v66
    v_lshlrev_b32 v238, 16, v48
    v_and_b32 v239, 0xffff0000, v48
    v_lshlrev_b32 v248, 16, v50
    v_and_b32 v249, 0xffff0000, v50
    s_sub_u32 s63, s65, 9
    s_mul_i32 s42, s64, 18432
    s_mul_i32 s56, s3, 2304
    s_add_u32 s42, s42, s56
    s_add_u32 s42, s42, 0x250000
    s_mul_i32 s41, s64, 36864
    s_add_u32 s41, s41, 0x274000
    s_lshr_b32 s57, s63, 1
    s_lshl3_add_u32 s40, s57, s3
    s_and_b32 s63, s63, 1
    s_lshl1_add_u32 s40, s40, s63
    s_lshl_b32 s40, s40, 8
    s_add_u32 s40, s40, s41
    s_mul_i32 s56, s63, 18432
    s_add_u32 s41, s41, s56
    s_mul_i32 s43, s3, 9
    s_add_u32 s43, s43, s57
    s_lshl3_add_u32 s43, s43, s64
    s_lshl1_add_u32 s43, s43, s63
    s_lshl_b32 s43, s43, 8
    s_add_u32 s43, s43, 0x38c000
    v_mov_b32 v137, s34
    v_mov_b32 v139, s34
    v_mov_b32 v143, s34
    s_add_u32 s57, s40, 0xac000
    s_mov_b64 exec, 0xffff
    buffer_load_dwordx4 v[80:83], v2, s[36:39], s57 offen offset:0
    s_mov_b64 exec, -1
    s_waitcnt vmcnt(5)
    s_barrier
    ds_read_b64_tr_b16 v[160:161], v19 offset:0
    ds_read_b64_tr_b16 v[162:163], v19 offset:512
    ds_read_b64_tr_b16 v[164:165], v19 offset:8192
    ds_read_b64_tr_b16 v[166:167], v19 offset:8704
    ds_read_b64_tr_b16 v[168:169], v19 offset:16384
    ds_read_b64_tr_b16 v[170:171], v19 offset:16896
    ds_read_b64_tr_b16 v[172:173], v19 offset:24576
    ds_read_b64_tr_b16 v[174:175], v19 offset:25088
    ds_read_b64_tr_b16 v[176:177], v20 offset:0
    ds_read_b64_tr_b16 v[178:179], v20 offset:512
    ds_read_b64_tr_b16 v[180:181], v20 offset:8192
    ds_read_b64_tr_b16 v[182:183], v20 offset:8704
    ds_read_b64_tr_b16 v[184:185], v20 offset:16384
    ds_read_b64_tr_b16 v[186:187], v20 offset:16896
    ds_read_b64_tr_b16 v[188:189], v20 offset:24576
    ds_read_b64_tr_b16 v[190:191], v20 offset:25088
    ds_read_b64_tr_b16 v[192:193], v20 offset:32768
    ds_read_b64_tr_b16 v[194:195], v20 offset:33280
.Lbc_x:
    s_add_u32 s58, s42, s0
    s_lshl1_add_u32 s42, s42, 0xac000
    s_cmp_eq_u32 s0, 0
    s_cselect_b32 s32, 64, 0
    s_mov_b64 s[88:89], exec
    s_mov_b64 s[90:91], exec
    s_mov_b64 s[92:93], exec
.mp_185:
    s_mov_b64 exec, s[88:89]
    buffer_load_dwordx4 v[144:147], v2, s[36:39], s58 offen offset:0 sc1
    s_mov_b64 exec, s[90:91]
    buffer_load_dwordx4 v[148:151], v2, s[36:39], s58 offen offset:1024 sc1
    s_mov_b64 exec, s[92:93]
    buffer_load_dwordx2 v[152:153], v5, s[36:39], s58 offen offset:0 sc1
    s_mov_b64 exec, -1
    s_sub_u32 s35, s35, 1
    s_cbranch_scc1 .Lexit
    s_sub_u32 vcc_lo, s42, s58
    s_add_u32 s32, s32, 1
    s_cmp_ge_u32 s32, 64
    s_cselect_b32 s58, vcc_lo, s58
    s_waitcnt vmcnt(0)
.mpj_186:
    v_cmp_ne_u32 s[88:89], s34, v145
    v_cmp_ne_u32 vcc, s34, v147
    s_or_b64 s[88:89], s[88:89], vcc
    v_cmp_ne_u32 s[90:91], s34, v149
    v_cmp_ne_u32 vcc, s34, v151
    s_or_b64 s[90:91], s[90:91], vcc
    v_cmp_ne_u32 s[92:93], s34, v153
    s_or_b64 vcc, s[88:89], s[90:91]
    s_or_b64 vcc, vcc, s[92:93]
    s_cbranch_scc1 .mp_185
    s_mov_b32 s56, 0x3f803f80
    v_dot2_f32_bf16 v250, v144, s56, 0
    v_dot2_f32_bf16 v251, v144, v144, 0
    v_dot2_f32_bf16 v250, v146, s56, v250
    v_dot2_f32_bf16 v251, v146, v146, v251
    v_dot2_f32_bf16 v250, v148, s56, v250
    v_dot2_f32_bf16 v251, v148, v148, v251
    v_dot2_f32_bf16 v250, v150, s56, v250
    v_dot2_f32_bf16 v251, v150, v150, v251
    s_mov_b64 exec, 0xffffffff
    v_dot2_f32_bf16 v250, v152, s56, v250
    v_dot2_f32_bf16 v251, v152, v152, v251
    s_mov_b64 exec, -1
    s_nop 1
    v_permlane32_swap_b32 v250, v251
    v_add_f32 v250, v250, v251
    v_mov_b32 v252, v250
    s_nop 1
    v_permlane16_swap_b32 v252, v250
    v_add_f32 v250, v252, v250
    v_lshlrev_b32 v220, 16, v144
    v_and_b32 v221, 0xffff0000, v144
    v_add_f32_dpp v250, v250, v250 row_ror:8 row_mask:0xf bank_mask:0xf
    v_lshlrev_b32 v222, 16, v146
    v_and_b32 v223, 0xffff0000, v146
    v_add_f32_dpp v250, v250, v250 row_ror:4 row_mask:0xf bank_mask:0xf
    v_lshlrev_b32 v224, 16, v148
    v_and_b32 v225, 0xffff0000, v148
    v_add_f32_dpp v250, v250, v250 quad_perm:[2,3,0,1] row_mask:0xf bank_mask:0xf
    v_lshlrev_b32 v226, 16, v150
    v_and_b32 v227, 0xffff0000, v150
    v_add_f32_dpp v250, v250, v250 quad_perm:[1,0,3,2] row_mask:0xf bank_mask:0xf
    v_mul_f32 v250, 0x3ae38e39, v250
    v_lshlrev_b32 v228, 16, v152
    v_and_b32 v229, 0xffff0000, v152
    v_readlane_b32 s56, v250, 0
    v_readlane_b32 s57, v250, 32
    s_nop 0
    v_mov_b32 v250, s56
    v_fma_f32 v251, -v250, v250, s57
    v_max_f32 v251, 0, v251
    v_add_f32 v251, 0x3727c5ac, v251
    v_rsq_f32 v252, v251
    s_nop 0
    v_mul_f32 v251, -v250, v252
    v_mul_f32 v250, -v250, v252
    v_mov_b32 v253, v252
    v_pk_fma_f32 v[220:221], v[220:221], v[252:253], v[250:251]
    v_pk_fma_f32 v[222:223], v[222:223], v[252:253], v[250:251]
    v_pk_fma_f32 v[224:225], v[224:225], v[252:253], v[250:251]
    v_pk_fma_f32 v[226:227], v[226:227], v[252:253], v[250:251]
    v_pk_fma_f32 v[228:229], v[228:229], v[252:253], v[250:251]
    v_pk_fma_f32 v[220:221], v[220:221], v[240:241], v[230:231]
    v_pk_fma_f32 v[222:223], v[222:223], v[242:243], v[232:233]
    v_pk_fma_f32 v[224:225], v[224:225], v[244:245], v[234:235]
    v_pk_fma_f32 v[226:227], v[226:227], v[246:247], v[236:237]
    v_pk_fma_f32 v[228:229], v[228:229], v[248:249], v[238:239]
    v_cvt_pk_bf16_f32 v154, v220, v221
    v_cvt_pk_bf16_f32 v155, v222, v223
    v_cvt_pk_bf16_f32 v156, v224, v225
    v_cvt_pk_bf16_f32 v157, v226, v227
    v_cvt_pk_bf16_f32 v158, v228, v229
    ds_write_b64 v17, v[154:155]
    ds_write_b64 v17, v[156:157] offset:512
    ds_write_b32 v18, v158
    s_waitcnt lgkmcnt(0)
    s_barrier
    ds_read_b128 v[96:99], v16 offset:0
    ds_read_b128 v[100:103], v16 offset:128
    ds_read_b128 v[104:107], v16 offset:256
    ds_read_b128 v[108:111], v16 offset:384
    ds_read_b128 v[112:115], v16 offset:512
    ds_read_b128 v[116:119], v16 offset:640
    ds_read_b128 v[120:123], v16 offset:768
    ds_read_b128 v[124:127], v16 offset:896
    ds_read_b128 v[128:131], v16 offset:1024
    s_waitcnt lgkmcnt(8)
    v_mfma_f32_16x16x32_bf16 v[132:135], v[160:163], v[96:99], 0
    s_waitcnt lgkmcnt(7)
    v_mfma_f32_16x16x32_bf16 v[132:135], v[164:167], v[100:103], v[132:135]
    s_waitcnt lgkmcnt(6)
    v_mfma_f32_16x16x32_bf16 v[132:135], v[168:171], v[104:107], v[132:135]
    s_waitcnt lgkmcnt(5)
    v_mfma_f32_16x16x32_bf16 v[132:135], v[172:175], v[108:111], v[132:135]
    s_waitcnt lgkmcnt(4)
    v_mfma_f32_16x16x32_bf16 v[132:135], v[176:179], v[112:115], v[132:135]
    s_waitcnt lgkmcnt(3)
    v_mfma_f32_16x16x32_bf16 v[132:135], v[180:183], v[116:119], v[132:135]
    s_waitcnt lgkmcnt(2)
    v_mfma_f32_16x16x32_bf16 v[132:135], v[184:187], v[120:123], v[132:135]
    s_waitcnt lgkmcnt(1)
    v_mfma_f32_16x16x32_bf16 v[132:135], v[188:191], v[124:127], v[132:135]
    s_waitcnt lgkmcnt(0)
    v_mfma_f32_16x16x32_bf16 v[132:135], v[192:195], v[128:131], v[132:135]
    s_cmp_lg_u32 s63, 0
    s_nop 6
    v_permlane32_swap_b32 v132, v134
    v_permlane32_swap_b32 v133, v135
    v_cndmask_b32 v133, v133, v134, s[96:97]
    v_cndmask_b32 v132, v132, v135, s[96:97]
    s_nop 1
    v_add_f32_dpp v12, v133, v132 quad_perm:[1,0,3,2] row_mask:0xf bank_mask:0xf
    s_nop 1
    s_cbranch_scc1 .up_189
    v_mul_f32 v7, 0xbfb8aa3b, v12
    v_exp_f32 v7, v7
    s_nop 0
    v_add_f32 v7, 1.0, v7
    v_rcp_f32 v7, v7
    s_nop 0
    v_mul_f32 v12, v12, v7
.up_189:
    s_nop 1
    v_mov_b32_dpp v8, v12 quad_perm:[0,0,2,2] row_mask:0xf bank_mask:0xf
    v_mov_b32_dpp v9, v12 quad_perm:[1,1,3,3] row_mask:0xf bank_mask:0xf
    v_cvt_pk_bf16_f32 v136, v8, v9
    v_cvt_pk_bf16_f32 v138, v8, v9
    s_nop 1
    v_permlane32_swap_b32 v136, v138
    s_mov_b64 exec, 0x55555555
    s_add_u32 s57, s40, 0xac000
    buffer_store_dwordx4 v[136:139], v26, s[36:39], s57 offen
    s_cmp_lg_u32 s0, 0
    s_cbranch_scc1 2
    buffer_store_dwordx4 v[136:139], v26, s[36:39], s40 offen sc1
    s_mov_b64 exec, -1
    s_barrier
    ds_read_b64_tr_b16 v[196:197], v21 offset:0
    ds_read_b64_tr_b16 v[198:199], v21 offset:512
    ds_read_b64_tr_b16 v[208:209], v22 offset:0
    ds_read_b64_tr_b16 v[210:211], v22 offset:512
    ds_read_b64_tr_b16 v[200:201], v21 offset:4096
    ds_read_b64_tr_b16 v[202:203], v21 offset:4608
    ds_read_b64_tr_b16 v[212:213], v22 offset:4096
    ds_read_b64_tr_b16 v[214:215], v22 offset:4608
    ds_read_b64_tr_b16 v[204:205], v21 offset:8192
    ds_read_b64_tr_b16 v[206:207], v21 offset:8704
    ds_read_b64_tr_b16 v[216:217], v22 offset:8192
    ds_read_b64_tr_b16 v[218:219], v22 offset:8704
    s_add_u32 s58, s41, s0
    s_lshl1_add_u32 s41, s41, 0xac000
    s_cmp_eq_u32 s0, 0
    s_cselect_b32 s32, 64, 0
    s_mov_b64 s[88:89], exec
    s_mov_b64 s[90:91], exec
    s_and_b64 s[92:93], exec, 0xff
    s_and_b64 s[56:57], exec, 0xff
.mp_190:
    s_mov_b64 exec, s[88:89]
    buffer_load_dwordx4 v[160:163], v27, s[36:39], s58 offen offset:0 sc1
    s_mov_b64 exec, s[90:91]
    buffer_load_dwordx4 v[164:167], v27, s[36:39], s58 offen offset:256 sc1
    s_mov_b64 exec, s[92:93]
    buffer_load_dwordx4 v[168:171], v28, s[36:39], s58 offen offset:0 sc1
    s_mov_b64 exec, s[56:57]
    buffer_load_dwordx4 v[172:175], v28, s[36:39], s58 offen offset:256 sc1
    s_mov_b64 exec, -1
    s_sub_u32 s35, s35, 1
    s_cbranch_scc1 .Lexit
    s_sub_u32 vcc_lo, s41, s58
    s_add_u32 s32, s32, 1
    s_cmp_ge_u32 s32, 64
    s_cselect_b32 s58, vcc_lo, s58
    s_cmp_eq_u32 s32, 64
    s_cbranch_scc0 .mpi_192
    s_mov_b64 exec, 0x55555555
    buffer_store_dwordx4 v[136:139], v26, s[36:39], s40 offen sc1
    s_mov_b64 exec, -1
.mpi_192:
    s_waitcnt vmcnt(0)
.mpj_191:
    v_cmp_ne_u32 s[88:89], s34, v161
    v_cmp_ne_u32 vcc, s34, v163
    s_or_b64 s[88:89], s[88:89], vcc
    v_cmp_ne_u32 s[90:91], s34, v165
    v_cmp_ne_u32 vcc, s34, v167
    s_or_b64 s[90:91], s[90:91], vcc
    v_cmp_ne_u32 s[92:93], s34, v169
    v_cmp_ne_u32 vcc, s34, v171
    s_or_b64 s[92:93], s[92:93], vcc
    s_and_b64 s[92:93], s[92:93], 0xff
    v_cmp_ne_u32 s[56:57], s34, v173
    v_cmp_ne_u32 vcc, s34, v175
    s_or_b64 s[56:57], s[56:57], vcc
    s_and_b64 s[56:57], s[56:57], 0xff
    s_or_b64 vcc, s[88:89], s[90:91]
    s_or_b64 vcc, vcc, s[92:93]
    s_or_b64 vcc, vcc, s[56:57]
    s_cbranch_scc1 .mp_190
    v_and_b32 v161, 0xffff0000, v160
    v_lshlrev_b32 v160, 16, v160
    v_and_b32 v163, 0xffff0000, v162
    v_lshlrev_b32 v162, 16, v162
    v_and_b32 v165, 0xffff0000, v164
    v_lshlrev_b32 v164, 16, v164
    v_and_b32 v167, 0xffff0000, v166
    v_lshlrev_b32 v166, 16, v166
    v_and_b32 v169, 0xffff0000, v168
    v_lshlrev_b32 v168, 16, v168
    v_and_b32 v171, 0xffff0000, v170
    v_lshlrev_b32 v170, 16, v170
    v_and_b32 v173, 0xffff0000, v172
    v_lshlrev_b32 v172, 16, v172
    v_and_b32 v175, 0xffff0000, v174
    v_lshlrev_b32 v174, 16, v174
    v_pk_mul_f32 v[160:161], v[160:161], v[164:165]
    v_pk_mul_f32 v[162:163], v[162:163], v[166:167]
    v_pk_mul_f32 v[168:169], v[168:169], v[172:173]
    v_pk_mul_f32 v[170:171], v[170:171], v[174:175]
    v_cvt_pk_bf16_f32 v160, v160, v161
    v_cvt_pk_bf16_f32 v161, v162, v163
    v_cvt_pk_bf16_f32 v168, v168, v169
    v_cvt_pk_bf16_f32 v169, v170, v171
    ds_write_b64 v29, v[160:161]
    s_mov_b64 exec, 0xff
    ds_write_b64 v30, v[168:169]
    s_mov_b64 exec, -1
    s_waitcnt lgkmcnt(0)
    s_barrier
    s_cmp_ge_u32 s3, 6
    s_cbranch_scc1 .tg_194
    ds_read_b128 v[96:99], v23 offset:0
    ds_read_b128 v[100:103], v23 offset:64
    ds_read_b128 v[104:107], v23 offset:128
    s_waitcnt lgkmcnt(2)
    v_mfma_f32_16x16x32_bf16 v[132:135], v[196:199], v[96:99], 0
    v_mfma_f32_16x16x32_bf16 v[136:139], v[208:211], v[96:99], 0
    s_waitcnt lgkmcnt(1)
    v_mfma_f32_16x16x32_bf16 v[132:135], v[200:203], v[100:103], v[132:135]
    v_mfma_f32_16x16x32_bf16 v[136:139], v[212:215], v[100:103], v[136:139]
    s_waitcnt lgkmcnt(0)
    v_mfma_f32_16x16x32_bf16 v[132:135], v[204:207], v[104:107], v[132:135]
    v_mfma_f32_16x16x32_bf16 v[136:139], v[216:219], v[104:107], v[136:139]
    s_nop 7
    v_cndmask_b32 v132, v132, v136, s[96:97]
    v_cndmask_b32 v133, v133, v137, s[96:97]
    v_cndmask_b32 v134, v134, v138, s[96:97]
    v_cndmask_b32 v135, v135, v139, s[96:97]
    ds_write_b128 v24, v[132:135]
    s_waitcnt lgkmcnt(0)
.tg_194:
    s_barrier
    ds_read_b128 v[112:115], v25 offset:0
    ds_read_b128 v[116:119], v25 offset:2176
    ds_read_b128 v[120:123], v25 offset:4352
    s_mov_b32 s60, 0x07060503
    s_mov_b32 s61, 0x07060502
    s_mov_b32 s62, 0x07060501
    s_waitcnt lgkmcnt(1)
    v_pk_add_f32 v[112:113], v[112:113], v[116:117]
    v_pk_add_f32 v[114:115], v[114:115], v[118:119]
    s_waitcnt lgkmcnt(0)
    v_pk_add_f32 v[112:113], v[112:113], v[120:121]
    v_pk_add_f32 v[114:115], v[114:115], v[122:123]
    v_perm_b32 v140, v112, v115, s60
    v_perm_b32 v141, v113, v115, s61
    v_perm_b32 v142, v114, v115, s62
    s_mov_b64 exec, 0xffff
    buffer_store_dwordx4 v[140:143], v2, s[36:39], s43 offen sc1
    s_mov_b64 exec, -1
    s_nop 0
    s_branch .Lexit
.Latt_n:
    v_and_b32 v8, 1, v0
    v_lshlrev_b32 v8, 8, v8
    v_and_b32 v9, 0x3c, v0
    v_lshl_add_u32 v9, v9, 2, v8
    v_lshlrev_b32 v7, 1, v9
    v_and_b32 v9, 0x3c, v0
    v_lshrrev_b32 v8, 4, v8
    v_and_b32 v9, 2, v0
    v_lshl_add_u32 v9, v9, 6, v8
    s_lshl_b32 s58, s66, 14
    s_lshl_b32 s59, s67, 10
    s_add_u32 s58, s58, s59
    s_add_u32 s58, s58, 0x40000
    s_lshl4_add_u32 s59, s66, s67
    s_lshl_b32 s59, s59, 8
    s_add_u32 s59, s59, 0x200000
    s_memrealtime s[8:9]
    s_waitcnt vmcnt(8)
    s_waitcnt lgkmcnt(0)
    s_sub_u32 s8, s8, s30
    s_cmpk_ge_u32 s8, 1147
    s_cbranch_scc1 .ap_195
    s_waitcnt vmcnt(5)
    s_cmpk_ge_u32 s8, 1082
    s_cbranch_scc1 .ap_195
    s_waitcnt vmcnt(3)
    s_bitcmp1_b64 s[14:15], 26
    s_cbranch_scc0 1
    s_waitcnt vmcnt(2)
    s_cmpk_ge_u32 s8, 1007
    s_cbranch_scc1 .ap_195
    s_waitcnt vmcnt(1)
.ap_195:
    s_add_u32 s63, s69, 409600
    buffer_load_dwordx4 v[88:91], v1, s[40:43], s63 offen nt
    s_memrealtime s[8:9]
    s_waitcnt vmcnt(8)
    s_waitcnt lgkmcnt(0)
    s_sub_u32 s8, s8, s30
    s_cmpk_ge_u32 s8, 1174
    s_cbranch_scc1 .ap_196
    s_waitcnt vmcnt(5)
    s_cmpk_ge_u32 s8, 1109
    s_cbranch_scc1 .ap_196
    s_waitcnt vmcnt(3)
    s_bitcmp1_b64 s[14:15], 27
    s_cbranch_scc0 1
    s_waitcnt vmcnt(2)
    s_cmpk_ge_u32 s8, 1034
    s_cbranch_scc1 .ap_196
    s_waitcnt vmcnt(1)
.ap_196:
    s_add_u32 s63, s69, 417792
    buffer_load_dwordx4 v[92:95], v1, s[40:43], s63 offen nt
    s_memrealtime s[8:9]
    s_waitcnt vmcnt(8)
    s_waitcnt lgkmcnt(0)
    s_sub_u32 s8, s8, s30
    s_cmpk_ge_u32 s8, 1201
    s_cbranch_scc1 .ap_197
    s_waitcnt vmcnt(5)
    s_cmpk_ge_u32 s8, 1136
    s_cbranch_scc1 .ap_197
    s_waitcnt vmcnt(3)
    s_bitcmp1_b64 s[14:15], 28
    s_cbranch_scc0 1
    s_waitcnt vmcnt(2)
    s_cmpk_ge_u32 s8, 1061
    s_cbranch_scc1 .ap_197
    s_waitcnt vmcnt(1)
.ap_197:
    s_add_u32 s63, s69, 425984
    buffer_load_dwordx4 v[120:123], v1, s[40:43], s63 offen nt
    s_memrealtime s[8:9]
    s_waitcnt vmcnt(8)
    s_waitcnt lgkmcnt(0)
    s_sub_u32 s8, s8, s30
    s_cmpk_ge_u32 s8, 1228
    s_cbranch_scc1 .ap_198
    s_waitcnt vmcnt(5)
    s_cmpk_ge_u32 s8, 1163
    s_cbranch_scc1 .ap_198
    s_waitcnt vmcnt(3)
    s_bitcmp1_b64 s[14:15], 29
    s_cbranch_scc0 1
    s_waitcnt vmcnt(2)
    s_cmpk_ge_u32 s8, 1088
    s_cbranch_scc1 .ap_198
    s_waitcnt vmcnt(1)
.ap_198:
    s_add_u32 s63, s69, 434176
    buffer_load_dwordx4 v[124:127], v1, s[40:43], s63 offen nt
    s_memrealtime s[8:9]
    s_waitcnt vmcnt(8)
    s_waitcnt lgkmcnt(0)
    s_sub_u32 s8, s8, s30
    s_cmpk_ge_u32 s8, 1255
    s_cbranch_scc1 .ap_199
    s_waitcnt vmcnt(5)
    s_cmpk_ge_u32 s8, 1190
    s_cbranch_scc1 .ap_199
    s_waitcnt vmcnt(3)
    s_bitcmp1_b64 s[14:15], 30
    s_cbranch_scc0 1
    s_waitcnt vmcnt(2)
    s_cmpk_ge_u32 s8, 1115
    s_cbranch_scc1 .ap_199
    s_waitcnt vmcnt(1)
.ap_199:
    s_add_u32 s63, s69, 442368
    buffer_load_dwordx4 v[152:155], v1, s[40:43], s63 offen nt
    s_memrealtime s[8:9]
    s_waitcnt vmcnt(8)
    s_waitcnt lgkmcnt(0)
    s_sub_u32 s8, s8, s30
    s_cmpk_ge_u32 s8, 1282
    s_cbranch_scc1 .ap_200
    s_waitcnt vmcnt(5)
    s_cmpk_ge_u32 s8, 1217
    s_cbranch_scc1 .ap_200
    s_waitcnt vmcnt(3)
    s_bitcmp1_b64 s[14:15], 31
    s_cbranch_scc0 1
    s_waitcnt vmcnt(2)
    s_cmpk_ge_u32 s8, 1142
    s_cbranch_scc1 .ap_200
    s_waitcnt vmcnt(1)
.ap_200:
    s_add_u32 s63, s69, 450560
    buffer_load_dwordx4 v[156:159], v1, s[40:43], s63 offen nt
    buffer_load_dwordx4 v[16:19], v7, s[36:39], s58 offen offset:0 sc1
    buffer_load_dwordx4 v[20:23], v7, s[36:39], s58 offen offset:16 sc1
    s_memrealtime s[8:9]
    s_waitcnt vmcnt(8)
    s_waitcnt lgkmcnt(0)
    s_sub_u32 s8, s8, s30
    s_cmpk_ge_u32 s8, 1309
    s_cbranch_scc1 .ap_201
    s_waitcnt vmcnt(5)
    s_cmpk_ge_u32 s8, 1244
    s_cbranch_scc1 .ap_201
    s_waitcnt vmcnt(3)
    s_bitcmp1_b64 s[14:15], 32
    s_cbranch_scc0 1
    s_waitcnt vmcnt(2)
    s_cmpk_ge_u32 s8, 1169
    s_cbranch_scc1 .ap_201
    s_waitcnt vmcnt(1)
.ap_201:
    s_add_u32 s63, s69, 0
    buffer_load_dwordx4 v[160:163], v2, s[44:47], s63 offen nt
    s_memrealtime s[8:9]
    s_waitcnt vmcnt(8)
    s_waitcnt lgkmcnt(0)
    s_sub_u32 s8, s8, s30
    s_cmpk_ge_u32 s8, 1336
    s_cbranch_scc1 .ap_202
    s_waitcnt vmcnt(5)
    s_cmpk_ge_u32 s8, 1271
    s_cbranch_scc1 .ap_202
    s_waitcnt vmcnt(3)
    s_bitcmp1_b64 s[14:15], 33
    s_cbranch_scc0 1
    s_waitcnt vmcnt(2)
    s_cmpk_ge_u32 s8, 1196
    s_cbranch_scc1 .ap_202
    s_waitcnt vmcnt(1)
.ap_202:
    s_add_u32 s63, s69, 8192
    buffer_load_dwordx4 v[164:167], v2, s[44:47], s63 offen nt
    s_memrealtime s[8:9]
    s_waitcnt vmcnt(8)
    s_waitcnt lgkmcnt(0)
    s_sub_u32 s8, s8, s30
    s_cmpk_ge_u32 s8, 1363
    s_cbranch_scc1 .ap_203
    s_waitcnt vmcnt(5)
    s_cmpk_ge_u32 s8, 1298
    s_cbranch_scc1 .ap_203
    s_waitcnt vmcnt(3)
    s_bitcmp1_b64 s[14:15], 34
    s_cbranch_scc0 1
    s_waitcnt vmcnt(2)
    s_cmpk_ge_u32 s8, 1223
    s_cbranch_scc1 .ap_203
    s_waitcnt vmcnt(1)
.ap_203:
    s_add_u32 s63, s69, 16384
    buffer_load_dwordx4 v[168:171], v2, s[44:47], s63 offen nt
    s_waitcnt vmcnt(3)
    s_branch .gpc_205
.gp_204:
    buffer_load_dwordx4 v[16:19], v7, s[36:39], s58 offen offset:0 sc1
    buffer_load_dwordx4 v[20:23], v7, s[36:39], s58 offen offset:16 sc1
    s_waitcnt vmcnt(0)
.gpc_205:
    v_min_u32 v10, v17, v19
    v_max_u32 v11, v17, v19
    v_min3_u32 v10, v10, v21, v23
    v_max3_u32 v11, v11, v21, v23
    v_cmp_eq_u32 vcc, s34, v10
    v_cmp_eq_u32 s[56:57], s34, v11
    s_and_b64 vcc, vcc, s[56:57]
    s_cmp_eq_u64 vcc, exec
    s_nop 2
    s_cbranch_scc1 .gpd_206
    s_sub_u32 s35, s35, 1
    s_cbranch_scc1 .Lexit
    s_sleep 1
    s_branch .gp_204
.gpd_206:
    s_mov_b32 vcc_lo, 0xcccccccc
    s_mov_b32 vcc_hi, 0xcccccccc
    v_cndmask_b32_e64 v24, v16, 0, vcc
    v_cndmask_b32_e64 v25, v18, 0, vcc
    v_cndmask_b32_e64 v26, v20, 0, vcc
    v_cndmask_b32_e64 v27, v22, 0, vcc
    v_cndmask_b32_e32 v28, 0, v16, vcc
    v_cndmask_b32_e32 v29, 0, v18, vcc
    v_cndmask_b32_e32 v30, 0, v20, vcc
    v_cndmask_b32_e32 v31, 0, v22, vcc
    v_mfma_f32_16x16x32_bf16 v[16:19], v[32:35], v[24:27], 0
    v_mfma_f32_16x16x32_bf16 v[32:35], v[40:43], v[24:27], 0
    v_mfma_f32_16x16x32_bf16 v[16:19], v[36:39], v[28:31], v[16:19]
    v_mfma_f32_16x16x32_bf16 v[40:43], v[48:51], v[24:27], 0
    v_mfma_f32_16x16x32_bf16 v[32:35], v[44:47], v[28:31], v[32:35]
    v_mfma_f32_16x16x32_bf16 v[48:51], v[56:59], v[24:27], 0
    v_mfma_f32_16x16x32_bf16 v[40:43], v[52:55], v[28:31], v[40:43]
    v_mfma_f32_16x16x32_bf16 v[56:59], v[64:67], v[24:27], 0
    v_mfma_f32_16x16x32_bf16 v[48:51], v[60:63], v[28:31], v[48:51]
    s_nop 1
    v_add_f32_dpp v10, v17, v16 row_ror:12 row_mask:0xf bank_mask:0x1
    s_memrealtime s[8:9]
    s_waitcnt lgkmcnt(0)
    s_sub_u32 s8, s8, s30
    s_cmpk_ge_u32 s8, 1390
    s_nop 0
    s_cbranch_scc1 .ap_207
    s_waitcnt vmcnt(3)
    s_cmpk_ge_u32 s8, 1325
    s_cbranch_scc1 .ap_207
    s_waitcnt vmcnt(3)
    s_bitcmp1_b64 s[14:15], 35
    s_cbranch_scc0 1
    s_waitcnt vmcnt(2)
    s_cmpk_ge_u32 s8, 1250
    s_cbranch_scc1 .ap_207
    s_waitcnt vmcnt(1)
.ap_207:
    s_add_u32 s63, s69, 24576
    buffer_load_dwordx4 v[172:175], v2, s[44:47], s63 offen nt
    v_mfma_f32_16x16x32_bf16 v[64:67], v[72:75], v[24:27], 0
    v_mfma_f32_16x16x32_bf16 v[56:59], v[68:71], v[28:31], v[56:59]
    v_add_f32_dpp v11, v33, v32 row_ror:12 row_mask:0xf bank_mask:0x1
    v_add_f32_dpp v10, v18, v10 row_ror:8 row_mask:0xf bank_mask:0x1
    v_mfma_f32_16x16x32_bf16 v[72:75], v[80:83], v[24:27], 0
    v_mfma_f32_16x16x32_bf16 v[64:67], v[76:79], v[28:31], v[64:67]
    v_add_f32_dpp v12, v41, v40 row_ror:12 row_mask:0xf bank_mask:0x1
    v_add_f32_dpp v11, v34, v11 row_ror:8 row_mask:0xf bank_mask:0x1
    v_add_f32_dpp v10, v19, v10 row_ror:4 row_mask:0xf bank_mask:0x1
    v_mfma_f32_16x16x32_bf16 v[80:83], v[88:91], v[24:27], 0
    v_mfma_f32_16x16x32_bf16 v[72:75], v[84:87], v[28:31], v[72:75]
    v_add_f32_dpp v13, v49, v48 row_ror:12 row_mask:0xf bank_mask:0x1
    v_add_f32_dpp v12, v42, v12 row_ror:8 row_mask:0xf bank_mask:0x1
    v_add_f32_dpp v11, v35, v11 row_ror:4 row_mask:0xf bank_mask:0x1
    v_mfma_f32_16x16x32_bf16 v[88:91], v[96:99], v[24:27], 0
    v_mfma_f32_16x16x32_bf16 v[80:83], v[92:95], v[28:31], v[80:83]
    v_add_f32_dpp v10, v58, v57 row_ror:12 row_mask:0xf bank_mask:0x2
    v_add_f32_dpp v13, v50, v13 row_ror:8 row_mask:0xf bank_mask:0x1
    v_add_f32_dpp v12, v43, v12 row_ror:4 row_mask:0xf bank_mask:0x1
    s_memrealtime s[8:9]
    s_waitcnt lgkmcnt(0)
    s_sub_u32 s8, s8, s30
    s_cmpk_ge_u32 s8, 1417
    s_nop 0
    s_cbranch_scc1 .ap_208
    s_waitcnt vmcnt(4)
    s_cmpk_ge_u32 s8, 1352
    s_cbranch_scc1 .ap_208
    s_waitcnt vmcnt(3)
    s_bitcmp1_b64 s[14:15], 36
    s_cbranch_scc0 1
    s_waitcnt vmcnt(2)
    s_cmpk_ge_u32 s8, 1277
    s_cbranch_scc1 .ap_208
    s_waitcnt vmcnt(1)
.ap_208:
    s_add_u32 s63, s69, 32768
    buffer_load_dwordx4 v[176:179], v2, s[44:47], s63 offen nt
    v_mfma_f32_16x16x32_bf16 v[96:99], v[104:107], v[24:27], 0
    v_mfma_f32_16x16x32_bf16 v[88:91], v[100:103], v[28:31], v[88:91]
    v_add_f32_dpp v11, v66, v65 row_ror:12 row_mask:0xf bank_mask:0x2
    v_add_f32_dpp v10, v59, v10 row_ror:8 row_mask:0xf bank_mask:0x2
    v_add_f32_dpp v13, v51, v13 row_ror:4 row_mask:0xf bank_mask:0x1
    v_mfma_f32_16x16x32_bf16 v[104:107], v[112:115], v[24:27], 0
    v_mfma_f32_16x16x32_bf16 v[96:99], v[108:111], v[28:31], v[96:99]
    v_add_f32_dpp v12, v74, v73 row_ror:12 row_mask:0xf bank_mask:0x2
    v_add_f32_dpp v11, v67, v11 row_ror:8 row_mask:0xf bank_mask:0x2
    v_add_f32_dpp v10, v56, v10 row_ror:4 row_mask:0xf bank_mask:0x2
    v_mfma_f32_16x16x32_bf16 v[112:115], v[120:123], v[24:27], 0
    v_mfma_f32_16x16x32_bf16 v[104:107], v[116:119], v[28:31], v[104:107]
    v_add_f32_dpp v13, v82, v81 row_ror:12 row_mask:0xf bank_mask:0x2
    v_add_f32_dpp v12, v75, v12 row_ror:8 row_mask:0xf bank_mask:0x2
    v_add_f32_dpp v11, v64, v11 row_ror:4 row_mask:0xf bank_mask:0x2
    v_mfma_f32_16x16x32_bf16 v[120:123], v[128:131], v[24:27], 0
    v_mfma_f32_16x16x32_bf16 v[112:115], v[124:127], v[28:31], v[112:115]
    v_add_f32_dpp v10, v91, v90 row_ror:12 row_mask:0xf bank_mask:0x4
    v_add_f32_dpp v13, v83, v13 row_ror:8 row_mask:0xf bank_mask:0x2
    v_add_f32_dpp v12, v72, v12 row_ror:4 row_mask:0xf bank_mask:0x2
    s_memrealtime s[8:9]
    s_waitcnt lgkmcnt(0)
    s_sub_u32 s8, s8, s30
    s_cmpk_ge_u32 s8, 1444
    s_nop 0
    s_cbranch_scc1 .ap_209
    s_waitcnt vmcnt(5)
    s_cmpk_ge_u32 s8, 1379
    s_cbranch_scc1 .ap_209
    s_waitcnt vmcnt(3)
    s_bitcmp1_b64 s[14:15], 37
    s_cbranch_scc0 1
    s_waitcnt vmcnt(2)
    s_cmpk_ge_u32 s8, 1304
    s_cbranch_scc1 .ap_209
    s_waitcnt vmcnt(1)
.ap_209:
    s_add_u32 s63, s69, 40960
    buffer_load_dwordx4 v[180:183], v2, s[44:47], s63 offen nt
    v_mfma_f32_16x16x32_bf16 v[128:131], v[136:139], v[24:27], 0
    v_mfma_f32_16x16x32_bf16 v[120:123], v[132:135], v[28:31], v[120:123]
    v_add_f32_dpp v11, v99, v98 row_ror:12 row_mask:0xf bank_mask:0x4
    v_add_f32_dpp v10, v88, v10 row_ror:8 row_mask:0xf bank_mask:0x4
    v_add_f32_dpp v13, v80, v13 row_ror:4 row_mask:0xf bank_mask:0x2
    v_mfma_f32_16x16x32_bf16 v[136:139], v[144:147], v[24:27], 0
    v_mfma_f32_16x16x32_bf16 v[128:131], v[140:143], v[28:31], v[128:131]
    v_add_f32_dpp v12, v107, v106 row_ror:12 row_mask:0xf bank_mask:0x4
    v_add_f32_dpp v11, v96, v11 row_ror:8 row_mask:0xf bank_mask:0x4
    v_add_f32_dpp v10, v89, v10 row_ror:4 row_mask:0xf bank_mask:0x4
    v_mfma_f32_16x16x32_bf16 v[144:147], v[152:155], v[24:27], 0
    v_mfma_f32_16x16x32_bf16 v[136:139], v[148:151], v[28:31], v[136:139]
    v_add_f32_dpp v13, v115, v114 row_ror:12 row_mask:0xf bank_mask:0x4
    v_add_f32_dpp v12, v104, v12 row_ror:8 row_mask:0xf bank_mask:0x4
    v_add_f32_dpp v11, v97, v11 row_ror:4 row_mask:0xf bank_mask:0x4
    v_mfma_f32_16x16x32_bf16 v[144:147], v[156:159], v[28:31], v[144:147]
    v_add_f32_dpp v10, v120, v123 row_ror:12 row_mask:0xf bank_mask:0x8
    v_add_f32_dpp v13, v112, v13 row_ror:8 row_mask:0xf bank_mask:0x4
    v_add_f32_dpp v12, v105, v12 row_ror:4 row_mask:0xf bank_mask:0x4
    s_memrealtime s[8:9]
    s_waitcnt lgkmcnt(0)
    s_sub_u32 s8, s8, s30
    s_cmpk_ge_u32 s8, 1471
    s_nop 0
    s_cbranch_scc1 .ap_210
    s_waitcnt vmcnt(5)
    s_cmpk_ge_u32 s8, 1406
    s_cbranch_scc1 .ap_210
    s_waitcnt vmcnt(3)
    s_bitcmp1_b64 s[14:15], 38
    s_cbranch_scc0 1
    s_waitcnt vmcnt(2)
    s_cmpk_ge_u32 s8, 1331
    s_cbranch_scc1 .ap_210
    s_waitcnt vmcnt(1)
.ap_210:
    s_add_u32 s63, s69, 49152
    buffer_load_dwordx4 v[184:187], v2, s[44:47], s63 offen nt
    v_add_f32_dpp v11, v128, v131 row_ror:12 row_mask:0xf bank_mask:0x8
    v_add_f32_dpp v10, v121, v10 row_ror:8 row_mask:0xf bank_mask:0x8
    v_add_f32_dpp v13, v113, v13 row_ror:4 row_mask:0xf bank_mask:0x4
    v_add_f32_dpp v12, v136, v139 row_ror:12 row_mask:0xf bank_mask:0x8
    v_add_f32_dpp v11, v129, v11 row_ror:8 row_mask:0xf bank_mask:0x8
    v_add_f32_dpp v10, v122, v10 row_ror:4 row_mask:0xf bank_mask:0x8
    v_add_f32_dpp v13, v144, v147 row_ror:12 row_mask:0xf bank_mask:0x8
    v_add_f32_dpp v12, v137, v12 row_ror:8 row_mask:0xf bank_mask:0x8
    v_add_f32_dpp v11, v130, v11 row_ror:4 row_mask:0xf bank_mask:0x8
    v_add_f32_dpp v13, v145, v13 row_ror:8 row_mask:0xf bank_mask:0x8
    v_add_f32_dpp v12, v138, v12 row_ror:4 row_mask:0xf bank_mask:0x8
    s_memrealtime s[8:9]
    s_waitcnt lgkmcnt(0)
    s_sub_u32 s8, s8, s30
    s_cmpk_ge_u32 s8, 1498
    s_cbranch_scc1 .ap_211
    s_waitcnt vmcnt(5)
    s_cmpk_ge_u32 s8, 1433
    s_cbranch_scc1 .ap_211
    s_waitcnt vmcnt(3)
    s_bitcmp1_b64 s[14:15], 39
    s_cbranch_scc0 1
    s_waitcnt vmcnt(2)
    s_cmpk_ge_u32 s8, 1358
    s_cbranch_scc1 .ap_211
    s_waitcnt vmcnt(1)
.ap_211:
    s_add_u32 s63, s69, 57344
    buffer_load_dwordx4 v[188:191], v2, s[44:47], s63 offen nt
    v_add_f32_dpp v13, v146, v13 row_ror:4 row_mask:0xf bank_mask:0x8
    s_mov_b32 s60, 0x3db504f3
    s_mov_b32 s61, 0x3db504f3
    v_cvt_pk_bf16_f32 v10, 0, v10
    v_cvt_pk_bf16_f32 v11, 0, v11
    v_cvt_pk_bf16_f32 v12, 0, v12
    v_cvt_pk_bf16_f32 v13, 0, v13
    v_pk_mul_f32 v[10:11], v[10:11], s[60:61]
    v_pk_mul_f32 v[12:13], v[12:13], s[60:61]
    v_cvt_pk_bf16_f32 v10, 0, v10
    v_cvt_pk_bf16_f32 v11, 0, v11
    v_cvt_pk_bf16_f32 v12, 0, v12
    v_cvt_pk_bf16_f32 v13, 0, v13
    v_max_f32 v14, v10, v11
    v_max3_f32 v14, v14, v12, v13
    s_mov_b32 s60, 0x3fb8aa3b
    v_mov_b32 v22, s34
    v_mov_b32 v23, s34
    v_max_f32_dpp v14, v14, v14 quad_perm:[2,3,0,1] row_mask:0xf bank_mask:0xf
    s_nop 1
    v_max_f32_dpp v14, v14, v14 row_ror:4 row_mask:0xf bank_mask:0xf
    s_nop 1
    v_max_f32_dpp v14, v14, v14 row_ror:8 row_mask:0xf bank_mask:0xf
    v_mov_b32 v15, v14
    s_nop 1
    v_permlane16_swap_b32 v15, v14
    v_max_f32 v14, v15, v14
    v_mov_b32 v15, v14
    s_nop 1
    v_permlane32_swap_b32 v15, v14
    v_max_f32 v14, v15, v14
    v_mul_f32 v15, 0xbfb8aa3b, v14
    v_fma_f32 v10, v10, s60, v15
    v_fma_f32 v11, v11, s60, v15
    v_fma_f32 v12, v12, s60, v15
    v_fma_f32 v13, v13, s60, v15
    v_exp_f32 v10, v10
    v_exp_f32 v11, v11
    v_exp_f32 v12, v12
    v_exp_f32 v13, v13
    v_mov_b32 v20, v14
    v_pk_add_f32 v[16:17], v[10:11], v[12:13]
    v_add_f32 v21, v16, v17
    s_lshl3_add_u32 s60, s68, s3
    s_lshl_b32 s60, s60, 5
    s_add_u32 s60, s60, s59
    v_add_f32_dpp v21, v21, v21 quad_perm:[2,3,0,1] row_mask:0xf bank_mask:0xf
    s_nop 1
    v_add_f32_dpp v21, v21, v21 row_ror:4 row_mask:0xf bank_mask:0xf
    s_nop 1
    v_add_f32_dpp v21, v21, v21 row_ror:8 row_mask:0xf bank_mask:0xf
    v_mov_b32 v15, v21
    s_nop 1
    v_permlane16_swap_b32 v15, v21
    v_add_f32 v21, v15, v21
    v_mov_b32 v15, v21
    s_nop 1
    v_permlane32_swap_b32 v15, v21
    v_add_f32 v21, v15, v21
    s_lshl_b32 s60, s3, 4
    s_add_u32 s60, s60, 159104
    v_add_u32 v16, s60, v3
    v_mov_b32 v17, 159232
    v_mov_b32 v18, 1
    s_mov_b64 exec, 3
    ds_write_b64 v16, v[20:21]
    s_mov_b64 exec, 1
    s_waitcnt lgkmcnt(0)
    ds_add_rtn_u32 v18, v17, v18
    s_mov_b64 exec, -1
    v_and_b32 v16, 0x78, v3
    v_add_u32 v16, 159104, v16
    s_waitcnt lgkmcnt(0)
    v_readfirstlane_b32 s60, v18
    s_cmp_lg_u32 s60, 7
    s_nop 3
    s_cbranch_scc1 .ml_212
    ds_read_b64 v[18:19], v16
    s_lshl_b32 s60, s68, 7
    s_add_u32 s60, s60, s59
    s_waitcnt lgkmcnt(0)
    v_mov_b32 v20, v18
    s_nop 1
    v_max_f32_dpp v20, v20, v20 quad_perm:[2,3,0,1] row_mask:0xf bank_mask:0xf
    s_nop 1
    v_max_f32_dpp v20, v20, v20 row_ror:4 row_mask:0xf bank_mask:0xf
    s_nop 1
    v_max_f32_dpp v20, v20, v20 row_ror:8 row_mask:0xf bank_mask:0xf
    v_sub_f32 v18, v18, v20
    v_mul_f32 v18, 0x3fb8aa3b, v18
    v_exp_f32 v18, v18
    s_nop 0
    v_mul_f32 v21, v18, v19
    s_nop 1
    v_add_f32_dpp v21, v21, v21 quad_perm:[2,3,0,1] row_mask:0xf bank_mask:0xf
    s_nop 1
    v_add_f32_dpp v21, v21, v21 row_ror:4 row_mask:0xf bank_mask:0xf
    s_nop 1
    v_add_f32_dpp v21, v21, v21 row_ror:8 row_mask:0xf bank_mask:0xf
    s_mov_b64 exec, 0xff
    buffer_store_dwordx4 v[20:23], v2, s[36:39], s60 offen sc1
    s_mov_b64 exec, -1
.ml_212:
    s_memrealtime s[8:9]
    s_waitcnt lgkmcnt(0)
    s_sub_u32 s8, s8, s30
    s_cmpk_ge_u32 s8, 1525
    s_cbranch_scc1 .ap_213
    s_waitcnt vmcnt(5)
    s_cmpk_ge_u32 s8, 1460
    s_cbranch_scc1 .ap_213
    s_waitcnt vmcnt(3)
    s_bitcmp1_b64 s[14:15], 40
    s_cbranch_scc0 1
    s_waitcnt vmcnt(2)
    s_cmpk_ge_u32 s8, 1385
    s_cbranch_scc1 .ap_213
    s_waitcnt vmcnt(1)
.ap_213:
    s_add_u32 s63, s69, 131072
    buffer_load_dwordx4 v[192:195], v2, s[44:47], s63 offen nt
    s_memrealtime s[8:9]
    s_waitcnt vmcnt(8)
    s_waitcnt lgkmcnt(0)
    s_sub_u32 s8, s8, s30
    s_cmpk_ge_u32 s8, 1552
    s_cbranch_scc1 .ap_214
    s_waitcnt vmcnt(5)
    s_cmpk_ge_u32 s8, 1487
    s_cbranch_scc1 .ap_214
    s_waitcnt vmcnt(3)
    s_bitcmp1_b64 s[14:15], 41
    s_cbranch_scc0 1
    s_waitcnt vmcnt(2)
    s_cmpk_ge_u32 s8, 1412
    s_cbranch_scc1 .ap_214
    s_waitcnt vmcnt(1)
.ap_214:
    s_add_u32 s63, s69, 139264
    buffer_load_dwordx4 v[196:199], v2, s[44:47], s63 offen nt
    s_memrealtime s[8:9]
    s_waitcnt vmcnt(8)
    s_waitcnt lgkmcnt(0)
    s_sub_u32 s8, s8, s30
    s_cmpk_ge_u32 s8, 1579
    s_cbranch_scc1 .ap_215
    s_waitcnt vmcnt(5)
    s_cmpk_ge_u32 s8, 1514
    s_cbranch_scc1 .ap_215
    s_waitcnt vmcnt(3)
    s_bitcmp1_b64 s[14:15], 42
    s_cbranch_scc0 1
    s_waitcnt vmcnt(2)
    s_cmpk_ge_u32 s8, 1439
    s_cbranch_scc1 .ap_215
    s_waitcnt vmcnt(1)
.ap_215:
    s_add_u32 s63, s69, 147456
    buffer_load_dwordx4 v[200:203], v2, s[44:47], s63 offen nt
    s_memrealtime s[8:9]
    s_waitcnt vmcnt(8)
    s_waitcnt lgkmcnt(0)
    s_sub_u32 s8, s8, s30
    s_cmpk_ge_u32 s8, 1606
    s_cbranch_scc1 .ap_216
    s_waitcnt vmcnt(5)
    s_cmpk_ge_u32 s8, 1541
    s_cbranch_scc1 .ap_216
    s_waitcnt vmcnt(3)
    s_bitcmp1_b64 s[14:15], 43
    s_cbranch_scc0 1
    s_waitcnt vmcnt(2)
    s_cmpk_ge_u32 s8, 1466
    s_cbranch_scc1 .ap_216
    s_waitcnt vmcnt(1)
.ap_216:
    s_add_u32 s63, s69, 155648
    buffer_load_dwordx4 v[204:207], v2, s[44:47], s63 offen nt
    s_memrealtime s[8:9]
    s_waitcnt vmcnt(8)
    s_waitcnt lgkmcnt(0)
    s_sub_u32 s8, s8, s30
    s_cmpk_ge_u32 s8, 1633
    s_cbranch_scc1 .ap_217
    s_waitcnt vmcnt(5)
    s_cmpk_ge_u32 s8, 1568
    s_cbranch_scc1 .ap_217
    s_waitcnt vmcnt(3)
    s_bitcmp1_b64 s[14:15], 44
    s_cbranch_scc0 1
    s_waitcnt vmcnt(2)
    s_cmpk_ge_u32 s8, 1493
    s_cbranch_scc1 .ap_217
    s_waitcnt vmcnt(1)
.ap_217:
    s_add_u32 s63, s69, 163840
    buffer_load_dwordx4 v[208:211], v2, s[44:47], s63 offen nt
    s_memrealtime s[8:9]
    s_waitcnt vmcnt(8)
    s_waitcnt lgkmcnt(0)
    s_sub_u32 s8, s8, s30
    s_cmpk_ge_u32 s8, 1660
    s_cbranch_scc1 .ap_218
    s_waitcnt vmcnt(5)
    s_cmpk_ge_u32 s8, 1595
    s_cbranch_scc1 .ap_218
    s_waitcnt vmcnt(3)
    s_bitcmp1_b64 s[14:15], 45
    s_cbranch_scc0 1
    s_waitcnt vmcnt(2)
    s_cmpk_ge_u32 s8, 1520
    s_cbranch_scc1 .ap_218
    s_waitcnt vmcnt(1)
.ap_218:
    s_add_u32 s63, s69, 172032
    buffer_load_dwordx4 v[212:215], v2, s[44:47], s63 offen nt
    s_memrealtime s[8:9]
    s_waitcnt vmcnt(8)
    s_waitcnt lgkmcnt(0)
    s_sub_u32 s8, s8, s30
    s_cmpk_ge_u32 s8, 1691
    s_cbranch_scc1 .ap_219
    s_waitcnt vmcnt(5)
    s_cmpk_ge_u32 s8, 1626
    s_cbranch_scc1 .ap_219
    s_waitcnt vmcnt(3)
    s_bitcmp1_b64 s[14:15], 46
    s_cbranch_scc0 1
    s_waitcnt vmcnt(2)
    s_cmpk_ge_u32 s8, 1551
    s_cbranch_scc1 .ap_219
    s_waitcnt vmcnt(1)
.ap_219:
    s_add_u32 s63, s69, 180224
    buffer_load_dwordx4 v[216:219], v2, s[44:47], s63 offen nt
    s_memrealtime s[8:9]
    s_waitcnt vmcnt(8)
    s_waitcnt lgkmcnt(0)
    s_sub_u32 s8, s8, s30
    s_cmpk_ge_u32 s8, 1722
    s_cbranch_scc1 .ap_220
    s_waitcnt vmcnt(5)
    s_cmpk_ge_u32 s8, 1657
    s_cbranch_scc1 .ap_220
    s_waitcnt vmcnt(3)
    s_bitcmp1_b64 s[14:15], 47
    s_cbranch_scc0 1
    s_waitcnt vmcnt(2)
    s_cmpk_ge_u32 s8, 1582
    s_cbranch_scc1 .ap_220
    s_waitcnt vmcnt(1)
.ap_220:
    s_add_u32 s63, s69, 188416
    buffer_load_dwordx4 v[220:223], v2, s[44:47], s63 offen nt
    s_memrealtime s[8:9]
    s_waitcnt vmcnt(8)
    s_waitcnt lgkmcnt(0)
    s_sub_u32 s8, s8, s30
    s_cmpk_ge_u32 s8, 1753
    s_cbranch_scc1 .ap_221
    s_waitcnt vmcnt(5)
    s_cmpk_ge_u32 s8, 1688
    s_cbranch_scc1 .ap_221
    s_waitcnt vmcnt(3)
    s_bitcmp1_b64 s[14:15], 48
    s_cbranch_scc0 1
    s_waitcnt vmcnt(2)
    s_cmpk_ge_u32 s8, 1613
    s_cbranch_scc1 .ap_221
    s_waitcnt vmcnt(1)
.ap_221:
    s_add_u32 s63, s69, 262144
    buffer_load_dwordx4 v[224:227], v2, s[44:47], s63 offen nt
    s_memrealtime s[8:9]
    s_waitcnt vmcnt(8)
    s_waitcnt lgkmcnt(0)
    s_sub_u32 s8, s8, s30
    s_cmpk_ge_u32 s8, 1784
    s_cbranch_scc1 .ap_222
    s_waitcnt vmcnt(5)
    s_cmpk_ge_u32 s8, 1719
    s_cbranch_scc1 .ap_222
    s_waitcnt vmcnt(3)
    s_bitcmp1_b64 s[14:15], 49
    s_cbranch_scc0 1
    s_waitcnt vmcnt(2)
    s_cmpk_ge_u32 s8, 1644
    s_cbranch_scc1 .ap_222
    s_waitcnt vmcnt(1)
.ap_222:
    s_add_u32 s63, s69, 270336
    buffer_load_dwordx4 v[228:231], v2, s[44:47], s63 offen nt
    s_memrealtime s[8:9]
    s_waitcnt vmcnt(8)
    s_waitcnt lgkmcnt(0)
    s_sub_u32 s8, s8, s30
    s_cmpk_ge_u32 s8, 1815
    s_cbranch_scc1 .ap_223
    s_waitcnt vmcnt(5)
    s_cmpk_ge_u32 s8, 1750
    s_cbranch_scc1 .ap_223
    s_waitcnt vmcnt(3)
    s_bitcmp1_b64 s[14:15], 50
    s_cbranch_scc0 1
    s_waitcnt vmcnt(2)
    s_cmpk_ge_u32 s8, 1675
    s_cbranch_scc1 .ap_223
    s_waitcnt vmcnt(1)
.ap_223:
    s_add_u32 s63, s69, 278528
    buffer_load_dwordx4 v[232:235], v2, s[44:47], s63 offen nt
    s_memrealtime s[8:9]
    s_waitcnt vmcnt(8)
    s_waitcnt lgkmcnt(0)
    s_sub_u32 s8, s8, s30
    s_cmpk_ge_u32 s8, 1846
    s_cbranch_scc1 .ap_224
    s_waitcnt vmcnt(5)
    s_cmpk_ge_u32 s8, 1781
    s_cbranch_scc1 .ap_224
    s_waitcnt vmcnt(3)
    s_bitcmp1_b64 s[14:15], 51
    s_cbranch_scc0 1
    s_waitcnt vmcnt(2)
    s_cmpk_ge_u32 s8, 1706
    s_cbranch_scc1 .ap_224
    s_waitcnt vmcnt(1)
.ap_224:
    s_add_u32 s63, s69, 286720
    buffer_load_dwordx4 v[236:239], v2, s[44:47], s63 offen nt
    s_memrealtime s[8:9]
    s_waitcnt vmcnt(8)
    s_waitcnt lgkmcnt(0)
    s_sub_u32 s8, s8, s30
    s_cmpk_ge_u32 s8, 1877
    s_cbranch_scc1 .ap_225
    s_waitcnt vmcnt(5)
    s_cmpk_ge_u32 s8, 1812
    s_cbranch_scc1 .ap_225
    s_waitcnt vmcnt(3)
    s_bitcmp1_b64 s[14:15], 52
    s_cbranch_scc0 1
    s_waitcnt vmcnt(2)
    s_cmpk_ge_u32 s8, 1737
    s_cbranch_scc1 .ap_225
    s_waitcnt vmcnt(1)
.ap_225:
    s_add_u32 s63, s69, 294912
    buffer_load_dwordx4 v[240:243], v2, s[44:47], s63 offen nt
    s_memrealtime s[8:9]
    s_waitcnt vmcnt(8)
    s_waitcnt lgkmcnt(0)
    s_sub_u32 s8, s8, s30
    s_cmpk_ge_u32 s8, 1908
    s_cbranch_scc1 .ap_226
    s_waitcnt vmcnt(5)
    s_cmpk_ge_u32 s8, 1843
    s_cbranch_scc1 .ap_226
    s_waitcnt vmcnt(3)
    s_bitcmp1_b64 s[14:15], 53
    s_cbranch_scc0 1
    s_waitcnt vmcnt(2)
    s_cmpk_ge_u32 s8, 1768
    s_cbranch_scc1 .ap_226
    s_waitcnt vmcnt(1)
.ap_226:
    s_add_u32 s63, s69, 303104
    buffer_load_dwordx4 v[244:247], v2, s[44:47], s63 offen nt
    s_load_dwordx2 s[88:89], s[6:7], s0
    buffer_load_dwordx4 v[24:27], v9, s[36:39], s59 offen offset:0 sc1
    s_memrealtime s[8:9]
    s_waitcnt vmcnt(8)
    s_waitcnt lgkmcnt(0)
    s_sub_u32 s8, s8, s30
    s_cmpk_ge_u32 s8, 1939
    s_cbranch_scc1 .ap_227
    s_waitcnt vmcnt(5)
    s_cmpk_ge_u32 s8, 1874
    s_cbranch_scc1 .ap_227
    s_waitcnt vmcnt(3)
    s_bitcmp1_b64 s[14:15], 54
    s_cbranch_scc0 1
    s_waitcnt vmcnt(2)
    s_cmpk_ge_u32 s8, 1799
    s_cbranch_scc1 .ap_227
    s_waitcnt vmcnt(1)
.ap_227:
    s_add_u32 s63, s69, 311296
    buffer_load_dwordx4 v[248:251], v2, s[44:47], s63 offen nt
    s_sub_u32 s56, s65, 27
    s_lshl3_add_u32 s56, s56, s3
    s_cmp_ge_u32 s56, 11
    s_cbranch_scc1 .cpf_228
    s_getpc_b64 s[8:9]
.Lcpf_pc:
    s_cmp_ge_u32 s56, 6
    s_mov_b32 s57, .Lcpf_pc-.Ltail_ar
    s_cselect_b32 s57, .Lcpf_pc-.Ltail_bc+6144, s57
    s_lshl_b32 s56, s56, 10
    s_sub_u32 s56, s57, s56
    s_sub_u32 s8, s8, s56
    s_subb_u32 s9, s9, 0
    v_mov_b32 v41, s9
    v_add_co_u32 v40, vcc, s8, v2
    s_nop 1
    v_addc_co_u32 v41, vcc, 0, v41, vcc
    global_load_dwordx4 v[32:35], v[40:41], off
.cpf_228:
    s_memrealtime s[8:9]
    s_waitcnt vmcnt(8)
    s_waitcnt lgkmcnt(0)
    s_sub_u32 s8, s8, s30
    s_cmpk_ge_u32 s8, 1970
    s_cbranch_scc1 .ap_229
    s_waitcnt vmcnt(5)
    s_cmpk_ge_u32 s8, 1905
    s_cbranch_scc1 .ap_229
    s_waitcnt vmcnt(3)
    s_bitcmp1_b64 s[14:15], 55
    s_cbranch_scc0 1
    s_waitcnt vmcnt(2)
    s_cmpk_ge_u32 s8, 1830
    s_cbranch_scc1 .ap_229
    s_waitcnt vmcnt(1)
.ap_229:
    s_add_u32 s63, s69, 319488
    buffer_load_dwordx4 v[252:255], v2, s[44:47], s63 offen nt
    s_memrealtime s[8:9]
    s_waitcnt vmcnt(8)
    s_waitcnt lgkmcnt(0)
    s_sub_u32 s8, s8, s30
    s_cmpk_ge_u32 s8, 2001
    s_cbranch_scc1 .ap_230
    s_waitcnt vmcnt(5)
    s_cmpk_ge_u32 s8, 1936
    s_cbranch_scc1 .ap_230
    s_waitcnt vmcnt(3)
    s_bitcmp1_b64 s[14:15], 56
    s_cbranch_scc0 1
    s_waitcnt vmcnt(2)
    s_cmpk_ge_u32 s8, 1861
    s_cbranch_scc1 .ap_230
    s_waitcnt vmcnt(1)
.ap_230:
    s_add_u32 s63, s69, 393216
    buffer_load_dwordx4 v[36:39], v2, s[44:47], s63 offen nt
    s_memrealtime s[8:9]
    s_waitcnt vmcnt(8)
    s_waitcnt lgkmcnt(0)
    s_sub_u32 s8, s8, s30
    s_cmpk_ge_u32 s8, 2032
    s_cbranch_scc1 .ap_231
    s_waitcnt vmcnt(5)
    s_cmpk_ge_u32 s8, 1967
    s_cbranch_scc1 .ap_231
    s_waitcnt vmcnt(3)
    s_bitcmp1_b64 s[14:15], 57
    s_cbranch_scc0 1
    s_waitcnt vmcnt(2)
    s_cmpk_ge_u32 s8, 1892
    s_cbranch_scc1 .ap_231
    s_waitcnt vmcnt(1)
.ap_231:
    s_add_u32 s63, s69, 401408
    buffer_load_dwordx4 v[44:47], v2, s[44:47], s63 offen nt
    s_memrealtime s[8:9]
    s_waitcnt vmcnt(8)
    s_waitcnt lgkmcnt(0)
    s_sub_u32 s8, s8, s30
    s_cmpk_ge_u32 s8, 2063
    s_cbranch_scc1 .ap_232
    s_waitcnt vmcnt(5)
    s_cmpk_ge_u32 s8, 1998
    s_cbranch_scc1 .ap_232
    s_waitcnt vmcnt(3)
    s_bitcmp1_b64 s[14:15], 58
    s_cbranch_scc0 1
    s_waitcnt vmcnt(2)
    s_cmpk_ge_u32 s8, 1923
    s_cbranch_scc1 .ap_232
    s_waitcnt vmcnt(1)
.ap_232:
    s_add_u32 s63, s69, 409600
    buffer_load_dwordx4 v[52:55], v2, s[44:47], s63 offen nt
    s_waitcnt vmcnt(5)
    s_branch .gpc_234
.gp_233:
    buffer_load_dwordx4 v[24:27], v9, s[36:39], s59 offen offset:0 sc1
    s_waitcnt vmcnt(0)
.gpc_234:
    v_cmp_eq_u32 vcc, s34, v26
    v_cmp_eq_u32 s[56:57], s34, v27
    s_and_b64 vcc, vcc, s[56:57]
    s_cmp_eq_u64 vcc, exec
    s_nop 2
    s_cbranch_scc1 .gpd_235
    s_sub_u32 s35, s35, 1
    s_cbranch_scc1 .Lexit
    s_sleep 1
    s_branch .gp_233
.gpd_235:
    s_lshr_b64 s[88:89], s[88:89], s1
    s_and_b32 s88, s88, 0xff
    s_cmp_eq_u32 s88, 32
    s_cselect_b32 s0, 0xac000, 0
    v_mov_b32 v16, v24
    s_nop 1
    v_max_f32_dpp v16, v16, v16 quad_perm:[2,3,0,1] row_mask:0xf bank_mask:0xf
    v_sub_f32 v17, v24, v16
    v_sub_f32 v18, v14, v16
    v_mul_f32 v17, 0x3fb8aa3b, v17
    v_mul_f32 v18, 0x3fb8aa3b, v18
    v_exp_f32 v17, v17
    v_exp_f32 v18, v18
    v_mul_f32 v17, v17, v25
    s_nop 1
    v_add_f32_dpp v17, v17, v17 quad_perm:[2,3,0,1] row_mask:0xf bank_mask:0xf
    v_rcp_f32 v19, v17
    s_nop 0
    v_fma_f32 v15, -v17, v19, 1.0
    v_fma_f32 v19, v15, v19, v19
    v_mul_f32 v18, v18, v19
    v_mul_f32 v10, v10, v18
    v_mul_f32 v11, v11, v18
    v_mul_f32 v12, v12, v18
    v_mul_f32 v13, v13, v18
    v_mov_b32_dpp v112, v10 quad_perm:[2,3,0,1] row_mask:0xf bank_mask:0xf
    v_mov_b32_dpp v113, v11 quad_perm:[2,3,0,1] row_mask:0xf bank_mask:0xf
    v_mov_b32_dpp v114, v12 quad_perm:[2,3,0,1] row_mask:0xf bank_mask:0xf
    v_mov_b32_dpp v115, v13 quad_perm:[2,3,0,1] row_mask:0xf bank_mask:0xf
    v_cvt_pk_bf16_f32 v96, v10, v112
    v_cvt_pk_bf16_f32 v100, v11, v113
    v_cvt_pk_bf16_f32 v104, v12, v114
    v_cvt_pk_bf16_f32 v108, v13, v115
    v_mov_b32_dpp v97, v96 row_ror:12 row_mask:0xf bank_mask:0xf
    v_mov_b32_dpp v101, v100 row_ror:12 row_mask:0xf bank_mask:0xf
    v_mov_b32_dpp v105, v104 row_ror:12 row_mask:0xf bank_mask:0xf
    v_mov_b32_dpp v109, v108 row_ror:12 row_mask:0xf bank_mask:0xf
    v_mov_b32_dpp v98, v96 row_ror:8 row_mask:0xf bank_mask:0xf
    v_mov_b32_dpp v102, v100 row_ror:8 row_mask:0xf bank_mask:0xf
    v_mov_b32_dpp v106, v104 row_ror:8 row_mask:0xf bank_mask:0xf
    v_mov_b32_dpp v110, v108 row_ror:8 row_mask:0xf bank_mask:0xf
    v_mov_b32_dpp v99, v96 row_ror:4 row_mask:0xf bank_mask:0xf
    v_mov_b32_dpp v103, v100 row_ror:4 row_mask:0xf bank_mask:0xf
    v_mov_b32_dpp v107, v104 row_ror:4 row_mask:0xf bank_mask:0xf
    v_mov_b32_dpp v111, v108 row_ror:4 row_mask:0xf bank_mask:0xf
    v_mov_b32_dpp v96, v96 row_shr:3 row_mask:0xf bank_mask:0x2
    v_mov_b32_dpp v97, v97 row_shr:3 row_mask:0xf bank_mask:0x2
    v_mov_b32_dpp v98, v98 row_shr:3 row_mask:0xf bank_mask:0x2
    v_mov_b32_dpp v99, v99 row_shr:3 row_mask:0xf bank_mask:0x2
    v_mov_b32_dpp v100, v100 row_shr:3 row_mask:0xf bank_mask:0x2
    v_mov_b32_dpp v101, v101 row_shr:3 row_mask:0xf bank_mask:0x2
    v_mov_b32_dpp v102, v102 row_shr:3 row_mask:0xf bank_mask:0x2
    v_mov_b32_dpp v103, v103 row_shr:3 row_mask:0xf bank_mask:0x2
    v_mov_b32_dpp v104, v104 row_shr:3 row_mask:0xf bank_mask:0x2
    v_mov_b32_dpp v105, v105 row_shr:3 row_mask:0xf bank_mask:0x2
    v_mov_b32_dpp v106, v106 row_shr:3 row_mask:0xf bank_mask:0x2
    v_mov_b32_dpp v107, v107 row_shr:3 row_mask:0xf bank_mask:0x2
    v_mov_b32_dpp v108, v108 row_shr:3 row_mask:0xf bank_mask:0x2
    v_mov_b32_dpp v109, v109 row_shr:3 row_mask:0xf bank_mask:0x2
    v_mov_b32_dpp v110, v110 row_shr:3 row_mask:0xf bank_mask:0x2
    v_mov_b32_dpp v111, v111 row_shr:3 row_mask:0xf bank_mask:0x2
    s_memrealtime s[8:9]
    s_waitcnt lgkmcnt(0)
    s_sub_u32 s8, s8, s30
    s_cmpk_ge_u32 s8, 2094
    s_cbranch_scc1 .ap_236
    s_waitcnt vmcnt(5)
    s_cmpk_ge_u32 s8, 2029
    s_cbranch_scc1 .ap_236
    s_waitcnt vmcnt(3)
    s_bitcmp1_b64 s[14:15], 59
    s_cbranch_scc0 1
    s_waitcnt vmcnt(2)
    s_cmpk_ge_u32 s8, 1954
    s_cbranch_scc1 .ap_236
    s_waitcnt vmcnt(1)
.ap_236:
    s_add_u32 s63, s69, 417792
    buffer_load_dwordx4 v[60:63], v2, s[44:47], s63 offen nt
    s_lshl_b32 s60, s3, 10
    s_add_u32 s60, s60, 132096
    v_lshlrev_b32 v10, 5, v0
    v_add_u32 v10, s60, v10
    v_lshrrev_b32 v11, 5, v0
    v_lshlrev_b32 v11, 13, v11
    v_and_b32 v12, 31, v0
    v_lshl_add_u32 v11, v12, 4, v11
    v_add_u32 v9, 132096, v2
    v_mov_b32 v15, s34
    s_memrealtime s[8:9]
    s_waitcnt lgkmcnt(0)
    s_sub_u32 s8, s8, s30
    s_cmpk_ge_u32 s8, 2125
    s_cbranch_scc1 .ap_237
    s_waitcnt vmcnt(5)
    s_cmpk_ge_u32 s8, 2060
    s_cbranch_scc1 .ap_237
    s_waitcnt vmcnt(3)
    s_bitcmp1_b64 s[14:15], 60
    s_cbranch_scc0 1
    s_waitcnt vmcnt(2)
    s_cmpk_ge_u32 s8, 1985
    s_cbranch_scc1 .ap_237
    s_waitcnt vmcnt(1)
.ap_237:
    s_add_u32 s63, s69, 425984
    buffer_load_dwordx4 v[68:71], v2, s[44:47], s63 offen nt
    v_perm_b32 v112, v164, v160, s94
    v_perm_b32 v113, v172, v168, s94
    v_perm_b32 v114, v180, v176, s94
    v_perm_b32 v115, v188, v184, s94
    s_nop 1
    v_mfma_f32_16x16x32_bf16 v[128:131], v[96:99], v[112:115], 0
    v_perm_b32 v116, v164, v160, s95
    v_perm_b32 v117, v172, v168, s95
    v_perm_b32 v118, v180, v176, s95
    v_perm_b32 v119, v188, v184, s95
    s_nop 1
    v_mfma_f32_16x16x32_bf16 v[132:135], v[96:99], v[116:119], 0
    v_perm_b32 v120, v165, v161, s94
    v_perm_b32 v121, v173, v169, s94
    v_perm_b32 v122, v181, v177, s94
    v_perm_b32 v123, v189, v185, s94
    s_nop 1
    v_mfma_f32_16x16x32_bf16 v[136:139], v[96:99], v[120:123], 0
    v_perm_b32 v124, v165, v161, s95
    v_perm_b32 v125, v173, v169, s95
    v_perm_b32 v126, v181, v177, s95
    v_perm_b32 v127, v189, v185, s95
    s_nop 1
    v_mfma_f32_16x16x32_bf16 v[140:143], v[96:99], v[124:127], 0
    v_perm_b32 v112, v166, v162, s94
    v_perm_b32 v113, v174, v170, s94
    v_perm_b32 v114, v182, v178, s94
    v_perm_b32 v115, v190, v186, s94
    s_nop 1
    v_mfma_f32_16x16x32_bf16 v[144:147], v[96:99], v[112:115], 0
    v_perm_b32 v116, v166, v162, s95
    v_perm_b32 v117, v174, v170, s95
    v_perm_b32 v118, v182, v178, s95
    v_perm_b32 v119, v190, v186, s95
    s_nop 1
    v_mfma_f32_16x16x32_bf16 v[148:151], v[96:99], v[116:119], 0
    v_perm_b32 v120, v167, v163, s94
    v_perm_b32 v121, v175, v171, s94
    v_perm_b32 v122, v183, v179, s94
    v_perm_b32 v123, v191, v187, s94
    s_nop 1
    v_mfma_f32_16x16x32_bf16 v[152:155], v[96:99], v[120:123], 0
    v_perm_b32 v124, v167, v163, s95
    v_perm_b32 v125, v175, v171, s95
    v_perm_b32 v126, v183, v179, s95
    v_perm_b32 v127, v191, v187, s95
    s_nop 1
    v_mfma_f32_16x16x32_bf16 v[156:159], v[96:99], v[124:127], 0
    s_memrealtime s[8:9]
    s_waitcnt lgkmcnt(0)
    s_sub_u32 s8, s8, s30
    s_cmpk_ge_u32 s8, 2156
    s_nop 3
    s_cbranch_scc1 .ap_238
    s_waitcnt vmcnt(5)
    s_cmpk_ge_u32 s8, 2091
    s_cbranch_scc1 .ap_238
    s_waitcnt vmcnt(3)
    s_bitcmp1_b64 s[14:15], 61
    s_cbranch_scc0 1
    s_waitcnt vmcnt(2)
    s_cmpk_ge_u32 s8, 2016
    s_cbranch_scc1 .ap_238
    s_waitcnt vmcnt(1)
.ap_238:
    s_add_u32 s63, s69, 434176
    buffer_load_dwordx4 v[76:79], v2, s[44:47], s63 offen nt
    v_perm_b32 v112, v196, v192, s94
    v_perm_b32 v113, v204, v200, s94
    v_perm_b32 v114, v212, v208, s94
    v_perm_b32 v115, v220, v216, s94
    s_nop 1
    v_mfma_f32_16x16x32_bf16 v[128:131], v[100:103], v[112:115], v[128:131]
    v_perm_b32 v116, v196, v192, s95
    v_perm_b32 v117, v204, v200, s95
    v_perm_b32 v118, v212, v208, s95
    v_perm_b32 v119, v220, v216, s95
    s_nop 1
    v_mfma_f32_16x16x32_bf16 v[132:135], v[100:103], v[116:119], v[132:135]
    v_perm_b32 v120, v197, v193, s94
    v_perm_b32 v121, v205, v201, s94
    v_perm_b32 v122, v213, v209, s94
    v_perm_b32 v123, v221, v217, s94
    s_nop 1
    v_mfma_f32_16x16x32_bf16 v[136:139], v[100:103], v[120:123], v[136:139]
    v_perm_b32 v124, v197, v193, s95
    v_perm_b32 v125, v205, v201, s95
    v_perm_b32 v126, v213, v209, s95
    v_perm_b32 v127, v221, v217, s95
    s_nop 1
    v_mfma_f32_16x16x32_bf16 v[140:143], v[100:103], v[124:127], v[140:143]
    v_perm_b32 v112, v198, v194, s94
    v_perm_b32 v113, v206, v202, s94
    v_perm_b32 v114, v214, v210, s94
    v_perm_b32 v115, v222, v218, s94
    s_nop 1
    v_mfma_f32_16x16x32_bf16 v[144:147], v[100:103], v[112:115], v[144:147]
    v_perm_b32 v116, v198, v194, s95
    v_perm_b32 v117, v206, v202, s95
    v_perm_b32 v118, v214, v210, s95
    v_perm_b32 v119, v222, v218, s95
    s_nop 1
    v_mfma_f32_16x16x32_bf16 v[148:151], v[100:103], v[116:119], v[148:151]
    v_perm_b32 v120, v199, v195, s94
    v_perm_b32 v121, v207, v203, s94
    v_perm_b32 v122, v215, v211, s94
    v_perm_b32 v123, v223, v219, s94
    s_nop 1
    v_mfma_f32_16x16x32_bf16 v[152:155], v[100:103], v[120:123], v[152:155]
    v_perm_b32 v124, v199, v195, s95
    v_perm_b32 v125, v207, v203, s95
    v_perm_b32 v126, v215, v211, s95
    v_perm_b32 v127, v223, v219, s95
    s_nop 1
    v_mfma_f32_16x16x32_bf16 v[156:159], v[100:103], v[124:127], v[156:159]
    s_memrealtime s[8:9]
    s_waitcnt lgkmcnt(0)
    s_sub_u32 s8, s8, s30
    s_cmpk_ge_u32 s8, 2187
    s_nop 3
    s_cbranch_scc1 .ap_239
    s_waitcnt vmcnt(5)
    s_cmpk_ge_u32 s8, 2122
    s_cbranch_scc1 .ap_239
    s_waitcnt vmcnt(3)
    s_bitcmp1_b64 s[14:15], 62
    s_cbranch_scc0 1
    s_waitcnt vmcnt(2)
    s_cmpk_ge_u32 s8, 2047
    s_cbranch_scc1 .ap_239
    s_waitcnt vmcnt(1)
.ap_239:
    s_add_u32 s63, s69, 442368
    buffer_load_dwordx4 v[84:87], v2, s[44:47], s63 offen nt
    s_waitcnt vmcnt(7)
    v_perm_b32 v112, v228, v224, s94
    v_perm_b32 v113, v236, v232, s94
    v_perm_b32 v114, v244, v240, s94
    v_perm_b32 v115, v252, v248, s94
    s_nop 1
    v_mfma_f32_16x16x32_bf16 v[128:131], v[104:107], v[112:115], v[128:131]
    v_perm_b32 v116, v228, v224, s95
    v_perm_b32 v117, v236, v232, s95
    v_perm_b32 v118, v244, v240, s95
    v_perm_b32 v119, v252, v248, s95
    s_nop 1
    v_mfma_f32_16x16x32_bf16 v[132:135], v[104:107], v[116:119], v[132:135]
    v_perm_b32 v120, v229, v225, s94
    v_perm_b32 v121, v237, v233, s94
    v_perm_b32 v122, v245, v241, s94
    v_perm_b32 v123, v253, v249, s94
    s_nop 1
    v_mfma_f32_16x16x32_bf16 v[136:139], v[104:107], v[120:123], v[136:139]
    v_perm_b32 v124, v229, v225, s95
    v_perm_b32 v125, v237, v233, s95
    v_perm_b32 v126, v245, v241, s95
    v_perm_b32 v127, v253, v249, s95
    s_nop 1
    v_mfma_f32_16x16x32_bf16 v[140:143], v[104:107], v[124:127], v[140:143]
    v_perm_b32 v112, v230, v226, s94
    v_perm_b32 v113, v238, v234, s94
    v_perm_b32 v114, v246, v242, s94
    v_perm_b32 v115, v254, v250, s94
    s_nop 1
    v_mfma_f32_16x16x32_bf16 v[144:147], v[104:107], v[112:115], v[144:147]
    v_perm_b32 v116, v230, v226, s95
    v_perm_b32 v117, v238, v234, s95
    v_perm_b32 v118, v246, v242, s95
    v_perm_b32 v119, v254, v250, s95
    s_nop 1
    v_mfma_f32_16x16x32_bf16 v[148:151], v[104:107], v[116:119], v[148:151]
    v_perm_b32 v120, v231, v227, s94
    v_perm_b32 v121, v239, v235, s94
    v_perm_b32 v122, v247, v243, s94
    v_perm_b32 v123, v255, v251, s94
    s_nop 1
    v_mfma_f32_16x16x32_bf16 v[152:155], v[104:107], v[120:123], v[152:155]
    v_perm_b32 v124, v231, v227, s95
    v_perm_b32 v125, v239, v235, s95
    v_perm_b32 v126, v247, v243, s95
    v_perm_b32 v127, v255, v251, s95
    s_nop 1
    v_mfma_f32_16x16x32_bf16 v[156:159], v[104:107], v[124:127], v[156:159]
    s_memrealtime s[8:9]
    s_waitcnt lgkmcnt(0)
    s_sub_u32 s8, s8, s30
    s_cmpk_ge_u32 s8, 2218
    s_nop 3
    s_cbranch_scc1 .ap_240
    s_waitcnt vmcnt(5)
    s_cmpk_ge_u32 s8, 2153
    s_cbranch_scc1 .ap_240
    s_waitcnt vmcnt(3)
    s_bitcmp1_b64 s[14:15], 63
    s_cbranch_scc0 1
    s_waitcnt vmcnt(2)
    s_cmpk_ge_u32 s8, 2078
    s_cbranch_scc1 .ap_240
    s_waitcnt vmcnt(1)
.ap_240:
    s_add_u32 s63, s69, 450560
    buffer_load_dwordx4 v[92:95], v2, s[44:47], s63 offen nt
    s_setprio 0
    s_waitcnt vmcnt(6)
    v_perm_b32 v160, v44, v36, s94
    v_perm_b32 v164, v44, v36, s95
    v_perm_b32 v168, v45, v37, s94
    v_perm_b32 v172, v45, v37, s95
    v_perm_b32 v176, v46, v38, s94
    v_perm_b32 v180, v46, v38, s95
    v_perm_b32 v184, v47, v39, s94
    v_perm_b32 v188, v47, v39, s95
    s_waitcnt vmcnt(4)
    v_perm_b32 v161, v60, v52, s94
    v_perm_b32 v165, v60, v52, s95
    v_perm_b32 v169, v61, v53, s94
    v_perm_b32 v173, v61, v53, s95
    v_perm_b32 v177, v62, v54, s94
    v_perm_b32 v181, v62, v54, s95
    v_perm_b32 v185, v63, v55, s94
    v_perm_b32 v189, v63, v55, s95
    v_mfma_f32_16x16x16_bf16 v[128:131], v[108:109], v[160:161], v[128:131]
    v_mfma_f32_16x16x16_bf16 v[132:135], v[108:109], v[164:165], v[132:135]
    v_mfma_f32_16x16x16_bf16 v[136:139], v[108:109], v[168:169], v[136:139]
    v_mfma_f32_16x16x16_bf16 v[140:143], v[108:109], v[172:173], v[140:143]
    v_mfma_f32_16x16x16_bf16 v[144:147], v[108:109], v[176:177], v[144:147]
    v_mfma_f32_16x16x16_bf16 v[148:151], v[108:109], v[180:181], v[148:151]
    v_mfma_f32_16x16x16_bf16 v[152:155], v[108:109], v[184:185], v[152:155]
    v_mfma_f32_16x16x16_bf16 v[156:159], v[108:109], v[188:189], v[156:159]
    s_waitcnt vmcnt(2)
    v_perm_b32 v162, v76, v68, s94
    v_perm_b32 v166, v76, v68, s95
    v_perm_b32 v170, v77, v69, s94
    v_perm_b32 v174, v77, v69, s95
    v_perm_b32 v178, v78, v70, s94
    v_perm_b32 v182, v78, v70, s95
    v_perm_b32 v186, v79, v71, s94
    v_perm_b32 v190, v79, v71, s95
    s_lshl4_add_u32 s59, s67, s66
    s_lshl1_add_u32 s59, s59, s68
    s_lshl_b32 s59, s59, 9
    s_add_u32 s59, s59, 0x210000
    s_mov_b32 s60, 0x07060503
    s_mov_b32 s61, 0x07060502
    s_mov_b32 s62, 0x07060501
.Ltail_n:
    s_waitcnt vmcnt(0)
    v_perm_b32 v163, v92, v84, s94
    v_perm_b32 v167, v92, v84, s95
    v_perm_b32 v171, v93, v85, s94
    v_perm_b32 v175, v93, v85, s95
    v_perm_b32 v179, v94, v86, s94
    v_perm_b32 v183, v94, v86, s95
    v_perm_b32 v187, v95, v87, s94
    v_perm_b32 v191, v95, v87, s95
    v_mfma_f32_16x16x16_bf16 v[128:131], v[110:111], v[162:163], v[128:131]
    v_mfma_f32_16x16x16_bf16 v[132:135], v[110:111], v[166:167], v[132:135]
    v_mfma_f32_16x16x16_bf16 v[136:139], v[110:111], v[170:171], v[136:139]
    v_mfma_f32_16x16x16_bf16 v[140:143], v[110:111], v[174:175], v[140:143]
    v_mfma_f32_16x16x16_bf16 v[144:147], v[110:111], v[178:179], v[144:147]
    v_mfma_f32_16x16x16_bf16 v[148:151], v[110:111], v[182:183], v[148:151]
    v_mfma_f32_16x16x16_bf16 v[152:155], v[110:111], v[186:187], v[152:155]
    v_mfma_f32_16x16x16_bf16 v[156:159], v[110:111], v[190:191], v[156:159]
    s_mov_b64 exec, 0xffffffff
    s_nop 0
    ds_write2_b32 v10, v128, v132 offset0:0 offset1:1
    s_nop 0
    ds_write2_b32 v10, v136, v140 offset0:2 offset1:3
    s_nop 0
    ds_write2_b32 v10, v144, v148 offset0:4 offset1:5
    s_nop 0
    ds_write2_b32 v10, v152, v156 offset0:6 offset1:7
    s_mov_b64 exec, -1
    s_waitcnt lgkmcnt(0)
    s_barrier
    s_cmp_lg_u32 s3, 7
    s_cbranch_scc1 .opub_241
    ds_read_b128 v[196:199], v9 offset:0
    ds_read_b128 v[200:203], v9 offset:1024
    ds_read_b128 v[204:207], v9 offset:2048
    ds_read_b128 v[208:211], v9 offset:3072
    ds_read_b128 v[212:215], v9 offset:4096
    ds_read_b128 v[216:219], v9 offset:5120
    ds_read_b128 v[220:223], v9 offset:6144
    ds_read_b128 v[224:227], v9 offset:7168
    s_waitcnt lgkmcnt(6)
    v_pk_add_f32 v[196:197], v[196:197], v[200:201]
    v_pk_add_f32 v[198:199], v[198:199], v[202:203]
    s_waitcnt lgkmcnt(4)
    v_pk_add_f32 v[204:205], v[204:205], v[208:209]
    v_pk_add_f32 v[206:207], v[206:207], v[210:211]
    v_pk_add_f32 v[196:197], v[196:197], v[204:205]
    v_pk_add_f32 v[198:199], v[198:199], v[206:207]
    s_waitcnt lgkmcnt(2)
    v_pk_add_f32 v[212:213], v[212:213], v[216:217]
    v_pk_add_f32 v[214:215], v[214:215], v[218:219]
    s_waitcnt lgkmcnt(0)
    v_pk_add_f32 v[220:221], v[220:221], v[224:225]
    v_pk_add_f32 v[222:223], v[222:223], v[226:227]
    v_pk_add_f32 v[212:213], v[212:213], v[220:221]
    v_pk_add_f32 v[214:215], v[214:215], v[222:223]
    v_pk_add_f32 v[196:197], v[196:197], v[212:213]
    v_pk_add_f32 v[198:199], v[198:199], v[214:215]
    v_perm_b32 v12, v196, v199, s60
    v_perm_b32 v13, v197, v199, s61
    v_perm_b32 v14, v198, v199, s62
    s_add_u32 s57, s59, 0xac000
    buffer_store_dwordx4 v[12:15], v11, s[36:39], s57 offen
    buffer_store_dwordx4 v[12:15], v11, s[36:39], s59 offen sc1
.opub_241:
.Lexit:
.Lend:
s_endpgm
.section .rodata,"a"
.p2align 6
.amdhsa_kernel adaLN_cond__sliding_block_cached__moe_arch_mod__decode_kernel
  .amdhsa_next_free_vgpr 256
  .amdhsa_next_free_sgpr 102
  .amdhsa_accum_offset 256
  .amdhsa_group_segment_fixed_size 0
  .amdhsa_kernarg_size 120
  .amdhsa_user_sgpr_count 2
  .amdhsa_user_sgpr_kernarg_segment_ptr 1
  .amdhsa_system_sgpr_workgroup_id_x 1
.end_amdhsa_kernel
```

```asm
; @launch grid=(256,1,1) block=(512,1,1) lds=159360
.amdgcn_target "amdgcn-amd-amdhsa--gfx950"
.text
.globl adaLN_cond__sliding_block_cached__moe_arch_mod__decode_kernel
.p2align 8
.type adaLN_cond__sliding_block_cached__moe_arch_mod__decode_kernel,@function
adaLN_cond__sliding_block_cached__moe_arch_mod__decode_kernel:
    s_cmp_ge_u32 s2, 256
    s_cbranch_scc1 .Lend
    s_load_dwordx16 s[4:19], s[0:1], 0
    s_load_dwordx8 s[20:27], s[0:1], 64
    s_load_dwordx4 s[28:31], s[0:1], 96
    s_load_dwordx2 s[32:33], s[0:1], 112
    s_memrealtime s[70:71]
    v_lshrrev_b32 v1, 6, v0
    v_and_b32 v0, 63, v0
    v_readfirstlane_b32 s3, v1
    s_mov_b32 s35, 0x3ffff
    s_mov_b32 s98, 0xbfb8aa3b
    s_mov_b32 s94, 0x05040100
    s_mov_b32 s95, 0x07060302
    s_mov_b32 s96, 0xaaaaaaaa
    s_mov_b32 s97, 0xaaaaaaaa
    s_and_b32 s64, s2, 7
    s_lshr_b32 s65, s2, 3
    s_and_b32 s66, s65, 7
    s_lshr_b32 s67, s2, 7
    s_lshl1_add_u32 s67, s64, s67
    s_bfe_u32 s68, s2, 0x10006
    s_lshl4_add_u32 s69, s66, s67
    s_lshl_b32 s69, s69, 21
    s_lshl_b32 s56, s68, 16
    s_add_u32 s69, s69, s56
    s_lshl_b32 s56, s3, 10
    s_add_u32 s69, s69, s56
    s_add_u32 s69, s69, 0x180000
    v_bfe_u32 v1, v0, 2, 2
    v_lshrrev_b32 v2, 4, v0
    v_lshl_add_u32 v1, v1, 2, v2
    v_and_b32 v2, 3, v0
    v_lshl_add_u32 v1, v1, 2, v2
    v_lshlrev_b32 v1, 4, v1
    v_lshlrev_b32 v2, 4, v0
    v_lshlrev_b32 v3, 3, v0
    v_and_b32 v4, 31, v0
    v_lshlrev_b32 v4, 2, v4
    v_add_u32 v4, 1024, v4
    v_lshlrev_b32 v5, 1, v4
    s_waitcnt lgkmcnt(0)
    s_load_dword s34, s[32:33], 0
    s_sub_u32 s99, s2, 216
    s_cmp_ge_u32 s99, 18
    s_cbranch_scc1 .Lmcf_no
    s_mul_i32 s58, s3, 1152
    s_mov_b32 s52, s24
    s_and_b32 s53, s25, 0xffff
    s_mov_b32 s54, 0x2400
    s_mov_b32 s55, 0x00020000
    buffer_load_dwordx2 v[246:247], v3, s[52:55], s58 offen
    buffer_load_dwordx2 v[248:249], v3, s[52:55], s58 offen offset:512
    buffer_load_dword v250, v4, s[52:55], s58 offen
    s_mov_b32 s48, s26
    s_and_b32 s49, s27, 0xffff
    s_mov_b32 s50, 0x3cc000
    s_mov_b32 s51, 0x00020000
    v_bfe_u32 v12, v0, 4, 1
    s_and_b32 s56, s3, 3
    s_lshl_b32 s56, s56, 1
    v_or_b32 v12, s56, v12
    v_and_b32 v19, 7, v0
    v_xor_b32 v12, v12, v19
    v_lshrrev_b32 v19, 3, v0
    v_mul_u32_u24 v19, 6912, v19
    v_lshl_add_u32 v19, v12, 4, v19
    s_mul_i32 s57, s3, 55296
    s_lshl_b32 s59, s99, 7
    s_add_u32 s57, s57, s59
    s_lshl_b32 s100, s3, 10
    s_add_u32 m0, s100, 0
    s_add_u32 s56, s57, 0
    buffer_load_dwordx4 v19, s[48:51], s56 offen nt lds
    s_add_u32 m0, s100, 8192
    s_add_u32 s56, s57, 442368
    buffer_load_dwordx4 v19, s[48:51], s56 offen nt lds
    s_add_u32 m0, s100, 16384
    s_add_u32 s56, s57, 884736
    buffer_load_dwordx4 v19, s[48:51], s56 offen nt lds
    s_add_u32 m0, s100, 24576
    s_add_u32 s56, s57, 1327104
    buffer_load_dwordx4 v19, s[48:51], s56 offen nt lds
    s_add_u32 m0, s100, 32768
    s_add_u32 s56, s57, 1769472
    buffer_load_dwordx4 v19, s[48:51], s56 offen nt lds
    s_add_u32 m0, s100, 40960
    s_add_u32 s56, s57, 2211840
    buffer_load_dwordx4 v19, s[48:51], s56 offen nt lds
    s_add_u32 m0, s100, 49152
    s_add_u32 s56, s57, 2654208
    buffer_load_dwordx4 v19, s[48:51], s56 offen nt lds
    s_add_u32 m0, s100, 57344
    s_add_u32 s56, s57, 3096576
    buffer_load_dwordx4 v19, s[48:51], s56 offen nt lds
    s_add_u32 m0, s100, 65536
    s_add_u32 s56, s57, 3538944
    buffer_load_dwordx4 v19, s[48:51], s56 offen nt lds
.Lmcf_no:
    s_mov_b32 s40, s6
    s_and_b32 s41, s7, 0xffff
    s_mov_b32 s42, 0x10000000
    s_mov_b32 s43, 0x00020000
    s_add_u32 s63, s69, 0
    buffer_load_dwordx4 v[32:35], v1, s[40:43], s63 offen nt
    s_add_u32 s63, s69, 8192
    buffer_load_dwordx4 v[36:39], v1, s[40:43], s63 offen nt
    s_add_u32 s63, s69, 16384
    buffer_load_dwordx4 v[64:67], v1, s[40:43], s63 offen nt
    s_add_u32 s63, s69, 24576
    buffer_load_dwordx4 v[68:71], v1, s[40:43], s63 offen nt
    s_mov_b32 s44, s8
    s_and_b32 s45, s9, 0xffff
    s_mov_b32 s46, 0x10000000
    s_mov_b32 s47, 0x00020000
    s_mov_b32 s36, s32
    s_and_b32 s37, s33, 0xffff
    s_mov_b32 s38, 0x40000000
    s_mov_b32 s39, 0x00020000
    s_lshl3_add_u32 s56, s3, s2
    s_cmp_lt_u32 s56, 8
    s_cbranch_scc0 .Let_no
    s_lshl_b32 s56, s2, 7
    s_add_u32 s56, s56, 0x400
    v_mov_b32 v7, s70
    s_mov_b64 exec, 1
    buffer_store_dword v7, v2, s[36:39], s56 offen sc1
    s_mov_b64 exec, -1
.Let_no:
    s_mov_b32 s52, s30
    s_and_b32 s53, s31, 0xffff
    s_mov_b32 s54, 0x100
    s_mov_b32 s55, 0x00020000
    s_mov_b64 s[6:7], s[30:31]
    s_getreg_b32 s1, hwreg(HW_REG_XCC_ID)
    s_and_b32 s1, s1, 7
    s_lshl_b32 s1, s1, 3
    s_lshl_b32 s0, s64, 5
    s_cmp_lg_u32 s3, 0
    s_cbranch_scc1 .Lxa_no
    s_lshl_b64 s[56:57], 1, s1
    v_mov_b32 v8, s56
    v_mov_b32 v9, s57
    s_mov_b64 exec, 1
    buffer_atomic_add_x2 v[8:9], v2, s[52:55], s0 offen sc1
    v_mov_b32 v8, 0
    v_mov_b32 v9, 159232
    ds_write_b32 v9, v8
    s_waitcnt lgkmcnt(0)
    s_mov_b64 exec, -1
.Lxa_no:
    s_barrier
    s_cmp_lt_u32 s3, 4
    s_cbranch_scc1 1
    s_setprio 1
.Lresume:
    s_cmp_lt_u32 s65, 9
    s_cbranch_scc1 .Le_a
    s_sub_u32 s56, 3, s64
    s_and_b32 s56, s56, 7
    s_lshl1_add_u32 s56, s56, 9
    s_sub_u32 s56, s65, s56
    s_cselect_b32 s57, 18, 0
    s_add_u32 s56, s56, s57
    s_sub_u32 s101, s56, 2
    s_cmp_ge_u32 s56, 5
    s_addc_u32 s101, s101, 0
    s_sub_u32 s99, s56, 5
    s_min_u32 s99, s99, 7
    s_cmp_lt_u32 s65, 27
    s_cbranch_scc1 .Lrole_bc
    s_mov_b32 s101, 3
    s_sub_u32 s99, s65, 27
    s_cmp_ge_u32 s65, 31
    s_cselect_b32 s56, 2, 9
.Lrole_bc:
    s_lshl3_add_u32 s99, s99, s64
    s_sub_u32 s56, s56, 2
    s_cmp_lt_u32 s56, 7
    s_cbranch_scc1 .Le_q
    s_cmp_lt_u32 s99, 18
    s_cbranch_scc1 .Le_mc
    s_cmp_lt_u32 s99, 54
    s_mov_b32 s14, 0xfdff7fdf
    s_cselect_b32 s14, 0x6b5ad6b5, s14
    s_mov_b32 s15, 0xff7fdff7
    s_cselect_b32 s15, 0x5ad6b5ad, s15
    s_cselect_b32 s30, -30, 0
    s_add_u32 s30, s30, 0
    s_add_u32 s30, s30, s70
    s_sub_u32 s56, s65, 9
    s_lshr_b32 s56, s56, 1
    s_add_u32 s56, s56, s64
    s_and_b32 s56, s56, 7
    s_cmp_eq_u32 s56, 3
    s_cselect_b32 s56, -30, 0
    s_cmp_lt_u32 s99, 54
    s_cselect_b32 s56, 0, s56
    s_add_u32 s30, s30, s56
    s_waitcnt vmcnt(3)
    s_bitcmp1_b64 s[14:15], 4
    s_cbranch_scc0 1
    s_waitcnt vmcnt(2)
    s_add_u32 s63, s69, 32768
    buffer_load_dwordx4 v[96:99], v1, s[40:43], s63 offen nt
    s_memrealtime s[8:9]
    s_waitcnt lgkmcnt(0)
    s_sub_u32 s8, s8, s30
    s_cmpk_ge_u32 s8, 290
    s_cbranch_scc1 .ap_1
    s_waitcnt vmcnt(4)
    s_cmpk_ge_u32 s8, 225
    s_cbranch_scc1 .ap_1
    s_waitcnt vmcnt(3)
    s_bitcmp1_b64 s[14:15], 5
    s_cbranch_scc0 1
    s_waitcnt vmcnt(2)
    s_cmpk_ge_u32 s8, 150
    s_cbranch_scc1 .ap_1
    s_waitcnt vmcnt(1)
.ap_1:
    s_add_u32 s63, s69, 40960
    buffer_load_dwordx4 v[100:103], v1, s[40:43], s63 offen nt
    s_memrealtime s[8:9]
    s_waitcnt lgkmcnt(0)
    s_sub_u32 s8, s8, s30
    s_cmpk_ge_u32 s8, 315
    s_cbranch_scc1 .ap_2
    s_waitcnt vmcnt(5)
    s_cmpk_ge_u32 s8, 250
    s_cbranch_scc1 .ap_2
    s_waitcnt vmcnt(3)
    s_bitcmp1_b64 s[14:15], 6
    s_cbranch_scc0 1
    s_waitcnt vmcnt(2)
    s_cmpk_ge_u32 s8, 175
    s_cbranch_scc1 .ap_2
    s_waitcnt vmcnt(1)
.ap_2:
    s_add_u32 s63, s69, 49152
    buffer_load_dwordx4 v[128:131], v1, s[40:43], s63 offen nt
    s_memrealtime s[8:9]
    s_waitcnt lgkmcnt(0)
    s_sub_u32 s8, s8, s30
    s_cmpk_ge_u32 s8, 340
    s_cbranch_scc1 .ap_3
    s_waitcnt vmcnt(5)
    s_cmpk_ge_u32 s8, 275
    s_cbranch_scc1 .ap_3
    s_waitcnt vmcnt(3)
    s_bitcmp1_b64 s[14:15], 7
    s_cbranch_scc0 1
    s_waitcnt vmcnt(2)
    s_cmpk_ge_u32 s8, 200
    s_cbranch_scc1 .ap_3
    s_waitcnt vmcnt(1)
.ap_3:
    s_add_u32 s63, s69, 57344
    buffer_load_dwordx4 v[132:135], v1, s[40:43], s63 offen nt
    s_memrealtime s[8:9]
    s_waitcnt lgkmcnt(0)
    s_sub_u32 s8, s8, s30
    s_cmpk_ge_u32 s8, 365
    s_cbranch_scc1 .ap_4
    s_waitcnt vmcnt(5)
    s_cmpk_ge_u32 s8, 300
    s_cbranch_scc1 .ap_4
    s_waitcnt vmcnt(3)
    s_bitcmp1_b64 s[14:15], 8
    s_cbranch_scc0 1
    s_waitcnt vmcnt(2)
    s_cmpk_ge_u32 s8, 225
    s_cbranch_scc1 .ap_4
    s_waitcnt vmcnt(1)
.ap_4:
    s_add_u32 s63, s69, 131072
    buffer_load_dwordx4 v[40:43], v1, s[40:43], s63 offen nt
    s_memrealtime s[8:9]
    s_waitcnt lgkmcnt(0)
    s_sub_u32 s8, s8, s30
    s_cmpk_ge_u32 s8, 390
    s_cbranch_scc1 .ap_5
    s_waitcnt vmcnt(5)
    s_cmpk_ge_u32 s8, 325
    s_cbranch_scc1 .ap_5
    s_waitcnt vmcnt(3)
    s_bitcmp1_b64 s[14:15], 9
    s_cbranch_scc0 1
    s_waitcnt vmcnt(2)
    s_cmpk_ge_u32 s8, 250
    s_cbranch_scc1 .ap_5
    s_waitcnt vmcnt(1)
.ap_5:
    s_add_u32 s63, s69, 139264
    buffer_load_dwordx4 v[44:47], v1, s[40:43], s63 offen nt
    s_waitcnt lgkmcnt(0)
    s_mul_i32 s34, s34, 0x9e3779b1
    s_add_u32 s34, s34, 0x7f4a7c15
    s_cmp_lt_u32 s99, 54
    s_cbranch_scc1 .Le_mr
    s_sub_u32 s57, s65, 9
    s_bitcmp1_b32 s57, 0
    s_cselect_b32 s48, s20, s18
    s_cselect_b32 s49, s21, s19
    s_cselect_b32 s33, 36, 0
    s_and_b32 s49, s49, 0xffff
    s_mov_b32 s50, 0x510000
    s_mov_b32 s51, 0x00020000
    s_mov_b32 s52, s22
    s_and_b32 s53, s23, 0xffff
    s_mov_b32 s54, 0x510000
    s_mov_b32 s55, 0x00020000
    s_lshr_b32 s57, s57, 1
    s_lshl_b32 s57, s57, 7
    s_mul_i32 s101, s64, 1152
    s_add_u32 s101, s101, s57
    s_mul_i32 s56, s3, 73728
    s_add_u32 s101, s101, s56
    s_mul_i32 s56, s64, 72
    s_add_u32 s33, s33, s56
    s_add_u32 s33, s33, s3
    s_mul_i32 s33, s33, 9216
    s_add_u32 s33, s33, s57
    s_bfe_u32 s56, s101, 0x30007
    s_cmp_eq_u32 s56, 3
    s_cselect_b32 s100, 1, 0
    v_bfe_u32 v12, v0, 4, 1
    s_and_b32 s56, s3, 3
    s_lshl_b32 s56, s56, 1
    v_or_b32 v12, s56, v12
    v_and_b32 v6, 7, v0
    v_xor_b32 v12, v12, v6
    v_lshrrev_b32 v6, 3, v0
    v_mul_u32_u24 v6, 9216, v6
    v_lshl_add_u32 v6, v12, 4, v6
    v_bfe_u32 v12, v0, 4, 1
    s_and_b32 s56, s3, 1
    s_lshl_b32 s56, s56, 2
    v_lshl_or_b32 v12, v12, 1, s56
    v_and_b32 v13, 7, v0
    v_xor_b32 v12, v12, v13
    v_lshrrev_b32 v13, 3, v0
    v_mul_u32_u24 v13, 1152, v13
    v_lshl_add_u32 v31, v12, 4, v13
    s_lshl_b32 s32, s3, 10
    s_memrealtime s[8:9]
    s_waitcnt vmcnt(8)
    s_waitcnt lgkmcnt(0)
    s_sub_u32 s8, s8, s30
    s_cmpk_ge_u32 s8, 436
    s_cbranch_scc1 .ap_6
    s_waitcnt vmcnt(5)
    s_cmpk_ge_u32 s8, 371
    s_cbranch_scc1 .ap_6
    s_waitcnt vmcnt(3)
    s_bitcmp1_b64 s[14:15], 10
    s_cbranch_scc0 1
    s_waitcnt vmcnt(2)
    s_cmpk_ge_u32 s8, 296
    s_cbranch_scc1 .ap_6
    s_waitcnt vmcnt(1)
.ap_6:
    s_add_u32 s63, s69, 147456
    buffer_load_dwordx4 v[72:75], v1, s[40:43], s63 offen nt
    s_cmp_eq_u32 s100, 0
    s_cbranch_scc1 .ls_7
    s_add_u32 m0, s32, 0
    s_add_u32 s56, s101, 0
    buffer_load_dwordx4 v6, s[48:51], s56 offen nt lds
.ls_7:
    s_memrealtime s[8:9]
    s_waitcnt vmcnt(8)
    s_waitcnt lgkmcnt(0)
    s_sub_u32 s8, s8, s30
    s_cmpk_ge_u32 s8, 482
    s_cbranch_scc1 .ap_8
    s_waitcnt vmcnt(5)
    s_cmpk_ge_u32 s8, 417
    s_cbranch_scc1 .ap_8
    s_waitcnt vmcnt(3)
    s_bitcmp1_b64 s[14:15], 11
    s_cbranch_scc0 1
    s_waitcnt vmcnt(2)
    s_cmpk_ge_u32 s8, 342
    s_cbranch_scc1 .ap_8
    s_waitcnt vmcnt(1)
.ap_8:
    s_add_u32 s63, s69, 155648
    buffer_load_dwordx4 v[76:79], v1, s[40:43], s63 offen nt
    s_memrealtime s[8:9]
    s_waitcnt vmcnt(8)
    s_waitcnt lgkmcnt(0)
    s_sub_u32 s8, s8, s30
    s_cmpk_ge_u32 s8, 528
    s_cbranch_scc1 .ap_9
    s_waitcnt vmcnt(5)
    s_cmpk_ge_u32 s8, 463
    s_cbranch_scc1 .ap_9
    s_waitcnt vmcnt(3)
    s_bitcmp1_b64 s[14:15], 12
    s_cbranch_scc0 1
    s_waitcnt vmcnt(2)
    s_cmpk_ge_u32 s8, 388
    s_cbranch_scc1 .ap_9
    s_waitcnt vmcnt(1)
.ap_9:
    s_add_u32 s63, s69, 163840
    buffer_load_dwordx4 v[104:107], v1, s[40:43], s63 offen nt
    s_memrealtime s[8:9]
    s_waitcnt vmcnt(8)
    s_waitcnt lgkmcnt(0)
    s_sub_u32 s8, s8, s30
    s_cmpk_ge_u32 s8, 574
    s_cbranch_scc1 .ap_10
    s_waitcnt vmcnt(5)
    s_cmpk_ge_u32 s8, 509
    s_cbranch_scc1 .ap_10
    s_waitcnt vmcnt(3)
    s_bitcmp1_b64 s[14:15], 13
    s_cbranch_scc0 1
    s_waitcnt vmcnt(2)
    s_cmpk_ge_u32 s8, 434
    s_cbranch_scc1 .ap_10
    s_waitcnt vmcnt(1)
.ap_10:
    s_add_u32 s63, s69, 172032
    buffer_load_dwordx4 v[108:111], v1, s[40:43], s63 offen nt
    s_cmp_eq_u32 s100, 0
    s_cbranch_scc1 .ls_11
    s_add_u32 m0, s32, 8192
    s_add_u32 s56, s101, 589824
    buffer_load_dwordx4 v6, s[48:51], s56 offen nt lds
.ls_11:
    s_memrealtime s[8:9]
    s_waitcnt vmcnt(8)
    s_waitcnt lgkmcnt(0)
    s_sub_u32 s8, s8, s30
    s_cmpk_ge_u32 s8, 620
    s_cbranch_scc1 .ap_12
    s_waitcnt vmcnt(5)
    s_cmpk_ge_u32 s8, 555
    s_cbranch_scc1 .ap_12
    s_waitcnt vmcnt(3)
    s_bitcmp1_b64 s[14:15], 14
    s_cbranch_scc0 1
    s_waitcnt vmcnt(2)
    s_cmpk_ge_u32 s8, 480
    s_cbranch_scc1 .ap_12
    s_waitcnt vmcnt(1)
.ap_12:
    s_add_u32 s63, s69, 180224
    buffer_load_dwordx4 v[136:139], v1, s[40:43], s63 offen nt
    s_memrealtime s[8:9]
    s_waitcnt vmcnt(8)
    s_waitcnt lgkmcnt(0)
    s_sub_u32 s8, s8, s30
    s_cmpk_ge_u32 s8, 666
    s_cbranch_scc1 .ap_13
    s_waitcnt vmcnt(5)
    s_cmpk_ge_u32 s8, 601
    s_cbranch_scc1 .ap_13
    s_waitcnt vmcnt(3)
    s_bitcmp1_b64 s[14:15], 15
    s_cbranch_scc0 1
    s_waitcnt vmcnt(2)
    s_cmpk_ge_u32 s8, 526
    s_cbranch_scc1 .ap_13
    s_waitcnt vmcnt(1)
.ap_13:
    s_add_u32 s63, s69, 188416
    buffer_load_dwordx4 v[140:143], v1, s[40:43], s63 offen nt
    s_memrealtime s[8:9]
    s_waitcnt vmcnt(8)
    s_waitcnt lgkmcnt(0)
    s_sub_u32 s8, s8, s30
    s_cmpk_ge_u32 s8, 712
    s_cbranch_scc1 .ap_14
    s_waitcnt vmcnt(5)
    s_cmpk_ge_u32 s8, 647
    s_cbranch_scc1 .ap_14
    s_waitcnt vmcnt(3)
    s_bitcmp1_b64 s[14:15], 16
    s_cbranch_scc0 1
    s_waitcnt vmcnt(2)
    s_cmpk_ge_u32 s8, 572
    s_cbranch_scc1 .ap_14
    s_waitcnt vmcnt(1)
.ap_14:
    s_add_u32 s63, s69, 262144
    buffer_load_dwordx4 v[48:51], v1, s[40:43], s63 offen nt
    s_cmp_eq_u32 s100, 0
    s_cbranch_scc1 .ls_15
    s_add_u32 m0, s32, 16384
    s_add_u32 s56, s101, 1179648
    buffer_load_dwordx4 v6, s[48:51], s56 offen nt lds
.ls_15:
    s_memrealtime s[8:9]
    s_waitcnt vmcnt(8)
    s_waitcnt lgkmcnt(0)
    s_sub_u32 s8, s8, s30
    s_cmpk_ge_u32 s8, 758
    s_cbranch_scc1 .ap_16
    s_waitcnt vmcnt(5)
    s_cmpk_ge_u32 s8, 693
    s_cbranch_scc1 .ap_16
    s_waitcnt vmcnt(3)
    s_bitcmp1_b64 s[14:15], 17
    s_cbranch_scc0 1
    s_waitcnt vmcnt(2)
    s_cmpk_ge_u32 s8, 618
    s_cbranch_scc1 .ap_16
    s_waitcnt vmcnt(1)
.ap_16:
    s_add_u32 s63, s69, 270336
    buffer_load_dwordx4 v[52:55], v1, s[40:43], s63 offen nt
    s_memrealtime s[8:9]
    s_waitcnt vmcnt(8)
    s_waitcnt lgkmcnt(0)
    s_sub_u32 s8, s8, s30
    s_cmpk_ge_u32 s8, 804
    s_cbranch_scc1 .ap_17
    s_waitcnt vmcnt(5)
    s_cmpk_ge_u32 s8, 739
    s_cbranch_scc1 .ap_17
    s_waitcnt vmcnt(3)
    s_bitcmp1_b64 s[14:15], 18
    s_cbranch_scc0 1
    s_waitcnt vmcnt(2)
    s_cmpk_ge_u32 s8, 664
    s_cbranch_scc1 .ap_17
    s_waitcnt vmcnt(1)
.ap_17:
    s_add_u32 s63, s69, 278528
    buffer_load_dwordx4 v[80:83], v1, s[40:43], s63 offen nt
    v_and_b32 v157, 7, v0
    v_lshlrev_b32 v157, 7, v157
    s_mov_b32 s63, 0x400
    buffer_load_dword v156, v157, s[36:39], s63 offen
    s_memrealtime s[8:9]
    s_waitcnt vmcnt(9)
    s_waitcnt lgkmcnt(0)
    s_sub_u32 s8, s8, s30
    s_cmpk_ge_u32 s8, 850
    s_cbranch_scc1 .ap_18
    s_waitcnt vmcnt(6)
    s_cmpk_ge_u32 s8, 785
    s_cbranch_scc1 .ap_18
    s_waitcnt vmcnt(4)
    s_bitcmp1_b64 s[14:15], 19
    s_cbranch_scc0 1
    s_waitcnt vmcnt(3)
    s_cmpk_ge_u32 s8, 710
    s_cbranch_scc1 .ap_18
    s_waitcnt vmcnt(2)
.ap_18:
    s_add_u32 s63, s69, 286720
    buffer_load_dwordx4 v[84:87], v1, s[40:43], s63 offen nt
    s_cmp_eq_u32 s100, 0
    s_cbranch_scc1 .ls_19
    s_add_u32 m0, s32, 24576
    s_add_u32 s56, s101, 1769472
    buffer_load_dwordx4 v6, s[48:51], s56 offen nt lds
.ls_19:
    s_memrealtime s[8:9]
    s_waitcnt vmcnt(9)
    s_waitcnt lgkmcnt(0)
    s_sub_u32 s8, s8, s30
    s_cmpk_ge_u32 s8, 895
    s_cbranch_scc1 .ap_20
    s_waitcnt vmcnt(6)
    s_cmpk_ge_u32 s8, 830
    s_cbranch_scc1 .ap_20
    s_waitcnt vmcnt(4)
    s_bitcmp1_b64 s[14:15], 20
    s_cbranch_scc0 1
    s_waitcnt vmcnt(3)
    s_cmpk_ge_u32 s8, 755
    s_cbranch_scc1 .ap_20
    s_waitcnt vmcnt(2)
.ap_20:
    s_add_u32 s63, s69, 294912
    buffer_load_dwordx4 v[112:115], v1, s[40:43], s63 offen nt
    s_memrealtime s[8:9]
    s_waitcnt vmcnt(9)
    s_waitcnt lgkmcnt(0)
    s_sub_u32 s8, s8, s30
    s_cmpk_ge_u32 s8, 940
    s_cbranch_scc1 .ap_21
    s_waitcnt vmcnt(6)
    s_cmpk_ge_u32 s8, 875
    s_cbranch_scc1 .ap_21
    s_waitcnt vmcnt(4)
    s_bitcmp1_b64 s[14:15], 21
    s_cbranch_scc0 1
    s_waitcnt vmcnt(3)
    s_cmpk_ge_u32 s8, 800
    s_cbranch_scc1 .ap_21
    s_waitcnt vmcnt(1)
.ap_21:
    s_add_u32 s63, s69, 303104
    buffer_load_dwordx4 v[116:119], v1, s[40:43], s63 offen nt
    s_memrealtime s[8:9]
    s_waitcnt vmcnt(9)
    s_waitcnt lgkmcnt(0)
    s_sub_u32 s8, s8, s30
    s_cmpk_ge_u32 s8, 985
    s_cbranch_scc1 .ap_22
    s_waitcnt vmcnt(6)
    s_cmpk_ge_u32 s8, 920
    s_cbranch_scc1 .ap_22
    s_waitcnt vmcnt(4)
    s_bitcmp1_b64 s[14:15], 22
    s_cbranch_scc0 1
    s_waitcnt vmcnt(2)
    s_cmpk_ge_u32 s8, 845
    s_cbranch_scc1 .ap_22
    s_waitcnt vmcnt(1)
.ap_22:
    s_add_u32 s63, s69, 311296
    buffer_load_dwordx4 v[144:147], v1, s[40:43], s63 offen nt
    s_waitcnt vmcnt(4)
    s_sub_u32 s63, s70, 300
    v_subrev_u32 v156, s63, v156
    v_mov_b32 v157, 600
    v_cmp_lt_u32 s[8:9], v156, v157
    v_add_u32_dpp v156, v156, v156 quad_perm:[1,0,3,2] row_mask:0xf bank_mask:0xf
    s_nop 1
    v_add_u32_dpp v156, v156, v156 quad_perm:[2,3,0,1] row_mask:0xf bank_mask:0xf
    s_nop 1
    v_add_u32_dpp v156, v156, v156 row_ror:4 row_mask:0xf bank_mask:0xf
    s_nop 0
    v_readfirstlane_b32 s63, v156
    s_cmp_eq_u64 s[8:9], -1
    s_nop 3
    s_cbranch_scc0 .et_23
    s_lshr_b32 s63, s63, 3
    s_sub_u32 s63, s63, 300
    s_add_u32 s30, s30, s63
.et_23:
    s_cmp_eq_u32 s100, 0
    s_cbranch_scc1 .ls_24
    s_add_u32 m0, s32, 32768
    s_add_u32 s56, s101, 2359296
    buffer_load_dwordx4 v6, s[48:51], s56 offen nt lds
.ls_24:
    s_memrealtime s[8:9]
    s_waitcnt lgkmcnt(0)
    s_sub_u32 s8, s8, s30
    s_cmpk_ge_u32 s8, 1030
    s_cbranch_scc1 .ap_25
    s_waitcnt vmcnt(4)
    s_cmpk_ge_u32 s8, 965
    s_cbranch_scc1 .ap_25
    s_waitcnt vmcnt(3)
    s_bitcmp1_b64 s[14:15], 23
    s_cbranch_scc0 1
    s_waitcnt vmcnt(2)
    s_cmpk_ge_u32 s8, 890
    s_cbranch_scc1 .ap_25
    s_waitcnt vmcnt(1)
.ap_25:
    s_add_u32 s63, s69, 319488
    buffer_load_dwordx4 v[148:151], v1, s[40:43], s63 offen nt
    s_memrealtime s[8:9]
    s_waitcnt lgkmcnt(0)
    s_sub_u32 s8, s8, s30
    s_cmpk_ge_u32 s8, 1075
    s_cbranch_scc1 .ap_26
    s_waitcnt vmcnt(5)
    s_cmpk_ge_u32 s8, 1010
    s_cbranch_scc1 .ap_26
    s_waitcnt vmcnt(3)
    s_bitcmp1_b64 s[14:15], 24
    s_cbranch_scc0 1
    s_waitcnt vmcnt(2)
    s_cmpk_ge_u32 s8, 935
    s_cbranch_scc1 .ap_26
    s_waitcnt vmcnt(1)
.ap_26:
    s_add_u32 s63, s69, 393216
    buffer_load_dwordx4 v[56:59], v1, s[40:43], s63 offen nt
    s_memrealtime s[8:9]
    s_waitcnt lgkmcnt(0)
    s_sub_u32 s8, s8, s30
    s_cmpk_ge_u32 s8, 1120
    s_cbranch_scc1 .ap_27
    s_waitcnt vmcnt(5)
    s_cmpk_ge_u32 s8, 1055
    s_cbranch_scc1 .ap_27
    s_waitcnt vmcnt(3)
    s_bitcmp1_b64 s[14:15], 25
    s_cbranch_scc0 1
    s_waitcnt vmcnt(2)
    s_cmpk_ge_u32 s8, 980
    s_cbranch_scc1 .ap_27
    s_waitcnt vmcnt(1)
.ap_27:
    s_add_u32 s63, s69, 401408
    buffer_load_dwordx4 v[60:63], v1, s[40:43], s63 offen nt
    s_branch .Latt_bc
.Le_mr:
    s_mul_i32 s58, s3, 1152
    s_mov_b32 s52, s24
    s_and_b32 s53, s25, 0xffff
    s_mov_b32 s54, 0x2400
    s_mov_b32 s55, 0x00020000
    buffer_load_dwordx2 v[246:247], v3, s[52:55], s58 offen
    buffer_load_dwordx2 v[248:249], v3, s[52:55], s58 offen offset:512
    buffer_load_dword v250, v4, s[52:55], s58 offen
    s_mov_b32 s48, s26
    s_and_b32 s49, s27, 0xffff
    s_mov_b32 s50, 0x3cc000
    s_mov_b32 s51, 0x00020000
    v_bfe_u32 v12, v0, 4, 1
    s_and_b32 s56, s3, 3
    s_lshl_b32 s56, s56, 1
    v_or_b32 v12, s56, v12
    v_and_b32 v19, 7, v0
    v_xor_b32 v12, v12, v19
    v_lshrrev_b32 v19, 3, v0
    v_mul_u32_u24 v19, 6912, v19
    v_lshl_add_u32 v19, v12, 4, v19
    s_mul_i32 s57, s3, 55296
    s_lshl_b32 s59, s99, 7
    s_add_u32 s57, s57, s59
    s_lshl_b32 s100, s3, 10
    s_add_u32 m0, s100, 0
    s_add_u32 s56, s57, 0
    buffer_load_dwordx4 v19, s[48:51], s56 offen nt lds
    s_add_u32 m0, s100, 8192
    s_add_u32 s56, s57, 442368
    buffer_load_dwordx4 v19, s[48:51], s56 offen nt lds
    s_add_u32 m0, s100, 16384
    s_add_u32 s56, s57, 884736
    buffer_load_dwordx4 v19, s[48:51], s56 offen nt lds
    s_add_u32 m0, s100, 24576
    s_add_u32 s56, s57, 1327104
    buffer_load_dwordx4 v19, s[48:51], s56 offen nt lds
    s_add_u32 m0, s100, 32768
    s_add_u32 s56, s57, 1769472
    buffer_load_dwordx4 v19, s[48:51], s56 offen nt lds
    s_add_u32 m0, s100, 40960
    s_add_u32 s56, s57, 2211840
    buffer_load_dwordx4 v19, s[48:51], s56 offen nt lds
    s_add_u32 m0, s100, 49152
    s_add_u32 s56, s57, 2654208
    buffer_load_dwordx4 v19, s[48:51], s56 offen nt lds
    s_add_u32 m0, s100, 57344
    s_add_u32 s56, s57, 3096576
    buffer_load_dwordx4 v19, s[48:51], s56 offen nt lds
    s_add_u32 m0, s100, 65536
    s_add_u32 s56, s57, 3538944
    buffer_load_dwordx4 v19, s[48:51], s56 offen nt lds
    v_bfe_u32 v16, v0, 1, 3
    v_mul_u32_u24 v16, 1312, v16
    v_lshrrev_b32 v12, 4, v0
    v_lshl_add_u32 v16, v12, 5, v16
    v_and_b32 v12, 1, v0
    v_lshl_add_u32 v16, v12, 4, v16
    v_add_u32 v16, 147456, v16
    s_mul_i32 s56, s3, 1312
    s_add_u32 s56, s56, 147456
    v_add_u32 v17, s56, v3
    v_add_u32 v18, s56, v4
    v_lshrrev_b32 v12, 4, v0
    v_bfe_u32 v13, v0, 1, 1
    v_lshl_add_u32 v12, v12, 1, v13
    v_bfe_u32 v13, v0, 2, 2
    v_lshl_add_u32 v20, v12, 3, v13
    v_lshlrev_b32 v20, 7, v20
    v_and_b32 v12, 3, v12
    v_lshrrev_b32 v13, 1, v13
    v_lshl_add_u32 v12, v12, 1, v13
    v_xor_b32 v12, s3, v12
    v_lshl_add_u32 v20, v12, 4, v20
    v_and_b32 v12, 1, v0
    v_lshl_add_u32 v20, v12, 3, v20
    v_bfe_u32 v23, v0, 1, 3
    v_mul_u32_u24 v23, 144, v23
    v_bfe_u32 v12, v0, 4, 1
    v_lshl_add_u32 v23, v12, 3, v23
    v_lshrrev_b32 v12, 5, v0
    v_lshl_add_u32 v23, v12, 2, v23
    v_and_b32 v12, 1, v0
    v_lshl_add_u32 v23, v12, 1, v23
    s_lshl_b32 s56, s3, 4
    s_add_u32 s56, s56, 157952
    v_add_u32 v23, s56, v23
    v_and_b32 v24, 15, v0
    v_lshlrev_b32 v24, 3, v24
    s_mul_i32 s56, s3, 144
    s_add_u32 s56, s56, 157952
    v_add_u32 v24, s56, v24
    v_add_u32 v21, 32768, v20
    s_lshl_b32 s100, s3, 10
    v_lshrrev_b32 v12, 4, v0
    v_mul_u32_u24 v12, 18432, v12
    v_and_b32 v13, 15, v0
    v_lshl_add_u32 v22, v13, 4, v12
    s_mul_i32 s57, s99, 57
    s_lshr_b32 s57, s57, 9
    s_mul_i32 s58, s57, 9
    s_sub_u32 s58, s99, s58
    s_mul_i32 s59, s57, 36864
    s_lshl_b32 s58, s58, 8
    s_add_u32 s59, s59, s58
    s_mul_i32 s58, s3, 2304
    s_add_u32 s59, s59, s58
    s_add_u32 s59, s59, 0x3000
    s_mov_b32 s58, 0
    s_cmp_eq_u32 s57, 1
    s_cselect_b32 s58, 1.0, s58
    s_cmp_eq_u32 s57, 4
    s_cselect_b32 s58, 1.0, s58
    s_waitcnt vmcnt(9)
    v_lshlrev_b32 v236, 16, v246
    v_and_b32 v237, 0xffff0000, v246
    v_max_f32 v236, 0xc2ae0000, v236
    v_min_f32 v242, 0x43000000, v236
    v_mul_f32 v238, 0xbfb8aa3b, v242
    v_fma_f32 v240, v242, s98, -v238
    v_fmac_f32 v240, 0xb2a57060, v242
    v_exp_f32 v238, v238
    v_mul_f32 v240, 0x3f317218, v240
    v_fmac_f32 v238, v238, v240
    v_add_f32 v238, 1.0, v238
    v_rcp_f32 v240, v238
    s_nop 0
    v_mul_f32 v242, v236, v240
    v_fma_f32 v238, -v242, v238, v236
    v_fma_f32 v236, v238, v240, v242
    v_max_f32 v237, 0xc2ae0000, v237
    v_min_f32 v243, 0x43000000, v237
    v_mul_f32 v239, 0xbfb8aa3b, v243
    v_fma_f32 v241, v243, s98, -v239
    v_fmac_f32 v241, 0xb2a57060, v243
    v_exp_f32 v239, v239
    v_mul_f32 v241, 0x3f317218, v241
    v_fmac_f32 v239, v239, v241
    v_add_f32 v239, 1.0, v239
    v_rcp_f32 v241, v239
    s_nop 0
    v_mul_f32 v243, v237, v241
    v_fma_f32 v239, -v243, v239, v237
    v_fma_f32 v237, v239, v241, v243
    v_cvt_pk_bf16_f32 v246, v236, v237
    v_lshlrev_b32 v236, 16, v247
    v_and_b32 v237, 0xffff0000, v247
    v_max_f32 v236, 0xc2ae0000, v236
    v_min_f32 v242, 0x43000000, v236
    v_mul_f32 v238, 0xbfb8aa3b, v242
    v_fma_f32 v240, v242, s98, -v238
    v_fmac_f32 v240, 0xb2a57060, v242
    v_exp_f32 v238, v238
    v_mul_f32 v240, 0x3f317218, v240
    v_fmac_f32 v238, v238, v240
    v_add_f32 v238, 1.0, v238
    v_rcp_f32 v240, v238
    s_nop 0
    v_mul_f32 v242, v236, v240
    v_fma_f32 v238, -v242, v238, v236
    v_fma_f32 v236, v238, v240, v242
    v_max_f32 v237, 0xc2ae0000, v237
    v_min_f32 v243, 0x43000000, v237
    v_mul_f32 v239, 0xbfb8aa3b, v243
    v_fma_f32 v241, v243, s98, -v239
    v_fmac_f32 v241, 0xb2a57060, v243
    v_exp_f32 v239, v239
    v_mul_f32 v241, 0x3f317218, v241
    v_fmac_f32 v239, v239, v241
    v_add_f32 v239, 1.0, v239
    v_rcp_f32 v241, v239
    s_nop 0
    v_mul_f32 v243, v237, v241
    v_fma_f32 v239, -v243, v239, v237
    v_fma_f32 v237, v239, v241, v243
    v_cvt_pk_bf16_f32 v247, v236, v237
    v_lshlrev_b32 v236, 16, v248
    v_and_b32 v237, 0xffff0000, v248
    v_max_f32 v236, 0xc2ae0000, v236
    v_min_f32 v242, 0x43000000, v236
    v_mul_f32 v238, 0xbfb8aa3b, v242
    v_fma_f32 v240, v242, s98, -v238
    v_fmac_f32 v240, 0xb2a57060, v242
    v_exp_f32 v238, v238
    v_mul_f32 v240, 0x3f317218, v240
    v_fmac_f32 v238, v238, v240
    v_add_f32 v238, 1.0, v238
    v_rcp_f32 v240, v238
    s_nop 0
    v_mul_f32 v242, v236, v240
    v_fma_f32 v238, -v242, v238, v236
    v_fma_f32 v236, v238, v240, v242
    v_max_f32 v237, 0xc2ae0000, v237
    v_min_f32 v243, 0x43000000, v237
    v_mul_f32 v239, 0xbfb8aa3b, v243
    v_fma_f32 v241, v243, s98, -v239
    v_fmac_f32 v241, 0xb2a57060, v243
    v_exp_f32 v239, v239
    v_mul_f32 v241, 0x3f317218, v241
    v_fmac_f32 v239, v239, v241
    v_add_f32 v239, 1.0, v239
    v_rcp_f32 v241, v239
    s_nop 0
    v_mul_f32 v243, v237, v241
    v_fma_f32 v239, -v243, v239, v237
    v_fma_f32 v237, v239, v241, v243
    v_cvt_pk_bf16_f32 v248, v236, v237
    v_lshlrev_b32 v236, 16, v249
    v_and_b32 v237, 0xffff0000, v249
    v_max_f32 v236, 0xc2ae0000, v236
    v_min_f32 v242, 0x43000000, v236
    v_mul_f32 v238, 0xbfb8aa3b, v242
    v_fma_f32 v240, v242, s98, -v238
    v_fmac_f32 v240, 0xb2a57060, v242
    v_exp_f32 v238, v238
    v_mul_f32 v240, 0x3f317218, v240
    v_fmac_f32 v238, v238, v240
    v_add_f32 v238, 1.0, v238
    v_rcp_f32 v240, v238
    s_nop 0
    v_mul_f32 v242, v236, v240
    v_fma_f32 v238, -v242, v238, v236
    v_fma_f32 v236, v238, v240, v242
    v_max_f32 v237, 0xc2ae0000, v237
    v_min_f32 v243, 0x43000000, v237
    v_mul_f32 v239, 0xbfb8aa3b, v243
    v_fma_f32 v241, v243, s98, -v239
    v_fmac_f32 v241, 0xb2a57060, v243
    v_exp_f32 v239, v239
    v_mul_f32 v241, 0x3f317218, v241
    v_fmac_f32 v239, v239, v241
    v_add_f32 v239, 1.0, v239
    v_rcp_f32 v241, v239
    s_nop 0
    v_mul_f32 v243, v237, v241
    v_fma_f32 v239, -v243, v239, v237
    v_fma_f32 v237, v239, v241, v243
    v_cvt_pk_bf16_f32 v249, v236, v237
    v_lshlrev_b32 v236, 16, v250
    v_and_b32 v237, 0xffff0000, v250
    v_max_f32 v236, 0xc2ae0000, v236
    v_min_f32 v242, 0x43000000, v236
    v_mul_f32 v238, 0xbfb8aa3b, v242
    v_fma_f32 v240, v242, s98, -v238
    v_fmac_f32 v240, 0xb2a57060, v242
    v_exp_f32 v238, v238
    v_mul_f32 v240, 0x3f317218, v240
    v_fmac_f32 v238, v238, v240
    v_add_f32 v238, 1.0, v238
    v_rcp_f32 v240, v238
    s_nop 0
    v_mul_f32 v242, v236, v240
    v_fma_f32 v238, -v242, v238, v236
    v_fma_f32 v236, v238, v240, v242
    v_max_f32 v237, 0xc2ae0000, v237
    v_min_f32 v243, 0x43000000, v237
    v_mul_f32 v239, 0xbfb8aa3b, v243
    v_fma_f32 v241, v243, s98, -v239
    v_fmac_f32 v241, 0xb2a57060, v243
    v_exp_f32 v239, v239
    v_mul_f32 v241, 0x3f317218, v241
    v_fmac_f32 v239, v239, v241
    v_add_f32 v239, 1.0, v239
    v_rcp_f32 v241, v239
    s_nop 0
    v_mul_f32 v243, v237, v241
    v_fma_f32 v239, -v243, v239, v237
    v_fma_f32 v237, v239, v241, v243
    v_cvt_pk_bf16_f32 v250, v236, v237
    ds_write_b64 v17, v[246:247]
    ds_write_b64 v17, v[248:249] offset:512
    ds_write_b32 v18, v250
    s_waitcnt vmcnt(3)
    s_add_u32 s63, s69, 147456
    buffer_load_dwordx4 v[72:75], v1, s[40:43], s63 offen nt
    s_waitcnt vmcnt(3)
    s_add_u32 s63, s69, 155648
    buffer_load_dwordx4 v[76:79], v1, s[40:43], s63 offen nt
    s_waitcnt vmcnt(3)
    s_add_u32 s63, s69, 163840
    buffer_load_dwordx4 v[104:107], v1, s[40:43], s63 offen nt
    s_waitcnt vmcnt(3)
    s_add_u32 s63, s69, 172032
    buffer_load_dwordx4 v[108:111], v1, s[40:43], s63 offen nt
    s_waitcnt vmcnt(3)
    s_add_u32 s63, s69, 180224
    buffer_load_dwordx4 v[136:139], v1, s[40:43], s63 offen nt
    s_waitcnt vmcnt(3)
    s_add_u32 s63, s69, 188416
    buffer_load_dwordx4 v[140:143], v1, s[40:43], s63 offen nt
    s_waitcnt vmcnt(3)
    s_add_u32 s63, s69, 262144
    buffer_load_dwordx4 v[48:51], v1, s[40:43], s63 offen nt
    s_waitcnt vmcnt(3)
    s_add_u32 s63, s69, 270336
    buffer_load_dwordx4 v[52:55], v1, s[40:43], s63 offen nt
    s_waitcnt lgkmcnt(0)
    s_barrier
    ds_read_b64_tr_b16 v[160:161], v20 offset:0
    ds_read_b64_tr_b16 v[162:163], v20 offset:512
    ds_read_b64_tr_b16 v[164:165], v20 offset:8192
    ds_read_b64_tr_b16 v[166:167], v20 offset:8704
    ds_read_b64_tr_b16 v[168:169], v20 offset:16384
    ds_read_b64_tr_b16 v[170:171], v20 offset:16896
    ds_read_b64_tr_b16 v[172:173], v20 offset:24576
    ds_read_b64_tr_b16 v[174:175], v20 offset:25088
    ds_read_b64_tr_b16 v[176:177], v21 offset:0
    ds_read_b64_tr_b16 v[178:179], v21 offset:512
    ds_read_b64_tr_b16 v[180:181], v21 offset:8192
    ds_read_b64_tr_b16 v[182:183], v21 offset:8704
    ds_read_b64_tr_b16 v[184:185], v21 offset:16384
    ds_read_b64_tr_b16 v[186:187], v21 offset:16896
    ds_read_b64_tr_b16 v[188:189], v21 offset:24576
    ds_read_b64_tr_b16 v[190:191], v21 offset:25088
    ds_read_b64_tr_b16 v[192:193], v21 offset:32768
    ds_read_b64_tr_b16 v[194:195], v21 offset:33280
    ds_read_b128 v[196:199], v16 offset:0
    ds_read_b128 v[200:203], v16 offset:128
    ds_read_b128 v[204:207], v16 offset:256
    ds_read_b128 v[208:211], v16 offset:384
    ds_read_b128 v[212:215], v16 offset:512
    ds_read_b128 v[216:219], v16 offset:640
    ds_read_b128 v[220:223], v16 offset:768
    ds_read_b128 v[224:227], v16 offset:896
    ds_read_b128 v[228:231], v16 offset:1024
    s_waitcnt lgkmcnt(8)
    v_mfma_f32_16x16x32_bf16 v[232:235], v[160:163], v[196:199], 0
    s_waitcnt lgkmcnt(7)
    v_mfma_f32_16x16x32_bf16 v[232:235], v[164:167], v[200:203], v[232:235]
    s_waitcnt lgkmcnt(6)
    v_mfma_f32_16x16x32_bf16 v[232:235], v[168:171], v[204:207], v[232:235]
    s_waitcnt lgkmcnt(5)
    v_mfma_f32_16x16x32_bf16 v[232:235], v[172:175], v[208:211], v[232:235]
    s_waitcnt lgkmcnt(4)
    v_mfma_f32_16x16x32_bf16 v[232:235], v[176:179], v[212:215], v[232:235]
    s_waitcnt lgkmcnt(3)
    v_mfma_f32_16x16x32_bf16 v[232:235], v[180:183], v[216:219], v[232:235]
    s_waitcnt lgkmcnt(2)
    v_mfma_f32_16x16x32_bf16 v[232:235], v[184:187], v[220:223], v[232:235]
    s_waitcnt lgkmcnt(1)
    v_mfma_f32_16x16x32_bf16 v[232:235], v[188:191], v[224:227], v[232:235]
    s_waitcnt lgkmcnt(0)
    v_mfma_f32_16x16x32_bf16 v[232:235], v[192:195], v[228:231], v[232:235]
    s_nop 7
    v_permlane32_swap_b32 v232, v234
    v_permlane32_swap_b32 v233, v235
    v_cndmask_b32 v233, v233, v234, s[96:97]
    v_cndmask_b32 v232, v232, v235, s[96:97]
    s_nop 1
    v_add_f32_dpp v236, v233, v232 quad_perm:[1,0,3,2] row_mask:0xf bank_mask:0xf
    v_cvt_pk_bf16_f32 v236, 0, v236
    v_add_f32 v236, s58, v236
    v_cvt_pk_bf16_f32 v236, v236, v236
    ds_write_b16 v23, v236
    v_mov_b32 v243, s34
    s_waitcnt lgkmcnt(0)
    s_barrier
    ds_read2_b32 v[244:245], v24 offset1:1
    v_mov_b32 v241, s34
    s_waitcnt lgkmcnt(0)
    v_mov_b32 v240, v244
    v_mov_b32 v242, v245
    s_mov_b64 exec, 0xffff
    buffer_store_dwordx4 v[240:243], v22, s[36:39], s59 offen sc1
    s_mov_b64 exec, -1
    s_nop 0
    s_branch .Le_m2
.Le_mc:
    v_bfe_u32 v16, v0, 1, 3
    v_mul_u32_u24 v16, 1312, v16
    v_lshrrev_b32 v12, 4, v0
    v_lshl_add_u32 v16, v12, 5, v16
    v_and_b32 v12, 1, v0
    v_lshl_add_u32 v16, v12, 4, v16
    v_add_u32 v16, 147456, v16
    s_mul_i32 s56, s3, 1312
    s_add_u32 s56, s56, 147456
    v_add_u32 v17, s56, v3
    v_add_u32 v18, s56, v4
    v_lshrrev_b32 v12, 4, v0
    v_bfe_u32 v13, v0, 1, 1
    v_lshl_add_u32 v12, v12, 1, v13
    v_bfe_u32 v13, v0, 2, 2
    v_lshl_add_u32 v20, v12, 3, v13
    v_lshlrev_b32 v20, 7, v20
    v_and_b32 v12, 3, v12
    v_lshrrev_b32 v13, 1, v13
    v_lshl_add_u32 v12, v12, 1, v13
    v_xor_b32 v12, s3, v12
    v_lshl_add_u32 v20, v12, 4, v20
    v_and_b32 v12, 1, v0
    v_lshl_add_u32 v20, v12, 3, v20
    v_bfe_u32 v23, v0, 1, 3
    v_mul_u32_u24 v23, 144, v23
    v_bfe_u32 v12, v0, 4, 1
    v_lshl_add_u32 v23, v12, 3, v23
    v_lshrrev_b32 v12, 5, v0
    v_lshl_add_u32 v23, v12, 2, v23
    v_and_b32 v12, 1, v0
    v_lshl_add_u32 v23, v12, 1, v23
    s_lshl_b32 s56, s3, 4
    s_add_u32 s56, s56, 157952
    v_add_u32 v23, s56, v23
    v_and_b32 v24, 15, v0
    v_lshlrev_b32 v24, 3, v24
    s_mul_i32 s56, s3, 144
    s_add_u32 s56, s56, 157952
    v_add_u32 v24, s56, v24
    v_add_u32 v21, 32768, v20
    s_lshl_b32 s100, s3, 10
    s_waitcnt lgkmcnt(0)
    s_mul_i32 s34, s34, 0x9e3779b1
    s_add_u32 s34, s34, 0x7f4a7c15
    v_lshrrev_b32 v12, 4, v0
    v_mul_u32_u24 v12, 18432, v12
    v_and_b32 v13, 15, v0
    v_lshl_add_u32 v22, v13, 4, v12
    s_mul_i32 s57, s99, 57
    s_lshr_b32 s57, s57, 9
    s_mul_i32 s58, s57, 9
    s_sub_u32 s58, s99, s58
    s_mul_i32 s59, s57, 36864
    s_lshl_b32 s58, s58, 8
    s_add_u32 s59, s59, s58
    s_mul_i32 s58, s3, 2304
    s_add_u32 s59, s59, s58
    s_add_u32 s59, s59, 0x3000
    s_mov_b32 s58, 0
    s_cmp_eq_u32 s57, 1
    s_cselect_b32 s58, 1.0, s58
    s_cmp_eq_u32 s57, 4
    s_cselect_b32 s58, 1.0, s58
    s_waitcnt vmcnt(13)
    v_lshlrev_b32 v236, 16, v246
    v_and_b32 v237, 0xffff0000, v246
    v_max_f32 v236, 0xc2ae0000, v236
    v_min_f32 v242, 0x43000000, v236
    v_mul_f32 v238, 0xbfb8aa3b, v242
    v_fma_f32 v240, v242, s98, -v238
    v_fmac_f32 v240, 0xb2a57060, v242
    v_exp_f32 v238, v238
    v_mul_f32 v240, 0x3f317218, v240
    v_fmac_f32 v238, v238, v240
    v_add_f32 v238, 1.0, v238
    v_rcp_f32 v240, v238
    s_nop 0
    v_mul_f32 v242, v236, v240
    v_fma_f32 v238, -v242, v238, v236
    v_fma_f32 v236, v238, v240, v242
    v_max_f32 v237, 0xc2ae0000, v237
    v_min_f32 v243, 0x43000000, v237
    v_mul_f32 v239, 0xbfb8aa3b, v243
    v_fma_f32 v241, v243, s98, -v239
    v_fmac_f32 v241, 0xb2a57060, v243
    v_exp_f32 v239, v239
    v_mul_f32 v241, 0x3f317218, v241
    v_fmac_f32 v239, v239, v241
    v_add_f32 v239, 1.0, v239
    v_rcp_f32 v241, v239
    s_nop 0
    v_mul_f32 v243, v237, v241
    v_fma_f32 v239, -v243, v239, v237
    v_fma_f32 v237, v239, v241, v243
    v_cvt_pk_bf16_f32 v246, v236, v237
    v_lshlrev_b32 v236, 16, v247
    v_and_b32 v237, 0xffff0000, v247
    v_max_f32 v236, 0xc2ae0000, v236
    v_min_f32 v242, 0x43000000, v236
    v_mul_f32 v238, 0xbfb8aa3b, v242
    v_fma_f32 v240, v242, s98, -v238
    v_fmac_f32 v240, 0xb2a57060, v242
    v_exp_f32 v238, v238
    v_mul_f32 v240, 0x3f317218, v240
    v_fmac_f32 v238, v238, v240
    v_add_f32 v238, 1.0, v238
    v_rcp_f32 v240, v238
    s_nop 0
    v_mul_f32 v242, v236, v240
    v_fma_f32 v238, -v242, v238, v236
    v_fma_f32 v236, v238, v240, v242
    v_max_f32 v237, 0xc2ae0000, v237
    v_min_f32 v243, 0x43000000, v237
    v_mul_f32 v239, 0xbfb8aa3b, v243
    v_fma_f32 v241, v243, s98, -v239
    v_fmac_f32 v241, 0xb2a57060, v243
    v_exp_f32 v239, v239
    v_mul_f32 v241, 0x3f317218, v241
    v_fmac_f32 v239, v239, v241
    v_add_f32 v239, 1.0, v239
    v_rcp_f32 v241, v239
    s_nop 0
    v_mul_f32 v243, v237, v241
    v_fma_f32 v239, -v243, v239, v237
    v_fma_f32 v237, v239, v241, v243
    v_cvt_pk_bf16_f32 v247, v236, v237
    v_lshlrev_b32 v236, 16, v248
    v_and_b32 v237, 0xffff0000, v248
    v_max_f32 v236, 0xc2ae0000, v236
    v_min_f32 v242, 0x43000000, v236
    v_mul_f32 v238, 0xbfb8aa3b, v242
    v_fma_f32 v240, v242, s98, -v238
    v_fmac_f32 v240, 0xb2a57060, v242
    v_exp_f32 v238, v238
    v_mul_f32 v240, 0x3f317218, v240
    v_fmac_f32 v238, v238, v240
    v_add_f32 v238, 1.0, v238
    v_rcp_f32 v240, v238
    s_nop 0
    v_mul_f32 v242, v236, v240
    v_fma_f32 v238, -v242, v238, v236
    v_fma_f32 v236, v238, v240, v242
    v_max_f32 v237, 0xc2ae0000, v237
    v_min_f32 v243, 0x43000000, v237
    v_mul_f32 v239, 0xbfb8aa3b, v243
    v_fma_f32 v241, v243, s98, -v239
    v_fmac_f32 v241, 0xb2a57060, v243
    v_exp_f32 v239, v239
    v_mul_f32 v241, 0x3f317218, v241
    v_fmac_f32 v239, v239, v241
    v_add_f32 v239, 1.0, v239
    v_rcp_f32 v241, v239
    s_nop 0
    v_mul_f32 v243, v237, v241
    v_fma_f32 v239, -v243, v239, v237
    v_fma_f32 v237, v239, v241, v243
    v_cvt_pk_bf16_f32 v248, v236, v237
    v_lshlrev_b32 v236, 16, v249
    v_and_b32 v237, 0xffff0000, v249
    v_max_f32 v236, 0xc2ae0000, v236
    v_min_f32 v242, 0x43000000, v236
    v_mul_f32 v238, 0xbfb8aa3b, v242
    v_fma_f32 v240, v242, s98, -v238
    v_fmac_f32 v240, 0xb2a57060, v242
    v_exp_f32 v238, v238
    v_mul_f32 v240, 0x3f317218, v240
    v_fmac_f32 v238, v238, v240
    v_add_f32 v238, 1.0, v238
    v_rcp_f32 v240, v238
    s_nop 0
    v_mul_f32 v242, v236, v240
    v_fma_f32 v238, -v242, v238, v236
    v_fma_f32 v236, v238, v240, v242
    v_max_f32 v237, 0xc2ae0000, v237
    v_min_f32 v243, 0x43000000, v237
    v_mul_f32 v239, 0xbfb8aa3b, v243
    v_fma_f32 v241, v243, s98, -v239
    v_fmac_f32 v241, 0xb2a57060, v243
    v_exp_f32 v239, v239
    v_mul_f32 v241, 0x3f317218, v241
    v_fmac_f32 v239, v239, v241
    v_add_f32 v239, 1.0, v239
    v_rcp_f32 v241, v239
    s_nop 0
    v_mul_f32 v243, v237, v241
    v_fma_f32 v239, -v243, v239, v237
    v_fma_f32 v237, v239, v241, v243
    v_cvt_pk_bf16_f32 v249, v236, v237
    v_lshlrev_b32 v236, 16, v250
    v_and_b32 v237, 0xffff0000, v250
    v_max_f32 v236, 0xc2ae0000, v236
    v_min_f32 v242, 0x43000000, v236
    v_mul_f32 v238, 0xbfb8aa3b, v242
    v_fma_f32 v240, v242, s98, -v238
    v_fmac_f32 v240, 0xb2a57060, v242
    v_exp_f32 v238, v238
    v_mul_f32 v240, 0x3f317218, v240
    v_fmac_f32 v238, v238, v240
    v_add_f32 v238, 1.0, v238
    v_rcp_f32 v240, v238
    s_nop 0
    v_mul_f32 v242, v236, v240
    v_fma_f32 v238, -v242, v238, v236
    v_fma_f32 v236, v238, v240, v242
    v_max_f32 v237, 0xc2ae0000, v237
    v_min_f32 v243, 0x43000000, v237
    v_mul_f32 v239, 0xbfb8aa3b, v243
    v_fma_f32 v241, v243, s98, -v239
    v_fmac_f32 v241, 0xb2a57060, v243
    v_exp_f32 v239, v239
    v_mul_f32 v241, 0x3f317218, v241
    v_fmac_f32 v239, v239, v241
    v_add_f32 v239, 1.0, v239
    v_rcp_f32 v241, v239
    s_nop 0
    v_mul_f32 v243, v237, v241
    v_fma_f32 v239, -v243, v239, v237
    v_fma_f32 v237, v239, v241, v243
    v_cvt_pk_bf16_f32 v250, v236, v237
    ds_write_b64 v17, v[246:247]
    ds_write_b64 v17, v[248:249] offset:512
    ds_write_b32 v18, v250
    s_waitcnt vmcnt(4)
    s_waitcnt lgkmcnt(0)
    s_barrier
    ds_read_b64_tr_b16 v[160:161], v20 offset:0
    ds_read_b64_tr_b16 v[162:163], v20 offset:512
    ds_read_b64_tr_b16 v[164:165], v20 offset:8192
    ds_read_b64_tr_b16 v[166:167], v20 offset:8704
    ds_read_b64_tr_b16 v[168:169], v20 offset:16384
    ds_read_b64_tr_b16 v[170:171], v20 offset:16896
    ds_read_b64_tr_b16 v[172:173], v20 offset:24576
    ds_read_b64_tr_b16 v[174:175], v20 offset:25088
    ds_read_b64_tr_b16 v[176:177], v21 offset:0
    ds_read_b64_tr_b16 v[178:179], v21 offset:512
    ds_read_b64_tr_b16 v[180:181], v21 offset:8192
    ds_read_b64_tr_b16 v[182:183], v21 offset:8704
    ds_read_b64_tr_b16 v[184:185], v21 offset:16384
    ds_read_b64_tr_b16 v[186:187], v21 offset:16896
    ds_read_b64_tr_b16 v[188:189], v21 offset:24576
    ds_read_b64_tr_b16 v[190:191], v21 offset:25088
    ds_read_b64_tr_b16 v[192:193], v21 offset:32768
    ds_read_b64_tr_b16 v[194:195], v21 offset:33280
    ds_read_b128 v[196:199], v16 offset:0
    ds_read_b128 v[200:203], v16 offset:128
    ds_read_b128 v[204:207], v16 offset:256
    ds_read_b128 v[208:211], v16 offset:384
    ds_read_b128 v[212:215], v16 offset:512
    ds_read_b128 v[216:219], v16 offset:640
    ds_read_b128 v[220:223], v16 offset:768
    ds_read_b128 v[224:227], v16 offset:896
    ds_read_b128 v[228:231], v16 offset:1024
    s_waitcnt lgkmcnt(8)
    v_mfma_f32_16x16x32_bf16 v[232:235], v[160:163], v[196:199], 0
    s_waitcnt lgkmcnt(7)
    v_mfma_f32_16x16x32_bf16 v[232:235], v[164:167], v[200:203], v[232:235]
    s_waitcnt lgkmcnt(6)
    v_mfma_f32_16x16x32_bf16 v[232:235], v[168:171], v[204:207], v[232:235]
    s_waitcnt lgkmcnt(5)
    v_mfma_f32_16x16x32_bf16 v[232:235], v[172:175], v[208:211], v[232:235]
    s_waitcnt lgkmcnt(4)
    v_mfma_f32_16x16x32_bf16 v[232:235], v[176:179], v[212:215], v[232:235]
    s_waitcnt lgkmcnt(3)
    v_mfma_f32_16x16x32_bf16 v[232:235], v[180:183], v[216:219], v[232:235]
    s_waitcnt lgkmcnt(2)
    v_mfma_f32_16x16x32_bf16 v[232:235], v[184:187], v[220:223], v[232:235]
    s_waitcnt lgkmcnt(1)
    v_mfma_f32_16x16x32_bf16 v[232:235], v[188:191], v[224:227], v[232:235]
    s_waitcnt lgkmcnt(0)
    v_mfma_f32_16x16x32_bf16 v[232:235], v[192:195], v[228:231], v[232:235]
    s_nop 7
    v_permlane32_swap_b32 v232, v234
    v_permlane32_swap_b32 v233, v235
    v_cndmask_b32 v233, v233, v234, s[96:97]
    v_cndmask_b32 v232, v232, v235, s[96:97]
    s_nop 1
    v_add_f32_dpp v236, v233, v232 quad_perm:[1,0,3,2] row_mask:0xf bank_mask:0xf
    v_cvt_pk_bf16_f32 v236, 0, v236
    v_add_f32 v236, s58, v236
    v_cvt_pk_bf16_f32 v236, v236, v236
    ds_write_b16 v23, v236
    v_mov_b32 v243, s34
    s_waitcnt lgkmcnt(0)
    s_barrier
    ds_read2_b32 v[244:245], v24 offset1:1
    v_mov_b32 v241, s34
    s_waitcnt lgkmcnt(0)
    v_mov_b32 v240, v244
    v_mov_b32 v242, v245
    s_mov_b64 exec, 0xffffffff
    buffer_store_dwordx4 v[240:243], v22, s[36:39], s59 offen sc1
    s_mov_b64 exec, -1
    s_mov_b32 s14, 0x6b5ad6b5
    s_mov_b32 s15, 0x5ad6b5ad
    s_add_u32 s30, s70, -30
    s_waitcnt vmcnt(3)
    s_add_u32 s63, s69, 32768
    buffer_load_dwordx4 v[96:99], v1, s[40:43], s63 offen nt
    s_waitcnt vmcnt(3)
    s_add_u32 s63, s69, 40960
    buffer_load_dwordx4 v[100:103], v1, s[40:43], s63 offen nt
    s_waitcnt vmcnt(3)
    s_add_u32 s63, s69, 49152
    buffer_load_dwordx4 v[128:131], v1, s[40:43], s63 offen nt
    s_waitcnt vmcnt(3)
    s_add_u32 s63, s69, 57344
    buffer_load_dwordx4 v[132:135], v1, s[40:43], s63 offen nt
    s_waitcnt vmcnt(3)
    s_add_u32 s63, s69, 131072
    buffer_load_dwordx4 v[40:43], v1, s[40:43], s63 offen nt
    s_waitcnt vmcnt(3)
    s_add_u32 s63, s69, 139264
    buffer_load_dwordx4 v[44:47], v1, s[40:43], s63 offen nt
    s_waitcnt vmcnt(3)
    s_add_u32 s63, s69, 147456
    buffer_load_dwordx4 v[72:75], v1, s[40:43], s63 offen nt
    s_waitcnt vmcnt(3)
    s_add_u32 s63, s69, 155648
    buffer_load_dwordx4 v[76:79], v1, s[40:43], s63 offen nt
    s_waitcnt vmcnt(3)
    s_add_u32 s63, s69, 163840
    buffer_load_dwordx4 v[104:107], v1, s[40:43], s63 offen nt
    s_waitcnt vmcnt(3)
    s_add_u32 s63, s69, 172032
    buffer_load_dwordx4 v[108:111], v1, s[40:43], s63 offen nt
    s_waitcnt vmcnt(3)
    s_add_u32 s63, s69, 180224
    buffer_load_dwordx4 v[136:139], v1, s[40:43], s63 offen nt
    s_waitcnt vmcnt(3)
    s_add_u32 s63, s69, 188416
    buffer_load_dwordx4 v[140:143], v1, s[40:43], s63 offen nt
    s_waitcnt vmcnt(3)
    s_add_u32 s63, s69, 262144
    buffer_load_dwordx4 v[48:51], v1, s[40:43], s63 offen nt
    s_waitcnt vmcnt(3)
    s_add_u32 s63, s69, 270336
    buffer_load_dwordx4 v[52:55], v1, s[40:43], s63 offen nt
.Le_m2:
    s_waitcnt vmcnt(3)
    s_bitcmp1_b64 s[14:15], 18
    s_cbranch_scc0 1
    s_waitcnt vmcnt(2)
    s_add_u32 s63, s69, 278528
    buffer_load_dwordx4 v[80:83], v1, s[40:43], s63 offen nt
    v_and_b32 v157, 7, v0
    v_lshlrev_b32 v157, 7, v157
    s_mov_b32 s63, 0x400
    buffer_load_dword v156, v157, s[36:39], s63 offen
    s_memrealtime s[8:9]
    s_waitcnt lgkmcnt(0)
    s_sub_u32 s8, s8, s30
    s_cmpk_ge_u32 s8, 850
    s_cbranch_scc1 .ap_28
    s_waitcnt vmcnt(5)
    s_cmpk_ge_u32 s8, 785
    s_cbranch_scc1 .ap_28
    s_waitcnt vmcnt(4)
    s_bitcmp1_b64 s[14:15], 19
    s_cbranch_scc0 1
    s_waitcnt vmcnt(3)
    s_cmpk_ge_u32 s8, 710
    s_cbranch_scc1 .ap_28
    s_waitcnt vmcnt(2)
.ap_28:
    s_add_u32 s63, s69, 286720
    buffer_load_dwordx4 v[84:87], v1, s[40:43], s63 offen nt
    s_memrealtime s[8:9]
    s_waitcnt lgkmcnt(0)
    s_sub_u32 s8, s8, s30
    s_cmpk_ge_u32 s8, 895
    s_cbranch_scc1 .ap_29
    s_waitcnt vmcnt(6)
    s_cmpk_ge_u32 s8, 830
    s_cbranch_scc1 .ap_29
    s_waitcnt vmcnt(4)
    s_bitcmp1_b64 s[14:15], 20
    s_cbranch_scc0 1
    s_waitcnt vmcnt(3)
    s_cmpk_ge_u32 s8, 755
    s_cbranch_scc1 .ap_29
    s_waitcnt vmcnt(2)
.ap_29:
    s_add_u32 s63, s69, 294912
    buffer_load_dwordx4 v[112:115], v1, s[40:43], s63 offen nt
    s_memrealtime s[8:9]
    s_waitcnt lgkmcnt(0)
    s_sub_u32 s8, s8, s30
    s_cmpk_ge_u32 s8, 940
    s_cbranch_scc1 .ap_30
    s_waitcnt vmcnt(6)
    s_cmpk_ge_u32 s8, 875
    s_cbranch_scc1 .ap_30
    s_waitcnt vmcnt(4)
    s_bitcmp1_b64 s[14:15], 21
    s_cbranch_scc0 1
    s_waitcnt vmcnt(3)
    s_cmpk_ge_u32 s8, 800
    s_cbranch_scc1 .ap_30
    s_waitcnt vmcnt(1)
.ap_30:
    s_add_u32 s63, s69, 303104
    buffer_load_dwordx4 v[116:119], v1, s[40:43], s63 offen nt
    s_memrealtime s[8:9]
    s_waitcnt lgkmcnt(0)
    s_sub_u32 s8, s8, s30
    s_cmpk_ge_u32 s8, 985
    s_cbranch_scc1 .ap_31
    s_waitcnt vmcnt(6)
    s_cmpk_ge_u32 s8, 920
    s_cbranch_scc1 .ap_31
    s_waitcnt vmcnt(4)
    s_bitcmp1_b64 s[14:15], 22
    s_cbranch_scc0 1
    s_waitcnt vmcnt(2)
    s_cmpk_ge_u32 s8, 845
    s_cbranch_scc1 .ap_31
    s_waitcnt vmcnt(1)
.ap_31:
    s_add_u32 s63, s69, 311296
    buffer_load_dwordx4 v[144:147], v1, s[40:43], s63 offen nt
    s_waitcnt vmcnt(4)
    s_sub_u32 s63, s70, 300
    v_subrev_u32 v156, s63, v156
    v_mov_b32 v157, 600
    v_cmp_lt_u32 s[8:9], v156, v157
    v_add_u32_dpp v156, v156, v156 quad_perm:[1,0,3,2] row_mask:0xf bank_mask:0xf
    s_nop 1
    v_add_u32_dpp v156, v156, v156 quad_perm:[2,3,0,1] row_mask:0xf bank_mask:0xf
    s_nop 1
    v_add_u32_dpp v156, v156, v156 row_ror:4 row_mask:0xf bank_mask:0xf
    s_nop 0
    v_readfirstlane_b32 s63, v156
    s_cmp_eq_u64 s[8:9], -1
    s_nop 3
    s_cbranch_scc0 .et_32
    s_lshr_b32 s63, s63, 3
    s_sub_u32 s63, s63, 300
    s_add_u32 s30, s30, s63
.et_32:
    s_memrealtime s[8:9]
    s_waitcnt lgkmcnt(0)
    s_sub_u32 s8, s8, s30
    s_cmpk_ge_u32 s8, 1030
    s_cbranch_scc1 .ap_33
    s_waitcnt vmcnt(4)
    s_cmpk_ge_u32 s8, 965
    s_cbranch_scc1 .ap_33
    s_waitcnt vmcnt(3)
    s_bitcmp1_b64 s[14:15], 23
    s_cbranch_scc0 1
    s_waitcnt vmcnt(2)
    s_cmpk_ge_u32 s8, 890
    s_cbranch_scc1 .ap_33
    s_waitcnt vmcnt(1)
.ap_33:
    s_add_u32 s63, s69, 319488
    buffer_load_dwordx4 v[148:151], v1, s[40:43], s63 offen nt
    s_memrealtime s[8:9]
    s_waitcnt lgkmcnt(0)
    s_sub_u32 s8, s8, s30
    s_cmpk_ge_u32 s8, 1075
    s_cbranch_scc1 .ap_34
    s_waitcnt vmcnt(5)
    s_cmpk_ge_u32 s8, 1010
    s_cbranch_scc1 .ap_34
    s_waitcnt vmcnt(3)
    s_bitcmp1_b64 s[14:15], 24
    s_cbranch_scc0 1
    s_waitcnt vmcnt(2)
    s_cmpk_ge_u32 s8, 935
    s_cbranch_scc1 .ap_34
    s_waitcnt vmcnt(1)
.ap_34:
    s_add_u32 s63, s69, 393216
    buffer_load_dwordx4 v[56:59], v1, s[40:43], s63 offen nt
    s_memrealtime s[8:9]
    s_waitcnt lgkmcnt(0)
    s_sub_u32 s8, s8, s30
    s_cmpk_ge_u32 s8, 1120
    s_cbranch_scc1 .ap_35
    s_waitcnt vmcnt(5)
    s_cmpk_ge_u32 s8, 1055
    s_cbranch_scc1 .ap_35
    s_waitcnt vmcnt(3)
    s_bitcmp1_b64 s[14:15], 25
    s_cbranch_scc0 1
    s_waitcnt vmcnt(2)
    s_cmpk_ge_u32 s8, 980
    s_cbranch_scc1 .ap_35
    s_waitcnt vmcnt(1)
.ap_35:
    s_add_u32 s63, s69, 401408
    buffer_load_dwordx4 v[60:63], v1, s[40:43], s63 offen nt
    s_mov_b32 s24, 0
    s_cmp_lt_u32 s2, 216
    s_cbranch_scc1 .Latt_bc
    s_branch .Latt_n
.Le_q:
    s_cmp_ge_u32 s65, 27
    s_mov_b32 s14, 0x94a5294a
    s_cselect_b32 s14, 0x0, s14
    s_mov_b32 s15, 0xa5294a52
    s_cselect_b32 s15, 0x0, s15
    s_cselect_b32 s30, -30, 0
    s_add_u32 s30, s30, 0
    s_add_u32 s30, s30, s70
    s_mul_i32 s58, s3, 1152
    s_mov_b32 s52, s4
    s_and_b32 s53, s5, 0xffff
    s_mov_b32 s54, 0x2400
    s_mov_b32 s55, 0x00020000
    buffer_load_dwordx2 v[246:247], v3, s[52:55], s58 offen
    buffer_load_dwordx2 v[248:249], v3, s[52:55], s58 offen offset:512
    buffer_load_dword v250, v4, s[52:55], s58 offen
    s_mov_b32 s48, s10
    s_and_b32 s49, s11, 0xffff
    s_mov_b32 s50, 0x480000
    s_mov_b32 s51, 0x00020000
    v_bfe_u32 v12, v0, 4, 1
    s_and_b32 s56, s3, 3
    s_lshl_b32 s56, s56, 1
    v_or_b32 v12, s56, v12
    v_and_b32 v19, 7, v0
    v_xor_b32 v12, v12, v19
    v_lshrrev_b32 v19, 3, v0
    v_mul_u32_u24 v19, 8192, v19
    v_lshl_add_u32 v19, v12, 4, v19
    s_lshl3_add_u32 s101, s64, s101
    s_lshl_b32 s99, s3, 16
    s_lshl_b32 s59, s101, 7
    s_add_u32 s99, s99, s59
    s_lshl_b32 s100, s3, 10
    s_add_u32 m0, s100, 0
    s_add_u32 s56, s99, 0
    buffer_load_dwordx4 v19, s[48:51], s56 offen nt lds
    s_add_u32 s63, s69, 32768
    buffer_load_dwordx4 v[96:99], v1, s[40:43], s63 offen nt
    v_bfe_u32 v16, v0, 1, 3
    v_mul_u32_u24 v16, 1312, v16
    v_lshrrev_b32 v12, 4, v0
    v_lshl_add_u32 v16, v12, 5, v16
    v_and_b32 v12, 1, v0
    v_lshl_add_u32 v16, v12, 4, v16
    v_add_u32 v16, 147456, v16
    s_mul_i32 s56, s3, 1312
    s_add_u32 s56, s56, 147456
    v_add_u32 v17, s56, v3
    v_add_u32 v18, s56, v4
    v_lshrrev_b32 v12, 4, v0
    v_bfe_u32 v13, v0, 1, 1
    v_lshl_add_u32 v12, v12, 1, v13
    v_bfe_u32 v13, v0, 2, 2
    v_lshl_add_u32 v20, v12, 3, v13
    v_lshlrev_b32 v20, 7, v20
    v_and_b32 v12, 3, v12
    v_lshrrev_b32 v13, 1, v13
    v_lshl_add_u32 v12, v12, 1, v13
    v_xor_b32 v12, s3, v12
    v_lshl_add_u32 v20, v12, 4, v20
    v_and_b32 v12, 1, v0
    v_lshl_add_u32 v20, v12, 3, v20
    v_bfe_u32 v23, v0, 1, 3
    v_mul_u32_u24 v23, 144, v23
    v_bfe_u32 v12, v0, 4, 1
    v_lshl_add_u32 v23, v12, 3, v23
    v_lshrrev_b32 v12, 5, v0
    v_lshl_add_u32 v23, v12, 2, v23
    v_and_b32 v12, 1, v0
    v_lshl_add_u32 v23, v12, 1, v23
    s_lshl_b32 s56, s3, 4
    s_add_u32 s56, s56, 157952
    v_add_u32 v23, s56, v23
    v_and_b32 v24, 15, v0
    v_lshlrev_b32 v24, 3, v24
    s_mul_i32 s56, s3, 144
    s_add_u32 s56, s56, 157952
    v_add_u32 v24, s56, v24
    v_add_u32 v21, 32768, v20
    s_lshl_b32 s100, s3, 10
    s_waitcnt lgkmcnt(0)
    s_mul_i32 s34, s34, 0x9e3779b1
    s_add_u32 s34, s34, 0x7f4a7c15
    s_lshl_b32 s101, s101, 8
    s_lshl_b32 s58, s3, 14
    s_add_u32 s101, s101, s58
    s_add_u32 s101, s101, 0x40000
    s_and_b32 s58, s64, 1
    s_mul_i32 s58, s58, 18432
    s_mul_i32 s59, s3, 2304
    s_add_u32 s58, s58, s59
    s_add_u32 s58, s58, 0x3000
    s_add_u32 s59, s58, 36864
    s_waitcnt vmcnt(5)
    s_add_u32 m0, s100, 8192
    s_add_u32 s56, s99, 524288
    buffer_load_dwordx4 v19, s[48:51], s56 offen nt lds
    s_waitcnt vmcnt(5)
    s_add_u32 s63, s69, 40960
    buffer_load_dwordx4 v[100:103], v1, s[40:43], s63 offen nt
    s_waitcnt vmcnt(5)
    s_add_u32 m0, s100, 16384
    s_add_u32 s56, s99, 1048576
    buffer_load_dwordx4 v19, s[48:51], s56 offen nt lds
    s_waitcnt vmcnt(5)
    s_add_u32 s63, s69, 49152
    buffer_load_dwordx4 v[128:131], v1, s[40:43], s63 offen nt
    v_lshlrev_b32 v236, 16, v246
    v_and_b32 v237, 0xffff0000, v246
    v_lshlrev_b32 v238, 16, v247
    v_and_b32 v239, 0xffff0000, v247
    v_lshlrev_b32 v240, 16, v248
    v_and_b32 v241, 0xffff0000, v248
    v_lshlrev_b32 v242, 16, v249
    v_and_b32 v243, 0xffff0000, v249
    v_lshlrev_b32 v244, 16, v250
    v_and_b32 v245, 0xffff0000, v250
    s_mov_b32 s56, 0x3f803f80
    v_dot2_f32_bf16 v10, v246, s56, 0
    v_dot2_f32_bf16 v11, v246, v246, 0
    v_dot2_f32_bf16 v10, v247, s56, v10
    v_dot2_f32_bf16 v11, v247, v247, v11
    v_dot2_f32_bf16 v10, v248, s56, v10
    v_dot2_f32_bf16 v11, v248, v248, v11
    v_dot2_f32_bf16 v10, v249, s56, v10
    v_dot2_f32_bf16 v11, v249, v249, v11
    s_mov_b64 exec, 0xffffffff
    v_dot2_f32_bf16 v10, v250, s56, v10
    v_dot2_f32_bf16 v11, v250, v250, v11
    s_mov_b64 exec, -1
    s_nop 1
    v_permlane32_swap_b32 v10, v11
    v_add_f32 v10, v10, v11
    v_mov_b32 v12, v10
    s_nop 1
    v_permlane16_swap_b32 v12, v10
    v_add_f32 v10, v12, v10
    s_nop 1
    v_add_f32_dpp v10, v10, v10 row_ror:8 row_mask:0xf bank_mask:0xf
    s_nop 1
    v_add_f32_dpp v10, v10, v10 row_ror:4 row_mask:0xf bank_mask:0xf
    s_nop 1
    v_add_f32_dpp v10, v10, v10 quad_perm:[2,3,0,1] row_mask:0xf bank_mask:0xf
    s_nop 1
    v_add_f32_dpp v10, v10, v10 quad_perm:[1,0,3,2] row_mask:0xf bank_mask:0xf
    v_mul_f32 v10, 0x3ae38e39, v10
    s_nop 0
    v_readlane_b32 s56, v10, 0
    v_readlane_b32 s57, v10, 32
    s_nop 0
    v_mov_b32 v10, s56
    v_fma_f32 v11, -v10, v10, s57
    v_max_f32 v11, 0, v11
    v_cvt_pk_bf16_f32 v13, 0, v11
    v_cvt_pk_bf16_f32 v11, 0, -v10
    v_cvt_pk_bf16_f32 v10, 0, -v10
    v_add_f32 v13, 0x3727c5ac, v13
    v_pk_add_f32 v[236:237], v[236:237], v[10:11]
    v_pk_add_f32 v[238:239], v[238:239], v[10:11]
    v_pk_add_f32 v[240:241], v[240:241], v[10:11]
    v_cvt_pk_bf16_f32 v13, 0, v13
    v_pk_add_f32 v[242:243], v[242:243], v[10:11]
    v_pk_add_f32 v[244:245], v[244:245], v[10:11]
    v_cvt_pk_bf16_f32 v236, 0, v236
    v_sqrt_f32 v13, v13
    v_cvt_pk_bf16_f32 v237, 0, v237
    v_cvt_pk_bf16_f32 v238, 0, v238
    v_cvt_pk_bf16_f32 v239, 0, v239
    v_cvt_pk_bf16_f32 v13, 0, v13
    v_cvt_pk_bf16_f32 v240, 0, v240
    v_cvt_pk_bf16_f32 v241, 0, v241
    v_cvt_pk_bf16_f32 v242, 0, v242
    v_rcp_f32 v12, v13
    v_cvt_pk_bf16_f32 v243, 0, v243
    v_cvt_pk_bf16_f32 v244, 0, v244
    v_cvt_pk_bf16_f32 v245, 0, v245
    v_mov_b32 v13, v12
    v_pk_mul_f32 v[236:237], v[236:237], v[12:13]
    v_pk_mul_f32 v[238:239], v[238:239], v[12:13]
    v_pk_mul_f32 v[240:241], v[240:241], v[12:13]
    v_pk_mul_f32 v[242:243], v[242:243], v[12:13]
    v_pk_mul_f32 v[244:245], v[244:245], v[12:13]
    v_cvt_pk_bf16_f32 v236, 0, v236
    v_cvt_pk_bf16_f32 v237, 0, v237
    v_cvt_pk_bf16_f32 v238, 0, v238
    v_cvt_pk_bf16_f32 v239, 0, v239
    v_cvt_pk_bf16_f32 v240, 0, v240
    v_cvt_pk_bf16_f32 v241, 0, v241
    v_cvt_pk_bf16_f32 v242, 0, v242
    v_cvt_pk_bf16_f32 v243, 0, v243
    v_cvt_pk_bf16_f32 v244, 0, v244
    v_cvt_pk_bf16_f32 v245, 0, v245
    s_waitcnt vmcnt(5)
    s_add_u32 m0, s100, 24576
    s_add_u32 s56, s99, 1572864
    buffer_load_dwordx4 v19, s[48:51], s56 offen nt lds
    s_waitcnt vmcnt(5)
    s_add_u32 s63, s69, 57344
    buffer_load_dwordx4 v[132:135], v1, s[40:43], s63 offen nt
    s_waitcnt vmcnt(5)
    s_add_u32 m0, s100, 32768
    s_add_u32 s56, s99, 2097152
    buffer_load_dwordx4 v19, s[48:51], s56 offen nt lds
    s_waitcnt vmcnt(5)
    s_add_u32 s63, s69, 131072
    buffer_load_dwordx4 v[40:43], v1, s[40:43], s63 offen nt
    s_waitcnt vmcnt(5)
    s_add_u32 m0, s100, 40960
    s_add_u32 s56, s99, 2621440
    buffer_load_dwordx4 v19, s[48:51], s56 offen nt lds
    s_waitcnt vmcnt(5)
    s_add_u32 s63, s69, 139264
    buffer_load_dwordx4 v[44:47], v1, s[40:43], s63 offen nt
    s_waitcnt vmcnt(5)
    s_add_u32 m0, s100, 49152
    s_add_u32 s56, s99, 3145728
    buffer_load_dwordx4 v19, s[48:51], s56 offen nt lds
    s_waitcnt vmcnt(5)
    s_add_u32 s63, s69, 147456
    buffer_load_dwordx4 v[72:75], v1, s[40:43], s63 offen nt
    s_waitcnt vmcnt(5)
    s_add_u32 m0, s100, 57344
    s_add_u32 s56, s99, 3670016
    buffer_load_dwordx4 v19, s[48:51], s56 offen nt lds
    s_waitcnt vmcnt(5)
    s_add_u32 s63, s69, 155648
    buffer_load_dwordx4 v[76:79], v1, s[40:43], s63 offen nt
    buffer_load_dwordx4 v[196:199], v2, s[36:39], s58 offen offset:0 sc1
    buffer_load_dwordx4 v[200:203], v2, s[36:39], s58 offen offset:1024 sc1
    buffer_load_dwordx2 v[204:205], v5, s[36:39], s58 offen offset:0 sc1
    buffer_load_dwordx4 v[206:209], v2, s[36:39], s59 offen offset:0 sc1
    buffer_load_dwordx4 v[210:213], v2, s[36:39], s59 offen offset:1024 sc1
    buffer_load_dwordx2 v[214:215], v5, s[36:39], s59 offen offset:0 sc1
    s_waitcnt vmcnt(11)
    s_add_u32 m0, s100, 65536
    s_add_u32 s56, s99, 4194304
    buffer_load_dwordx4 v19, s[48:51], s56 offen nt lds
    s_waitcnt vmcnt(11)
    s_add_u32 s63, s69, 163840
    buffer_load_dwordx4 v[104:107], v1, s[40:43], s63 offen nt
    s_waitcnt vmcnt(11)
    s_add_u32 s63, s69, 172032
    buffer_load_dwordx4 v[108:111], v1, s[40:43], s63 offen nt
    s_waitcnt vmcnt(11)
    s_add_u32 s63, s69, 180224
    buffer_load_dwordx4 v[136:139], v1, s[40:43], s63 offen nt
    s_waitcnt vmcnt(4)
    s_branch .gpc_37
.gp_36:
    buffer_load_dwordx4 v[196:199], v2, s[36:39], s58 offen offset:0 sc1
    buffer_load_dwordx4 v[200:203], v2, s[36:39], s58 offen offset:1024 sc1
    buffer_load_dwordx2 v[204:205], v5, s[36:39], s58 offen offset:0 sc1
    buffer_load_dwordx4 v[206:209], v2, s[36:39], s59 offen offset:0 sc1
    buffer_load_dwordx4 v[210:213], v2, s[36:39], s59 offen offset:1024 sc1
    buffer_load_dwordx2 v[214:215], v5, s[36:39], s59 offen offset:0 sc1
    s_waitcnt vmcnt(0)
.gpc_37:
    v_min_u32 v10, v197, v199
    v_max_u32 v11, v197, v199
    v_min3_u32 v10, v10, v201, v203
    v_max3_u32 v11, v11, v201, v203
    v_min3_u32 v10, v10, v205, v207
    v_max3_u32 v11, v11, v205, v207
    v_min3_u32 v10, v10, v209, v211
    v_max3_u32 v11, v11, v209, v211
    v_min3_u32 v10, v10, v213, v215
    v_max3_u32 v11, v11, v213, v215
    v_cmp_eq_u32 vcc, s34, v10
    v_cmp_eq_u32 s[56:57], s34, v11
    s_and_b64 vcc, vcc, s[56:57]
    s_cmp_eq_u64 vcc, exec
    s_nop 2
    s_cbranch_scc1 .gpd_38
    s_sub_u32 s35, s35, 1
    s_cbranch_scc1 .Lexit
    s_branch .gp_36
.gpd_38:
    v_and_b32 v207, 0xffff0000, v206
    v_lshlrev_b32 v206, 16, v206
    v_and_b32 v209, 0xffff0000, v208
    v_lshlrev_b32 v208, 16, v208
    v_and_b32 v211, 0xffff0000, v210
    v_lshlrev_b32 v210, 16, v210
    v_and_b32 v213, 0xffff0000, v212
    v_lshlrev_b32 v212, 16, v212
    v_and_b32 v215, 0xffff0000, v214
    v_lshlrev_b32 v214, 16, v214
    v_and_b32 v197, 0xffff0000, v196
    v_lshlrev_b32 v196, 16, v196
    v_and_b32 v199, 0xffff0000, v198
    v_lshlrev_b32 v198, 16, v198
    v_and_b32 v201, 0xffff0000, v200
    v_lshlrev_b32 v200, 16, v200
    v_and_b32 v203, 0xffff0000, v202
    v_lshlrev_b32 v202, 16, v202
    v_and_b32 v205, 0xffff0000, v204
    v_lshlrev_b32 v204, 16, v204
    v_pk_mul_f32 v[236:237], v[236:237], v[206:207]
    v_pk_mul_f32 v[238:239], v[238:239], v[208:209]
    v_pk_mul_f32 v[240:241], v[240:241], v[210:211]
    v_pk_mul_f32 v[242:243], v[242:243], v[212:213]
    v_pk_mul_f32 v[244:245], v[244:245], v[214:215]
    v_cvt_pk_bf16_f32 v236, 0, v236
    v_cvt_pk_bf16_f32 v237, 0, v237
    v_cvt_pk_bf16_f32 v238, 0, v238
    v_cvt_pk_bf16_f32 v239, 0, v239
    v_cvt_pk_bf16_f32 v240, 0, v240
    v_cvt_pk_bf16_f32 v241, 0, v241
    v_cvt_pk_bf16_f32 v242, 0, v242
    v_cvt_pk_bf16_f32 v243, 0, v243
    v_cvt_pk_bf16_f32 v244, 0, v244
    v_cvt_pk_bf16_f32 v245, 0, v245
    v_pk_add_f32 v[236:237], v[236:237], v[196:197]
    v_pk_add_f32 v[238:239], v[238:239], v[198:199]
    v_pk_add_f32 v[240:241], v[240:241], v[200:201]
    v_pk_add_f32 v[242:243], v[242:243], v[202:203]
    v_pk_add_f32 v[244:245], v[244:245], v[204:205]
    v_cvt_pk_bf16_f32 v246, v236, v237
    v_cvt_pk_bf16_f32 v247, v238, v239
    v_cvt_pk_bf16_f32 v248, v240, v241
    v_cvt_pk_bf16_f32 v249, v242, v243
    v_cvt_pk_bf16_f32 v250, v244, v245
    ds_write_b64 v17, v[246:247]
    ds_write_b64 v17, v[248:249] offset:512
    ds_write_b32 v18, v250
    s_add_u32 s63, s69, 188416
    buffer_load_dwordx4 v[140:143], v1, s[40:43], s63 offen nt
    s_add_u32 s63, s69, 262144
    buffer_load_dwordx4 v[48:51], v1, s[40:43], s63 offen nt
    s_add_u32 s63, s69, 270336
    buffer_load_dwordx4 v[52:55], v1, s[40:43], s63 offen nt
    s_add_u32 s63, s69, 278528
    buffer_load_dwordx4 v[80:83], v1, s[40:43], s63 offen nt
    v_and_b32 v157, 7, v0
    v_lshlrev_b32 v157, 7, v157
    s_mov_b32 s63, 0x400
    buffer_load_dword v156, v157, s[36:39], s63 offen
    s_waitcnt vmcnt(8)
    s_waitcnt lgkmcnt(0)
    s_barrier
    ds_read_b64_tr_b16 v[160:161], v20 offset:0
    ds_read_b64_tr_b16 v[162:163], v20 offset:512
    ds_read_b64_tr_b16 v[164:165], v20 offset:8192
    ds_read_b64_tr_b16 v[166:167], v20 offset:8704
    ds_read_b64_tr_b16 v[168:169], v20 offset:16384
    ds_read_b64_tr_b16 v[170:171], v20 offset:16896
    ds_read_b64_tr_b16 v[172:173], v20 offset:24576
    ds_read_b64_tr_b16 v[174:175], v20 offset:25088
    ds_read_b64_tr_b16 v[176:177], v21 offset:0
    ds_read_b64_tr_b16 v[178:179], v21 offset:512
    ds_read_b64_tr_b16 v[180:181], v21 offset:8192
    ds_read_b64_tr_b16 v[182:183], v21 offset:8704
    ds_read_b64_tr_b16 v[184:185], v21 offset:16384
    ds_read_b64_tr_b16 v[186:187], v21 offset:16896
    ds_read_b64_tr_b16 v[188:189], v21 offset:24576
    ds_read_b64_tr_b16 v[190:191], v21 offset:25088
    ds_read_b64_tr_b16 v[192:193], v21 offset:32768
    ds_read_b64_tr_b16 v[194:195], v21 offset:33280
    s_waitcnt lgkmcnt(0)
    ds_read_b128 v[196:199], v16 offset:0
    ds_read_b128 v[200:203], v16 offset:128
    ds_read_b128 v[204:207], v16 offset:256
    ds_read_b128 v[208:211], v16 offset:384
    ds_read_b128 v[212:215], v16 offset:512
    ds_read_b128 v[216:219], v16 offset:640
    ds_read_b128 v[220:223], v16 offset:768
    ds_read_b128 v[224:227], v16 offset:896
    ds_read_b128 v[228:231], v16 offset:1024
    s_waitcnt lgkmcnt(8)
    v_mfma_f32_16x16x32_bf16 v[232:235], v[160:163], v[196:199], 0
    s_waitcnt lgkmcnt(7)
    v_mfma_f32_16x16x32_bf16 v[232:235], v[164:167], v[200:203], v[232:235]
    s_waitcnt lgkmcnt(6)
    v_mfma_f32_16x16x32_bf16 v[232:235], v[168:171], v[204:207], v[232:235]
    s_waitcnt lgkmcnt(5)
    v_mfma_f32_16x16x32_bf16 v[232:235], v[172:175], v[208:211], v[232:235]
    s_waitcnt lgkmcnt(4)
    v_mfma_f32_16x16x32_bf16 v[232:235], v[176:179], v[212:215], v[232:235]
    s_waitcnt lgkmcnt(3)
    v_mfma_f32_16x16x32_bf16 v[232:235], v[180:183], v[216:219], v[232:235]
    s_waitcnt lgkmcnt(2)
    v_mfma_f32_16x16x32_bf16 v[232:235], v[184:187], v[220:223], v[232:235]
    s_waitcnt lgkmcnt(1)
    v_mfma_f32_16x16x32_bf16 v[232:235], v[188:191], v[224:227], v[232:235]
    s_waitcnt lgkmcnt(0)
    v_mfma_f32_16x16x32_bf16 v[232:235], v[192:195], v[228:231], v[232:235]
    s_nop 7
    v_permlane32_swap_b32 v232, v234
    v_permlane32_swap_b32 v233, v235
    v_cndmask_b32 v233, v233, v234, s[96:97]
    v_cndmask_b32 v232, v232, v235, s[96:97]
    s_nop 1
    v_add_f32_dpp v236, v233, v232 quad_perm:[1,0,3,2] row_mask:0xf bank_mask:0xf
    v_cvt_pk_bf16_f32 v236, v236, v236
    ds_write_b16 v23, v236
    v_mov_b32 v243, s34
    s_waitcnt lgkmcnt(0)
    s_barrier
    ds_read2_b32 v[244:245], v24 offset1:1
    v_mov_b32 v241, s34
    s_waitcnt lgkmcnt(0)
    v_mov_b32 v240, v244
    v_mov_b32 v242, v245
    s_mov_b64 exec, 0xffff
    buffer_store_dwordx4 v[240:243], v2, s[36:39], s101 offen sc1
    s_mov_b64 exec, -1
.Lq_done:
    s_memrealtime s[8:9]
    s_waitcnt lgkmcnt(0)
    s_sub_u32 s8, s8, s30
    s_cmpk_ge_u32 s8, 850
    s_cbranch_scc1 .ap_39
    s_waitcnt vmcnt(6)
    s_cmpk_ge_u32 s8, 785
    s_cbranch_scc1 .ap_39
    s_waitcnt vmcnt(4)
    s_bitcmp1_b64 s[14:15], 19
    s_cbranch_scc0 1
    s_waitcnt vmcnt(3)
    s_cmpk_ge_u32 s8, 710
    s_cbranch_scc1 .ap_39
    s_waitcnt vmcnt(2)
.ap_39:
    s_add_u32 s63, s69, 286720
    buffer_load_dwordx4 v[84:87], v1, s[40:43], s63 offen nt
    s_memrealtime s[8:9]
    s_waitcnt lgkmcnt(0)
    s_sub_u32 s8, s8, s30
    s_cmpk_ge_u32 s8, 895
    s_cbranch_scc1 .ap_40
    s_waitcnt vmcnt(6)
    s_cmpk_ge_u32 s8, 830
    s_cbranch_scc1 .ap_40
    s_waitcnt vmcnt(4)
    s_bitcmp1_b64 s[14:15], 20
    s_cbranch_scc0 1
    s_waitcnt vmcnt(3)
    s_cmpk_ge_u32 s8, 755
    s_cbranch_scc1 .ap_40
    s_waitcnt vmcnt(2)
.ap_40:
    s_add_u32 s63, s69, 294912
    buffer_load_dwordx4 v[112:115], v1, s[40:43], s63 offen nt
    s_memrealtime s[8:9]
    s_waitcnt vmcnt(9)
    s_waitcnt lgkmcnt(0)
    s_sub_u32 s8, s8, s30
    s_cmpk_ge_u32 s8, 940
    s_cbranch_scc1 .ap_41
    s_waitcnt vmcnt(6)
    s_cmpk_ge_u32 s8, 875
    s_cbranch_scc1 .ap_41
    s_waitcnt vmcnt(4)
    s_bitcmp1_b64 s[14:15], 21
    s_cbranch_scc0 1
    s_waitcnt vmcnt(3)
    s_cmpk_ge_u32 s8, 800
    s_cbranch_scc1 .ap_41
    s_waitcnt vmcnt(1)
.ap_41:
    s_add_u32 s63, s69, 303104
    buffer_load_dwordx4 v[116:119], v1, s[40:43], s63 offen nt
    s_memrealtime s[8:9]
    s_waitcnt vmcnt(9)
    s_waitcnt lgkmcnt(0)
    s_sub_u32 s8, s8, s30
    s_cmpk_ge_u32 s8, 985
    s_cbranch_scc1 .ap_42
    s_waitcnt vmcnt(6)
    s_cmpk_ge_u32 s8, 920
    s_cbranch_scc1 .ap_42
    s_waitcnt vmcnt(4)
    s_bitcmp1_b64 s[14:15], 22
    s_cbranch_scc0 1
    s_waitcnt vmcnt(2)
    s_cmpk_ge_u32 s8, 845
    s_cbranch_scc1 .ap_42
    s_waitcnt vmcnt(1)
.ap_42:
    s_add_u32 s63, s69, 311296
    buffer_load_dwordx4 v[144:147], v1, s[40:43], s63 offen nt
    s_waitcnt vmcnt(4)
    s_sub_u32 s63, s70, 300
    v_subrev_u32 v156, s63, v156
    v_mov_b32 v157, 600
    v_cmp_lt_u32 s[8:9], v156, v157
    v_add_u32_dpp v156, v156, v156 quad_perm:[1,0,3,2] row_mask:0xf bank_mask:0xf
    s_nop 1
    v_add_u32_dpp v156, v156, v156 quad_perm:[2,3,0,1] row_mask:0xf bank_mask:0xf
    s_nop 1
    v_add_u32_dpp v156, v156, v156 row_ror:4 row_mask:0xf bank_mask:0xf
    s_nop 0
    v_readfirstlane_b32 s63, v156
    s_cmp_eq_u64 s[8:9], -1
    s_nop 3
    s_cbranch_scc0 .et_43
    s_lshr_b32 s63, s63, 3
    s_sub_u32 s63, s63, 300
    s_add_u32 s30, s30, s63
.et_43:
    s_memrealtime s[8:9]
    s_waitcnt lgkmcnt(0)
    s_sub_u32 s8, s8, s30
    s_cmpk_ge_u32 s8, 1030
    s_cbranch_scc1 .ap_44
    s_waitcnt vmcnt(4)
    s_cmpk_ge_u32 s8, 965
    s_cbranch_scc1 .ap_44
    s_waitcnt vmcnt(3)
    s_bitcmp1_b64 s[14:15], 23
    s_cbranch_scc0 1
    s_waitcnt vmcnt(2)
    s_cmpk_ge_u32 s8, 890
    s_cbranch_scc1 .ap_44
    s_waitcnt vmcnt(1)
.ap_44:
    s_add_u32 s63, s69, 319488
    buffer_load_dwordx4 v[148:151], v1, s[40:43], s63 offen nt
    s_memrealtime s[8:9]
    s_waitcnt lgkmcnt(0)
    s_sub_u32 s8, s8, s30
    s_cmpk_ge_u32 s8, 1075
    s_cbranch_scc1 .ap_45
    s_waitcnt vmcnt(5)
    s_cmpk_ge_u32 s8, 1010
    s_cbranch_scc1 .ap_45
    s_waitcnt vmcnt(3)
    s_bitcmp1_b64 s[14:15], 24
    s_cbranch_scc0 1
    s_waitcnt vmcnt(2)
    s_cmpk_ge_u32 s8, 935
    s_cbranch_scc1 .ap_45
    s_waitcnt vmcnt(1)
.ap_45:
    s_add_u32 s63, s69, 393216
    buffer_load_dwordx4 v[56:59], v1, s[40:43], s63 offen nt
    s_memrealtime s[8:9]
    s_waitcnt lgkmcnt(0)
    s_sub_u32 s8, s8, s30
    s_cmpk_ge_u32 s8, 1120
    s_cbranch_scc1 .ap_46
    s_waitcnt vmcnt(5)
    s_cmpk_ge_u32 s8, 1055
    s_cbranch_scc1 .ap_46
    s_waitcnt vmcnt(3)
    s_bitcmp1_b64 s[14:15], 25
    s_cbranch_scc0 1
    s_waitcnt vmcnt(2)
    s_cmpk_ge_u32 s8, 980
    s_cbranch_scc1 .ap_46
    s_waitcnt vmcnt(1)
.ap_46:
    s_add_u32 s63, s69, 401408
    buffer_load_dwordx4 v[60:63], v1, s[40:43], s63 offen nt
    s_mov_b32 s24, 0
    s_cmp_lt_u32 s2, 216
    s_cbranch_scc1 .Latt_bc
    s_branch .Latt_n
.Le_a:
    s_mov_b32 s14, 0x6ddb76dd
    s_mov_b32 s15, 0xdb76ddb7
    s_add_u32 s30, s70, -50
    s_mov_b32 s48, s12
    s_and_b32 s49, s13, 0xffff
    s_mov_b32 s50, 0x480000
    s_mov_b32 s51, 0x00020000
    v_bfe_u32 v12, v0, 4, 1
    s_and_b32 s56, s3, 1
    s_lshl_b32 s56, s56, 2
    v_lshl_or_b32 v12, v12, 1, s56
    v_and_b32 v13, 7, v0
    v_xor_b32 v12, v12, v13
    v_lshrrev_b32 v13, 3, v0
    v_mul_u32_u24 v13, 1152, v13
    v_lshl_add_u32 v6, v12, 4, v13
    s_lshl_b32 s101, s64, 6
    s_add_u32 s101, s101, s3
    s_mul_i32 s101, s101, 9216
    s_lshl_b32 s56, s65, 7
    s_add_u32 s101, s101, s56
    s_lshl_b32 s100, s3, 10
    s_waitcnt vmcnt(3)
    s_add_u32 m0, s100, 0
    s_add_u32 s56, s101, 0
    buffer_load_dwordx4 v6, s[48:51], s56 offen nt lds
    s_waitcnt vmcnt(3)
    s_bitcmp1_b64 s[14:15], 4
    s_cbranch_scc0 1
    s_waitcnt vmcnt(2)
    s_add_u32 s63, s69, 32768
    buffer_load_dwordx4 v[96:99], v1, s[40:43], s63 offen nt
    s_waitcnt vmcnt(3)
    s_add_u32 m0, s100, 8192
    s_add_u32 s56, s101, 73728
    buffer_load_dwordx4 v6, s[48:51], s56 offen nt lds
    s_waitcnt vmcnt(3)
    s_bitcmp1_b64 s[14:15], 5
    s_cbranch_scc0 1
    s_waitcnt vmcnt(2)
    s_add_u32 s63, s69, 40960
    buffer_load_dwordx4 v[100:103], v1, s[40:43], s63 offen nt
    s_waitcnt vmcnt(3)
    s_bitcmp1_b64 s[14:15], 6
    s_cbranch_scc0 1
    s_waitcnt vmcnt(2)
    s_add_u32 s63, s69, 49152
    buffer_load_dwordx4 v[128:131], v1, s[40:43], s63 offen nt
    s_waitcnt vmcnt(3)
    s_bitcmp1_b64 s[14:15], 7
    s_cbranch_scc0 1
    s_waitcnt vmcnt(2)
    s_add_u32 s63, s69, 57344
    buffer_load_dwordx4 v[132:135], v1, s[40:43], s63 offen nt
    s_waitcnt vmcnt(3)
    s_add_u32 m0, s100, 16384
    s_add_u32 s56, s101, 147456
    buffer_load_dwordx4 v6, s[48:51], s56 offen nt lds
    s_waitcnt vmcnt(3)
    s_bitcmp1_b64 s[14:15], 8
    s_cbranch_scc0 1
    s_waitcnt vmcnt(2)
    s_add_u32 s63, s69, 131072
    buffer_load_dwordx4 v[40:43], v1, s[40:43], s63 offen nt
    s_waitcnt vmcnt(3)
    s_bitcmp1_b64 s[14:15], 9
    s_cbranch_scc0 1
    s_waitcnt vmcnt(2)
    s_add_u32 s63, s69, 139264
    buffer_load_dwordx4 v[44:47], v1, s[40:43], s63 offen nt
    s_memrealtime s[8:9]
    s_waitcnt lgkmcnt(0)
    s_sub_u32 s8, s8, s30
    s_cmpk_ge_u32 s8, 436
    s_cbranch_scc1 .ap_47
    s_waitcnt vmcnt(4)
    s_cmpk_ge_u32 s8, 371
    s_cbranch_scc1 .ap_47
    s_waitcnt vmcnt(3)
    s_bitcmp1_b64 s[14:15], 10
    s_cbranch_scc0 1
    s_waitcnt vmcnt(2)
    s_cmpk_ge_u32 s8, 296
    s_cbranch_scc1 .ap_47
    s_waitcnt vmcnt(1)
.ap_47:
    s_add_u32 s63, s69, 147456
    buffer_load_dwordx4 v[72:75], v1, s[40:43], s63 offen nt
    s_waitcnt vmcnt(3)
    s_add_u32 m0, s100, 24576
    s_add_u32 s56, s101, 221184
    buffer_load_dwordx4 v6, s[48:51], s56 offen nt lds
    s_memrealtime s[8:9]
    s_waitcnt lgkmcnt(0)
    s_sub_u32 s8, s8, s30
    s_cmpk_ge_u32 s8, 482
    s_cbranch_scc1 .ap_48
    s_waitcnt vmcnt(4)
    s_cmpk_ge_u32 s8, 417
    s_cbranch_scc1 .ap_48
    s_waitcnt vmcnt(3)
    s_bitcmp1_b64 s[14:15], 11
    s_cbranch_scc0 1
    s_waitcnt vmcnt(2)
    s_cmpk_ge_u32 s8, 342
    s_cbranch_scc1 .ap_48
    s_waitcnt vmcnt(1)
.ap_48:
    s_add_u32 s63, s69, 155648
    buffer_load_dwordx4 v[76:79], v1, s[40:43], s63 offen nt
    s_waitcnt lgkmcnt(0)
    s_mul_i32 s34, s34, 0x9e3779b1
    s_add_u32 s34, s34, 0x7f4a7c15
    s_memrealtime s[8:9]
    s_waitcnt lgkmcnt(0)
    s_sub_u32 s8, s8, s30
    s_cmpk_ge_u32 s8, 528
    s_cbranch_scc1 .ap_49
    s_waitcnt vmcnt(5)
    s_cmpk_ge_u32 s8, 463
    s_cbranch_scc1 .ap_49
    s_waitcnt vmcnt(3)
    s_bitcmp1_b64 s[14:15], 12
    s_cbranch_scc0 1
    s_waitcnt vmcnt(2)
    s_cmpk_ge_u32 s8, 388
    s_cbranch_scc1 .ap_49
    s_waitcnt vmcnt(1)
.ap_49:
    s_add_u32 s63, s69, 163840
    buffer_load_dwordx4 v[104:107], v1, s[40:43], s63 offen nt
    s_memrealtime s[8:9]
    s_waitcnt lgkmcnt(0)
    s_sub_u32 s8, s8, s30
    s_cmpk_ge_u32 s8, 574
    s_cbranch_scc1 .ap_50
    s_waitcnt vmcnt(5)
    s_cmpk_ge_u32 s8, 509
    s_cbranch_scc1 .ap_50
    s_waitcnt vmcnt(3)
    s_bitcmp1_b64 s[14:15], 13
    s_cbranch_scc0 1
    s_waitcnt vmcnt(2)
    s_cmpk_ge_u32 s8, 434
    s_cbranch_scc1 .ap_50
    s_waitcnt vmcnt(1)
.ap_50:
    s_add_u32 s63, s69, 172032
    buffer_load_dwordx4 v[108:111], v1, s[40:43], s63 offen nt
    s_waitcnt vmcnt(3)
    s_add_u32 m0, s100, 32768
    s_add_u32 s56, s101, 294912
    buffer_load_dwordx4 v6, s[48:51], s56 offen nt lds
    s_memrealtime s[8:9]
    s_waitcnt lgkmcnt(0)
    s_sub_u32 s8, s8, s30
    s_cmpk_ge_u32 s8, 620
    s_cbranch_scc1 .ap_51
    s_waitcnt vmcnt(4)
    s_cmpk_ge_u32 s8, 555
    s_cbranch_scc1 .ap_51
    s_waitcnt vmcnt(3)
    s_bitcmp1_b64 s[14:15], 14
    s_cbranch_scc0 1
    s_waitcnt vmcnt(2)
    s_cmpk_ge_u32 s8, 480
    s_cbranch_scc1 .ap_51
    s_waitcnt vmcnt(1)
.ap_51:
    s_add_u32 s63, s69, 180224
    buffer_load_dwordx4 v[136:139], v1, s[40:43], s63 offen nt
    s_memrealtime s[8:9]
    s_waitcnt lgkmcnt(0)
    s_sub_u32 s8, s8, s30
    s_cmpk_ge_u32 s8, 666
    s_cbranch_scc1 .ap_52
    s_waitcnt vmcnt(5)
    s_cmpk_ge_u32 s8, 601
    s_cbranch_scc1 .ap_52
    s_waitcnt vmcnt(3)
    s_bitcmp1_b64 s[14:15], 15
    s_cbranch_scc0 1
    s_waitcnt vmcnt(2)
    s_cmpk_ge_u32 s8, 526
    s_cbranch_scc1 .ap_52
    s_waitcnt vmcnt(1)
.ap_52:
    s_add_u32 s63, s69, 188416
    buffer_load_dwordx4 v[140:143], v1, s[40:43], s63 offen nt
    s_memrealtime s[8:9]
    s_waitcnt lgkmcnt(0)
    s_sub_u32 s8, s8, s30
    s_cmpk_ge_u32 s8, 712
    s_cbranch_scc1 .ap_53
    s_waitcnt vmcnt(5)
    s_cmpk_ge_u32 s8, 647
    s_cbranch_scc1 .ap_53
    s_waitcnt vmcnt(3)
    s_bitcmp1_b64 s[14:15], 16
    s_cbranch_scc0 1
    s_waitcnt vmcnt(2)
    s_cmpk_ge_u32 s8, 572
    s_cbranch_scc1 .ap_53
    s_waitcnt vmcnt(1)
.ap_53:
    s_add_u32 s63, s69, 262144
    buffer_load_dwordx4 v[48:51], v1, s[40:43], s63 offen nt
    s_waitcnt vmcnt(3)
    s_add_u32 m0, s100, 40960
    s_add_u32 s56, s101, 368640
    buffer_load_dwordx4 v6, s[48:51], s56 offen nt lds
    s_memrealtime s[8:9]
    s_waitcnt lgkmcnt(0)
    s_sub_u32 s8, s8, s30
    s_cmpk_ge_u32 s8, 758
    s_cbranch_scc1 .ap_54
    s_waitcnt vmcnt(4)
    s_cmpk_ge_u32 s8, 693
    s_cbranch_scc1 .ap_54
    s_waitcnt vmcnt(3)
    s_bitcmp1_b64 s[14:15], 17
    s_cbranch_scc0 1
    s_waitcnt vmcnt(2)
    s_cmpk_ge_u32 s8, 618
    s_cbranch_scc1 .ap_54
    s_waitcnt vmcnt(1)
.ap_54:
    s_add_u32 s63, s69, 270336
    buffer_load_dwordx4 v[52:55], v1, s[40:43], s63 offen nt
    s_memrealtime s[8:9]
    s_waitcnt lgkmcnt(0)
    s_sub_u32 s8, s8, s30
    s_cmpk_ge_u32 s8, 804
    s_cbranch_scc1 .ap_55
    s_waitcnt vmcnt(5)
    s_cmpk_ge_u32 s8, 739
    s_cbranch_scc1 .ap_55
    s_waitcnt vmcnt(3)
    s_bitcmp1_b64 s[14:15], 18
    s_cbranch_scc0 1
    s_waitcnt vmcnt(2)
    s_cmpk_ge_u32 s8, 664
    s_cbranch_scc1 .ap_55
    s_waitcnt vmcnt(1)
.ap_55:
    s_add_u32 s63, s69, 278528
    buffer_load_dwordx4 v[80:83], v1, s[40:43], s63 offen nt
    v_and_b32 v157, 7, v0
    v_lshlrev_b32 v157, 7, v157
    s_mov_b32 s63, 0x400
    buffer_load_dword v156, v157, s[36:39], s63 offen
    s_memrealtime s[8:9]
    s_waitcnt lgkmcnt(0)
    s_sub_u32 s8, s8, s30
    s_cmpk_ge_u32 s8, 850
    s_cbranch_scc1 .ap_56
    s_waitcnt vmcnt(6)
    s_cmpk_ge_u32 s8, 785
    s_cbranch_scc1 .ap_56
    s_waitcnt vmcnt(4)
    s_bitcmp1_b64 s[14:15], 19
    s_cbranch_scc0 1
    s_waitcnt vmcnt(3)
    s_cmpk_ge_u32 s8, 710
    s_cbranch_scc1 .ap_56
    s_waitcnt vmcnt(2)
.ap_56:
    s_add_u32 s63, s69, 286720
    buffer_load_dwordx4 v[84:87], v1, s[40:43], s63 offen nt
    s_waitcnt vmcnt(4)
    s_add_u32 m0, s100, 49152
    s_add_u32 s56, s101, 442368
    buffer_load_dwordx4 v6, s[48:51], s56 offen nt lds
    s_memrealtime s[8:9]
    s_waitcnt lgkmcnt(0)
    s_sub_u32 s8, s8, s30
    s_cmpk_ge_u32 s8, 895
    s_cbranch_scc1 .ap_57
    s_waitcnt vmcnt(5)
    s_cmpk_ge_u32 s8, 830
    s_cbranch_scc1 .ap_57
    s_waitcnt vmcnt(4)
    s_bitcmp1_b64 s[14:15], 20
    s_cbranch_scc0 1
    s_waitcnt vmcnt(3)
    s_cmpk_ge_u32 s8, 755
    s_cbranch_scc1 .ap_57
    s_waitcnt vmcnt(1)
.ap_57:
    s_add_u32 s63, s69, 294912
    buffer_load_dwordx4 v[112:115], v1, s[40:43], s63 offen nt
    s_memrealtime s[8:9]
    s_waitcnt lgkmcnt(0)
    s_sub_u32 s8, s8, s30
    s_cmpk_ge_u32 s8, 940
    s_cbranch_scc1 .ap_58
    s_waitcnt vmcnt(6)
    s_cmpk_ge_u32 s8, 875
    s_cbranch_scc1 .ap_58
    s_waitcnt vmcnt(4)
    s_bitcmp1_b64 s[14:15], 21
    s_cbranch_scc0 1
    s_waitcnt vmcnt(2)
    s_cmpk_ge_u32 s8, 800
    s_cbranch_scc1 .ap_58
    s_waitcnt vmcnt(1)
.ap_58:
    s_add_u32 s63, s69, 303104
    buffer_load_dwordx4 v[116:119], v1, s[40:43], s63 offen nt
    s_memrealtime s[8:9]
    s_waitcnt lgkmcnt(0)
    s_sub_u32 s8, s8, s30
    s_cmpk_ge_u32 s8, 985
    s_cbranch_scc1 .ap_59
    s_waitcnt vmcnt(6)
    s_cmpk_ge_u32 s8, 920
    s_cbranch_scc1 .ap_59
    s_waitcnt vmcnt(3)
    s_bitcmp1_b64 s[14:15], 22
    s_cbranch_scc0 1
    s_waitcnt vmcnt(2)
    s_cmpk_ge_u32 s8, 845
    s_cbranch_scc1 .ap_59
    s_waitcnt vmcnt(1)
.ap_59:
    s_add_u32 s63, s69, 311296
    buffer_load_dwordx4 v[144:147], v1, s[40:43], s63 offen nt
    s_waitcnt vmcnt(5)
    s_sub_u32 s63, s70, 300
    v_subrev_u32 v156, s63, v156
    v_mov_b32 v157, 600
    v_cmp_lt_u32 s[8:9], v156, v157
    v_add_u32_dpp v156, v156, v156 quad_perm:[1,0,3,2] row_mask:0xf bank_mask:0xf
    s_nop 1
    v_add_u32_dpp v156, v156, v156 quad_perm:[2,3,0,1] row_mask:0xf bank_mask:0xf
    s_nop 1
    v_add_u32_dpp v156, v156, v156 row_ror:4 row_mask:0xf bank_mask:0xf
    s_nop 0
    v_readfirstlane_b32 s63, v156
    s_cmp_eq_u64 s[8:9], -1
    s_nop 3
    s_cbranch_scc0 .et_60
    s_lshr_b32 s63, s63, 3
    s_sub_u32 s63, s63, 300
    s_add_u32 s30, s30, s63
.et_60:
    s_waitcnt vmcnt(3)
    s_add_u32 m0, s100, 57344
    s_add_u32 s56, s101, 516096
    buffer_load_dwordx4 v6, s[48:51], s56 offen nt lds
    s_memrealtime s[8:9]
    s_waitcnt lgkmcnt(0)
    s_sub_u32 s8, s8, s30
    s_cmpk_ge_u32 s8, 1030
    s_cbranch_scc1 .ap_61
    s_waitcnt vmcnt(4)
    s_cmpk_ge_u32 s8, 965
    s_cbranch_scc1 .ap_61
    s_waitcnt vmcnt(3)
    s_bitcmp1_b64 s[14:15], 23
    s_cbranch_scc0 1
    s_waitcnt vmcnt(2)
    s_cmpk_ge_u32 s8, 890
    s_cbranch_scc1 .ap_61
    s_waitcnt vmcnt(1)
.ap_61:
    s_add_u32 s63, s69, 319488
    buffer_load_dwordx4 v[148:151], v1, s[40:43], s63 offen nt
    s_memrealtime s[8:9]
    s_waitcnt lgkmcnt(0)
    s_sub_u32 s8, s8, s30
    s_cmpk_ge_u32 s8, 1075
    s_cbranch_scc1 .ap_62
    s_waitcnt vmcnt(5)
    s_cmpk_ge_u32 s8, 1010
    s_cbranch_scc1 .ap_62
    s_waitcnt vmcnt(3)
    s_bitcmp1_b64 s[14:15], 24
    s_cbranch_scc0 1
    s_waitcnt vmcnt(2)
    s_cmpk_ge_u32 s8, 935
    s_cbranch_scc1 .ap_62
    s_waitcnt vmcnt(1)
.ap_62:
    s_add_u32 s63, s69, 393216
    buffer_load_dwordx4 v[56:59], v1, s[40:43], s63 offen nt
    s_memrealtime s[8:9]
    s_waitcnt lgkmcnt(0)
    s_sub_u32 s8, s8, s30
    s_cmpk_ge_u32 s8, 1120
    s_cbranch_scc1 .ap_63
    s_waitcnt vmcnt(5)
    s_cmpk_ge_u32 s8, 1055
    s_cbranch_scc1 .ap_63
    s_waitcnt vmcnt(3)
    s_bitcmp1_b64 s[14:15], 25
    s_cbranch_scc0 1
    s_waitcnt vmcnt(2)
    s_cmpk_ge_u32 s8, 980
    s_cbranch_scc1 .ap_63
    s_waitcnt vmcnt(1)
.ap_63:
    s_add_u32 s63, s69, 401408
    buffer_load_dwordx4 v[60:63], v1, s[40:43], s63 offen nt
.Latt_ar:
    v_and_b32 v8, 1, v0
    v_lshlrev_b32 v8, 8, v8
    v_and_b32 v9, 0x3c, v0
    v_lshl_add_u32 v9, v9, 2, v8
    v_lshlrev_b32 v7, 1, v9
    v_and_b32 v9, 0x3c, v0
    v_lshrrev_b32 v8, 4, v8
    v_and_b32 v9, 2, v0
    v_lshl_add_u32 v9, v9, 6, v8
    s_lshl_b32 s58, s66, 14
    s_lshl_b32 s59, s67, 10
    s_add_u32 s58, s58, s59
    s_add_u32 s58, s58, 0x40000
    s_lshl4_add_u32 s59, s66, s67
    s_lshl_b32 s59, s59, 8
    s_add_u32 s59, s59, 0x200000
    s_memrealtime s[8:9]
    s_waitcnt vmcnt(8)
    s_waitcnt lgkmcnt(0)
    s_sub_u32 s8, s8, s30
    s_cmpk_ge_u32 s8, 1147
    s_cbranch_scc1 .ap_64
    s_waitcnt vmcnt(5)
    s_cmpk_ge_u32 s8, 1082
    s_cbranch_scc1 .ap_64
    s_waitcnt vmcnt(3)
    s_bitcmp1_b64 s[14:15], 26
    s_cbranch_scc0 1
    s_waitcnt vmcnt(2)
    s_cmpk_ge_u32 s8, 1007
    s_cbranch_scc1 .ap_64
    s_waitcnt vmcnt(1)
.ap_64:
    s_add_u32 s63, s69, 409600
    buffer_load_dwordx4 v[88:91], v1, s[40:43], s63 offen nt
    s_memrealtime s[8:9]
    s_waitcnt vmcnt(8)
    s_waitcnt lgkmcnt(0)
    s_sub_u32 s8, s8, s30
    s_cmpk_ge_u32 s8, 1174
    s_cbranch_scc1 .ap_65
    s_waitcnt vmcnt(5)
    s_cmpk_ge_u32 s8, 1109
    s_cbranch_scc1 .ap_65
    s_waitcnt vmcnt(3)
    s_bitcmp1_b64 s[14:15], 27
    s_cbranch_scc0 1
    s_waitcnt vmcnt(2)
    s_cmpk_ge_u32 s8, 1034
    s_cbranch_scc1 .ap_65
    s_waitcnt vmcnt(1)
.ap_65:
    s_add_u32 s63, s69, 417792
    buffer_load_dwordx4 v[92:95], v1, s[40:43], s63 offen nt
    s_memrealtime s[8:9]
    s_waitcnt vmcnt(8)
    s_waitcnt lgkmcnt(0)
    s_sub_u32 s8, s8, s30
    s_cmpk_ge_u32 s8, 1201
    s_cbranch_scc1 .ap_66
    s_waitcnt vmcnt(5)
    s_cmpk_ge_u32 s8, 1136
    s_cbranch_scc1 .ap_66
    s_waitcnt vmcnt(3)
    s_bitcmp1_b64 s[14:15], 28
    s_cbranch_scc0 1
    s_waitcnt vmcnt(2)
    s_cmpk_ge_u32 s8, 1061
    s_cbranch_scc1 .ap_66
    s_waitcnt vmcnt(1)
.ap_66:
    s_add_u32 s63, s69, 425984
    buffer_load_dwordx4 v[120:123], v1, s[40:43], s63 offen nt
    s_memrealtime s[8:9]
    s_waitcnt vmcnt(8)
    s_waitcnt lgkmcnt(0)
    s_sub_u32 s8, s8, s30
    s_cmpk_ge_u32 s8, 1228
    s_cbranch_scc1 .ap_67
    s_waitcnt vmcnt(5)
    s_cmpk_ge_u32 s8, 1163
    s_cbranch_scc1 .ap_67
    s_waitcnt vmcnt(3)
    s_bitcmp1_b64 s[14:15], 29
    s_cbranch_scc0 1
    s_waitcnt vmcnt(2)
    s_cmpk_ge_u32 s8, 1088
    s_cbranch_scc1 .ap_67
    s_waitcnt vmcnt(1)
.ap_67:
    s_add_u32 s63, s69, 434176
    buffer_load_dwordx4 v[124:127], v1, s[40:43], s63 offen nt
    s_memrealtime s[8:9]
    s_waitcnt vmcnt(8)
    s_waitcnt lgkmcnt(0)
    s_sub_u32 s8, s8, s30
    s_cmpk_ge_u32 s8, 1255
    s_cbranch_scc1 .ap_68
    s_waitcnt vmcnt(5)
    s_cmpk_ge_u32 s8, 1190
    s_cbranch_scc1 .ap_68
    s_waitcnt vmcnt(3)
    s_bitcmp1_b64 s[14:15], 30
    s_cbranch_scc0 1
    s_waitcnt vmcnt(2)
    s_cmpk_ge_u32 s8, 1115
    s_cbranch_scc1 .ap_68
    s_waitcnt vmcnt(1)
.ap_68:
    s_add_u32 s63, s69, 442368
    buffer_load_dwordx4 v[152:155], v1, s[40:43], s63 offen nt
    s_memrealtime s[8:9]
    s_waitcnt vmcnt(8)
    s_waitcnt lgkmcnt(0)
    s_sub_u32 s8, s8, s30
    s_cmpk_ge_u32 s8, 1282
    s_cbranch_scc1 .ap_69
    s_waitcnt vmcnt(5)
    s_cmpk_ge_u32 s8, 1217
    s_cbranch_scc1 .ap_69
    s_waitcnt vmcnt(3)
    s_bitcmp1_b64 s[14:15], 31
    s_cbranch_scc0 1
    s_waitcnt vmcnt(2)
    s_cmpk_ge_u32 s8, 1142
    s_cbranch_scc1 .ap_69
    s_waitcnt vmcnt(1)
.ap_69:
    s_add_u32 s63, s69, 450560
    buffer_load_dwordx4 v[156:159], v1, s[40:43], s63 offen nt
    buffer_load_dwordx4 v[16:19], v7, s[36:39], s58 offen offset:0 sc1
    buffer_load_dwordx4 v[20:23], v7, s[36:39], s58 offen offset:16 sc1
    s_memrealtime s[8:9]
    s_waitcnt vmcnt(8)
    s_waitcnt lgkmcnt(0)
    s_sub_u32 s8, s8, s30
    s_cmpk_ge_u32 s8, 1309
    s_cbranch_scc1 .ap_70
    s_waitcnt vmcnt(5)
    s_cmpk_ge_u32 s8, 1244
    s_cbranch_scc1 .ap_70
    s_waitcnt vmcnt(3)
    s_bitcmp1_b64 s[14:15], 32
    s_cbranch_scc0 1
    s_waitcnt vmcnt(2)
    s_cmpk_ge_u32 s8, 1169
    s_cbranch_scc1 .ap_70
    s_waitcnt vmcnt(1)
.ap_70:
    s_add_u32 s63, s69, 0
    buffer_load_dwordx4 v[160:163], v2, s[44:47], s63 offen nt
    s_memrealtime s[8:9]
    s_waitcnt vmcnt(8)
    s_waitcnt lgkmcnt(0)
    s_sub_u32 s8, s8, s30
    s_cmpk_ge_u32 s8, 1336
    s_cbranch_scc1 .ap_71
    s_waitcnt vmcnt(5)
    s_cmpk_ge_u32 s8, 1271
    s_cbranch_scc1 .ap_71
    s_waitcnt vmcnt(3)
    s_bitcmp1_b64 s[14:15], 33
    s_cbranch_scc0 1
    s_waitcnt vmcnt(2)
    s_cmpk_ge_u32 s8, 1196
    s_cbranch_scc1 .ap_71
    s_waitcnt vmcnt(1)
.ap_71:
    s_add_u32 s63, s69, 8192
    buffer_load_dwordx4 v[164:167], v2, s[44:47], s63 offen nt
    s_memrealtime s[8:9]
    s_waitcnt vmcnt(8)
    s_waitcnt lgkmcnt(0)
    s_sub_u32 s8, s8, s30
    s_cmpk_ge_u32 s8, 1363
    s_cbranch_scc1 .ap_72
    s_waitcnt vmcnt(5)
    s_cmpk_ge_u32 s8, 1298
    s_cbranch_scc1 .ap_72
    s_waitcnt vmcnt(3)
    s_bitcmp1_b64 s[14:15], 34
    s_cbranch_scc0 1
    s_waitcnt vmcnt(2)
    s_cmpk_ge_u32 s8, 1223
    s_cbranch_scc1 .ap_72
    s_waitcnt vmcnt(1)
.ap_72:
    s_add_u32 s63, s69, 16384
    buffer_load_dwordx4 v[168:171], v2, s[44:47], s63 offen nt
    s_waitcnt vmcnt(3)
    s_branch .gpc_74
.gp_73:
    buffer_load_dwordx4 v[16:19], v7, s[36:39], s58 offen offset:0 sc1
    buffer_load_dwordx4 v[20:23], v7, s[36:39], s58 offen offset:16 sc1
    s_waitcnt vmcnt(0)
.gpc_74:
    v_min_u32 v10, v17, v19
    v_max_u32 v11, v17, v19
    v_min3_u32 v10, v10, v21, v23
    v_max3_u32 v11, v11, v21, v23
    v_cmp_eq_u32 vcc, s34, v10
    v_cmp_eq_u32 s[56:57], s34, v11
    s_and_b64 vcc, vcc, s[56:57]
    s_cmp_eq_u64 vcc, exec
    s_nop 2
    s_cbranch_scc1 .gpd_75
    s_sub_u32 s35, s35, 1
    s_cbranch_scc1 .Lexit
    s_sleep 1
    s_branch .gp_73
.gpd_75:
    s_mov_b32 vcc_lo, 0xcccccccc
    s_mov_b32 vcc_hi, 0xcccccccc
    v_cndmask_b32_e64 v24, v16, 0, vcc
    v_cndmask_b32_e64 v25, v18, 0, vcc
    v_cndmask_b32_e64 v26, v20, 0, vcc
    v_cndmask_b32_e64 v27, v22, 0, vcc
    v_cndmask_b32_e32 v28, 0, v16, vcc
    v_cndmask_b32_e32 v29, 0, v18, vcc
    v_cndmask_b32_e32 v30, 0, v20, vcc
    v_cndmask_b32_e32 v31, 0, v22, vcc
    v_mfma_f32_16x16x32_bf16 v[16:19], v[32:35], v[24:27], 0
    v_mfma_f32_16x16x32_bf16 v[32:35], v[40:43], v[24:27], 0
    v_mfma_f32_16x16x32_bf16 v[16:19], v[36:39], v[28:31], v[16:19]
    v_mfma_f32_16x16x32_bf16 v[40:43], v[48:51], v[24:27], 0
    v_mfma_f32_16x16x32_bf16 v[32:35], v[44:47], v[28:31], v[32:35]
    v_mfma_f32_16x16x32_bf16 v[48:51], v[56:59], v[24:27], 0
    v_mfma_f32_16x16x32_bf16 v[40:43], v[52:55], v[28:31], v[40:43]
    v_mfma_f32_16x16x32_bf16 v[56:59], v[64:67], v[24:27], 0
    v_mfma_f32_16x16x32_bf16 v[48:51], v[60:63], v[28:31], v[48:51]
    s_nop 1
    v_add_f32_dpp v10, v17, v16 row_ror:12 row_mask:0xf bank_mask:0x1
    s_memrealtime s[8:9]
    s_waitcnt lgkmcnt(0)
    s_sub_u32 s8, s8, s30
    s_cmpk_ge_u32 s8, 1390
    s_nop 0
    s_cbranch_scc1 .ap_76
    s_waitcnt vmcnt(3)
    s_cmpk_ge_u32 s8, 1325
    s_cbranch_scc1 .ap_76
    s_waitcnt vmcnt(3)
    s_bitcmp1_b64 s[14:15], 35
    s_cbranch_scc0 1
    s_waitcnt vmcnt(2)
    s_cmpk_ge_u32 s8, 1250
    s_cbranch_scc1 .ap_76
    s_waitcnt vmcnt(1)
.ap_76:
    s_add_u32 s63, s69, 24576
    buffer_load_dwordx4 v[172:175], v2, s[44:47], s63 offen nt
    v_mfma_f32_16x16x32_bf16 v[64:67], v[72:75], v[24:27], 0
    v_mfma_f32_16x16x32_bf16 v[56:59], v[68:71], v[28:31], v[56:59]
    v_add_f32_dpp v11, v33, v32 row_ror:12 row_mask:0xf bank_mask:0x1
    v_add_f32_dpp v10, v18, v10 row_ror:8 row_mask:0xf bank_mask:0x1
    v_mfma_f32_16x16x32_bf16 v[72:75], v[80:83], v[24:27], 0
    v_mfma_f32_16x16x32_bf16 v[64:67], v[76:79], v[28:31], v[64:67]
    v_add_f32_dpp v12, v41, v40 row_ror:12 row_mask:0xf bank_mask:0x1
    v_add_f32_dpp v11, v34, v11 row_ror:8 row_mask:0xf bank_mask:0x1
    v_add_f32_dpp v10, v19, v10 row_ror:4 row_mask:0xf bank_mask:0x1
    v_mfma_f32_16x16x32_bf16 v[80:83], v[88:91], v[24:27], 0
    v_mfma_f32_16x16x32_bf16 v[72:75], v[84:87], v[28:31], v[72:75]
    v_add_f32_dpp v13, v49, v48 row_ror:12 row_mask:0xf bank_mask:0x1
    v_add_f32_dpp v12, v42, v12 row_ror:8 row_mask:0xf bank_mask:0x1
    v_add_f32_dpp v11, v35, v11 row_ror:4 row_mask:0xf bank_mask:0x1
    v_mfma_f32_16x16x32_bf16 v[88:91], v[96:99], v[24:27], 0
    v_mfma_f32_16x16x32_bf16 v[80:83], v[92:95], v[28:31], v[80:83]
    v_add_f32_dpp v10, v58, v57 row_ror:12 row_mask:0xf bank_mask:0x2
    v_add_f32_dpp v13, v50, v13 row_ror:8 row_mask:0xf bank_mask:0x1
    v_add_f32_dpp v12, v43, v12 row_ror:4 row_mask:0xf bank_mask:0x1
    s_memrealtime s[8:9]
    s_waitcnt lgkmcnt(0)
    s_sub_u32 s8, s8, s30
    s_cmpk_ge_u32 s8, 1417
    s_nop 0
    s_cbranch_scc1 .ap_77
    s_waitcnt vmcnt(4)
    s_cmpk_ge_u32 s8, 1352
    s_cbranch_scc1 .ap_77
    s_waitcnt vmcnt(3)
    s_bitcmp1_b64 s[14:15], 36
    s_cbranch_scc0 1
    s_waitcnt vmcnt(2)
    s_cmpk_ge_u32 s8, 1277
    s_cbranch_scc1 .ap_77
    s_waitcnt vmcnt(1)
.ap_77:
    s_add_u32 s63, s69, 32768
    buffer_load_dwordx4 v[176:179], v2, s[44:47], s63 offen nt
    v_mfma_f32_16x16x32_bf16 v[96:99], v[104:107], v[24:27], 0
    v_mfma_f32_16x16x32_bf16 v[88:91], v[100:103], v[28:31], v[88:91]
    v_add_f32_dpp v11, v66, v65 row_ror:12 row_mask:0xf bank_mask:0x2
    v_add_f32_dpp v10, v59, v10 row_ror:8 row_mask:0xf bank_mask:0x2
    v_add_f32_dpp v13, v51, v13 row_ror:4 row_mask:0xf bank_mask:0x1
    v_mfma_f32_16x16x32_bf16 v[104:107], v[112:115], v[24:27], 0
    v_mfma_f32_16x16x32_bf16 v[96:99], v[108:111], v[28:31], v[96:99]
    v_add_f32_dpp v12, v74, v73 row_ror:12 row_mask:0xf bank_mask:0x2
    v_add_f32_dpp v11, v67, v11 row_ror:8 row_mask:0xf bank_mask:0x2
    v_add_f32_dpp v10, v56, v10 row_ror:4 row_mask:0xf bank_mask:0x2
    v_mfma_f32_16x16x32_bf16 v[112:115], v[120:123], v[24:27], 0
    v_mfma_f32_16x16x32_bf16 v[104:107], v[116:119], v[28:31], v[104:107]
    v_add_f32_dpp v13, v82, v81 row_ror:12 row_mask:0xf bank_mask:0x2
    v_add_f32_dpp v12, v75, v12 row_ror:8 row_mask:0xf bank_mask:0x2
    v_add_f32_dpp v11, v64, v11 row_ror:4 row_mask:0xf bank_mask:0x2
    v_mfma_f32_16x16x32_bf16 v[120:123], v[128:131], v[24:27], 0
    v_mfma_f32_16x16x32_bf16 v[112:115], v[124:127], v[28:31], v[112:115]
    v_add_f32_dpp v10, v91, v90 row_ror:12 row_mask:0xf bank_mask:0x4
    v_add_f32_dpp v13, v83, v13 row_ror:8 row_mask:0xf bank_mask:0x2
    v_add_f32_dpp v12, v72, v12 row_ror:4 row_mask:0xf bank_mask:0x2
    s_memrealtime s[8:9]
    s_waitcnt lgkmcnt(0)
    s_sub_u32 s8, s8, s30
    s_cmpk_ge_u32 s8, 1444
    s_nop 0
    s_cbranch_scc1 .ap_78
    s_waitcnt vmcnt(5)
    s_cmpk_ge_u32 s8, 1379
    s_cbranch_scc1 .ap_78
    s_waitcnt vmcnt(3)
    s_bitcmp1_b64 s[14:15], 37
    s_cbranch_scc0 1
    s_waitcnt vmcnt(2)
    s_cmpk_ge_u32 s8, 1304
    s_cbranch_scc1 .ap_78
    s_waitcnt vmcnt(1)
.ap_78:
    s_add_u32 s63, s69, 40960
    buffer_load_dwordx4 v[180:183], v2, s[44:47], s63 offen nt
    v_mfma_f32_16x16x32_bf16 v[128:131], v[136:139], v[24:27], 0
    v_mfma_f32_16x16x32_bf16 v[120:123], v[132:135], v[28:31], v[120:123]
    v_add_f32_dpp v11, v99, v98 row_ror:12 row_mask:0xf bank_mask:0x4
    v_add_f32_dpp v10, v88, v10 row_ror:8 row_mask:0xf bank_mask:0x4
    v_add_f32_dpp v13, v80, v13 row_ror:4 row_mask:0xf bank_mask:0x2
    v_mfma_f32_16x16x32_bf16 v[136:139], v[144:147], v[24:27], 0
    v_mfma_f32_16x16x32_bf16 v[128:131], v[140:143], v[28:31], v[128:131]
    v_add_f32_dpp v12, v107, v106 row_ror:12 row_mask:0xf bank_mask:0x4
    v_add_f32_dpp v11, v96, v11 row_ror:8 row_mask:0xf bank_mask:0x4
    v_add_f32_dpp v10, v89, v10 row_ror:4 row_mask:0xf bank_mask:0x4
    v_mfma_f32_16x16x32_bf16 v[144:147], v[152:155], v[24:27], 0
    v_mfma_f32_16x16x32_bf16 v[136:139], v[148:151], v[28:31], v[136:139]
    v_add_f32_dpp v13, v115, v114 row_ror:12 row_mask:0xf bank_mask:0x4
    v_add_f32_dpp v12, v104, v12 row_ror:8 row_mask:0xf bank_mask:0x4
    v_add_f32_dpp v11, v97, v11 row_ror:4 row_mask:0xf bank_mask:0x4
    v_mfma_f32_16x16x32_bf16 v[144:147], v[156:159], v[28:31], v[144:147]
    v_add_f32_dpp v10, v120, v123 row_ror:12 row_mask:0xf bank_mask:0x8
    v_add_f32_dpp v13, v112, v13 row_ror:8 row_mask:0xf bank_mask:0x4
    v_add_f32_dpp v12, v105, v12 row_ror:4 row_mask:0xf bank_mask:0x4
    s_memrealtime s[8:9]
    s_waitcnt lgkmcnt(0)
    s_sub_u32 s8, s8, s30
    s_cmpk_ge_u32 s8, 1471
    s_nop 0
    s_cbranch_scc1 .ap_79
    s_waitcnt vmcnt(5)
    s_cmpk_ge_u32 s8, 1406
    s_cbranch_scc1 .ap_79
    s_waitcnt vmcnt(3)
    s_bitcmp1_b64 s[14:15], 38
    s_cbranch_scc0 1
    s_waitcnt vmcnt(2)
    s_cmpk_ge_u32 s8, 1331
    s_cbranch_scc1 .ap_79
    s_waitcnt vmcnt(1)
.ap_79:
    s_add_u32 s63, s69, 49152
    buffer_load_dwordx4 v[184:187], v2, s[44:47], s63 offen nt
    v_add_f32_dpp v11, v128, v131 row_ror:12 row_mask:0xf bank_mask:0x8
    v_add_f32_dpp v10, v121, v10 row_ror:8 row_mask:0xf bank_mask:0x8
    v_add_f32_dpp v13, v113, v13 row_ror:4 row_mask:0xf bank_mask:0x4
    v_add_f32_dpp v12, v136, v139 row_ror:12 row_mask:0xf bank_mask:0x8
    v_add_f32_dpp v11, v129, v11 row_ror:8 row_mask:0xf bank_mask:0x8
    v_add_f32_dpp v10, v122, v10 row_ror:4 row_mask:0xf bank_mask:0x8
    v_add_f32_dpp v13, v144, v147 row_ror:12 row_mask:0xf bank_mask:0x8
    v_add_f32_dpp v12, v137, v12 row_ror:8 row_mask:0xf bank_mask:0x8
    v_add_f32_dpp v11, v130, v11 row_ror:4 row_mask:0xf bank_mask:0x8
    v_add_f32_dpp v13, v145, v13 row_ror:8 row_mask:0xf bank_mask:0x8
    v_add_f32_dpp v12, v138, v12 row_ror:4 row_mask:0xf bank_mask:0x8
    s_memrealtime s[8:9]
    s_waitcnt lgkmcnt(0)
    s_sub_u32 s8, s8, s30
    s_cmpk_ge_u32 s8, 1498
    s_cbranch_scc1 .ap_80
    s_waitcnt vmcnt(5)
    s_cmpk_ge_u32 s8, 1433
    s_cbranch_scc1 .ap_80
    s_waitcnt vmcnt(3)
    s_bitcmp1_b64 s[14:15], 39
    s_cbranch_scc0 1
    s_waitcnt vmcnt(2)
    s_cmpk_ge_u32 s8, 1358
    s_cbranch_scc1 .ap_80
    s_waitcnt vmcnt(1)
.ap_80:
    s_add_u32 s63, s69, 57344
    buffer_load_dwordx4 v[188:191], v2, s[44:47], s63 offen nt
    v_add_f32_dpp v13, v146, v13 row_ror:4 row_mask:0xf bank_mask:0x8
    s_mov_b32 s60, 0x3db504f3
    s_mov_b32 s61, 0x3db504f3
    v_cvt_pk_bf16_f32 v10, 0, v10
    v_cvt_pk_bf16_f32 v11, 0, v11
    v_cvt_pk_bf16_f32 v12, 0, v12
    v_cvt_pk_bf16_f32 v13, 0, v13
    v_pk_mul_f32 v[10:11], v[10:11], s[60:61]
    v_pk_mul_f32 v[12:13], v[12:13], s[60:61]
    v_cvt_pk_bf16_f32 v10, 0, v10
    v_cvt_pk_bf16_f32 v11, 0, v11
    v_cvt_pk_bf16_f32 v12, 0, v12
    v_cvt_pk_bf16_f32 v13, 0, v13
    v_max_f32 v14, v10, v11
    v_max3_f32 v14, v14, v12, v13
    s_mov_b32 s60, 0x3fb8aa3b
    v_mov_b32 v22, s34
    v_mov_b32 v23, s34
    v_max_f32_dpp v14, v14, v14 quad_perm:[2,3,0,1] row_mask:0xf bank_mask:0xf
    s_nop 1
    v_max_f32_dpp v14, v14, v14 row_ror:4 row_mask:0xf bank_mask:0xf
    s_nop 1
    v_max_f32_dpp v14, v14, v14 row_ror:8 row_mask:0xf bank_mask:0xf
    v_mov_b32 v15, v14
    s_nop 1
    v_permlane16_swap_b32 v15, v14
    v_max_f32 v14, v15, v14
    v_mov_b32 v15, v14
    s_nop 1
    v_permlane32_swap_b32 v15, v14
    v_max_f32 v14, v15, v14
    v_mul_f32 v15, 0xbfb8aa3b, v14
    v_fma_f32 v10, v10, s60, v15
    v_fma_f32 v11, v11, s60, v15
    v_fma_f32 v12, v12, s60, v15
    v_fma_f32 v13, v13, s60, v15
    v_exp_f32 v10, v10
    v_exp_f32 v11, v11
    v_exp_f32 v12, v12
    v_exp_f32 v13, v13
    v_mov_b32 v20, v14
    v_pk_add_f32 v[16:17], v[10:11], v[12:13]
    v_add_f32 v21, v16, v17
    s_lshl3_add_u32 s60, s68, s3
    s_lshl_b32 s60, s60, 5
    s_add_u32 s60, s60, s59
    v_add_f32_dpp v21, v21, v21 quad_perm:[2,3,0,1] row_mask:0xf bank_mask:0xf
    s_nop 1
    v_add_f32_dpp v21, v21, v21 row_ror:4 row_mask:0xf bank_mask:0xf
    s_nop 1
    v_add_f32_dpp v21, v21, v21 row_ror:8 row_mask:0xf bank_mask:0xf
    v_mov_b32 v15, v21
    s_nop 1
    v_permlane16_swap_b32 v15, v21
    v_add_f32 v21, v15, v21
    v_mov_b32 v15, v21
    s_nop 1
    v_permlane32_swap_b32 v15, v21
    v_add_f32 v21, v15, v21
    s_lshl_b32 s60, s3, 4
    s_add_u32 s60, s60, 159104
    v_add_u32 v16, s60, v3
    v_mov_b32 v17, 159232
    v_mov_b32 v18, 1
    s_mov_b64 exec, 3
    ds_write_b64 v16, v[20:21]
    s_mov_b64 exec, 1
    s_waitcnt lgkmcnt(0)
    ds_add_rtn_u32 v18, v17, v18
    s_mov_b64 exec, -1
    v_and_b32 v16, 0x78, v3
    v_add_u32 v16, 159104, v16
    s_waitcnt lgkmcnt(0)
    v_readfirstlane_b32 s60, v18
    s_cmp_lg_u32 s60, 7
    s_nop 3
    s_cbranch_scc1 .ml_81
    ds_read_b64 v[18:19], v16
    s_lshl_b32 s60, s68, 7
    s_add_u32 s60, s60, s59
    s_waitcnt lgkmcnt(0)
    v_mov_b32 v20, v18
    s_nop 1
    v_max_f32_dpp v20, v20, v20 quad_perm:[2,3,0,1] row_mask:0xf bank_mask:0xf
    s_nop 1
    v_max_f32_dpp v20, v20, v20 row_ror:4 row_mask:0xf bank_mask:0xf
    s_nop 1
    v_max_f32_dpp v20, v20, v20 row_ror:8 row_mask:0xf bank_mask:0xf
    v_sub_f32 v18, v18, v20
    v_mul_f32 v18, 0x3fb8aa3b, v18
    v_exp_f32 v18, v18
    s_nop 0
    v_mul_f32 v21, v18, v19
    s_nop 1
    v_add_f32_dpp v21, v21, v21 quad_perm:[2,3,0,1] row_mask:0xf bank_mask:0xf
    s_nop 1
    v_add_f32_dpp v21, v21, v21 row_ror:4 row_mask:0xf bank_mask:0xf
    s_nop 1
    v_add_f32_dpp v21, v21, v21 row_ror:8 row_mask:0xf bank_mask:0xf
    s_mov_b64 exec, 0xff
    buffer_store_dwordx4 v[20:23], v2, s[36:39], s60 offen sc1
    s_mov_b64 exec, -1
.ml_81:
    s_memrealtime s[8:9]
    s_waitcnt lgkmcnt(0)
    s_sub_u32 s8, s8, s30
    s_cmpk_ge_u32 s8, 1525
    s_cbranch_scc1 .ap_82
    s_waitcnt vmcnt(5)
    s_cmpk_ge_u32 s8, 1460
    s_cbranch_scc1 .ap_82
    s_waitcnt vmcnt(3)
    s_bitcmp1_b64 s[14:15], 40
    s_cbranch_scc0 1
    s_waitcnt vmcnt(2)
    s_cmpk_ge_u32 s8, 1385
    s_cbranch_scc1 .ap_82
    s_waitcnt vmcnt(1)
.ap_82:
    s_add_u32 s63, s69, 131072
    buffer_load_dwordx4 v[192:195], v2, s[44:47], s63 offen nt
    s_memrealtime s[8:9]
    s_waitcnt vmcnt(8)
    s_waitcnt lgkmcnt(0)
    s_sub_u32 s8, s8, s30
    s_cmpk_ge_u32 s8, 1552
    s_cbranch_scc1 .ap_83
    s_waitcnt vmcnt(5)
    s_cmpk_ge_u32 s8, 1487
    s_cbranch_scc1 .ap_83
    s_waitcnt vmcnt(3)
    s_bitcmp1_b64 s[14:15], 41
    s_cbranch_scc0 1
    s_waitcnt vmcnt(2)
    s_cmpk_ge_u32 s8, 1412
    s_cbranch_scc1 .ap_83
    s_waitcnt vmcnt(1)
.ap_83:
    s_add_u32 s63, s69, 139264
    buffer_load_dwordx4 v[196:199], v2, s[44:47], s63 offen nt
    s_memrealtime s[8:9]
    s_waitcnt vmcnt(8)
    s_waitcnt lgkmcnt(0)
    s_sub_u32 s8, s8, s30
    s_cmpk_ge_u32 s8, 1579
    s_cbranch_scc1 .ap_84
    s_waitcnt vmcnt(5)
    s_cmpk_ge_u32 s8, 1514
    s_cbranch_scc1 .ap_84
    s_waitcnt vmcnt(3)
    s_bitcmp1_b64 s[14:15], 42
    s_cbranch_scc0 1
    s_waitcnt vmcnt(2)
    s_cmpk_ge_u32 s8, 1439
    s_cbranch_scc1 .ap_84
    s_waitcnt vmcnt(1)
.ap_84:
    s_add_u32 s63, s69, 147456
    buffer_load_dwordx4 v[200:203], v2, s[44:47], s63 offen nt
    s_memrealtime s[8:9]
    s_waitcnt vmcnt(8)
    s_waitcnt lgkmcnt(0)
    s_sub_u32 s8, s8, s30
    s_cmpk_ge_u32 s8, 1606
    s_cbranch_scc1 .ap_85
    s_waitcnt vmcnt(5)
    s_cmpk_ge_u32 s8, 1541
    s_cbranch_scc1 .ap_85
    s_waitcnt vmcnt(3)
    s_bitcmp1_b64 s[14:15], 43
    s_cbranch_scc0 1
    s_waitcnt vmcnt(2)
    s_cmpk_ge_u32 s8, 1466
    s_cbranch_scc1 .ap_85
    s_waitcnt vmcnt(1)
.ap_85:
    s_add_u32 s63, s69, 155648
    buffer_load_dwordx4 v[204:207], v2, s[44:47], s63 offen nt
    s_memrealtime s[8:9]
    s_waitcnt vmcnt(8)
    s_waitcnt lgkmcnt(0)
    s_sub_u32 s8, s8, s30
    s_cmpk_ge_u32 s8, 1633
    s_cbranch_scc1 .ap_86
    s_waitcnt vmcnt(5)
    s_cmpk_ge_u32 s8, 1568
    s_cbranch_scc1 .ap_86
    s_waitcnt vmcnt(3)
    s_bitcmp1_b64 s[14:15], 44
    s_cbranch_scc0 1
    s_waitcnt vmcnt(2)
    s_cmpk_ge_u32 s8, 1493
    s_cbranch_scc1 .ap_86
    s_waitcnt vmcnt(1)
.ap_86:
    s_add_u32 s63, s69, 163840
    buffer_load_dwordx4 v[208:211], v2, s[44:47], s63 offen nt
    v_and_b32 v16, 15, v0
    v_lshrrev_b32 v17, 4, v0
    v_lshl_add_u32 v16, v16, 2, v17
    v_lshlrev_b32 v31, 1, v16
    s_lshl_b32 s56, s65, 7
    v_add_u32 v31, s56, v31
    v_and_b32 v6, -4, v31
    v_lshlrev_b32 v6, 1, v6
    s_mul_i32 s56, s3, 1152
    s_mov_b32 s52, s4
    s_and_b32 s53, s5, 0xffff
    s_mov_b32 s54, 0x2400
    s_mov_b32 s55, 0x00020000
    buffer_load_ushort v29, v31, s[52:55], s56 offen
    s_mul_i32 s101, s3, 2304
    s_add_u32 s101, s101, 0x15000
    s_add_u32 s99, s101, 36864
    s_add_u32 s100, s101, 73728
    s_add_u32 s33, s101, 110592
    buffer_load_dwordx2 v[72:73], v6, s[36:39], s101 offen offset:0 sc1
    s_cmp_lg_u32 s3, s64
    s_cbranch_scc1 .rin_87
    buffer_load_dwordx4 v[32:35], v2, s[36:39], s99 offen offset:0 sc1
    buffer_load_dwordx4 v[40:43], v2, s[36:39], s99 offen offset:1024 sc1
    buffer_load_dwordx2 v[48:49], v5, s[36:39], s99 offen offset:0 sc1
    buffer_load_dwordx4 v[56:59], v2, s[36:39], s100 offen offset:0 sc1
    buffer_load_dwordx4 v[64:67], v2, s[36:39], s100 offen offset:1024 sc1
    buffer_load_dwordx2 v[50:51], v5, s[36:39], s100 offen offset:0 sc1
    buffer_load_dwordx2 v[74:75], v6, s[36:39], s99 offen offset:0 sc1
    buffer_load_dwordx2 v[80:81], v6, s[36:39], s100 offen offset:0 sc1
    buffer_load_dwordx2 v[82:83], v6, s[36:39], s33 offen offset:0 sc1
    s_mov_b32 s48, s16
    s_and_b32 s49, s17, 0xffff
    s_mov_b32 s50, 0x480
    s_mov_b32 s51, 0x00020000
    buffer_load_dwordx2 v[88:89], v3, s[48:51], 0 offen
    buffer_load_dwordx2 v[90:91], v3, s[48:51], 0 offen offset:512
    buffer_load_dword v30, v4, s[48:51], 0 offen
.rin_87:
    s_memrealtime s[8:9]
    s_waitcnt vmcnt(10)
    s_waitcnt lgkmcnt(0)
    s_sub_u32 s8, s8, s30
    s_cmpk_ge_u32 s8, 1660
    s_cbranch_scc1 .ap_88
    s_waitcnt vmcnt(7)
    s_cmpk_ge_u32 s8, 1595
    s_cbranch_scc1 .ap_88
    s_waitcnt vmcnt(5)
    s_bitcmp1_b64 s[14:15], 45
    s_cbranch_scc0 1
    s_waitcnt vmcnt(4)
    s_cmpk_ge_u32 s8, 1520
    s_cbranch_scc1 .ap_88
    s_waitcnt vmcnt(3)
.ap_88:
    s_add_u32 s63, s69, 172032
    buffer_load_dwordx4 v[212:215], v2, s[44:47], s63 offen nt
    s_memrealtime s[8:9]
    s_waitcnt vmcnt(10)
    s_waitcnt lgkmcnt(0)
    s_sub_u32 s8, s8, s30
    s_cmpk_ge_u32 s8, 1691
    s_cbranch_scc1 .ap_89
    s_waitcnt vmcnt(7)
    s_cmpk_ge_u32 s8, 1626
    s_cbranch_scc1 .ap_89
    s_waitcnt vmcnt(5)
    s_bitcmp1_b64 s[14:15], 46
    s_cbranch_scc0 1
    s_waitcnt vmcnt(4)
    s_cmpk_ge_u32 s8, 1551
    s_cbranch_scc1 .ap_89
    s_waitcnt vmcnt(3)
.ap_89:
    s_add_u32 s63, s69, 180224
    buffer_load_dwordx4 v[216:219], v2, s[44:47], s63 offen nt
    s_memrealtime s[8:9]
    s_waitcnt vmcnt(10)
    s_waitcnt lgkmcnt(0)
    s_sub_u32 s8, s8, s30
    s_cmpk_ge_u32 s8, 1722
    s_cbranch_scc1 .ap_90
    s_waitcnt vmcnt(7)
    s_cmpk_ge_u32 s8, 1657
    s_cbranch_scc1 .ap_90
    s_waitcnt vmcnt(5)
    s_bitcmp1_b64 s[14:15], 47
    s_cbranch_scc0 1
    s_waitcnt vmcnt(4)
    s_cmpk_ge_u32 s8, 1582
    s_cbranch_scc1 .ap_90
    s_waitcnt vmcnt(1)
.ap_90:
    s_add_u32 s63, s69, 188416
    buffer_load_dwordx4 v[220:223], v2, s[44:47], s63 offen nt
    s_memrealtime s[8:9]
    s_waitcnt vmcnt(10)
    s_waitcnt lgkmcnt(0)
    s_sub_u32 s8, s8, s30
    s_cmpk_ge_u32 s8, 1753
    s_cbranch_scc1 .ap_91
    s_waitcnt vmcnt(7)
    s_cmpk_ge_u32 s8, 1688
    s_cbranch_scc1 .ap_91
    s_waitcnt vmcnt(5)
    s_bitcmp1_b64 s[14:15], 48
    s_cbranch_scc0 1
    s_waitcnt vmcnt(2)
    s_cmpk_ge_u32 s8, 1613
    s_cbranch_scc1 .ap_91
    s_waitcnt vmcnt(1)
.ap_91:
    s_add_u32 s63, s69, 262144
    buffer_load_dwordx4 v[224:227], v2, s[44:47], s63 offen nt
    s_memrealtime s[8:9]
    s_waitcnt vmcnt(10)
    s_waitcnt lgkmcnt(0)
    s_sub_u32 s8, s8, s30
    s_cmpk_ge_u32 s8, 1784
    s_cbranch_scc1 .ap_92
    s_waitcnt vmcnt(7)
    s_cmpk_ge_u32 s8, 1719
    s_cbranch_scc1 .ap_92
    s_waitcnt vmcnt(3)
    s_bitcmp1_b64 s[14:15], 49
    s_cbranch_scc0 1
    s_waitcnt vmcnt(2)
    s_cmpk_ge_u32 s8, 1644
    s_cbranch_scc1 .ap_92
    s_waitcnt vmcnt(1)
.ap_92:
    s_add_u32 s63, s69, 270336
    buffer_load_dwordx4 v[228:231], v2, s[44:47], s63 offen nt
    s_memrealtime s[8:9]
    s_waitcnt vmcnt(10)
    s_waitcnt lgkmcnt(0)
    s_sub_u32 s8, s8, s30
    s_cmpk_ge_u32 s8, 1815
    s_cbranch_scc1 .ap_93
    s_waitcnt vmcnt(7)
    s_cmpk_ge_u32 s8, 1750
    s_cbranch_scc1 .ap_93
    s_waitcnt vmcnt(3)
    s_bitcmp1_b64 s[14:15], 50
    s_cbranch_scc0 1
    s_waitcnt vmcnt(2)
    s_cmpk_ge_u32 s8, 1675
    s_cbranch_scc1 .ap_93
    s_waitcnt vmcnt(1)
.ap_93:
    s_add_u32 s63, s69, 278528
    buffer_load_dwordx4 v[232:235], v2, s[44:47], s63 offen nt
    s_memrealtime s[8:9]
    s_waitcnt vmcnt(10)
    s_waitcnt lgkmcnt(0)
    s_sub_u32 s8, s8, s30
    s_cmpk_ge_u32 s8, 1846
    s_cbranch_scc1 .ap_94
    s_waitcnt vmcnt(5)
    s_cmpk_ge_u32 s8, 1781
    s_cbranch_scc1 .ap_94
    s_waitcnt vmcnt(3)
    s_bitcmp1_b64 s[14:15], 51
    s_cbranch_scc0 1
    s_waitcnt vmcnt(2)
    s_cmpk_ge_u32 s8, 1706
    s_cbranch_scc1 .ap_94
    s_waitcnt vmcnt(1)
.ap_94:
    s_add_u32 s63, s69, 286720
    buffer_load_dwordx4 v[236:239], v2, s[44:47], s63 offen nt
    s_memrealtime s[8:9]
    s_waitcnt vmcnt(10)
    s_waitcnt lgkmcnt(0)
    s_sub_u32 s8, s8, s30
    s_cmpk_ge_u32 s8, 1877
    s_cbranch_scc1 .ap_95
    s_waitcnt vmcnt(5)
    s_cmpk_ge_u32 s8, 1812
    s_cbranch_scc1 .ap_95
    s_waitcnt vmcnt(3)
    s_bitcmp1_b64 s[14:15], 52
    s_cbranch_scc0 1
    s_waitcnt vmcnt(2)
    s_cmpk_ge_u32 s8, 1737
    s_cbranch_scc1 .ap_95
    s_waitcnt vmcnt(1)
.ap_95:
    s_add_u32 s63, s69, 294912
    buffer_load_dwordx4 v[240:243], v2, s[44:47], s63 offen nt
    s_memrealtime s[8:9]
    s_waitcnt vmcnt(10)
    s_waitcnt lgkmcnt(0)
    s_sub_u32 s8, s8, s30
    s_cmpk_ge_u32 s8, 1908
    s_cbranch_scc1 .ap_96
    s_waitcnt vmcnt(5)
    s_cmpk_ge_u32 s8, 1843
    s_cbranch_scc1 .ap_96
    s_waitcnt vmcnt(3)
    s_bitcmp1_b64 s[14:15], 53
    s_cbranch_scc0 1
    s_waitcnt vmcnt(2)
    s_cmpk_ge_u32 s8, 1768
    s_cbranch_scc1 .ap_96
    s_waitcnt vmcnt(1)
.ap_96:
    s_add_u32 s63, s69, 303104
    buffer_load_dwordx4 v[244:247], v2, s[44:47], s63 offen nt
    s_load_dwordx2 s[88:89], s[6:7], s0
    buffer_load_dwordx4 v[24:27], v9, s[36:39], s59 offen offset:0 sc1
    s_memrealtime s[8:9]
    s_waitcnt vmcnt(8)
    s_waitcnt lgkmcnt(0)
    s_sub_u32 s8, s8, s30
    s_cmpk_ge_u32 s8, 1939
    s_cbranch_scc1 .ap_97
    s_waitcnt vmcnt(5)
    s_cmpk_ge_u32 s8, 1874
    s_cbranch_scc1 .ap_97
    s_waitcnt vmcnt(3)
    s_bitcmp1_b64 s[14:15], 54
    s_cbranch_scc0 1
    s_waitcnt vmcnt(2)
    s_cmpk_ge_u32 s8, 1799
    s_cbranch_scc1 .ap_97
    s_waitcnt vmcnt(1)
.ap_97:
    s_add_u32 s63, s69, 311296
    buffer_load_dwordx4 v[248:251], v2, s[44:47], s63 offen nt
    s_memrealtime s[8:9]
    s_waitcnt vmcnt(8)
    s_waitcnt lgkmcnt(0)
    s_sub_u32 s8, s8, s30
    s_cmpk_ge_u32 s8, 1970
    s_cbranch_scc1 .ap_98
    s_waitcnt vmcnt(5)
    s_cmpk_ge_u32 s8, 1905
    s_cbranch_scc1 .ap_98
    s_waitcnt vmcnt(3)
    s_bitcmp1_b64 s[14:15], 55
    s_cbranch_scc0 1
    s_waitcnt vmcnt(2)
    s_cmpk_ge_u32 s8, 1830
    s_cbranch_scc1 .ap_98
    s_waitcnt vmcnt(1)
.ap_98:
    s_add_u32 s63, s69, 319488
    buffer_load_dwordx4 v[252:255], v2, s[44:47], s63 offen nt
    s_memrealtime s[8:9]
    s_waitcnt vmcnt(8)
    s_waitcnt lgkmcnt(0)
    s_sub_u32 s8, s8, s30
    s_cmpk_ge_u32 s8, 2001
    s_cbranch_scc1 .ap_99
    s_waitcnt vmcnt(5)
    s_cmpk_ge_u32 s8, 1936
    s_cbranch_scc1 .ap_99
    s_waitcnt vmcnt(3)
    s_bitcmp1_b64 s[14:15], 56
    s_cbranch_scc0 1
    s_waitcnt vmcnt(2)
    s_cmpk_ge_u32 s8, 1861
    s_cbranch_scc1 .ap_99
    s_waitcnt vmcnt(1)
.ap_99:
    s_add_u32 s63, s69, 393216
    buffer_load_dwordx4 v[36:39], v2, s[44:47], s63 offen nt
    s_memrealtime s[8:9]
    s_waitcnt vmcnt(8)
    s_waitcnt lgkmcnt(0)
    s_sub_u32 s8, s8, s30
    s_cmpk_ge_u32 s8, 2032
    s_cbranch_scc1 .ap_100
    s_waitcnt vmcnt(5)
    s_cmpk_ge_u32 s8, 1967
    s_cbranch_scc1 .ap_100
    s_waitcnt vmcnt(3)
    s_bitcmp1_b64 s[14:15], 57
    s_cbranch_scc0 1
    s_waitcnt vmcnt(2)
    s_cmpk_ge_u32 s8, 1892
    s_cbranch_scc1 .ap_100
    s_waitcnt vmcnt(1)
.ap_100:
    s_add_u32 s63, s69, 401408
    buffer_load_dwordx4 v[44:47], v2, s[44:47], s63 offen nt
    s_memrealtime s[8:9]
    s_waitcnt vmcnt(8)
    s_waitcnt lgkmcnt(0)
    s_sub_u32 s8, s8, s30
    s_cmpk_ge_u32 s8, 2063
    s_cbranch_scc1 .ap_101
    s_waitcnt vmcnt(5)
    s_cmpk_ge_u32 s8, 1998
    s_cbranch_scc1 .ap_101
    s_waitcnt vmcnt(3)
    s_bitcmp1_b64 s[14:15], 58
    s_cbranch_scc0 1
    s_waitcnt vmcnt(2)
    s_cmpk_ge_u32 s8, 1923
    s_cbranch_scc1 .ap_101
    s_waitcnt vmcnt(1)
.ap_101:
    s_add_u32 s63, s69, 409600
    buffer_load_dwordx4 v[52:55], v2, s[44:47], s63 offen nt
    s_waitcnt vmcnt(5)
    s_branch .gpc_103
.gp_102:
    buffer_load_dwordx4 v[24:27], v9, s[36:39], s59 offen offset:0 sc1
    s_waitcnt vmcnt(0)
.gpc_103:
    v_cmp_eq_u32 vcc, s34, v26
    v_cmp_eq_u32 s[56:57], s34, v27
    s_and_b64 vcc, vcc, s[56:57]
    s_cmp_eq_u64 vcc, exec
    s_nop 2
    s_cbranch_scc1 .gpd_104
    s_sub_u32 s35, s35, 1
    s_cbranch_scc1 .Lexit
    s_sleep 1
    s_branch .gp_102
.gpd_104:
    s_lshr_b64 s[88:89], s[88:89], s1
    s_and_b32 s88, s88, 0xff
    s_cmp_eq_u32 s88, 32
    s_cselect_b32 s0, 0xac000, 0
    v_mov_b32 v16, v24
    s_nop 1
    v_max_f32_dpp v16, v16, v16 quad_perm:[2,3,0,1] row_mask:0xf bank_mask:0xf
    v_sub_f32 v17, v24, v16
    v_sub_f32 v18, v14, v16
    v_mul_f32 v17, 0x3fb8aa3b, v17
    v_mul_f32 v18, 0x3fb8aa3b, v18
    v_exp_f32 v17, v17
    v_exp_f32 v18, v18
    v_mul_f32 v17, v17, v25
    s_nop 1
    v_add_f32_dpp v17, v17, v17 quad_perm:[2,3,0,1] row_mask:0xf bank_mask:0xf
    v_rcp_f32 v19, v17
    s_nop 0
    v_fma_f32 v15, -v17, v19, 1.0
    v_fma_f32 v19, v15, v19, v19
    v_mul_f32 v18, v18, v19
    v_mul_f32 v10, v10, v18
    v_mul_f32 v11, v11, v18
    v_mul_f32 v12, v12, v18
    v_mul_f32 v13, v13, v18
    v_mov_b32_dpp v112, v10 quad_perm:[2,3,0,1] row_mask:0xf bank_mask:0xf
    v_mov_b32_dpp v113, v11 quad_perm:[2,3,0,1] row_mask:0xf bank_mask:0xf
    v_mov_b32_dpp v114, v12 quad_perm:[2,3,0,1] row_mask:0xf bank_mask:0xf
    v_mov_b32_dpp v115, v13 quad_perm:[2,3,0,1] row_mask:0xf bank_mask:0xf
    v_cvt_pk_bf16_f32 v96, v10, v112
    v_cvt_pk_bf16_f32 v100, v11, v113
    v_cvt_pk_bf16_f32 v104, v12, v114
    v_cvt_pk_bf16_f32 v108, v13, v115
    v_mov_b32_dpp v97, v96 row_ror:12 row_mask:0xf bank_mask:0xf
    v_mov_b32_dpp v101, v100 row_ror:12 row_mask:0xf bank_mask:0xf
    v_mov_b32_dpp v105, v104 row_ror:12 row_mask:0xf bank_mask:0xf
    v_mov_b32_dpp v109, v108 row_ror:12 row_mask:0xf bank_mask:0xf
    v_mov_b32_dpp v98, v96 row_ror:8 row_mask:0xf bank_mask:0xf
    v_mov_b32_dpp v102, v100 row_ror:8 row_mask:0xf bank_mask:0xf
    v_mov_b32_dpp v106, v104 row_ror:8 row_mask:0xf bank_mask:0xf
    v_mov_b32_dpp v110, v108 row_ror:8 row_mask:0xf bank_mask:0xf
    v_mov_b32_dpp v99, v96 row_ror:4 row_mask:0xf bank_mask:0xf
    v_mov_b32_dpp v103, v100 row_ror:4 row_mask:0xf bank_mask:0xf
    v_mov_b32_dpp v107, v104 row_ror:4 row_mask:0xf bank_mask:0xf
    v_mov_b32_dpp v111, v108 row_ror:4 row_mask:0xf bank_mask:0xf
    v_mov_b32_dpp v96, v96 row_shr:3 row_mask:0xf bank_mask:0x2
    v_mov_b32_dpp v97, v97 row_shr:3 row_mask:0xf bank_mask:0x2
    v_mov_b32_dpp v98, v98 row_shr:3 row_mask:0xf bank_mask:0x2
    v_mov_b32_dpp v99, v99 row_shr:3 row_mask:0xf bank_mask:0x2
    v_mov_b32_dpp v100, v100 row_shr:3 row_mask:0xf bank_mask:0x2
    v_mov_b32_dpp v101, v101 row_shr:3 row_mask:0xf bank_mask:0x2
    v_mov_b32_dpp v102, v102 row_shr:3 row_mask:0xf bank_mask:0x2
    v_mov_b32_dpp v103, v103 row_shr:3 row_mask:0xf bank_mask:0x2
    v_mov_b32_dpp v104, v104 row_shr:3 row_mask:0xf bank_mask:0x2
    v_mov_b32_dpp v105, v105 row_shr:3 row_mask:0xf bank_mask:0x2
    v_mov_b32_dpp v106, v106 row_shr:3 row_mask:0xf bank_mask:0x2
    v_mov_b32_dpp v107, v107 row_shr:3 row_mask:0xf bank_mask:0x2
    v_mov_b32_dpp v108, v108 row_shr:3 row_mask:0xf bank_mask:0x2
    v_mov_b32_dpp v109, v109 row_shr:3 row_mask:0xf bank_mask:0x2
    v_mov_b32_dpp v110, v110 row_shr:3 row_mask:0xf bank_mask:0x2
    v_mov_b32_dpp v111, v111 row_shr:3 row_mask:0xf bank_mask:0x2
    s_memrealtime s[8:9]
    s_waitcnt lgkmcnt(0)
    s_sub_u32 s8, s8, s30
    s_cmpk_ge_u32 s8, 2094
    s_cbranch_scc1 .ap_105
    s_waitcnt vmcnt(5)
    s_cmpk_ge_u32 s8, 2029
    s_cbranch_scc1 .ap_105
    s_waitcnt vmcnt(3)
    s_bitcmp1_b64 s[14:15], 59
    s_cbranch_scc0 1
    s_waitcnt vmcnt(2)
    s_cmpk_ge_u32 s8, 1954
    s_cbranch_scc1 .ap_105
    s_waitcnt vmcnt(1)
.ap_105:
    s_add_u32 s63, s69, 417792
    buffer_load_dwordx4 v[60:63], v2, s[44:47], s63 offen nt
    s_lshl_b32 s60, s3, 10
    s_add_u32 s60, s60, 132096
    v_lshlrev_b32 v10, 5, v0
    v_add_u32 v10, s60, v10
    v_lshrrev_b32 v11, 5, v0
    v_lshlrev_b32 v11, 13, v11
    v_and_b32 v12, 31, v0
    v_lshl_add_u32 v11, v12, 4, v11
    v_add_u32 v9, 132096, v2
    v_mov_b32 v15, s34
    v_lshrrev_b32 v25, 4, v0
    v_bfe_u32 v26, v0, 2, 2
    v_lshl_add_u32 v16, v25, 3, v26
    v_lshlrev_b32 v16, 7, v16
    v_and_b32 v25, 1, v25
    v_lshrrev_b32 v26, 1, v26
    v_lshl_add_u32 v25, v25, 1, v26
    s_and_b32 s56, s3, 1
    s_lshl_b32 s56, s56, 1
    v_xor_b32 v25, s56, v25
    v_and_b32 v26, 3, v0
    v_lshl_add_u32 v16, v26, 3, v16
    s_lshr_b32 s56, s3, 1
    s_mul_i32 s56, s56, 16384
    v_add_u32 v16, s56, v16
    v_xor_b32 v26, 1, v25
    v_lshl_add_u32 v17, v26, 5, v16
    v_lshl_add_u32 v16, v25, 5, v16
    v_bfe_u32 v25, v0, 1, 3
    v_mul_u32_u24 v19, 1312, v25
    v_mul_u32_u24 v20, 272, v25
    v_and_b32 v25, 48, v0
    s_lshr_b32 s56, s3, 1
    s_mul_i32 s57, s56, 256
    s_add_u32 s57, s57, 147456
    v_add3_u32 v19, v19, v25, s57
    s_mul_i32 s56, s56, 2176
    s_and_b32 s57, s3, 1
    s_lshl_b32 s57, s57, 7
    s_add_u32 s56, s56, s57
    s_add_u32 s56, s56, 122880
    v_add3_u32 v20, v20, v25, s56
    v_and_b32 v25, 1, v0
    v_lshl_add_u32 v20, v25, 6, v20
    v_and_b32 v25, 15, v0
    s_mul_i32 s56, s3, 272
    s_add_u32 s56, s56, 122880
    v_lshl_add_u32 v21, v25, 4, s56
    s_mul_i32 s56, s3, 1312
    s_add_u32 s56, s56, 147456
    v_add_u32 v18, s56, v3
    v_add_u32 v7, 16384, v11
    s_nop 1
    s_branch .gpc_107
.gp_106:
    buffer_load_dwordx2 v[72:73], v6, s[36:39], s101 offen offset:0 sc1
    s_waitcnt vmcnt(0)
.gpc_107:
    v_cmp_eq_u32 vcc, s34, v73
    s_cmp_eq_u64 vcc, exec
    s_nop 3
    s_cbranch_scc1 .gpd_108
    s_sub_u32 s35, s35, 1
    s_cbranch_scc1 .Lexit
    s_sleep 2
    s_branch .gp_106
.gpd_108:
    v_lshlrev_b32 v23, 16, v72
    v_and_b32 v72, 0xffff0000, v72
    s_mov_b32 vcc_lo, 0xffff0000
    s_mov_b32 vcc_hi, 0xffff0000
    v_cndmask_b32 v23, v23, v72, vcc
    v_lshlrev_b32 v29, 16, v29
    s_memrealtime s[8:9]
    s_waitcnt lgkmcnt(0)
    s_sub_u32 s8, s8, s30
    s_cmpk_ge_u32 s8, 2125
    s_cbranch_scc1 .ap_109
    s_waitcnt vmcnt(5)
    s_cmpk_ge_u32 s8, 2060
    s_cbranch_scc1 .ap_109
    s_waitcnt vmcnt(3)
    s_bitcmp1_b64 s[14:15], 60
    s_cbranch_scc0 1
    s_waitcnt vmcnt(2)
    s_cmpk_ge_u32 s8, 1985
    s_cbranch_scc1 .ap_109
    s_waitcnt vmcnt(1)
.ap_109:
    s_add_u32 s63, s69, 425984
    buffer_load_dwordx4 v[68:71], v2, s[44:47], s63 offen nt
    v_perm_b32 v112, v164, v160, s94
    v_perm_b32 v113, v172, v168, s94
    v_perm_b32 v114, v180, v176, s94
    v_perm_b32 v115, v188, v184, s94
    s_nop 1
    v_mfma_f32_16x16x32_bf16 v[128:131], v[96:99], v[112:115], 0
    v_perm_b32 v116, v164, v160, s95
    v_perm_b32 v117, v172, v168, s95
    v_perm_b32 v118, v180, v176, s95
    v_perm_b32 v119, v188, v184, s95
    s_nop 1
    v_mfma_f32_16x16x32_bf16 v[132:135], v[96:99], v[116:119], 0
    v_perm_b32 v120, v165, v161, s94
    v_perm_b32 v121, v173, v169, s94
    v_perm_b32 v122, v181, v177, s94
    v_perm_b32 v123, v189, v185, s94
    s_nop 1
    v_mfma_f32_16x16x32_bf16 v[136:139], v[96:99], v[120:123], 0
    v_perm_b32 v124, v165, v161, s95
    v_perm_b32 v125, v173, v169, s95
    v_perm_b32 v126, v181, v177, s95
    v_perm_b32 v127, v189, v185, s95
    s_nop 1
    v_mfma_f32_16x16x32_bf16 v[140:143], v[96:99], v[124:127], 0
    v_perm_b32 v112, v166, v162, s94
    v_perm_b32 v113, v174, v170, s94
    v_perm_b32 v114, v182, v178, s94
    v_perm_b32 v115, v190, v186, s94
    s_nop 1
    v_mfma_f32_16x16x32_bf16 v[144:147], v[96:99], v[112:115], 0
    v_perm_b32 v116, v166, v162, s95
    v_perm_b32 v117, v174, v170, s95
    v_perm_b32 v118, v182, v178, s95
    v_perm_b32 v119, v190, v186, s95
    s_nop 1
    v_mfma_f32_16x16x32_bf16 v[148:151], v[96:99], v[116:119], 0
    v_perm_b32 v120, v167, v163, s94
    v_perm_b32 v121, v175, v171, s94
    v_perm_b32 v122, v183, v179, s94
    v_perm_b32 v123, v191, v187, s94
    s_nop 1
    v_mfma_f32_16x16x32_bf16 v[152:155], v[96:99], v[120:123], 0
    v_perm_b32 v124, v167, v163, s95
    v_perm_b32 v125, v175, v171, s95
    v_perm_b32 v126, v183, v179, s95
    v_perm_b32 v127, v191, v187, s95
    s_nop 1
    v_mfma_f32_16x16x32_bf16 v[156:159], v[96:99], v[124:127], 0
    s_memrealtime s[8:9]
    s_waitcnt lgkmcnt(0)
    s_sub_u32 s8, s8, s30
    s_cmpk_ge_u32 s8, 2156
    s_nop 3
    s_cbranch_scc1 .ap_110
    s_waitcnt vmcnt(5)
    s_cmpk_ge_u32 s8, 2091
    s_cbranch_scc1 .ap_110
    s_waitcnt vmcnt(3)
    s_bitcmp1_b64 s[14:15], 61
    s_cbranch_scc0 1
    s_waitcnt vmcnt(2)
    s_cmpk_ge_u32 s8, 2016
    s_cbranch_scc1 .ap_110
    s_waitcnt vmcnt(1)
.ap_110:
    s_add_u32 s63, s69, 434176
    buffer_load_dwordx4 v[76:79], v2, s[44:47], s63 offen nt
    v_perm_b32 v112, v196, v192, s94
    v_perm_b32 v113, v204, v200, s94
    v_perm_b32 v114, v212, v208, s94
    v_perm_b32 v115, v220, v216, s94
    s_nop 1
    v_mfma_f32_16x16x32_bf16 v[128:131], v[100:103], v[112:115], v[128:131]
    v_perm_b32 v116, v196, v192, s95
    v_perm_b32 v117, v204, v200, s95
    v_perm_b32 v118, v212, v208, s95
    v_perm_b32 v119, v220, v216, s95
    s_nop 1
    v_mfma_f32_16x16x32_bf16 v[132:135], v[100:103], v[116:119], v[132:135]
    v_perm_b32 v120, v197, v193, s94
    v_perm_b32 v121, v205, v201, s94
    v_perm_b32 v122, v213, v209, s94
    v_perm_b32 v123, v221, v217, s94
    s_nop 1
    v_mfma_f32_16x16x32_bf16 v[136:139], v[100:103], v[120:123], v[136:139]
    v_perm_b32 v124, v197, v193, s95
    v_perm_b32 v125, v205, v201, s95
    v_perm_b32 v126, v213, v209, s95
    v_perm_b32 v127, v221, v217, s95
    s_nop 1
    v_mfma_f32_16x16x32_bf16 v[140:143], v[100:103], v[124:127], v[140:143]
    v_perm_b32 v112, v198, v194, s94
    v_perm_b32 v113, v206, v202, s94
    v_perm_b32 v114, v214, v210, s94
    v_perm_b32 v115, v222, v218, s94
    s_nop 1
    v_mfma_f32_16x16x32_bf16 v[144:147], v[100:103], v[112:115], v[144:147]
    v_perm_b32 v116, v198, v194, s95
    v_perm_b32 v117, v206, v202, s95
    v_perm_b32 v118, v214, v210, s95
    v_perm_b32 v119, v222, v218, s95
    s_nop 1
    v_mfma_f32_16x16x32_bf16 v[148:151], v[100:103], v[116:119], v[148:151]
    v_perm_b32 v120, v199, v195, s94
    v_perm_b32 v121, v207, v203, s94
    v_perm_b32 v122, v215, v211, s94
    v_perm_b32 v123, v223, v219, s94
    s_nop 1
    v_mfma_f32_16x16x32_bf16 v[152:155], v[100:103], v[120:123], v[152:155]
    v_perm_b32 v124, v199, v195, s95
    v_perm_b32 v125, v207, v203, s95
    v_perm_b32 v126, v215, v211, s95
    v_perm_b32 v127, v223, v219, s95
    s_nop 1
    v_mfma_f32_16x16x32_bf16 v[156:159], v[100:103], v[124:127], v[156:159]
    s_memrealtime s[8:9]
    s_waitcnt lgkmcnt(0)
    s_sub_u32 s8, s8, s30
    s_cmpk_ge_u32 s8, 2187
    s_nop 3
    s_cbranch_scc1 .ap_111
    s_waitcnt vmcnt(5)
    s_cmpk_ge_u32 s8, 2122
    s_cbranch_scc1 .ap_111
    s_waitcnt vmcnt(3)
    s_bitcmp1_b64 s[14:15], 62
    s_cbranch_scc0 1
    s_waitcnt vmcnt(2)
    s_cmpk_ge_u32 s8, 2047
    s_cbranch_scc1 .ap_111
    s_waitcnt vmcnt(1)
.ap_111:
    s_add_u32 s63, s69, 442368
    buffer_load_dwordx4 v[84:87], v2, s[44:47], s63 offen nt
    s_waitcnt vmcnt(7)
    v_perm_b32 v112, v228, v224, s94
    v_perm_b32 v113, v236, v232, s94
    v_perm_b32 v114, v244, v240, s94
    v_perm_b32 v115, v252, v248, s94
    s_nop 1
    v_mfma_f32_16x16x32_bf16 v[128:131], v[104:107], v[112:115], v[128:131]
    v_perm_b32 v116, v228, v224, s95
    v_perm_b32 v117, v236, v232, s95
    v_perm_b32 v118, v244, v240, s95
    v_perm_b32 v119, v252, v248, s95
    s_nop 1
    v_mfma_f32_16x16x32_bf16 v[132:135], v[104:107], v[116:119], v[132:135]
    v_perm_b32 v120, v229, v225, s94
    v_perm_b32 v121, v237, v233, s94
    v_perm_b32 v122, v245, v241, s94
    v_perm_b32 v123, v253, v249, s94
    s_nop 1
    v_mfma_f32_16x16x32_bf16 v[136:139], v[104:107], v[120:123], v[136:139]
    v_perm_b32 v124, v229, v225, s95
    v_perm_b32 v125, v237, v233, s95
    v_perm_b32 v126, v245, v241, s95
    v_perm_b32 v127, v253, v249, s95
    s_nop 1
    v_mfma_f32_16x16x32_bf16 v[140:143], v[104:107], v[124:127], v[140:143]
    v_perm_b32 v112, v230, v226, s94
    v_perm_b32 v113, v238, v234, s94
    v_perm_b32 v114, v246, v242, s94
    v_perm_b32 v115, v254, v250, s94
    s_nop 1
    v_mfma_f32_16x16x32_bf16 v[144:147], v[104:107], v[112:115], v[144:147]
    v_perm_b32 v116, v230, v226, s95
    v_perm_b32 v117, v238, v234, s95
    v_perm_b32 v118, v246, v242, s95
    v_perm_b32 v119, v254, v250, s95
    s_nop 1
    v_mfma_f32_16x16x32_bf16 v[148:151], v[104:107], v[116:119], v[148:151]
    v_perm_b32 v120, v231, v227, s94
    v_perm_b32 v121, v239, v235, s94
    v_perm_b32 v122, v247, v243, s94
    v_perm_b32 v123, v255, v251, s94
    s_nop 1
    v_mfma_f32_16x16x32_bf16 v[152:155], v[104:107], v[120:123], v[152:155]
    v_perm_b32 v124, v231, v227, s95
    v_perm_b32 v125, v239, v235, s95
    v_perm_b32 v126, v247, v243, s95
    v_perm_b32 v127, v255, v251, s95
    s_nop 1
    v_mfma_f32_16x16x32_bf16 v[156:159], v[104:107], v[124:127], v[156:159]
    s_memrealtime s[8:9]
    s_waitcnt lgkmcnt(0)
    s_sub_u32 s8, s8, s30
    s_cmpk_ge_u32 s8, 2218
    s_nop 3
    s_cbranch_scc1 .ap_112
    s_waitcnt vmcnt(5)
    s_cmpk_ge_u32 s8, 2153
    s_cbranch_scc1 .ap_112
    s_waitcnt vmcnt(3)
    s_bitcmp1_b64 s[14:15], 63
    s_cbranch_scc0 1
    s_waitcnt vmcnt(2)
    s_cmpk_ge_u32 s8, 2078
    s_cbranch_scc1 .ap_112
    s_waitcnt vmcnt(1)
.ap_112:
    s_add_u32 s63, s69, 450560
    buffer_load_dwordx4 v[92:95], v2, s[44:47], s63 offen nt
    s_setprio 0
    s_waitcnt vmcnt(6)
    v_perm_b32 v160, v44, v36, s94
    v_perm_b32 v164, v44, v36, s95
    v_perm_b32 v168, v45, v37, s94
    v_perm_b32 v172, v45, v37, s95
    v_perm_b32 v176, v46, v38, s94
    v_perm_b32 v180, v46, v38, s95
    v_perm_b32 v184, v47, v39, s94
    v_perm_b32 v188, v47, v39, s95
    s_waitcnt vmcnt(4)
    v_perm_b32 v161, v60, v52, s94
    v_perm_b32 v165, v60, v52, s95
    v_perm_b32 v169, v61, v53, s94
    v_perm_b32 v173, v61, v53, s95
    v_perm_b32 v177, v62, v54, s94
    v_perm_b32 v181, v62, v54, s95
    v_perm_b32 v185, v63, v55, s94
    v_perm_b32 v189, v63, v55, s95
    v_mfma_f32_16x16x16_bf16 v[128:131], v[108:109], v[160:161], v[128:131]
    v_mfma_f32_16x16x16_bf16 v[132:135], v[108:109], v[164:165], v[132:135]
    v_mfma_f32_16x16x16_bf16 v[136:139], v[108:109], v[168:169], v[136:139]
    v_mfma_f32_16x16x16_bf16 v[140:143], v[108:109], v[172:173], v[140:143]
    v_mfma_f32_16x16x16_bf16 v[144:147], v[108:109], v[176:177], v[144:147]
    v_mfma_f32_16x16x16_bf16 v[148:151], v[108:109], v[180:181], v[148:151]
    v_mfma_f32_16x16x16_bf16 v[152:155], v[108:109], v[184:185], v[152:155]
    v_mfma_f32_16x16x16_bf16 v[156:159], v[108:109], v[188:189], v[156:159]
    s_waitcnt vmcnt(2)
    v_perm_b32 v162, v76, v68, s94
    v_perm_b32 v166, v76, v68, s95
    v_perm_b32 v170, v77, v69, s94
    v_perm_b32 v174, v77, v69, s95
    v_perm_b32 v178, v78, v70, s94
    v_perm_b32 v182, v78, v70, s95
    v_perm_b32 v186, v79, v71, s94
    v_perm_b32 v190, v79, v71, s95
    s_lshl4_add_u32 s59, s67, s66
    s_lshl1_add_u32 s59, s59, s68
    s_lshl_b32 s59, s59, 9
    s_add_u32 s59, s59, 0x210000
    s_mov_b32 s60, 0x07060503
    s_mov_b32 s61, 0x07060502
    s_mov_b32 s62, 0x07060501
.Ltail_ar:
    s_waitcnt vmcnt(0)
    v_perm_b32 v163, v92, v84, s94
    v_perm_b32 v167, v92, v84, s95
    v_perm_b32 v171, v93, v85, s94
    v_perm_b32 v175, v93, v85, s95
    v_perm_b32 v179, v94, v86, s94
    v_perm_b32 v183, v94, v86, s95
    v_perm_b32 v187, v95, v87, s94
    v_perm_b32 v191, v95, v87, s95
    v_mfma_f32_16x16x16_bf16 v[128:131], v[110:111], v[162:163], v[128:131]
    v_mfma_f32_16x16x16_bf16 v[132:135], v[110:111], v[166:167], v[132:135]
    v_mfma_f32_16x16x16_bf16 v[136:139], v[110:111], v[170:171], v[136:139]
    v_mfma_f32_16x16x16_bf16 v[140:143], v[110:111], v[174:175], v[140:143]
    v_mfma_f32_16x16x16_bf16 v[144:147], v[110:111], v[178:179], v[144:147]
    v_mfma_f32_16x16x16_bf16 v[148:151], v[110:111], v[182:183], v[148:151]
    v_mfma_f32_16x16x16_bf16 v[152:155], v[110:111], v[186:187], v[152:155]
    v_mfma_f32_16x16x16_bf16 v[156:159], v[110:111], v[190:191], v[156:159]
    s_nop 1
    s_mov_b64 exec, 0xffffffff
    ds_write2_b32 v10, v128, v132 offset0:0 offset1:1
    ds_write2_b32 v10, v136, v140 offset0:2 offset1:3
    s_nop 0
    ds_write2_b32 v10, v144, v148 offset0:4 offset1:5
    s_nop 0
    ds_write2_b32 v10, v152, v156 offset0:6 offset1:7
    s_mov_b64 exec, -1
    s_waitcnt lgkmcnt(0)
    s_barrier
    s_cmp_lg_u32 s3, 7
    s_cbranch_scc1 .opub_113
    ds_read_b128 v[196:199], v9 offset:0
    ds_read_b128 v[200:203], v9 offset:1024
    ds_read_b128 v[204:207], v9 offset:2048
    ds_read_b128 v[208:211], v9 offset:3072
    ds_read_b128 v[212:215], v9 offset:4096
    ds_read_b128 v[216:219], v9 offset:5120
    ds_read_b128 v[220:223], v9 offset:6144
    ds_read_b128 v[224:227], v9 offset:7168
    s_waitcnt lgkmcnt(6)
    v_pk_add_f32 v[196:197], v[196:197], v[200:201]
    v_pk_add_f32 v[198:199], v[198:199], v[202:203]
    s_waitcnt lgkmcnt(4)
    v_pk_add_f32 v[204:205], v[204:205], v[208:209]
    v_pk_add_f32 v[206:207], v[206:207], v[210:211]
    v_pk_add_f32 v[196:197], v[196:197], v[204:205]
    v_pk_add_f32 v[198:199], v[198:199], v[206:207]
    s_waitcnt lgkmcnt(2)
    v_pk_add_f32 v[212:213], v[212:213], v[216:217]
    v_pk_add_f32 v[214:215], v[214:215], v[218:219]
    s_waitcnt lgkmcnt(0)
    v_pk_add_f32 v[220:221], v[220:221], v[224:225]
    v_pk_add_f32 v[222:223], v[222:223], v[226:227]
    v_pk_add_f32 v[212:213], v[212:213], v[220:221]
    v_pk_add_f32 v[214:215], v[214:215], v[222:223]
    v_pk_add_f32 v[196:197], v[196:197], v[212:213]
    v_pk_add_f32 v[198:199], v[198:199], v[214:215]
    v_perm_b32 v12, v196, v199, s60
    v_perm_b32 v13, v197, v199, s61
    v_perm_b32 v14, v198, v199, s62
    s_add_u32 s57, s59, 0xac000
    buffer_store_dwordx4 v[12:15], v11, s[36:39], s57 offen
    buffer_store_dwordx4 v[12:15], v11, s[36:39], s59 offen sc1
.opub_113:
    ds_read_b64_tr_b16 v[160:161], v16 offset:0
    ds_read_b64_tr_b16 v[162:163], v16 offset:512
    ds_read_b64_tr_b16 v[176:177], v17 offset:0
    ds_read_b64_tr_b16 v[178:179], v17 offset:512
    ds_read_b64_tr_b16 v[164:165], v16 offset:4096
    ds_read_b64_tr_b16 v[166:167], v16 offset:4608
    ds_read_b64_tr_b16 v[180:181], v17 offset:4096
    ds_read_b64_tr_b16 v[182:183], v17 offset:4608
    ds_read_b64_tr_b16 v[168:169], v16 offset:8192
    ds_read_b64_tr_b16 v[170:171], v16 offset:8704
    ds_read_b64_tr_b16 v[184:185], v17 offset:8192
    ds_read_b64_tr_b16 v[186:187], v17 offset:8704
    ds_read_b64_tr_b16 v[172:173], v16 offset:12288
    ds_read_b64_tr_b16 v[174:175], v16 offset:12800
    ds_read_b64_tr_b16 v[188:189], v17 offset:12288
    ds_read_b64_tr_b16 v[190:191], v17 offset:12800
    s_lshl_b32 s59, s64, 5
    s_add_u32 s59, s59, s3
    s_lshl_b32 s59, s59, 10
    s_add_u32 s59, s59, 0x210000
    s_mov_b32 s60, 0x04000c0c
    s_mov_b32 s61, 0x0706000c
    v_mov_b32 v143, s34
    s_mul_i32 s40, s3, 9
    s_add_u32 s40, s40, s65
    s_lshl_b32 s40, s40, 11
    s_add_u32 s41, s40, 0x368000
    s_lshl_b32 s63, s64, 8
    s_add_u32 s63, s63, s41
    s_mul_i32 s101, s64, 18432
    s_mul_i32 s56, s3, 2304
    s_add_u32 s101, s101, s56
    s_add_u32 s101, s101, 0x250000
    s_lshl_b32 s42, s65, 8
    s_add_u32 s42, s42, s101
    v_mov_b32 v253, s34
    v_mov_b32 v255, s34
    s_add_u32 s58, s59, s0
    s_lshl1_add_u32 s59, s59, 0xac000
    s_cmp_eq_u32 s0, 0
    s_cselect_b32 s32, 64, 0
    s_mov_b64 s[88:89], exec
    s_mov_b64 s[90:91], exec
    s_mov_b64 s[92:93], exec
    s_mov_b64 s[56:57], exec
.mp_114:
    s_or_b64 exec, s[88:89], 1
    buffer_load_dwordx4 v[192:195], v11, s[36:39], s58 offen offset:0 sc1
    s_or_b64 exec, s[90:91], 1
    buffer_load_dwordx4 v[196:199], v11, s[36:39], s58 offen offset:512 sc1
    s_or_b64 exec, s[92:93], 1
    buffer_load_dwordx4 v[200:203], v7, s[36:39], s58 offen offset:0 sc1
    s_or_b64 exec, s[56:57], 1
    buffer_load_dwordx4 v[204:207], v7, s[36:39], s58 offen offset:512 sc1
    s_mov_b64 exec, -1
    s_sub_u32 s35, s35, 1
    s_cbranch_scc1 .Lexit
    s_sub_u32 vcc_lo, s59, s58
    s_add_u32 s32, s32, 1
    s_cmp_ge_u32 s32, 64
    s_cselect_b32 s58, vcc_lo, s58
    s_waitcnt vmcnt(0)
.mpj_115:
    v_cmp_ne_u32 s[88:89], s34, v195
    v_cmp_ne_u32 s[90:91], s34, v199
    v_cmp_ne_u32 s[92:93], s34, v203
    v_cmp_ne_u32 s[56:57], s34, v207
    s_or_b64 vcc, s[88:89], s[90:91]
    s_or_b64 vcc, vcc, s[92:93]
    s_or_b64 vcc, vcc, s[56:57]
    s_cbranch_scc1 .mp_114
    v_perm_b32 v195, v192, v193, s60
    v_perm_b32 v199, v196, v197, s60
    v_perm_b32 v203, v200, v201, s60
    v_perm_b32 v207, v204, v205, s60
    v_perm_b32 v195, v195, v194, s61
    v_perm_b32 v199, v199, v198, s61
    v_perm_b32 v203, v203, v202, s61
    v_perm_b32 v207, v207, v206, s61
    v_pk_add_f32 v[192:193], v[192:193], v[196:197]
    v_pk_add_f32 v[194:195], v[194:195], v[198:199]
    v_pk_add_f32 v[200:201], v[200:201], v[204:205]
    v_pk_add_f32 v[202:203], v[202:203], v[206:207]
    v_cvt_pk_bf16_f32 v192, v192, v193
    v_cvt_pk_bf16_f32 v193, v194, v195
    v_cvt_pk_bf16_f32 v200, v200, v201
    v_cvt_pk_bf16_f32 v201, v202, v203
    ds_write_b64 v18, v[192:193]
    ds_write_b64 v18, v[200:201] offset:512
    s_waitcnt lgkmcnt(0)
    s_barrier
    ds_read_b128 v[224:227], v19 offset:0
    ds_read_b128 v[228:231], v19 offset:64
    ds_read_b128 v[232:235], v19 offset:128
    ds_read_b128 v[236:239], v19 offset:192
    s_waitcnt lgkmcnt(3)
    v_mfma_f32_16x16x32_bf16 v[132:135], v[160:163], v[224:227], 0
    v_mfma_f32_16x16x32_bf16 v[136:139], v[176:179], v[224:227], 0
    s_waitcnt lgkmcnt(2)
    v_mfma_f32_16x16x32_bf16 v[132:135], v[164:167], v[228:231], v[132:135]
    v_mfma_f32_16x16x32_bf16 v[136:139], v[180:183], v[228:231], v[136:139]
    s_waitcnt lgkmcnt(1)
    v_mfma_f32_16x16x32_bf16 v[132:135], v[168:171], v[232:235], v[132:135]
    v_mfma_f32_16x16x32_bf16 v[136:139], v[184:187], v[232:235], v[136:139]
    s_waitcnt lgkmcnt(0)
    v_mfma_f32_16x16x32_bf16 v[132:135], v[172:175], v[236:239], v[132:135]
    v_mfma_f32_16x16x32_bf16 v[136:139], v[188:191], v[236:239], v[136:139]
    s_nop 7
    v_cndmask_b32 v132, v132, v136, s[96:97]
    v_cndmask_b32 v133, v133, v137, s[96:97]
    v_cndmask_b32 v134, v134, v138, s[96:97]
    v_cndmask_b32 v135, v135, v139, s[96:97]
    ds_write_b128 v20, v[132:135]
    s_waitcnt lgkmcnt(0)
    s_barrier
    ds_read_b128 v[224:227], v21 offset:0
    ds_read_b128 v[228:231], v21 offset:2176
    ds_read_b128 v[232:235], v21 offset:4352
    ds_read_b128 v[236:239], v21 offset:6528
    s_mov_b32 s60, 0x07060503
    s_mov_b32 s61, 0x07060502
    s_mov_b32 s62, 0x07060501
    s_waitcnt lgkmcnt(2)
    v_pk_add_f32 v[224:225], v[224:225], v[228:229]
    v_pk_add_f32 v[226:227], v[226:227], v[230:231]
    s_waitcnt lgkmcnt(0)
    v_pk_add_f32 v[232:233], v[232:233], v[236:237]
    v_pk_add_f32 v[234:235], v[234:235], v[238:239]
    v_pk_add_f32 v[224:225], v[224:225], v[232:233]
    v_pk_add_f32 v[226:227], v[226:227], v[234:235]
    v_perm_b32 v140, v224, v227, s60
    v_perm_b32 v141, v225, v227, s61
    v_perm_b32 v142, v226, v227, s62
    s_mov_b64 exec, 0xffff
    buffer_store_dwordx4 v[140:143], v2, s[36:39], s63 offen sc1
    s_mov_b64 exec, -1
    s_barrier
    s_mov_b32 s60, 0x04000c0c
    s_mov_b32 s61, 0x0706000c
    s_mov_b64 s[88:89], exec
    s_mov_b64 s[90:91], exec
.mp_118:
    s_or_b64 exec, s[88:89], 1
    buffer_load_dwordx4 v[108:111], v2, s[36:39], s41 offen offset:0 sc1
    s_or_b64 exec, s[90:91], 1
    buffer_load_dwordx4 v[112:115], v2, s[36:39], s41 offen offset:1024 sc1
    s_mov_b64 exec, -1
    s_sub_u32 s35, s35, 1
    s_cbranch_scc1 .Lexit
    s_waitcnt vmcnt(0)
.mpj_119:
    v_cmp_ne_u32 s[88:89], s34, v111
    v_cmp_ne_u32 s[90:91], s34, v115
    s_or_b64 vcc, s[88:89], s[90:91]
    s_cbranch_scc1 .mp_118
    v_perm_b32 v111, v108, v109, s60
    v_perm_b32 v115, v112, v113, s60
    v_perm_b32 v111, v111, v110, s61
    v_perm_b32 v115, v115, v114, s61
    v_pk_add_f32 v[248:249], v[108:109], v[112:113]
    v_pk_add_f32 v[250:251], v[110:111], v[114:115]
    s_nop 1
    v_permlane32_swap_b32 v248, v250
    v_permlane32_swap_b32 v249, v251
    v_pk_add_f32 v[248:249], v[248:249], v[250:251]
    s_nop 1
    v_permlane16_swap_b32 v248, v249
    v_add_f32 v248, v248, v249
    v_cvt_pk_bf16_f32 v248, 0, v248
    v_mul_f32 v248, v248, v23
    v_cvt_pk_bf16_f32 v248, 0, v248
    v_add_f32 v249, v248, v29
    v_add_f32 v248, v248, v29
    v_mov_b32 v24, v248
    s_nop 0
    v_permlane16_swap_b32 v248, v249
    v_cvt_pk_bf16_f32 v252, v248, v249
    v_cvt_pk_bf16_f32 v254, v248, v249
    s_nop 1
    v_permlane32_swap_b32 v252, v254
    s_mov_b64 exec, 0xffff
    s_add_u32 s57, s42, 0xac000
    buffer_store_dwordx4 v[252:255], v2, s[36:39], s57 offen
    s_cmp_lg_u32 s0, 0
    s_cbranch_scc1 2
    buffer_store_dwordx4 v[252:255], v2, s[36:39], s42 offen sc1
    s_mov_b64 exec, -1
    s_cmp_eq_u32 s3, s64
    s_cbranch_scc1 .r2_122
    s_branch .Lexit
.r2_122:
    v_cvt_pk_bf16_f32 v24, 0, v24
    s_nop 1
    s_branch .gpc_124
.gp_123:
    buffer_load_dwordx4 v[32:35], v2, s[36:39], s99 offen offset:0 sc1
    buffer_load_dwordx4 v[40:43], v2, s[36:39], s99 offen offset:1024 sc1
    buffer_load_dwordx2 v[48:49], v5, s[36:39], s99 offen offset:0 sc1
    buffer_load_dwordx4 v[56:59], v2, s[36:39], s100 offen offset:0 sc1
    buffer_load_dwordx4 v[64:67], v2, s[36:39], s100 offen offset:1024 sc1
    buffer_load_dwordx2 v[50:51], v5, s[36:39], s100 offen offset:0 sc1
    buffer_load_dwordx2 v[74:75], v6, s[36:39], s99 offen offset:0 sc1
    buffer_load_dwordx2 v[80:81], v6, s[36:39], s100 offen offset:0 sc1
    buffer_load_dwordx2 v[82:83], v6, s[36:39], s33 offen offset:0 sc1
    s_waitcnt vmcnt(0)
.gpc_124:
    v_min3_u32 v25, v33, v35, v41
    v_max3_u32 v26, v33, v35, v41
    v_min3_u32 v25, v25, v43, v49
    v_max3_u32 v26, v26, v43, v49
    v_min3_u32 v25, v25, v57, v59
    v_max3_u32 v26, v26, v57, v59
    v_min3_u32 v25, v25, v65, v67
    v_max3_u32 v26, v26, v65, v67
    v_min3_u32 v25, v25, v51, v75
    v_max3_u32 v26, v26, v51, v75
    v_min3_u32 v25, v25, v81, v83
    v_max3_u32 v26, v26, v81, v83
    v_cmp_eq_u32 vcc, s34, v25
    v_cmp_eq_u32 s[56:57], s34, v26
    s_and_b64 vcc, vcc, s[56:57]
    s_cmp_eq_u64 vcc, exec
    s_nop 2
    s_cbranch_scc1 .gpd_125
    s_sub_u32 s35, s35, 1
    s_cbranch_scc1 .Lexit
    s_sleep 2
    s_branch .gp_123
.gpd_125:
    v_lshlrev_b32 v160, 16, v32
    v_and_b32 v161, 0xffff0000, v32
    v_lshlrev_b32 v170, 16, v56
    v_and_b32 v171, 0xffff0000, v56
    v_lshlrev_b32 v162, 16, v34
    v_and_b32 v163, 0xffff0000, v34
    v_lshlrev_b32 v172, 16, v58
    v_and_b32 v173, 0xffff0000, v58
    v_lshlrev_b32 v164, 16, v40
    v_and_b32 v165, 0xffff0000, v40
    v_lshlrev_b32 v174, 16, v64
    v_and_b32 v175, 0xffff0000, v64
    v_lshlrev_b32 v166, 16, v42
    v_and_b32 v167, 0xffff0000, v42
    v_lshlrev_b32 v176, 16, v66
    v_and_b32 v177, 0xffff0000, v66
    v_lshlrev_b32 v168, 16, v48
    v_and_b32 v169, 0xffff0000, v48
    v_lshlrev_b32 v178, 16, v50
    v_and_b32 v179, 0xffff0000, v50
    v_lshlrev_b32 v75, 16, v74
    v_and_b32 v74, 0xffff0000, v74
    s_mov_b32 vcc_lo, 0xffff0000
    s_mov_b32 vcc_hi, 0xffff0000
    v_cndmask_b32 v75, v75, v74, vcc
    v_lshlrev_b32 v81, 16, v80
    v_and_b32 v80, 0xffff0000, v80
    s_mov_b32 vcc_lo, 0xffff0000
    s_mov_b32 vcc_hi, 0xffff0000
    v_cndmask_b32 v81, v81, v80, vcc
    v_lshlrev_b32 v83, 16, v82
    v_and_b32 v82, 0xffff0000, v82
    s_mov_b32 vcc_lo, 0xffff0000
    s_mov_b32 vcc_hi, 0xffff0000
    v_cndmask_b32 v83, v83, v82, vcc
    s_waitcnt vmcnt(0)
    s_add_u32 s58, s101, s0
    s_lshl1_add_u32 s101, s101, 0xac000
    s_cmp_eq_u32 s0, 0
    s_cselect_b32 s32, 64, 0
    s_mov_b64 s[88:89], exec
    s_mov_b64 s[90:91], exec
    s_mov_b64 s[92:93], exec
.mp_126:
    s_or_b64 exec, s[88:89], 1
    buffer_load_dwordx4 v[180:183], v2, s[36:39], s58 offen offset:0 sc1
    s_or_b64 exec, s[90:91], 1
    buffer_load_dwordx4 v[184:187], v2, s[36:39], s58 offen offset:1024 sc1
    s_or_b64 exec, s[92:93], 1
    buffer_load_dwordx2 v[188:189], v5, s[36:39], s58 offen offset:0 sc1
    s_mov_b64 exec, -1
    s_sub_u32 s35, s35, 1
    s_cbranch_scc1 .Lexit
    s_sub_u32 vcc_lo, s101, s58
    s_add_u32 s32, s32, 1
    s_cmp_ge_u32 s32, 64
    s_cselect_b32 s58, vcc_lo, s58
    s_waitcnt vmcnt(0)
.mpj_127:
    v_cmp_ne_u32 s[88:89], s34, v181
    v_cmp_ne_u32 vcc, s34, v183
    s_or_b64 s[88:89], s[88:89], vcc
    v_cmp_ne_u32 s[90:91], s34, v185
    v_cmp_ne_u32 vcc, s34, v187
    s_or_b64 s[90:91], s[90:91], vcc
    v_cmp_ne_u32 s[92:93], s34, v189
    s_or_b64 vcc, s[88:89], s[90:91]
    s_or_b64 vcc, vcc, s[92:93]
    s_cbranch_scc1 .mp_126
    s_mov_b32 s56, 0x3f803f80
    v_dot2_f32_bf16 v200, v180, s56, 0
    v_dot2_f32_bf16 v201, v180, v180, 0
    v_dot2_f32_bf16 v200, v182, s56, v200
    v_dot2_f32_bf16 v201, v182, v182, v201
    v_dot2_f32_bf16 v200, v184, s56, v200
    v_dot2_f32_bf16 v201, v184, v184, v201
    v_dot2_f32_bf16 v200, v186, s56, v200
    v_dot2_f32_bf16 v201, v186, v186, v201
    s_mov_b64 exec, 0xffffffff
    v_dot2_f32_bf16 v200, v188, s56, v200
    v_dot2_f32_bf16 v201, v188, v188, v201
    s_mov_b64 exec, -1
    s_nop 1
    v_permlane32_swap_b32 v200, v201
    v_add_f32 v200, v200, v201
    v_mov_b32 v202, v200
    s_nop 1
    v_permlane16_swap_b32 v202, v200
    v_add_f32 v200, v202, v200
    v_lshlrev_b32 v190, 16, v180
    v_and_b32 v191, 0xffff0000, v180
    v_add_f32_dpp v200, v200, v200 row_ror:8 row_mask:0xf bank_mask:0xf
    v_lshlrev_b32 v192, 16, v182
    v_and_b32 v193, 0xffff0000, v182
    v_add_f32_dpp v200, v200, v200 row_ror:4 row_mask:0xf bank_mask:0xf
    v_lshlrev_b32 v194, 16, v184
    v_and_b32 v195, 0xffff0000, v184
    v_add_f32_dpp v200, v200, v200 quad_perm:[2,3,0,1] row_mask:0xf bank_mask:0xf
    v_lshlrev_b32 v196, 16, v186
    v_and_b32 v197, 0xffff0000, v186
    v_add_f32_dpp v200, v200, v200 quad_perm:[1,0,3,2] row_mask:0xf bank_mask:0xf
    v_mul_f32 v200, 0x3ae38e39, v200
    v_lshlrev_b32 v198, 16, v188
    v_and_b32 v199, 0xffff0000, v188
    v_readlane_b32 s56, v200, 0
    v_readlane_b32 s57, v200, 32
    s_nop 0
    v_mov_b32 v200, s56
    v_fma_f32 v201, -v200, v200, s57
    v_max_f32 v201, 0, v201
    v_cvt_pk_bf16_f32 v203, 0, v201
    v_cvt_pk_bf16_f32 v201, 0, -v200
    v_cvt_pk_bf16_f32 v200, 0, -v200
    v_add_f32 v203, 0x3727c5ac, v203
    v_pk_add_f32 v[190:191], v[190:191], v[200:201]
    v_pk_add_f32 v[192:193], v[192:193], v[200:201]
    v_pk_add_f32 v[194:195], v[194:195], v[200:201]
    v_cvt_pk_bf16_f32 v203, 0, v203
    v_pk_add_f32 v[196:197], v[196:197], v[200:201]
    v_pk_add_f32 v[198:199], v[198:199], v[200:201]
    v_cvt_pk_bf16_f32 v190, 0, v190
    v_sqrt_f32 v203, v203
    v_cvt_pk_bf16_f32 v191, 0, v191
    v_cvt_pk_bf16_f32 v192, 0, v192
    v_cvt_pk_bf16_f32 v193, 0, v193
    v_cvt_pk_bf16_f32 v203, 0, v203
    v_cvt_pk_bf16_f32 v194, 0, v194
    v_cvt_pk_bf16_f32 v195, 0, v195
    v_cvt_pk_bf16_f32 v196, 0, v196
    v_rcp_f32 v202, v203
    v_cvt_pk_bf16_f32 v197, 0, v197
    v_cvt_pk_bf16_f32 v198, 0, v198
    v_cvt_pk_bf16_f32 v199, 0, v199
    v_mov_b32 v203, v202
    v_pk_mul_f32 v[190:191], v[190:191], v[202:203]
    v_pk_mul_f32 v[192:193], v[192:193], v[202:203]
    v_pk_mul_f32 v[194:195], v[194:195], v[202:203]
    v_pk_mul_f32 v[196:197], v[196:197], v[202:203]
    v_pk_mul_f32 v[198:199], v[198:199], v[202:203]
    v_cvt_pk_bf16_f32 v190, 0, v190
    v_cvt_pk_bf16_f32 v191, 0, v191
    v_cvt_pk_bf16_f32 v192, 0, v192
    v_cvt_pk_bf16_f32 v193, 0, v193
    v_cvt_pk_bf16_f32 v194, 0, v194
    v_cvt_pk_bf16_f32 v195, 0, v195
    v_cvt_pk_bf16_f32 v196, 0, v196
    v_cvt_pk_bf16_f32 v197, 0, v197
    v_cvt_pk_bf16_f32 v198, 0, v198
    v_cvt_pk_bf16_f32 v199, 0, v199
    v_pk_mul_f32 v[190:191], v[190:191], v[170:171]
    v_pk_mul_f32 v[192:193], v[192:193], v[172:173]
    v_pk_mul_f32 v[194:195], v[194:195], v[174:175]
    v_pk_mul_f32 v[196:197], v[196:197], v[176:177]
    v_pk_mul_f32 v[198:199], v[198:199], v[178:179]
    v_cvt_pk_bf16_f32 v190, 0, v190
    v_cvt_pk_bf16_f32 v191, 0, v191
    v_cvt_pk_bf16_f32 v192, 0, v192
    v_cvt_pk_bf16_f32 v193, 0, v193
    v_cvt_pk_bf16_f32 v194, 0, v194
    v_cvt_pk_bf16_f32 v195, 0, v195
    v_cvt_pk_bf16_f32 v196, 0, v196
    v_cvt_pk_bf16_f32 v197, 0, v197
    v_cvt_pk_bf16_f32 v198, 0, v198
    v_cvt_pk_bf16_f32 v199, 0, v199
    v_pk_add_f32 v[190:191], v[190:191], v[160:161]
    v_pk_add_f32 v[192:193], v[192:193], v[162:163]
    v_pk_add_f32 v[194:195], v[194:195], v[164:165]
    v_pk_add_f32 v[196:197], v[196:197], v[166:167]
    v_pk_add_f32 v[198:199], v[198:199], v[168:169]
    v_cvt_pk_bf16_f32 v206, v190, v191
    v_cvt_pk_bf16_f32 v207, v192, v193
    v_cvt_pk_bf16_f32 v208, v194, v195
    v_cvt_pk_bf16_f32 v209, v196, v197
    v_cvt_pk_bf16_f32 v210, v198, v199
    v_dot2_f32_bf16 v14, v206, v88, 0
    v_dot2_f32_bf16 v14, v207, v89, v14
    v_dot2_f32_bf16 v14, v208, v90, v14
    v_dot2_f32_bf16 v14, v209, v91, v14
    s_mov_b64 exec, 0xffffffff
    v_dot2_f32_bf16 v14, v210, v30, v14
    s_mov_b64 exec, -1
    s_nop 1
    v_mov_b32 v15, v14
    s_nop 1
    v_permlane32_swap_b32 v15, v14
    v_add_f32 v14, v15, v14
    v_mov_b32 v15, v14
    s_nop 1
    v_permlane16_swap_b32 v15, v14
    v_add_f32 v14, v15, v14
    s_nop 1
    v_add_f32_dpp v14, v14, v14 row_ror:8 row_mask:0xf bank_mask:0xf
    s_nop 1
    v_add_f32_dpp v14, v14, v14 row_ror:4 row_mask:0xf bank_mask:0xf
    s_nop 1
    v_add_f32_dpp v14, v14, v14 quad_perm:[2,3,0,1] row_mask:0xf bank_mask:0xf
    s_nop 1
    v_add_f32_dpp v14, v14, v14 quad_perm:[1,0,3,2] row_mask:0xf bank_mask:0xf
    v_cvt_pk_bf16_f32 v14, 0, v14
    v_max_f32 v14, 0xc2ae0000, v14
    v_min_f32 v14, 0x43000000, v14
    v_mul_f32 v15, 0xbfb8aa3b, v14
    v_fma_f32 v16, v14, s98, -v15
    v_fmac_f32 v16, 0xb2a57060, v14
    v_exp_f32 v15, v15
    v_mul_f32 v16, 0x3f317218, v16
    v_fmac_f32 v15, v15, v16
    v_add_f32 v15, 1.0, v15
    v_rcp_f32 v16, v15
    s_nop 0
    v_fma_f32 v15, -v15, v16, 1.0
    v_fma_f32 v14, v15, v16, v16
    v_cvt_pk_bf16_f32 v14, 0, v14
    v_add_f32 v17, v24, v200
    v_cvt_pk_bf16_f32 v17, 0, v17
    v_mul_f32 v17, v17, v202
    v_cvt_pk_bf16_f32 v17, 0, v17
    v_mul_f32 v17, v17, v81
    v_cvt_pk_bf16_f32 v17, 0, v17
    v_add_f32 v17, v17, v75
    v_cvt_pk_bf16_f32 v17, 0, v17
    s_lshl_b32 s59, s40, 1
    s_add_u32 s58, s59, 0x38c000
    s_mov_b32 s60, 0x04000c0c
    s_mov_b32 s61, 0x0706000c
    s_mov_b32 s48, s28
    s_and_b32 s49, s29, 0xffff
    s_mov_b32 s50, 0x2400
    s_mov_b32 s51, 0x00020000
    s_mul_i32 s63, s3, 1152
    s_lshl_b32 s56, s65, 7
    s_add_u32 s63, s63, s56
    s_mov_b64 s[88:89], exec
    s_mov_b64 s[90:91], exec
    s_mov_b64 s[92:93], exec
    s_mov_b64 s[56:57], exec
.mp_130:
    s_or_b64 exec, s[88:89], 1
    buffer_load_dwordx4 v[96:99], v2, s[36:39], s58 offen offset:0 sc1
    s_or_b64 exec, s[90:91], 1
    buffer_load_dwordx4 v[100:103], v2, s[36:39], s58 offen offset:1024 sc1
    s_or_b64 exec, s[92:93], 1
    buffer_load_dwordx4 v[104:107], v2, s[36:39], s58 offen offset:2048 sc1
    s_or_b64 exec, s[56:57], 1
    buffer_load_dwordx4 v[108:111], v2, s[36:39], s58 offen offset:3072 sc1
    s_mov_b64 exec, -1
    s_sub_u32 s35, s35, 1
    s_cbranch_scc1 .Lexit
    s_waitcnt vmcnt(0)
.mpj_131:
    v_cmp_ne_u32 s[88:89], s34, v99
    v_cmp_ne_u32 s[90:91], s34, v103
    v_cmp_ne_u32 s[92:93], s34, v107
    v_cmp_ne_u32 s[56:57], s34, v111
    s_or_b64 vcc, s[88:89], s[90:91]
    s_or_b64 vcc, vcc, s[92:93]
    s_or_b64 vcc, vcc, s[56:57]
    s_cbranch_scc1 .mp_130
    v_perm_b32 v99, v96, v97, s60
    v_perm_b32 v103, v100, v101, s60
    v_perm_b32 v107, v104, v105, s60
    v_perm_b32 v111, v108, v109, s60
    v_perm_b32 v99, v99, v98, s61
    v_perm_b32 v103, v103, v102, s61
    v_perm_b32 v107, v107, v106, s61
    v_perm_b32 v111, v111, v110, s61
    v_pk_add_f32 v[96:97], v[96:97], v[100:101]
    v_pk_add_f32 v[98:99], v[98:99], v[102:103]
    v_pk_add_f32 v[248:249], v[104:105], v[108:109]
    v_pk_add_f32 v[250:251], v[106:107], v[110:111]
    v_pk_add_f32 v[248:249], v[248:249], v[96:97]
    v_pk_add_f32 v[250:251], v[250:251], v[98:99]
    s_nop 1
    v_permlane32_swap_b32 v248, v250
    v_permlane32_swap_b32 v249, v251
    v_pk_add_f32 v[248:249], v[248:249], v[250:251]
    s_nop 1
    v_permlane16_swap_b32 v248, v249
    v_add_f32 v248, v248, v249
    v_cvt_pk_bf16_f32 v248, 0, v248
    v_mul_f32 v248, v248, v14
    v_cvt_pk_bf16_f32 v248, 0, v248
    v_add_f32 v248, v248, v17
    v_cvt_pk_bf16_f32 v248, 0, v248
    v_mul_f32 v248, v248, v83
    v_cvt_pk_bf16_f32 v248, 0, v248
    v_add_f32 v249, v248, v24
    v_add_f32 v248, v248, v24
    s_nop 1
    v_permlane16_swap_b32 v248, v249
    v_cvt_pk_bf16_f32 v252, v248, v249
    v_cvt_pk_bf16_f32 v253, v248, v249
    s_nop 1
    v_permlane32_swap_b32 v252, v253
    s_mov_b64 exec, 0xffff
    buffer_store_dwordx2 v[252:253], v3, s[48:51], s63 offen
    s_mov_b64 exec, -1
    s_waitcnt vmcnt(0)
    s_cmp_lg_u32 s2, 0
    s_cbranch_scc1 .Lexit
    v_mov_b32 v13, s34
    s_mov_b64 exec, 1
    buffer_store_dword v13, v2, s[36:39], 0 offen
    s_mov_b64 exec, -1
    s_branch .Lexit
.Latt_bc:
    v_and_b32 v8, 1, v0
    v_lshlrev_b32 v8, 8, v8
    v_and_b32 v9, 0x3c, v0
    v_lshl_add_u32 v9, v9, 2, v8
    v_lshlrev_b32 v7, 1, v9
    v_and_b32 v9, 0x3c, v0
    v_lshrrev_b32 v8, 4, v8
    v_and_b32 v9, 2, v0
    v_lshl_add_u32 v9, v9, 6, v8
    s_lshl_b32 s58, s66, 14
    s_lshl_b32 s59, s67, 10
    s_add_u32 s58, s58, s59
    s_add_u32 s58, s58, 0x40000
    s_lshl4_add_u32 s59, s66, s67
    s_lshl_b32 s59, s59, 8
    s_add_u32 s59, s59, 0x200000
    s_memrealtime s[8:9]
    s_waitcnt vmcnt(8)
    s_waitcnt lgkmcnt(0)
    s_sub_u32 s8, s8, s30
    s_cmpk_ge_u32 s8, 1147
    s_cbranch_scc1 .ap_134
    s_waitcnt vmcnt(5)
    s_cmpk_ge_u32 s8, 1082
    s_cbranch_scc1 .ap_134
    s_waitcnt vmcnt(3)
    s_bitcmp1_b64 s[14:15], 26
    s_cbranch_scc0 1
    s_waitcnt vmcnt(2)
    s_cmpk_ge_u32 s8, 1007
    s_cbranch_scc1 .ap_134
    s_waitcnt vmcnt(1)
.ap_134:
    s_add_u32 s63, s69, 409600
    buffer_load_dwordx4 v[88:91], v1, s[40:43], s63 offen nt
    s_memrealtime s[8:9]
    s_waitcnt vmcnt(8)
    s_waitcnt lgkmcnt(0)
    s_sub_u32 s8, s8, s30
    s_cmpk_ge_u32 s8, 1174
    s_cbranch_scc1 .ap_135
    s_waitcnt vmcnt(5)
    s_cmpk_ge_u32 s8, 1109
    s_cbranch_scc1 .ap_135
    s_waitcnt vmcnt(3)
    s_bitcmp1_b64 s[14:15], 27
    s_cbranch_scc0 1
    s_waitcnt vmcnt(2)
    s_cmpk_ge_u32 s8, 1034
    s_cbranch_scc1 .ap_135
    s_waitcnt vmcnt(1)
.ap_135:
    s_add_u32 s63, s69, 417792
    buffer_load_dwordx4 v[92:95], v1, s[40:43], s63 offen nt
    s_memrealtime s[8:9]
    s_waitcnt vmcnt(8)
    s_waitcnt lgkmcnt(0)
    s_sub_u32 s8, s8, s30
    s_cmpk_ge_u32 s8, 1201
    s_cbranch_scc1 .ap_136
    s_waitcnt vmcnt(5)
    s_cmpk_ge_u32 s8, 1136
    s_cbranch_scc1 .ap_136
    s_waitcnt vmcnt(3)
    s_bitcmp1_b64 s[14:15], 28
    s_cbranch_scc0 1
    s_waitcnt vmcnt(2)
    s_cmpk_ge_u32 s8, 1061
    s_cbranch_scc1 .ap_136
    s_waitcnt vmcnt(1)
.ap_136:
    s_add_u32 s63, s69, 425984
    buffer_load_dwordx4 v[120:123], v1, s[40:43], s63 offen nt
    s_memrealtime s[8:9]
    s_waitcnt vmcnt(8)
    s_waitcnt lgkmcnt(0)
    s_sub_u32 s8, s8, s30
    s_cmpk_ge_u32 s8, 1228
    s_cbranch_scc1 .ap_137
    s_waitcnt vmcnt(5)
    s_cmpk_ge_u32 s8, 1163
    s_cbranch_scc1 .ap_137
    s_waitcnt vmcnt(3)
    s_bitcmp1_b64 s[14:15], 29
    s_cbranch_scc0 1
    s_waitcnt vmcnt(2)
    s_cmpk_ge_u32 s8, 1088
    s_cbranch_scc1 .ap_137
    s_waitcnt vmcnt(1)
.ap_137:
    s_add_u32 s63, s69, 434176
    buffer_load_dwordx4 v[124:127], v1, s[40:43], s63 offen nt
    s_memrealtime s[8:9]
    s_waitcnt vmcnt(8)
    s_waitcnt lgkmcnt(0)
    s_sub_u32 s8, s8, s30
    s_cmpk_ge_u32 s8, 1255
    s_cbranch_scc1 .ap_138
    s_waitcnt vmcnt(5)
    s_cmpk_ge_u32 s8, 1190
    s_cbranch_scc1 .ap_138
    s_waitcnt vmcnt(3)
    s_bitcmp1_b64 s[14:15], 30
    s_cbranch_scc0 1
    s_waitcnt vmcnt(2)
    s_cmpk_ge_u32 s8, 1115
    s_cbranch_scc1 .ap_138
    s_waitcnt vmcnt(1)
.ap_138:
    s_add_u32 s63, s69, 442368
    buffer_load_dwordx4 v[152:155], v1, s[40:43], s63 offen nt
    s_memrealtime s[8:9]
    s_waitcnt vmcnt(8)
    s_waitcnt lgkmcnt(0)
    s_sub_u32 s8, s8, s30
    s_cmpk_ge_u32 s8, 1282
    s_cbranch_scc1 .ap_139
    s_waitcnt vmcnt(5)
    s_cmpk_ge_u32 s8, 1217
    s_cbranch_scc1 .ap_139
    s_waitcnt vmcnt(3)
    s_bitcmp1_b64 s[14:15], 31
    s_cbranch_scc0 1
    s_waitcnt vmcnt(2)
    s_cmpk_ge_u32 s8, 1142
    s_cbranch_scc1 .ap_139
    s_waitcnt vmcnt(1)
.ap_139:
    s_add_u32 s63, s69, 450560
    buffer_load_dwordx4 v[156:159], v1, s[40:43], s63 offen nt
    buffer_load_dwordx4 v[16:19], v7, s[36:39], s58 offen offset:0 sc1
    buffer_load_dwordx4 v[20:23], v7, s[36:39], s58 offen offset:16 sc1
    s_memrealtime s[8:9]
    s_waitcnt vmcnt(8)
    s_waitcnt lgkmcnt(0)
    s_sub_u32 s8, s8, s30
    s_cmpk_ge_u32 s8, 1309
    s_cbranch_scc1 .ap_140
    s_waitcnt vmcnt(5)
    s_cmpk_ge_u32 s8, 1244
    s_cbranch_scc1 .ap_140
    s_waitcnt vmcnt(3)
    s_bitcmp1_b64 s[14:15], 32
    s_cbranch_scc0 1
    s_waitcnt vmcnt(2)
    s_cmpk_ge_u32 s8, 1169
    s_cbranch_scc1 .ap_140
    s_waitcnt vmcnt(1)
.ap_140:
    s_add_u32 s63, s69, 0
    buffer_load_dwordx4 v[160:163], v2, s[44:47], s63 offen nt
    s_memrealtime s[8:9]
    s_waitcnt vmcnt(8)
    s_waitcnt lgkmcnt(0)
    s_sub_u32 s8, s8, s30
    s_cmpk_ge_u32 s8, 1336
    s_cbranch_scc1 .ap_141
    s_waitcnt vmcnt(5)
    s_cmpk_ge_u32 s8, 1271
    s_cbranch_scc1 .ap_141
    s_waitcnt vmcnt(3)
    s_bitcmp1_b64 s[14:15], 33
    s_cbranch_scc0 1
    s_waitcnt vmcnt(2)
    s_cmpk_ge_u32 s8, 1196
    s_cbranch_scc1 .ap_141
    s_waitcnt vmcnt(1)
.ap_141:
    s_add_u32 s63, s69, 8192
    buffer_load_dwordx4 v[164:167], v2, s[44:47], s63 offen nt
    s_memrealtime s[8:9]
    s_waitcnt vmcnt(8)
    s_waitcnt lgkmcnt(0)
    s_sub_u32 s8, s8, s30
    s_cmpk_ge_u32 s8, 1363
    s_cbranch_scc1 .ap_142
    s_waitcnt vmcnt(5)
    s_cmpk_ge_u32 s8, 1298
    s_cbranch_scc1 .ap_142
    s_waitcnt vmcnt(3)
    s_bitcmp1_b64 s[14:15], 34
    s_cbranch_scc0 1
    s_waitcnt vmcnt(2)
    s_cmpk_ge_u32 s8, 1223
    s_cbranch_scc1 .ap_142
    s_waitcnt vmcnt(1)
.ap_142:
    s_add_u32 s63, s69, 16384
    buffer_load_dwordx4 v[168:171], v2, s[44:47], s63 offen nt
    s_waitcnt vmcnt(3)
    s_branch .gpc_144
.gp_143:
    buffer_load_dwordx4 v[16:19], v7, s[36:39], s58 offen offset:0 sc1
    buffer_load_dwordx4 v[20:23], v7, s[36:39], s58 offen offset:16 sc1
    s_waitcnt vmcnt(0)
.gpc_144:
    v_min_u32 v10, v17, v19
    v_max_u32 v11, v17, v19
    v_min3_u32 v10, v10, v21, v23
    v_max3_u32 v11, v11, v21, v23
    v_cmp_eq_u32 vcc, s34, v10
    v_cmp_eq_u32 s[56:57], s34, v11
    s_and_b64 vcc, vcc, s[56:57]
    s_cmp_eq_u64 vcc, exec
    s_nop 2
    s_cbranch_scc1 .gpd_145
    s_sub_u32 s35, s35, 1
    s_cbranch_scc1 .Lexit
    s_sleep 1
    s_branch .gp_143
.gpd_145:
    s_mov_b32 vcc_lo, 0xcccccccc
    s_mov_b32 vcc_hi, 0xcccccccc
    v_cndmask_b32_e64 v24, v16, 0, vcc
    v_cndmask_b32_e64 v25, v18, 0, vcc
    v_cndmask_b32_e64 v26, v20, 0, vcc
    v_cndmask_b32_e64 v27, v22, 0, vcc
    v_cndmask_b32_e32 v28, 0, v16, vcc
    v_cndmask_b32_e32 v29, 0, v18, vcc
    v_cndmask_b32_e32 v30, 0, v20, vcc
    v_cndmask_b32_e32 v31, 0, v22, vcc
    v_mfma_f32_16x16x32_bf16 v[16:19], v[32:35], v[24:27], 0
    v_mfma_f32_16x16x32_bf16 v[32:35], v[40:43], v[24:27], 0
    v_mfma_f32_16x16x32_bf16 v[16:19], v[36:39], v[28:31], v[16:19]
    v_mfma_f32_16x16x32_bf16 v[40:43], v[48:51], v[24:27], 0
    v_mfma_f32_16x16x32_bf16 v[32:35], v[44:47], v[28:31], v[32:35]
    v_mfma_f32_16x16x32_bf16 v[48:51], v[56:59], v[24:27], 0
    v_mfma_f32_16x16x32_bf16 v[40:43], v[52:55], v[28:31], v[40:43]
    v_mfma_f32_16x16x32_bf16 v[56:59], v[64:67], v[24:27], 0
    v_mfma_f32_16x16x32_bf16 v[48:51], v[60:63], v[28:31], v[48:51]
    s_nop 1
    v_add_f32_dpp v10, v17, v16 row_ror:12 row_mask:0xf bank_mask:0x1
    s_memrealtime s[8:9]
    s_waitcnt lgkmcnt(0)
    s_sub_u32 s8, s8, s30
    s_cmpk_ge_u32 s8, 1390
    s_nop 0
    s_cbranch_scc1 .ap_146
    s_waitcnt vmcnt(3)
    s_cmpk_ge_u32 s8, 1325
    s_cbranch_scc1 .ap_146
    s_waitcnt vmcnt(3)
    s_bitcmp1_b64 s[14:15], 35
    s_cbranch_scc0 1
    s_waitcnt vmcnt(2)
    s_cmpk_ge_u32 s8, 1250
    s_cbranch_scc1 .ap_146
    s_waitcnt vmcnt(1)
.ap_146:
    s_add_u32 s63, s69, 24576
    buffer_load_dwordx4 v[172:175], v2, s[44:47], s63 offen nt
    v_mfma_f32_16x16x32_bf16 v[64:67], v[72:75], v[24:27], 0
    v_mfma_f32_16x16x32_bf16 v[56:59], v[68:71], v[28:31], v[56:59]
    v_add_f32_dpp v11, v33, v32 row_ror:12 row_mask:0xf bank_mask:0x1
    v_add_f32_dpp v10, v18, v10 row_ror:8 row_mask:0xf bank_mask:0x1
    v_mfma_f32_16x16x32_bf16 v[72:75], v[80:83], v[24:27], 0
    v_mfma_f32_16x16x32_bf16 v[64:67], v[76:79], v[28:31], v[64:67]
    v_add_f32_dpp v12, v41, v40 row_ror:12 row_mask:0xf bank_mask:0x1
    v_add_f32_dpp v11, v34, v11 row_ror:8 row_mask:0xf bank_mask:0x1
    v_add_f32_dpp v10, v19, v10 row_ror:4 row_mask:0xf bank_mask:0x1
    v_mfma_f32_16x16x32_bf16 v[80:83], v[88:91], v[24:27], 0
    v_mfma_f32_16x16x32_bf16 v[72:75], v[84:87], v[28:31], v[72:75]
    v_add_f32_dpp v13, v49, v48 row_ror:12 row_mask:0xf bank_mask:0x1
    v_add_f32_dpp v12, v42, v12 row_ror:8 row_mask:0xf bank_mask:0x1
    v_add_f32_dpp v11, v35, v11 row_ror:4 row_mask:0xf bank_mask:0x1
    v_mfma_f32_16x16x32_bf16 v[88:91], v[96:99], v[24:27], 0
    v_mfma_f32_16x16x32_bf16 v[80:83], v[92:95], v[28:31], v[80:83]
    v_add_f32_dpp v10, v58, v57 row_ror:12 row_mask:0xf bank_mask:0x2
    v_add_f32_dpp v13, v50, v13 row_ror:8 row_mask:0xf bank_mask:0x1
    v_add_f32_dpp v12, v43, v12 row_ror:4 row_mask:0xf bank_mask:0x1
    s_memrealtime s[8:9]
    s_waitcnt lgkmcnt(0)
    s_sub_u32 s8, s8, s30
    s_cmpk_ge_u32 s8, 1417
    s_nop 0
    s_cbranch_scc1 .ap_147
    s_waitcnt vmcnt(4)
    s_cmpk_ge_u32 s8, 1352
    s_cbranch_scc1 .ap_147
    s_waitcnt vmcnt(3)
    s_bitcmp1_b64 s[14:15], 36
    s_cbranch_scc0 1
    s_waitcnt vmcnt(2)
    s_cmpk_ge_u32 s8, 1277
    s_cbranch_scc1 .ap_147
    s_waitcnt vmcnt(1)
.ap_147:
    s_add_u32 s63, s69, 32768
    buffer_load_dwordx4 v[176:179], v2, s[44:47], s63 offen nt
    v_mfma_f32_16x16x32_bf16 v[96:99], v[104:107], v[24:27], 0
    v_mfma_f32_16x16x32_bf16 v[88:91], v[100:103], v[28:31], v[88:91]
    v_add_f32_dpp v11, v66, v65 row_ror:12 row_mask:0xf bank_mask:0x2
    v_add_f32_dpp v10, v59, v10 row_ror:8 row_mask:0xf bank_mask:0x2
    v_add_f32_dpp v13, v51, v13 row_ror:4 row_mask:0xf bank_mask:0x1
    v_mfma_f32_16x16x32_bf16 v[104:107], v[112:115], v[24:27], 0
    v_mfma_f32_16x16x32_bf16 v[96:99], v[108:111], v[28:31], v[96:99]
    v_add_f32_dpp v12, v74, v73 row_ror:12 row_mask:0xf bank_mask:0x2
    v_add_f32_dpp v11, v67, v11 row_ror:8 row_mask:0xf bank_mask:0x2
    v_add_f32_dpp v10, v56, v10 row_ror:4 row_mask:0xf bank_mask:0x2
    v_mfma_f32_16x16x32_bf16 v[112:115], v[120:123], v[24:27], 0
    v_mfma_f32_16x16x32_bf16 v[104:107], v[116:119], v[28:31], v[104:107]
    v_add_f32_dpp v13, v82, v81 row_ror:12 row_mask:0xf bank_mask:0x2
    v_add_f32_dpp v12, v75, v12 row_ror:8 row_mask:0xf bank_mask:0x2
    v_add_f32_dpp v11, v64, v11 row_ror:4 row_mask:0xf bank_mask:0x2
    v_mfma_f32_16x16x32_bf16 v[120:123], v[128:131], v[24:27], 0
    v_mfma_f32_16x16x32_bf16 v[112:115], v[124:127], v[28:31], v[112:115]
    v_add_f32_dpp v10, v91, v90 row_ror:12 row_mask:0xf bank_mask:0x4
    v_add_f32_dpp v13, v83, v13 row_ror:8 row_mask:0xf bank_mask:0x2
    v_add_f32_dpp v12, v72, v12 row_ror:4 row_mask:0xf bank_mask:0x2
    s_memrealtime s[8:9]
    s_waitcnt lgkmcnt(0)
    s_sub_u32 s8, s8, s30
    s_cmpk_ge_u32 s8, 1444
    s_nop 0
    s_cbranch_scc1 .ap_148
    s_waitcnt vmcnt(5)
    s_cmpk_ge_u32 s8, 1379
    s_cbranch_scc1 .ap_148
    s_waitcnt vmcnt(3)
    s_bitcmp1_b64 s[14:15], 37
    s_cbranch_scc0 1
    s_waitcnt vmcnt(2)
    s_cmpk_ge_u32 s8, 1304
    s_cbranch_scc1 .ap_148
    s_waitcnt vmcnt(1)
.ap_148:
    s_add_u32 s63, s69, 40960
    buffer_load_dwordx4 v[180:183], v2, s[44:47], s63 offen nt
    v_mfma_f32_16x16x32_bf16 v[128:131], v[136:139], v[24:27], 0
    v_mfma_f32_16x16x32_bf16 v[120:123], v[132:135], v[28:31], v[120:123]
    v_add_f32_dpp v11, v99, v98 row_ror:12 row_mask:0xf bank_mask:0x4
    v_add_f32_dpp v10, v88, v10 row_ror:8 row_mask:0xf bank_mask:0x4
    v_add_f32_dpp v13, v80, v13 row_ror:4 row_mask:0xf bank_mask:0x2
    v_mfma_f32_16x16x32_bf16 v[136:139], v[144:147], v[24:27], 0
    v_mfma_f32_16x16x32_bf16 v[128:131], v[140:143], v[28:31], v[128:131]
    v_add_f32_dpp v12, v107, v106 row_ror:12 row_mask:0xf bank_mask:0x4
    v_add_f32_dpp v11, v96, v11 row_ror:8 row_mask:0xf bank_mask:0x4
    v_add_f32_dpp v10, v89, v10 row_ror:4 row_mask:0xf bank_mask:0x4
    v_mfma_f32_16x16x32_bf16 v[144:147], v[152:155], v[24:27], 0
    v_mfma_f32_16x16x32_bf16 v[136:139], v[148:151], v[28:31], v[136:139]
    v_add_f32_dpp v13, v115, v114 row_ror:12 row_mask:0xf bank_mask:0x4
    v_add_f32_dpp v12, v104, v12 row_ror:8 row_mask:0xf bank_mask:0x4
    v_add_f32_dpp v11, v97, v11 row_ror:4 row_mask:0xf bank_mask:0x4
    v_mfma_f32_16x16x32_bf16 v[144:147], v[156:159], v[28:31], v[144:147]
    v_add_f32_dpp v10, v120, v123 row_ror:12 row_mask:0xf bank_mask:0x8
    v_add_f32_dpp v13, v112, v13 row_ror:8 row_mask:0xf bank_mask:0x4
    v_add_f32_dpp v12, v105, v12 row_ror:4 row_mask:0xf bank_mask:0x4
    s_memrealtime s[8:9]
    s_waitcnt lgkmcnt(0)
    s_sub_u32 s8, s8, s30
    s_cmpk_ge_u32 s8, 1471
    s_nop 0
    s_cbranch_scc1 .ap_149
    s_waitcnt vmcnt(5)
    s_cmpk_ge_u32 s8, 1406
    s_cbranch_scc1 .ap_149
    s_waitcnt vmcnt(3)
    s_bitcmp1_b64 s[14:15], 38
    s_cbranch_scc0 1
    s_waitcnt vmcnt(2)
    s_cmpk_ge_u32 s8, 1331
    s_cbranch_scc1 .ap_149
    s_waitcnt vmcnt(1)
.ap_149:
    s_add_u32 s63, s69, 49152
    buffer_load_dwordx4 v[184:187], v2, s[44:47], s63 offen nt
    v_add_f32_dpp v11, v128, v131 row_ror:12 row_mask:0xf bank_mask:0x8
    v_add_f32_dpp v10, v121, v10 row_ror:8 row_mask:0xf bank_mask:0x8
    v_add_f32_dpp v13, v113, v13 row_ror:4 row_mask:0xf bank_mask:0x4
    v_add_f32_dpp v12, v136, v139 row_ror:12 row_mask:0xf bank_mask:0x8
    v_add_f32_dpp v11, v129, v11 row_ror:8 row_mask:0xf bank_mask:0x8
    v_add_f32_dpp v10, v122, v10 row_ror:4 row_mask:0xf bank_mask:0x8
    v_add_f32_dpp v13, v144, v147 row_ror:12 row_mask:0xf bank_mask:0x8
    v_add_f32_dpp v12, v137, v12 row_ror:8 row_mask:0xf bank_mask:0x8
    v_add_f32_dpp v11, v130, v11 row_ror:4 row_mask:0xf bank_mask:0x8
    v_add_f32_dpp v13, v145, v13 row_ror:8 row_mask:0xf bank_mask:0x8
    v_add_f32_dpp v12, v138, v12 row_ror:4 row_mask:0xf bank_mask:0x8
    s_memrealtime s[8:9]
    s_waitcnt lgkmcnt(0)
    s_sub_u32 s8, s8, s30
    s_cmpk_ge_u32 s8, 1498
    s_cbranch_scc1 .ap_150
    s_waitcnt vmcnt(5)
    s_cmpk_ge_u32 s8, 1433
    s_cbranch_scc1 .ap_150
    s_waitcnt vmcnt(3)
    s_bitcmp1_b64 s[14:15], 39
    s_cbranch_scc0 1
    s_waitcnt vmcnt(2)
    s_cmpk_ge_u32 s8, 1358
    s_cbranch_scc1 .ap_150
    s_waitcnt vmcnt(1)
.ap_150:
    s_add_u32 s63, s69, 57344
    buffer_load_dwordx4 v[188:191], v2, s[44:47], s63 offen nt
    v_add_f32_dpp v13, v146, v13 row_ror:4 row_mask:0xf bank_mask:0x8
    s_mov_b32 s60, 0x3db504f3
    s_mov_b32 s61, 0x3db504f3
    v_cvt_pk_bf16_f32 v10, 0, v10
    v_cvt_pk_bf16_f32 v11, 0, v11
    v_cvt_pk_bf16_f32 v12, 0, v12
    v_cvt_pk_bf16_f32 v13, 0, v13
    v_pk_mul_f32 v[10:11], v[10:11], s[60:61]
    v_pk_mul_f32 v[12:13], v[12:13], s[60:61]
    v_cvt_pk_bf16_f32 v10, 0, v10
    v_cvt_pk_bf16_f32 v11, 0, v11
    v_cvt_pk_bf16_f32 v12, 0, v12
    v_cvt_pk_bf16_f32 v13, 0, v13
    v_max_f32 v14, v10, v11
    v_max3_f32 v14, v14, v12, v13
    s_mov_b32 s60, 0x3fb8aa3b
    v_mov_b32 v22, s34
    v_mov_b32 v23, s34
    v_max_f32_dpp v14, v14, v14 quad_perm:[2,3,0,1] row_mask:0xf bank_mask:0xf
    s_nop 1
    v_max_f32_dpp v14, v14, v14 row_ror:4 row_mask:0xf bank_mask:0xf
    s_nop 1
    v_max_f32_dpp v14, v14, v14 row_ror:8 row_mask:0xf bank_mask:0xf
    v_mov_b32 v15, v14
    s_nop 1
    v_permlane16_swap_b32 v15, v14
    v_max_f32 v14, v15, v14
    v_mov_b32 v15, v14
    s_nop 1
    v_permlane32_swap_b32 v15, v14
    v_max_f32 v14, v15, v14
    v_mul_f32 v15, 0xbfb8aa3b, v14
    v_fma_f32 v10, v10, s60, v15
    v_fma_f32 v11, v11, s60, v15
    v_fma_f32 v12, v12, s60, v15
    v_fma_f32 v13, v13, s60, v15
    v_exp_f32 v10, v10
    v_exp_f32 v11, v11
    v_exp_f32 v12, v12
    v_exp_f32 v13, v13
    v_mov_b32 v20, v14
    v_pk_add_f32 v[16:17], v[10:11], v[12:13]
    v_add_f32 v21, v16, v17
    s_lshl3_add_u32 s60, s68, s3
    s_lshl_b32 s60, s60, 5
    s_add_u32 s60, s60, s59
    v_add_f32_dpp v21, v21, v21 quad_perm:[2,3,0,1] row_mask:0xf bank_mask:0xf
    s_nop 1
    v_add_f32_dpp v21, v21, v21 row_ror:4 row_mask:0xf bank_mask:0xf
    s_nop 1
    v_add_f32_dpp v21, v21, v21 row_ror:8 row_mask:0xf bank_mask:0xf
    v_mov_b32 v15, v21
    s_nop 1
    v_permlane16_swap_b32 v15, v21
    v_add_f32 v21, v15, v21
    v_mov_b32 v15, v21
    s_nop 1
    v_permlane32_swap_b32 v15, v21
    v_add_f32 v21, v15, v21
    s_lshl_b32 s60, s3, 4
    s_add_u32 s60, s60, 159104
    v_add_u32 v16, s60, v3
    v_mov_b32 v17, 159232
    v_mov_b32 v18, 1
    s_mov_b64 exec, 3
    ds_write_b64 v16, v[20:21]
    s_mov_b64 exec, 1
    s_waitcnt lgkmcnt(0)
    ds_add_rtn_u32 v18, v17, v18
    s_mov_b64 exec, -1
    v_and_b32 v16, 0x78, v3
    v_add_u32 v16, 159104, v16
    s_waitcnt lgkmcnt(0)
    v_readfirstlane_b32 s60, v18
    s_cmp_lg_u32 s60, 7
    s_nop 3
    s_cbranch_scc1 .ml_151
    ds_read_b64 v[18:19], v16
    s_lshl_b32 s60, s68, 7
    s_add_u32 s60, s60, s59
    s_waitcnt lgkmcnt(0)
    v_mov_b32 v20, v18
    s_nop 1
    v_max_f32_dpp v20, v20, v20 quad_perm:[2,3,0,1] row_mask:0xf bank_mask:0xf
    s_nop 1
    v_max_f32_dpp v20, v20, v20 row_ror:4 row_mask:0xf bank_mask:0xf
    s_nop 1
    v_max_f32_dpp v20, v20, v20 row_ror:8 row_mask:0xf bank_mask:0xf
    v_sub_f32 v18, v18, v20
    v_mul_f32 v18, 0x3fb8aa3b, v18
    v_exp_f32 v18, v18
    s_nop 0
    v_mul_f32 v21, v18, v19
    s_nop 1
    v_add_f32_dpp v21, v21, v21 quad_perm:[2,3,0,1] row_mask:0xf bank_mask:0xf
    s_nop 1
    v_add_f32_dpp v21, v21, v21 row_ror:4 row_mask:0xf bank_mask:0xf
    s_nop 1
    v_add_f32_dpp v21, v21, v21 row_ror:8 row_mask:0xf bank_mask:0xf
    s_mov_b64 exec, 0xff
    buffer_store_dwordx4 v[20:23], v2, s[36:39], s60 offen sc1
    s_mov_b64 exec, -1
.ml_151:
    s_memrealtime s[8:9]
    s_waitcnt lgkmcnt(0)
    s_sub_u32 s8, s8, s30
    s_cmpk_ge_u32 s8, 1525
    s_cbranch_scc1 .ap_152
    s_waitcnt vmcnt(5)
    s_cmpk_ge_u32 s8, 1460
    s_cbranch_scc1 .ap_152
    s_waitcnt vmcnt(3)
    s_bitcmp1_b64 s[14:15], 40
    s_cbranch_scc0 1
    s_waitcnt vmcnt(2)
    s_cmpk_ge_u32 s8, 1385
    s_cbranch_scc1 .ap_152
    s_waitcnt vmcnt(1)
.ap_152:
    s_add_u32 s63, s69, 131072
    buffer_load_dwordx4 v[192:195], v2, s[44:47], s63 offen nt
    s_sub_u32 s57, s65, 9
    s_bitcmp1_b32 s57, 0
    s_cselect_b32 s48, s20, s18
    s_cselect_b32 s49, s21, s19
    s_cselect_b32 s33, 36, 0
    s_and_b32 s49, s49, 0xffff
    s_mov_b32 s50, 0x510000
    s_mov_b32 s51, 0x00020000
    s_mov_b32 s52, s22
    s_and_b32 s53, s23, 0xffff
    s_mov_b32 s54, 0x510000
    s_mov_b32 s55, 0x00020000
    s_lshr_b32 s57, s57, 1
    s_lshl_b32 s57, s57, 7
    s_mul_i32 s101, s64, 1152
    s_add_u32 s101, s101, s57
    s_mul_i32 s56, s3, 73728
    s_add_u32 s101, s101, s56
    s_mul_i32 s56, s64, 72
    s_add_u32 s33, s33, s56
    s_add_u32 s33, s33, s3
    s_mul_i32 s33, s33, 9216
    s_add_u32 s33, s33, s57
    s_bfe_u32 s56, s101, 0x30007
    s_cmp_eq_u32 s56, 3
    s_cselect_b32 s43, 1, 0
    v_bfe_u32 v16, v0, 4, 1
    s_and_b32 s56, s3, 3
    s_lshl_b32 s56, s56, 1
    v_or_b32 v16, s56, v16
    v_and_b32 v6, 7, v0
    v_xor_b32 v16, v16, v6
    v_lshrrev_b32 v6, 3, v0
    v_mul_u32_u24 v6, 9216, v6
    v_lshl_add_u32 v6, v16, 4, v6
    v_bfe_u32 v16, v0, 4, 1
    s_and_b32 s56, s3, 1
    s_lshl_b32 s56, s56, 2
    v_lshl_or_b32 v16, v16, 1, s56
    v_and_b32 v17, 7, v0
    v_xor_b32 v16, v16, v17
    v_lshrrev_b32 v17, 3, v0
    v_mul_u32_u24 v17, 1152, v17
    v_lshl_add_u32 v31, v16, 4, v17
    s_memrealtime s[8:9]
    s_waitcnt vmcnt(8)
    s_waitcnt lgkmcnt(0)
    s_sub_u32 s8, s8, s30
    s_cmpk_ge_u32 s8, 1552
    s_cbranch_scc1 .ap_153
    s_waitcnt vmcnt(5)
    s_cmpk_ge_u32 s8, 1487
    s_cbranch_scc1 .ap_153
    s_waitcnt vmcnt(3)
    s_bitcmp1_b64 s[14:15], 41
    s_cbranch_scc0 1
    s_waitcnt vmcnt(2)
    s_cmpk_ge_u32 s8, 1412
    s_cbranch_scc1 .ap_153
    s_waitcnt vmcnt(1)
.ap_153:
    s_add_u32 s63, s69, 139264
    buffer_load_dwordx4 v[196:199], v2, s[44:47], s63 offen nt
    s_memrealtime s[8:9]
    s_waitcnt vmcnt(8)
    s_waitcnt lgkmcnt(0)
    s_sub_u32 s8, s8, s30
    s_cmpk_ge_u32 s8, 1579
    s_cbranch_scc1 .ap_154
    s_waitcnt vmcnt(5)
    s_cmpk_ge_u32 s8, 1514
    s_cbranch_scc1 .ap_154
    s_waitcnt vmcnt(3)
    s_bitcmp1_b64 s[14:15], 42
    s_cbranch_scc0 1
    s_waitcnt vmcnt(2)
    s_cmpk_ge_u32 s8, 1439
    s_cbranch_scc1 .ap_154
    s_waitcnt vmcnt(1)
.ap_154:
    s_add_u32 s63, s69, 147456
    buffer_load_dwordx4 v[200:203], v2, s[44:47], s63 offen nt
    s_memrealtime s[8:9]
    s_waitcnt vmcnt(8)
    s_waitcnt lgkmcnt(0)
    s_sub_u32 s8, s8, s30
    s_cmpk_ge_u32 s8, 1606
    s_cbranch_scc1 .ap_155
    s_waitcnt vmcnt(5)
    s_cmpk_ge_u32 s8, 1541
    s_cbranch_scc1 .ap_155
    s_waitcnt vmcnt(3)
    s_bitcmp1_b64 s[14:15], 43
    s_cbranch_scc0 1
    s_waitcnt vmcnt(2)
    s_cmpk_ge_u32 s8, 1466
    s_cbranch_scc1 .ap_155
    s_waitcnt vmcnt(1)
.ap_155:
    s_add_u32 s63, s69, 155648
    buffer_load_dwordx4 v[204:207], v2, s[44:47], s63 offen nt
    s_memrealtime s[8:9]
    s_waitcnt vmcnt(8)
    s_waitcnt lgkmcnt(0)
    s_sub_u32 s8, s8, s30
    s_cmpk_ge_u32 s8, 1633
    s_cbranch_scc1 .ap_156
    s_waitcnt vmcnt(5)
    s_cmpk_ge_u32 s8, 1568
    s_cbranch_scc1 .ap_156
    s_waitcnt vmcnt(3)
    s_bitcmp1_b64 s[14:15], 44
    s_cbranch_scc0 1
    s_waitcnt vmcnt(2)
    s_cmpk_ge_u32 s8, 1493
    s_cbranch_scc1 .ap_156
    s_waitcnt vmcnt(1)
.ap_156:
    s_add_u32 s63, s69, 163840
    buffer_load_dwordx4 v[208:211], v2, s[44:47], s63 offen nt
    s_memrealtime s[8:9]
    s_waitcnt vmcnt(8)
    s_waitcnt lgkmcnt(0)
    s_sub_u32 s8, s8, s30
    s_cmpk_ge_u32 s8, 1660
    s_cbranch_scc1 .ap_157
    s_waitcnt vmcnt(5)
    s_cmpk_ge_u32 s8, 1595
    s_cbranch_scc1 .ap_157
    s_waitcnt vmcnt(3)
    s_bitcmp1_b64 s[14:15], 45
    s_cbranch_scc0 1
    s_waitcnt vmcnt(2)
    s_cmpk_ge_u32 s8, 1520
    s_cbranch_scc1 .ap_157
    s_waitcnt vmcnt(1)
.ap_157:
    s_add_u32 s63, s69, 172032
    buffer_load_dwordx4 v[212:215], v2, s[44:47], s63 offen nt
    s_memrealtime s[8:9]
    s_waitcnt vmcnt(8)
    s_waitcnt lgkmcnt(0)
    s_sub_u32 s8, s8, s30
    s_cmpk_ge_u32 s8, 1691
    s_cbranch_scc1 .ap_158
    s_waitcnt vmcnt(5)
    s_cmpk_ge_u32 s8, 1626
    s_cbranch_scc1 .ap_158
    s_waitcnt vmcnt(3)
    s_bitcmp1_b64 s[14:15], 46
    s_cbranch_scc0 1
    s_waitcnt vmcnt(2)
    s_cmpk_ge_u32 s8, 1551
    s_cbranch_scc1 .ap_158
    s_waitcnt vmcnt(1)
.ap_158:
    s_add_u32 s63, s69, 180224
    buffer_load_dwordx4 v[216:219], v2, s[44:47], s63 offen nt
    s_memrealtime s[8:9]
    s_waitcnt vmcnt(8)
    s_waitcnt lgkmcnt(0)
    s_sub_u32 s8, s8, s30
    s_cmpk_ge_u32 s8, 1722
    s_cbranch_scc1 .ap_159
    s_waitcnt vmcnt(5)
    s_cmpk_ge_u32 s8, 1657
    s_cbranch_scc1 .ap_159
    s_waitcnt vmcnt(3)
    s_bitcmp1_b64 s[14:15], 47
    s_cbranch_scc0 1
    s_waitcnt vmcnt(2)
    s_cmpk_ge_u32 s8, 1582
    s_cbranch_scc1 .ap_159
    s_waitcnt vmcnt(1)
.ap_159:
    s_add_u32 s63, s69, 188416
    buffer_load_dwordx4 v[220:223], v2, s[44:47], s63 offen nt
    s_mul_i32 s99, s3, 2304
    s_add_u32 s99, s99, 0x1e000
    buffer_load_dwordx4 v[32:35], v2, s[36:39], s99 offen offset:0 sc1
    buffer_load_dwordx4 v[40:43], v2, s[36:39], s99 offen offset:1024 sc1
    buffer_load_dwordx2 v[48:49], v5, s[36:39], s99 offen offset:0 sc1
    s_memrealtime s[8:9]
    s_waitcnt vmcnt(11)
    s_waitcnt lgkmcnt(0)
    s_sub_u32 s8, s8, s30
    s_cmpk_ge_u32 s8, 1753
    s_cbranch_scc1 .ap_160
    s_waitcnt vmcnt(8)
    s_cmpk_ge_u32 s8, 1688
    s_cbranch_scc1 .ap_160
    s_waitcnt vmcnt(6)
    s_bitcmp1_b64 s[14:15], 48
    s_cbranch_scc0 1
    s_waitcnt vmcnt(5)
    s_cmpk_ge_u32 s8, 1613
    s_cbranch_scc1 .ap_160
    s_waitcnt vmcnt(4)
.ap_160:
    s_add_u32 s63, s69, 262144
    buffer_load_dwordx4 v[224:227], v2, s[44:47], s63 offen nt
    s_memrealtime s[8:9]
    s_waitcnt vmcnt(11)
    s_waitcnt lgkmcnt(0)
    s_sub_u32 s8, s8, s30
    s_cmpk_ge_u32 s8, 1784
    s_cbranch_scc1 .ap_161
    s_waitcnt vmcnt(8)
    s_cmpk_ge_u32 s8, 1719
    s_cbranch_scc1 .ap_161
    s_waitcnt vmcnt(6)
    s_bitcmp1_b64 s[14:15], 49
    s_cbranch_scc0 1
    s_waitcnt vmcnt(5)
    s_cmpk_ge_u32 s8, 1644
    s_cbranch_scc1 .ap_161
    s_waitcnt vmcnt(4)
.ap_161:
    s_add_u32 s63, s69, 270336
    buffer_load_dwordx4 v[228:231], v2, s[44:47], s63 offen nt
    s_mul_i32 s100, s3, 2304
    s_add_u32 s100, s100, 0x27000
    buffer_load_dwordx4 v[56:59], v2, s[36:39], s100 offen offset:0 sc1
    buffer_load_dwordx4 v[64:67], v2, s[36:39], s100 offen offset:1024 sc1
    buffer_load_dwordx2 v[50:51], v5, s[36:39], s100 offen offset:0 sc1
    s_memrealtime s[8:9]
    s_waitcnt vmcnt(14)
    s_waitcnt lgkmcnt(0)
    s_sub_u32 s8, s8, s30
    s_cmpk_ge_u32 s8, 1815
    s_cbranch_scc1 .ap_162
    s_waitcnt vmcnt(11)
    s_cmpk_ge_u32 s8, 1750
    s_cbranch_scc1 .ap_162
    s_waitcnt vmcnt(9)
    s_bitcmp1_b64 s[14:15], 50
    s_cbranch_scc0 1
    s_waitcnt vmcnt(8)
    s_cmpk_ge_u32 s8, 1675
    s_cbranch_scc1 .ap_162
    s_waitcnt vmcnt(4)
.ap_162:
    s_add_u32 s63, s69, 278528
    buffer_load_dwordx4 v[232:235], v2, s[44:47], s63 offen nt
    s_memrealtime s[8:9]
    s_waitcnt vmcnt(14)
    s_waitcnt lgkmcnt(0)
    s_sub_u32 s8, s8, s30
    s_cmpk_ge_u32 s8, 1846
    s_cbranch_scc1 .ap_163
    s_waitcnt vmcnt(11)
    s_cmpk_ge_u32 s8, 1781
    s_cbranch_scc1 .ap_163
    s_waitcnt vmcnt(9)
    s_bitcmp1_b64 s[14:15], 51
    s_cbranch_scc0 1
    s_waitcnt vmcnt(5)
    s_cmpk_ge_u32 s8, 1706
    s_cbranch_scc1 .ap_163
    s_waitcnt vmcnt(4)
.ap_163:
    s_add_u32 s63, s69, 286720
    buffer_load_dwordx4 v[236:239], v2, s[44:47], s63 offen nt
    s_memrealtime s[8:9]
    s_waitcnt vmcnt(14)
    s_waitcnt lgkmcnt(0)
    s_sub_u32 s8, s8, s30
    s_cmpk_ge_u32 s8, 1877
    s_cbranch_scc1 .ap_164
    s_waitcnt vmcnt(11)
    s_cmpk_ge_u32 s8, 1812
    s_cbranch_scc1 .ap_164
    s_waitcnt vmcnt(6)
    s_bitcmp1_b64 s[14:15], 52
    s_cbranch_scc0 1
    s_waitcnt vmcnt(5)
    s_cmpk_ge_u32 s8, 1737
    s_cbranch_scc1 .ap_164
    s_waitcnt vmcnt(1)
.ap_164:
    s_add_u32 s63, s69, 294912
    buffer_load_dwordx4 v[240:243], v2, s[44:47], s63 offen nt
    s_memrealtime s[8:9]
    s_waitcnt vmcnt(14)
    s_waitcnt lgkmcnt(0)
    s_sub_u32 s8, s8, s30
    s_cmpk_ge_u32 s8, 1908
    s_cbranch_scc1 .ap_165
    s_waitcnt vmcnt(11)
    s_cmpk_ge_u32 s8, 1843
    s_cbranch_scc1 .ap_165
    s_waitcnt vmcnt(6)
    s_bitcmp1_b64 s[14:15], 53
    s_cbranch_scc0 1
    s_waitcnt vmcnt(2)
    s_cmpk_ge_u32 s8, 1768
    s_cbranch_scc1 .ap_165
    s_waitcnt vmcnt(1)
.ap_165:
    s_add_u32 s63, s69, 303104
    buffer_load_dwordx4 v[244:247], v2, s[44:47], s63 offen nt
    s_load_dwordx2 s[88:89], s[6:7], s0
    buffer_load_dwordx4 v[24:27], v9, s[36:39], s59 offen offset:0 sc1
    s_memrealtime s[8:9]
    s_waitcnt vmcnt(14)
    s_waitcnt lgkmcnt(0)
    s_sub_u32 s8, s8, s30
    s_cmpk_ge_u32 s8, 1939
    s_cbranch_scc1 .ap_166
    s_waitcnt vmcnt(8)
    s_cmpk_ge_u32 s8, 1874
    s_cbranch_scc1 .ap_166
    s_waitcnt vmcnt(3)
    s_bitcmp1_b64 s[14:15], 54
    s_cbranch_scc0 1
    s_waitcnt vmcnt(2)
    s_cmpk_ge_u32 s8, 1799
    s_cbranch_scc1 .ap_166
    s_waitcnt vmcnt(1)
.ap_166:
    s_add_u32 s63, s69, 311296
    buffer_load_dwordx4 v[248:251], v2, s[44:47], s63 offen nt
    s_memrealtime s[8:9]
    s_waitcnt vmcnt(14)
    s_waitcnt lgkmcnt(0)
    s_sub_u32 s8, s8, s30
    s_cmpk_ge_u32 s8, 1970
    s_cbranch_scc1 .ap_167
    s_waitcnt vmcnt(5)
    s_cmpk_ge_u32 s8, 1905
    s_cbranch_scc1 .ap_167
    s_waitcnt vmcnt(3)
    s_bitcmp1_b64 s[14:15], 55
    s_cbranch_scc0 1
    s_waitcnt vmcnt(2)
    s_cmpk_ge_u32 s8, 1830
    s_cbranch_scc1 .ap_167
    s_waitcnt vmcnt(1)
.ap_167:
    s_add_u32 s63, s69, 319488
    buffer_load_dwordx4 v[252:255], v2, s[44:47], s63 offen nt
    s_memrealtime s[8:9]
    s_waitcnt vmcnt(11)
    s_waitcnt lgkmcnt(0)
    s_sub_u32 s8, s8, s30
    s_cmpk_ge_u32 s8, 2001
    s_cbranch_scc1 .ap_168
    s_waitcnt vmcnt(5)
    s_cmpk_ge_u32 s8, 1936
    s_cbranch_scc1 .ap_168
    s_waitcnt vmcnt(3)
    s_bitcmp1_b64 s[14:15], 56
    s_cbranch_scc0 1
    s_waitcnt vmcnt(2)
    s_cmpk_ge_u32 s8, 1861
    s_cbranch_scc1 .ap_168
    s_waitcnt vmcnt(1)
.ap_168:
    s_add_u32 s63, s69, 393216
    buffer_load_dwordx4 v[36:39], v2, s[44:47], s63 offen nt
    s_memrealtime s[8:9]
    s_waitcnt vmcnt(11)
    s_waitcnt lgkmcnt(0)
    s_sub_u32 s8, s8, s30
    s_cmpk_ge_u32 s8, 2032
    s_cbranch_scc1 .ap_169
    s_waitcnt vmcnt(5)
    s_cmpk_ge_u32 s8, 1967
    s_cbranch_scc1 .ap_169
    s_waitcnt vmcnt(3)
    s_bitcmp1_b64 s[14:15], 57
    s_cbranch_scc0 1
    s_waitcnt vmcnt(2)
    s_cmpk_ge_u32 s8, 1892
    s_cbranch_scc1 .ap_169
    s_waitcnt vmcnt(1)
.ap_169:
    s_add_u32 s63, s69, 401408
    buffer_load_dwordx4 v[44:47], v2, s[44:47], s63 offen nt
    s_memrealtime s[8:9]
    s_waitcnt vmcnt(8)
    s_waitcnt lgkmcnt(0)
    s_sub_u32 s8, s8, s30
    s_cmpk_ge_u32 s8, 2063
    s_cbranch_scc1 .ap_170
    s_waitcnt vmcnt(5)
    s_cmpk_ge_u32 s8, 1998
    s_cbranch_scc1 .ap_170
    s_waitcnt vmcnt(3)
    s_bitcmp1_b64 s[14:15], 58
    s_cbranch_scc0 1
    s_waitcnt vmcnt(2)
    s_cmpk_ge_u32 s8, 1923
    s_cbranch_scc1 .ap_170
    s_waitcnt vmcnt(1)
.ap_170:
    s_add_u32 s63, s69, 409600
    buffer_load_dwordx4 v[52:55], v2, s[44:47], s63 offen nt
    s_waitcnt vmcnt(5)
    s_branch .gpc_172
.gp_171:
    buffer_load_dwordx4 v[24:27], v9, s[36:39], s59 offen offset:0 sc1
    s_waitcnt vmcnt(0)
.gpc_172:
    v_cmp_eq_u32 vcc, s34, v26
    v_cmp_eq_u32 s[56:57], s34, v27
    s_and_b64 vcc, vcc, s[56:57]
    s_cmp_eq_u64 vcc, exec
    s_nop 2
    s_cbranch_scc1 .gpd_173
    s_sub_u32 s35, s35, 1
    s_cbranch_scc1 .Lexit
    s_sleep 1
    s_branch .gp_171
.gpd_173:
    s_lshr_b64 s[88:89], s[88:89], s1
    s_and_b32 s88, s88, 0xff
    s_cmp_eq_u32 s88, 32
    s_cselect_b32 s0, 0xac000, 0
    v_mov_b32 v16, v24
    s_nop 1
    v_max_f32_dpp v16, v16, v16 quad_perm:[2,3,0,1] row_mask:0xf bank_mask:0xf
    v_sub_f32 v17, v24, v16
    v_sub_f32 v18, v14, v16
    v_mul_f32 v17, 0x3fb8aa3b, v17
    v_mul_f32 v18, 0x3fb8aa3b, v18
    v_exp_f32 v17, v17
    v_exp_f32 v18, v18
    v_mul_f32 v17, v17, v25
    s_nop 1
    v_add_f32_dpp v17, v17, v17 quad_perm:[2,3,0,1] row_mask:0xf bank_mask:0xf
    v_rcp_f32 v19, v17
    s_nop 0
    v_fma_f32 v15, -v17, v19, 1.0
    v_fma_f32 v19, v15, v19, v19
    v_mul_f32 v18, v18, v19
    v_mul_f32 v10, v10, v18
    v_mul_f32 v11, v11, v18
    v_mul_f32 v12, v12, v18
    v_mul_f32 v13, v13, v18
    v_mov_b32_dpp v112, v10 quad_perm:[2,3,0,1] row_mask:0xf bank_mask:0xf
    v_mov_b32_dpp v113, v11 quad_perm:[2,3,0,1] row_mask:0xf bank_mask:0xf
    v_mov_b32_dpp v114, v12 quad_perm:[2,3,0,1] row_mask:0xf bank_mask:0xf
    v_mov_b32_dpp v115, v13 quad_perm:[2,3,0,1] row_mask:0xf bank_mask:0xf
    v_cvt_pk_bf16_f32 v96, v10, v112
    v_cvt_pk_bf16_f32 v100, v11, v113
    v_cvt_pk_bf16_f32 v104, v12, v114
    v_cvt_pk_bf16_f32 v108, v13, v115
    v_mov_b32_dpp v97, v96 row_ror:12 row_mask:0xf bank_mask:0xf
    v_mov_b32_dpp v101, v100 row_ror:12 row_mask:0xf bank_mask:0xf
    v_mov_b32_dpp v105, v104 row_ror:12 row_mask:0xf bank_mask:0xf
    v_mov_b32_dpp v109, v108 row_ror:12 row_mask:0xf bank_mask:0xf
    v_mov_b32_dpp v98, v96 row_ror:8 row_mask:0xf bank_mask:0xf
    v_mov_b32_dpp v102, v100 row_ror:8 row_mask:0xf bank_mask:0xf
    v_mov_b32_dpp v106, v104 row_ror:8 row_mask:0xf bank_mask:0xf
    v_mov_b32_dpp v110, v108 row_ror:8 row_mask:0xf bank_mask:0xf
    v_mov_b32_dpp v99, v96 row_ror:4 row_mask:0xf bank_mask:0xf
    v_mov_b32_dpp v103, v100 row_ror:4 row_mask:0xf bank_mask:0xf
    v_mov_b32_dpp v107, v104 row_ror:4 row_mask:0xf bank_mask:0xf
    v_mov_b32_dpp v111, v108 row_ror:4 row_mask:0xf bank_mask:0xf
    v_mov_b32_dpp v96, v96 row_shr:3 row_mask:0xf bank_mask:0x2
    v_mov_b32_dpp v97, v97 row_shr:3 row_mask:0xf bank_mask:0x2
    v_mov_b32_dpp v98, v98 row_shr:3 row_mask:0xf bank_mask:0x2
    v_mov_b32_dpp v99, v99 row_shr:3 row_mask:0xf bank_mask:0x2
    v_mov_b32_dpp v100, v100 row_shr:3 row_mask:0xf bank_mask:0x2
    v_mov_b32_dpp v101, v101 row_shr:3 row_mask:0xf bank_mask:0x2
    v_mov_b32_dpp v102, v102 row_shr:3 row_mask:0xf bank_mask:0x2
    v_mov_b32_dpp v103, v103 row_shr:3 row_mask:0xf bank_mask:0x2
    v_mov_b32_dpp v104, v104 row_shr:3 row_mask:0xf bank_mask:0x2
    v_mov_b32_dpp v105, v105 row_shr:3 row_mask:0xf bank_mask:0x2
    v_mov_b32_dpp v106, v106 row_shr:3 row_mask:0xf bank_mask:0x2
    v_mov_b32_dpp v107, v107 row_shr:3 row_mask:0xf bank_mask:0x2
    v_mov_b32_dpp v108, v108 row_shr:3 row_mask:0xf bank_mask:0x2
    v_mov_b32_dpp v109, v109 row_shr:3 row_mask:0xf bank_mask:0x2
    v_mov_b32_dpp v110, v110 row_shr:3 row_mask:0xf bank_mask:0x2
    v_mov_b32_dpp v111, v111 row_shr:3 row_mask:0xf bank_mask:0x2
    s_memrealtime s[8:9]
    s_waitcnt lgkmcnt(0)
    s_sub_u32 s8, s8, s30
    s_cmpk_ge_u32 s8, 2094
    s_cbranch_scc1 .ap_174
    s_waitcnt vmcnt(5)
    s_cmpk_ge_u32 s8, 2029
    s_cbranch_scc1 .ap_174
    s_waitcnt vmcnt(3)
    s_bitcmp1_b64 s[14:15], 59
    s_cbranch_scc0 1
    s_waitcnt vmcnt(2)
    s_cmpk_ge_u32 s8, 1954
    s_cbranch_scc1 .ap_174
    s_waitcnt vmcnt(1)
.ap_174:
    s_add_u32 s63, s69, 417792
    buffer_load_dwordx4 v[60:63], v2, s[44:47], s63 offen nt
    s_lshl_b32 s60, s3, 10
    s_add_u32 s60, s60, 132096
    v_lshlrev_b32 v10, 5, v0
    v_add_u32 v10, s60, v10
    v_lshrrev_b32 v11, 5, v0
    v_lshlrev_b32 v11, 13, v11
    v_and_b32 v12, 31, v0
    v_lshl_add_u32 v11, v12, 4, v11
    v_add_u32 v9, 132096, v2
    v_mov_b32 v15, s34
    v_mov_b32 v13, 110592
    s_mov_b32 s1, s43
    v_bfe_u32 v16, v0, 1, 3
    v_mul_u32_u24 v16, 1312, v16
    v_lshrrev_b32 v7, 4, v0
    v_lshl_add_u32 v16, v7, 5, v16
    v_and_b32 v7, 1, v0
    v_lshl_add_u32 v16, v7, 4, v16
    v_add_u32 v16, 147456, v16
    s_mul_i32 s56, s3, 1312
    s_add_u32 s56, s56, 147456
    v_add_u32 v17, s56, v3
    v_add_u32 v18, s56, v4
    v_lshrrev_b32 v7, 4, v0
    v_bfe_u32 v8, v0, 1, 1
    v_lshl_add_u32 v7, v7, 1, v8
    v_bfe_u32 v8, v0, 2, 2
    v_lshl_add_u32 v19, v7, 3, v8
    v_lshlrev_b32 v19, 7, v19
    v_and_b32 v7, 3, v7
    v_lshrrev_b32 v8, 1, v8
    v_lshl_add_u32 v7, v7, 1, v8
    v_xor_b32 v7, s3, v7
    v_lshl_add_u32 v19, v7, 4, v19
    v_and_b32 v7, 1, v0
    v_lshl_add_u32 v19, v7, 3, v19
    v_add_u32 v20, 32768, v19
    v_lshrrev_b32 v7, 4, v0
    v_bfe_u32 v8, v0, 2, 2
    v_lshl_add_u32 v21, v7, 3, v8
    v_lshlrev_b32 v21, 7, v21
    v_and_b32 v7, 1, v7
    v_lshrrev_b32 v8, 1, v8
    v_lshl_add_u32 v7, v7, 1, v8
    s_and_b32 s56, s3, 1
    s_lshl_b32 s56, s56, 1
    v_xor_b32 v7, s56, v7
    v_and_b32 v8, 3, v0
    v_lshl_add_u32 v21, v8, 3, v21
    s_lshr_b32 s56, s3, 1
    s_mul_i32 s56, s56, 12288
    s_add_u32 s56, s56, 73728
    v_add_u32 v21, s56, v21
    v_xor_b32 v8, 1, v7
    v_lshl_add_u32 v22, v8, 5, v21
    v_lshl_add_u32 v21, v7, 5, v21
    v_bfe_u32 v7, v0, 1, 3
    v_mul_u32_u24 v23, 1312, v7
    v_mul_u32_u24 v24, 272, v7
    v_and_b32 v7, 48, v0
    s_lshr_b32 s56, s3, 1
    s_mul_i32 s57, s56, 192
    s_add_u32 s57, s57, 110592
    v_add3_u32 v23, v23, v7, s57
    s_mul_i32 s56, s56, 2176
    s_and_b32 s57, s3, 1
    s_lshl_b32 s57, s57, 7
    s_add_u32 s56, s56, s57
    s_add_u32 s56, s56, 122880
    v_add3_u32 v24, v24, v7, s56
    v_and_b32 v7, 1, v0
    v_lshl_add_u32 v24, v7, 6, v24
    v_and_b32 v7, 15, v0
    s_mul_i32 s56, s3, 272
    s_add_u32 s56, s56, 122880
    v_lshl_add_u32 v25, v7, 4, s56
    v_bfe_u32 v26, v0, 1, 4
    v_lshlrev_b32 v26, 4, v26
    s_mul_i32 s56, s3, 72
    v_add_u32 v7, s56, v0
    v_lshrrev_b32 v8, 4, v7
    v_lshlrev_b32 v27, 9, v8
    v_and_b32 v29, 15, v7
    v_lshl_add_u32 v27, v29, 4, v27
    v_and_b32 v29, 7, v7
    v_mul_u32_u24 v29, 1312, v29
    v_and_b32 v7, -8, v7
    v_add3_u32 v29, v29, v7, v13
    v_and_b32 v7, 7, v0
    v_add3_u32 v7, v7, s56, 64
    v_lshrrev_b32 v8, 4, v7
    v_lshlrev_b32 v28, 9, v8
    v_and_b32 v30, 15, v7
    v_lshl_add_u32 v28, v30, 4, v28
    v_and_b32 v30, 7, v7
    v_mul_u32_u24 v30, 1312, v30
    v_and_b32 v7, -8, v7
    v_add3_u32 v30, v30, v7, v13
    s_memrealtime s[8:9]
    s_waitcnt lgkmcnt(0)
    s_sub_u32 s8, s8, s30
    s_cmpk_ge_u32 s8, 2125
    s_cbranch_scc1 .ap_175
    s_waitcnt vmcnt(5)
    s_cmpk_ge_u32 s8, 2060
    s_cbranch_scc1 .ap_175
    s_waitcnt vmcnt(3)
    s_bitcmp1_b64 s[14:15], 60
    s_cbranch_scc0 1
    s_waitcnt vmcnt(2)
    s_cmpk_ge_u32 s8, 1985
    s_cbranch_scc1 .ap_175
    s_waitcnt vmcnt(1)
.ap_175:
    s_add_u32 s63, s69, 425984
    buffer_load_dwordx4 v[68:71], v2, s[44:47], s63 offen nt
    v_perm_b32 v112, v164, v160, s94
    v_perm_b32 v113, v172, v168, s94
    v_perm_b32 v114, v180, v176, s94
    v_perm_b32 v115, v188, v184, s94
    s_nop 1
    v_mfma_f32_16x16x32_bf16 v[128:131], v[96:99], v[112:115], 0
    v_perm_b32 v116, v164, v160, s95
    v_perm_b32 v117, v172, v168, s95
    v_perm_b32 v118, v180, v176, s95
    v_perm_b32 v119, v188, v184, s95
    s_nop 1
    v_mfma_f32_16x16x32_bf16 v[132:135], v[96:99], v[116:119], 0
    v_perm_b32 v120, v165, v161, s94
    v_perm_b32 v121, v173, v169, s94
    v_perm_b32 v122, v181, v177, s94
    v_perm_b32 v123, v189, v185, s94
    s_nop 1
    v_mfma_f32_16x16x32_bf16 v[136:139], v[96:99], v[120:123], 0
    v_perm_b32 v124, v165, v161, s95
    v_perm_b32 v125, v173, v169, s95
    v_perm_b32 v126, v181, v177, s95
    v_perm_b32 v127, v189, v185, s95
    s_nop 1
    v_mfma_f32_16x16x32_bf16 v[140:143], v[96:99], v[124:127], 0
    v_perm_b32 v112, v166, v162, s94
    v_perm_b32 v113, v174, v170, s94
    v_perm_b32 v114, v182, v178, s94
    v_perm_b32 v115, v190, v186, s94
    s_nop 1
    v_mfma_f32_16x16x32_bf16 v[144:147], v[96:99], v[112:115], 0
    v_perm_b32 v116, v166, v162, s95
    v_perm_b32 v117, v174, v170, s95
    v_perm_b32 v118, v182, v178, s95
    v_perm_b32 v119, v190, v186, s95
    s_nop 1
    v_mfma_f32_16x16x32_bf16 v[148:151], v[96:99], v[116:119], 0
    v_perm_b32 v120, v167, v163, s94
    v_perm_b32 v121, v175, v171, s94
    v_perm_b32 v122, v183, v179, s94
    v_perm_b32 v123, v191, v187, s94
    s_nop 1
    v_mfma_f32_16x16x32_bf16 v[152:155], v[96:99], v[120:123], 0
    v_perm_b32 v124, v167, v163, s95
    v_perm_b32 v125, v175, v171, s95
    v_perm_b32 v126, v183, v179, s95
    v_perm_b32 v127, v191, v187, s95
    s_nop 1
    v_mfma_f32_16x16x32_bf16 v[156:159], v[96:99], v[124:127], 0
    s_memrealtime s[8:9]
    s_waitcnt lgkmcnt(0)
    s_sub_u32 s8, s8, s30
    s_cmpk_ge_u32 s8, 2156
    s_nop 3
    s_cbranch_scc1 .ap_176
    s_waitcnt vmcnt(5)
    s_cmpk_ge_u32 s8, 2091
    s_cbranch_scc1 .ap_176
    s_waitcnt vmcnt(3)
    s_bitcmp1_b64 s[14:15], 61
    s_cbranch_scc0 1
    s_waitcnt vmcnt(2)
    s_cmpk_ge_u32 s8, 2016
    s_cbranch_scc1 .ap_176
    s_waitcnt vmcnt(1)
.ap_176:
    s_add_u32 s63, s69, 434176
    buffer_load_dwordx4 v[76:79], v2, s[44:47], s63 offen nt
    v_perm_b32 v112, v196, v192, s94
    v_perm_b32 v113, v204, v200, s94
    v_perm_b32 v114, v212, v208, s94
    v_perm_b32 v115, v220, v216, s94
    s_nop 1
    v_mfma_f32_16x16x32_bf16 v[128:131], v[100:103], v[112:115], v[128:131]
    v_perm_b32 v116, v196, v192, s95
    v_perm_b32 v117, v204, v200, s95
    v_perm_b32 v118, v212, v208, s95
    v_perm_b32 v119, v220, v216, s95
    s_nop 1
    v_mfma_f32_16x16x32_bf16 v[132:135], v[100:103], v[116:119], v[132:135]
    v_perm_b32 v120, v197, v193, s94
    v_perm_b32 v121, v205, v201, s94
    v_perm_b32 v122, v213, v209, s94
    v_perm_b32 v123, v221, v217, s94
    s_nop 1
    v_mfma_f32_16x16x32_bf16 v[136:139], v[100:103], v[120:123], v[136:139]
    v_perm_b32 v124, v197, v193, s95
    v_perm_b32 v125, v205, v201, s95
    v_perm_b32 v126, v213, v209, s95
    v_perm_b32 v127, v221, v217, s95
    s_nop 1
    v_mfma_f32_16x16x32_bf16 v[140:143], v[100:103], v[124:127], v[140:143]
    v_perm_b32 v112, v198, v194, s94
    v_perm_b32 v113, v206, v202, s94
    v_perm_b32 v114, v214, v210, s94
    v_perm_b32 v115, v222, v218, s94
    s_nop 1
    v_mfma_f32_16x16x32_bf16 v[144:147], v[100:103], v[112:115], v[144:147]
    v_perm_b32 v116, v198, v194, s95
    v_perm_b32 v117, v206, v202, s95
    v_perm_b32 v118, v214, v210, s95
    v_perm_b32 v119, v222, v218, s95
    s_nop 1
    v_mfma_f32_16x16x32_bf16 v[148:151], v[100:103], v[116:119], v[148:151]
    v_perm_b32 v120, v199, v195, s94
    v_perm_b32 v121, v207, v203, s94
    v_perm_b32 v122, v215, v211, s94
    v_perm_b32 v123, v223, v219, s94
    s_nop 1
    v_mfma_f32_16x16x32_bf16 v[152:155], v[100:103], v[120:123], v[152:155]
    v_perm_b32 v124, v199, v195, s95
    v_perm_b32 v125, v207, v203, s95
    v_perm_b32 v126, v215, v211, s95
    v_perm_b32 v127, v223, v219, s95
    s_nop 1
    v_mfma_f32_16x16x32_bf16 v[156:159], v[100:103], v[124:127], v[156:159]
    s_memrealtime s[8:9]
    s_waitcnt lgkmcnt(0)
    s_sub_u32 s8, s8, s30
    s_cmpk_ge_u32 s8, 2187
    s_nop 3
    s_cbranch_scc1 .ap_177
    s_waitcnt vmcnt(5)
    s_cmpk_ge_u32 s8, 2122
    s_cbranch_scc1 .ap_177
    s_waitcnt vmcnt(3)
    s_bitcmp1_b64 s[14:15], 62
    s_cbranch_scc0 1
    s_waitcnt vmcnt(2)
    s_cmpk_ge_u32 s8, 2047
    s_cbranch_scc1 .ap_177
    s_waitcnt vmcnt(1)
.ap_177:
    s_add_u32 s63, s69, 442368
    buffer_load_dwordx4 v[84:87], v2, s[44:47], s63 offen nt
    s_waitcnt vmcnt(7)
    v_perm_b32 v112, v228, v224, s94
    v_perm_b32 v113, v236, v232, s94
    v_perm_b32 v114, v244, v240, s94
    v_perm_b32 v115, v252, v248, s94
    s_nop 1
    v_mfma_f32_16x16x32_bf16 v[128:131], v[104:107], v[112:115], v[128:131]
    v_perm_b32 v116, v228, v224, s95
    v_perm_b32 v117, v236, v232, s95
    v_perm_b32 v118, v244, v240, s95
    v_perm_b32 v119, v252, v248, s95
    s_nop 1
    v_mfma_f32_16x16x32_bf16 v[132:135], v[104:107], v[116:119], v[132:135]
    v_perm_b32 v120, v229, v225, s94
    v_perm_b32 v121, v237, v233, s94
    v_perm_b32 v122, v245, v241, s94
    v_perm_b32 v123, v253, v249, s94
    s_nop 1
    v_mfma_f32_16x16x32_bf16 v[136:139], v[104:107], v[120:123], v[136:139]
    v_perm_b32 v124, v229, v225, s95
    v_perm_b32 v125, v237, v233, s95
    v_perm_b32 v126, v245, v241, s95
    v_perm_b32 v127, v253, v249, s95
    s_nop 1
    v_mfma_f32_16x16x32_bf16 v[140:143], v[104:107], v[124:127], v[140:143]
    v_perm_b32 v112, v230, v226, s94
    v_perm_b32 v113, v238, v234, s94
    v_perm_b32 v114, v246, v242, s94
    v_perm_b32 v115, v254, v250, s94
    s_nop 1
    v_mfma_f32_16x16x32_bf16 v[144:147], v[104:107], v[112:115], v[144:147]
    v_perm_b32 v116, v230, v226, s95
    v_perm_b32 v117, v238, v234, s95
    v_perm_b32 v118, v246, v242, s95
    v_perm_b32 v119, v254, v250, s95
    s_nop 1
    v_mfma_f32_16x16x32_bf16 v[148:151], v[104:107], v[116:119], v[148:151]
    v_perm_b32 v120, v231, v227, s94
    v_perm_b32 v121, v239, v235, s94
    v_perm_b32 v122, v247, v243, s94
    v_perm_b32 v123, v255, v251, s94
    s_nop 1
    v_mfma_f32_16x16x32_bf16 v[152:155], v[104:107], v[120:123], v[152:155]
    v_perm_b32 v124, v231, v227, s95
    v_perm_b32 v125, v239, v235, s95
    v_perm_b32 v126, v247, v243, s95
    v_perm_b32 v127, v255, v251, s95
    s_nop 1
    v_mfma_f32_16x16x32_bf16 v[156:159], v[104:107], v[124:127], v[156:159]
    s_memrealtime s[8:9]
    s_waitcnt lgkmcnt(0)
    s_sub_u32 s8, s8, s30
    s_cmpk_ge_u32 s8, 2218
    s_nop 3
    s_cbranch_scc1 .ap_178
    s_waitcnt vmcnt(5)
    s_cmpk_ge_u32 s8, 2153
    s_cbranch_scc1 .ap_178
    s_waitcnt vmcnt(3)
    s_bitcmp1_b64 s[14:15], 63
    s_cbranch_scc0 1
    s_waitcnt vmcnt(2)
    s_cmpk_ge_u32 s8, 2078
    s_cbranch_scc1 .ap_178
    s_waitcnt vmcnt(1)
.ap_178:
    s_add_u32 s63, s69, 450560
    buffer_load_dwordx4 v[92:95], v2, s[44:47], s63 offen nt
    s_setprio 0
    s_waitcnt vmcnt(6)
    v_perm_b32 v160, v44, v36, s94
    v_perm_b32 v164, v44, v36, s95
    v_perm_b32 v168, v45, v37, s94
    v_perm_b32 v172, v45, v37, s95
    v_perm_b32 v176, v46, v38, s94
    v_perm_b32 v180, v46, v38, s95
    v_perm_b32 v184, v47, v39, s94
    v_perm_b32 v188, v47, v39, s95
    s_waitcnt vmcnt(4)
    v_perm_b32 v161, v60, v52, s94
    v_perm_b32 v165, v60, v52, s95
    v_perm_b32 v169, v61, v53, s94
    v_perm_b32 v173, v61, v53, s95
    v_perm_b32 v177, v62, v54, s94
    v_perm_b32 v181, v62, v54, s95
    v_perm_b32 v185, v63, v55, s94
    v_perm_b32 v189, v63, v55, s95
    v_mfma_f32_16x16x16_bf16 v[128:131], v[108:109], v[160:161], v[128:131]
    v_mfma_f32_16x16x16_bf16 v[132:135], v[108:109], v[164:165], v[132:135]
    v_mfma_f32_16x16x16_bf16 v[136:139], v[108:109], v[168:169], v[136:139]
    v_mfma_f32_16x16x16_bf16 v[140:143], v[108:109], v[172:173], v[140:143]
    v_mfma_f32_16x16x16_bf16 v[144:147], v[108:109], v[176:177], v[144:147]
    v_mfma_f32_16x16x16_bf16 v[148:151], v[108:109], v[180:181], v[148:151]
    v_mfma_f32_16x16x16_bf16 v[152:155], v[108:109], v[184:185], v[152:155]
    v_mfma_f32_16x16x16_bf16 v[156:159], v[108:109], v[188:189], v[156:159]
    s_waitcnt vmcnt(2)
    v_perm_b32 v162, v76, v68, s94
    v_perm_b32 v166, v76, v68, s95
    v_perm_b32 v170, v77, v69, s94
    v_perm_b32 v174, v77, v69, s95
    v_perm_b32 v178, v78, v70, s94
    v_perm_b32 v182, v78, v70, s95
    v_perm_b32 v186, v79, v71, s94
    v_perm_b32 v190, v79, v71, s95
    s_lshl4_add_u32 s59, s67, s66
    s_lshl1_add_u32 s59, s59, s68
    s_lshl_b32 s59, s59, 9
    s_add_u32 s59, s59, 0x210000
    s_mov_b32 s60, 0x07060503
    s_mov_b32 s61, 0x07060502
    s_mov_b32 s62, 0x07060501
.Ltail_bc:
    s_waitcnt vmcnt(0)
    v_perm_b32 v163, v92, v84, s94
    v_perm_b32 v167, v92, v84, s95
    v_perm_b32 v171, v93, v85, s94
    v_perm_b32 v175, v93, v85, s95
    v_perm_b32 v179, v94, v86, s94
    v_perm_b32 v183, v94, v86, s95
    v_perm_b32 v187, v95, v87, s94
    v_perm_b32 v191, v95, v87, s95
    v_mfma_f32_16x16x16_bf16 v[128:131], v[110:111], v[162:163], v[128:131]
    v_mfma_f32_16x16x16_bf16 v[132:135], v[110:111], v[166:167], v[132:135]
    v_mfma_f32_16x16x16_bf16 v[136:139], v[110:111], v[170:171], v[136:139]
    v_mfma_f32_16x16x16_bf16 v[140:143], v[110:111], v[174:175], v[140:143]
    v_mfma_f32_16x16x16_bf16 v[144:147], v[110:111], v[178:179], v[144:147]
    v_mfma_f32_16x16x16_bf16 v[148:151], v[110:111], v[182:183], v[148:151]
    v_mfma_f32_16x16x16_bf16 v[152:155], v[110:111], v[186:187], v[152:155]
    v_mfma_f32_16x16x16_bf16 v[156:159], v[110:111], v[190:191], v[156:159]
    s_nop 1
    s_mov_b64 exec, 0xffffffff
    ds_write2_b32 v10, v128, v132 offset0:0 offset1:1
    ds_write2_b32 v10, v136, v140 offset0:2 offset1:3
    s_nop 0
    ds_write2_b32 v10, v144, v148 offset0:4 offset1:5
    s_nop 0
    ds_write2_b32 v10, v152, v156 offset0:6 offset1:7
    s_mov_b64 exec, -1
    s_lshl_b32 s32, s3, 10
    s_add_u32 m0, s32, 73728
    s_add_u32 s56, s33, 0
    buffer_load_dwordx4 v31, s[52:55], s56 offen nt lds
    s_add_u32 m0, s32, 81920
    s_add_u32 s56, s33, 73728
    buffer_load_dwordx4 v31, s[52:55], s56 offen nt lds
    s_add_u32 m0, s32, 90112
    s_add_u32 s56, s33, 147456
    buffer_load_dwordx4 v31, s[52:55], s56 offen nt lds
    s_add_u32 m0, s32, 98304
    s_add_u32 s56, s33, 221184
    buffer_load_dwordx4 v31, s[52:55], s56 offen nt lds
    s_waitcnt lgkmcnt(0)
    s_barrier
    s_cmp_lg_u32 s3, 7
    s_cbranch_scc1 .opub_179
    ds_read_b128 v[196:199], v9 offset:0
    ds_read_b128 v[200:203], v9 offset:1024
    ds_read_b128 v[204:207], v9 offset:2048
    ds_read_b128 v[208:211], v9 offset:3072
    ds_read_b128 v[212:215], v9 offset:4096
    ds_read_b128 v[216:219], v9 offset:5120
    ds_read_b128 v[220:223], v9 offset:6144
    ds_read_b128 v[224:227], v9 offset:7168
    s_waitcnt lgkmcnt(6)
    v_pk_add_f32 v[196:197], v[196:197], v[200:201]
    v_pk_add_f32 v[198:199], v[198:199], v[202:203]
    s_waitcnt lgkmcnt(4)
    v_pk_add_f32 v[204:205], v[204:205], v[208:209]
    v_pk_add_f32 v[206:207], v[206:207], v[210:211]
    v_pk_add_f32 v[196:197], v[196:197], v[204:205]
    v_pk_add_f32 v[198:199], v[198:199], v[206:207]
    s_waitcnt lgkmcnt(2)
    v_pk_add_f32 v[212:213], v[212:213], v[216:217]
    v_pk_add_f32 v[214:215], v[214:215], v[218:219]
    s_waitcnt lgkmcnt(0)
    v_pk_add_f32 v[220:221], v[220:221], v[224:225]
    v_pk_add_f32 v[222:223], v[222:223], v[226:227]
    v_pk_add_f32 v[212:213], v[212:213], v[220:221]
    v_pk_add_f32 v[214:215], v[214:215], v[222:223]
    v_pk_add_f32 v[196:197], v[196:197], v[212:213]
    v_pk_add_f32 v[198:199], v[198:199], v[214:215]
    v_perm_b32 v12, v196, v199, s60
    v_perm_b32 v13, v197, v199, s61
    v_perm_b32 v14, v198, v199, s62
    s_add_u32 s57, s59, 0xac000
    buffer_store_dwordx4 v[12:15], v11, s[36:39], s57 offen
    buffer_store_dwordx4 v[12:15], v11, s[36:39], s59 offen sc1
.opub_179:
    s_barrier
    s_bitcmp1_b32 s1, 0
    s_cbranch_scc1 .lt_180
    s_lshl_b32 s32, s3, 10
    s_add_u32 m0, s32, 0
    s_add_u32 s56, s101, 0
    buffer_load_dwordx4 v6, s[48:51], s56 offen nt lds
    s_add_u32 m0, s32, 8192
    s_add_u32 s56, s101, 589824
    buffer_load_dwordx4 v6, s[48:51], s56 offen nt lds
    s_add_u32 m0, s32, 16384
    s_add_u32 s56, s101, 1179648
    buffer_load_dwordx4 v6, s[48:51], s56 offen nt lds
    s_add_u32 m0, s32, 24576
    s_add_u32 s56, s101, 1769472
    buffer_load_dwordx4 v6, s[48:51], s56 offen nt lds
    s_add_u32 m0, s32, 32768
    s_add_u32 s56, s101, 2359296
    buffer_load_dwordx4 v6, s[48:51], s56 offen nt lds
.lt_180:
    s_lshl_b32 s32, s3, 10
    s_add_u32 m0, s32, 40960
    s_add_u32 s56, s101, 2949120
    buffer_load_dwordx4 v6, s[48:51], s56 offen nt lds
    s_add_u32 m0, s32, 49152
    s_add_u32 s56, s101, 3538944
    buffer_load_dwordx4 v6, s[48:51], s56 offen nt lds
    s_add_u32 m0, s32, 57344
    s_add_u32 s56, s101, 4128768
    buffer_load_dwordx4 v6, s[48:51], s56 offen nt lds
    s_add_u32 m0, s32, 65536
    s_add_u32 s56, s101, 4718592
    buffer_load_dwordx4 v6, s[48:51], s56 offen nt lds
    s_lshl_b32 s32, s3, 10
    s_cmp_ge_u32 s3, 4
    s_cbranch_scc1 .nod_181
    s_add_u32 m0, s32, 106496
    s_add_u32 s56, s33, 294912
    buffer_load_dwordx4 v31, s[52:55], s56 offen nt lds
.nod_181:
    s_branch .gpc_183
.gp_182:
    buffer_load_dwordx4 v[32:35], v2, s[36:39], s99 offen offset:0 sc1
    buffer_load_dwordx4 v[40:43], v2, s[36:39], s99 offen offset:1024 sc1
    buffer_load_dwordx2 v[48:49], v5, s[36:39], s99 offen offset:0 sc1
    buffer_load_dwordx4 v[56:59], v2, s[36:39], s100 offen offset:0 sc1
    buffer_load_dwordx4 v[64:67], v2, s[36:39], s100 offen offset:1024 sc1
    buffer_load_dwordx2 v[50:51], v5, s[36:39], s100 offen offset:0 sc1
    s_waitcnt vmcnt(0)
.gpc_183:
    v_min_u32 v7, v33, v35
    v_max_u32 v8, v33, v35
    v_min3_u32 v7, v7, v41, v43
    v_max3_u32 v8, v8, v41, v43
    v_min3_u32 v7, v7, v49, v57
    v_max3_u32 v8, v8, v49, v57
    v_min3_u32 v7, v7, v59, v65
    v_max3_u32 v8, v8, v59, v65
    v_min3_u32 v7, v7, v67, v51
    v_max3_u32 v8, v8, v67, v51
    v_cmp_eq_u32 vcc, s34, v7
    v_cmp_eq_u32 s[56:57], s34, v8
    s_and_b64 vcc, vcc, s[56:57]
    s_cmp_eq_u64 vcc, exec
    s_nop 2
    s_cbranch_scc1 .gpd_184
    s_sub_u32 s35, s35, 1
    s_cbranch_scc1 .Lexit
    s_sleep 2
    s_branch .gp_182
.gpd_184:
    v_lshlrev_b32 v230, 16, v32
    v_and_b32 v231, 0xffff0000, v32
    v_lshlrev_b32 v240, 16, v56
    v_and_b32 v241, 0xffff0000, v56
    v_lshlrev_b32 v232, 16, v34
    v_and_b32 v233, 0xffff0000, v34
    v_lshlrev_b32 v242, 16, v58
    v_and_b32 v243, 0xffff0000, v58
    v_lshlrev_b32 v234, 16, v40
    v_and_b32 v235, 0xffff0000, v40
    v_lshlrev_b32 v244, 16, v64
    v_and_b32 v245, 0xffff0000, v64
    v_lshlrev_b32 v236, 16, v42
    v_and_b32 v237, 0xffff0000, v42
    v_lshlrev_b32 v246, 16, v66
    v_and_b32 v247, 0xffff0000, v66
    v_lshlrev_b32 v238, 16, v48
    v_and_b32 v239, 0xffff0000, v48
    v_lshlrev_b32 v248, 16, v50
    v_and_b32 v249, 0xffff0000, v50
    s_sub_u32 s63, s65, 9
    s_mul_i32 s42, s64, 18432
    s_mul_i32 s56, s3, 2304
    s_add_u32 s42, s42, s56
    s_add_u32 s42, s42, 0x250000
    s_mul_i32 s41, s64, 36864
    s_add_u32 s41, s41, 0x274000
    s_lshr_b32 s57, s63, 1
    s_lshl3_add_u32 s40, s57, s3
    s_and_b32 s63, s63, 1
    s_lshl1_add_u32 s40, s40, s63
    s_lshl_b32 s40, s40, 8
    s_add_u32 s40, s40, s41
    s_mul_i32 s56, s63, 18432
    s_add_u32 s41, s41, s56
    s_mul_i32 s43, s3, 9
    s_add_u32 s43, s43, s57
    s_lshl3_add_u32 s43, s43, s64
    s_lshl1_add_u32 s43, s43, s63
    s_lshl_b32 s43, s43, 8
    s_add_u32 s43, s43, 0x38c000
    v_mov_b32 v137, s34
    v_mov_b32 v139, s34
    v_mov_b32 v143, s34
    s_add_u32 s57, s40, 0xac000
    s_mov_b64 exec, 0xffff
    buffer_load_dwordx4 v[80:83], v2, s[36:39], s57 offen offset:0 sc1
    s_mov_b64 exec, -1
    s_waitcnt vmcnt(0)
    s_barrier
    ds_read_b64_tr_b16 v[160:161], v19 offset:0
    ds_read_b64_tr_b16 v[162:163], v19 offset:512
    ds_read_b64_tr_b16 v[164:165], v19 offset:8192
    ds_read_b64_tr_b16 v[166:167], v19 offset:8704
    ds_read_b64_tr_b16 v[168:169], v19 offset:16384
    ds_read_b64_tr_b16 v[170:171], v19 offset:16896
    ds_read_b64_tr_b16 v[172:173], v19 offset:24576
    ds_read_b64_tr_b16 v[174:175], v19 offset:25088
    ds_read_b64_tr_b16 v[176:177], v20 offset:0
    ds_read_b64_tr_b16 v[178:179], v20 offset:512
    ds_read_b64_tr_b16 v[180:181], v20 offset:8192
    ds_read_b64_tr_b16 v[182:183], v20 offset:8704
    ds_read_b64_tr_b16 v[184:185], v20 offset:16384
    ds_read_b64_tr_b16 v[186:187], v20 offset:16896
    ds_read_b64_tr_b16 v[188:189], v20 offset:24576
    ds_read_b64_tr_b16 v[190:191], v20 offset:25088
    ds_read_b64_tr_b16 v[192:193], v20 offset:32768
    ds_read_b64_tr_b16 v[194:195], v20 offset:33280
.Lbc_x:
    s_add_u32 s58, s42, s0
    s_lshl1_add_u32 s42, s42, 0xac000
    s_cmp_eq_u32 s0, 0
    s_cselect_b32 s32, 64, 0
    s_mov_b64 s[88:89], exec
    s_mov_b64 s[90:91], exec
    s_mov_b64 s[92:93], exec
.mp_185:
    s_or_b64 exec, s[88:89], 1
    buffer_load_dwordx4 v[144:147], v2, s[36:39], s58 offen offset:0 sc1
    s_or_b64 exec, s[90:91], 1
    buffer_load_dwordx4 v[148:151], v2, s[36:39], s58 offen offset:1024 sc1
    s_or_b64 exec, s[92:93], 1
    buffer_load_dwordx2 v[152:153], v5, s[36:39], s58 offen offset:0 sc1
    s_mov_b64 exec, -1
    s_sub_u32 s35, s35, 1
    s_cbranch_scc1 .Lexit
    s_sub_u32 vcc_lo, s42, s58
    s_add_u32 s32, s32, 1
    s_cmp_ge_u32 s32, 64
    s_cselect_b32 s58, vcc_lo, s58
    s_waitcnt vmcnt(0)
.mpj_186:
    v_cmp_ne_u32 s[88:89], s34, v145
    v_cmp_ne_u32 vcc, s34, v147
    s_or_b64 s[88:89], s[88:89], vcc
    v_cmp_ne_u32 s[90:91], s34, v149
    v_cmp_ne_u32 vcc, s34, v151
    s_or_b64 s[90:91], s[90:91], vcc
    v_cmp_ne_u32 s[92:93], s34, v153
    s_or_b64 vcc, s[88:89], s[90:91]
    s_or_b64 vcc, vcc, s[92:93]
    s_cbranch_scc1 .mp_185
    s_mov_b32 s56, 0x3f803f80
    v_dot2_f32_bf16 v250, v144, s56, 0
    v_dot2_f32_bf16 v251, v144, v144, 0
    v_dot2_f32_bf16 v250, v146, s56, v250
    v_dot2_f32_bf16 v251, v146, v146, v251
    v_dot2_f32_bf16 v250, v148, s56, v250
    v_dot2_f32_bf16 v251, v148, v148, v251
    v_dot2_f32_bf16 v250, v150, s56, v250
    v_dot2_f32_bf16 v251, v150, v150, v251
    s_mov_b64 exec, 0xffffffff
    v_dot2_f32_bf16 v250, v152, s56, v250
    v_dot2_f32_bf16 v251, v152, v152, v251
    s_mov_b64 exec, -1
    s_nop 1
    v_permlane32_swap_b32 v250, v251
    v_add_f32 v250, v250, v251
    v_mov_b32 v252, v250
    s_nop 1
    v_permlane16_swap_b32 v252, v250
    v_add_f32 v250, v252, v250
    v_lshlrev_b32 v220, 16, v144
    v_and_b32 v221, 0xffff0000, v144
    v_add_f32_dpp v250, v250, v250 row_ror:8 row_mask:0xf bank_mask:0xf
    v_lshlrev_b32 v222, 16, v146
    v_and_b32 v223, 0xffff0000, v146
    v_add_f32_dpp v250, v250, v250 row_ror:4 row_mask:0xf bank_mask:0xf
    v_lshlrev_b32 v224, 16, v148
    v_and_b32 v225, 0xffff0000, v148
    v_add_f32_dpp v250, v250, v250 quad_perm:[2,3,0,1] row_mask:0xf bank_mask:0xf
    v_lshlrev_b32 v226, 16, v150
    v_and_b32 v227, 0xffff0000, v150
    v_add_f32_dpp v250, v250, v250 quad_perm:[1,0,3,2] row_mask:0xf bank_mask:0xf
    v_mul_f32 v250, 0x3ae38e39, v250
    v_lshlrev_b32 v228, 16, v152
    v_and_b32 v229, 0xffff0000, v152
    v_readlane_b32 s56, v250, 0
    v_readlane_b32 s57, v250, 32
    s_nop 0
    v_mov_b32 v250, s56
    v_fma_f32 v251, -v250, v250, s57
    v_max_f32 v251, 0, v251
    v_add_f32 v251, 0x3727c5ac, v251
    v_rsq_f32 v252, v251
    s_nop 0
    v_mul_f32 v251, -v250, v252
    v_mul_f32 v250, -v250, v252
    v_mov_b32 v253, v252
    v_pk_fma_f32 v[220:221], v[220:221], v[252:253], v[250:251]
    v_pk_fma_f32 v[222:223], v[222:223], v[252:253], v[250:251]
    v_pk_fma_f32 v[224:225], v[224:225], v[252:253], v[250:251]
    v_pk_fma_f32 v[226:227], v[226:227], v[252:253], v[250:251]
    v_pk_fma_f32 v[228:229], v[228:229], v[252:253], v[250:251]
    v_pk_fma_f32 v[220:221], v[220:221], v[240:241], v[230:231]
    v_pk_fma_f32 v[222:223], v[222:223], v[242:243], v[232:233]
    v_pk_fma_f32 v[224:225], v[224:225], v[244:245], v[234:235]
    v_pk_fma_f32 v[226:227], v[226:227], v[246:247], v[236:237]
    v_pk_fma_f32 v[228:229], v[228:229], v[248:249], v[238:239]
    v_cvt_pk_bf16_f32 v154, v220, v221
    v_cvt_pk_bf16_f32 v155, v222, v223
    v_cvt_pk_bf16_f32 v156, v224, v225
    v_cvt_pk_bf16_f32 v157, v226, v227
    v_cvt_pk_bf16_f32 v158, v228, v229
    ds_write_b64 v17, v[154:155]
    ds_write_b64 v17, v[156:157] offset:512
    ds_write_b32 v18, v158
    s_waitcnt lgkmcnt(0)
    s_barrier
    ds_read_b128 v[96:99], v16 offset:0
    ds_read_b128 v[100:103], v16 offset:128
    ds_read_b128 v[104:107], v16 offset:256
    ds_read_b128 v[108:111], v16 offset:384
    ds_read_b128 v[112:115], v16 offset:512
    ds_read_b128 v[116:119], v16 offset:640
    ds_read_b128 v[120:123], v16 offset:768
    ds_read_b128 v[124:127], v16 offset:896
    ds_read_b128 v[128:131], v16 offset:1024
    s_waitcnt lgkmcnt(8)
    v_mfma_f32_16x16x32_bf16 v[132:135], v[160:163], v[96:99], 0
    s_waitcnt lgkmcnt(7)
    v_mfma_f32_16x16x32_bf16 v[132:135], v[164:167], v[100:103], v[132:135]
    s_waitcnt lgkmcnt(6)
    v_mfma_f32_16x16x32_bf16 v[132:135], v[168:171], v[104:107], v[132:135]
    s_waitcnt lgkmcnt(5)
    v_mfma_f32_16x16x32_bf16 v[132:135], v[172:175], v[108:111], v[132:135]
    s_waitcnt lgkmcnt(4)
    v_mfma_f32_16x16x32_bf16 v[132:135], v[176:179], v[112:115], v[132:135]
    s_waitcnt lgkmcnt(3)
    v_mfma_f32_16x16x32_bf16 v[132:135], v[180:183], v[116:119], v[132:135]
    s_waitcnt lgkmcnt(2)
    v_mfma_f32_16x16x32_bf16 v[132:135], v[184:187], v[120:123], v[132:135]
    s_waitcnt lgkmcnt(1)
    v_mfma_f32_16x16x32_bf16 v[132:135], v[188:191], v[124:127], v[132:135]
    s_waitcnt lgkmcnt(0)
    v_mfma_f32_16x16x32_bf16 v[132:135], v[192:195], v[128:131], v[132:135]
    s_cmp_lg_u32 s63, 0
    s_nop 6
    v_permlane32_swap_b32 v132, v134
    v_permlane32_swap_b32 v133, v135
    v_cndmask_b32 v133, v133, v134, s[96:97]
    v_cndmask_b32 v132, v132, v135, s[96:97]
    s_nop 1
    v_add_f32_dpp v12, v133, v132 quad_perm:[1,0,3,2] row_mask:0xf bank_mask:0xf
    s_nop 1
    s_cbranch_scc1 .up_189
    v_mul_f32 v7, 0xbfb8aa3b, v12
    v_exp_f32 v7, v7
    s_nop 0
    v_add_f32 v7, 1.0, v7
    v_rcp_f32 v7, v7
    s_nop 0
    v_mul_f32 v12, v12, v7
.up_189:
    s_nop 1
    v_mov_b32_dpp v8, v12 quad_perm:[0,0,2,2] row_mask:0xf bank_mask:0xf
    v_mov_b32_dpp v9, v12 quad_perm:[1,1,3,3] row_mask:0xf bank_mask:0xf
    v_cvt_pk_bf16_f32 v136, v8, v9
    v_cvt_pk_bf16_f32 v138, v8, v9
    s_nop 1
    v_permlane32_swap_b32 v136, v138
    s_mov_b64 exec, 0x55555555
    s_add_u32 s57, s40, 0xac000
    buffer_store_dwordx4 v[136:139], v26, s[36:39], s57 offen
    s_cmp_lg_u32 s0, 0
    s_cbranch_scc1 2
    buffer_store_dwordx4 v[136:139], v26, s[36:39], s40 offen sc1
    s_mov_b64 exec, -1
    s_barrier
    ds_read_b64_tr_b16 v[196:197], v21 offset:0
    ds_read_b64_tr_b16 v[198:199], v21 offset:512
    ds_read_b64_tr_b16 v[208:209], v22 offset:0
    ds_read_b64_tr_b16 v[210:211], v22 offset:512
    ds_read_b64_tr_b16 v[200:201], v21 offset:4096
    ds_read_b64_tr_b16 v[202:203], v21 offset:4608
    ds_read_b64_tr_b16 v[212:213], v22 offset:4096
    ds_read_b64_tr_b16 v[214:215], v22 offset:4608
    ds_read_b64_tr_b16 v[204:205], v21 offset:8192
    ds_read_b64_tr_b16 v[206:207], v21 offset:8704
    ds_read_b64_tr_b16 v[216:217], v22 offset:8192
    ds_read_b64_tr_b16 v[218:219], v22 offset:8704
    s_add_u32 s58, s41, s0
    s_lshl1_add_u32 s41, s41, 0xac000
    s_cmp_eq_u32 s0, 0
    s_cselect_b32 s32, 64, 0
    s_mov_b64 s[88:89], exec
    s_mov_b64 s[90:91], exec
    s_and_b64 s[92:93], exec, 0xff
    s_and_b64 s[56:57], exec, 0xff
.mp_190:
    s_or_b64 exec, s[88:89], 1
    buffer_load_dwordx4 v[160:163], v27, s[36:39], s58 offen offset:0 sc1
    s_or_b64 exec, s[90:91], 1
    buffer_load_dwordx4 v[164:167], v27, s[36:39], s58 offen offset:256 sc1
    s_or_b64 exec, s[92:93], 1
    buffer_load_dwordx4 v[168:171], v28, s[36:39], s58 offen offset:0 sc1
    s_or_b64 exec, s[56:57], 1
    buffer_load_dwordx4 v[172:175], v28, s[36:39], s58 offen offset:256 sc1
    s_mov_b64 exec, -1
    s_sub_u32 s35, s35, 1
    s_cbranch_scc1 .Lexit
    s_sub_u32 vcc_lo, s41, s58
    s_add_u32 s32, s32, 1
    s_cmp_ge_u32 s32, 64
    s_cselect_b32 s58, vcc_lo, s58
    s_cmp_eq_u32 s32, 64
    s_cbranch_scc0 .mpi_192
    s_mov_b64 exec, 0x55555555
    buffer_store_dwordx4 v[136:139], v26, s[36:39], s40 offen sc1
    s_mov_b64 exec, -1
.mpi_192:
    s_waitcnt vmcnt(0)
.mpj_191:
    v_cmp_ne_u32 s[88:89], s34, v161
    v_cmp_ne_u32 vcc, s34, v163
    s_or_b64 s[88:89], s[88:89], vcc
    v_cmp_ne_u32 s[90:91], s34, v165
    v_cmp_ne_u32 vcc, s34, v167
    s_or_b64 s[90:91], s[90:91], vcc
    v_cmp_ne_u32 s[92:93], s34, v169
    v_cmp_ne_u32 vcc, s34, v171
    s_or_b64 s[92:93], s[92:93], vcc
    s_and_b64 s[92:93], s[92:93], 0xff
    v_cmp_ne_u32 s[56:57], s34, v173
    v_cmp_ne_u32 vcc, s34, v175
    s_or_b64 s[56:57], s[56:57], vcc
    s_and_b64 s[56:57], s[56:57], 0xff
    s_or_b64 vcc, s[88:89], s[90:91]
    s_or_b64 vcc, vcc, s[92:93]
    s_or_b64 vcc, vcc, s[56:57]
    s_cbranch_scc1 .mp_190
    v_and_b32 v161, 0xffff0000, v160
    v_lshlrev_b32 v160, 16, v160
    v_and_b32 v163, 0xffff0000, v162
    v_lshlrev_b32 v162, 16, v162
    v_and_b32 v165, 0xffff0000, v164
    v_lshlrev_b32 v164, 16, v164
    v_and_b32 v167, 0xffff0000, v166
    v_lshlrev_b32 v166, 16, v166
    v_and_b32 v169, 0xffff0000, v168
    v_lshlrev_b32 v168, 16, v168
    v_and_b32 v171, 0xffff0000, v170
    v_lshlrev_b32 v170, 16, v170
    v_and_b32 v173, 0xffff0000, v172
    v_lshlrev_b32 v172, 16, v172
    v_and_b32 v175, 0xffff0000, v174
    v_lshlrev_b32 v174, 16, v174
    v_pk_mul_f32 v[160:161], v[160:161], v[164:165]
    v_pk_mul_f32 v[162:163], v[162:163], v[166:167]
    v_pk_mul_f32 v[168:169], v[168:169], v[172:173]
    v_pk_mul_f32 v[170:171], v[170:171], v[174:175]
    v_cvt_pk_bf16_f32 v160, v160, v161
    v_cvt_pk_bf16_f32 v161, v162, v163
    v_cvt_pk_bf16_f32 v168, v168, v169
    v_cvt_pk_bf16_f32 v169, v170, v171
    ds_write_b64 v29, v[160:161]
    s_mov_b64 exec, 0xff
    ds_write_b64 v30, v[168:169]
    s_mov_b64 exec, -1
    s_waitcnt lgkmcnt(0)
    s_barrier
    s_cmp_ge_u32 s3, 6
    s_cbranch_scc1 .tg_194
    ds_read_b128 v[96:99], v23 offset:0
    ds_read_b128 v[100:103], v23 offset:64
    ds_read_b128 v[104:107], v23 offset:128
    s_waitcnt lgkmcnt(2)
    v_mfma_f32_16x16x32_bf16 v[132:135], v[196:199], v[96:99], 0
    v_mfma_f32_16x16x32_bf16 v[136:139], v[208:211], v[96:99], 0
    s_waitcnt lgkmcnt(1)
    v_mfma_f32_16x16x32_bf16 v[132:135], v[200:203], v[100:103], v[132:135]
    v_mfma_f32_16x16x32_bf16 v[136:139], v[212:215], v[100:103], v[136:139]
    s_waitcnt lgkmcnt(0)
    v_mfma_f32_16x16x32_bf16 v[132:135], v[204:207], v[104:107], v[132:135]
    v_mfma_f32_16x16x32_bf16 v[136:139], v[216:219], v[104:107], v[136:139]
    s_nop 7
    v_cndmask_b32 v132, v132, v136, s[96:97]
    v_cndmask_b32 v133, v133, v137, s[96:97]
    v_cndmask_b32 v134, v134, v138, s[96:97]
    v_cndmask_b32 v135, v135, v139, s[96:97]
    ds_write_b128 v24, v[132:135]
    s_waitcnt lgkmcnt(0)
.tg_194:
    s_barrier
    ds_read_b128 v[112:115], v25 offset:0
    ds_read_b128 v[116:119], v25 offset:2176
    ds_read_b128 v[120:123], v25 offset:4352
    s_mov_b32 s60, 0x07060503
    s_mov_b32 s61, 0x07060502
    s_mov_b32 s62, 0x07060501
    s_waitcnt lgkmcnt(1)
    v_pk_add_f32 v[112:113], v[112:113], v[116:117]
    v_pk_add_f32 v[114:115], v[114:115], v[118:119]
    s_waitcnt lgkmcnt(0)
    v_pk_add_f32 v[112:113], v[112:113], v[120:121]
    v_pk_add_f32 v[114:115], v[114:115], v[122:123]
    v_perm_b32 v140, v112, v115, s60
    v_perm_b32 v141, v113, v115, s61
    v_perm_b32 v142, v114, v115, s62
    s_mov_b64 exec, 0xffff
    buffer_store_dwordx4 v[140:143], v2, s[36:39], s43 offen sc1
    s_mov_b64 exec, -1
    s_nop 0
    s_branch .Lexit
.Latt_n:
    v_and_b32 v8, 1, v0
    v_lshlrev_b32 v8, 8, v8
    v_and_b32 v9, 0x3c, v0
    v_lshl_add_u32 v9, v9, 2, v8
    v_lshlrev_b32 v7, 1, v9
    v_and_b32 v9, 0x3c, v0
    v_lshrrev_b32 v8, 4, v8
    v_and_b32 v9, 2, v0
    v_lshl_add_u32 v9, v9, 6, v8
    s_lshl_b32 s58, s66, 14
    s_lshl_b32 s59, s67, 10
    s_add_u32 s58, s58, s59
    s_add_u32 s58, s58, 0x40000
    s_lshl4_add_u32 s59, s66, s67
    s_lshl_b32 s59, s59, 8
    s_add_u32 s59, s59, 0x200000
    s_memrealtime s[8:9]
    s_waitcnt vmcnt(8)
    s_waitcnt lgkmcnt(0)
    s_sub_u32 s8, s8, s30
    s_cmpk_ge_u32 s8, 1147
    s_cbranch_scc1 .ap_195
    s_waitcnt vmcnt(5)
    s_cmpk_ge_u32 s8, 1082
    s_cbranch_scc1 .ap_195
    s_waitcnt vmcnt(3)
    s_bitcmp1_b64 s[14:15], 26
    s_cbranch_scc0 1
    s_waitcnt vmcnt(2)
    s_cmpk_ge_u32 s8, 1007
    s_cbranch_scc1 .ap_195
    s_waitcnt vmcnt(1)
.ap_195:
    s_add_u32 s63, s69, 409600
    buffer_load_dwordx4 v[88:91], v1, s[40:43], s63 offen nt
    s_memrealtime s[8:9]
    s_waitcnt vmcnt(8)
    s_waitcnt lgkmcnt(0)
    s_sub_u32 s8, s8, s30
    s_cmpk_ge_u32 s8, 1174
    s_cbranch_scc1 .ap_196
    s_waitcnt vmcnt(5)
    s_cmpk_ge_u32 s8, 1109
    s_cbranch_scc1 .ap_196
    s_waitcnt vmcnt(3)
    s_bitcmp1_b64 s[14:15], 27
    s_cbranch_scc0 1
    s_waitcnt vmcnt(2)
    s_cmpk_ge_u32 s8, 1034
    s_cbranch_scc1 .ap_196
    s_waitcnt vmcnt(1)
.ap_196:
    s_add_u32 s63, s69, 417792
    buffer_load_dwordx4 v[92:95], v1, s[40:43], s63 offen nt
    s_memrealtime s[8:9]
    s_waitcnt vmcnt(8)
    s_waitcnt lgkmcnt(0)
    s_sub_u32 s8, s8, s30
    s_cmpk_ge_u32 s8, 1201
    s_cbranch_scc1 .ap_197
    s_waitcnt vmcnt(5)
    s_cmpk_ge_u32 s8, 1136
    s_cbranch_scc1 .ap_197
    s_waitcnt vmcnt(3)
    s_bitcmp1_b64 s[14:15], 28
    s_cbranch_scc0 1
    s_waitcnt vmcnt(2)
    s_cmpk_ge_u32 s8, 1061
    s_cbranch_scc1 .ap_197
    s_waitcnt vmcnt(1)
.ap_197:
    s_add_u32 s63, s69, 425984
    buffer_load_dwordx4 v[120:123], v1, s[40:43], s63 offen nt
    s_memrealtime s[8:9]
    s_waitcnt vmcnt(8)
    s_waitcnt lgkmcnt(0)
    s_sub_u32 s8, s8, s30
    s_cmpk_ge_u32 s8, 1228
    s_cbranch_scc1 .ap_198
    s_waitcnt vmcnt(5)
    s_cmpk_ge_u32 s8, 1163
    s_cbranch_scc1 .ap_198
    s_waitcnt vmcnt(3)
    s_bitcmp1_b64 s[14:15], 29
    s_cbranch_scc0 1
    s_waitcnt vmcnt(2)
    s_cmpk_ge_u32 s8, 1088
    s_cbranch_scc1 .ap_198
    s_waitcnt vmcnt(1)
.ap_198:
    s_add_u32 s63, s69, 434176
    buffer_load_dwordx4 v[124:127], v1, s[40:43], s63 offen nt
    s_memrealtime s[8:9]
    s_waitcnt vmcnt(8)
    s_waitcnt lgkmcnt(0)
    s_sub_u32 s8, s8, s30
    s_cmpk_ge_u32 s8, 1255
    s_cbranch_scc1 .ap_199
    s_waitcnt vmcnt(5)
    s_cmpk_ge_u32 s8, 1190
    s_cbranch_scc1 .ap_199
    s_waitcnt vmcnt(3)
    s_bitcmp1_b64 s[14:15], 30
    s_cbranch_scc0 1
    s_waitcnt vmcnt(2)
    s_cmpk_ge_u32 s8, 1115
    s_cbranch_scc1 .ap_199
    s_waitcnt vmcnt(1)
.ap_199:
    s_add_u32 s63, s69, 442368
    buffer_load_dwordx4 v[152:155], v1, s[40:43], s63 offen nt
    s_memrealtime s[8:9]
    s_waitcnt vmcnt(8)
    s_waitcnt lgkmcnt(0)
    s_sub_u32 s8, s8, s30
    s_cmpk_ge_u32 s8, 1282
    s_cbranch_scc1 .ap_200
    s_waitcnt vmcnt(5)
    s_cmpk_ge_u32 s8, 1217
    s_cbranch_scc1 .ap_200
    s_waitcnt vmcnt(3)
    s_bitcmp1_b64 s[14:15], 31
    s_cbranch_scc0 1
    s_waitcnt vmcnt(2)
    s_cmpk_ge_u32 s8, 1142
    s_cbranch_scc1 .ap_200
    s_waitcnt vmcnt(1)
.ap_200:
    s_add_u32 s63, s69, 450560
    buffer_load_dwordx4 v[156:159], v1, s[40:43], s63 offen nt
    buffer_load_dwordx4 v[16:19], v7, s[36:39], s58 offen offset:0 sc1
    buffer_load_dwordx4 v[20:23], v7, s[36:39], s58 offen offset:16 sc1
    s_memrealtime s[8:9]
    s_waitcnt vmcnt(8)
    s_waitcnt lgkmcnt(0)
    s_sub_u32 s8, s8, s30
    s_cmpk_ge_u32 s8, 1309
    s_cbranch_scc1 .ap_201
    s_waitcnt vmcnt(5)
    s_cmpk_ge_u32 s8, 1244
    s_cbranch_scc1 .ap_201
    s_waitcnt vmcnt(3)
    s_bitcmp1_b64 s[14:15], 32
    s_cbranch_scc0 1
    s_waitcnt vmcnt(2)
    s_cmpk_ge_u32 s8, 1169
    s_cbranch_scc1 .ap_201
    s_waitcnt vmcnt(1)
.ap_201:
    s_add_u32 s63, s69, 0
    buffer_load_dwordx4 v[160:163], v2, s[44:47], s63 offen nt
    s_memrealtime s[8:9]
    s_waitcnt vmcnt(8)
    s_waitcnt lgkmcnt(0)
    s_sub_u32 s8, s8, s30
    s_cmpk_ge_u32 s8, 1336
    s_cbranch_scc1 .ap_202
    s_waitcnt vmcnt(5)
    s_cmpk_ge_u32 s8, 1271
    s_cbranch_scc1 .ap_202
    s_waitcnt vmcnt(3)
    s_bitcmp1_b64 s[14:15], 33
    s_cbranch_scc0 1
    s_waitcnt vmcnt(2)
    s_cmpk_ge_u32 s8, 1196
    s_cbranch_scc1 .ap_202
    s_waitcnt vmcnt(1)
.ap_202:
    s_add_u32 s63, s69, 8192
    buffer_load_dwordx4 v[164:167], v2, s[44:47], s63 offen nt
    s_memrealtime s[8:9]
    s_waitcnt vmcnt(8)
    s_waitcnt lgkmcnt(0)
    s_sub_u32 s8, s8, s30
    s_cmpk_ge_u32 s8, 1363
    s_cbranch_scc1 .ap_203
    s_waitcnt vmcnt(5)
    s_cmpk_ge_u32 s8, 1298
    s_cbranch_scc1 .ap_203
    s_waitcnt vmcnt(3)
    s_bitcmp1_b64 s[14:15], 34
    s_cbranch_scc0 1
    s_waitcnt vmcnt(2)
    s_cmpk_ge_u32 s8, 1223
    s_cbranch_scc1 .ap_203
    s_waitcnt vmcnt(1)
.ap_203:
    s_add_u32 s63, s69, 16384
    buffer_load_dwordx4 v[168:171], v2, s[44:47], s63 offen nt
    s_waitcnt vmcnt(3)
    s_branch .gpc_205
.gp_204:
    buffer_load_dwordx4 v[16:19], v7, s[36:39], s58 offen offset:0 sc1
    buffer_load_dwordx4 v[20:23], v7, s[36:39], s58 offen offset:16 sc1
    s_waitcnt vmcnt(0)
.gpc_205:
    v_min_u32 v10, v17, v19
    v_max_u32 v11, v17, v19
    v_min3_u32 v10, v10, v21, v23
    v_max3_u32 v11, v11, v21, v23
    v_cmp_eq_u32 vcc, s34, v10
    v_cmp_eq_u32 s[56:57], s34, v11
    s_and_b64 vcc, vcc, s[56:57]
    s_cmp_eq_u64 vcc, exec
    s_nop 2
    s_cbranch_scc1 .gpd_206
    s_sub_u32 s35, s35, 1
    s_cbranch_scc1 .Lexit
    s_sleep 1
    s_branch .gp_204
.gpd_206:
    s_mov_b32 vcc_lo, 0xcccccccc
    s_mov_b32 vcc_hi, 0xcccccccc
    v_cndmask_b32_e64 v24, v16, 0, vcc
    v_cndmask_b32_e64 v25, v18, 0, vcc
    v_cndmask_b32_e64 v26, v20, 0, vcc
    v_cndmask_b32_e64 v27, v22, 0, vcc
    v_cndmask_b32_e32 v28, 0, v16, vcc
    v_cndmask_b32_e32 v29, 0, v18, vcc
    v_cndmask_b32_e32 v30, 0, v20, vcc
    v_cndmask_b32_e32 v31, 0, v22, vcc
    v_mfma_f32_16x16x32_bf16 v[16:19], v[32:35], v[24:27], 0
    v_mfma_f32_16x16x32_bf16 v[32:35], v[40:43], v[24:27], 0
    v_mfma_f32_16x16x32_bf16 v[16:19], v[36:39], v[28:31], v[16:19]
    v_mfma_f32_16x16x32_bf16 v[40:43], v[48:51], v[24:27], 0
    v_mfma_f32_16x16x32_bf16 v[32:35], v[44:47], v[28:31], v[32:35]
    v_mfma_f32_16x16x32_bf16 v[48:51], v[56:59], v[24:27], 0
    v_mfma_f32_16x16x32_bf16 v[40:43], v[52:55], v[28:31], v[40:43]
    v_mfma_f32_16x16x32_bf16 v[56:59], v[64:67], v[24:27], 0
    v_mfma_f32_16x16x32_bf16 v[48:51], v[60:63], v[28:31], v[48:51]
    s_nop 1
    v_add_f32_dpp v10, v17, v16 row_ror:12 row_mask:0xf bank_mask:0x1
    s_memrealtime s[8:9]
    s_waitcnt lgkmcnt(0)
    s_sub_u32 s8, s8, s30
    s_cmpk_ge_u32 s8, 1390
    s_nop 0
    s_cbranch_scc1 .ap_207
    s_waitcnt vmcnt(3)
    s_cmpk_ge_u32 s8, 1325
    s_cbranch_scc1 .ap_207
    s_waitcnt vmcnt(3)
    s_bitcmp1_b64 s[14:15], 35
    s_cbranch_scc0 1
    s_waitcnt vmcnt(2)
    s_cmpk_ge_u32 s8, 1250
    s_cbranch_scc1 .ap_207
    s_waitcnt vmcnt(1)
.ap_207:
    s_add_u32 s63, s69, 24576
    buffer_load_dwordx4 v[172:175], v2, s[44:47], s63 offen nt
    v_mfma_f32_16x16x32_bf16 v[64:67], v[72:75], v[24:27], 0
    v_mfma_f32_16x16x32_bf16 v[56:59], v[68:71], v[28:31], v[56:59]
    v_add_f32_dpp v11, v33, v32 row_ror:12 row_mask:0xf bank_mask:0x1
    v_add_f32_dpp v10, v18, v10 row_ror:8 row_mask:0xf bank_mask:0x1
    v_mfma_f32_16x16x32_bf16 v[72:75], v[80:83], v[24:27], 0
    v_mfma_f32_16x16x32_bf16 v[64:67], v[76:79], v[28:31], v[64:67]
    v_add_f32_dpp v12, v41, v40 row_ror:12 row_mask:0xf bank_mask:0x1
    v_add_f32_dpp v11, v34, v11 row_ror:8 row_mask:0xf bank_mask:0x1
    v_add_f32_dpp v10, v19, v10 row_ror:4 row_mask:0xf bank_mask:0x1
    v_mfma_f32_16x16x32_bf16 v[80:83], v[88:91], v[24:27], 0
    v_mfma_f32_16x16x32_bf16 v[72:75], v[84:87], v[28:31], v[72:75]
    v_add_f32_dpp v13, v49, v48 row_ror:12 row_mask:0xf bank_mask:0x1
    v_add_f32_dpp v12, v42, v12 row_ror:8 row_mask:0xf bank_mask:0x1
    v_add_f32_dpp v11, v35, v11 row_ror:4 row_mask:0xf bank_mask:0x1
    v_mfma_f32_16x16x32_bf16 v[88:91], v[96:99], v[24:27], 0
    v_mfma_f32_16x16x32_bf16 v[80:83], v[92:95], v[28:31], v[80:83]
    v_add_f32_dpp v10, v58, v57 row_ror:12 row_mask:0xf bank_mask:0x2
    v_add_f32_dpp v13, v50, v13 row_ror:8 row_mask:0xf bank_mask:0x1
    v_add_f32_dpp v12, v43, v12 row_ror:4 row_mask:0xf bank_mask:0x1
    s_memrealtime s[8:9]
    s_waitcnt lgkmcnt(0)
    s_sub_u32 s8, s8, s30
    s_cmpk_ge_u32 s8, 1417
    s_nop 0
    s_cbranch_scc1 .ap_208
    s_waitcnt vmcnt(4)
    s_cmpk_ge_u32 s8, 1352
    s_cbranch_scc1 .ap_208
    s_waitcnt vmcnt(3)
    s_bitcmp1_b64 s[14:15], 36
    s_cbranch_scc0 1
    s_waitcnt vmcnt(2)
    s_cmpk_ge_u32 s8, 1277
    s_cbranch_scc1 .ap_208
    s_waitcnt vmcnt(1)
.ap_208:
    s_add_u32 s63, s69, 32768
    buffer_load_dwordx4 v[176:179], v2, s[44:47], s63 offen nt
    v_mfma_f32_16x16x32_bf16 v[96:99], v[104:107], v[24:27], 0
    v_mfma_f32_16x16x32_bf16 v[88:91], v[100:103], v[28:31], v[88:91]
    v_add_f32_dpp v11, v66, v65 row_ror:12 row_mask:0xf bank_mask:0x2
    v_add_f32_dpp v10, v59, v10 row_ror:8 row_mask:0xf bank_mask:0x2
    v_add_f32_dpp v13, v51, v13 row_ror:4 row_mask:0xf bank_mask:0x1
    v_mfma_f32_16x16x32_bf16 v[104:107], v[112:115], v[24:27], 0
    v_mfma_f32_16x16x32_bf16 v[96:99], v[108:111], v[28:31], v[96:99]
    v_add_f32_dpp v12, v74, v73 row_ror:12 row_mask:0xf bank_mask:0x2
    v_add_f32_dpp v11, v67, v11 row_ror:8 row_mask:0xf bank_mask:0x2
    v_add_f32_dpp v10, v56, v10 row_ror:4 row_mask:0xf bank_mask:0x2
    v_mfma_f32_16x16x32_bf16 v[112:115], v[120:123], v[24:27], 0
    v_mfma_f32_16x16x32_bf16 v[104:107], v[116:119], v[28:31], v[104:107]
    v_add_f32_dpp v13, v82, v81 row_ror:12 row_mask:0xf bank_mask:0x2
    v_add_f32_dpp v12, v75, v12 row_ror:8 row_mask:0xf bank_mask:0x2
    v_add_f32_dpp v11, v64, v11 row_ror:4 row_mask:0xf bank_mask:0x2
    v_mfma_f32_16x16x32_bf16 v[120:123], v[128:131], v[24:27], 0
    v_mfma_f32_16x16x32_bf16 v[112:115], v[124:127], v[28:31], v[112:115]
    v_add_f32_dpp v10, v91, v90 row_ror:12 row_mask:0xf bank_mask:0x4
    v_add_f32_dpp v13, v83, v13 row_ror:8 row_mask:0xf bank_mask:0x2
    v_add_f32_dpp v12, v72, v12 row_ror:4 row_mask:0xf bank_mask:0x2
    s_memrealtime s[8:9]
    s_waitcnt lgkmcnt(0)
    s_sub_u32 s8, s8, s30
    s_cmpk_ge_u32 s8, 1444
    s_nop 0
    s_cbranch_scc1 .ap_209
    s_waitcnt vmcnt(5)
    s_cmpk_ge_u32 s8, 1379
    s_cbranch_scc1 .ap_209
    s_waitcnt vmcnt(3)
    s_bitcmp1_b64 s[14:15], 37
    s_cbranch_scc0 1
    s_waitcnt vmcnt(2)
    s_cmpk_ge_u32 s8, 1304
    s_cbranch_scc1 .ap_209
    s_waitcnt vmcnt(1)
.ap_209:
    s_add_u32 s63, s69, 40960
    buffer_load_dwordx4 v[180:183], v2, s[44:47], s63 offen nt
    v_mfma_f32_16x16x32_bf16 v[128:131], v[136:139], v[24:27], 0
    v_mfma_f32_16x16x32_bf16 v[120:123], v[132:135], v[28:31], v[120:123]
    v_add_f32_dpp v11, v99, v98 row_ror:12 row_mask:0xf bank_mask:0x4
    v_add_f32_dpp v10, v88, v10 row_ror:8 row_mask:0xf bank_mask:0x4
    v_add_f32_dpp v13, v80, v13 row_ror:4 row_mask:0xf bank_mask:0x2
    v_mfma_f32_16x16x32_bf16 v[136:139], v[144:147], v[24:27], 0
    v_mfma_f32_16x16x32_bf16 v[128:131], v[140:143], v[28:31], v[128:131]
    v_add_f32_dpp v12, v107, v106 row_ror:12 row_mask:0xf bank_mask:0x4
    v_add_f32_dpp v11, v96, v11 row_ror:8 row_mask:0xf bank_mask:0x4
    v_add_f32_dpp v10, v89, v10 row_ror:4 row_mask:0xf bank_mask:0x4
    v_mfma_f32_16x16x32_bf16 v[144:147], v[152:155], v[24:27], 0
    v_mfma_f32_16x16x32_bf16 v[136:139], v[148:151], v[28:31], v[136:139]
    v_add_f32_dpp v13, v115, v114 row_ror:12 row_mask:0xf bank_mask:0x4
    v_add_f32_dpp v12, v104, v12 row_ror:8 row_mask:0xf bank_mask:0x4
    v_add_f32_dpp v11, v97, v11 row_ror:4 row_mask:0xf bank_mask:0x4
    v_mfma_f32_16x16x32_bf16 v[144:147], v[156:159], v[28:31], v[144:147]
    v_add_f32_dpp v10, v120, v123 row_ror:12 row_mask:0xf bank_mask:0x8
    v_add_f32_dpp v13, v112, v13 row_ror:8 row_mask:0xf bank_mask:0x4
    v_add_f32_dpp v12, v105, v12 row_ror:4 row_mask:0xf bank_mask:0x4
    s_memrealtime s[8:9]
    s_waitcnt lgkmcnt(0)
    s_sub_u32 s8, s8, s30
    s_cmpk_ge_u32 s8, 1471
    s_nop 0
    s_cbranch_scc1 .ap_210
    s_waitcnt vmcnt(5)
    s_cmpk_ge_u32 s8, 1406
    s_cbranch_scc1 .ap_210
    s_waitcnt vmcnt(3)
    s_bitcmp1_b64 s[14:15], 38
    s_cbranch_scc0 1
    s_waitcnt vmcnt(2)
    s_cmpk_ge_u32 s8, 1331
    s_cbranch_scc1 .ap_210
    s_waitcnt vmcnt(1)
.ap_210:
    s_add_u32 s63, s69, 49152
    buffer_load_dwordx4 v[184:187], v2, s[44:47], s63 offen nt
    v_add_f32_dpp v11, v128, v131 row_ror:12 row_mask:0xf bank_mask:0x8
    v_add_f32_dpp v10, v121, v10 row_ror:8 row_mask:0xf bank_mask:0x8
    v_add_f32_dpp v13, v113, v13 row_ror:4 row_mask:0xf bank_mask:0x4
    v_add_f32_dpp v12, v136, v139 row_ror:12 row_mask:0xf bank_mask:0x8
    v_add_f32_dpp v11, v129, v11 row_ror:8 row_mask:0xf bank_mask:0x8
    v_add_f32_dpp v10, v122, v10 row_ror:4 row_mask:0xf bank_mask:0x8
    v_add_f32_dpp v13, v144, v147 row_ror:12 row_mask:0xf bank_mask:0x8
    v_add_f32_dpp v12, v137, v12 row_ror:8 row_mask:0xf bank_mask:0x8
    v_add_f32_dpp v11, v130, v11 row_ror:4 row_mask:0xf bank_mask:0x8
    v_add_f32_dpp v13, v145, v13 row_ror:8 row_mask:0xf bank_mask:0x8
    v_add_f32_dpp v12, v138, v12 row_ror:4 row_mask:0xf bank_mask:0x8
    s_memrealtime s[8:9]
    s_waitcnt lgkmcnt(0)
    s_sub_u32 s8, s8, s30
    s_cmpk_ge_u32 s8, 1498
    s_cbranch_scc1 .ap_211
    s_waitcnt vmcnt(5)
    s_cmpk_ge_u32 s8, 1433
    s_cbranch_scc1 .ap_211
    s_waitcnt vmcnt(3)
    s_bitcmp1_b64 s[14:15], 39
    s_cbranch_scc0 1
    s_waitcnt vmcnt(2)
    s_cmpk_ge_u32 s8, 1358
    s_cbranch_scc1 .ap_211
    s_waitcnt vmcnt(1)
.ap_211:
    s_add_u32 s63, s69, 57344
    buffer_load_dwordx4 v[188:191], v2, s[44:47], s63 offen nt
    v_add_f32_dpp v13, v146, v13 row_ror:4 row_mask:0xf bank_mask:0x8
    s_mov_b32 s60, 0x3db504f3
    s_mov_b32 s61, 0x3db504f3
    v_cvt_pk_bf16_f32 v10, 0, v10
    v_cvt_pk_bf16_f32 v11, 0, v11
    v_cvt_pk_bf16_f32 v12, 0, v12
    v_cvt_pk_bf16_f32 v13, 0, v13
    v_pk_mul_f32 v[10:11], v[10:11], s[60:61]
    v_pk_mul_f32 v[12:13], v[12:13], s[60:61]
    v_cvt_pk_bf16_f32 v10, 0, v10
    v_cvt_pk_bf16_f32 v11, 0, v11
    v_cvt_pk_bf16_f32 v12, 0, v12
    v_cvt_pk_bf16_f32 v13, 0, v13
    v_max_f32 v14, v10, v11
    v_max3_f32 v14, v14, v12, v13
    s_mov_b32 s60, 0x3fb8aa3b
    v_mov_b32 v22, s34
    v_mov_b32 v23, s34
    v_max_f32_dpp v14, v14, v14 quad_perm:[2,3,0,1] row_mask:0xf bank_mask:0xf
    s_nop 1
    v_max_f32_dpp v14, v14, v14 row_ror:4 row_mask:0xf bank_mask:0xf
    s_nop 1
    v_max_f32_dpp v14, v14, v14 row_ror:8 row_mask:0xf bank_mask:0xf
    v_mov_b32 v15, v14
    s_nop 1
    v_permlane16_swap_b32 v15, v14
    v_max_f32 v14, v15, v14
    v_mov_b32 v15, v14
    s_nop 1
    v_permlane32_swap_b32 v15, v14
    v_max_f32 v14, v15, v14
    v_mul_f32 v15, 0xbfb8aa3b, v14
    v_fma_f32 v10, v10, s60, v15
    v_fma_f32 v11, v11, s60, v15
    v_fma_f32 v12, v12, s60, v15
    v_fma_f32 v13, v13, s60, v15
    v_exp_f32 v10, v10
    v_exp_f32 v11, v11
    v_exp_f32 v12, v12
    v_exp_f32 v13, v13
    v_mov_b32 v20, v14
    v_pk_add_f32 v[16:17], v[10:11], v[12:13]
    v_add_f32 v21, v16, v17
    s_lshl3_add_u32 s60, s68, s3
    s_lshl_b32 s60, s60, 5
    s_add_u32 s60, s60, s59
    v_add_f32_dpp v21, v21, v21 quad_perm:[2,3,0,1] row_mask:0xf bank_mask:0xf
    s_nop 1
    v_add_f32_dpp v21, v21, v21 row_ror:4 row_mask:0xf bank_mask:0xf
    s_nop 1
    v_add_f32_dpp v21, v21, v21 row_ror:8 row_mask:0xf bank_mask:0xf
    v_mov_b32 v15, v21
    s_nop 1
    v_permlane16_swap_b32 v15, v21
    v_add_f32 v21, v15, v21
    v_mov_b32 v15, v21
    s_nop 1
    v_permlane32_swap_b32 v15, v21
    v_add_f32 v21, v15, v21
    s_lshl_b32 s60, s3, 4
    s_add_u32 s60, s60, 159104
    v_add_u32 v16, s60, v3
    v_mov_b32 v17, 159232
    v_mov_b32 v18, 1
    s_mov_b64 exec, 3
    ds_write_b64 v16, v[20:21]
    s_mov_b64 exec, 1
    s_waitcnt lgkmcnt(0)
    ds_add_rtn_u32 v18, v17, v18
    s_mov_b64 exec, -1
    v_and_b32 v16, 0x78, v3
    v_add_u32 v16, 159104, v16
    s_waitcnt lgkmcnt(0)
    v_readfirstlane_b32 s60, v18
    s_cmp_lg_u32 s60, 7
    s_nop 3
    s_cbranch_scc1 .ml_212
    ds_read_b64 v[18:19], v16
    s_lshl_b32 s60, s68, 7
    s_add_u32 s60, s60, s59
    s_waitcnt lgkmcnt(0)
    v_mov_b32 v20, v18
    s_nop 1
    v_max_f32_dpp v20, v20, v20 quad_perm:[2,3,0,1] row_mask:0xf bank_mask:0xf
    s_nop 1
    v_max_f32_dpp v20, v20, v20 row_ror:4 row_mask:0xf bank_mask:0xf
    s_nop 1
    v_max_f32_dpp v20, v20, v20 row_ror:8 row_mask:0xf bank_mask:0xf
    v_sub_f32 v18, v18, v20
    v_mul_f32 v18, 0x3fb8aa3b, v18
    v_exp_f32 v18, v18
    s_nop 0
    v_mul_f32 v21, v18, v19
    s_nop 1
    v_add_f32_dpp v21, v21, v21 quad_perm:[2,3,0,1] row_mask:0xf bank_mask:0xf
    s_nop 1
    v_add_f32_dpp v21, v21, v21 row_ror:4 row_mask:0xf bank_mask:0xf
    s_nop 1
    v_add_f32_dpp v21, v21, v21 row_ror:8 row_mask:0xf bank_mask:0xf
    s_mov_b64 exec, 0xff
    buffer_store_dwordx4 v[20:23], v2, s[36:39], s60 offen sc1
    s_mov_b64 exec, -1
.ml_212:
    s_memrealtime s[8:9]
    s_waitcnt lgkmcnt(0)
    s_sub_u32 s8, s8, s30
    s_cmpk_ge_u32 s8, 1525
    s_cbranch_scc1 .ap_213
    s_waitcnt vmcnt(5)
    s_cmpk_ge_u32 s8, 1460
    s_cbranch_scc1 .ap_213
    s_waitcnt vmcnt(3)
    s_bitcmp1_b64 s[14:15], 40
    s_cbranch_scc0 1
    s_waitcnt vmcnt(2)
    s_cmpk_ge_u32 s8, 1385
    s_cbranch_scc1 .ap_213
    s_waitcnt vmcnt(1)
.ap_213:
    s_add_u32 s63, s69, 131072
    buffer_load_dwordx4 v[192:195], v2, s[44:47], s63 offen nt
    s_memrealtime s[8:9]
    s_waitcnt vmcnt(8)
    s_waitcnt lgkmcnt(0)
    s_sub_u32 s8, s8, s30
    s_cmpk_ge_u32 s8, 1552
    s_cbranch_scc1 .ap_214
    s_waitcnt vmcnt(5)
    s_cmpk_ge_u32 s8, 1487
    s_cbranch_scc1 .ap_214
    s_waitcnt vmcnt(3)
    s_bitcmp1_b64 s[14:15], 41
    s_cbranch_scc0 1
    s_waitcnt vmcnt(2)
    s_cmpk_ge_u32 s8, 1412
    s_cbranch_scc1 .ap_214
    s_waitcnt vmcnt(1)
.ap_214:
    s_add_u32 s63, s69, 139264
    buffer_load_dwordx4 v[196:199], v2, s[44:47], s63 offen nt
    s_memrealtime s[8:9]
    s_waitcnt vmcnt(8)
    s_waitcnt lgkmcnt(0)
    s_sub_u32 s8, s8, s30
    s_cmpk_ge_u32 s8, 1579
    s_cbranch_scc1 .ap_215
    s_waitcnt vmcnt(5)
    s_cmpk_ge_u32 s8, 1514
    s_cbranch_scc1 .ap_215
    s_waitcnt vmcnt(3)
    s_bitcmp1_b64 s[14:15], 42
    s_cbranch_scc0 1
    s_waitcnt vmcnt(2)
    s_cmpk_ge_u32 s8, 1439
    s_cbranch_scc1 .ap_215
    s_waitcnt vmcnt(1)
.ap_215:
    s_add_u32 s63, s69, 147456
    buffer_load_dwordx4 v[200:203], v2, s[44:47], s63 offen nt
    s_memrealtime s[8:9]
    s_waitcnt vmcnt(8)
    s_waitcnt lgkmcnt(0)
    s_sub_u32 s8, s8, s30
    s_cmpk_ge_u32 s8, 1606
    s_cbranch_scc1 .ap_216
    s_waitcnt vmcnt(5)
    s_cmpk_ge_u32 s8, 1541
    s_cbranch_scc1 .ap_216
    s_waitcnt vmcnt(3)
    s_bitcmp1_b64 s[14:15], 43
    s_cbranch_scc0 1
    s_waitcnt vmcnt(2)
    s_cmpk_ge_u32 s8, 1466
    s_cbranch_scc1 .ap_216
    s_waitcnt vmcnt(1)
.ap_216:
    s_add_u32 s63, s69, 155648
    buffer_load_dwordx4 v[204:207], v2, s[44:47], s63 offen nt
    s_memrealtime s[8:9]
    s_waitcnt vmcnt(8)
    s_waitcnt lgkmcnt(0)
    s_sub_u32 s8, s8, s30
    s_cmpk_ge_u32 s8, 1633
    s_cbranch_scc1 .ap_217
    s_waitcnt vmcnt(5)
    s_cmpk_ge_u32 s8, 1568
    s_cbranch_scc1 .ap_217
    s_waitcnt vmcnt(3)
    s_bitcmp1_b64 s[14:15], 44
    s_cbranch_scc0 1
    s_waitcnt vmcnt(2)
    s_cmpk_ge_u32 s8, 1493
    s_cbranch_scc1 .ap_217
    s_waitcnt vmcnt(1)
.ap_217:
    s_add_u32 s63, s69, 163840
    buffer_load_dwordx4 v[208:211], v2, s[44:47], s63 offen nt
    s_memrealtime s[8:9]
    s_waitcnt vmcnt(8)
    s_waitcnt lgkmcnt(0)
    s_sub_u32 s8, s8, s30
    s_cmpk_ge_u32 s8, 1660
    s_cbranch_scc1 .ap_218
    s_waitcnt vmcnt(5)
    s_cmpk_ge_u32 s8, 1595
    s_cbranch_scc1 .ap_218
    s_waitcnt vmcnt(3)
    s_bitcmp1_b64 s[14:15], 45
    s_cbranch_scc0 1
    s_waitcnt vmcnt(2)
    s_cmpk_ge_u32 s8, 1520
    s_cbranch_scc1 .ap_218
    s_waitcnt vmcnt(1)
.ap_218:
    s_add_u32 s63, s69, 172032
    buffer_load_dwordx4 v[212:215], v2, s[44:47], s63 offen nt
    s_memrealtime s[8:9]
    s_waitcnt vmcnt(8)
    s_waitcnt lgkmcnt(0)
    s_sub_u32 s8, s8, s30
    s_cmpk_ge_u32 s8, 1691
    s_cbranch_scc1 .ap_219
    s_waitcnt vmcnt(5)
    s_cmpk_ge_u32 s8, 1626
    s_cbranch_scc1 .ap_219
    s_waitcnt vmcnt(3)
    s_bitcmp1_b64 s[14:15], 46
    s_cbranch_scc0 1
    s_waitcnt vmcnt(2)
    s_cmpk_ge_u32 s8, 1551
    s_cbranch_scc1 .ap_219
    s_waitcnt vmcnt(1)
.ap_219:
    s_add_u32 s63, s69, 180224
    buffer_load_dwordx4 v[216:219], v2, s[44:47], s63 offen nt
    s_memrealtime s[8:9]
    s_waitcnt vmcnt(8)
    s_waitcnt lgkmcnt(0)
    s_sub_u32 s8, s8, s30
    s_cmpk_ge_u32 s8, 1722
    s_cbranch_scc1 .ap_220
    s_waitcnt vmcnt(5)
    s_cmpk_ge_u32 s8, 1657
    s_cbranch_scc1 .ap_220
    s_waitcnt vmcnt(3)
    s_bitcmp1_b64 s[14:15], 47
    s_cbranch_scc0 1
    s_waitcnt vmcnt(2)
    s_cmpk_ge_u32 s8, 1582
    s_cbranch_scc1 .ap_220
    s_waitcnt vmcnt(1)
.ap_220:
    s_add_u32 s63, s69, 188416
    buffer_load_dwordx4 v[220:223], v2, s[44:47], s63 offen nt
    s_memrealtime s[8:9]
    s_waitcnt vmcnt(8)
    s_waitcnt lgkmcnt(0)
    s_sub_u32 s8, s8, s30
    s_cmpk_ge_u32 s8, 1753
    s_cbranch_scc1 .ap_221
    s_waitcnt vmcnt(5)
    s_cmpk_ge_u32 s8, 1688
    s_cbranch_scc1 .ap_221
    s_waitcnt vmcnt(3)
    s_bitcmp1_b64 s[14:15], 48
    s_cbranch_scc0 1
    s_waitcnt vmcnt(2)
    s_cmpk_ge_u32 s8, 1613
    s_cbranch_scc1 .ap_221
    s_waitcnt vmcnt(1)
.ap_221:
    s_add_u32 s63, s69, 262144
    buffer_load_dwordx4 v[224:227], v2, s[44:47], s63 offen nt
    s_memrealtime s[8:9]
    s_waitcnt vmcnt(8)
    s_waitcnt lgkmcnt(0)
    s_sub_u32 s8, s8, s30
    s_cmpk_ge_u32 s8, 1784
    s_cbranch_scc1 .ap_222
    s_waitcnt vmcnt(5)
    s_cmpk_ge_u32 s8, 1719
    s_cbranch_scc1 .ap_222
    s_waitcnt vmcnt(3)
    s_bitcmp1_b64 s[14:15], 49
    s_cbranch_scc0 1
    s_waitcnt vmcnt(2)
    s_cmpk_ge_u32 s8, 1644
    s_cbranch_scc1 .ap_222
    s_waitcnt vmcnt(1)
.ap_222:
    s_add_u32 s63, s69, 270336
    buffer_load_dwordx4 v[228:231], v2, s[44:47], s63 offen nt
    s_memrealtime s[8:9]
    s_waitcnt vmcnt(8)
    s_waitcnt lgkmcnt(0)
    s_sub_u32 s8, s8, s30
    s_cmpk_ge_u32 s8, 1815
    s_cbranch_scc1 .ap_223
    s_waitcnt vmcnt(5)
    s_cmpk_ge_u32 s8, 1750
    s_cbranch_scc1 .ap_223
    s_waitcnt vmcnt(3)
    s_bitcmp1_b64 s[14:15], 50
    s_cbranch_scc0 1
    s_waitcnt vmcnt(2)
    s_cmpk_ge_u32 s8, 1675
    s_cbranch_scc1 .ap_223
    s_waitcnt vmcnt(1)
.ap_223:
    s_add_u32 s63, s69, 278528
    buffer_load_dwordx4 v[232:235], v2, s[44:47], s63 offen nt
    s_memrealtime s[8:9]
    s_waitcnt vmcnt(8)
    s_waitcnt lgkmcnt(0)
    s_sub_u32 s8, s8, s30
    s_cmpk_ge_u32 s8, 1846
    s_cbranch_scc1 .ap_224
    s_waitcnt vmcnt(5)
    s_cmpk_ge_u32 s8, 1781
    s_cbranch_scc1 .ap_224
    s_waitcnt vmcnt(3)
    s_bitcmp1_b64 s[14:15], 51
    s_cbranch_scc0 1
    s_waitcnt vmcnt(2)
    s_cmpk_ge_u32 s8, 1706
    s_cbranch_scc1 .ap_224
    s_waitcnt vmcnt(1)
.ap_224:
    s_add_u32 s63, s69, 286720
    buffer_load_dwordx4 v[236:239], v2, s[44:47], s63 offen nt
    s_memrealtime s[8:9]
    s_waitcnt vmcnt(8)
    s_waitcnt lgkmcnt(0)
    s_sub_u32 s8, s8, s30
    s_cmpk_ge_u32 s8, 1877
    s_cbranch_scc1 .ap_225
    s_waitcnt vmcnt(5)
    s_cmpk_ge_u32 s8, 1812
    s_cbranch_scc1 .ap_225
    s_waitcnt vmcnt(3)
    s_bitcmp1_b64 s[14:15], 52
    s_cbranch_scc0 1
    s_waitcnt vmcnt(2)
    s_cmpk_ge_u32 s8, 1737
    s_cbranch_scc1 .ap_225
    s_waitcnt vmcnt(1)
.ap_225:
    s_add_u32 s63, s69, 294912
    buffer_load_dwordx4 v[240:243], v2, s[44:47], s63 offen nt
    s_memrealtime s[8:9]
    s_waitcnt vmcnt(8)
    s_waitcnt lgkmcnt(0)
    s_sub_u32 s8, s8, s30
    s_cmpk_ge_u32 s8, 1908
    s_cbranch_scc1 .ap_226
    s_waitcnt vmcnt(5)
    s_cmpk_ge_u32 s8, 1843
    s_cbranch_scc1 .ap_226
    s_waitcnt vmcnt(3)
    s_bitcmp1_b64 s[14:15], 53
    s_cbranch_scc0 1
    s_waitcnt vmcnt(2)
    s_cmpk_ge_u32 s8, 1768
    s_cbranch_scc1 .ap_226
    s_waitcnt vmcnt(1)
.ap_226:
    s_add_u32 s63, s69, 303104
    buffer_load_dwordx4 v[244:247], v2, s[44:47], s63 offen nt
    s_load_dwordx2 s[88:89], s[6:7], s0
    buffer_load_dwordx4 v[24:27], v9, s[36:39], s59 offen offset:0 sc1
    s_memrealtime s[8:9]
    s_waitcnt vmcnt(8)
    s_waitcnt lgkmcnt(0)
    s_sub_u32 s8, s8, s30
    s_cmpk_ge_u32 s8, 1939
    s_cbranch_scc1 .ap_227
    s_waitcnt vmcnt(5)
    s_cmpk_ge_u32 s8, 1874
    s_cbranch_scc1 .ap_227
    s_waitcnt vmcnt(3)
    s_bitcmp1_b64 s[14:15], 54
    s_cbranch_scc0 1
    s_waitcnt vmcnt(2)
    s_cmpk_ge_u32 s8, 1799
    s_cbranch_scc1 .ap_227
    s_waitcnt vmcnt(1)
.ap_227:
    s_add_u32 s63, s69, 311296
    buffer_load_dwordx4 v[248:251], v2, s[44:47], s63 offen nt
    s_sub_u32 s56, s65, 27
    s_lshl3_add_u32 s56, s56, s3
    s_cmp_ge_u32 s56, 11
    s_cbranch_scc1 .cpf_228
    s_getpc_b64 s[8:9]
.Lcpf_pc:
    s_cmp_ge_u32 s56, 6
    s_mov_b32 s57, .Lcpf_pc-.Ltail_ar
    s_cselect_b32 s57, .Lcpf_pc-.Ltail_bc+6144, s57
    s_lshl_b32 s56, s56, 10
    s_sub_u32 s56, s57, s56
    s_sub_u32 s8, s8, s56
    s_subb_u32 s9, s9, 0
    v_mov_b32 v41, s9
    v_add_co_u32 v40, vcc, s8, v2
    s_nop 1
    v_addc_co_u32 v41, vcc, 0, v41, vcc
    global_load_dwordx4 v[32:35], v[40:41], off
.cpf_228:
    s_memrealtime s[8:9]
    s_waitcnt vmcnt(8)
    s_waitcnt lgkmcnt(0)
    s_sub_u32 s8, s8, s30
    s_cmpk_ge_u32 s8, 1970
    s_cbranch_scc1 .ap_229
    s_waitcnt vmcnt(5)
    s_cmpk_ge_u32 s8, 1905
    s_cbranch_scc1 .ap_229
    s_waitcnt vmcnt(3)
    s_bitcmp1_b64 s[14:15], 55
    s_cbranch_scc0 1
    s_waitcnt vmcnt(2)
    s_cmpk_ge_u32 s8, 1830
    s_cbranch_scc1 .ap_229
    s_waitcnt vmcnt(1)
.ap_229:
    s_add_u32 s63, s69, 319488
    buffer_load_dwordx4 v[252:255], v2, s[44:47], s63 offen nt
    s_memrealtime s[8:9]
    s_waitcnt vmcnt(8)
    s_waitcnt lgkmcnt(0)
    s_sub_u32 s8, s8, s30
    s_cmpk_ge_u32 s8, 2001
    s_cbranch_scc1 .ap_230
    s_waitcnt vmcnt(5)
    s_cmpk_ge_u32 s8, 1936
    s_cbranch_scc1 .ap_230
    s_waitcnt vmcnt(3)
    s_bitcmp1_b64 s[14:15], 56
    s_cbranch_scc0 1
    s_waitcnt vmcnt(2)
    s_cmpk_ge_u32 s8, 1861
    s_cbranch_scc1 .ap_230
    s_waitcnt vmcnt(1)
.ap_230:
    s_add_u32 s63, s69, 393216
    buffer_load_dwordx4 v[36:39], v2, s[44:47], s63 offen nt
    s_memrealtime s[8:9]
    s_waitcnt vmcnt(8)
    s_waitcnt lgkmcnt(0)
    s_sub_u32 s8, s8, s30
    s_cmpk_ge_u32 s8, 2032
    s_cbranch_scc1 .ap_231
    s_waitcnt vmcnt(5)
    s_cmpk_ge_u32 s8, 1967
    s_cbranch_scc1 .ap_231
    s_waitcnt vmcnt(3)
    s_bitcmp1_b64 s[14:15], 57
    s_cbranch_scc0 1
    s_waitcnt vmcnt(2)
    s_cmpk_ge_u32 s8, 1892
    s_cbranch_scc1 .ap_231
    s_waitcnt vmcnt(1)
.ap_231:
    s_add_u32 s63, s69, 401408
    buffer_load_dwordx4 v[44:47], v2, s[44:47], s63 offen nt
    s_memrealtime s[8:9]
    s_waitcnt vmcnt(8)
    s_waitcnt lgkmcnt(0)
    s_sub_u32 s8, s8, s30
    s_cmpk_ge_u32 s8, 2063
    s_cbranch_scc1 .ap_232
    s_waitcnt vmcnt(5)
    s_cmpk_ge_u32 s8, 1998
    s_cbranch_scc1 .ap_232
    s_waitcnt vmcnt(3)
    s_bitcmp1_b64 s[14:15], 58
    s_cbranch_scc0 1
    s_waitcnt vmcnt(2)
    s_cmpk_ge_u32 s8, 1923
    s_cbranch_scc1 .ap_232
    s_waitcnt vmcnt(1)
.ap_232:
    s_add_u32 s63, s69, 409600
    buffer_load_dwordx4 v[52:55], v2, s[44:47], s63 offen nt
    s_waitcnt vmcnt(5)
    s_branch .gpc_234
.gp_233:
    buffer_load_dwordx4 v[24:27], v9, s[36:39], s59 offen offset:0 sc1
    s_waitcnt vmcnt(0)
.gpc_234:
    v_cmp_eq_u32 vcc, s34, v26
    v_cmp_eq_u32 s[56:57], s34, v27
    s_and_b64 vcc, vcc, s[56:57]
    s_cmp_eq_u64 vcc, exec
    s_nop 2
    s_cbranch_scc1 .gpd_235
    s_sub_u32 s35, s35, 1
    s_cbranch_scc1 .Lexit
    s_sleep 1
    s_branch .gp_233
.gpd_235:
    s_lshr_b64 s[88:89], s[88:89], s1
    s_and_b32 s88, s88, 0xff
    s_cmp_eq_u32 s88, 32
    s_cselect_b32 s0, 0xac000, 0
    v_mov_b32 v16, v24
    s_nop 1
    v_max_f32_dpp v16, v16, v16 quad_perm:[2,3,0,1] row_mask:0xf bank_mask:0xf
    v_sub_f32 v17, v24, v16
    v_sub_f32 v18, v14, v16
    v_mul_f32 v17, 0x3fb8aa3b, v17
    v_mul_f32 v18, 0x3fb8aa3b, v18
    v_exp_f32 v17, v17
    v_exp_f32 v18, v18
    v_mul_f32 v17, v17, v25
    s_nop 1
    v_add_f32_dpp v17, v17, v17 quad_perm:[2,3,0,1] row_mask:0xf bank_mask:0xf
    v_rcp_f32 v19, v17
    s_nop 0
    v_fma_f32 v15, -v17, v19, 1.0
    v_fma_f32 v19, v15, v19, v19
    v_mul_f32 v18, v18, v19
    v_mul_f32 v10, v10, v18
    v_mul_f32 v11, v11, v18
    v_mul_f32 v12, v12, v18
    v_mul_f32 v13, v13, v18
    v_mov_b32_dpp v112, v10 quad_perm:[2,3,0,1] row_mask:0xf bank_mask:0xf
    v_mov_b32_dpp v113, v11 quad_perm:[2,3,0,1] row_mask:0xf bank_mask:0xf
    v_mov_b32_dpp v114, v12 quad_perm:[2,3,0,1] row_mask:0xf bank_mask:0xf
    v_mov_b32_dpp v115, v13 quad_perm:[2,3,0,1] row_mask:0xf bank_mask:0xf
    v_cvt_pk_bf16_f32 v96, v10, v112
    v_cvt_pk_bf16_f32 v100, v11, v113
    v_cvt_pk_bf16_f32 v104, v12, v114
    v_cvt_pk_bf16_f32 v108, v13, v115
    v_mov_b32_dpp v97, v96 row_ror:12 row_mask:0xf bank_mask:0xf
    v_mov_b32_dpp v101, v100 row_ror:12 row_mask:0xf bank_mask:0xf
    v_mov_b32_dpp v105, v104 row_ror:12 row_mask:0xf bank_mask:0xf
    v_mov_b32_dpp v109, v108 row_ror:12 row_mask:0xf bank_mask:0xf
    v_mov_b32_dpp v98, v96 row_ror:8 row_mask:0xf bank_mask:0xf
    v_mov_b32_dpp v102, v100 row_ror:8 row_mask:0xf bank_mask:0xf
    v_mov_b32_dpp v106, v104 row_ror:8 row_mask:0xf bank_mask:0xf
    v_mov_b32_dpp v110, v108 row_ror:8 row_mask:0xf bank_mask:0xf
    v_mov_b32_dpp v99, v96 row_ror:4 row_mask:0xf bank_mask:0xf
    v_mov_b32_dpp v103, v100 row_ror:4 row_mask:0xf bank_mask:0xf
    v_mov_b32_dpp v107, v104 row_ror:4 row_mask:0xf bank_mask:0xf
    v_mov_b32_dpp v111, v108 row_ror:4 row_mask:0xf bank_mask:0xf
    v_mov_b32_dpp v96, v96 row_shr:3 row_mask:0xf bank_mask:0x2
    v_mov_b32_dpp v97, v97 row_shr:3 row_mask:0xf bank_mask:0x2
    v_mov_b32_dpp v98, v98 row_shr:3 row_mask:0xf bank_mask:0x2
    v_mov_b32_dpp v99, v99 row_shr:3 row_mask:0xf bank_mask:0x2
    v_mov_b32_dpp v100, v100 row_shr:3 row_mask:0xf bank_mask:0x2
    v_mov_b32_dpp v101, v101 row_shr:3 row_mask:0xf bank_mask:0x2
    v_mov_b32_dpp v102, v102 row_shr:3 row_mask:0xf bank_mask:0x2
    v_mov_b32_dpp v103, v103 row_shr:3 row_mask:0xf bank_mask:0x2
    v_mov_b32_dpp v104, v104 row_shr:3 row_mask:0xf bank_mask:0x2
    v_mov_b32_dpp v105, v105 row_shr:3 row_mask:0xf bank_mask:0x2
    v_mov_b32_dpp v106, v106 row_shr:3 row_mask:0xf bank_mask:0x2
    v_mov_b32_dpp v107, v107 row_shr:3 row_mask:0xf bank_mask:0x2
    v_mov_b32_dpp v108, v108 row_shr:3 row_mask:0xf bank_mask:0x2
    v_mov_b32_dpp v109, v109 row_shr:3 row_mask:0xf bank_mask:0x2
    v_mov_b32_dpp v110, v110 row_shr:3 row_mask:0xf bank_mask:0x2
    v_mov_b32_dpp v111, v111 row_shr:3 row_mask:0xf bank_mask:0x2
    s_memrealtime s[8:9]
    s_waitcnt lgkmcnt(0)
    s_sub_u32 s8, s8, s30
    s_cmpk_ge_u32 s8, 2094
    s_cbranch_scc1 .ap_236
    s_waitcnt vmcnt(5)
    s_cmpk_ge_u32 s8, 2029
    s_cbranch_scc1 .ap_236
    s_waitcnt vmcnt(3)
    s_bitcmp1_b64 s[14:15], 59
    s_cbranch_scc0 1
    s_waitcnt vmcnt(2)
    s_cmpk_ge_u32 s8, 1954
    s_cbranch_scc1 .ap_236
    s_waitcnt vmcnt(1)
.ap_236:
    s_add_u32 s63, s69, 417792
    buffer_load_dwordx4 v[60:63], v2, s[44:47], s63 offen nt
    s_lshl_b32 s60, s3, 10
    s_add_u32 s60, s60, 132096
    v_lshlrev_b32 v10, 5, v0
    v_add_u32 v10, s60, v10
    v_lshrrev_b32 v11, 5, v0
    v_lshlrev_b32 v11, 13, v11
    v_and_b32 v12, 31, v0
    v_lshl_add_u32 v11, v12, 4, v11
    v_add_u32 v9, 132096, v2
    v_mov_b32 v15, s34
    s_memrealtime s[8:9]
    s_waitcnt lgkmcnt(0)
    s_sub_u32 s8, s8, s30
    s_cmpk_ge_u32 s8, 2125
    s_cbranch_scc1 .ap_237
    s_waitcnt vmcnt(5)
    s_cmpk_ge_u32 s8, 2060
    s_cbranch_scc1 .ap_237
    s_waitcnt vmcnt(3)
    s_bitcmp1_b64 s[14:15], 60
    s_cbranch_scc0 1
    s_waitcnt vmcnt(2)
    s_cmpk_ge_u32 s8, 1985
    s_cbranch_scc1 .ap_237
    s_waitcnt vmcnt(1)
.ap_237:
    s_add_u32 s63, s69, 425984
    buffer_load_dwordx4 v[68:71], v2, s[44:47], s63 offen nt
    v_perm_b32 v112, v164, v160, s94
    v_perm_b32 v113, v172, v168, s94
    v_perm_b32 v114, v180, v176, s94
    v_perm_b32 v115, v188, v184, s94
    s_nop 1
    v_mfma_f32_16x16x32_bf16 v[128:131], v[96:99], v[112:115], 0
    v_perm_b32 v116, v164, v160, s95
    v_perm_b32 v117, v172, v168, s95
    v_perm_b32 v118, v180, v176, s95
    v_perm_b32 v119, v188, v184, s95
    s_nop 1
    v_mfma_f32_16x16x32_bf16 v[132:135], v[96:99], v[116:119], 0
    v_perm_b32 v120, v165, v161, s94
    v_perm_b32 v121, v173, v169, s94
    v_perm_b32 v122, v181, v177, s94
    v_perm_b32 v123, v189, v185, s94
    s_nop 1
    v_mfma_f32_16x16x32_bf16 v[136:139], v[96:99], v[120:123], 0
    v_perm_b32 v124, v165, v161, s95
    v_perm_b32 v125, v173, v169, s95
    v_perm_b32 v126, v181, v177, s95
    v_perm_b32 v127, v189, v185, s95
    s_nop 1
    v_mfma_f32_16x16x32_bf16 v[140:143], v[96:99], v[124:127], 0
    v_perm_b32 v112, v166, v162, s94
    v_perm_b32 v113, v174, v170, s94
    v_perm_b32 v114, v182, v178, s94
    v_perm_b32 v115, v190, v186, s94
    s_nop 1
    v_mfma_f32_16x16x32_bf16 v[144:147], v[96:99], v[112:115], 0
    v_perm_b32 v116, v166, v162, s95
    v_perm_b32 v117, v174, v170, s95
    v_perm_b32 v118, v182, v178, s95
    v_perm_b32 v119, v190, v186, s95
    s_nop 1
    v_mfma_f32_16x16x32_bf16 v[148:151], v[96:99], v[116:119], 0
    v_perm_b32 v120, v167, v163, s94
    v_perm_b32 v121, v175, v171, s94
    v_perm_b32 v122, v183, v179, s94
    v_perm_b32 v123, v191, v187, s94
    s_nop 1
    v_mfma_f32_16x16x32_bf16 v[152:155], v[96:99], v[120:123], 0
    v_perm_b32 v124, v167, v163, s95
    v_perm_b32 v125, v175, v171, s95
    v_perm_b32 v126, v183, v179, s95
    v_perm_b32 v127, v191, v187, s95
    s_nop 1
    v_mfma_f32_16x16x32_bf16 v[156:159], v[96:99], v[124:127], 0
    s_memrealtime s[8:9]
    s_waitcnt lgkmcnt(0)
    s_sub_u32 s8, s8, s30
    s_cmpk_ge_u32 s8, 2156
    s_nop 3
    s_cbranch_scc1 .ap_238
    s_waitcnt vmcnt(5)
    s_cmpk_ge_u32 s8, 2091
    s_cbranch_scc1 .ap_238
    s_waitcnt vmcnt(3)
    s_bitcmp1_b64 s[14:15], 61
    s_cbranch_scc0 1
    s_waitcnt vmcnt(2)
    s_cmpk_ge_u32 s8, 2016
    s_cbranch_scc1 .ap_238
    s_waitcnt vmcnt(1)
.ap_238:
    s_add_u32 s63, s69, 434176
    buffer_load_dwordx4 v[76:79], v2, s[44:47], s63 offen nt
    v_perm_b32 v112, v196, v192, s94
    v_perm_b32 v113, v204, v200, s94
    v_perm_b32 v114, v212, v208, s94
    v_perm_b32 v115, v220, v216, s94
    s_nop 1
    v_mfma_f32_16x16x32_bf16 v[128:131], v[100:103], v[112:115], v[128:131]
    v_perm_b32 v116, v196, v192, s95
    v_perm_b32 v117, v204, v200, s95
    v_perm_b32 v118, v212, v208, s95
    v_perm_b32 v119, v220, v216, s95
    s_nop 1
    v_mfma_f32_16x16x32_bf16 v[132:135], v[100:103], v[116:119], v[132:135]
    v_perm_b32 v120, v197, v193, s94
    v_perm_b32 v121, v205, v201, s94
    v_perm_b32 v122, v213, v209, s94
    v_perm_b32 v123, v221, v217, s94
    s_nop 1
    v_mfma_f32_16x16x32_bf16 v[136:139], v[100:103], v[120:123], v[136:139]
    v_perm_b32 v124, v197, v193, s95
    v_perm_b32 v125, v205, v201, s95
    v_perm_b32 v126, v213, v209, s95
    v_perm_b32 v127, v221, v217, s95
    s_nop 1
    v_mfma_f32_16x16x32_bf16 v[140:143], v[100:103], v[124:127], v[140:143]
    v_perm_b32 v112, v198, v194, s94
    v_perm_b32 v113, v206, v202, s94
    v_perm_b32 v114, v214, v210, s94
    v_perm_b32 v115, v222, v218, s94
    s_nop 1
    v_mfma_f32_16x16x32_bf16 v[144:147], v[100:103], v[112:115], v[144:147]
    v_perm_b32 v116, v198, v194, s95
    v_perm_b32 v117, v206, v202, s95
    v_perm_b32 v118, v214, v210, s95
    v_perm_b32 v119, v222, v218, s95
    s_nop 1
    v_mfma_f32_16x16x32_bf16 v[148:151], v[100:103], v[116:119], v[148:151]
    v_perm_b32 v120, v199, v195, s94
    v_perm_b32 v121, v207, v203, s94
    v_perm_b32 v122, v215, v211, s94
    v_perm_b32 v123, v223, v219, s94
    s_nop 1
    v_mfma_f32_16x16x32_bf16 v[152:155], v[100:103], v[120:123], v[152:155]
    v_perm_b32 v124, v199, v195, s95
    v_perm_b32 v125, v207, v203, s95
    v_perm_b32 v126, v215, v211, s95
    v_perm_b32 v127, v223, v219, s95
    s_nop 1
    v_mfma_f32_16x16x32_bf16 v[156:159], v[100:103], v[124:127], v[156:159]
    s_memrealtime s[8:9]
    s_waitcnt lgkmcnt(0)
    s_sub_u32 s8, s8, s30
    s_cmpk_ge_u32 s8, 2187
    s_nop 3
    s_cbranch_scc1 .ap_239
    s_waitcnt vmcnt(5)
    s_cmpk_ge_u32 s8, 2122
    s_cbranch_scc1 .ap_239
    s_waitcnt vmcnt(3)
    s_bitcmp1_b64 s[14:15], 62
    s_cbranch_scc0 1
    s_waitcnt vmcnt(2)
    s_cmpk_ge_u32 s8, 2047
    s_cbranch_scc1 .ap_239
    s_waitcnt vmcnt(1)
.ap_239:
    s_add_u32 s63, s69, 442368
    buffer_load_dwordx4 v[84:87], v2, s[44:47], s63 offen nt
    s_waitcnt vmcnt(7)
    v_perm_b32 v112, v228, v224, s94
    v_perm_b32 v113, v236, v232, s94
    v_perm_b32 v114, v244, v240, s94
    v_perm_b32 v115, v252, v248, s94
    s_nop 1
    v_mfma_f32_16x16x32_bf16 v[128:131], v[104:107], v[112:115], v[128:131]
    v_perm_b32 v116, v228, v224, s95
    v_perm_b32 v117, v236, v232, s95
    v_perm_b32 v118, v244, v240, s95
    v_perm_b32 v119, v252, v248, s95
    s_nop 1
    v_mfma_f32_16x16x32_bf16 v[132:135], v[104:107], v[116:119], v[132:135]
    v_perm_b32 v120, v229, v225, s94
    v_perm_b32 v121, v237, v233, s94
    v_perm_b32 v122, v245, v241, s94
    v_perm_b32 v123, v253, v249, s94
    s_nop 1
    v_mfma_f32_16x16x32_bf16 v[136:139], v[104:107], v[120:123], v[136:139]
    v_perm_b32 v124, v229, v225, s95
    v_perm_b32 v125, v237, v233, s95
    v_perm_b32 v126, v245, v241, s95
    v_perm_b32 v127, v253, v249, s95
    s_nop 1
    v_mfma_f32_16x16x32_bf16 v[140:143], v[104:107], v[124:127], v[140:143]
    v_perm_b32 v112, v230, v226, s94
    v_perm_b32 v113, v238, v234, s94
    v_perm_b32 v114, v246, v242, s94
    v_perm_b32 v115, v254, v250, s94
    s_nop 1
    v_mfma_f32_16x16x32_bf16 v[144:147], v[104:107], v[112:115], v[144:147]
    v_perm_b32 v116, v230, v226, s95
    v_perm_b32 v117, v238, v234, s95
    v_perm_b32 v118, v246, v242, s95
    v_perm_b32 v119, v254, v250, s95
    s_nop 1
    v_mfma_f32_16x16x32_bf16 v[148:151], v[104:107], v[116:119], v[148:151]
    v_perm_b32 v120, v231, v227, s94
    v_perm_b32 v121, v239, v235, s94
    v_perm_b32 v122, v247, v243, s94
    v_perm_b32 v123, v255, v251, s94
    s_nop 1
    v_mfma_f32_16x16x32_bf16 v[152:155], v[104:107], v[120:123], v[152:155]
    v_perm_b32 v124, v231, v227, s95
    v_perm_b32 v125, v239, v235, s95
    v_perm_b32 v126, v247, v243, s95
    v_perm_b32 v127, v255, v251, s95
    s_nop 1
    v_mfma_f32_16x16x32_bf16 v[156:159], v[104:107], v[124:127], v[156:159]
    s_memrealtime s[8:9]
    s_waitcnt lgkmcnt(0)
    s_sub_u32 s8, s8, s30
    s_cmpk_ge_u32 s8, 2218
    s_nop 3
    s_cbranch_scc1 .ap_240
    s_waitcnt vmcnt(5)
    s_cmpk_ge_u32 s8, 2153
    s_cbranch_scc1 .ap_240
    s_waitcnt vmcnt(3)
    s_bitcmp1_b64 s[14:15], 63
    s_cbranch_scc0 1
    s_waitcnt vmcnt(2)
    s_cmpk_ge_u32 s8, 2078
    s_cbranch_scc1 .ap_240
    s_waitcnt vmcnt(1)
.ap_240:
    s_add_u32 s63, s69, 450560
    buffer_load_dwordx4 v[92:95], v2, s[44:47], s63 offen nt
    s_setprio 0
    s_waitcnt vmcnt(6)
    v_perm_b32 v160, v44, v36, s94
    v_perm_b32 v164, v44, v36, s95
    v_perm_b32 v168, v45, v37, s94
    v_perm_b32 v172, v45, v37, s95
    v_perm_b32 v176, v46, v38, s94
    v_perm_b32 v180, v46, v38, s95
    v_perm_b32 v184, v47, v39, s94
    v_perm_b32 v188, v47, v39, s95
    s_waitcnt vmcnt(4)
    v_perm_b32 v161, v60, v52, s94
    v_perm_b32 v165, v60, v52, s95
    v_perm_b32 v169, v61, v53, s94
    v_perm_b32 v173, v61, v53, s95
    v_perm_b32 v177, v62, v54, s94
    v_perm_b32 v181, v62, v54, s95
    v_perm_b32 v185, v63, v55, s94
    v_perm_b32 v189, v63, v55, s95
    v_mfma_f32_16x16x16_bf16 v[128:131], v[108:109], v[160:161], v[128:131]
    v_mfma_f32_16x16x16_bf16 v[132:135], v[108:109], v[164:165], v[132:135]
    v_mfma_f32_16x16x16_bf16 v[136:139], v[108:109], v[168:169], v[136:139]
    v_mfma_f32_16x16x16_bf16 v[140:143], v[108:109], v[172:173], v[140:143]
    v_mfma_f32_16x16x16_bf16 v[144:147], v[108:109], v[176:177], v[144:147]
    v_mfma_f32_16x16x16_bf16 v[148:151], v[108:109], v[180:181], v[148:151]
    v_mfma_f32_16x16x16_bf16 v[152:155], v[108:109], v[184:185], v[152:155]
    v_mfma_f32_16x16x16_bf16 v[156:159], v[108:109], v[188:189], v[156:159]
    s_waitcnt vmcnt(2)
    v_perm_b32 v162, v76, v68, s94
    v_perm_b32 v166, v76, v68, s95
    v_perm_b32 v170, v77, v69, s94
    v_perm_b32 v174, v77, v69, s95
    v_perm_b32 v178, v78, v70, s94
    v_perm_b32 v182, v78, v70, s95
    v_perm_b32 v186, v79, v71, s94
    v_perm_b32 v190, v79, v71, s95
    s_lshl4_add_u32 s59, s67, s66
    s_lshl1_add_u32 s59, s59, s68
    s_lshl_b32 s59, s59, 9
    s_add_u32 s59, s59, 0x210000
    s_mov_b32 s60, 0x07060503
    s_mov_b32 s61, 0x07060502
    s_mov_b32 s62, 0x07060501
.Ltail_n:
    s_waitcnt vmcnt(0)
    v_perm_b32 v163, v92, v84, s94
    v_perm_b32 v167, v92, v84, s95
    v_perm_b32 v171, v93, v85, s94
    v_perm_b32 v175, v93, v85, s95
    v_perm_b32 v179, v94, v86, s94
    v_perm_b32 v183, v94, v86, s95
    v_perm_b32 v187, v95, v87, s94
    v_perm_b32 v191, v95, v87, s95
    v_mfma_f32_16x16x16_bf16 v[128:131], v[110:111], v[162:163], v[128:131]
    v_mfma_f32_16x16x16_bf16 v[132:135], v[110:111], v[166:167], v[132:135]
    v_mfma_f32_16x16x16_bf16 v[136:139], v[110:111], v[170:171], v[136:139]
    v_mfma_f32_16x16x16_bf16 v[140:143], v[110:111], v[174:175], v[140:143]
    v_mfma_f32_16x16x16_bf16 v[144:147], v[110:111], v[178:179], v[144:147]
    v_mfma_f32_16x16x16_bf16 v[148:151], v[110:111], v[182:183], v[148:151]
    v_mfma_f32_16x16x16_bf16 v[152:155], v[110:111], v[186:187], v[152:155]
    v_mfma_f32_16x16x16_bf16 v[156:159], v[110:111], v[190:191], v[156:159]
    s_nop 1
    s_mov_b64 exec, 0xffffffff
    ds_write2_b32 v10, v128, v132 offset0:0 offset1:1
    ds_write2_b32 v10, v136, v140 offset0:2 offset1:3
    s_nop 0
    ds_write2_b32 v10, v144, v148 offset0:4 offset1:5
    s_nop 0
    ds_write2_b32 v10, v152, v156 offset0:6 offset1:7
    s_mov_b64 exec, -1
    s_waitcnt lgkmcnt(0)
    s_barrier
    s_cmp_lg_u32 s3, 7
    s_cbranch_scc1 .opub_241
    ds_read_b128 v[196:199], v9 offset:0
    ds_read_b128 v[200:203], v9 offset:1024
    ds_read_b128 v[204:207], v9 offset:2048
    ds_read_b128 v[208:211], v9 offset:3072
    ds_read_b128 v[212:215], v9 offset:4096
    ds_read_b128 v[216:219], v9 offset:5120
    ds_read_b128 v[220:223], v9 offset:6144
    ds_read_b128 v[224:227], v9 offset:7168
    s_waitcnt lgkmcnt(6)
    v_pk_add_f32 v[196:197], v[196:197], v[200:201]
    v_pk_add_f32 v[198:199], v[198:199], v[202:203]
    s_waitcnt lgkmcnt(4)
    v_pk_add_f32 v[204:205], v[204:205], v[208:209]
    v_pk_add_f32 v[206:207], v[206:207], v[210:211]
    v_pk_add_f32 v[196:197], v[196:197], v[204:205]
    v_pk_add_f32 v[198:199], v[198:199], v[206:207]
    s_waitcnt lgkmcnt(2)
    v_pk_add_f32 v[212:213], v[212:213], v[216:217]
    v_pk_add_f32 v[214:215], v[214:215], v[218:219]
    s_waitcnt lgkmcnt(0)
    v_pk_add_f32 v[220:221], v[220:221], v[224:225]
    v_pk_add_f32 v[222:223], v[222:223], v[226:227]
    v_pk_add_f32 v[212:213], v[212:213], v[220:221]
    v_pk_add_f32 v[214:215], v[214:215], v[222:223]
    v_pk_add_f32 v[196:197], v[196:197], v[212:213]
    v_pk_add_f32 v[198:199], v[198:199], v[214:215]
    v_perm_b32 v12, v196, v199, s60
    v_perm_b32 v13, v197, v199, s61
    v_perm_b32 v14, v198, v199, s62
    s_add_u32 s57, s59, 0xac000
    buffer_store_dwordx4 v[12:15], v11, s[36:39], s57 offen
    buffer_store_dwordx4 v[12:15], v11, s[36:39], s59 offen sc1
.opub_241:
.Lexit:
.Lend:
s_endpgm
.section .rodata,"a"
.p2align 6
.amdhsa_kernel adaLN_cond__sliding_block_cached__moe_arch_mod__decode_kernel
  .amdhsa_next_free_vgpr 256
  .amdhsa_next_free_sgpr 102
  .amdhsa_accum_offset 256
  .amdhsa_group_segment_fixed_size 0
  .amdhsa_kernarg_size 120
  .amdhsa_user_sgpr_count 2
  .amdhsa_user_sgpr_kernarg_segment_ptr 1
  .amdhsa_system_sgpr_workgroup_id_x 1
.end_amdhsa_kernel
```

```asm
; @launch grid=(256,1,1) block=(512,1,1) lds=159360
.amdgcn_target "amdgcn-amd-amdhsa--gfx950"
.text
.globl adaLN_cond__sliding_block_cached__moe_arch_mod__decode_kernel
.p2align 8
.type adaLN_cond__sliding_block_cached__moe_arch_mod__decode_kernel,@function
adaLN_cond__sliding_block_cached__moe_arch_mod__decode_kernel:
    s_cmp_ge_u32 s2, 256
    s_cbranch_scc1 .Lend
    s_load_dwordx16 s[4:19], s[0:1], 0
    s_load_dwordx8 s[20:27], s[0:1], 64
    s_load_dwordx4 s[28:31], s[0:1], 96
    s_load_dwordx2 s[32:33], s[0:1], 112
    s_memrealtime s[70:71]
    v_lshrrev_b32 v1, 6, v0
    v_and_b32 v0, 63, v0
    v_readfirstlane_b32 s3, v1
    s_mov_b32 s35, 0x3ffff
    s_mov_b32 s98, 0xbfb8aa3b
    s_mov_b32 s94, 0x05040100
    s_mov_b32 s95, 0x07060302
    s_mov_b32 s96, 0xaaaaaaaa
    s_mov_b32 s97, 0xaaaaaaaa
    s_and_b32 s64, s2, 7
    s_lshr_b32 s65, s2, 3
    s_and_b32 s66, s65, 7
    s_lshr_b32 s67, s2, 7
    s_lshl1_add_u32 s67, s64, s67
    s_bfe_u32 s68, s2, 0x10006
    s_lshl4_add_u32 s69, s66, s67
    s_lshl_b32 s69, s69, 21
    s_lshl_b32 s56, s68, 16
    s_add_u32 s69, s69, s56
    s_lshl_b32 s56, s3, 10
    s_add_u32 s69, s69, s56
    s_add_u32 s69, s69, 0x180000
    v_bfe_u32 v1, v0, 2, 2
    v_lshrrev_b32 v2, 4, v0
    v_lshl_add_u32 v1, v1, 2, v2
    v_and_b32 v2, 3, v0
    v_lshl_add_u32 v1, v1, 2, v2
    v_lshlrev_b32 v1, 4, v1
    v_lshlrev_b32 v2, 4, v0
    v_lshlrev_b32 v3, 3, v0
    v_and_b32 v4, 31, v0
    v_lshlrev_b32 v4, 2, v4
    v_add_u32 v4, 1024, v4
    v_lshlrev_b32 v5, 1, v4
    s_waitcnt lgkmcnt(0)
    s_load_dword s34, s[32:33], 0
    s_sub_u32 s99, s2, 216
    s_cmp_ge_u32 s99, 18
    s_cbranch_scc1 .Lmcf_no
    s_mul_i32 s58, s3, 1152
    s_mov_b32 s52, s24
    s_and_b32 s53, s25, 0xffff
    s_mov_b32 s54, 0x2400
    s_mov_b32 s55, 0x00020000
    buffer_load_dwordx2 v[246:247], v3, s[52:55], s58 offen
    buffer_load_dwordx2 v[248:249], v3, s[52:55], s58 offen offset:512
    buffer_load_dword v250, v4, s[52:55], s58 offen
    s_mov_b32 s48, s26
    s_and_b32 s49, s27, 0xffff
    s_mov_b32 s50, 0x3cc000
    s_mov_b32 s51, 0x00020000
    v_bfe_u32 v12, v0, 4, 1
    s_and_b32 s56, s3, 3
    s_lshl_b32 s56, s56, 1
    v_or_b32 v12, s56, v12
    v_and_b32 v19, 7, v0
    v_xor_b32 v12, v12, v19
    v_lshrrev_b32 v19, 3, v0
    v_mul_u32_u24 v19, 6912, v19
    v_lshl_add_u32 v19, v12, 4, v19
    s_mul_i32 s57, s3, 55296
    s_lshl_b32 s59, s99, 7
    s_add_u32 s57, s57, s59
    s_lshl_b32 s100, s3, 10
    s_add_u32 m0, s100, 0
    s_add_u32 s56, s57, 0
    buffer_load_dwordx4 v19, s[48:51], s56 offen nt lds
    s_add_u32 m0, s100, 8192
    s_add_u32 s56, s57, 442368
    buffer_load_dwordx4 v19, s[48:51], s56 offen nt lds
    s_add_u32 m0, s100, 16384
    s_add_u32 s56, s57, 884736
    buffer_load_dwordx4 v19, s[48:51], s56 offen nt lds
    s_add_u32 m0, s100, 24576
    s_add_u32 s56, s57, 1327104
    buffer_load_dwordx4 v19, s[48:51], s56 offen nt lds
    s_add_u32 m0, s100, 32768
    s_add_u32 s56, s57, 1769472
    buffer_load_dwordx4 v19, s[48:51], s56 offen nt lds
    s_add_u32 m0, s100, 40960
    s_add_u32 s56, s57, 2211840
    buffer_load_dwordx4 v19, s[48:51], s56 offen nt lds
    s_add_u32 m0, s100, 49152
    s_add_u32 s56, s57, 2654208
    buffer_load_dwordx4 v19, s[48:51], s56 offen nt lds
    s_add_u32 m0, s100, 57344
    s_add_u32 s56, s57, 3096576
    buffer_load_dwordx4 v19, s[48:51], s56 offen nt lds
    s_add_u32 m0, s100, 65536
    s_add_u32 s56, s57, 3538944
    buffer_load_dwordx4 v19, s[48:51], s56 offen nt lds
.Lmcf_no:
    s_mov_b32 s40, s6
    s_and_b32 s41, s7, 0xffff
    s_mov_b32 s42, 0x10000000
    s_mov_b32 s43, 0x00020000
    s_add_u32 s63, s69, 0
    buffer_load_dwordx4 v[32:35], v1, s[40:43], s63 offen nt
    s_add_u32 s63, s69, 8192
    buffer_load_dwordx4 v[36:39], v1, s[40:43], s63 offen nt
    s_add_u32 s63, s69, 16384
    buffer_load_dwordx4 v[64:67], v1, s[40:43], s63 offen nt
    s_add_u32 s63, s69, 24576
    buffer_load_dwordx4 v[68:71], v1, s[40:43], s63 offen nt
    s_mov_b32 s44, s8
    s_and_b32 s45, s9, 0xffff
    s_mov_b32 s46, 0x10000000
    s_mov_b32 s47, 0x00020000
    s_mov_b32 s36, s32
    s_and_b32 s37, s33, 0xffff
    s_mov_b32 s38, 0x40000000
    s_mov_b32 s39, 0x00020000
    s_lshl3_add_u32 s56, s3, s2
    s_cmp_lt_u32 s56, 8
    s_cbranch_scc0 .Let_no
    s_lshl_b32 s56, s2, 7
    s_add_u32 s56, s56, 0x400
    v_mov_b32 v7, s70
    s_mov_b64 exec, 1
    buffer_store_dword v7, v2, s[36:39], s56 offen sc1
    s_mov_b64 exec, -1
.Let_no:
    s_mov_b32 s52, s30
    s_and_b32 s53, s31, 0xffff
    s_mov_b32 s54, 0x100
    s_mov_b32 s55, 0x00020000
    s_mov_b64 s[6:7], s[30:31]
    s_getreg_b32 s1, hwreg(HW_REG_XCC_ID)
    s_and_b32 s1, s1, 7
    s_lshl_b32 s1, s1, 3
    s_lshl_b32 s0, s64, 5
    s_cmp_lg_u32 s3, 0
    s_cbranch_scc1 .Lxa_no
    s_lshl_b64 s[56:57], 1, s1
    v_mov_b32 v8, s56
    v_mov_b32 v9, s57
    s_mov_b64 exec, 1
    buffer_atomic_add_x2 v[8:9], v2, s[52:55], s0 offen sc1
    v_mov_b32 v8, 0
    v_mov_b32 v9, 159232
    ds_write_b32 v9, v8
    s_waitcnt lgkmcnt(0)
    s_mov_b64 exec, -1
.Lxa_no:
    s_barrier
    s_cmp_lt_u32 s3, 4
    s_cbranch_scc1 1
    s_setprio 1
.Lresume:
    s_cmp_lt_u32 s65, 9
    s_cbranch_scc1 .Le_a
    s_sub_u32 s56, 3, s64
    s_and_b32 s56, s56, 7
    s_lshl1_add_u32 s56, s56, 9
    s_sub_u32 s56, s65, s56
    s_cselect_b32 s57, 18, 0
    s_add_u32 s56, s56, s57
    s_sub_u32 s101, s56, 2
    s_cmp_ge_u32 s56, 5
    s_addc_u32 s101, s101, 0
    s_sub_u32 s99, s56, 5
    s_min_u32 s99, s99, 7
    s_cmp_lt_u32 s65, 27
    s_cbranch_scc1 .Lrole_bc
    s_mov_b32 s101, 3
    s_sub_u32 s99, s65, 27
    s_cmp_ge_u32 s65, 31
    s_cselect_b32 s56, 2, 9
.Lrole_bc:
    s_lshl3_add_u32 s99, s99, s64
    s_sub_u32 s56, s56, 2
    s_cmp_lt_u32 s56, 7
    s_cbranch_scc1 .Le_q
    s_cmp_lt_u32 s99, 18
    s_cbranch_scc1 .Le_mc
    s_cmp_lt_u32 s99, 54
    s_mov_b32 s14, 0xfdff7fdf
    s_cselect_b32 s14, 0x6b5ad6b5, s14
    s_mov_b32 s15, 0xff7fdff7
    s_cselect_b32 s15, 0x5ad6b5ad, s15
    s_cselect_b32 s30, -30, 0
    s_add_u32 s30, s30, 0
    s_add_u32 s30, s30, s70
    s_sub_u32 s56, s65, 9
    s_lshr_b32 s56, s56, 1
    s_add_u32 s56, s56, s64
    s_and_b32 s56, s56, 7
    s_cmp_eq_u32 s56, 3
    s_cselect_b32 s56, -30, 0
    s_cmp_lt_u32 s99, 54
    s_cselect_b32 s56, 0, s56
    s_add_u32 s30, s30, s56
    s_waitcnt vmcnt(3)
    s_bitcmp1_b64 s[14:15], 4
    s_cbranch_scc0 1
    s_waitcnt vmcnt(2)
    s_add_u32 s63, s69, 32768
    buffer_load_dwordx4 v[96:99], v1, s[40:43], s63 offen nt
    s_memrealtime s[8:9]
    s_waitcnt lgkmcnt(0)
    s_sub_u32 s8, s8, s30
    s_cmpk_ge_u32 s8, 290
    s_cbranch_scc1 .ap_1
    s_waitcnt vmcnt(4)
    s_cmpk_ge_u32 s8, 225
    s_cbranch_scc1 .ap_1
    s_waitcnt vmcnt(3)
    s_bitcmp1_b64 s[14:15], 5
    s_cbranch_scc0 1
    s_waitcnt vmcnt(2)
    s_cmpk_ge_u32 s8, 150
    s_cbranch_scc1 .ap_1
    s_waitcnt vmcnt(1)
.ap_1:
    s_add_u32 s63, s69, 40960
    buffer_load_dwordx4 v[100:103], v1, s[40:43], s63 offen nt
    s_memrealtime s[8:9]
    s_waitcnt lgkmcnt(0)
    s_sub_u32 s8, s8, s30
    s_cmpk_ge_u32 s8, 315
    s_cbranch_scc1 .ap_2
    s_waitcnt vmcnt(5)
    s_cmpk_ge_u32 s8, 250
    s_cbranch_scc1 .ap_2
    s_waitcnt vmcnt(3)
    s_bitcmp1_b64 s[14:15], 6
    s_cbranch_scc0 1
    s_waitcnt vmcnt(2)
    s_cmpk_ge_u32 s8, 175
    s_cbranch_scc1 .ap_2
    s_waitcnt vmcnt(1)
.ap_2:
    s_add_u32 s63, s69, 49152
    buffer_load_dwordx4 v[128:131], v1, s[40:43], s63 offen nt
    s_memrealtime s[8:9]
    s_waitcnt lgkmcnt(0)
    s_sub_u32 s8, s8, s30
    s_cmpk_ge_u32 s8, 340
    s_cbranch_scc1 .ap_3
    s_waitcnt vmcnt(5)
    s_cmpk_ge_u32 s8, 275
    s_cbranch_scc1 .ap_3
    s_waitcnt vmcnt(3)
    s_bitcmp1_b64 s[14:15], 7
    s_cbranch_scc0 1
    s_waitcnt vmcnt(2)
    s_cmpk_ge_u32 s8, 200
    s_cbranch_scc1 .ap_3
    s_waitcnt vmcnt(1)
.ap_3:
    s_add_u32 s63, s69, 57344
    buffer_load_dwordx4 v[132:135], v1, s[40:43], s63 offen nt
    s_memrealtime s[8:9]
    s_waitcnt lgkmcnt(0)
    s_sub_u32 s8, s8, s30
    s_cmpk_ge_u32 s8, 365
    s_cbranch_scc1 .ap_4
    s_waitcnt vmcnt(5)
    s_cmpk_ge_u32 s8, 300
    s_cbranch_scc1 .ap_4
    s_waitcnt vmcnt(3)
    s_bitcmp1_b64 s[14:15], 8
    s_cbranch_scc0 1
    s_waitcnt vmcnt(2)
    s_cmpk_ge_u32 s8, 225
    s_cbranch_scc1 .ap_4
    s_waitcnt vmcnt(1)
.ap_4:
    s_add_u32 s63, s69, 131072
    buffer_load_dwordx4 v[40:43], v1, s[40:43], s63 offen nt
    s_memrealtime s[8:9]
    s_waitcnt lgkmcnt(0)
    s_sub_u32 s8, s8, s30
    s_cmpk_ge_u32 s8, 390
    s_cbranch_scc1 .ap_5
    s_waitcnt vmcnt(5)
    s_cmpk_ge_u32 s8, 325
    s_cbranch_scc1 .ap_5
    s_waitcnt vmcnt(3)
    s_bitcmp1_b64 s[14:15], 9
    s_cbranch_scc0 1
    s_waitcnt vmcnt(2)
    s_cmpk_ge_u32 s8, 250
    s_cbranch_scc1 .ap_5
    s_waitcnt vmcnt(1)
.ap_5:
    s_add_u32 s63, s69, 139264
    buffer_load_dwordx4 v[44:47], v1, s[40:43], s63 offen nt
    s_waitcnt lgkmcnt(0)
    s_mul_i32 s34, s34, 0x9e3779b1
    s_add_u32 s34, s34, 0x7f4a7c15
    s_cmp_lt_u32 s99, 54
    s_cbranch_scc1 .Le_mr
    s_sub_u32 s57, s65, 9
    s_bitcmp1_b32 s57, 0
    s_cselect_b32 s48, s20, s18
    s_cselect_b32 s49, s21, s19
    s_cselect_b32 s33, 36, 0
    s_and_b32 s49, s49, 0xffff
    s_mov_b32 s50, 0x510000
    s_mov_b32 s51, 0x00020000
    s_mov_b32 s52, s22
    s_and_b32 s53, s23, 0xffff
    s_mov_b32 s54, 0x510000
    s_mov_b32 s55, 0x00020000
    s_lshr_b32 s57, s57, 1
    s_lshl_b32 s57, s57, 7
    s_mul_i32 s101, s64, 1152
    s_add_u32 s101, s101, s57
    s_mul_i32 s56, s3, 73728
    s_add_u32 s101, s101, s56
    s_mul_i32 s56, s64, 72
    s_add_u32 s33, s33, s56
    s_add_u32 s33, s33, s3
    s_mul_i32 s33, s33, 9216
    s_add_u32 s33, s33, s57
    s_bfe_u32 s56, s101, 0x30007
    s_cmp_eq_u32 s56, 3
    s_cselect_b32 s100, 1, 0
    v_bfe_u32 v12, v0, 4, 1
    s_and_b32 s56, s3, 3
    s_lshl_b32 s56, s56, 1
    v_or_b32 v12, s56, v12
    v_and_b32 v6, 7, v0
    v_xor_b32 v12, v12, v6
    v_lshrrev_b32 v6, 3, v0
    v_mul_u32_u24 v6, 9216, v6
    v_lshl_add_u32 v6, v12, 4, v6
    v_bfe_u32 v12, v0, 4, 1
    s_and_b32 s56, s3, 1
    s_lshl_b32 s56, s56, 2
    v_lshl_or_b32 v12, v12, 1, s56
    v_and_b32 v13, 7, v0
    v_xor_b32 v12, v12, v13
    v_lshrrev_b32 v13, 3, v0
    v_mul_u32_u24 v13, 1152, v13
    v_lshl_add_u32 v31, v12, 4, v13
    s_lshl_b32 s32, s3, 10
    s_memrealtime s[8:9]
    s_waitcnt vmcnt(8)
    s_waitcnt lgkmcnt(0)
    s_sub_u32 s8, s8, s30
    s_cmpk_ge_u32 s8, 436
    s_cbranch_scc1 .ap_6
    s_waitcnt vmcnt(5)
    s_cmpk_ge_u32 s8, 371
    s_cbranch_scc1 .ap_6
    s_waitcnt vmcnt(3)
    s_bitcmp1_b64 s[14:15], 10
    s_cbranch_scc0 1
    s_waitcnt vmcnt(2)
    s_cmpk_ge_u32 s8, 296
    s_cbranch_scc1 .ap_6
    s_waitcnt vmcnt(1)
.ap_6:
    s_add_u32 s63, s69, 147456
    buffer_load_dwordx4 v[72:75], v1, s[40:43], s63 offen nt
    s_cmp_eq_u32 s100, 0
    s_cbranch_scc1 .ls_7
    s_add_u32 m0, s32, 0
    s_add_u32 s56, s101, 0
    buffer_load_dwordx4 v6, s[48:51], s56 offen nt lds
.ls_7:
    s_memrealtime s[8:9]
    s_waitcnt vmcnt(8)
    s_waitcnt lgkmcnt(0)
    s_sub_u32 s8, s8, s30
    s_cmpk_ge_u32 s8, 482
    s_cbranch_scc1 .ap_8
    s_waitcnt vmcnt(5)
    s_cmpk_ge_u32 s8, 417
    s_cbranch_scc1 .ap_8
    s_waitcnt vmcnt(3)
    s_bitcmp1_b64 s[14:15], 11
    s_cbranch_scc0 1
    s_waitcnt vmcnt(2)
    s_cmpk_ge_u32 s8, 342
    s_cbranch_scc1 .ap_8
    s_waitcnt vmcnt(1)
.ap_8:
    s_add_u32 s63, s69, 155648
    buffer_load_dwordx4 v[76:79], v1, s[40:43], s63 offen nt
    s_memrealtime s[8:9]
    s_waitcnt vmcnt(8)
    s_waitcnt lgkmcnt(0)
    s_sub_u32 s8, s8, s30
    s_cmpk_ge_u32 s8, 528
    s_cbranch_scc1 .ap_9
    s_waitcnt vmcnt(5)
    s_cmpk_ge_u32 s8, 463
    s_cbranch_scc1 .ap_9
    s_waitcnt vmcnt(3)
    s_bitcmp1_b64 s[14:15], 12
    s_cbranch_scc0 1
    s_waitcnt vmcnt(2)
    s_cmpk_ge_u32 s8, 388
    s_cbranch_scc1 .ap_9
    s_waitcnt vmcnt(1)
.ap_9:
    s_add_u32 s63, s69, 163840
    buffer_load_dwordx4 v[104:107], v1, s[40:43], s63 offen nt
    s_memrealtime s[8:9]
    s_waitcnt vmcnt(8)
    s_waitcnt lgkmcnt(0)
    s_sub_u32 s8, s8, s30
    s_cmpk_ge_u32 s8, 574
    s_cbranch_scc1 .ap_10
    s_waitcnt vmcnt(5)
    s_cmpk_ge_u32 s8, 509
    s_cbranch_scc1 .ap_10
    s_waitcnt vmcnt(3)
    s_bitcmp1_b64 s[14:15], 13
    s_cbranch_scc0 1
    s_waitcnt vmcnt(2)
    s_cmpk_ge_u32 s8, 434
    s_cbranch_scc1 .ap_10
    s_waitcnt vmcnt(1)
.ap_10:
    s_add_u32 s63, s69, 172032
    buffer_load_dwordx4 v[108:111], v1, s[40:43], s63 offen nt
    s_cmp_eq_u32 s100, 0
    s_cbranch_scc1 .ls_11
    s_add_u32 m0, s32, 8192
    s_add_u32 s56, s101, 589824
    buffer_load_dwordx4 v6, s[48:51], s56 offen nt lds
.ls_11:
    s_memrealtime s[8:9]
    s_waitcnt vmcnt(8)
    s_waitcnt lgkmcnt(0)
    s_sub_u32 s8, s8, s30
    s_cmpk_ge_u32 s8, 620
    s_cbranch_scc1 .ap_12
    s_waitcnt vmcnt(5)
    s_cmpk_ge_u32 s8, 555
    s_cbranch_scc1 .ap_12
    s_waitcnt vmcnt(3)
    s_bitcmp1_b64 s[14:15], 14
    s_cbranch_scc0 1
    s_waitcnt vmcnt(2)
    s_cmpk_ge_u32 s8, 480
    s_cbranch_scc1 .ap_12
    s_waitcnt vmcnt(1)
.ap_12:
    s_add_u32 s63, s69, 180224
    buffer_load_dwordx4 v[136:139], v1, s[40:43], s63 offen nt
    s_memrealtime s[8:9]
    s_waitcnt vmcnt(8)
    s_waitcnt lgkmcnt(0)
    s_sub_u32 s8, s8, s30
    s_cmpk_ge_u32 s8, 666
    s_cbranch_scc1 .ap_13
    s_waitcnt vmcnt(5)
    s_cmpk_ge_u32 s8, 601
    s_cbranch_scc1 .ap_13
    s_waitcnt vmcnt(3)
    s_bitcmp1_b64 s[14:15], 15
    s_cbranch_scc0 1
    s_waitcnt vmcnt(2)
    s_cmpk_ge_u32 s8, 526
    s_cbranch_scc1 .ap_13
    s_waitcnt vmcnt(1)
.ap_13:
    s_add_u32 s63, s69, 188416
    buffer_load_dwordx4 v[140:143], v1, s[40:43], s63 offen nt
    s_memrealtime s[8:9]
    s_waitcnt vmcnt(8)
    s_waitcnt lgkmcnt(0)
    s_sub_u32 s8, s8, s30
    s_cmpk_ge_u32 s8, 712
    s_cbranch_scc1 .ap_14
    s_waitcnt vmcnt(5)
    s_cmpk_ge_u32 s8, 647
    s_cbranch_scc1 .ap_14
    s_waitcnt vmcnt(3)
    s_bitcmp1_b64 s[14:15], 16
    s_cbranch_scc0 1
    s_waitcnt vmcnt(2)
    s_cmpk_ge_u32 s8, 572
    s_cbranch_scc1 .ap_14
    s_waitcnt vmcnt(1)
.ap_14:
    s_add_u32 s63, s69, 262144
    buffer_load_dwordx4 v[48:51], v1, s[40:43], s63 offen nt
    s_cmp_eq_u32 s100, 0
    s_cbranch_scc1 .ls_15
    s_add_u32 m0, s32, 16384
    s_add_u32 s56, s101, 1179648
    buffer_load_dwordx4 v6, s[48:51], s56 offen nt lds
.ls_15:
    s_memrealtime s[8:9]
    s_waitcnt vmcnt(8)
    s_waitcnt lgkmcnt(0)
    s_sub_u32 s8, s8, s30
    s_cmpk_ge_u32 s8, 758
    s_cbranch_scc1 .ap_16
    s_waitcnt vmcnt(5)
    s_cmpk_ge_u32 s8, 693
    s_cbranch_scc1 .ap_16
    s_waitcnt vmcnt(3)
    s_bitcmp1_b64 s[14:15], 17
    s_cbranch_scc0 1
    s_waitcnt vmcnt(2)
    s_cmpk_ge_u32 s8, 618
    s_cbranch_scc1 .ap_16
    s_waitcnt vmcnt(1)
.ap_16:
    s_add_u32 s63, s69, 270336
    buffer_load_dwordx4 v[52:55], v1, s[40:43], s63 offen nt
    s_memrealtime s[8:9]
    s_waitcnt vmcnt(8)
    s_waitcnt lgkmcnt(0)
    s_sub_u32 s8, s8, s30
    s_cmpk_ge_u32 s8, 804
    s_cbranch_scc1 .ap_17
    s_waitcnt vmcnt(5)
    s_cmpk_ge_u32 s8, 739
    s_cbranch_scc1 .ap_17
    s_waitcnt vmcnt(3)
    s_bitcmp1_b64 s[14:15], 18
    s_cbranch_scc0 1
    s_waitcnt vmcnt(2)
    s_cmpk_ge_u32 s8, 664
    s_cbranch_scc1 .ap_17
    s_waitcnt vmcnt(1)
.ap_17:
    s_add_u32 s63, s69, 278528
    buffer_load_dwordx4 v[80:83], v1, s[40:43], s63 offen nt
    v_and_b32 v157, 7, v0
    v_lshlrev_b32 v157, 7, v157
    s_mov_b32 s63, 0x400
    buffer_load_dword v156, v157, s[36:39], s63 offen
    s_memrealtime s[8:9]
    s_waitcnt vmcnt(9)
    s_waitcnt lgkmcnt(0)
    s_sub_u32 s8, s8, s30
    s_cmpk_ge_u32 s8, 850
    s_cbranch_scc1 .ap_18
    s_waitcnt vmcnt(6)
    s_cmpk_ge_u32 s8, 785
    s_cbranch_scc1 .ap_18
    s_waitcnt vmcnt(4)
    s_bitcmp1_b64 s[14:15], 19
    s_cbranch_scc0 1
    s_waitcnt vmcnt(3)
    s_cmpk_ge_u32 s8, 710
    s_cbranch_scc1 .ap_18
    s_waitcnt vmcnt(2)
.ap_18:
    s_add_u32 s63, s69, 286720
    buffer_load_dwordx4 v[84:87], v1, s[40:43], s63 offen nt
    s_cmp_eq_u32 s100, 0
    s_cbranch_scc1 .ls_19
    s_add_u32 m0, s32, 24576
    s_add_u32 s56, s101, 1769472
    buffer_load_dwordx4 v6, s[48:51], s56 offen nt lds
.ls_19:
    s_memrealtime s[8:9]
    s_waitcnt vmcnt(9)
    s_waitcnt lgkmcnt(0)
    s_sub_u32 s8, s8, s30
    s_cmpk_ge_u32 s8, 895
    s_cbranch_scc1 .ap_20
    s_waitcnt vmcnt(6)
    s_cmpk_ge_u32 s8, 830
    s_cbranch_scc1 .ap_20
    s_waitcnt vmcnt(4)
    s_bitcmp1_b64 s[14:15], 20
    s_cbranch_scc0 1
    s_waitcnt vmcnt(3)
    s_cmpk_ge_u32 s8, 755
    s_cbranch_scc1 .ap_20
    s_waitcnt vmcnt(2)
.ap_20:
    s_add_u32 s63, s69, 294912
    buffer_load_dwordx4 v[112:115], v1, s[40:43], s63 offen nt
    s_memrealtime s[8:9]
    s_waitcnt vmcnt(9)
    s_waitcnt lgkmcnt(0)
    s_sub_u32 s8, s8, s30
    s_cmpk_ge_u32 s8, 940
    s_cbranch_scc1 .ap_21
    s_waitcnt vmcnt(6)
    s_cmpk_ge_u32 s8, 875
    s_cbranch_scc1 .ap_21
    s_waitcnt vmcnt(4)
    s_bitcmp1_b64 s[14:15], 21
    s_cbranch_scc0 1
    s_waitcnt vmcnt(3)
    s_cmpk_ge_u32 s8, 800
    s_cbranch_scc1 .ap_21
    s_waitcnt vmcnt(1)
.ap_21:
    s_add_u32 s63, s69, 303104
    buffer_load_dwordx4 v[116:119], v1, s[40:43], s63 offen nt
    s_memrealtime s[8:9]
    s_waitcnt vmcnt(9)
    s_waitcnt lgkmcnt(0)
    s_sub_u32 s8, s8, s30
    s_cmpk_ge_u32 s8, 985
    s_cbranch_scc1 .ap_22
    s_waitcnt vmcnt(6)
    s_cmpk_ge_u32 s8, 920
    s_cbranch_scc1 .ap_22
    s_waitcnt vmcnt(4)
    s_bitcmp1_b64 s[14:15], 22
    s_cbranch_scc0 1
    s_waitcnt vmcnt(2)
    s_cmpk_ge_u32 s8, 845
    s_cbranch_scc1 .ap_22
    s_waitcnt vmcnt(1)
.ap_22:
    s_add_u32 s63, s69, 311296
    buffer_load_dwordx4 v[144:147], v1, s[40:43], s63 offen nt
    s_waitcnt vmcnt(4)
    s_sub_u32 s63, s70, 300
    v_subrev_u32 v156, s63, v156
    v_mov_b32 v157, 600
    v_cmp_lt_u32 s[8:9], v156, v157
    v_add_u32_dpp v156, v156, v156 quad_perm:[1,0,3,2] row_mask:0xf bank_mask:0xf
    s_nop 1
    v_add_u32_dpp v156, v156, v156 quad_perm:[2,3,0,1] row_mask:0xf bank_mask:0xf
    s_nop 1
    v_add_u32_dpp v156, v156, v156 row_ror:4 row_mask:0xf bank_mask:0xf
    s_nop 0
    v_readfirstlane_b32 s63, v156
    s_cmp_eq_u64 s[8:9], -1
    s_nop 3
    s_cbranch_scc0 .et_23
    s_lshr_b32 s63, s63, 3
    s_sub_u32 s63, s63, 300
    s_add_u32 s30, s30, s63
.et_23:
    s_cmp_eq_u32 s100, 0
    s_cbranch_scc1 .ls_24
    s_add_u32 m0, s32, 32768
    s_add_u32 s56, s101, 2359296
    buffer_load_dwordx4 v6, s[48:51], s56 offen nt lds
.ls_24:
    s_memrealtime s[8:9]
    s_waitcnt lgkmcnt(0)
    s_sub_u32 s8, s8, s30
    s_cmpk_ge_u32 s8, 1030
    s_cbranch_scc1 .ap_25
    s_waitcnt vmcnt(4)
    s_cmpk_ge_u32 s8, 965
    s_cbranch_scc1 .ap_25
    s_waitcnt vmcnt(3)
    s_bitcmp1_b64 s[14:15], 23
    s_cbranch_scc0 1
    s_waitcnt vmcnt(2)
    s_cmpk_ge_u32 s8, 890
    s_cbranch_scc1 .ap_25
    s_waitcnt vmcnt(1)
.ap_25:
    s_add_u32 s63, s69, 319488
    buffer_load_dwordx4 v[148:151], v1, s[40:43], s63 offen nt
    s_memrealtime s[8:9]
    s_waitcnt lgkmcnt(0)
    s_sub_u32 s8, s8, s30
    s_cmpk_ge_u32 s8, 1075
    s_cbranch_scc1 .ap_26
    s_waitcnt vmcnt(5)
    s_cmpk_ge_u32 s8, 1010
    s_cbranch_scc1 .ap_26
    s_waitcnt vmcnt(3)
    s_bitcmp1_b64 s[14:15], 24
    s_cbranch_scc0 1
    s_waitcnt vmcnt(2)
    s_cmpk_ge_u32 s8, 935
    s_cbranch_scc1 .ap_26
    s_waitcnt vmcnt(1)
.ap_26:
    s_add_u32 s63, s69, 393216
    buffer_load_dwordx4 v[56:59], v1, s[40:43], s63 offen nt
    s_memrealtime s[8:9]
    s_waitcnt lgkmcnt(0)
    s_sub_u32 s8, s8, s30
    s_cmpk_ge_u32 s8, 1120
    s_cbranch_scc1 .ap_27
    s_waitcnt vmcnt(5)
    s_cmpk_ge_u32 s8, 1055
    s_cbranch_scc1 .ap_27
    s_waitcnt vmcnt(3)
    s_bitcmp1_b64 s[14:15], 25
    s_cbranch_scc0 1
    s_waitcnt vmcnt(2)
    s_cmpk_ge_u32 s8, 980
    s_cbranch_scc1 .ap_27
    s_waitcnt vmcnt(1)
.ap_27:
    s_add_u32 s63, s69, 401408
    buffer_load_dwordx4 v[60:63], v1, s[40:43], s63 offen nt
    s_branch .Latt_bc
.Le_mr:
    s_mul_i32 s58, s3, 1152
    s_mov_b32 s52, s24
    s_and_b32 s53, s25, 0xffff
    s_mov_b32 s54, 0x2400
    s_mov_b32 s55, 0x00020000
    buffer_load_dwordx2 v[246:247], v3, s[52:55], s58 offen
    buffer_load_dwordx2 v[248:249], v3, s[52:55], s58 offen offset:512
    buffer_load_dword v250, v4, s[52:55], s58 offen
    s_mov_b32 s48, s26
    s_and_b32 s49, s27, 0xffff
    s_mov_b32 s50, 0x3cc000
    s_mov_b32 s51, 0x00020000
    v_bfe_u32 v12, v0, 4, 1
    s_and_b32 s56, s3, 3
    s_lshl_b32 s56, s56, 1
    v_or_b32 v12, s56, v12
    v_and_b32 v19, 7, v0
    v_xor_b32 v12, v12, v19
    v_lshrrev_b32 v19, 3, v0
    v_mul_u32_u24 v19, 6912, v19
    v_lshl_add_u32 v19, v12, 4, v19
    s_mul_i32 s57, s3, 55296
    s_lshl_b32 s59, s99, 7
    s_add_u32 s57, s57, s59
    s_lshl_b32 s100, s3, 10
    s_add_u32 m0, s100, 0
    s_add_u32 s56, s57, 0
    buffer_load_dwordx4 v19, s[48:51], s56 offen nt lds
    s_add_u32 m0, s100, 8192
    s_add_u32 s56, s57, 442368
    buffer_load_dwordx4 v19, s[48:51], s56 offen nt lds
    s_add_u32 m0, s100, 16384
    s_add_u32 s56, s57, 884736
    buffer_load_dwordx4 v19, s[48:51], s56 offen nt lds
    s_add_u32 m0, s100, 24576
    s_add_u32 s56, s57, 1327104
    buffer_load_dwordx4 v19, s[48:51], s56 offen nt lds
    s_add_u32 m0, s100, 32768
    s_add_u32 s56, s57, 1769472
    buffer_load_dwordx4 v19, s[48:51], s56 offen nt lds
    s_add_u32 m0, s100, 40960
    s_add_u32 s56, s57, 2211840
    buffer_load_dwordx4 v19, s[48:51], s56 offen nt lds
    s_add_u32 m0, s100, 49152
    s_add_u32 s56, s57, 2654208
    buffer_load_dwordx4 v19, s[48:51], s56 offen nt lds
    s_add_u32 m0, s100, 57344
    s_add_u32 s56, s57, 3096576
    buffer_load_dwordx4 v19, s[48:51], s56 offen nt lds
    s_add_u32 m0, s100, 65536
    s_add_u32 s56, s57, 3538944
    buffer_load_dwordx4 v19, s[48:51], s56 offen nt lds
    v_bfe_u32 v16, v0, 1, 3
    v_mul_u32_u24 v16, 1312, v16
    v_lshrrev_b32 v12, 4, v0
    v_lshl_add_u32 v16, v12, 5, v16
    v_and_b32 v12, 1, v0
    v_lshl_add_u32 v16, v12, 4, v16
    v_add_u32 v16, 147456, v16
    s_mul_i32 s56, s3, 1312
    s_add_u32 s56, s56, 147456
    v_add_u32 v17, s56, v3
    v_add_u32 v18, s56, v4
    v_lshrrev_b32 v12, 4, v0
    v_bfe_u32 v13, v0, 1, 1
    v_lshl_add_u32 v12, v12, 1, v13
    v_bfe_u32 v13, v0, 2, 2
    v_lshl_add_u32 v20, v12, 3, v13
    v_lshlrev_b32 v20, 7, v20
    v_and_b32 v12, 3, v12
    v_lshrrev_b32 v13, 1, v13
    v_lshl_add_u32 v12, v12, 1, v13
    v_xor_b32 v12, s3, v12
    v_lshl_add_u32 v20, v12, 4, v20
    v_and_b32 v12, 1, v0
    v_lshl_add_u32 v20, v12, 3, v20
    v_bfe_u32 v23, v0, 1, 3
    v_mul_u32_u24 v23, 144, v23
    v_bfe_u32 v12, v0, 4, 1
    v_lshl_add_u32 v23, v12, 3, v23
    v_lshrrev_b32 v12, 5, v0
    v_lshl_add_u32 v23, v12, 2, v23
    v_and_b32 v12, 1, v0
    v_lshl_add_u32 v23, v12, 1, v23
    s_lshl_b32 s56, s3, 4
    s_add_u32 s56, s56, 157952
    v_add_u32 v23, s56, v23
    v_and_b32 v24, 15, v0
    v_lshlrev_b32 v24, 3, v24
    s_mul_i32 s56, s3, 144
    s_add_u32 s56, s56, 157952
    v_add_u32 v24, s56, v24
    v_add_u32 v21, 32768, v20
    s_lshl_b32 s100, s3, 10
    v_lshrrev_b32 v12, 4, v0
    v_mul_u32_u24 v12, 18432, v12
    v_and_b32 v13, 15, v0
    v_lshl_add_u32 v22, v13, 4, v12
    s_mul_i32 s57, s99, 57
    s_lshr_b32 s57, s57, 9
    s_mul_i32 s58, s57, 9
    s_sub_u32 s58, s99, s58
    s_mul_i32 s59, s57, 36864
    s_lshl_b32 s58, s58, 8
    s_add_u32 s59, s59, s58
    s_mul_i32 s58, s3, 2304
    s_add_u32 s59, s59, s58
    s_add_u32 s59, s59, 0x3000
    s_mov_b32 s58, 0
    s_cmp_eq_u32 s57, 1
    s_cselect_b32 s58, 1.0, s58
    s_cmp_eq_u32 s57, 4
    s_cselect_b32 s58, 1.0, s58
    s_waitcnt vmcnt(9)
    v_lshlrev_b32 v236, 16, v246
    v_and_b32 v237, 0xffff0000, v246
    v_max_f32 v236, 0xc2ae0000, v236
    v_min_f32 v242, 0x43000000, v236
    v_mul_f32 v238, 0xbfb8aa3b, v242
    v_fma_f32 v240, v242, s98, -v238
    v_fmac_f32 v240, 0xb2a57060, v242
    v_exp_f32 v238, v238
    v_mul_f32 v240, 0x3f317218, v240
    v_fmac_f32 v238, v238, v240
    v_add_f32 v238, 1.0, v238
    v_rcp_f32 v240, v238
    s_nop 0
    v_mul_f32 v242, v236, v240
    v_fma_f32 v238, -v242, v238, v236
    v_fma_f32 v236, v238, v240, v242
    v_max_f32 v237, 0xc2ae0000, v237
    v_min_f32 v243, 0x43000000, v237
    v_mul_f32 v239, 0xbfb8aa3b, v243
    v_fma_f32 v241, v243, s98, -v239
    v_fmac_f32 v241, 0xb2a57060, v243
    v_exp_f32 v239, v239
    v_mul_f32 v241, 0x3f317218, v241
    v_fmac_f32 v239, v239, v241
    v_add_f32 v239, 1.0, v239
    v_rcp_f32 v241, v239
    s_nop 0
    v_mul_f32 v243, v237, v241
    v_fma_f32 v239, -v243, v239, v237
    v_fma_f32 v237, v239, v241, v243
    v_cvt_pk_bf16_f32 v246, v236, v237
    v_lshlrev_b32 v236, 16, v247
    v_and_b32 v237, 0xffff0000, v247
    v_max_f32 v236, 0xc2ae0000, v236
    v_min_f32 v242, 0x43000000, v236
    v_mul_f32 v238, 0xbfb8aa3b, v242
    v_fma_f32 v240, v242, s98, -v238
    v_fmac_f32 v240, 0xb2a57060, v242
    v_exp_f32 v238, v238
    v_mul_f32 v240, 0x3f317218, v240
    v_fmac_f32 v238, v238, v240
    v_add_f32 v238, 1.0, v238
    v_rcp_f32 v240, v238
    s_nop 0
    v_mul_f32 v242, v236, v240
    v_fma_f32 v238, -v242, v238, v236
    v_fma_f32 v236, v238, v240, v242
    v_max_f32 v237, 0xc2ae0000, v237
    v_min_f32 v243, 0x43000000, v237
    v_mul_f32 v239, 0xbfb8aa3b, v243
    v_fma_f32 v241, v243, s98, -v239
    v_fmac_f32 v241, 0xb2a57060, v243
    v_exp_f32 v239, v239
    v_mul_f32 v241, 0x3f317218, v241
    v_fmac_f32 v239, v239, v241
    v_add_f32 v239, 1.0, v239
    v_rcp_f32 v241, v239
    s_nop 0
    v_mul_f32 v243, v237, v241
    v_fma_f32 v239, -v243, v239, v237
    v_fma_f32 v237, v239, v241, v243
    v_cvt_pk_bf16_f32 v247, v236, v237
    v_lshlrev_b32 v236, 16, v248
    v_and_b32 v237, 0xffff0000, v248
    v_max_f32 v236, 0xc2ae0000, v236
    v_min_f32 v242, 0x43000000, v236
    v_mul_f32 v238, 0xbfb8aa3b, v242
    v_fma_f32 v240, v242, s98, -v238
    v_fmac_f32 v240, 0xb2a57060, v242
    v_exp_f32 v238, v238
    v_mul_f32 v240, 0x3f317218, v240
    v_fmac_f32 v238, v238, v240
    v_add_f32 v238, 1.0, v238
    v_rcp_f32 v240, v238
    s_nop 0
    v_mul_f32 v242, v236, v240
    v_fma_f32 v238, -v242, v238, v236
    v_fma_f32 v236, v238, v240, v242
    v_max_f32 v237, 0xc2ae0000, v237
    v_min_f32 v243, 0x43000000, v237
    v_mul_f32 v239, 0xbfb8aa3b, v243
    v_fma_f32 v241, v243, s98, -v239
    v_fmac_f32 v241, 0xb2a57060, v243
    v_exp_f32 v239, v239
    v_mul_f32 v241, 0x3f317218, v241
    v_fmac_f32 v239, v239, v241
    v_add_f32 v239, 1.0, v239
    v_rcp_f32 v241, v239
    s_nop 0
    v_mul_f32 v243, v237, v241
    v_fma_f32 v239, -v243, v239, v237
    v_fma_f32 v237, v239, v241, v243
    v_cvt_pk_bf16_f32 v248, v236, v237
    v_lshlrev_b32 v236, 16, v249
    v_and_b32 v237, 0xffff0000, v249
    v_max_f32 v236, 0xc2ae0000, v236
    v_min_f32 v242, 0x43000000, v236
    v_mul_f32 v238, 0xbfb8aa3b, v242
    v_fma_f32 v240, v242, s98, -v238
    v_fmac_f32 v240, 0xb2a57060, v242
    v_exp_f32 v238, v238
    v_mul_f32 v240, 0x3f317218, v240
    v_fmac_f32 v238, v238, v240
    v_add_f32 v238, 1.0, v238
    v_rcp_f32 v240, v238
    s_nop 0
    v_mul_f32 v242, v236, v240
    v_fma_f32 v238, -v242, v238, v236
    v_fma_f32 v236, v238, v240, v242
    v_max_f32 v237, 0xc2ae0000, v237
    v_min_f32 v243, 0x43000000, v237
    v_mul_f32 v239, 0xbfb8aa3b, v243
    v_fma_f32 v241, v243, s98, -v239
    v_fmac_f32 v241, 0xb2a57060, v243
    v_exp_f32 v239, v239
    v_mul_f32 v241, 0x3f317218, v241
    v_fmac_f32 v239, v239, v241
    v_add_f32 v239, 1.0, v239
    v_rcp_f32 v241, v239
    s_nop 0
    v_mul_f32 v243, v237, v241
    v_fma_f32 v239, -v243, v239, v237
    v_fma_f32 v237, v239, v241, v243
    v_cvt_pk_bf16_f32 v249, v236, v237
    v_lshlrev_b32 v236, 16, v250
    v_and_b32 v237, 0xffff0000, v250
    v_max_f32 v236, 0xc2ae0000, v236
    v_min_f32 v242, 0x43000000, v236
    v_mul_f32 v238, 0xbfb8aa3b, v242
    v_fma_f32 v240, v242, s98, -v238
    v_fmac_f32 v240, 0xb2a57060, v242
    v_exp_f32 v238, v238
    v_mul_f32 v240, 0x3f317218, v240
    v_fmac_f32 v238, v238, v240
    v_add_f32 v238, 1.0, v238
    v_rcp_f32 v240, v238
    s_nop 0
    v_mul_f32 v242, v236, v240
    v_fma_f32 v238, -v242, v238, v236
    v_fma_f32 v236, v238, v240, v242
    v_max_f32 v237, 0xc2ae0000, v237
    v_min_f32 v243, 0x43000000, v237
    v_mul_f32 v239, 0xbfb8aa3b, v243
    v_fma_f32 v241, v243, s98, -v239
    v_fmac_f32 v241, 0xb2a57060, v243
    v_exp_f32 v239, v239
    v_mul_f32 v241, 0x3f317218, v241
    v_fmac_f32 v239, v239, v241
    v_add_f32 v239, 1.0, v239
    v_rcp_f32 v241, v239
    s_nop 0
    v_mul_f32 v243, v237, v241
    v_fma_f32 v239, -v243, v239, v237
    v_fma_f32 v237, v239, v241, v243
    v_cvt_pk_bf16_f32 v250, v236, v237
    ds_write_b64 v17, v[246:247]
    ds_write_b64 v17, v[248:249] offset:512
    ds_write_b32 v18, v250
    s_waitcnt vmcnt(3)
    s_add_u32 s63, s69, 147456
    buffer_load_dwordx4 v[72:75], v1, s[40:43], s63 offen nt
    s_waitcnt vmcnt(3)
    s_add_u32 s63, s69, 155648
    buffer_load_dwordx4 v[76:79], v1, s[40:43], s63 offen nt
    s_waitcnt vmcnt(3)
    s_add_u32 s63, s69, 163840
    buffer_load_dwordx4 v[104:107], v1, s[40:43], s63 offen nt
    s_waitcnt vmcnt(3)
    s_add_u32 s63, s69, 172032
    buffer_load_dwordx4 v[108:111], v1, s[40:43], s63 offen nt
    s_waitcnt vmcnt(3)
    s_add_u32 s63, s69, 180224
    buffer_load_dwordx4 v[136:139], v1, s[40:43], s63 offen nt
    s_waitcnt vmcnt(3)
    s_add_u32 s63, s69, 188416
    buffer_load_dwordx4 v[140:143], v1, s[40:43], s63 offen nt
    s_waitcnt vmcnt(3)
    s_add_u32 s63, s69, 262144
    buffer_load_dwordx4 v[48:51], v1, s[40:43], s63 offen nt
    s_waitcnt vmcnt(3)
    s_add_u32 s63, s69, 270336
    buffer_load_dwordx4 v[52:55], v1, s[40:43], s63 offen nt
    s_waitcnt lgkmcnt(0)
    s_barrier
    ds_read_b64_tr_b16 v[160:161], v20 offset:0
    ds_read_b64_tr_b16 v[162:163], v20 offset:512
    ds_read_b64_tr_b16 v[164:165], v20 offset:8192
    ds_read_b64_tr_b16 v[166:167], v20 offset:8704
    ds_read_b64_tr_b16 v[168:169], v20 offset:16384
    ds_read_b64_tr_b16 v[170:171], v20 offset:16896
    ds_read_b64_tr_b16 v[172:173], v20 offset:24576
    ds_read_b64_tr_b16 v[174:175], v20 offset:25088
    ds_read_b64_tr_b16 v[176:177], v21 offset:0
    ds_read_b64_tr_b16 v[178:179], v21 offset:512
    ds_read_b64_tr_b16 v[180:181], v21 offset:8192
    ds_read_b64_tr_b16 v[182:183], v21 offset:8704
    ds_read_b64_tr_b16 v[184:185], v21 offset:16384
    ds_read_b64_tr_b16 v[186:187], v21 offset:16896
    ds_read_b64_tr_b16 v[188:189], v21 offset:24576
    ds_read_b64_tr_b16 v[190:191], v21 offset:25088
    ds_read_b64_tr_b16 v[192:193], v21 offset:32768
    ds_read_b64_tr_b16 v[194:195], v21 offset:33280
    ds_read_b128 v[196:199], v16 offset:0
    ds_read_b128 v[200:203], v16 offset:128
    ds_read_b128 v[204:207], v16 offset:256
    ds_read_b128 v[208:211], v16 offset:384
    ds_read_b128 v[212:215], v16 offset:512
    ds_read_b128 v[216:219], v16 offset:640
    ds_read_b128 v[220:223], v16 offset:768
    ds_read_b128 v[224:227], v16 offset:896
    ds_read_b128 v[228:231], v16 offset:1024
    s_waitcnt lgkmcnt(8)
    v_mfma_f32_16x16x32_bf16 v[232:235], v[160:163], v[196:199], 0
    s_waitcnt lgkmcnt(7)
    v_mfma_f32_16x16x32_bf16 v[232:235], v[164:167], v[200:203], v[232:235]
    s_waitcnt lgkmcnt(6)
    v_mfma_f32_16x16x32_bf16 v[232:235], v[168:171], v[204:207], v[232:235]
    s_waitcnt lgkmcnt(5)
    v_mfma_f32_16x16x32_bf16 v[232:235], v[172:175], v[208:211], v[232:235]
    s_waitcnt lgkmcnt(4)
    v_mfma_f32_16x16x32_bf16 v[232:235], v[176:179], v[212:215], v[232:235]
    s_waitcnt lgkmcnt(3)
    v_mfma_f32_16x16x32_bf16 v[232:235], v[180:183], v[216:219], v[232:235]
    s_waitcnt lgkmcnt(2)
    v_mfma_f32_16x16x32_bf16 v[232:235], v[184:187], v[220:223], v[232:235]
    s_waitcnt lgkmcnt(1)
    v_mfma_f32_16x16x32_bf16 v[232:235], v[188:191], v[224:227], v[232:235]
    s_waitcnt lgkmcnt(0)
    v_mfma_f32_16x16x32_bf16 v[232:235], v[192:195], v[228:231], v[232:235]
    s_nop 7
    v_permlane32_swap_b32 v232, v234
    v_permlane32_swap_b32 v233, v235
    v_cndmask_b32 v233, v233, v234, s[96:97]
    v_cndmask_b32 v232, v232, v235, s[96:97]
    s_nop 1
    v_add_f32_dpp v236, v233, v232 quad_perm:[1,0,3,2] row_mask:0xf bank_mask:0xf
    v_cvt_pk_bf16_f32 v236, 0, v236
    v_add_f32 v236, s58, v236
    v_cvt_pk_bf16_f32 v236, v236, v236
    ds_write_b16 v23, v236
    v_mov_b32 v243, s34
    s_waitcnt lgkmcnt(0)
    s_barrier
    ds_read2_b32 v[244:245], v24 offset1:1
    v_mov_b32 v241, s34
    s_waitcnt lgkmcnt(0)
    v_mov_b32 v240, v244
    v_mov_b32 v242, v245
    s_mov_b64 exec, 0xffff
    buffer_store_dwordx4 v[240:243], v22, s[36:39], s59 offen sc1
    s_mov_b64 exec, -1
    s_nop 0
    s_branch .Le_m2
.Le_mc:
    v_bfe_u32 v16, v0, 1, 3
    v_mul_u32_u24 v16, 1312, v16
    v_lshrrev_b32 v12, 4, v0
    v_lshl_add_u32 v16, v12, 5, v16
    v_and_b32 v12, 1, v0
    v_lshl_add_u32 v16, v12, 4, v16
    v_add_u32 v16, 147456, v16
    s_mul_i32 s56, s3, 1312
    s_add_u32 s56, s56, 147456
    v_add_u32 v17, s56, v3
    v_add_u32 v18, s56, v4
    v_lshrrev_b32 v12, 4, v0
    v_bfe_u32 v13, v0, 1, 1
    v_lshl_add_u32 v12, v12, 1, v13
    v_bfe_u32 v13, v0, 2, 2
    v_lshl_add_u32 v20, v12, 3, v13
    v_lshlrev_b32 v20, 7, v20
    v_and_b32 v12, 3, v12
    v_lshrrev_b32 v13, 1, v13
    v_lshl_add_u32 v12, v12, 1, v13
    v_xor_b32 v12, s3, v12
    v_lshl_add_u32 v20, v12, 4, v20
    v_and_b32 v12, 1, v0
    v_lshl_add_u32 v20, v12, 3, v20
    v_bfe_u32 v23, v0, 1, 3
    v_mul_u32_u24 v23, 144, v23
    v_bfe_u32 v12, v0, 4, 1
    v_lshl_add_u32 v23, v12, 3, v23
    v_lshrrev_b32 v12, 5, v0
    v_lshl_add_u32 v23, v12, 2, v23
    v_and_b32 v12, 1, v0
    v_lshl_add_u32 v23, v12, 1, v23
    s_lshl_b32 s56, s3, 4
    s_add_u32 s56, s56, 157952
    v_add_u32 v23, s56, v23
    v_and_b32 v24, 15, v0
    v_lshlrev_b32 v24, 3, v24
    s_mul_i32 s56, s3, 144
    s_add_u32 s56, s56, 157952
    v_add_u32 v24, s56, v24
    v_add_u32 v21, 32768, v20
    s_lshl_b32 s100, s3, 10
    s_waitcnt lgkmcnt(0)
    s_mul_i32 s34, s34, 0x9e3779b1
    s_add_u32 s34, s34, 0x7f4a7c15
    v_lshrrev_b32 v12, 4, v0
    v_mul_u32_u24 v12, 18432, v12
    v_and_b32 v13, 15, v0
    v_lshl_add_u32 v22, v13, 4, v12
    s_mul_i32 s57, s99, 57
    s_lshr_b32 s57, s57, 9
    s_mul_i32 s58, s57, 9
    s_sub_u32 s58, s99, s58
    s_mul_i32 s59, s57, 36864
    s_lshl_b32 s58, s58, 8
    s_add_u32 s59, s59, s58
    s_mul_i32 s58, s3, 2304
    s_add_u32 s59, s59, s58
    s_add_u32 s59, s59, 0x3000
    s_mov_b32 s58, 0
    s_cmp_eq_u32 s57, 1
    s_cselect_b32 s58, 1.0, s58
    s_cmp_eq_u32 s57, 4
    s_cselect_b32 s58, 1.0, s58
    s_waitcnt vmcnt(13)
    v_lshlrev_b32 v236, 16, v246
    v_and_b32 v237, 0xffff0000, v246
    v_max_f32 v236, 0xc2ae0000, v236
    v_min_f32 v242, 0x43000000, v236
    v_mul_f32 v238, 0xbfb8aa3b, v242
    v_fma_f32 v240, v242, s98, -v238
    v_fmac_f32 v240, 0xb2a57060, v242
    v_exp_f32 v238, v238
    v_mul_f32 v240, 0x3f317218, v240
    v_fmac_f32 v238, v238, v240
    v_add_f32 v238, 1.0, v238
    v_rcp_f32 v240, v238
    s_nop 0
    v_mul_f32 v242, v236, v240
    v_fma_f32 v238, -v242, v238, v236
    v_fma_f32 v236, v238, v240, v242
    v_max_f32 v237, 0xc2ae0000, v237
    v_min_f32 v243, 0x43000000, v237
    v_mul_f32 v239, 0xbfb8aa3b, v243
    v_fma_f32 v241, v243, s98, -v239
    v_fmac_f32 v241, 0xb2a57060, v243
    v_exp_f32 v239, v239
    v_mul_f32 v241, 0x3f317218, v241
    v_fmac_f32 v239, v239, v241
    v_add_f32 v239, 1.0, v239
    v_rcp_f32 v241, v239
    s_nop 0
    v_mul_f32 v243, v237, v241
    v_fma_f32 v239, -v243, v239, v237
    v_fma_f32 v237, v239, v241, v243
    v_cvt_pk_bf16_f32 v246, v236, v237
    v_lshlrev_b32 v236, 16, v247
    v_and_b32 v237, 0xffff0000, v247
    v_max_f32 v236, 0xc2ae0000, v236
    v_min_f32 v242, 0x43000000, v236
    v_mul_f32 v238, 0xbfb8aa3b, v242
    v_fma_f32 v240, v242, s98, -v238
    v_fmac_f32 v240, 0xb2a57060, v242
    v_exp_f32 v238, v238
    v_mul_f32 v240, 0x3f317218, v240
    v_fmac_f32 v238, v238, v240
    v_add_f32 v238, 1.0, v238
    v_rcp_f32 v240, v238
    s_nop 0
    v_mul_f32 v242, v236, v240
    v_fma_f32 v238, -v242, v238, v236
    v_fma_f32 v236, v238, v240, v242
    v_max_f32 v237, 0xc2ae0000, v237
    v_min_f32 v243, 0x43000000, v237
    v_mul_f32 v239, 0xbfb8aa3b, v243
    v_fma_f32 v241, v243, s98, -v239
    v_fmac_f32 v241, 0xb2a57060, v243
    v_exp_f32 v239, v239
    v_mul_f32 v241, 0x3f317218, v241
    v_fmac_f32 v239, v239, v241
    v_add_f32 v239, 1.0, v239
    v_rcp_f32 v241, v239
    s_nop 0
    v_mul_f32 v243, v237, v241
    v_fma_f32 v239, -v243, v239, v237
    v_fma_f32 v237, v239, v241, v243
    v_cvt_pk_bf16_f32 v247, v236, v237
    v_lshlrev_b32 v236, 16, v248
    v_and_b32 v237, 0xffff0000, v248
    v_max_f32 v236, 0xc2ae0000, v236
    v_min_f32 v242, 0x43000000, v236
    v_mul_f32 v238, 0xbfb8aa3b, v242
    v_fma_f32 v240, v242, s98, -v238
    v_fmac_f32 v240, 0xb2a57060, v242
    v_exp_f32 v238, v238
    v_mul_f32 v240, 0x3f317218, v240
    v_fmac_f32 v238, v238, v240
    v_add_f32 v238, 1.0, v238
    v_rcp_f32 v240, v238
    s_nop 0
    v_mul_f32 v242, v236, v240
    v_fma_f32 v238, -v242, v238, v236
    v_fma_f32 v236, v238, v240, v242
    v_max_f32 v237, 0xc2ae0000, v237
    v_min_f32 v243, 0x43000000, v237
    v_mul_f32 v239, 0xbfb8aa3b, v243
    v_fma_f32 v241, v243, s98, -v239
    v_fmac_f32 v241, 0xb2a57060, v243
    v_exp_f32 v239, v239
    v_mul_f32 v241, 0x3f317218, v241
    v_fmac_f32 v239, v239, v241
    v_add_f32 v239, 1.0, v239
    v_rcp_f32 v241, v239
    s_nop 0
    v_mul_f32 v243, v237, v241
    v_fma_f32 v239, -v243, v239, v237
    v_fma_f32 v237, v239, v241, v243
    v_cvt_pk_bf16_f32 v248, v236, v237
    v_lshlrev_b32 v236, 16, v249
    v_and_b32 v237, 0xffff0000, v249
    v_max_f32 v236, 0xc2ae0000, v236
    v_min_f32 v242, 0x43000000, v236
    v_mul_f32 v238, 0xbfb8aa3b, v242
    v_fma_f32 v240, v242, s98, -v238
    v_fmac_f32 v240, 0xb2a57060, v242
    v_exp_f32 v238, v238
    v_mul_f32 v240, 0x3f317218, v240
    v_fmac_f32 v238, v238, v240
    v_add_f32 v238, 1.0, v238
    v_rcp_f32 v240, v238
    s_nop 0
    v_mul_f32 v242, v236, v240
    v_fma_f32 v238, -v242, v238, v236
    v_fma_f32 v236, v238, v240, v242
    v_max_f32 v237, 0xc2ae0000, v237
    v_min_f32 v243, 0x43000000, v237
    v_mul_f32 v239, 0xbfb8aa3b, v243
    v_fma_f32 v241, v243, s98, -v239
    v_fmac_f32 v241, 0xb2a57060, v243
    v_exp_f32 v239, v239
    v_mul_f32 v241, 0x3f317218, v241
    v_fmac_f32 v239, v239, v241
    v_add_f32 v239, 1.0, v239
    v_rcp_f32 v241, v239
    s_nop 0
    v_mul_f32 v243, v237, v241
    v_fma_f32 v239, -v243, v239, v237
    v_fma_f32 v237, v239, v241, v243
    v_cvt_pk_bf16_f32 v249, v236, v237
    v_lshlrev_b32 v236, 16, v250
    v_and_b32 v237, 0xffff0000, v250
    v_max_f32 v236, 0xc2ae0000, v236
    v_min_f32 v242, 0x43000000, v236
    v_mul_f32 v238, 0xbfb8aa3b, v242
    v_fma_f32 v240, v242, s98, -v238
    v_fmac_f32 v240, 0xb2a57060, v242
    v_exp_f32 v238, v238
    v_mul_f32 v240, 0x3f317218, v240
    v_fmac_f32 v238, v238, v240
    v_add_f32 v238, 1.0, v238
    v_rcp_f32 v240, v238
    s_nop 0
    v_mul_f32 v242, v236, v240
    v_fma_f32 v238, -v242, v238, v236
    v_fma_f32 v236, v238, v240, v242
    v_max_f32 v237, 0xc2ae0000, v237
    v_min_f32 v243, 0x43000000, v237
    v_mul_f32 v239, 0xbfb8aa3b, v243
    v_fma_f32 v241, v243, s98, -v239
    v_fmac_f32 v241, 0xb2a57060, v243
    v_exp_f32 v239, v239
    v_mul_f32 v241, 0x3f317218, v241
    v_fmac_f32 v239, v239, v241
    v_add_f32 v239, 1.0, v239
    v_rcp_f32 v241, v239
    s_nop 0
    v_mul_f32 v243, v237, v241
    v_fma_f32 v239, -v243, v239, v237
    v_fma_f32 v237, v239, v241, v243
    v_cvt_pk_bf16_f32 v250, v236, v237
    ds_write_b64 v17, v[246:247]
    ds_write_b64 v17, v[248:249] offset:512
    ds_write_b32 v18, v250
    s_waitcnt vmcnt(4)
    s_waitcnt lgkmcnt(0)
    s_barrier
    ds_read_b64_tr_b16 v[160:161], v20 offset:0
    ds_read_b64_tr_b16 v[162:163], v20 offset:512
    ds_read_b64_tr_b16 v[164:165], v20 offset:8192
    ds_read_b64_tr_b16 v[166:167], v20 offset:8704
    ds_read_b64_tr_b16 v[168:169], v20 offset:16384
    ds_read_b64_tr_b16 v[170:171], v20 offset:16896
    ds_read_b64_tr_b16 v[172:173], v20 offset:24576
    ds_read_b64_tr_b16 v[174:175], v20 offset:25088
    ds_read_b64_tr_b16 v[176:177], v21 offset:0
    ds_read_b64_tr_b16 v[178:179], v21 offset:512
    ds_read_b64_tr_b16 v[180:181], v21 offset:8192
    ds_read_b64_tr_b16 v[182:183], v21 offset:8704
    ds_read_b64_tr_b16 v[184:185], v21 offset:16384
    ds_read_b64_tr_b16 v[186:187], v21 offset:16896
    ds_read_b64_tr_b16 v[188:189], v21 offset:24576
    ds_read_b64_tr_b16 v[190:191], v21 offset:25088
    ds_read_b64_tr_b16 v[192:193], v21 offset:32768
    ds_read_b64_tr_b16 v[194:195], v21 offset:33280
    ds_read_b128 v[196:199], v16 offset:0
    ds_read_b128 v[200:203], v16 offset:128
    ds_read_b128 v[204:207], v16 offset:256
    ds_read_b128 v[208:211], v16 offset:384
    ds_read_b128 v[212:215], v16 offset:512
    ds_read_b128 v[216:219], v16 offset:640
    ds_read_b128 v[220:223], v16 offset:768
    ds_read_b128 v[224:227], v16 offset:896
    ds_read_b128 v[228:231], v16 offset:1024
    s_waitcnt lgkmcnt(8)
    v_mfma_f32_16x16x32_bf16 v[232:235], v[160:163], v[196:199], 0
    s_waitcnt lgkmcnt(7)
    v_mfma_f32_16x16x32_bf16 v[232:235], v[164:167], v[200:203], v[232:235]
    s_waitcnt lgkmcnt(6)
    v_mfma_f32_16x16x32_bf16 v[232:235], v[168:171], v[204:207], v[232:235]
    s_waitcnt lgkmcnt(5)
    v_mfma_f32_16x16x32_bf16 v[232:235], v[172:175], v[208:211], v[232:235]
    s_waitcnt lgkmcnt(4)
    v_mfma_f32_16x16x32_bf16 v[232:235], v[176:179], v[212:215], v[232:235]
    s_waitcnt lgkmcnt(3)
    v_mfma_f32_16x16x32_bf16 v[232:235], v[180:183], v[216:219], v[232:235]
    s_waitcnt lgkmcnt(2)
    v_mfma_f32_16x16x32_bf16 v[232:235], v[184:187], v[220:223], v[232:235]
    s_waitcnt lgkmcnt(1)
    v_mfma_f32_16x16x32_bf16 v[232:235], v[188:191], v[224:227], v[232:235]
    s_waitcnt lgkmcnt(0)
    v_mfma_f32_16x16x32_bf16 v[232:235], v[192:195], v[228:231], v[232:235]
    s_nop 7
    v_permlane32_swap_b32 v232, v234
    v_permlane32_swap_b32 v233, v235
    v_cndmask_b32 v233, v233, v234, s[96:97]
    v_cndmask_b32 v232, v232, v235, s[96:97]
    s_nop 1
    v_add_f32_dpp v236, v233, v232 quad_perm:[1,0,3,2] row_mask:0xf bank_mask:0xf
    v_cvt_pk_bf16_f32 v236, 0, v236
    v_add_f32 v236, s58, v236
    v_cvt_pk_bf16_f32 v236, v236, v236
    ds_write_b16 v23, v236
    v_mov_b32 v243, s34
    s_waitcnt lgkmcnt(0)
    s_barrier
    ds_read2_b32 v[244:245], v24 offset1:1
    v_mov_b32 v241, s34
    s_waitcnt lgkmcnt(0)
    v_mov_b32 v240, v244
    v_mov_b32 v242, v245
    s_mov_b64 exec, 0xffffffff
    buffer_store_dwordx4 v[240:243], v22, s[36:39], s59 offen sc1
    s_mov_b64 exec, -1
    s_mov_b32 s14, 0x6b5ad6b5
    s_mov_b32 s15, 0x5ad6b5ad
    s_add_u32 s30, s70, -30
    s_waitcnt vmcnt(3)
    s_add_u32 s63, s69, 32768
    buffer_load_dwordx4 v[96:99], v1, s[40:43], s63 offen nt
    s_waitcnt vmcnt(3)
    s_add_u32 s63, s69, 40960
    buffer_load_dwordx4 v[100:103], v1, s[40:43], s63 offen nt
    s_waitcnt vmcnt(3)
    s_add_u32 s63, s69, 49152
    buffer_load_dwordx4 v[128:131], v1, s[40:43], s63 offen nt
    s_waitcnt vmcnt(3)
    s_add_u32 s63, s69, 57344
    buffer_load_dwordx4 v[132:135], v1, s[40:43], s63 offen nt
    s_waitcnt vmcnt(3)
    s_add_u32 s63, s69, 131072
    buffer_load_dwordx4 v[40:43], v1, s[40:43], s63 offen nt
    s_waitcnt vmcnt(3)
    s_add_u32 s63, s69, 139264
    buffer_load_dwordx4 v[44:47], v1, s[40:43], s63 offen nt
    s_waitcnt vmcnt(3)
    s_add_u32 s63, s69, 147456
    buffer_load_dwordx4 v[72:75], v1, s[40:43], s63 offen nt
    s_waitcnt vmcnt(3)
    s_add_u32 s63, s69, 155648
    buffer_load_dwordx4 v[76:79], v1, s[40:43], s63 offen nt
    s_waitcnt vmcnt(3)
    s_add_u32 s63, s69, 163840
    buffer_load_dwordx4 v[104:107], v1, s[40:43], s63 offen nt
    s_waitcnt vmcnt(3)
    s_add_u32 s63, s69, 172032
    buffer_load_dwordx4 v[108:111], v1, s[40:43], s63 offen nt
    s_waitcnt vmcnt(3)
    s_add_u32 s63, s69, 180224
    buffer_load_dwordx4 v[136:139], v1, s[40:43], s63 offen nt
    s_waitcnt vmcnt(3)
    s_add_u32 s63, s69, 188416
    buffer_load_dwordx4 v[140:143], v1, s[40:43], s63 offen nt
    s_waitcnt vmcnt(3)
    s_add_u32 s63, s69, 262144
    buffer_load_dwordx4 v[48:51], v1, s[40:43], s63 offen nt
    s_waitcnt vmcnt(3)
    s_add_u32 s63, s69, 270336
    buffer_load_dwordx4 v[52:55], v1, s[40:43], s63 offen nt
.Le_m2:
    s_waitcnt vmcnt(3)
    s_bitcmp1_b64 s[14:15], 18
    s_cbranch_scc0 1
    s_waitcnt vmcnt(2)
    s_add_u32 s63, s69, 278528
    buffer_load_dwordx4 v[80:83], v1, s[40:43], s63 offen nt
    v_and_b32 v157, 7, v0
    v_lshlrev_b32 v157, 7, v157
    s_mov_b32 s63, 0x400
    buffer_load_dword v156, v157, s[36:39], s63 offen
    s_memrealtime s[8:9]
    s_waitcnt lgkmcnt(0)
    s_sub_u32 s8, s8, s30
    s_cmpk_ge_u32 s8, 850
    s_cbranch_scc1 .ap_28
    s_waitcnt vmcnt(5)
    s_cmpk_ge_u32 s8, 785
    s_cbranch_scc1 .ap_28
    s_waitcnt vmcnt(4)
    s_bitcmp1_b64 s[14:15], 19
    s_cbranch_scc0 1
    s_waitcnt vmcnt(3)
    s_cmpk_ge_u32 s8, 710
    s_cbranch_scc1 .ap_28
    s_waitcnt vmcnt(2)
.ap_28:
    s_add_u32 s63, s69, 286720
    buffer_load_dwordx4 v[84:87], v1, s[40:43], s63 offen nt
    s_memrealtime s[8:9]
    s_waitcnt lgkmcnt(0)
    s_sub_u32 s8, s8, s30
    s_cmpk_ge_u32 s8, 895
    s_cbranch_scc1 .ap_29
    s_waitcnt vmcnt(6)
    s_cmpk_ge_u32 s8, 830
    s_cbranch_scc1 .ap_29
    s_waitcnt vmcnt(4)
    s_bitcmp1_b64 s[14:15], 20
    s_cbranch_scc0 1
    s_waitcnt vmcnt(3)
    s_cmpk_ge_u32 s8, 755
    s_cbranch_scc1 .ap_29
    s_waitcnt vmcnt(2)
.ap_29:
    s_add_u32 s63, s69, 294912
    buffer_load_dwordx4 v[112:115], v1, s[40:43], s63 offen nt
    s_memrealtime s[8:9]
    s_waitcnt lgkmcnt(0)
    s_sub_u32 s8, s8, s30
    s_cmpk_ge_u32 s8, 940
    s_cbranch_scc1 .ap_30
    s_waitcnt vmcnt(6)
    s_cmpk_ge_u32 s8, 875
    s_cbranch_scc1 .ap_30
    s_waitcnt vmcnt(4)
    s_bitcmp1_b64 s[14:15], 21
    s_cbranch_scc0 1
    s_waitcnt vmcnt(3)
    s_cmpk_ge_u32 s8, 800
    s_cbranch_scc1 .ap_30
    s_waitcnt vmcnt(1)
.ap_30:
    s_add_u32 s63, s69, 303104
    buffer_load_dwordx4 v[116:119], v1, s[40:43], s63 offen nt
    s_memrealtime s[8:9]
    s_waitcnt lgkmcnt(0)
    s_sub_u32 s8, s8, s30
    s_cmpk_ge_u32 s8, 985
    s_cbranch_scc1 .ap_31
    s_waitcnt vmcnt(6)
    s_cmpk_ge_u32 s8, 920
    s_cbranch_scc1 .ap_31
    s_waitcnt vmcnt(4)
    s_bitcmp1_b64 s[14:15], 22
    s_cbranch_scc0 1
    s_waitcnt vmcnt(2)
    s_cmpk_ge_u32 s8, 845
    s_cbranch_scc1 .ap_31
    s_waitcnt vmcnt(1)
.ap_31:
    s_add_u32 s63, s69, 311296
    buffer_load_dwordx4 v[144:147], v1, s[40:43], s63 offen nt
    s_waitcnt vmcnt(4)
    s_sub_u32 s63, s70, 300
    v_subrev_u32 v156, s63, v156
    v_mov_b32 v157, 600
    v_cmp_lt_u32 s[8:9], v156, v157
    v_add_u32_dpp v156, v156, v156 quad_perm:[1,0,3,2] row_mask:0xf bank_mask:0xf
    s_nop 1
    v_add_u32_dpp v156, v156, v156 quad_perm:[2,3,0,1] row_mask:0xf bank_mask:0xf
    s_nop 1
    v_add_u32_dpp v156, v156, v156 row_ror:4 row_mask:0xf bank_mask:0xf
    s_nop 0
    v_readfirstlane_b32 s63, v156
    s_cmp_eq_u64 s[8:9], -1
    s_nop 3
    s_cbranch_scc0 .et_32
    s_lshr_b32 s63, s63, 3
    s_sub_u32 s63, s63, 300
    s_add_u32 s30, s30, s63
.et_32:
    s_memrealtime s[8:9]
    s_waitcnt lgkmcnt(0)
    s_sub_u32 s8, s8, s30
    s_cmpk_ge_u32 s8, 1030
    s_cbranch_scc1 .ap_33
    s_waitcnt vmcnt(4)
    s_cmpk_ge_u32 s8, 965
    s_cbranch_scc1 .ap_33
    s_waitcnt vmcnt(3)
    s_bitcmp1_b64 s[14:15], 23
    s_cbranch_scc0 1
    s_waitcnt vmcnt(2)
    s_cmpk_ge_u32 s8, 890
    s_cbranch_scc1 .ap_33
    s_waitcnt vmcnt(1)
.ap_33:
    s_add_u32 s63, s69, 319488
    buffer_load_dwordx4 v[148:151], v1, s[40:43], s63 offen nt
    s_memrealtime s[8:9]
    s_waitcnt lgkmcnt(0)
    s_sub_u32 s8, s8, s30
    s_cmpk_ge_u32 s8, 1075
    s_cbranch_scc1 .ap_34
    s_waitcnt vmcnt(5)
    s_cmpk_ge_u32 s8, 1010
    s_cbranch_scc1 .ap_34
    s_waitcnt vmcnt(3)
    s_bitcmp1_b64 s[14:15], 24
    s_cbranch_scc0 1
    s_waitcnt vmcnt(2)
    s_cmpk_ge_u32 s8, 935
    s_cbranch_scc1 .ap_34
    s_waitcnt vmcnt(1)
.ap_34:
    s_add_u32 s63, s69, 393216
    buffer_load_dwordx4 v[56:59], v1, s[40:43], s63 offen nt
    s_memrealtime s[8:9]
    s_waitcnt lgkmcnt(0)
    s_sub_u32 s8, s8, s30
    s_cmpk_ge_u32 s8, 1120
    s_cbranch_scc1 .ap_35
    s_waitcnt vmcnt(5)
    s_cmpk_ge_u32 s8, 1055
    s_cbranch_scc1 .ap_35
    s_waitcnt vmcnt(3)
    s_bitcmp1_b64 s[14:15], 25
    s_cbranch_scc0 1
    s_waitcnt vmcnt(2)
    s_cmpk_ge_u32 s8, 980
    s_cbranch_scc1 .ap_35
    s_waitcnt vmcnt(1)
.ap_35:
    s_add_u32 s63, s69, 401408
    buffer_load_dwordx4 v[60:63], v1, s[40:43], s63 offen nt
    s_mov_b32 s24, 0
    s_cmp_lt_u32 s2, 216
    s_cbranch_scc1 .Latt_bc
    s_branch .Latt_n
.Le_q:
    s_cmp_ge_u32 s65, 27
    s_mov_b32 s14, 0x94a5294a
    s_cselect_b32 s14, 0x0, s14
    s_mov_b32 s15, 0xa5294a52
    s_cselect_b32 s15, 0x0, s15
    s_cselect_b32 s30, -30, 0
    s_add_u32 s30, s30, 0
    s_add_u32 s30, s30, s70
    s_mul_i32 s58, s3, 1152
    s_mov_b32 s52, s4
    s_and_b32 s53, s5, 0xffff
    s_mov_b32 s54, 0x2400
    s_mov_b32 s55, 0x00020000
    buffer_load_dwordx2 v[246:247], v3, s[52:55], s58 offen
    buffer_load_dwordx2 v[248:249], v3, s[52:55], s58 offen offset:512
    buffer_load_dword v250, v4, s[52:55], s58 offen
    s_mov_b32 s48, s10
    s_and_b32 s49, s11, 0xffff
    s_mov_b32 s50, 0x480000
    s_mov_b32 s51, 0x00020000
    v_bfe_u32 v12, v0, 4, 1
    s_and_b32 s56, s3, 3
    s_lshl_b32 s56, s56, 1
    v_or_b32 v12, s56, v12
    v_and_b32 v19, 7, v0
    v_xor_b32 v12, v12, v19
    v_lshrrev_b32 v19, 3, v0
    v_mul_u32_u24 v19, 8192, v19
    v_lshl_add_u32 v19, v12, 4, v19
    s_lshl3_add_u32 s101, s64, s101
    s_lshl_b32 s99, s3, 16
    s_lshl_b32 s59, s101, 7
    s_add_u32 s99, s99, s59
    s_lshl_b32 s100, s3, 10
    s_add_u32 m0, s100, 0
    s_add_u32 s56, s99, 0
    buffer_load_dwordx4 v19, s[48:51], s56 offen nt lds
    s_add_u32 s63, s69, 32768
    buffer_load_dwordx4 v[96:99], v1, s[40:43], s63 offen nt
    v_bfe_u32 v16, v0, 1, 3
    v_mul_u32_u24 v16, 1312, v16
    v_lshrrev_b32 v12, 4, v0
    v_lshl_add_u32 v16, v12, 5, v16
    v_and_b32 v12, 1, v0
    v_lshl_add_u32 v16, v12, 4, v16
    v_add_u32 v16, 147456, v16
    s_mul_i32 s56, s3, 1312
    s_add_u32 s56, s56, 147456
    v_add_u32 v17, s56, v3
    v_add_u32 v18, s56, v4
    v_lshrrev_b32 v12, 4, v0
    v_bfe_u32 v13, v0, 1, 1
    v_lshl_add_u32 v12, v12, 1, v13
    v_bfe_u32 v13, v0, 2, 2
    v_lshl_add_u32 v20, v12, 3, v13
    v_lshlrev_b32 v20, 7, v20
    v_and_b32 v12, 3, v12
    v_lshrrev_b32 v13, 1, v13
    v_lshl_add_u32 v12, v12, 1, v13
    v_xor_b32 v12, s3, v12
    v_lshl_add_u32 v20, v12, 4, v20
    v_and_b32 v12, 1, v0
    v_lshl_add_u32 v20, v12, 3, v20
    v_bfe_u32 v23, v0, 1, 3
    v_mul_u32_u24 v23, 144, v23
    v_bfe_u32 v12, v0, 4, 1
    v_lshl_add_u32 v23, v12, 3, v23
    v_lshrrev_b32 v12, 5, v0
    v_lshl_add_u32 v23, v12, 2, v23
    v_and_b32 v12, 1, v0
    v_lshl_add_u32 v23, v12, 1, v23
    s_lshl_b32 s56, s3, 4
    s_add_u32 s56, s56, 157952
    v_add_u32 v23, s56, v23
    v_and_b32 v24, 15, v0
    v_lshlrev_b32 v24, 3, v24
    s_mul_i32 s56, s3, 144
    s_add_u32 s56, s56, 157952
    v_add_u32 v24, s56, v24
    v_add_u32 v21, 32768, v20
    s_lshl_b32 s100, s3, 10
    s_waitcnt lgkmcnt(0)
    s_mul_i32 s34, s34, 0x9e3779b1
    s_add_u32 s34, s34, 0x7f4a7c15
    s_lshl_b32 s101, s101, 8
    s_lshl_b32 s58, s3, 14
    s_add_u32 s101, s101, s58
    s_add_u32 s101, s101, 0x40000
    s_and_b32 s58, s64, 1
    s_mul_i32 s58, s58, 18432
    s_mul_i32 s59, s3, 2304
    s_add_u32 s58, s58, s59
    s_add_u32 s58, s58, 0x3000
    s_add_u32 s59, s58, 36864
    s_waitcnt vmcnt(5)
    s_add_u32 m0, s100, 8192
    s_add_u32 s56, s99, 524288
    buffer_load_dwordx4 v19, s[48:51], s56 offen nt lds
    s_waitcnt vmcnt(5)
    s_add_u32 s63, s69, 40960
    buffer_load_dwordx4 v[100:103], v1, s[40:43], s63 offen nt
    s_waitcnt vmcnt(5)
    s_add_u32 m0, s100, 16384
    s_add_u32 s56, s99, 1048576
    buffer_load_dwordx4 v19, s[48:51], s56 offen nt lds
    s_waitcnt vmcnt(5)
    s_add_u32 s63, s69, 49152
    buffer_load_dwordx4 v[128:131], v1, s[40:43], s63 offen nt
    v_lshlrev_b32 v236, 16, v246
    v_and_b32 v237, 0xffff0000, v246
    v_lshlrev_b32 v238, 16, v247
    v_and_b32 v239, 0xffff0000, v247
    v_lshlrev_b32 v240, 16, v248
    v_and_b32 v241, 0xffff0000, v248
    v_lshlrev_b32 v242, 16, v249
    v_and_b32 v243, 0xffff0000, v249
    v_lshlrev_b32 v244, 16, v250
    v_and_b32 v245, 0xffff0000, v250
    s_mov_b32 s56, 0x3f803f80
    v_dot2_f32_bf16 v10, v246, s56, 0
    v_dot2_f32_bf16 v11, v246, v246, 0
    v_dot2_f32_bf16 v10, v247, s56, v10
    v_dot2_f32_bf16 v11, v247, v247, v11
    v_dot2_f32_bf16 v10, v248, s56, v10
    v_dot2_f32_bf16 v11, v248, v248, v11
    v_dot2_f32_bf16 v10, v249, s56, v10
    v_dot2_f32_bf16 v11, v249, v249, v11
    s_mov_b64 exec, 0xffffffff
    v_dot2_f32_bf16 v10, v250, s56, v10
    v_dot2_f32_bf16 v11, v250, v250, v11
    s_mov_b64 exec, -1
    s_nop 1
    v_permlane32_swap_b32 v10, v11
    v_add_f32 v10, v10, v11
    v_mov_b32 v12, v10
    s_nop 1
    v_permlane16_swap_b32 v12, v10
    v_add_f32 v10, v12, v10
    s_nop 1
    v_add_f32_dpp v10, v10, v10 row_ror:8 row_mask:0xf bank_mask:0xf
    s_nop 1
    v_add_f32_dpp v10, v10, v10 row_ror:4 row_mask:0xf bank_mask:0xf
    s_nop 1
    v_add_f32_dpp v10, v10, v10 quad_perm:[2,3,0,1] row_mask:0xf bank_mask:0xf
    s_nop 1
    v_add_f32_dpp v10, v10, v10 quad_perm:[1,0,3,2] row_mask:0xf bank_mask:0xf
    v_mul_f32 v10, 0x3ae38e39, v10
    s_nop 0
    v_readlane_b32 s56, v10, 0
    v_readlane_b32 s57, v10, 32
    s_nop 0
    v_mov_b32 v10, s56
    v_fma_f32 v11, -v10, v10, s57
    v_max_f32 v11, 0, v11
    v_cvt_pk_bf16_f32 v13, 0, v11
    v_cvt_pk_bf16_f32 v11, 0, -v10
    v_cvt_pk_bf16_f32 v10, 0, -v10
    v_add_f32 v13, 0x3727c5ac, v13
    v_pk_add_f32 v[236:237], v[236:237], v[10:11]
    v_pk_add_f32 v[238:239], v[238:239], v[10:11]
    v_pk_add_f32 v[240:241], v[240:241], v[10:11]
    v_cvt_pk_bf16_f32 v13, 0, v13
    v_pk_add_f32 v[242:243], v[242:243], v[10:11]
    v_pk_add_f32 v[244:245], v[244:245], v[10:11]
    v_cvt_pk_bf16_f32 v236, 0, v236
    v_sqrt_f32 v13, v13
    v_cvt_pk_bf16_f32 v237, 0, v237
    v_cvt_pk_bf16_f32 v238, 0, v238
    v_cvt_pk_bf16_f32 v239, 0, v239
    v_cvt_pk_bf16_f32 v13, 0, v13
    v_cvt_pk_bf16_f32 v240, 0, v240
    v_cvt_pk_bf16_f32 v241, 0, v241
    v_cvt_pk_bf16_f32 v242, 0, v242
    v_rcp_f32 v12, v13
    v_cvt_pk_bf16_f32 v243, 0, v243
    v_cvt_pk_bf16_f32 v244, 0, v244
    v_cvt_pk_bf16_f32 v245, 0, v245
    v_mov_b32 v13, v12
    v_pk_mul_f32 v[236:237], v[236:237], v[12:13]
    v_pk_mul_f32 v[238:239], v[238:239], v[12:13]
    v_pk_mul_f32 v[240:241], v[240:241], v[12:13]
    v_pk_mul_f32 v[242:243], v[242:243], v[12:13]
    v_pk_mul_f32 v[244:245], v[244:245], v[12:13]
    v_cvt_pk_bf16_f32 v236, 0, v236
    v_cvt_pk_bf16_f32 v237, 0, v237
    v_cvt_pk_bf16_f32 v238, 0, v238
    v_cvt_pk_bf16_f32 v239, 0, v239
    v_cvt_pk_bf16_f32 v240, 0, v240
    v_cvt_pk_bf16_f32 v241, 0, v241
    v_cvt_pk_bf16_f32 v242, 0, v242
    v_cvt_pk_bf16_f32 v243, 0, v243
    v_cvt_pk_bf16_f32 v244, 0, v244
    v_cvt_pk_bf16_f32 v245, 0, v245
    s_waitcnt vmcnt(5)
    s_add_u32 m0, s100, 24576
    s_add_u32 s56, s99, 1572864
    buffer_load_dwordx4 v19, s[48:51], s56 offen nt lds
    s_waitcnt vmcnt(5)
    s_add_u32 s63, s69, 57344
    buffer_load_dwordx4 v[132:135], v1, s[40:43], s63 offen nt
    s_waitcnt vmcnt(5)
    s_add_u32 m0, s100, 32768
    s_add_u32 s56, s99, 2097152
    buffer_load_dwordx4 v19, s[48:51], s56 offen nt lds
    s_waitcnt vmcnt(5)
    s_add_u32 s63, s69, 131072
    buffer_load_dwordx4 v[40:43], v1, s[40:43], s63 offen nt
    s_waitcnt vmcnt(5)
    s_add_u32 m0, s100, 40960
    s_add_u32 s56, s99, 2621440
    buffer_load_dwordx4 v19, s[48:51], s56 offen nt lds
    s_waitcnt vmcnt(5)
    s_add_u32 s63, s69, 139264
    buffer_load_dwordx4 v[44:47], v1, s[40:43], s63 offen nt
    s_waitcnt vmcnt(5)
    s_add_u32 m0, s100, 49152
    s_add_u32 s56, s99, 3145728
    buffer_load_dwordx4 v19, s[48:51], s56 offen nt lds
    s_waitcnt vmcnt(5)
    s_add_u32 s63, s69, 147456
    buffer_load_dwordx4 v[72:75], v1, s[40:43], s63 offen nt
    s_waitcnt vmcnt(5)
    s_add_u32 m0, s100, 57344
    s_add_u32 s56, s99, 3670016
    buffer_load_dwordx4 v19, s[48:51], s56 offen nt lds
    s_waitcnt vmcnt(5)
    s_add_u32 s63, s69, 155648
    buffer_load_dwordx4 v[76:79], v1, s[40:43], s63 offen nt
    buffer_load_dwordx4 v[196:199], v2, s[36:39], s58 offen offset:0 sc1
    buffer_load_dwordx4 v[200:203], v2, s[36:39], s58 offen offset:1024 sc1
    buffer_load_dwordx2 v[204:205], v5, s[36:39], s58 offen offset:0 sc1
    buffer_load_dwordx4 v[206:209], v2, s[36:39], s59 offen offset:0 sc1
    buffer_load_dwordx4 v[210:213], v2, s[36:39], s59 offen offset:1024 sc1
    buffer_load_dwordx2 v[214:215], v5, s[36:39], s59 offen offset:0 sc1
    s_waitcnt vmcnt(11)
    s_add_u32 m0, s100, 65536
    s_add_u32 s56, s99, 4194304
    buffer_load_dwordx4 v19, s[48:51], s56 offen nt lds
    s_waitcnt vmcnt(11)
    s_add_u32 s63, s69, 163840
    buffer_load_dwordx4 v[104:107], v1, s[40:43], s63 offen nt
    s_waitcnt vmcnt(11)
    s_add_u32 s63, s69, 172032
    buffer_load_dwordx4 v[108:111], v1, s[40:43], s63 offen nt
    s_waitcnt vmcnt(11)
    s_add_u32 s63, s69, 180224
    buffer_load_dwordx4 v[136:139], v1, s[40:43], s63 offen nt
    s_waitcnt vmcnt(4)
    s_branch .gpc_37
.gp_36:
    buffer_load_dwordx4 v[196:199], v2, s[36:39], s58 offen offset:0 sc1
    buffer_load_dwordx4 v[200:203], v2, s[36:39], s58 offen offset:1024 sc1
    buffer_load_dwordx2 v[204:205], v5, s[36:39], s58 offen offset:0 sc1
    buffer_load_dwordx4 v[206:209], v2, s[36:39], s59 offen offset:0 sc1
    buffer_load_dwordx4 v[210:213], v2, s[36:39], s59 offen offset:1024 sc1
    buffer_load_dwordx2 v[214:215], v5, s[36:39], s59 offen offset:0 sc1
    s_waitcnt vmcnt(0)
.gpc_37:
    v_min_u32 v10, v197, v199
    v_max_u32 v11, v197, v199
    v_min3_u32 v10, v10, v201, v203
    v_max3_u32 v11, v11, v201, v203
    v_min3_u32 v10, v10, v205, v207
    v_max3_u32 v11, v11, v205, v207
    v_min3_u32 v10, v10, v209, v211
    v_max3_u32 v11, v11, v209, v211
    v_min3_u32 v10, v10, v213, v215
    v_max3_u32 v11, v11, v213, v215
    v_cmp_eq_u32 vcc, s34, v10
    v_cmp_eq_u32 s[56:57], s34, v11
    s_and_b64 vcc, vcc, s[56:57]
    s_cmp_eq_u64 vcc, exec
    s_nop 2
    s_cbranch_scc1 .gpd_38
    s_sub_u32 s35, s35, 1
    s_cbranch_scc1 .Lexit
    s_branch .gp_36
.gpd_38:
    v_and_b32 v207, 0xffff0000, v206
    v_lshlrev_b32 v206, 16, v206
    v_and_b32 v209, 0xffff0000, v208
    v_lshlrev_b32 v208, 16, v208
    v_and_b32 v211, 0xffff0000, v210
    v_lshlrev_b32 v210, 16, v210
    v_and_b32 v213, 0xffff0000, v212
    v_lshlrev_b32 v212, 16, v212
    v_and_b32 v215, 0xffff0000, v214
    v_lshlrev_b32 v214, 16, v214
    v_and_b32 v197, 0xffff0000, v196
    v_lshlrev_b32 v196, 16, v196
    v_and_b32 v199, 0xffff0000, v198
    v_lshlrev_b32 v198, 16, v198
    v_and_b32 v201, 0xffff0000, v200
    v_lshlrev_b32 v200, 16, v200
    v_and_b32 v203, 0xffff0000, v202
    v_lshlrev_b32 v202, 16, v202
    v_and_b32 v205, 0xffff0000, v204
    v_lshlrev_b32 v204, 16, v204
    v_pk_mul_f32 v[236:237], v[236:237], v[206:207]
    v_pk_mul_f32 v[238:239], v[238:239], v[208:209]
    v_pk_mul_f32 v[240:241], v[240:241], v[210:211]
    v_pk_mul_f32 v[242:243], v[242:243], v[212:213]
    v_pk_mul_f32 v[244:245], v[244:245], v[214:215]
    v_cvt_pk_bf16_f32 v236, 0, v236
    v_cvt_pk_bf16_f32 v237, 0, v237
    v_cvt_pk_bf16_f32 v238, 0, v238
    v_cvt_pk_bf16_f32 v239, 0, v239
    v_cvt_pk_bf16_f32 v240, 0, v240
    v_cvt_pk_bf16_f32 v241, 0, v241
    v_cvt_pk_bf16_f32 v242, 0, v242
    v_cvt_pk_bf16_f32 v243, 0, v243
    v_cvt_pk_bf16_f32 v244, 0, v244
    v_cvt_pk_bf16_f32 v245, 0, v245
    v_pk_add_f32 v[236:237], v[236:237], v[196:197]
    v_pk_add_f32 v[238:239], v[238:239], v[198:199]
    v_pk_add_f32 v[240:241], v[240:241], v[200:201]
    v_pk_add_f32 v[242:243], v[242:243], v[202:203]
    v_pk_add_f32 v[244:245], v[244:245], v[204:205]
    v_cvt_pk_bf16_f32 v246, v236, v237
    v_cvt_pk_bf16_f32 v247, v238, v239
    v_cvt_pk_bf16_f32 v248, v240, v241
    v_cvt_pk_bf16_f32 v249, v242, v243
    v_cvt_pk_bf16_f32 v250, v244, v245
    ds_write_b64 v17, v[246:247]
    ds_write_b64 v17, v[248:249] offset:512
    ds_write_b32 v18, v250
    s_add_u32 s63, s69, 188416
    buffer_load_dwordx4 v[140:143], v1, s[40:43], s63 offen nt
    s_add_u32 s63, s69, 262144
    buffer_load_dwordx4 v[48:51], v1, s[40:43], s63 offen nt
    s_add_u32 s63, s69, 270336
    buffer_load_dwordx4 v[52:55], v1, s[40:43], s63 offen nt
    s_add_u32 s63, s69, 278528
    buffer_load_dwordx4 v[80:83], v1, s[40:43], s63 offen nt
    v_and_b32 v157, 7, v0
    v_lshlrev_b32 v157, 7, v157
    s_mov_b32 s63, 0x400
    buffer_load_dword v156, v157, s[36:39], s63 offen
    s_waitcnt vmcnt(8)
    s_waitcnt lgkmcnt(0)
    s_barrier
    ds_read_b64_tr_b16 v[160:161], v20 offset:0
    ds_read_b64_tr_b16 v[162:163], v20 offset:512
    ds_read_b64_tr_b16 v[164:165], v20 offset:8192
    ds_read_b64_tr_b16 v[166:167], v20 offset:8704
    ds_read_b64_tr_b16 v[168:169], v20 offset:16384
    ds_read_b64_tr_b16 v[170:171], v20 offset:16896
    ds_read_b64_tr_b16 v[172:173], v20 offset:24576
    ds_read_b64_tr_b16 v[174:175], v20 offset:25088
    ds_read_b64_tr_b16 v[176:177], v21 offset:0
    ds_read_b64_tr_b16 v[178:179], v21 offset:512
    ds_read_b64_tr_b16 v[180:181], v21 offset:8192
    ds_read_b64_tr_b16 v[182:183], v21 offset:8704
    ds_read_b64_tr_b16 v[184:185], v21 offset:16384
    ds_read_b64_tr_b16 v[186:187], v21 offset:16896
    ds_read_b64_tr_b16 v[188:189], v21 offset:24576
    ds_read_b64_tr_b16 v[190:191], v21 offset:25088
    ds_read_b64_tr_b16 v[192:193], v21 offset:32768
    ds_read_b64_tr_b16 v[194:195], v21 offset:33280
    s_waitcnt lgkmcnt(0)
    ds_read_b128 v[196:199], v16 offset:0
    ds_read_b128 v[200:203], v16 offset:128
    ds_read_b128 v[204:207], v16 offset:256
    ds_read_b128 v[208:211], v16 offset:384
    ds_read_b128 v[212:215], v16 offset:512
    ds_read_b128 v[216:219], v16 offset:640
    ds_read_b128 v[220:223], v16 offset:768
    ds_read_b128 v[224:227], v16 offset:896
    ds_read_b128 v[228:231], v16 offset:1024
    s_waitcnt lgkmcnt(8)
    v_mfma_f32_16x16x32_bf16 v[232:235], v[160:163], v[196:199], 0
    s_waitcnt lgkmcnt(7)
    v_mfma_f32_16x16x32_bf16 v[232:235], v[164:167], v[200:203], v[232:235]
    s_waitcnt lgkmcnt(6)
    v_mfma_f32_16x16x32_bf16 v[232:235], v[168:171], v[204:207], v[232:235]
    s_waitcnt lgkmcnt(5)
    v_mfma_f32_16x16x32_bf16 v[232:235], v[172:175], v[208:211], v[232:235]
    s_waitcnt lgkmcnt(4)
    v_mfma_f32_16x16x32_bf16 v[232:235], v[176:179], v[212:215], v[232:235]
    s_waitcnt lgkmcnt(3)
    v_mfma_f32_16x16x32_bf16 v[232:235], v[180:183], v[216:219], v[232:235]
    s_waitcnt lgkmcnt(2)
    v_mfma_f32_16x16x32_bf16 v[232:235], v[184:187], v[220:223], v[232:235]
    s_waitcnt lgkmcnt(1)
    v_mfma_f32_16x16x32_bf16 v[232:235], v[188:191], v[224:227], v[232:235]
    s_waitcnt lgkmcnt(0)
    v_mfma_f32_16x16x32_bf16 v[232:235], v[192:195], v[228:231], v[232:235]
    s_nop 7
    v_permlane32_swap_b32 v232, v234
    v_permlane32_swap_b32 v233, v235
    v_cndmask_b32 v233, v233, v234, s[96:97]
    v_cndmask_b32 v232, v232, v235, s[96:97]
    s_nop 1
    v_add_f32_dpp v236, v233, v232 quad_perm:[1,0,3,2] row_mask:0xf bank_mask:0xf
    v_cvt_pk_bf16_f32 v236, v236, v236
    ds_write_b16 v23, v236
    v_mov_b32 v243, s34
    s_waitcnt lgkmcnt(0)
    s_barrier
    ds_read2_b32 v[244:245], v24 offset1:1
    v_mov_b32 v241, s34
    s_waitcnt lgkmcnt(0)
    v_mov_b32 v240, v244
    v_mov_b32 v242, v245
    s_mov_b64 exec, 0xffff
    buffer_store_dwordx4 v[240:243], v2, s[36:39], s101 offen sc1
    s_mov_b64 exec, -1
.Lq_done:
    s_memrealtime s[8:9]
    s_waitcnt lgkmcnt(0)
    s_sub_u32 s8, s8, s30
    s_cmpk_ge_u32 s8, 850
    s_cbranch_scc1 .ap_39
    s_waitcnt vmcnt(6)
    s_cmpk_ge_u32 s8, 785
    s_cbranch_scc1 .ap_39
    s_waitcnt vmcnt(4)
    s_bitcmp1_b64 s[14:15], 19
    s_cbranch_scc0 1
    s_waitcnt vmcnt(3)
    s_cmpk_ge_u32 s8, 710
    s_cbranch_scc1 .ap_39
    s_waitcnt vmcnt(2)
.ap_39:
    s_add_u32 s63, s69, 286720
    buffer_load_dwordx4 v[84:87], v1, s[40:43], s63 offen nt
    s_memrealtime s[8:9]
    s_waitcnt lgkmcnt(0)
    s_sub_u32 s8, s8, s30
    s_cmpk_ge_u32 s8, 895
    s_cbranch_scc1 .ap_40
    s_waitcnt vmcnt(6)
    s_cmpk_ge_u32 s8, 830
    s_cbranch_scc1 .ap_40
    s_waitcnt vmcnt(4)
    s_bitcmp1_b64 s[14:15], 20
    s_cbranch_scc0 1
    s_waitcnt vmcnt(3)
    s_cmpk_ge_u32 s8, 755
    s_cbranch_scc1 .ap_40
    s_waitcnt vmcnt(2)
.ap_40:
    s_add_u32 s63, s69, 294912
    buffer_load_dwordx4 v[112:115], v1, s[40:43], s63 offen nt
    s_memrealtime s[8:9]
    s_waitcnt vmcnt(9)
    s_waitcnt lgkmcnt(0)
    s_sub_u32 s8, s8, s30
    s_cmpk_ge_u32 s8, 940
    s_cbranch_scc1 .ap_41
    s_waitcnt vmcnt(6)
    s_cmpk_ge_u32 s8, 875
    s_cbranch_scc1 .ap_41
    s_waitcnt vmcnt(4)
    s_bitcmp1_b64 s[14:15], 21
    s_cbranch_scc0 1
    s_waitcnt vmcnt(3)
    s_cmpk_ge_u32 s8, 800
    s_cbranch_scc1 .ap_41
    s_waitcnt vmcnt(1)
.ap_41:
    s_add_u32 s63, s69, 303104
    buffer_load_dwordx4 v[116:119], v1, s[40:43], s63 offen nt
    s_memrealtime s[8:9]
    s_waitcnt vmcnt(9)
    s_waitcnt lgkmcnt(0)
    s_sub_u32 s8, s8, s30
    s_cmpk_ge_u32 s8, 985
    s_cbranch_scc1 .ap_42
    s_waitcnt vmcnt(6)
    s_cmpk_ge_u32 s8, 920
    s_cbranch_scc1 .ap_42
    s_waitcnt vmcnt(4)
    s_bitcmp1_b64 s[14:15], 22
    s_cbranch_scc0 1
    s_waitcnt vmcnt(2)
    s_cmpk_ge_u32 s8, 845
    s_cbranch_scc1 .ap_42
    s_waitcnt vmcnt(1)
.ap_42:
    s_add_u32 s63, s69, 311296
    buffer_load_dwordx4 v[144:147], v1, s[40:43], s63 offen nt
    s_waitcnt vmcnt(4)
    s_sub_u32 s63, s70, 300
    v_subrev_u32 v156, s63, v156
    v_mov_b32 v157, 600
    v_cmp_lt_u32 s[8:9], v156, v157
    v_add_u32_dpp v156, v156, v156 quad_perm:[1,0,3,2] row_mask:0xf bank_mask:0xf
    s_nop 1
    v_add_u32_dpp v156, v156, v156 quad_perm:[2,3,0,1] row_mask:0xf bank_mask:0xf
    s_nop 1
    v_add_u32_dpp v156, v156, v156 row_ror:4 row_mask:0xf bank_mask:0xf
    s_nop 0
    v_readfirstlane_b32 s63, v156
    s_cmp_eq_u64 s[8:9], -1
    s_nop 3
    s_cbranch_scc0 .et_43
    s_lshr_b32 s63, s63, 3
    s_sub_u32 s63, s63, 300
    s_add_u32 s30, s30, s63
.et_43:
    s_memrealtime s[8:9]
    s_waitcnt lgkmcnt(0)
    s_sub_u32 s8, s8, s30
    s_cmpk_ge_u32 s8, 1030
    s_cbranch_scc1 .ap_44
    s_waitcnt vmcnt(4)
    s_cmpk_ge_u32 s8, 965
    s_cbranch_scc1 .ap_44
    s_waitcnt vmcnt(3)
    s_bitcmp1_b64 s[14:15], 23
    s_cbranch_scc0 1
    s_waitcnt vmcnt(2)
    s_cmpk_ge_u32 s8, 890
    s_cbranch_scc1 .ap_44
    s_waitcnt vmcnt(1)
.ap_44:
    s_add_u32 s63, s69, 319488
    buffer_load_dwordx4 v[148:151], v1, s[40:43], s63 offen nt
    s_memrealtime s[8:9]
    s_waitcnt lgkmcnt(0)
    s_sub_u32 s8, s8, s30
    s_cmpk_ge_u32 s8, 1075
    s_cbranch_scc1 .ap_45
    s_waitcnt vmcnt(5)
    s_cmpk_ge_u32 s8, 1010
    s_cbranch_scc1 .ap_45
    s_waitcnt vmcnt(3)
    s_bitcmp1_b64 s[14:15], 24
    s_cbranch_scc0 1
    s_waitcnt vmcnt(2)
    s_cmpk_ge_u32 s8, 935
    s_cbranch_scc1 .ap_45
    s_waitcnt vmcnt(1)
.ap_45:
    s_add_u32 s63, s69, 393216
    buffer_load_dwordx4 v[56:59], v1, s[40:43], s63 offen nt
    s_memrealtime s[8:9]
    s_waitcnt lgkmcnt(0)
    s_sub_u32 s8, s8, s30
    s_cmpk_ge_u32 s8, 1120
    s_cbranch_scc1 .ap_46
    s_waitcnt vmcnt(5)
    s_cmpk_ge_u32 s8, 1055
    s_cbranch_scc1 .ap_46
    s_waitcnt vmcnt(3)
    s_bitcmp1_b64 s[14:15], 25
    s_cbranch_scc0 1
    s_waitcnt vmcnt(2)
    s_cmpk_ge_u32 s8, 980
    s_cbranch_scc1 .ap_46
    s_waitcnt vmcnt(1)
.ap_46:
    s_add_u32 s63, s69, 401408
    buffer_load_dwordx4 v[60:63], v1, s[40:43], s63 offen nt
    s_mov_b32 s24, 0
    s_cmp_lt_u32 s2, 216
    s_cbranch_scc1 .Latt_bc
    s_branch .Latt_n
.Le_a:
    s_mov_b32 s14, 0x6ddb76dd
    s_mov_b32 s15, 0xdb76ddb7
    s_add_u32 s30, s70, -50
    s_mov_b32 s48, s12
    s_and_b32 s49, s13, 0xffff
    s_mov_b32 s50, 0x480000
    s_mov_b32 s51, 0x00020000
    v_bfe_u32 v12, v0, 4, 1
    s_and_b32 s56, s3, 1
    s_lshl_b32 s56, s56, 2
    v_lshl_or_b32 v12, v12, 1, s56
    v_and_b32 v13, 7, v0
    v_xor_b32 v12, v12, v13
    v_lshrrev_b32 v13, 3, v0
    v_mul_u32_u24 v13, 1152, v13
    v_lshl_add_u32 v6, v12, 4, v13
    s_lshl_b32 s101, s64, 6
    s_add_u32 s101, s101, s3
    s_mul_i32 s101, s101, 9216
    s_lshl_b32 s56, s65, 7
    s_add_u32 s101, s101, s56
    s_lshl_b32 s100, s3, 10
    s_waitcnt vmcnt(3)
    s_add_u32 m0, s100, 0
    s_add_u32 s56, s101, 0
    buffer_load_dwordx4 v6, s[48:51], s56 offen nt lds
    s_waitcnt vmcnt(3)
    s_bitcmp1_b64 s[14:15], 4
    s_cbranch_scc0 1
    s_waitcnt vmcnt(2)
    s_add_u32 s63, s69, 32768
    buffer_load_dwordx4 v[96:99], v1, s[40:43], s63 offen nt
    s_waitcnt vmcnt(3)
    s_add_u32 m0, s100, 8192
    s_add_u32 s56, s101, 73728
    buffer_load_dwordx4 v6, s[48:51], s56 offen nt lds
    s_waitcnt vmcnt(3)
    s_bitcmp1_b64 s[14:15], 5
    s_cbranch_scc0 1
    s_waitcnt vmcnt(2)
    s_add_u32 s63, s69, 40960
    buffer_load_dwordx4 v[100:103], v1, s[40:43], s63 offen nt
    s_waitcnt vmcnt(3)
    s_bitcmp1_b64 s[14:15], 6
    s_cbranch_scc0 1
    s_waitcnt vmcnt(2)
    s_add_u32 s63, s69, 49152
    buffer_load_dwordx4 v[128:131], v1, s[40:43], s63 offen nt
    s_waitcnt vmcnt(3)
    s_bitcmp1_b64 s[14:15], 7
    s_cbranch_scc0 1
    s_waitcnt vmcnt(2)
    s_add_u32 s63, s69, 57344
    buffer_load_dwordx4 v[132:135], v1, s[40:43], s63 offen nt
    s_waitcnt vmcnt(3)
    s_add_u32 m0, s100, 16384
    s_add_u32 s56, s101, 147456
    buffer_load_dwordx4 v6, s[48:51], s56 offen nt lds
    s_waitcnt vmcnt(3)
    s_bitcmp1_b64 s[14:15], 8
    s_cbranch_scc0 1
    s_waitcnt vmcnt(2)
    s_add_u32 s63, s69, 131072
    buffer_load_dwordx4 v[40:43], v1, s[40:43], s63 offen nt
    s_waitcnt vmcnt(3)
    s_bitcmp1_b64 s[14:15], 9
    s_cbranch_scc0 1
    s_waitcnt vmcnt(2)
    s_add_u32 s63, s69, 139264
    buffer_load_dwordx4 v[44:47], v1, s[40:43], s63 offen nt
    s_memrealtime s[8:9]
    s_waitcnt lgkmcnt(0)
    s_sub_u32 s8, s8, s30
    s_cmpk_ge_u32 s8, 436
    s_cbranch_scc1 .ap_47
    s_waitcnt vmcnt(4)
    s_cmpk_ge_u32 s8, 371
    s_cbranch_scc1 .ap_47
    s_waitcnt vmcnt(3)
    s_bitcmp1_b64 s[14:15], 10
    s_cbranch_scc0 1
    s_waitcnt vmcnt(2)
    s_cmpk_ge_u32 s8, 296
    s_cbranch_scc1 .ap_47
    s_waitcnt vmcnt(1)
.ap_47:
    s_add_u32 s63, s69, 147456
    buffer_load_dwordx4 v[72:75], v1, s[40:43], s63 offen nt
    s_waitcnt vmcnt(3)
    s_add_u32 m0, s100, 24576
    s_add_u32 s56, s101, 221184
    buffer_load_dwordx4 v6, s[48:51], s56 offen nt lds
    s_memrealtime s[8:9]
    s_waitcnt lgkmcnt(0)
    s_sub_u32 s8, s8, s30
    s_cmpk_ge_u32 s8, 482
    s_cbranch_scc1 .ap_48
    s_waitcnt vmcnt(4)
    s_cmpk_ge_u32 s8, 417
    s_cbranch_scc1 .ap_48
    s_waitcnt vmcnt(3)
    s_bitcmp1_b64 s[14:15], 11
    s_cbranch_scc0 1
    s_waitcnt vmcnt(2)
    s_cmpk_ge_u32 s8, 342
    s_cbranch_scc1 .ap_48
    s_waitcnt vmcnt(1)
.ap_48:
    s_add_u32 s63, s69, 155648
    buffer_load_dwordx4 v[76:79], v1, s[40:43], s63 offen nt
    s_waitcnt lgkmcnt(0)
    s_mul_i32 s34, s34, 0x9e3779b1
    s_add_u32 s34, s34, 0x7f4a7c15
    s_memrealtime s[8:9]
    s_waitcnt lgkmcnt(0)
    s_sub_u32 s8, s8, s30
    s_cmpk_ge_u32 s8, 528
    s_cbranch_scc1 .ap_49
    s_waitcnt vmcnt(5)
    s_cmpk_ge_u32 s8, 463
    s_cbranch_scc1 .ap_49
    s_waitcnt vmcnt(3)
    s_bitcmp1_b64 s[14:15], 12
    s_cbranch_scc0 1
    s_waitcnt vmcnt(2)
    s_cmpk_ge_u32 s8, 388
    s_cbranch_scc1 .ap_49
    s_waitcnt vmcnt(1)
.ap_49:
    s_add_u32 s63, s69, 163840
    buffer_load_dwordx4 v[104:107], v1, s[40:43], s63 offen nt
    s_memrealtime s[8:9]
    s_waitcnt lgkmcnt(0)
    s_sub_u32 s8, s8, s30
    s_cmpk_ge_u32 s8, 574
    s_cbranch_scc1 .ap_50
    s_waitcnt vmcnt(5)
    s_cmpk_ge_u32 s8, 509
    s_cbranch_scc1 .ap_50
    s_waitcnt vmcnt(3)
    s_bitcmp1_b64 s[14:15], 13
    s_cbranch_scc0 1
    s_waitcnt vmcnt(2)
    s_cmpk_ge_u32 s8, 434
    s_cbranch_scc1 .ap_50
    s_waitcnt vmcnt(1)
.ap_50:
    s_add_u32 s63, s69, 172032
    buffer_load_dwordx4 v[108:111], v1, s[40:43], s63 offen nt
    s_waitcnt vmcnt(3)
    s_add_u32 m0, s100, 32768
    s_add_u32 s56, s101, 294912
    buffer_load_dwordx4 v6, s[48:51], s56 offen nt lds
    s_memrealtime s[8:9]
    s_waitcnt lgkmcnt(0)
    s_sub_u32 s8, s8, s30
    s_cmpk_ge_u32 s8, 620
    s_cbranch_scc1 .ap_51
    s_waitcnt vmcnt(4)
    s_cmpk_ge_u32 s8, 555
    s_cbranch_scc1 .ap_51
    s_waitcnt vmcnt(3)
    s_bitcmp1_b64 s[14:15], 14
    s_cbranch_scc0 1
    s_waitcnt vmcnt(2)
    s_cmpk_ge_u32 s8, 480
    s_cbranch_scc1 .ap_51
    s_waitcnt vmcnt(1)
.ap_51:
    s_add_u32 s63, s69, 180224
    buffer_load_dwordx4 v[136:139], v1, s[40:43], s63 offen nt
    s_memrealtime s[8:9]
    s_waitcnt lgkmcnt(0)
    s_sub_u32 s8, s8, s30
    s_cmpk_ge_u32 s8, 666
    s_cbranch_scc1 .ap_52
    s_waitcnt vmcnt(5)
    s_cmpk_ge_u32 s8, 601
    s_cbranch_scc1 .ap_52
    s_waitcnt vmcnt(3)
    s_bitcmp1_b64 s[14:15], 15
    s_cbranch_scc0 1
    s_waitcnt vmcnt(2)
    s_cmpk_ge_u32 s8, 526
    s_cbranch_scc1 .ap_52
    s_waitcnt vmcnt(1)
.ap_52:
    s_add_u32 s63, s69, 188416
    buffer_load_dwordx4 v[140:143], v1, s[40:43], s63 offen nt
    s_memrealtime s[8:9]
    s_waitcnt lgkmcnt(0)
    s_sub_u32 s8, s8, s30
    s_cmpk_ge_u32 s8, 712
    s_cbranch_scc1 .ap_53
    s_waitcnt vmcnt(5)
    s_cmpk_ge_u32 s8, 647
    s_cbranch_scc1 .ap_53
    s_waitcnt vmcnt(3)
    s_bitcmp1_b64 s[14:15], 16
    s_cbranch_scc0 1
    s_waitcnt vmcnt(2)
    s_cmpk_ge_u32 s8, 572
    s_cbranch_scc1 .ap_53
    s_waitcnt vmcnt(1)
.ap_53:
    s_add_u32 s63, s69, 262144
    buffer_load_dwordx4 v[48:51], v1, s[40:43], s63 offen nt
    s_waitcnt vmcnt(3)
    s_add_u32 m0, s100, 40960
    s_add_u32 s56, s101, 368640
    buffer_load_dwordx4 v6, s[48:51], s56 offen nt lds
    s_memrealtime s[8:9]
    s_waitcnt lgkmcnt(0)
    s_sub_u32 s8, s8, s30
    s_cmpk_ge_u32 s8, 758
    s_cbranch_scc1 .ap_54
    s_waitcnt vmcnt(4)
    s_cmpk_ge_u32 s8, 693
    s_cbranch_scc1 .ap_54
    s_waitcnt vmcnt(3)
    s_bitcmp1_b64 s[14:15], 17
    s_cbranch_scc0 1
    s_waitcnt vmcnt(2)
    s_cmpk_ge_u32 s8, 618
    s_cbranch_scc1 .ap_54
    s_waitcnt vmcnt(1)
.ap_54:
    s_add_u32 s63, s69, 270336
    buffer_load_dwordx4 v[52:55], v1, s[40:43], s63 offen nt
    s_memrealtime s[8:9]
    s_waitcnt lgkmcnt(0)
    s_sub_u32 s8, s8, s30
    s_cmpk_ge_u32 s8, 804
    s_cbranch_scc1 .ap_55
    s_waitcnt vmcnt(5)
    s_cmpk_ge_u32 s8, 739
    s_cbranch_scc1 .ap_55
    s_waitcnt vmcnt(3)
    s_bitcmp1_b64 s[14:15], 18
    s_cbranch_scc0 1
    s_waitcnt vmcnt(2)
    s_cmpk_ge_u32 s8, 664
    s_cbranch_scc1 .ap_55
    s_waitcnt vmcnt(1)
.ap_55:
    s_add_u32 s63, s69, 278528
    buffer_load_dwordx4 v[80:83], v1, s[40:43], s63 offen nt
    v_and_b32 v157, 7, v0
    v_lshlrev_b32 v157, 7, v157
    s_mov_b32 s63, 0x400
    buffer_load_dword v156, v157, s[36:39], s63 offen
    s_memrealtime s[8:9]
    s_waitcnt lgkmcnt(0)
    s_sub_u32 s8, s8, s30
    s_cmpk_ge_u32 s8, 850
    s_cbranch_scc1 .ap_56
    s_waitcnt vmcnt(6)
    s_cmpk_ge_u32 s8, 785
    s_cbranch_scc1 .ap_56
    s_waitcnt vmcnt(4)
    s_bitcmp1_b64 s[14:15], 19
    s_cbranch_scc0 1
    s_waitcnt vmcnt(3)
    s_cmpk_ge_u32 s8, 710
    s_cbranch_scc1 .ap_56
    s_waitcnt vmcnt(2)
.ap_56:
    s_add_u32 s63, s69, 286720
    buffer_load_dwordx4 v[84:87], v1, s[40:43], s63 offen nt
    s_waitcnt vmcnt(4)
    s_add_u32 m0, s100, 49152
    s_add_u32 s56, s101, 442368
    buffer_load_dwordx4 v6, s[48:51], s56 offen nt lds
    s_memrealtime s[8:9]
    s_waitcnt lgkmcnt(0)
    s_sub_u32 s8, s8, s30
    s_cmpk_ge_u32 s8, 895
    s_cbranch_scc1 .ap_57
    s_waitcnt vmcnt(5)
    s_cmpk_ge_u32 s8, 830
    s_cbranch_scc1 .ap_57
    s_waitcnt vmcnt(4)
    s_bitcmp1_b64 s[14:15], 20
    s_cbranch_scc0 1
    s_waitcnt vmcnt(3)
    s_cmpk_ge_u32 s8, 755
    s_cbranch_scc1 .ap_57
    s_waitcnt vmcnt(1)
.ap_57:
    s_add_u32 s63, s69, 294912
    buffer_load_dwordx4 v[112:115], v1, s[40:43], s63 offen nt
    s_memrealtime s[8:9]
    s_waitcnt lgkmcnt(0)
    s_sub_u32 s8, s8, s30
    s_cmpk_ge_u32 s8, 940
    s_cbranch_scc1 .ap_58
    s_waitcnt vmcnt(6)
    s_cmpk_ge_u32 s8, 875
    s_cbranch_scc1 .ap_58
    s_waitcnt vmcnt(4)
    s_bitcmp1_b64 s[14:15], 21
    s_cbranch_scc0 1
    s_waitcnt vmcnt(2)
    s_cmpk_ge_u32 s8, 800
    s_cbranch_scc1 .ap_58
    s_waitcnt vmcnt(1)
.ap_58:
    s_add_u32 s63, s69, 303104
    buffer_load_dwordx4 v[116:119], v1, s[40:43], s63 offen nt
    s_memrealtime s[8:9]
    s_waitcnt lgkmcnt(0)
    s_sub_u32 s8, s8, s30
    s_cmpk_ge_u32 s8, 985
    s_cbranch_scc1 .ap_59
    s_waitcnt vmcnt(6)
    s_cmpk_ge_u32 s8, 920
    s_cbranch_scc1 .ap_59
    s_waitcnt vmcnt(3)
    s_bitcmp1_b64 s[14:15], 22
    s_cbranch_scc0 1
    s_waitcnt vmcnt(2)
    s_cmpk_ge_u32 s8, 845
    s_cbranch_scc1 .ap_59
    s_waitcnt vmcnt(1)
.ap_59:
    s_add_u32 s63, s69, 311296
    buffer_load_dwordx4 v[144:147], v1, s[40:43], s63 offen nt
    s_waitcnt vmcnt(5)
    s_sub_u32 s63, s70, 300
    v_subrev_u32 v156, s63, v156
    v_mov_b32 v157, 600
    v_cmp_lt_u32 s[8:9], v156, v157
    v_add_u32_dpp v156, v156, v156 quad_perm:[1,0,3,2] row_mask:0xf bank_mask:0xf
    s_nop 1
    v_add_u32_dpp v156, v156, v156 quad_perm:[2,3,0,1] row_mask:0xf bank_mask:0xf
    s_nop 1
    v_add_u32_dpp v156, v156, v156 row_ror:4 row_mask:0xf bank_mask:0xf
    s_nop 0
    v_readfirstlane_b32 s63, v156
    s_cmp_eq_u64 s[8:9], -1
    s_nop 3
    s_cbranch_scc0 .et_60
    s_lshr_b32 s63, s63, 3
    s_sub_u32 s63, s63, 300
    s_add_u32 s30, s30, s63
.et_60:
    s_waitcnt vmcnt(3)
    s_add_u32 m0, s100, 57344
    s_add_u32 s56, s101, 516096
    buffer_load_dwordx4 v6, s[48:51], s56 offen nt lds
    s_memrealtime s[8:9]
    s_waitcnt lgkmcnt(0)
    s_sub_u32 s8, s8, s30
    s_cmpk_ge_u32 s8, 1030
    s_cbranch_scc1 .ap_61
    s_waitcnt vmcnt(4)
    s_cmpk_ge_u32 s8, 965
    s_cbranch_scc1 .ap_61
    s_waitcnt vmcnt(3)
    s_bitcmp1_b64 s[14:15], 23
    s_cbranch_scc0 1
    s_waitcnt vmcnt(2)
    s_cmpk_ge_u32 s8, 890
    s_cbranch_scc1 .ap_61
    s_waitcnt vmcnt(1)
.ap_61:
    s_add_u32 s63, s69, 319488
    buffer_load_dwordx4 v[148:151], v1, s[40:43], s63 offen nt
    s_memrealtime s[8:9]
    s_waitcnt lgkmcnt(0)
    s_sub_u32 s8, s8, s30
    s_cmpk_ge_u32 s8, 1075
    s_cbranch_scc1 .ap_62
    s_waitcnt vmcnt(5)
    s_cmpk_ge_u32 s8, 1010
    s_cbranch_scc1 .ap_62
    s_waitcnt vmcnt(3)
    s_bitcmp1_b64 s[14:15], 24
    s_cbranch_scc0 1
    s_waitcnt vmcnt(2)
    s_cmpk_ge_u32 s8, 935
    s_cbranch_scc1 .ap_62
    s_waitcnt vmcnt(1)
.ap_62:
    s_add_u32 s63, s69, 393216
    buffer_load_dwordx4 v[56:59], v1, s[40:43], s63 offen nt
    s_memrealtime s[8:9]
    s_waitcnt lgkmcnt(0)
    s_sub_u32 s8, s8, s30
    s_cmpk_ge_u32 s8, 1120
    s_cbranch_scc1 .ap_63
    s_waitcnt vmcnt(5)
    s_cmpk_ge_u32 s8, 1055
    s_cbranch_scc1 .ap_63
    s_waitcnt vmcnt(3)
    s_bitcmp1_b64 s[14:15], 25
    s_cbranch_scc0 1
    s_waitcnt vmcnt(2)
    s_cmpk_ge_u32 s8, 980
    s_cbranch_scc1 .ap_63
    s_waitcnt vmcnt(1)
.ap_63:
    s_add_u32 s63, s69, 401408
    buffer_load_dwordx4 v[60:63], v1, s[40:43], s63 offen nt
.Latt_ar:
    v_and_b32 v8, 1, v0
    v_lshlrev_b32 v8, 8, v8
    v_and_b32 v9, 0x3c, v0
    v_lshl_add_u32 v9, v9, 2, v8
    v_lshlrev_b32 v7, 1, v9
    v_and_b32 v9, 0x3c, v0
    v_lshrrev_b32 v8, 4, v8
    v_and_b32 v9, 2, v0
    v_lshl_add_u32 v9, v9, 6, v8
    s_lshl_b32 s58, s66, 14
    s_lshl_b32 s59, s67, 10
    s_add_u32 s58, s58, s59
    s_add_u32 s58, s58, 0x40000
    s_lshl4_add_u32 s59, s66, s67
    s_lshl_b32 s59, s59, 8
    s_add_u32 s59, s59, 0x200000
    s_memrealtime s[8:9]
    s_waitcnt vmcnt(8)
    s_waitcnt lgkmcnt(0)
    s_sub_u32 s8, s8, s30
    s_cmpk_ge_u32 s8, 1147
    s_cbranch_scc1 .ap_64
    s_waitcnt vmcnt(5)
    s_cmpk_ge_u32 s8, 1082
    s_cbranch_scc1 .ap_64
    s_waitcnt vmcnt(3)
    s_bitcmp1_b64 s[14:15], 26
    s_cbranch_scc0 1
    s_waitcnt vmcnt(2)
    s_cmpk_ge_u32 s8, 1007
    s_cbranch_scc1 .ap_64
    s_waitcnt vmcnt(1)
.ap_64:
    s_add_u32 s63, s69, 409600
    buffer_load_dwordx4 v[88:91], v1, s[40:43], s63 offen nt
    s_memrealtime s[8:9]
    s_waitcnt vmcnt(8)
    s_waitcnt lgkmcnt(0)
    s_sub_u32 s8, s8, s30
    s_cmpk_ge_u32 s8, 1174
    s_cbranch_scc1 .ap_65
    s_waitcnt vmcnt(5)
    s_cmpk_ge_u32 s8, 1109
    s_cbranch_scc1 .ap_65
    s_waitcnt vmcnt(3)
    s_bitcmp1_b64 s[14:15], 27
    s_cbranch_scc0 1
    s_waitcnt vmcnt(2)
    s_cmpk_ge_u32 s8, 1034
    s_cbranch_scc1 .ap_65
    s_waitcnt vmcnt(1)
.ap_65:
    s_add_u32 s63, s69, 417792
    buffer_load_dwordx4 v[92:95], v1, s[40:43], s63 offen nt
    s_memrealtime s[8:9]
    s_waitcnt vmcnt(8)
    s_waitcnt lgkmcnt(0)
    s_sub_u32 s8, s8, s30
    s_cmpk_ge_u32 s8, 1201
    s_cbranch_scc1 .ap_66
    s_waitcnt vmcnt(5)
    s_cmpk_ge_u32 s8, 1136
    s_cbranch_scc1 .ap_66
    s_waitcnt vmcnt(3)
    s_bitcmp1_b64 s[14:15], 28
    s_cbranch_scc0 1
    s_waitcnt vmcnt(2)
    s_cmpk_ge_u32 s8, 1061
    s_cbranch_scc1 .ap_66
    s_waitcnt vmcnt(1)
.ap_66:
    s_add_u32 s63, s69, 425984
    buffer_load_dwordx4 v[120:123], v1, s[40:43], s63 offen nt
    s_memrealtime s[8:9]
    s_waitcnt vmcnt(8)
    s_waitcnt lgkmcnt(0)
    s_sub_u32 s8, s8, s30
    s_cmpk_ge_u32 s8, 1228
    s_cbranch_scc1 .ap_67
    s_waitcnt vmcnt(5)
    s_cmpk_ge_u32 s8, 1163
    s_cbranch_scc1 .ap_67
    s_waitcnt vmcnt(3)
    s_bitcmp1_b64 s[14:15], 29
    s_cbranch_scc0 1
    s_waitcnt vmcnt(2)
    s_cmpk_ge_u32 s8, 1088
    s_cbranch_scc1 .ap_67
    s_waitcnt vmcnt(1)
.ap_67:
    s_add_u32 s63, s69, 434176
    buffer_load_dwordx4 v[124:127], v1, s[40:43], s63 offen nt
    s_memrealtime s[8:9]
    s_waitcnt vmcnt(8)
    s_waitcnt lgkmcnt(0)
    s_sub_u32 s8, s8, s30
    s_cmpk_ge_u32 s8, 1255
    s_cbranch_scc1 .ap_68
    s_waitcnt vmcnt(5)
    s_cmpk_ge_u32 s8, 1190
    s_cbranch_scc1 .ap_68
    s_waitcnt vmcnt(3)
    s_bitcmp1_b64 s[14:15], 30
    s_cbranch_scc0 1
    s_waitcnt vmcnt(2)
    s_cmpk_ge_u32 s8, 1115
    s_cbranch_scc1 .ap_68
    s_waitcnt vmcnt(1)
.ap_68:
    s_add_u32 s63, s69, 442368
    buffer_load_dwordx4 v[152:155], v1, s[40:43], s63 offen nt
    s_memrealtime s[8:9]
    s_waitcnt vmcnt(8)
    s_waitcnt lgkmcnt(0)
    s_sub_u32 s8, s8, s30
    s_cmpk_ge_u32 s8, 1282
    s_cbranch_scc1 .ap_69
    s_waitcnt vmcnt(5)
    s_cmpk_ge_u32 s8, 1217
    s_cbranch_scc1 .ap_69
    s_waitcnt vmcnt(3)
    s_bitcmp1_b64 s[14:15], 31
    s_cbranch_scc0 1
    s_waitcnt vmcnt(2)
    s_cmpk_ge_u32 s8, 1142
    s_cbranch_scc1 .ap_69
    s_waitcnt vmcnt(1)
.ap_69:
    s_add_u32 s63, s69, 450560
    buffer_load_dwordx4 v[156:159], v1, s[40:43], s63 offen nt
    buffer_load_dwordx4 v[16:19], v7, s[36:39], s58 offen offset:0 sc1
    buffer_load_dwordx4 v[20:23], v7, s[36:39], s58 offen offset:16 sc1
    s_memrealtime s[8:9]
    s_waitcnt vmcnt(8)
    s_waitcnt lgkmcnt(0)
    s_sub_u32 s8, s8, s30
    s_cmpk_ge_u32 s8, 1309
    s_cbranch_scc1 .ap_70
    s_waitcnt vmcnt(5)
    s_cmpk_ge_u32 s8, 1244
    s_cbranch_scc1 .ap_70
    s_waitcnt vmcnt(3)
    s_bitcmp1_b64 s[14:15], 32
    s_cbranch_scc0 1
    s_waitcnt vmcnt(2)
    s_cmpk_ge_u32 s8, 1169
    s_cbranch_scc1 .ap_70
    s_waitcnt vmcnt(1)
.ap_70:
    s_add_u32 s63, s69, 0
    buffer_load_dwordx4 v[160:163], v2, s[44:47], s63 offen nt
    s_memrealtime s[8:9]
    s_waitcnt vmcnt(8)
    s_waitcnt lgkmcnt(0)
    s_sub_u32 s8, s8, s30
    s_cmpk_ge_u32 s8, 1336
    s_cbranch_scc1 .ap_71
    s_waitcnt vmcnt(5)
    s_cmpk_ge_u32 s8, 1271
    s_cbranch_scc1 .ap_71
    s_waitcnt vmcnt(3)
    s_bitcmp1_b64 s[14:15], 33
    s_cbranch_scc0 1
    s_waitcnt vmcnt(2)
    s_cmpk_ge_u32 s8, 1196
    s_cbranch_scc1 .ap_71
    s_waitcnt vmcnt(1)
.ap_71:
    s_add_u32 s63, s69, 8192
    buffer_load_dwordx4 v[164:167], v2, s[44:47], s63 offen nt
    s_memrealtime s[8:9]
    s_waitcnt vmcnt(8)
    s_waitcnt lgkmcnt(0)
    s_sub_u32 s8, s8, s30
    s_cmpk_ge_u32 s8, 1363
    s_cbranch_scc1 .ap_72
    s_waitcnt vmcnt(5)
    s_cmpk_ge_u32 s8, 1298
    s_cbranch_scc1 .ap_72
    s_waitcnt vmcnt(3)
    s_bitcmp1_b64 s[14:15], 34
    s_cbranch_scc0 1
    s_waitcnt vmcnt(2)
    s_cmpk_ge_u32 s8, 1223
    s_cbranch_scc1 .ap_72
    s_waitcnt vmcnt(1)
.ap_72:
    s_add_u32 s63, s69, 16384
    buffer_load_dwordx4 v[168:171], v2, s[44:47], s63 offen nt
    s_waitcnt vmcnt(3)
    s_branch .gpc_74
.gp_73:
    buffer_load_dwordx4 v[16:19], v7, s[36:39], s58 offen offset:0 sc1
    buffer_load_dwordx4 v[20:23], v7, s[36:39], s58 offen offset:16 sc1
    s_waitcnt vmcnt(0)
.gpc_74:
    v_min_u32 v10, v17, v19
    v_max_u32 v11, v17, v19
    v_min3_u32 v10, v10, v21, v23
    v_max3_u32 v11, v11, v21, v23
    v_cmp_eq_u32 vcc, s34, v10
    v_cmp_eq_u32 s[56:57], s34, v11
    s_and_b64 vcc, vcc, s[56:57]
    s_cmp_eq_u64 vcc, exec
    s_nop 2
    s_cbranch_scc1 .gpd_75
    s_sub_u32 s35, s35, 1
    s_cbranch_scc1 .Lexit
    s_sleep 1
    s_branch .gp_73
.gpd_75:
    s_mov_b32 vcc_lo, 0xcccccccc
    s_mov_b32 vcc_hi, 0xcccccccc
    v_cndmask_b32_e64 v24, v16, 0, vcc
    v_cndmask_b32_e64 v25, v18, 0, vcc
    v_cndmask_b32_e64 v26, v20, 0, vcc
    v_cndmask_b32_e64 v27, v22, 0, vcc
    v_cndmask_b32_e32 v28, 0, v16, vcc
    v_cndmask_b32_e32 v29, 0, v18, vcc
    v_cndmask_b32_e32 v30, 0, v20, vcc
    v_cndmask_b32_e32 v31, 0, v22, vcc
    v_mfma_f32_16x16x32_bf16 v[16:19], v[32:35], v[24:27], 0
    v_mfma_f32_16x16x32_bf16 v[32:35], v[40:43], v[24:27], 0
    v_mfma_f32_16x16x32_bf16 v[16:19], v[36:39], v[28:31], v[16:19]
    v_mfma_f32_16x16x32_bf16 v[40:43], v[48:51], v[24:27], 0
    v_mfma_f32_16x16x32_bf16 v[32:35], v[44:47], v[28:31], v[32:35]
    v_mfma_f32_16x16x32_bf16 v[48:51], v[56:59], v[24:27], 0
    v_mfma_f32_16x16x32_bf16 v[40:43], v[52:55], v[28:31], v[40:43]
    v_mfma_f32_16x16x32_bf16 v[56:59], v[64:67], v[24:27], 0
    v_mfma_f32_16x16x32_bf16 v[48:51], v[60:63], v[28:31], v[48:51]
    s_nop 1
    v_add_f32_dpp v10, v17, v16 row_ror:12 row_mask:0xf bank_mask:0x1
    s_memrealtime s[8:9]
    s_waitcnt lgkmcnt(0)
    s_sub_u32 s8, s8, s30
    s_cmpk_ge_u32 s8, 1390
    s_nop 0
    s_cbranch_scc1 .ap_76
    s_waitcnt vmcnt(3)
    s_cmpk_ge_u32 s8, 1325
    s_cbranch_scc1 .ap_76
    s_waitcnt vmcnt(3)
    s_bitcmp1_b64 s[14:15], 35
    s_cbranch_scc0 1
    s_waitcnt vmcnt(2)
    s_cmpk_ge_u32 s8, 1250
    s_cbranch_scc1 .ap_76
    s_waitcnt vmcnt(1)
.ap_76:
    s_add_u32 s63, s69, 24576
    buffer_load_dwordx4 v[172:175], v2, s[44:47], s63 offen nt
    v_mfma_f32_16x16x32_bf16 v[64:67], v[72:75], v[24:27], 0
    v_mfma_f32_16x16x32_bf16 v[56:59], v[68:71], v[28:31], v[56:59]
    v_add_f32_dpp v11, v33, v32 row_ror:12 row_mask:0xf bank_mask:0x1
    v_add_f32_dpp v10, v18, v10 row_ror:8 row_mask:0xf bank_mask:0x1
    v_mfma_f32_16x16x32_bf16 v[72:75], v[80:83], v[24:27], 0
    v_mfma_f32_16x16x32_bf16 v[64:67], v[76:79], v[28:31], v[64:67]
    v_add_f32_dpp v12, v41, v40 row_ror:12 row_mask:0xf bank_mask:0x1
    v_add_f32_dpp v11, v34, v11 row_ror:8 row_mask:0xf bank_mask:0x1
    v_add_f32_dpp v10, v19, v10 row_ror:4 row_mask:0xf bank_mask:0x1
    v_mfma_f32_16x16x32_bf16 v[80:83], v[88:91], v[24:27], 0
    v_mfma_f32_16x16x32_bf16 v[72:75], v[84:87], v[28:31], v[72:75]
    v_add_f32_dpp v13, v49, v48 row_ror:12 row_mask:0xf bank_mask:0x1
    v_add_f32_dpp v12, v42, v12 row_ror:8 row_mask:0xf bank_mask:0x1
    v_add_f32_dpp v11, v35, v11 row_ror:4 row_mask:0xf bank_mask:0x1
    v_mfma_f32_16x16x32_bf16 v[88:91], v[96:99], v[24:27], 0
    v_mfma_f32_16x16x32_bf16 v[80:83], v[92:95], v[28:31], v[80:83]
    v_add_f32_dpp v10, v58, v57 row_ror:12 row_mask:0xf bank_mask:0x2
    v_add_f32_dpp v13, v50, v13 row_ror:8 row_mask:0xf bank_mask:0x1
    v_add_f32_dpp v12, v43, v12 row_ror:4 row_mask:0xf bank_mask:0x1
    s_memrealtime s[8:9]
    s_waitcnt lgkmcnt(0)
    s_sub_u32 s8, s8, s30
    s_cmpk_ge_u32 s8, 1417
    s_nop 0
    s_cbranch_scc1 .ap_77
    s_waitcnt vmcnt(4)
    s_cmpk_ge_u32 s8, 1352
    s_cbranch_scc1 .ap_77
    s_waitcnt vmcnt(3)
    s_bitcmp1_b64 s[14:15], 36
    s_cbranch_scc0 1
    s_waitcnt vmcnt(2)
    s_cmpk_ge_u32 s8, 1277
    s_cbranch_scc1 .ap_77
    s_waitcnt vmcnt(1)
.ap_77:
    s_add_u32 s63, s69, 32768
    buffer_load_dwordx4 v[176:179], v2, s[44:47], s63 offen nt
    v_mfma_f32_16x16x32_bf16 v[96:99], v[104:107], v[24:27], 0
    v_mfma_f32_16x16x32_bf16 v[88:91], v[100:103], v[28:31], v[88:91]
    v_add_f32_dpp v11, v66, v65 row_ror:12 row_mask:0xf bank_mask:0x2
    v_add_f32_dpp v10, v59, v10 row_ror:8 row_mask:0xf bank_mask:0x2
    v_add_f32_dpp v13, v51, v13 row_ror:4 row_mask:0xf bank_mask:0x1
    v_mfma_f32_16x16x32_bf16 v[104:107], v[112:115], v[24:27], 0
    v_mfma_f32_16x16x32_bf16 v[96:99], v[108:111], v[28:31], v[96:99]
    v_add_f32_dpp v12, v74, v73 row_ror:12 row_mask:0xf bank_mask:0x2
    v_add_f32_dpp v11, v67, v11 row_ror:8 row_mask:0xf bank_mask:0x2
    v_add_f32_dpp v10, v56, v10 row_ror:4 row_mask:0xf bank_mask:0x2
    v_mfma_f32_16x16x32_bf16 v[112:115], v[120:123], v[24:27], 0
    v_mfma_f32_16x16x32_bf16 v[104:107], v[116:119], v[28:31], v[104:107]
    v_add_f32_dpp v13, v82, v81 row_ror:12 row_mask:0xf bank_mask:0x2
    v_add_f32_dpp v12, v75, v12 row_ror:8 row_mask:0xf bank_mask:0x2
    v_add_f32_dpp v11, v64, v11 row_ror:4 row_mask:0xf bank_mask:0x2
    v_mfma_f32_16x16x32_bf16 v[120:123], v[128:131], v[24:27], 0
    v_mfma_f32_16x16x32_bf16 v[112:115], v[124:127], v[28:31], v[112:115]
    v_add_f32_dpp v10, v91, v90 row_ror:12 row_mask:0xf bank_mask:0x4
    v_add_f32_dpp v13, v83, v13 row_ror:8 row_mask:0xf bank_mask:0x2
    v_add_f32_dpp v12, v72, v12 row_ror:4 row_mask:0xf bank_mask:0x2
    s_memrealtime s[8:9]
    s_waitcnt lgkmcnt(0)
    s_sub_u32 s8, s8, s30
    s_cmpk_ge_u32 s8, 1444
    s_nop 0
    s_cbranch_scc1 .ap_78
    s_waitcnt vmcnt(5)
    s_cmpk_ge_u32 s8, 1379
    s_cbranch_scc1 .ap_78
    s_waitcnt vmcnt(3)
    s_bitcmp1_b64 s[14:15], 37
    s_cbranch_scc0 1
    s_waitcnt vmcnt(2)
    s_cmpk_ge_u32 s8, 1304
    s_cbranch_scc1 .ap_78
    s_waitcnt vmcnt(1)
.ap_78:
    s_add_u32 s63, s69, 40960
    buffer_load_dwordx4 v[180:183], v2, s[44:47], s63 offen nt
    v_mfma_f32_16x16x32_bf16 v[128:131], v[136:139], v[24:27], 0
    v_mfma_f32_16x16x32_bf16 v[120:123], v[132:135], v[28:31], v[120:123]
    v_add_f32_dpp v11, v99, v98 row_ror:12 row_mask:0xf bank_mask:0x4
    v_add_f32_dpp v10, v88, v10 row_ror:8 row_mask:0xf bank_mask:0x4
    v_add_f32_dpp v13, v80, v13 row_ror:4 row_mask:0xf bank_mask:0x2
    v_mfma_f32_16x16x32_bf16 v[136:139], v[144:147], v[24:27], 0
    v_mfma_f32_16x16x32_bf16 v[128:131], v[140:143], v[28:31], v[128:131]
    v_add_f32_dpp v12, v107, v106 row_ror:12 row_mask:0xf bank_mask:0x4
    v_add_f32_dpp v11, v96, v11 row_ror:8 row_mask:0xf bank_mask:0x4
    v_add_f32_dpp v10, v89, v10 row_ror:4 row_mask:0xf bank_mask:0x4
    v_mfma_f32_16x16x32_bf16 v[144:147], v[152:155], v[24:27], 0
    v_mfma_f32_16x16x32_bf16 v[136:139], v[148:151], v[28:31], v[136:139]
    v_add_f32_dpp v13, v115, v114 row_ror:12 row_mask:0xf bank_mask:0x4
    v_add_f32_dpp v12, v104, v12 row_ror:8 row_mask:0xf bank_mask:0x4
    v_add_f32_dpp v11, v97, v11 row_ror:4 row_mask:0xf bank_mask:0x4
    v_mfma_f32_16x16x32_bf16 v[144:147], v[156:159], v[28:31], v[144:147]
    v_add_f32_dpp v10, v120, v123 row_ror:12 row_mask:0xf bank_mask:0x8
    v_add_f32_dpp v13, v112, v13 row_ror:8 row_mask:0xf bank_mask:0x4
    v_add_f32_dpp v12, v105, v12 row_ror:4 row_mask:0xf bank_mask:0x4
    s_memrealtime s[8:9]
    s_waitcnt lgkmcnt(0)
    s_sub_u32 s8, s8, s30
    s_cmpk_ge_u32 s8, 1471
    s_nop 0
    s_cbranch_scc1 .ap_79
    s_waitcnt vmcnt(5)
    s_cmpk_ge_u32 s8, 1406
    s_cbranch_scc1 .ap_79
    s_waitcnt vmcnt(3)
    s_bitcmp1_b64 s[14:15], 38
    s_cbranch_scc0 1
    s_waitcnt vmcnt(2)
    s_cmpk_ge_u32 s8, 1331
    s_cbranch_scc1 .ap_79
    s_waitcnt vmcnt(1)
.ap_79:
    s_add_u32 s63, s69, 49152
    buffer_load_dwordx4 v[184:187], v2, s[44:47], s63 offen nt
    v_add_f32_dpp v11, v128, v131 row_ror:12 row_mask:0xf bank_mask:0x8
    v_add_f32_dpp v10, v121, v10 row_ror:8 row_mask:0xf bank_mask:0x8
    v_add_f32_dpp v13, v113, v13 row_ror:4 row_mask:0xf bank_mask:0x4
    v_add_f32_dpp v12, v136, v139 row_ror:12 row_mask:0xf bank_mask:0x8
    v_add_f32_dpp v11, v129, v11 row_ror:8 row_mask:0xf bank_mask:0x8
    v_add_f32_dpp v10, v122, v10 row_ror:4 row_mask:0xf bank_mask:0x8
    v_add_f32_dpp v13, v144, v147 row_ror:12 row_mask:0xf bank_mask:0x8
    v_add_f32_dpp v12, v137, v12 row_ror:8 row_mask:0xf bank_mask:0x8
    v_add_f32_dpp v11, v130, v11 row_ror:4 row_mask:0xf bank_mask:0x8
    v_add_f32_dpp v13, v145, v13 row_ror:8 row_mask:0xf bank_mask:0x8
    v_add_f32_dpp v12, v138, v12 row_ror:4 row_mask:0xf bank_mask:0x8
    s_memrealtime s[8:9]
    s_waitcnt lgkmcnt(0)
    s_sub_u32 s8, s8, s30
    s_cmpk_ge_u32 s8, 1498
    s_cbranch_scc1 .ap_80
    s_waitcnt vmcnt(5)
    s_cmpk_ge_u32 s8, 1433
    s_cbranch_scc1 .ap_80
    s_waitcnt vmcnt(3)
    s_bitcmp1_b64 s[14:15], 39
    s_cbranch_scc0 1
    s_waitcnt vmcnt(2)
    s_cmpk_ge_u32 s8, 1358
    s_cbranch_scc1 .ap_80
    s_waitcnt vmcnt(1)
.ap_80:
    s_add_u32 s63, s69, 57344
    buffer_load_dwordx4 v[188:191], v2, s[44:47], s63 offen nt
    v_add_f32_dpp v13, v146, v13 row_ror:4 row_mask:0xf bank_mask:0x8
    s_mov_b32 s60, 0x3db504f3
    s_mov_b32 s61, 0x3db504f3
    v_cvt_pk_bf16_f32 v10, 0, v10
    v_cvt_pk_bf16_f32 v11, 0, v11
    v_cvt_pk_bf16_f32 v12, 0, v12
    v_cvt_pk_bf16_f32 v13, 0, v13
    v_pk_mul_f32 v[10:11], v[10:11], s[60:61]
    v_pk_mul_f32 v[12:13], v[12:13], s[60:61]
    v_cvt_pk_bf16_f32 v10, 0, v10
    v_cvt_pk_bf16_f32 v11, 0, v11
    v_cvt_pk_bf16_f32 v12, 0, v12
    v_cvt_pk_bf16_f32 v13, 0, v13
    v_max_f32 v14, v10, v11
    v_max3_f32 v14, v14, v12, v13
    s_mov_b32 s60, 0x3fb8aa3b
    v_mov_b32 v22, s34
    v_mov_b32 v23, s34
    v_max_f32_dpp v14, v14, v14 quad_perm:[2,3,0,1] row_mask:0xf bank_mask:0xf
    s_nop 1
    v_max_f32_dpp v14, v14, v14 row_ror:4 row_mask:0xf bank_mask:0xf
    s_nop 1
    v_max_f32_dpp v14, v14, v14 row_ror:8 row_mask:0xf bank_mask:0xf
    v_mov_b32 v15, v14
    s_nop 1
    v_permlane16_swap_b32 v15, v14
    v_max_f32 v14, v15, v14
    v_mov_b32 v15, v14
    s_nop 1
    v_permlane32_swap_b32 v15, v14
    v_max_f32 v14, v15, v14
    v_mul_f32 v15, 0xbfb8aa3b, v14
    v_fma_f32 v10, v10, s60, v15
    v_fma_f32 v11, v11, s60, v15
    v_fma_f32 v12, v12, s60, v15
    v_fma_f32 v13, v13, s60, v15
    v_exp_f32 v10, v10
    v_exp_f32 v11, v11
    v_exp_f32 v12, v12
    v_exp_f32 v13, v13
    v_mov_b32 v20, v14
    v_pk_add_f32 v[16:17], v[10:11], v[12:13]
    v_add_f32 v21, v16, v17
    s_lshl3_add_u32 s60, s68, s3
    s_lshl_b32 s60, s60, 5
    s_add_u32 s60, s60, s59
    v_add_f32_dpp v21, v21, v21 quad_perm:[2,3,0,1] row_mask:0xf bank_mask:0xf
    s_nop 1
    v_add_f32_dpp v21, v21, v21 row_ror:4 row_mask:0xf bank_mask:0xf
    s_nop 1
    v_add_f32_dpp v21, v21, v21 row_ror:8 row_mask:0xf bank_mask:0xf
    v_mov_b32 v15, v21
    s_nop 1
    v_permlane16_swap_b32 v15, v21
    v_add_f32 v21, v15, v21
    v_mov_b32 v15, v21
    s_nop 1
    v_permlane32_swap_b32 v15, v21
    v_add_f32 v21, v15, v21
    s_lshl_b32 s60, s3, 4
    s_add_u32 s60, s60, 159104
    v_add_u32 v16, s60, v3
    v_mov_b32 v17, 159232
    v_mov_b32 v18, 1
    s_mov_b64 exec, 3
    ds_write_b64 v16, v[20:21]
    s_mov_b64 exec, 1
    s_waitcnt lgkmcnt(0)
    ds_add_rtn_u32 v18, v17, v18
    s_mov_b64 exec, -1
    v_and_b32 v16, 0x78, v3
    v_add_u32 v16, 159104, v16
    s_waitcnt lgkmcnt(0)
    v_readfirstlane_b32 s60, v18
    s_cmp_lg_u32 s60, 7
    s_nop 3
    s_cbranch_scc1 .ml_81
    ds_read_b64 v[18:19], v16
    s_lshl_b32 s60, s68, 7
    s_add_u32 s60, s60, s59
    s_waitcnt lgkmcnt(0)
    v_mov_b32 v20, v18
    s_nop 1
    v_max_f32_dpp v20, v20, v20 quad_perm:[2,3,0,1] row_mask:0xf bank_mask:0xf
    s_nop 1
    v_max_f32_dpp v20, v20, v20 row_ror:4 row_mask:0xf bank_mask:0xf
    s_nop 1
    v_max_f32_dpp v20, v20, v20 row_ror:8 row_mask:0xf bank_mask:0xf
    v_sub_f32 v18, v18, v20
    v_mul_f32 v18, 0x3fb8aa3b, v18
    v_exp_f32 v18, v18
    s_nop 0
    v_mul_f32 v21, v18, v19
    s_nop 1
    v_add_f32_dpp v21, v21, v21 quad_perm:[2,3,0,1] row_mask:0xf bank_mask:0xf
    s_nop 1
    v_add_f32_dpp v21, v21, v21 row_ror:4 row_mask:0xf bank_mask:0xf
    s_nop 1
    v_add_f32_dpp v21, v21, v21 row_ror:8 row_mask:0xf bank_mask:0xf
    s_mov_b64 exec, 0xff
    buffer_store_dwordx4 v[20:23], v2, s[36:39], s60 offen sc1
    s_mov_b64 exec, -1
.ml_81:
    s_memrealtime s[8:9]
    s_waitcnt lgkmcnt(0)
    s_sub_u32 s8, s8, s30
    s_cmpk_ge_u32 s8, 1525
    s_cbranch_scc1 .ap_82
    s_waitcnt vmcnt(5)
    s_cmpk_ge_u32 s8, 1460
    s_cbranch_scc1 .ap_82
    s_waitcnt vmcnt(3)
    s_bitcmp1_b64 s[14:15], 40
    s_cbranch_scc0 1
    s_waitcnt vmcnt(2)
    s_cmpk_ge_u32 s8, 1385
    s_cbranch_scc1 .ap_82
    s_waitcnt vmcnt(1)
.ap_82:
    s_add_u32 s63, s69, 131072
    buffer_load_dwordx4 v[192:195], v2, s[44:47], s63 offen nt
    s_memrealtime s[8:9]
    s_waitcnt vmcnt(8)
    s_waitcnt lgkmcnt(0)
    s_sub_u32 s8, s8, s30
    s_cmpk_ge_u32 s8, 1552
    s_cbranch_scc1 .ap_83
    s_waitcnt vmcnt(5)
    s_cmpk_ge_u32 s8, 1487
    s_cbranch_scc1 .ap_83
    s_waitcnt vmcnt(3)
    s_bitcmp1_b64 s[14:15], 41
    s_cbranch_scc0 1
    s_waitcnt vmcnt(2)
    s_cmpk_ge_u32 s8, 1412
    s_cbranch_scc1 .ap_83
    s_waitcnt vmcnt(1)
.ap_83:
    s_add_u32 s63, s69, 139264
    buffer_load_dwordx4 v[196:199], v2, s[44:47], s63 offen nt
    s_memrealtime s[8:9]
    s_waitcnt vmcnt(8)
    s_waitcnt lgkmcnt(0)
    s_sub_u32 s8, s8, s30
    s_cmpk_ge_u32 s8, 1579
    s_cbranch_scc1 .ap_84
    s_waitcnt vmcnt(5)
    s_cmpk_ge_u32 s8, 1514
    s_cbranch_scc1 .ap_84
    s_waitcnt vmcnt(3)
    s_bitcmp1_b64 s[14:15], 42
    s_cbranch_scc0 1
    s_waitcnt vmcnt(2)
    s_cmpk_ge_u32 s8, 1439
    s_cbranch_scc1 .ap_84
    s_waitcnt vmcnt(1)
.ap_84:
    s_add_u32 s63, s69, 147456
    buffer_load_dwordx4 v[200:203], v2, s[44:47], s63 offen nt
    s_memrealtime s[8:9]
    s_waitcnt vmcnt(8)
    s_waitcnt lgkmcnt(0)
    s_sub_u32 s8, s8, s30
    s_cmpk_ge_u32 s8, 1606
    s_cbranch_scc1 .ap_85
    s_waitcnt vmcnt(5)
    s_cmpk_ge_u32 s8, 1541
    s_cbranch_scc1 .ap_85
    s_waitcnt vmcnt(3)
    s_bitcmp1_b64 s[14:15], 43
    s_cbranch_scc0 1
    s_waitcnt vmcnt(2)
    s_cmpk_ge_u32 s8, 1466
    s_cbranch_scc1 .ap_85
    s_waitcnt vmcnt(1)
.ap_85:
    s_add_u32 s63, s69, 155648
    buffer_load_dwordx4 v[204:207], v2, s[44:47], s63 offen nt
    s_memrealtime s[8:9]
    s_waitcnt vmcnt(8)
    s_waitcnt lgkmcnt(0)
    s_sub_u32 s8, s8, s30
    s_cmpk_ge_u32 s8, 1633
    s_cbranch_scc1 .ap_86
    s_waitcnt vmcnt(5)
    s_cmpk_ge_u32 s8, 1568
    s_cbranch_scc1 .ap_86
    s_waitcnt vmcnt(3)
    s_bitcmp1_b64 s[14:15], 44
    s_cbranch_scc0 1
    s_waitcnt vmcnt(2)
    s_cmpk_ge_u32 s8, 1493
    s_cbranch_scc1 .ap_86
    s_waitcnt vmcnt(1)
.ap_86:
    s_add_u32 s63, s69, 163840
    buffer_load_dwordx4 v[208:211], v2, s[44:47], s63 offen nt
    v_and_b32 v16, 15, v0
    v_lshrrev_b32 v17, 4, v0
    v_lshl_add_u32 v16, v16, 2, v17
    v_lshlrev_b32 v31, 1, v16
    s_lshl_b32 s56, s65, 7
    v_add_u32 v31, s56, v31
    v_and_b32 v6, -4, v31
    v_lshlrev_b32 v6, 1, v6
    s_mul_i32 s56, s3, 1152
    s_mov_b32 s52, s4
    s_and_b32 s53, s5, 0xffff
    s_mov_b32 s54, 0x2400
    s_mov_b32 s55, 0x00020000
    buffer_load_ushort v29, v31, s[52:55], s56 offen
    s_mul_i32 s101, s3, 2304
    s_add_u32 s101, s101, 0x15000
    s_add_u32 s99, s101, 36864
    s_add_u32 s100, s101, 73728
    s_add_u32 s33, s101, 110592
    buffer_load_dwordx2 v[72:73], v6, s[36:39], s101 offen offset:0 sc1
    s_cmp_lg_u32 s3, s64
    s_cbranch_scc1 .rin_87
    buffer_load_dwordx4 v[32:35], v2, s[36:39], s99 offen offset:0 sc1
    buffer_load_dwordx4 v[40:43], v2, s[36:39], s99 offen offset:1024 sc1
    buffer_load_dwordx2 v[48:49], v5, s[36:39], s99 offen offset:0 sc1
    buffer_load_dwordx4 v[56:59], v2, s[36:39], s100 offen offset:0 sc1
    buffer_load_dwordx4 v[64:67], v2, s[36:39], s100 offen offset:1024 sc1
    buffer_load_dwordx2 v[50:51], v5, s[36:39], s100 offen offset:0 sc1
    buffer_load_dwordx2 v[74:75], v6, s[36:39], s99 offen offset:0 sc1
    buffer_load_dwordx2 v[80:81], v6, s[36:39], s100 offen offset:0 sc1
    buffer_load_dwordx2 v[82:83], v6, s[36:39], s33 offen offset:0 sc1
    s_mov_b32 s48, s16
    s_and_b32 s49, s17, 0xffff
    s_mov_b32 s50, 0x480
    s_mov_b32 s51, 0x00020000
    buffer_load_dwordx2 v[88:89], v3, s[48:51], 0 offen
    buffer_load_dwordx2 v[90:91], v3, s[48:51], 0 offen offset:512
    buffer_load_dword v30, v4, s[48:51], 0 offen
.rin_87:
    s_memrealtime s[8:9]
    s_waitcnt vmcnt(10)
    s_waitcnt lgkmcnt(0)
    s_sub_u32 s8, s8, s30
    s_cmpk_ge_u32 s8, 1660
    s_cbranch_scc1 .ap_88
    s_waitcnt vmcnt(7)
    s_cmpk_ge_u32 s8, 1595
    s_cbranch_scc1 .ap_88
    s_waitcnt vmcnt(5)
    s_bitcmp1_b64 s[14:15], 45
    s_cbranch_scc0 1
    s_waitcnt vmcnt(4)
    s_cmpk_ge_u32 s8, 1520
    s_cbranch_scc1 .ap_88
    s_waitcnt vmcnt(3)
.ap_88:
    s_add_u32 s63, s69, 172032
    buffer_load_dwordx4 v[212:215], v2, s[44:47], s63 offen nt
    s_memrealtime s[8:9]
    s_waitcnt vmcnt(10)
    s_waitcnt lgkmcnt(0)
    s_sub_u32 s8, s8, s30
    s_cmpk_ge_u32 s8, 1691
    s_cbranch_scc1 .ap_89
    s_waitcnt vmcnt(7)
    s_cmpk_ge_u32 s8, 1626
    s_cbranch_scc1 .ap_89
    s_waitcnt vmcnt(5)
    s_bitcmp1_b64 s[14:15], 46
    s_cbranch_scc0 1
    s_waitcnt vmcnt(4)
    s_cmpk_ge_u32 s8, 1551
    s_cbranch_scc1 .ap_89
    s_waitcnt vmcnt(3)
.ap_89:
    s_add_u32 s63, s69, 180224
    buffer_load_dwordx4 v[216:219], v2, s[44:47], s63 offen nt
    s_memrealtime s[8:9]
    s_waitcnt vmcnt(10)
    s_waitcnt lgkmcnt(0)
    s_sub_u32 s8, s8, s30
    s_cmpk_ge_u32 s8, 1722
    s_cbranch_scc1 .ap_90
    s_waitcnt vmcnt(7)
    s_cmpk_ge_u32 s8, 1657
    s_cbranch_scc1 .ap_90
    s_waitcnt vmcnt(5)
    s_bitcmp1_b64 s[14:15], 47
    s_cbranch_scc0 1
    s_waitcnt vmcnt(4)
    s_cmpk_ge_u32 s8, 1582
    s_cbranch_scc1 .ap_90
    s_waitcnt vmcnt(1)
.ap_90:
    s_add_u32 s63, s69, 188416
    buffer_load_dwordx4 v[220:223], v2, s[44:47], s63 offen nt
    s_memrealtime s[8:9]
    s_waitcnt vmcnt(10)
    s_waitcnt lgkmcnt(0)
    s_sub_u32 s8, s8, s30
    s_cmpk_ge_u32 s8, 1753
    s_cbranch_scc1 .ap_91
    s_waitcnt vmcnt(7)
    s_cmpk_ge_u32 s8, 1688
    s_cbranch_scc1 .ap_91
    s_waitcnt vmcnt(5)
    s_bitcmp1_b64 s[14:15], 48
    s_cbranch_scc0 1
    s_waitcnt vmcnt(2)
    s_cmpk_ge_u32 s8, 1613
    s_cbranch_scc1 .ap_91
    s_waitcnt vmcnt(1)
.ap_91:
    s_add_u32 s63, s69, 262144
    buffer_load_dwordx4 v[224:227], v2, s[44:47], s63 offen nt
    s_memrealtime s[8:9]
    s_waitcnt vmcnt(10)
    s_waitcnt lgkmcnt(0)
    s_sub_u32 s8, s8, s30
    s_cmpk_ge_u32 s8, 1784
    s_cbranch_scc1 .ap_92
    s_waitcnt vmcnt(7)
    s_cmpk_ge_u32 s8, 1719
    s_cbranch_scc1 .ap_92
    s_waitcnt vmcnt(3)
    s_bitcmp1_b64 s[14:15], 49
    s_cbranch_scc0 1
    s_waitcnt vmcnt(2)
    s_cmpk_ge_u32 s8, 1644
    s_cbranch_scc1 .ap_92
    s_waitcnt vmcnt(1)
.ap_92:
    s_add_u32 s63, s69, 270336
    buffer_load_dwordx4 v[228:231], v2, s[44:47], s63 offen nt
    s_memrealtime s[8:9]
    s_waitcnt vmcnt(10)
    s_waitcnt lgkmcnt(0)
    s_sub_u32 s8, s8, s30
    s_cmpk_ge_u32 s8, 1815
    s_cbranch_scc1 .ap_93
    s_waitcnt vmcnt(7)
    s_cmpk_ge_u32 s8, 1750
    s_cbranch_scc1 .ap_93
    s_waitcnt vmcnt(3)
    s_bitcmp1_b64 s[14:15], 50
    s_cbranch_scc0 1
    s_waitcnt vmcnt(2)
    s_cmpk_ge_u32 s8, 1675
    s_cbranch_scc1 .ap_93
    s_waitcnt vmcnt(1)
.ap_93:
    s_add_u32 s63, s69, 278528
    buffer_load_dwordx4 v[232:235], v2, s[44:47], s63 offen nt
    s_memrealtime s[8:9]
    s_waitcnt vmcnt(10)
    s_waitcnt lgkmcnt(0)
    s_sub_u32 s8, s8, s30
    s_cmpk_ge_u32 s8, 1846
    s_cbranch_scc1 .ap_94
    s_waitcnt vmcnt(5)
    s_cmpk_ge_u32 s8, 1781
    s_cbranch_scc1 .ap_94
    s_waitcnt vmcnt(3)
    s_bitcmp1_b64 s[14:15], 51
    s_cbranch_scc0 1
    s_waitcnt vmcnt(2)
    s_cmpk_ge_u32 s8, 1706
    s_cbranch_scc1 .ap_94
    s_waitcnt vmcnt(1)
.ap_94:
    s_add_u32 s63, s69, 286720
    buffer_load_dwordx4 v[236:239], v2, s[44:47], s63 offen nt
    s_memrealtime s[8:9]
    s_waitcnt vmcnt(10)
    s_waitcnt lgkmcnt(0)
    s_sub_u32 s8, s8, s30
    s_cmpk_ge_u32 s8, 1877
    s_cbranch_scc1 .ap_95
    s_waitcnt vmcnt(5)
    s_cmpk_ge_u32 s8, 1812
    s_cbranch_scc1 .ap_95
    s_waitcnt vmcnt(3)
    s_bitcmp1_b64 s[14:15], 52
    s_cbranch_scc0 1
    s_waitcnt vmcnt(2)
    s_cmpk_ge_u32 s8, 1737
    s_cbranch_scc1 .ap_95
    s_waitcnt vmcnt(1)
.ap_95:
    s_add_u32 s63, s69, 294912
    buffer_load_dwordx4 v[240:243], v2, s[44:47], s63 offen nt
    s_memrealtime s[8:9]
    s_waitcnt vmcnt(10)
    s_waitcnt lgkmcnt(0)
    s_sub_u32 s8, s8, s30
    s_cmpk_ge_u32 s8, 1908
    s_cbranch_scc1 .ap_96
    s_waitcnt vmcnt(5)
    s_cmpk_ge_u32 s8, 1843
    s_cbranch_scc1 .ap_96
    s_waitcnt vmcnt(3)
    s_bitcmp1_b64 s[14:15], 53
    s_cbranch_scc0 1
    s_waitcnt vmcnt(2)
    s_cmpk_ge_u32 s8, 1768
    s_cbranch_scc1 .ap_96
    s_waitcnt vmcnt(1)
.ap_96:
    s_add_u32 s63, s69, 303104
    buffer_load_dwordx4 v[244:247], v2, s[44:47], s63 offen nt
    s_load_dwordx2 s[88:89], s[6:7], s0
    buffer_load_dwordx4 v[24:27], v9, s[36:39], s59 offen offset:0 sc1
    s_memrealtime s[8:9]
    s_waitcnt vmcnt(8)
    s_waitcnt lgkmcnt(0)
    s_sub_u32 s8, s8, s30
    s_cmpk_ge_u32 s8, 1939
    s_cbranch_scc1 .ap_97
    s_waitcnt vmcnt(5)
    s_cmpk_ge_u32 s8, 1874
    s_cbranch_scc1 .ap_97
    s_waitcnt vmcnt(3)
    s_bitcmp1_b64 s[14:15], 54
    s_cbranch_scc0 1
    s_waitcnt vmcnt(2)
    s_cmpk_ge_u32 s8, 1799
    s_cbranch_scc1 .ap_97
    s_waitcnt vmcnt(1)
.ap_97:
    s_add_u32 s63, s69, 311296
    buffer_load_dwordx4 v[248:251], v2, s[44:47], s63 offen nt
    s_memrealtime s[8:9]
    s_waitcnt vmcnt(8)
    s_waitcnt lgkmcnt(0)
    s_sub_u32 s8, s8, s30
    s_cmpk_ge_u32 s8, 1970
    s_cbranch_scc1 .ap_98
    s_waitcnt vmcnt(5)
    s_cmpk_ge_u32 s8, 1905
    s_cbranch_scc1 .ap_98
    s_waitcnt vmcnt(3)
    s_bitcmp1_b64 s[14:15], 55
    s_cbranch_scc0 1
    s_waitcnt vmcnt(2)
    s_cmpk_ge_u32 s8, 1830
    s_cbranch_scc1 .ap_98
    s_waitcnt vmcnt(1)
.ap_98:
    s_add_u32 s63, s69, 319488
    buffer_load_dwordx4 v[252:255], v2, s[44:47], s63 offen nt
    s_memrealtime s[8:9]
    s_waitcnt vmcnt(8)
    s_waitcnt lgkmcnt(0)
    s_sub_u32 s8, s8, s30
    s_cmpk_ge_u32 s8, 2001
    s_cbranch_scc1 .ap_99
    s_waitcnt vmcnt(5)
    s_cmpk_ge_u32 s8, 1936
    s_cbranch_scc1 .ap_99
    s_waitcnt vmcnt(3)
    s_bitcmp1_b64 s[14:15], 56
    s_cbranch_scc0 1
    s_waitcnt vmcnt(2)
    s_cmpk_ge_u32 s8, 1861
    s_cbranch_scc1 .ap_99
    s_waitcnt vmcnt(1)
.ap_99:
    s_add_u32 s63, s69, 393216
    buffer_load_dwordx4 v[36:39], v2, s[44:47], s63 offen nt
    s_memrealtime s[8:9]
    s_waitcnt vmcnt(8)
    s_waitcnt lgkmcnt(0)
    s_sub_u32 s8, s8, s30
    s_cmpk_ge_u32 s8, 2032
    s_cbranch_scc1 .ap_100
    s_waitcnt vmcnt(5)
    s_cmpk_ge_u32 s8, 1967
    s_cbranch_scc1 .ap_100
    s_waitcnt vmcnt(3)
    s_bitcmp1_b64 s[14:15], 57
    s_cbranch_scc0 1
    s_waitcnt vmcnt(2)
    s_cmpk_ge_u32 s8, 1892
    s_cbranch_scc1 .ap_100
    s_waitcnt vmcnt(1)
.ap_100:
    s_add_u32 s63, s69, 401408
    buffer_load_dwordx4 v[44:47], v2, s[44:47], s63 offen nt
    s_memrealtime s[8:9]
    s_waitcnt vmcnt(8)
    s_waitcnt lgkmcnt(0)
    s_sub_u32 s8, s8, s30
    s_cmpk_ge_u32 s8, 2063
    s_cbranch_scc1 .ap_101
    s_waitcnt vmcnt(5)
    s_cmpk_ge_u32 s8, 1998
    s_cbranch_scc1 .ap_101
    s_waitcnt vmcnt(3)
    s_bitcmp1_b64 s[14:15], 58
    s_cbranch_scc0 1
    s_waitcnt vmcnt(2)
    s_cmpk_ge_u32 s8, 1923
    s_cbranch_scc1 .ap_101
    s_waitcnt vmcnt(1)
.ap_101:
    s_add_u32 s63, s69, 409600
    buffer_load_dwordx4 v[52:55], v2, s[44:47], s63 offen nt
    s_waitcnt vmcnt(5)
    s_branch .gpc_103
.gp_102:
    buffer_load_dwordx4 v[24:27], v9, s[36:39], s59 offen offset:0 sc1
    s_waitcnt vmcnt(0)
.gpc_103:
    v_cmp_eq_u32 vcc, s34, v26
    v_cmp_eq_u32 s[56:57], s34, v27
    s_and_b64 vcc, vcc, s[56:57]
    s_cmp_eq_u64 vcc, exec
    s_nop 2
    s_cbranch_scc1 .gpd_104
    s_sub_u32 s35, s35, 1
    s_cbranch_scc1 .Lexit
    s_sleep 1
    s_branch .gp_102
.gpd_104:
    s_lshr_b64 s[88:89], s[88:89], s1
    s_and_b32 s88, s88, 0xff
    s_cmp_eq_u32 s88, 32
    s_cselect_b32 s0, 0xac000, 0
    v_mov_b32 v16, v24
    s_nop 1
    v_max_f32_dpp v16, v16, v16 quad_perm:[2,3,0,1] row_mask:0xf bank_mask:0xf
    v_sub_f32 v17, v24, v16
    v_sub_f32 v18, v14, v16
    v_mul_f32 v17, 0x3fb8aa3b, v17
    v_mul_f32 v18, 0x3fb8aa3b, v18
    v_exp_f32 v17, v17
    v_exp_f32 v18, v18
    v_mul_f32 v17, v17, v25
    s_nop 1
    v_add_f32_dpp v17, v17, v17 quad_perm:[2,3,0,1] row_mask:0xf bank_mask:0xf
    v_rcp_f32 v19, v17
    s_nop 0
    v_fma_f32 v15, -v17, v19, 1.0
    v_fma_f32 v19, v15, v19, v19
    v_mul_f32 v18, v18, v19
    v_mul_f32 v10, v10, v18
    v_mul_f32 v11, v11, v18
    v_mul_f32 v12, v12, v18
    v_mul_f32 v13, v13, v18
    v_mov_b32_dpp v112, v10 quad_perm:[2,3,0,1] row_mask:0xf bank_mask:0xf
    v_mov_b32_dpp v113, v11 quad_perm:[2,3,0,1] row_mask:0xf bank_mask:0xf
    v_mov_b32_dpp v114, v12 quad_perm:[2,3,0,1] row_mask:0xf bank_mask:0xf
    v_mov_b32_dpp v115, v13 quad_perm:[2,3,0,1] row_mask:0xf bank_mask:0xf
    v_cvt_pk_bf16_f32 v96, v10, v112
    v_cvt_pk_bf16_f32 v100, v11, v113
    v_cvt_pk_bf16_f32 v104, v12, v114
    v_cvt_pk_bf16_f32 v108, v13, v115
    v_mov_b32_dpp v97, v96 row_ror:12 row_mask:0xf bank_mask:0xf
    v_mov_b32_dpp v101, v100 row_ror:12 row_mask:0xf bank_mask:0xf
    v_mov_b32_dpp v105, v104 row_ror:12 row_mask:0xf bank_mask:0xf
    v_mov_b32_dpp v109, v108 row_ror:12 row_mask:0xf bank_mask:0xf
    v_mov_b32_dpp v98, v96 row_ror:8 row_mask:0xf bank_mask:0xf
    v_mov_b32_dpp v102, v100 row_ror:8 row_mask:0xf bank_mask:0xf
    v_mov_b32_dpp v106, v104 row_ror:8 row_mask:0xf bank_mask:0xf
    v_mov_b32_dpp v110, v108 row_ror:8 row_mask:0xf bank_mask:0xf
    v_mov_b32_dpp v99, v96 row_ror:4 row_mask:0xf bank_mask:0xf
    v_mov_b32_dpp v103, v100 row_ror:4 row_mask:0xf bank_mask:0xf
    v_mov_b32_dpp v107, v104 row_ror:4 row_mask:0xf bank_mask:0xf
    v_mov_b32_dpp v111, v108 row_ror:4 row_mask:0xf bank_mask:0xf
    v_mov_b32_dpp v96, v96 row_shr:3 row_mask:0xf bank_mask:0x2
    v_mov_b32_dpp v97, v97 row_shr:3 row_mask:0xf bank_mask:0x2
    v_mov_b32_dpp v98, v98 row_shr:3 row_mask:0xf bank_mask:0x2
    v_mov_b32_dpp v99, v99 row_shr:3 row_mask:0xf bank_mask:0x2
    v_mov_b32_dpp v100, v100 row_shr:3 row_mask:0xf bank_mask:0x2
    v_mov_b32_dpp v101, v101 row_shr:3 row_mask:0xf bank_mask:0x2
    v_mov_b32_dpp v102, v102 row_shr:3 row_mask:0xf bank_mask:0x2
    v_mov_b32_dpp v103, v103 row_shr:3 row_mask:0xf bank_mask:0x2
    v_mov_b32_dpp v104, v104 row_shr:3 row_mask:0xf bank_mask:0x2
    v_mov_b32_dpp v105, v105 row_shr:3 row_mask:0xf bank_mask:0x2
    v_mov_b32_dpp v106, v106 row_shr:3 row_mask:0xf bank_mask:0x2
    v_mov_b32_dpp v107, v107 row_shr:3 row_mask:0xf bank_mask:0x2
    v_mov_b32_dpp v108, v108 row_shr:3 row_mask:0xf bank_mask:0x2
    v_mov_b32_dpp v109, v109 row_shr:3 row_mask:0xf bank_mask:0x2
    v_mov_b32_dpp v110, v110 row_shr:3 row_mask:0xf bank_mask:0x2
    v_mov_b32_dpp v111, v111 row_shr:3 row_mask:0xf bank_mask:0x2
    s_memrealtime s[8:9]
    s_waitcnt lgkmcnt(0)
    s_sub_u32 s8, s8, s30
    s_cmpk_ge_u32 s8, 2094
    s_cbranch_scc1 .ap_105
    s_waitcnt vmcnt(5)
    s_cmpk_ge_u32 s8, 2029
    s_cbranch_scc1 .ap_105
    s_waitcnt vmcnt(3)
    s_bitcmp1_b64 s[14:15], 59
    s_cbranch_scc0 1
    s_waitcnt vmcnt(2)
    s_cmpk_ge_u32 s8, 1954
    s_cbranch_scc1 .ap_105
    s_waitcnt vmcnt(1)
.ap_105:
    s_add_u32 s63, s69, 417792
    buffer_load_dwordx4 v[60:63], v2, s[44:47], s63 offen nt
    s_lshl_b32 s60, s3, 10
    s_add_u32 s60, s60, 132096
    v_lshlrev_b32 v10, 5, v0
    v_add_u32 v10, s60, v10
    v_lshrrev_b32 v11, 5, v0
    v_lshlrev_b32 v11, 13, v11
    v_and_b32 v12, 31, v0
    v_lshl_add_u32 v11, v12, 4, v11
    v_add_u32 v9, 132096, v2
    v_mov_b32 v15, s34
    v_lshrrev_b32 v25, 4, v0
    v_bfe_u32 v26, v0, 2, 2
    v_lshl_add_u32 v16, v25, 3, v26
    v_lshlrev_b32 v16, 7, v16
    v_and_b32 v25, 1, v25
    v_lshrrev_b32 v26, 1, v26
    v_lshl_add_u32 v25, v25, 1, v26
    s_and_b32 s56, s3, 1
    s_lshl_b32 s56, s56, 1
    v_xor_b32 v25, s56, v25
    v_and_b32 v26, 3, v0
    v_lshl_add_u32 v16, v26, 3, v16
    s_lshr_b32 s56, s3, 1
    s_mul_i32 s56, s56, 16384
    v_add_u32 v16, s56, v16
    v_xor_b32 v26, 1, v25
    v_lshl_add_u32 v17, v26, 5, v16
    v_lshl_add_u32 v16, v25, 5, v16
    v_bfe_u32 v25, v0, 1, 3
    v_mul_u32_u24 v19, 1312, v25
    v_mul_u32_u24 v20, 272, v25
    v_and_b32 v25, 48, v0
    s_lshr_b32 s56, s3, 1
    s_mul_i32 s57, s56, 256
    s_add_u32 s57, s57, 147456
    v_add3_u32 v19, v19, v25, s57
    s_mul_i32 s56, s56, 2176
    s_and_b32 s57, s3, 1
    s_lshl_b32 s57, s57, 7
    s_add_u32 s56, s56, s57
    s_add_u32 s56, s56, 122880
    v_add3_u32 v20, v20, v25, s56
    v_and_b32 v25, 1, v0
    v_lshl_add_u32 v20, v25, 6, v20
    v_and_b32 v25, 15, v0
    s_mul_i32 s56, s3, 272
    s_add_u32 s56, s56, 122880
    v_lshl_add_u32 v21, v25, 4, s56
    s_mul_i32 s56, s3, 1312
    s_add_u32 s56, s56, 147456
    v_add_u32 v18, s56, v3
    v_add_u32 v7, 16384, v11
    s_nop 1
    s_branch .gpc_107
.gp_106:
    buffer_load_dwordx2 v[72:73], v6, s[36:39], s101 offen offset:0 sc1
    s_waitcnt vmcnt(0)
.gpc_107:
    v_cmp_eq_u32 vcc, s34, v73
    s_cmp_eq_u64 vcc, exec
    s_nop 3
    s_cbranch_scc1 .gpd_108
    s_sub_u32 s35, s35, 1
    s_cbranch_scc1 .Lexit
    s_sleep 2
    s_branch .gp_106
.gpd_108:
    v_lshlrev_b32 v23, 16, v72
    v_and_b32 v72, 0xffff0000, v72
    s_mov_b32 vcc_lo, 0xffff0000
    s_mov_b32 vcc_hi, 0xffff0000
    v_cndmask_b32 v23, v23, v72, vcc
    v_lshlrev_b32 v29, 16, v29
    s_memrealtime s[8:9]
    s_waitcnt lgkmcnt(0)
    s_sub_u32 s8, s8, s30
    s_cmpk_ge_u32 s8, 2125
    s_cbranch_scc1 .ap_109
    s_waitcnt vmcnt(5)
    s_cmpk_ge_u32 s8, 2060
    s_cbranch_scc1 .ap_109
    s_waitcnt vmcnt(3)
    s_bitcmp1_b64 s[14:15], 60
    s_cbranch_scc0 1
    s_waitcnt vmcnt(2)
    s_cmpk_ge_u32 s8, 1985
    s_cbranch_scc1 .ap_109
    s_waitcnt vmcnt(1)
.ap_109:
    s_add_u32 s63, s69, 425984
    buffer_load_dwordx4 v[68:71], v2, s[44:47], s63 offen nt
    v_perm_b32 v112, v164, v160, s94
    v_perm_b32 v113, v172, v168, s94
    v_perm_b32 v114, v180, v176, s94
    v_perm_b32 v115, v188, v184, s94
    s_nop 1
    v_mfma_f32_16x16x32_bf16 v[128:131], v[96:99], v[112:115], 0
    v_perm_b32 v116, v164, v160, s95
    v_perm_b32 v117, v172, v168, s95
    v_perm_b32 v118, v180, v176, s95
    v_perm_b32 v119, v188, v184, s95
    s_nop 1
    v_mfma_f32_16x16x32_bf16 v[132:135], v[96:99], v[116:119], 0
    v_perm_b32 v120, v165, v161, s94
    v_perm_b32 v121, v173, v169, s94
    v_perm_b32 v122, v181, v177, s94
    v_perm_b32 v123, v189, v185, s94
    s_nop 1
    v_mfma_f32_16x16x32_bf16 v[136:139], v[96:99], v[120:123], 0
    v_perm_b32 v124, v165, v161, s95
    v_perm_b32 v125, v173, v169, s95
    v_perm_b32 v126, v181, v177, s95
    v_perm_b32 v127, v189, v185, s95
    s_nop 1
    v_mfma_f32_16x16x32_bf16 v[140:143], v[96:99], v[124:127], 0
    v_perm_b32 v112, v166, v162, s94
    v_perm_b32 v113, v174, v170, s94
    v_perm_b32 v114, v182, v178, s94
    v_perm_b32 v115, v190, v186, s94
    s_nop 1
    v_mfma_f32_16x16x32_bf16 v[144:147], v[96:99], v[112:115], 0
    v_perm_b32 v116, v166, v162, s95
    v_perm_b32 v117, v174, v170, s95
    v_perm_b32 v118, v182, v178, s95
    v_perm_b32 v119, v190, v186, s95
    s_nop 1
    v_mfma_f32_16x16x32_bf16 v[148:151], v[96:99], v[116:119], 0
    v_perm_b32 v120, v167, v163, s94
    v_perm_b32 v121, v175, v171, s94
    v_perm_b32 v122, v183, v179, s94
    v_perm_b32 v123, v191, v187, s94
    s_nop 1
    v_mfma_f32_16x16x32_bf16 v[152:155], v[96:99], v[120:123], 0
    v_perm_b32 v124, v167, v163, s95
    v_perm_b32 v125, v175, v171, s95
    v_perm_b32 v126, v183, v179, s95
    v_perm_b32 v127, v191, v187, s95
    s_nop 1
    v_mfma_f32_16x16x32_bf16 v[156:159], v[96:99], v[124:127], 0
    s_memrealtime s[8:9]
    s_waitcnt lgkmcnt(0)
    s_sub_u32 s8, s8, s30
    s_cmpk_ge_u32 s8, 2156
    s_nop 3
    s_cbranch_scc1 .ap_110
    s_waitcnt vmcnt(5)
    s_cmpk_ge_u32 s8, 2091
    s_cbranch_scc1 .ap_110
    s_waitcnt vmcnt(3)
    s_bitcmp1_b64 s[14:15], 61
    s_cbranch_scc0 1
    s_waitcnt vmcnt(2)
    s_cmpk_ge_u32 s8, 2016
    s_cbranch_scc1 .ap_110
    s_waitcnt vmcnt(1)
.ap_110:
    s_add_u32 s63, s69, 434176
    buffer_load_dwordx4 v[76:79], v2, s[44:47], s63 offen nt
    v_perm_b32 v112, v196, v192, s94
    v_perm_b32 v113, v204, v200, s94
    v_perm_b32 v114, v212, v208, s94
    v_perm_b32 v115, v220, v216, s94
    s_nop 1
    v_mfma_f32_16x16x32_bf16 v[128:131], v[100:103], v[112:115], v[128:131]
    v_perm_b32 v116, v196, v192, s95
    v_perm_b32 v117, v204, v200, s95
    v_perm_b32 v118, v212, v208, s95
    v_perm_b32 v119, v220, v216, s95
    s_nop 1
    v_mfma_f32_16x16x32_bf16 v[132:135], v[100:103], v[116:119], v[132:135]
    v_perm_b32 v120, v197, v193, s94
    v_perm_b32 v121, v205, v201, s94
    v_perm_b32 v122, v213, v209, s94
    v_perm_b32 v123, v221, v217, s94
    s_nop 1
    v_mfma_f32_16x16x32_bf16 v[136:139], v[100:103], v[120:123], v[136:139]
    v_perm_b32 v124, v197, v193, s95
    v_perm_b32 v125, v205, v201, s95
    v_perm_b32 v126, v213, v209, s95
    v_perm_b32 v127, v221, v217, s95
    s_nop 1
    v_mfma_f32_16x16x32_bf16 v[140:143], v[100:103], v[124:127], v[140:143]
    v_perm_b32 v112, v198, v194, s94
    v_perm_b32 v113, v206, v202, s94
    v_perm_b32 v114, v214, v210, s94
    v_perm_b32 v115, v222, v218, s94
    s_nop 1
    v_mfma_f32_16x16x32_bf16 v[144:147], v[100:103], v[112:115], v[144:147]
    v_perm_b32 v116, v198, v194, s95
    v_perm_b32 v117, v206, v202, s95
    v_perm_b32 v118, v214, v210, s95
    v_perm_b32 v119, v222, v218, s95
    s_nop 1
    v_mfma_f32_16x16x32_bf16 v[148:151], v[100:103], v[116:119], v[148:151]
    v_perm_b32 v120, v199, v195, s94
    v_perm_b32 v121, v207, v203, s94
    v_perm_b32 v122, v215, v211, s94
    v_perm_b32 v123, v223, v219, s94
    s_nop 1
    v_mfma_f32_16x16x32_bf16 v[152:155], v[100:103], v[120:123], v[152:155]
    v_perm_b32 v124, v199, v195, s95
    v_perm_b32 v125, v207, v203, s95
    v_perm_b32 v126, v215, v211, s95
    v_perm_b32 v127, v223, v219, s95
    s_nop 1
    v_mfma_f32_16x16x32_bf16 v[156:159], v[100:103], v[124:127], v[156:159]
    s_memrealtime s[8:9]
    s_waitcnt lgkmcnt(0)
    s_sub_u32 s8, s8, s30
    s_cmpk_ge_u32 s8, 2187
    s_nop 3
    s_cbranch_scc1 .ap_111
    s_waitcnt vmcnt(5)
    s_cmpk_ge_u32 s8, 2122
    s_cbranch_scc1 .ap_111
    s_waitcnt vmcnt(3)
    s_bitcmp1_b64 s[14:15], 62
    s_cbranch_scc0 1
    s_waitcnt vmcnt(2)
    s_cmpk_ge_u32 s8, 2047
    s_cbranch_scc1 .ap_111
    s_waitcnt vmcnt(1)
.ap_111:
    s_add_u32 s63, s69, 442368
    buffer_load_dwordx4 v[84:87], v2, s[44:47], s63 offen nt
    s_waitcnt vmcnt(7)
    v_perm_b32 v112, v228, v224, s94
    v_perm_b32 v113, v236, v232, s94
    v_perm_b32 v114, v244, v240, s94
    v_perm_b32 v115, v252, v248, s94
    s_nop 1
    v_mfma_f32_16x16x32_bf16 v[128:131], v[104:107], v[112:115], v[128:131]
    v_perm_b32 v116, v228, v224, s95
    v_perm_b32 v117, v236, v232, s95
    v_perm_b32 v118, v244, v240, s95
    v_perm_b32 v119, v252, v248, s95
    s_nop 1
    v_mfma_f32_16x16x32_bf16 v[132:135], v[104:107], v[116:119], v[132:135]
    v_perm_b32 v120, v229, v225, s94
    v_perm_b32 v121, v237, v233, s94
    v_perm_b32 v122, v245, v241, s94
    v_perm_b32 v123, v253, v249, s94
    s_nop 1
    v_mfma_f32_16x16x32_bf16 v[136:139], v[104:107], v[120:123], v[136:139]
    v_perm_b32 v124, v229, v225, s95
    v_perm_b32 v125, v237, v233, s95
    v_perm_b32 v126, v245, v241, s95
    v_perm_b32 v127, v253, v249, s95
    s_nop 1
    v_mfma_f32_16x16x32_bf16 v[140:143], v[104:107], v[124:127], v[140:143]
    v_perm_b32 v112, v230, v226, s94
    v_perm_b32 v113, v238, v234, s94
    v_perm_b32 v114, v246, v242, s94
    v_perm_b32 v115, v254, v250, s94
    s_nop 1
    v_mfma_f32_16x16x32_bf16 v[144:147], v[104:107], v[112:115], v[144:147]
    v_perm_b32 v116, v230, v226, s95
    v_perm_b32 v117, v238, v234, s95
    v_perm_b32 v118, v246, v242, s95
    v_perm_b32 v119, v254, v250, s95
    s_nop 1
    v_mfma_f32_16x16x32_bf16 v[148:151], v[104:107], v[116:119], v[148:151]
    v_perm_b32 v120, v231, v227, s94
    v_perm_b32 v121, v239, v235, s94
    v_perm_b32 v122, v247, v243, s94
    v_perm_b32 v123, v255, v251, s94
    s_nop 1
    v_mfma_f32_16x16x32_bf16 v[152:155], v[104:107], v[120:123], v[152:155]
    v_perm_b32 v124, v231, v227, s95
    v_perm_b32 v125, v239, v235, s95
    v_perm_b32 v126, v247, v243, s95
    v_perm_b32 v127, v255, v251, s95
    s_nop 1
    v_mfma_f32_16x16x32_bf16 v[156:159], v[104:107], v[124:127], v[156:159]
    s_memrealtime s[8:9]
    s_waitcnt lgkmcnt(0)
    s_sub_u32 s8, s8, s30
    s_cmpk_ge_u32 s8, 2218
    s_nop 3
    s_cbranch_scc1 .ap_112
    s_waitcnt vmcnt(5)
    s_cmpk_ge_u32 s8, 2153
    s_cbranch_scc1 .ap_112
    s_waitcnt vmcnt(3)
    s_bitcmp1_b64 s[14:15], 63
    s_cbranch_scc0 1
    s_waitcnt vmcnt(2)
    s_cmpk_ge_u32 s8, 2078
    s_cbranch_scc1 .ap_112
    s_waitcnt vmcnt(1)
.ap_112:
    s_add_u32 s63, s69, 450560
    buffer_load_dwordx4 v[92:95], v2, s[44:47], s63 offen nt
    s_setprio 0
    s_waitcnt vmcnt(6)
    v_perm_b32 v160, v44, v36, s94
    v_perm_b32 v164, v44, v36, s95
    v_perm_b32 v168, v45, v37, s94
    v_perm_b32 v172, v45, v37, s95
    v_perm_b32 v176, v46, v38, s94
    v_perm_b32 v180, v46, v38, s95
    v_perm_b32 v184, v47, v39, s94
    v_perm_b32 v188, v47, v39, s95
    s_waitcnt vmcnt(4)
    v_perm_b32 v161, v60, v52, s94
    v_perm_b32 v165, v60, v52, s95
    v_perm_b32 v169, v61, v53, s94
    v_perm_b32 v173, v61, v53, s95
    v_perm_b32 v177, v62, v54, s94
    v_perm_b32 v181, v62, v54, s95
    v_perm_b32 v185, v63, v55, s94
    v_perm_b32 v189, v63, v55, s95
    v_mfma_f32_16x16x16_bf16 v[128:131], v[108:109], v[160:161], v[128:131]
    v_mfma_f32_16x16x16_bf16 v[132:135], v[108:109], v[164:165], v[132:135]
    v_mfma_f32_16x16x16_bf16 v[136:139], v[108:109], v[168:169], v[136:139]
    v_mfma_f32_16x16x16_bf16 v[140:143], v[108:109], v[172:173], v[140:143]
    v_mfma_f32_16x16x16_bf16 v[144:147], v[108:109], v[176:177], v[144:147]
    v_mfma_f32_16x16x16_bf16 v[148:151], v[108:109], v[180:181], v[148:151]
    v_mfma_f32_16x16x16_bf16 v[152:155], v[108:109], v[184:185], v[152:155]
    v_mfma_f32_16x16x16_bf16 v[156:159], v[108:109], v[188:189], v[156:159]
    s_waitcnt vmcnt(2)
    v_perm_b32 v162, v76, v68, s94
    v_perm_b32 v166, v76, v68, s95
    v_perm_b32 v170, v77, v69, s94
    v_perm_b32 v174, v77, v69, s95
    v_perm_b32 v178, v78, v70, s94
    v_perm_b32 v182, v78, v70, s95
    v_perm_b32 v186, v79, v71, s94
    v_perm_b32 v190, v79, v71, s95
    s_lshl4_add_u32 s59, s67, s66
    s_lshl1_add_u32 s59, s59, s68
    s_lshl_b32 s59, s59, 9
    s_add_u32 s59, s59, 0x210000
    s_mov_b32 s60, 0x07060503
    s_mov_b32 s61, 0x07060502
    s_mov_b32 s62, 0x07060501
.Ltail_ar:
    s_waitcnt vmcnt(0)
    v_perm_b32 v163, v92, v84, s94
    v_perm_b32 v167, v92, v84, s95
    v_perm_b32 v171, v93, v85, s94
    v_perm_b32 v175, v93, v85, s95
    v_perm_b32 v179, v94, v86, s94
    v_perm_b32 v183, v94, v86, s95
    v_perm_b32 v187, v95, v87, s94
    v_perm_b32 v191, v95, v87, s95
    v_mfma_f32_16x16x16_bf16 v[128:131], v[110:111], v[162:163], v[128:131]
    v_mfma_f32_16x16x16_bf16 v[132:135], v[110:111], v[166:167], v[132:135]
    v_mfma_f32_16x16x16_bf16 v[136:139], v[110:111], v[170:171], v[136:139]
    v_mfma_f32_16x16x16_bf16 v[140:143], v[110:111], v[174:175], v[140:143]
    v_mfma_f32_16x16x16_bf16 v[144:147], v[110:111], v[178:179], v[144:147]
    v_mfma_f32_16x16x16_bf16 v[148:151], v[110:111], v[182:183], v[148:151]
    v_mfma_f32_16x16x16_bf16 v[152:155], v[110:111], v[186:187], v[152:155]
    v_mfma_f32_16x16x16_bf16 v[156:159], v[110:111], v[190:191], v[156:159]
    s_nop 1
    s_mov_b64 exec, 0xffffffff
    ds_write2_b32 v10, v128, v132 offset0:0 offset1:1
    ds_write2_b32 v10, v136, v140 offset0:2 offset1:3
    s_nop 0
    ds_write2_b32 v10, v144, v148 offset0:4 offset1:5
    s_nop 0
    ds_write2_b32 v10, v152, v156 offset0:6 offset1:7
    s_mov_b64 exec, -1
    s_waitcnt lgkmcnt(0)
    s_barrier
    s_cmp_lg_u32 s3, 7
    s_cbranch_scc1 .opub_113
    ds_read_b128 v[196:199], v9 offset:0
    ds_read_b128 v[200:203], v9 offset:1024
    ds_read_b128 v[204:207], v9 offset:2048
    ds_read_b128 v[208:211], v9 offset:3072
    ds_read_b128 v[212:215], v9 offset:4096
    ds_read_b128 v[216:219], v9 offset:5120
    ds_read_b128 v[220:223], v9 offset:6144
    ds_read_b128 v[224:227], v9 offset:7168
    s_waitcnt lgkmcnt(6)
    v_pk_add_f32 v[196:197], v[196:197], v[200:201]
    v_pk_add_f32 v[198:199], v[198:199], v[202:203]
    s_waitcnt lgkmcnt(4)
    v_pk_add_f32 v[204:205], v[204:205], v[208:209]
    v_pk_add_f32 v[206:207], v[206:207], v[210:211]
    v_pk_add_f32 v[196:197], v[196:197], v[204:205]
    v_pk_add_f32 v[198:199], v[198:199], v[206:207]
    s_waitcnt lgkmcnt(2)
    v_pk_add_f32 v[212:213], v[212:213], v[216:217]
    v_pk_add_f32 v[214:215], v[214:215], v[218:219]
    s_waitcnt lgkmcnt(0)
    v_pk_add_f32 v[220:221], v[220:221], v[224:225]
    v_pk_add_f32 v[222:223], v[222:223], v[226:227]
    v_pk_add_f32 v[212:213], v[212:213], v[220:221]
    v_pk_add_f32 v[214:215], v[214:215], v[222:223]
    v_pk_add_f32 v[196:197], v[196:197], v[212:213]
    v_pk_add_f32 v[198:199], v[198:199], v[214:215]
    v_perm_b32 v12, v196, v199, s60
    v_perm_b32 v13, v197, v199, s61
    v_perm_b32 v14, v198, v199, s62
    s_add_u32 s57, s59, 0xac000
    buffer_store_dwordx4 v[12:15], v11, s[36:39], s57 offen
    buffer_store_dwordx4 v[12:15], v11, s[36:39], s59 offen sc1
.opub_113:
    s_barrier
    s_lshl_b32 s59, s64, 5
    s_add_u32 s59, s59, s3
    s_lshl_b32 s59, s59, 10
    s_add_u32 s59, s59, 0x210000
    s_mov_b32 s60, 0x04000c0c
    s_mov_b32 s61, 0x0706000c
    v_mov_b32 v143, s34
    s_add_u32 s58, s59, s0
    s_lshl1_add_u32 s59, s59, 0xac000
    s_cmp_eq_u32 s0, 0
    s_cselect_b32 s32, 64, 0
    buffer_load_dwordx4 v[192:195], v11, s[36:39], s58 offen offset:0 sc1
    buffer_load_dwordx4 v[196:199], v11, s[36:39], s58 offen offset:512 sc1
    buffer_load_dwordx4 v[200:203], v7, s[36:39], s58 offen offset:0 sc1
    buffer_load_dwordx4 v[204:207], v7, s[36:39], s58 offen offset:512 sc1
    ds_read_b64_tr_b16 v[160:161], v16 offset:0
    ds_read_b64_tr_b16 v[162:163], v16 offset:512
    ds_read_b64_tr_b16 v[176:177], v17 offset:0
    ds_read_b64_tr_b16 v[178:179], v17 offset:512
    ds_read_b64_tr_b16 v[164:165], v16 offset:4096
    ds_read_b64_tr_b16 v[166:167], v16 offset:4608
    ds_read_b64_tr_b16 v[180:181], v17 offset:4096
    ds_read_b64_tr_b16 v[182:183], v17 offset:4608
    ds_read_b64_tr_b16 v[168:169], v16 offset:8192
    ds_read_b64_tr_b16 v[170:171], v16 offset:8704
    ds_read_b64_tr_b16 v[184:185], v17 offset:8192
    ds_read_b64_tr_b16 v[186:187], v17 offset:8704
    ds_read_b64_tr_b16 v[172:173], v16 offset:12288
    ds_read_b64_tr_b16 v[174:175], v16 offset:12800
    ds_read_b64_tr_b16 v[188:189], v17 offset:12288
    ds_read_b64_tr_b16 v[190:191], v17 offset:12800
    s_mul_i32 s40, s3, 9
    s_add_u32 s40, s40, s65
    s_lshl_b32 s40, s40, 11
    s_add_u32 s41, s40, 0x368000
    s_lshl_b32 s63, s64, 8
    s_add_u32 s63, s63, s41
    s_mul_i32 s101, s64, 18432
    s_mul_i32 s56, s3, 2304
    s_add_u32 s101, s101, s56
    s_add_u32 s101, s101, 0x250000
    s_lshl_b32 s42, s65, 8
    s_add_u32 s42, s42, s101
    v_mov_b32 v253, s34
    v_mov_b32 v255, s34
    s_nop 1
    s_branch .mpw_118
.mp_114:
    s_or_b64 exec, s[88:89], 1
    buffer_load_dwordx4 v[192:195], v11, s[36:39], s58 offen offset:0 sc1
    s_or_b64 exec, s[90:91], 1
    buffer_load_dwordx4 v[196:199], v11, s[36:39], s58 offen offset:512 sc1
    s_or_b64 exec, s[92:93], 1
    buffer_load_dwordx4 v[200:203], v7, s[36:39], s58 offen offset:0 sc1
    s_or_b64 exec, s[56:57], 1
    buffer_load_dwordx4 v[204:207], v7, s[36:39], s58 offen offset:512 sc1
    s_mov_b64 exec, -1
    s_sub_u32 s35, s35, 1
    s_cbranch_scc1 .Lexit
    s_sub_u32 vcc_lo, s59, s58
    s_add_u32 s32, s32, 1
    s_cmp_ge_u32 s32, 64
    s_cselect_b32 s58, vcc_lo, s58
.mpw_118:
    s_waitcnt vmcnt(0)
.mpj_115:
    v_cmp_ne_u32 s[88:89], s34, v195
    v_cmp_ne_u32 s[90:91], s34, v199
    v_cmp_ne_u32 s[92:93], s34, v203
    v_cmp_ne_u32 s[56:57], s34, v207
    s_or_b64 vcc, s[88:89], s[90:91]
    s_or_b64 vcc, vcc, s[92:93]
    s_or_b64 vcc, vcc, s[56:57]
    s_cbranch_scc1 .mp_114
    v_perm_b32 v195, v192, v193, s60
    v_perm_b32 v199, v196, v197, s60
    v_perm_b32 v203, v200, v201, s60
    v_perm_b32 v207, v204, v205, s60
    v_perm_b32 v195, v195, v194, s61
    v_perm_b32 v199, v199, v198, s61
    v_perm_b32 v203, v203, v202, s61
    v_perm_b32 v207, v207, v206, s61
    v_pk_add_f32 v[192:193], v[192:193], v[196:197]
    v_pk_add_f32 v[194:195], v[194:195], v[198:199]
    v_pk_add_f32 v[200:201], v[200:201], v[204:205]
    v_pk_add_f32 v[202:203], v[202:203], v[206:207]
    v_cvt_pk_bf16_f32 v192, v192, v193
    v_cvt_pk_bf16_f32 v193, v194, v195
    v_cvt_pk_bf16_f32 v200, v200, v201
    v_cvt_pk_bf16_f32 v201, v202, v203
    ds_write_b64 v18, v[192:193]
    ds_write_b64 v18, v[200:201] offset:512
    s_waitcnt lgkmcnt(0)
    s_barrier
    ds_read_b128 v[224:227], v19 offset:0
    ds_read_b128 v[228:231], v19 offset:64
    ds_read_b128 v[232:235], v19 offset:128
    ds_read_b128 v[236:239], v19 offset:192
    s_waitcnt lgkmcnt(3)
    v_mfma_f32_16x16x32_bf16 v[132:135], v[160:163], v[224:227], 0
    v_mfma_f32_16x16x32_bf16 v[136:139], v[176:179], v[224:227], 0
    s_waitcnt lgkmcnt(2)
    v_mfma_f32_16x16x32_bf16 v[132:135], v[164:167], v[228:231], v[132:135]
    v_mfma_f32_16x16x32_bf16 v[136:139], v[180:183], v[228:231], v[136:139]
    s_waitcnt lgkmcnt(1)
    v_mfma_f32_16x16x32_bf16 v[132:135], v[168:171], v[232:235], v[132:135]
    v_mfma_f32_16x16x32_bf16 v[136:139], v[184:187], v[232:235], v[136:139]
    s_waitcnt lgkmcnt(0)
    v_mfma_f32_16x16x32_bf16 v[132:135], v[172:175], v[236:239], v[132:135]
    v_mfma_f32_16x16x32_bf16 v[136:139], v[188:191], v[236:239], v[136:139]
    s_nop 7
    v_cndmask_b32 v132, v132, v136, s[96:97]
    v_cndmask_b32 v133, v133, v137, s[96:97]
    v_cndmask_b32 v134, v134, v138, s[96:97]
    v_cndmask_b32 v135, v135, v139, s[96:97]
    ds_write_b128 v20, v[132:135]
    s_waitcnt lgkmcnt(0)
    s_barrier
    ds_read_b128 v[224:227], v21 offset:0
    ds_read_b128 v[228:231], v21 offset:2176
    ds_read_b128 v[232:235], v21 offset:4352
    ds_read_b128 v[236:239], v21 offset:6528
    s_mov_b32 s60, 0x07060503
    s_mov_b32 s61, 0x07060502
    s_mov_b32 s62, 0x07060501
    s_waitcnt lgkmcnt(2)
    v_pk_add_f32 v[224:225], v[224:225], v[228:229]
    v_pk_add_f32 v[226:227], v[226:227], v[230:231]
    s_waitcnt lgkmcnt(0)
    v_pk_add_f32 v[232:233], v[232:233], v[236:237]
    v_pk_add_f32 v[234:235], v[234:235], v[238:239]
    v_pk_add_f32 v[224:225], v[224:225], v[232:233]
    v_pk_add_f32 v[226:227], v[226:227], v[234:235]
    v_perm_b32 v140, v224, v227, s60
    v_perm_b32 v141, v225, v227, s61
    v_perm_b32 v142, v226, v227, s62
    s_mov_b64 exec, 0xffff
    buffer_store_dwordx4 v[140:143], v2, s[36:39], s63 offen sc1
    s_mov_b64 exec, -1
    s_barrier
    s_mov_b32 s60, 0x04000c0c
    s_mov_b32 s61, 0x0706000c
    s_mov_b64 s[88:89], exec
    s_mov_b64 s[90:91], exec
.mp_119:
    s_or_b64 exec, s[88:89], 1
    buffer_load_dwordx4 v[108:111], v2, s[36:39], s41 offen offset:0 sc1
    s_or_b64 exec, s[90:91], 1
    buffer_load_dwordx4 v[112:115], v2, s[36:39], s41 offen offset:1024 sc1
    s_mov_b64 exec, -1
    s_sub_u32 s35, s35, 1
    s_cbranch_scc1 .Lexit
    s_waitcnt vmcnt(0)
.mpj_120:
    v_cmp_ne_u32 s[88:89], s34, v111
    v_cmp_ne_u32 s[90:91], s34, v115
    s_or_b64 vcc, s[88:89], s[90:91]
    s_cbranch_scc1 .mp_119
    v_perm_b32 v111, v108, v109, s60
    v_perm_b32 v115, v112, v113, s60
    v_perm_b32 v111, v111, v110, s61
    v_perm_b32 v115, v115, v114, s61
    v_pk_add_f32 v[248:249], v[108:109], v[112:113]
    v_pk_add_f32 v[250:251], v[110:111], v[114:115]
    s_nop 1
    v_permlane32_swap_b32 v248, v250
    v_permlane32_swap_b32 v249, v251
    v_pk_add_f32 v[248:249], v[248:249], v[250:251]
    s_nop 1
    v_permlane16_swap_b32 v248, v249
    v_add_f32 v248, v248, v249
    v_cvt_pk_bf16_f32 v248, 0, v248
    v_mul_f32 v248, v248, v23
    v_cvt_pk_bf16_f32 v248, 0, v248
    v_add_f32 v249, v248, v29
    v_add_f32 v248, v248, v29
    v_mov_b32 v24, v248
    s_nop 0
    v_permlane16_swap_b32 v248, v249
    v_cvt_pk_bf16_f32 v252, v248, v249
    v_cvt_pk_bf16_f32 v254, v248, v249
    s_nop 1
    v_permlane32_swap_b32 v252, v254
    s_mov_b64 exec, 0xffff
    s_add_u32 s57, s42, 0xac000
    buffer_store_dwordx4 v[252:255], v2, s[36:39], s57 offen
    s_cmp_lg_u32 s0, 0
    s_cbranch_scc1 2
    buffer_store_dwordx4 v[252:255], v2, s[36:39], s42 offen sc1
    s_mov_b64 exec, -1
    s_cmp_eq_u32 s3, s64
    s_cbranch_scc1 .r2_123
    s_branch .Lexit
.r2_123:
    v_cvt_pk_bf16_f32 v24, 0, v24
    s_nop 1
    s_branch .gpc_125
.gp_124:
    buffer_load_dwordx4 v[32:35], v2, s[36:39], s99 offen offset:0 sc1
    buffer_load_dwordx4 v[40:43], v2, s[36:39], s99 offen offset:1024 sc1
    buffer_load_dwordx2 v[48:49], v5, s[36:39], s99 offen offset:0 sc1
    buffer_load_dwordx4 v[56:59], v2, s[36:39], s100 offen offset:0 sc1
    buffer_load_dwordx4 v[64:67], v2, s[36:39], s100 offen offset:1024 sc1
    buffer_load_dwordx2 v[50:51], v5, s[36:39], s100 offen offset:0 sc1
    buffer_load_dwordx2 v[74:75], v6, s[36:39], s99 offen offset:0 sc1
    buffer_load_dwordx2 v[80:81], v6, s[36:39], s100 offen offset:0 sc1
    buffer_load_dwordx2 v[82:83], v6, s[36:39], s33 offen offset:0 sc1
    s_waitcnt vmcnt(0)
.gpc_125:
    v_min3_u32 v25, v33, v35, v41
    v_max3_u32 v26, v33, v35, v41
    v_min3_u32 v25, v25, v43, v49
    v_max3_u32 v26, v26, v43, v49
    v_min3_u32 v25, v25, v57, v59
    v_max3_u32 v26, v26, v57, v59
    v_min3_u32 v25, v25, v65, v67
    v_max3_u32 v26, v26, v65, v67
    v_min3_u32 v25, v25, v51, v75
    v_max3_u32 v26, v26, v51, v75
    v_min3_u32 v25, v25, v81, v83
    v_max3_u32 v26, v26, v81, v83
    v_cmp_eq_u32 vcc, s34, v25
    v_cmp_eq_u32 s[56:57], s34, v26
    s_and_b64 vcc, vcc, s[56:57]
    s_cmp_eq_u64 vcc, exec
    s_nop 2
    s_cbranch_scc1 .gpd_126
    s_sub_u32 s35, s35, 1
    s_cbranch_scc1 .Lexit
    s_sleep 2
    s_branch .gp_124
.gpd_126:
    v_lshlrev_b32 v160, 16, v32
    v_and_b32 v161, 0xffff0000, v32
    v_lshlrev_b32 v170, 16, v56
    v_and_b32 v171, 0xffff0000, v56
    v_lshlrev_b32 v162, 16, v34
    v_and_b32 v163, 0xffff0000, v34
    v_lshlrev_b32 v172, 16, v58
    v_and_b32 v173, 0xffff0000, v58
    v_lshlrev_b32 v164, 16, v40
    v_and_b32 v165, 0xffff0000, v40
    v_lshlrev_b32 v174, 16, v64
    v_and_b32 v175, 0xffff0000, v64
    v_lshlrev_b32 v166, 16, v42
    v_and_b32 v167, 0xffff0000, v42
    v_lshlrev_b32 v176, 16, v66
    v_and_b32 v177, 0xffff0000, v66
    v_lshlrev_b32 v168, 16, v48
    v_and_b32 v169, 0xffff0000, v48
    v_lshlrev_b32 v178, 16, v50
    v_and_b32 v179, 0xffff0000, v50
    v_lshlrev_b32 v75, 16, v74
    v_and_b32 v74, 0xffff0000, v74
    s_mov_b32 vcc_lo, 0xffff0000
    s_mov_b32 vcc_hi, 0xffff0000
    v_cndmask_b32 v75, v75, v74, vcc
    v_lshlrev_b32 v81, 16, v80
    v_and_b32 v80, 0xffff0000, v80
    s_mov_b32 vcc_lo, 0xffff0000
    s_mov_b32 vcc_hi, 0xffff0000
    v_cndmask_b32 v81, v81, v80, vcc
    v_lshlrev_b32 v83, 16, v82
    v_and_b32 v82, 0xffff0000, v82
    s_mov_b32 vcc_lo, 0xffff0000
    s_mov_b32 vcc_hi, 0xffff0000
    v_cndmask_b32 v83, v83, v82, vcc
    s_waitcnt vmcnt(0)
    s_add_u32 s58, s101, s0
    s_lshl1_add_u32 s101, s101, 0xac000
    s_cmp_eq_u32 s0, 0
    s_cselect_b32 s32, 64, 0
    s_mov_b64 s[88:89], exec
    s_mov_b64 s[90:91], exec
    s_mov_b64 s[92:93], exec
.mp_127:
    s_or_b64 exec, s[88:89], 1
    buffer_load_dwordx4 v[180:183], v2, s[36:39], s58 offen offset:0 sc1
    s_or_b64 exec, s[90:91], 1
    buffer_load_dwordx4 v[184:187], v2, s[36:39], s58 offen offset:1024 sc1
    s_or_b64 exec, s[92:93], 1
    buffer_load_dwordx2 v[188:189], v5, s[36:39], s58 offen offset:0 sc1
    s_mov_b64 exec, -1
    s_sub_u32 s35, s35, 1
    s_cbranch_scc1 .Lexit
    s_sub_u32 vcc_lo, s101, s58
    s_add_u32 s32, s32, 1
    s_cmp_ge_u32 s32, 64
    s_cselect_b32 s58, vcc_lo, s58
    s_waitcnt vmcnt(0)
.mpj_128:
    v_cmp_ne_u32 s[88:89], s34, v181
    v_cmp_ne_u32 vcc, s34, v183
    s_or_b64 s[88:89], s[88:89], vcc
    v_cmp_ne_u32 s[90:91], s34, v185
    v_cmp_ne_u32 vcc, s34, v187
    s_or_b64 s[90:91], s[90:91], vcc
    v_cmp_ne_u32 s[92:93], s34, v189
    s_or_b64 vcc, s[88:89], s[90:91]
    s_or_b64 vcc, vcc, s[92:93]
    s_cbranch_scc1 .mp_127
    s_mov_b32 s56, 0x3f803f80
    v_dot2_f32_bf16 v200, v180, s56, 0
    v_dot2_f32_bf16 v201, v180, v180, 0
    v_dot2_f32_bf16 v200, v182, s56, v200
    v_dot2_f32_bf16 v201, v182, v182, v201
    v_dot2_f32_bf16 v200, v184, s56, v200
    v_dot2_f32_bf16 v201, v184, v184, v201
    v_dot2_f32_bf16 v200, v186, s56, v200
    v_dot2_f32_bf16 v201, v186, v186, v201
    s_mov_b64 exec, 0xffffffff
    v_dot2_f32_bf16 v200, v188, s56, v200
    v_dot2_f32_bf16 v201, v188, v188, v201
    s_mov_b64 exec, -1
    s_nop 1
    v_permlane32_swap_b32 v200, v201
    v_add_f32 v200, v200, v201
    v_mov_b32 v202, v200
    s_nop 1
    v_permlane16_swap_b32 v202, v200
    v_add_f32 v200, v202, v200
    v_lshlrev_b32 v190, 16, v180
    v_and_b32 v191, 0xffff0000, v180
    v_add_f32_dpp v200, v200, v200 row_ror:8 row_mask:0xf bank_mask:0xf
    v_lshlrev_b32 v192, 16, v182
    v_and_b32 v193, 0xffff0000, v182
    v_add_f32_dpp v200, v200, v200 row_ror:4 row_mask:0xf bank_mask:0xf
    v_lshlrev_b32 v194, 16, v184
    v_and_b32 v195, 0xffff0000, v184
    v_add_f32_dpp v200, v200, v200 quad_perm:[2,3,0,1] row_mask:0xf bank_mask:0xf
    v_lshlrev_b32 v196, 16, v186
    v_and_b32 v197, 0xffff0000, v186
    v_add_f32_dpp v200, v200, v200 quad_perm:[1,0,3,2] row_mask:0xf bank_mask:0xf
    v_mul_f32 v200, 0x3ae38e39, v200
    v_lshlrev_b32 v198, 16, v188
    v_and_b32 v199, 0xffff0000, v188
    v_readlane_b32 s56, v200, 0
    v_readlane_b32 s57, v200, 32
    s_nop 0
    v_mov_b32 v200, s56
    v_fma_f32 v201, -v200, v200, s57
    v_max_f32 v201, 0, v201
    v_cvt_pk_bf16_f32 v203, 0, v201
    v_cvt_pk_bf16_f32 v201, 0, -v200
    v_cvt_pk_bf16_f32 v200, 0, -v200
    v_add_f32 v203, 0x3727c5ac, v203
    v_pk_add_f32 v[190:191], v[190:191], v[200:201]
    v_pk_add_f32 v[192:193], v[192:193], v[200:201]
    v_pk_add_f32 v[194:195], v[194:195], v[200:201]
    v_cvt_pk_bf16_f32 v203, 0, v203
    v_pk_add_f32 v[196:197], v[196:197], v[200:201]
    v_pk_add_f32 v[198:199], v[198:199], v[200:201]
    v_cvt_pk_bf16_f32 v190, 0, v190
    v_sqrt_f32 v203, v203
    v_cvt_pk_bf16_f32 v191, 0, v191
    v_cvt_pk_bf16_f32 v192, 0, v192
    v_cvt_pk_bf16_f32 v193, 0, v193
    v_cvt_pk_bf16_f32 v203, 0, v203
    v_cvt_pk_bf16_f32 v194, 0, v194
    v_cvt_pk_bf16_f32 v195, 0, v195
    v_cvt_pk_bf16_f32 v196, 0, v196
    v_rcp_f32 v202, v203
    v_cvt_pk_bf16_f32 v197, 0, v197
    v_cvt_pk_bf16_f32 v198, 0, v198
    v_cvt_pk_bf16_f32 v199, 0, v199
    v_mov_b32 v203, v202
    v_pk_mul_f32 v[190:191], v[190:191], v[202:203]
    v_pk_mul_f32 v[192:193], v[192:193], v[202:203]
    v_pk_mul_f32 v[194:195], v[194:195], v[202:203]
    v_pk_mul_f32 v[196:197], v[196:197], v[202:203]
    v_pk_mul_f32 v[198:199], v[198:199], v[202:203]
    v_cvt_pk_bf16_f32 v190, 0, v190
    v_cvt_pk_bf16_f32 v191, 0, v191
    v_cvt_pk_bf16_f32 v192, 0, v192
    v_cvt_pk_bf16_f32 v193, 0, v193
    v_cvt_pk_bf16_f32 v194, 0, v194
    v_cvt_pk_bf16_f32 v195, 0, v195
    v_cvt_pk_bf16_f32 v196, 0, v196
    v_cvt_pk_bf16_f32 v197, 0, v197
    v_cvt_pk_bf16_f32 v198, 0, v198
    v_cvt_pk_bf16_f32 v199, 0, v199
    v_pk_mul_f32 v[190:191], v[190:191], v[170:171]
    v_pk_mul_f32 v[192:193], v[192:193], v[172:173]
    v_pk_mul_f32 v[194:195], v[194:195], v[174:175]
    v_pk_mul_f32 v[196:197], v[196:197], v[176:177]
    v_pk_mul_f32 v[198:199], v[198:199], v[178:179]
    v_cvt_pk_bf16_f32 v190, 0, v190
    v_cvt_pk_bf16_f32 v191, 0, v191
    v_cvt_pk_bf16_f32 v192, 0, v192
    v_cvt_pk_bf16_f32 v193, 0, v193
    v_cvt_pk_bf16_f32 v194, 0, v194
    v_cvt_pk_bf16_f32 v195, 0, v195
    v_cvt_pk_bf16_f32 v196, 0, v196
    v_cvt_pk_bf16_f32 v197, 0, v197
    v_cvt_pk_bf16_f32 v198, 0, v198
    v_cvt_pk_bf16_f32 v199, 0, v199
    v_pk_add_f32 v[190:191], v[190:191], v[160:161]
    v_pk_add_f32 v[192:193], v[192:193], v[162:163]
    v_pk_add_f32 v[194:195], v[194:195], v[164:165]
    v_pk_add_f32 v[196:197], v[196:197], v[166:167]
    v_pk_add_f32 v[198:199], v[198:199], v[168:169]
    v_cvt_pk_bf16_f32 v206, v190, v191
    v_cvt_pk_bf16_f32 v207, v192, v193
    v_cvt_pk_bf16_f32 v208, v194, v195
    v_cvt_pk_bf16_f32 v209, v196, v197
    v_cvt_pk_bf16_f32 v210, v198, v199
    v_dot2_f32_bf16 v14, v206, v88, 0
    v_dot2_f32_bf16 v14, v207, v89, v14
    v_dot2_f32_bf16 v14, v208, v90, v14
    v_dot2_f32_bf16 v14, v209, v91, v14
    s_mov_b64 exec, 0xffffffff
    v_dot2_f32_bf16 v14, v210, v30, v14
    s_mov_b64 exec, -1
    s_nop 1
    v_mov_b32 v15, v14
    s_nop 1
    v_permlane32_swap_b32 v15, v14
    v_add_f32 v14, v15, v14
    v_mov_b32 v15, v14
    s_nop 1
    v_permlane16_swap_b32 v15, v14
    v_add_f32 v14, v15, v14
    s_nop 1
    v_add_f32_dpp v14, v14, v14 row_ror:8 row_mask:0xf bank_mask:0xf
    s_nop 1
    v_add_f32_dpp v14, v14, v14 row_ror:4 row_mask:0xf bank_mask:0xf
    s_nop 1
    v_add_f32_dpp v14, v14, v14 quad_perm:[2,3,0,1] row_mask:0xf bank_mask:0xf
    s_nop 1
    v_add_f32_dpp v14, v14, v14 quad_perm:[1,0,3,2] row_mask:0xf bank_mask:0xf
    v_cvt_pk_bf16_f32 v14, 0, v14
    v_max_f32 v14, 0xc2ae0000, v14
    v_min_f32 v14, 0x43000000, v14
    v_mul_f32 v15, 0xbfb8aa3b, v14
    v_fma_f32 v16, v14, s98, -v15
    v_fmac_f32 v16, 0xb2a57060, v14
    v_exp_f32 v15, v15
    v_mul_f32 v16, 0x3f317218, v16
    v_fmac_f32 v15, v15, v16
    v_add_f32 v15, 1.0, v15
    v_rcp_f32 v16, v15
    s_nop 0
    v_fma_f32 v15, -v15, v16, 1.0
    v_fma_f32 v14, v15, v16, v16
    v_cvt_pk_bf16_f32 v14, 0, v14
    v_add_f32 v17, v24, v200
    v_cvt_pk_bf16_f32 v17, 0, v17
    v_mul_f32 v17, v17, v202
    v_cvt_pk_bf16_f32 v17, 0, v17
    v_mul_f32 v17, v17, v81
    v_cvt_pk_bf16_f32 v17, 0, v17
    v_add_f32 v17, v17, v75
    v_cvt_pk_bf16_f32 v17, 0, v17
    s_lshl_b32 s59, s40, 1
    s_add_u32 s58, s59, 0x38c000
    s_mov_b32 s60, 0x04000c0c
    s_mov_b32 s61, 0x0706000c
    s_mov_b32 s48, s28
    s_and_b32 s49, s29, 0xffff
    s_mov_b32 s50, 0x2400
    s_mov_b32 s51, 0x00020000
    s_mul_i32 s63, s3, 1152
    s_lshl_b32 s56, s65, 7
    s_add_u32 s63, s63, s56
    s_mov_b64 s[88:89], exec
    s_mov_b64 s[90:91], exec
    s_mov_b64 s[92:93], exec
    s_mov_b64 s[56:57], exec
.mp_131:
    s_or_b64 exec, s[88:89], 1
    buffer_load_dwordx4 v[96:99], v2, s[36:39], s58 offen offset:0 sc1
    s_or_b64 exec, s[90:91], 1
    buffer_load_dwordx4 v[100:103], v2, s[36:39], s58 offen offset:1024 sc1
    s_or_b64 exec, s[92:93], 1
    buffer_load_dwordx4 v[104:107], v2, s[36:39], s58 offen offset:2048 sc1
    s_or_b64 exec, s[56:57], 1
    buffer_load_dwordx4 v[108:111], v2, s[36:39], s58 offen offset:3072 sc1
    s_mov_b64 exec, -1
    s_sub_u32 s35, s35, 1
    s_cbranch_scc1 .Lexit
    s_waitcnt vmcnt(0)
.mpj_132:
    v_cmp_ne_u32 s[88:89], s34, v99
    v_cmp_ne_u32 s[90:91], s34, v103
    v_cmp_ne_u32 s[92:93], s34, v107
    v_cmp_ne_u32 s[56:57], s34, v111
    s_or_b64 vcc, s[88:89], s[90:91]
    s_or_b64 vcc, vcc, s[92:93]
    s_or_b64 vcc, vcc, s[56:57]
    s_cbranch_scc1 .mp_131
    v_perm_b32 v99, v96, v97, s60
    v_perm_b32 v103, v100, v101, s60
    v_perm_b32 v107, v104, v105, s60
    v_perm_b32 v111, v108, v109, s60
    v_perm_b32 v99, v99, v98, s61
    v_perm_b32 v103, v103, v102, s61
    v_perm_b32 v107, v107, v106, s61
    v_perm_b32 v111, v111, v110, s61
    v_pk_add_f32 v[96:97], v[96:97], v[100:101]
    v_pk_add_f32 v[98:99], v[98:99], v[102:103]
    v_pk_add_f32 v[248:249], v[104:105], v[108:109]
    v_pk_add_f32 v[250:251], v[106:107], v[110:111]
    v_pk_add_f32 v[248:249], v[248:249], v[96:97]
    v_pk_add_f32 v[250:251], v[250:251], v[98:99]
    s_nop 1
    v_permlane32_swap_b32 v248, v250
    v_permlane32_swap_b32 v249, v251
    v_pk_add_f32 v[248:249], v[248:249], v[250:251]
    s_nop 1
    v_permlane16_swap_b32 v248, v249
    v_add_f32 v248, v248, v249
    v_cvt_pk_bf16_f32 v248, 0, v248
    v_mul_f32 v248, v248, v14
    v_cvt_pk_bf16_f32 v248, 0, v248
    v_add_f32 v248, v248, v17
    v_cvt_pk_bf16_f32 v248, 0, v248
    v_mul_f32 v248, v248, v83
    v_cvt_pk_bf16_f32 v248, 0, v248
    v_add_f32 v249, v248, v24
    v_add_f32 v248, v248, v24
    s_nop 1
    v_permlane16_swap_b32 v248, v249
    v_cvt_pk_bf16_f32 v252, v248, v249
    v_cvt_pk_bf16_f32 v253, v248, v249
    s_nop 1
    v_permlane32_swap_b32 v252, v253
    s_mov_b64 exec, 0xffff
    buffer_store_dwordx2 v[252:253], v3, s[48:51], s63 offen
    s_mov_b64 exec, -1
    s_waitcnt vmcnt(0)
    s_cmp_lg_u32 s2, 0
    s_cbranch_scc1 .Lexit
    v_mov_b32 v13, s34
    s_mov_b64 exec, 1
    buffer_store_dword v13, v2, s[36:39], 0 offen
    s_mov_b64 exec, -1
    s_branch .Lexit
.Latt_bc:
    v_and_b32 v8, 1, v0
    v_lshlrev_b32 v8, 8, v8
    v_and_b32 v9, 0x3c, v0
    v_lshl_add_u32 v9, v9, 2, v8
    v_lshlrev_b32 v7, 1, v9
    v_and_b32 v9, 0x3c, v0
    v_lshrrev_b32 v8, 4, v8
    v_and_b32 v9, 2, v0
    v_lshl_add_u32 v9, v9, 6, v8
    s_lshl_b32 s58, s66, 14
    s_lshl_b32 s59, s67, 10
    s_add_u32 s58, s58, s59
    s_add_u32 s58, s58, 0x40000
    s_lshl4_add_u32 s59, s66, s67
    s_lshl_b32 s59, s59, 8
    s_add_u32 s59, s59, 0x200000
    s_memrealtime s[8:9]
    s_waitcnt vmcnt(8)
    s_waitcnt lgkmcnt(0)
    s_sub_u32 s8, s8, s30
    s_cmpk_ge_u32 s8, 1147
    s_cbranch_scc1 .ap_135
    s_waitcnt vmcnt(5)
    s_cmpk_ge_u32 s8, 1082
    s_cbranch_scc1 .ap_135
    s_waitcnt vmcnt(3)
    s_bitcmp1_b64 s[14:15], 26
    s_cbranch_scc0 1
    s_waitcnt vmcnt(2)
    s_cmpk_ge_u32 s8, 1007
    s_cbranch_scc1 .ap_135
    s_waitcnt vmcnt(1)
.ap_135:
    s_add_u32 s63, s69, 409600
    buffer_load_dwordx4 v[88:91], v1, s[40:43], s63 offen nt
    s_memrealtime s[8:9]
    s_waitcnt vmcnt(8)
    s_waitcnt lgkmcnt(0)
    s_sub_u32 s8, s8, s30
    s_cmpk_ge_u32 s8, 1174
    s_cbranch_scc1 .ap_136
    s_waitcnt vmcnt(5)
    s_cmpk_ge_u32 s8, 1109
    s_cbranch_scc1 .ap_136
    s_waitcnt vmcnt(3)
    s_bitcmp1_b64 s[14:15], 27
    s_cbranch_scc0 1
    s_waitcnt vmcnt(2)
    s_cmpk_ge_u32 s8, 1034
    s_cbranch_scc1 .ap_136
    s_waitcnt vmcnt(1)
.ap_136:
    s_add_u32 s63, s69, 417792
    buffer_load_dwordx4 v[92:95], v1, s[40:43], s63 offen nt
    s_memrealtime s[8:9]
    s_waitcnt vmcnt(8)
    s_waitcnt lgkmcnt(0)
    s_sub_u32 s8, s8, s30
    s_cmpk_ge_u32 s8, 1201
    s_cbranch_scc1 .ap_137
    s_waitcnt vmcnt(5)
    s_cmpk_ge_u32 s8, 1136
    s_cbranch_scc1 .ap_137
    s_waitcnt vmcnt(3)
    s_bitcmp1_b64 s[14:15], 28
    s_cbranch_scc0 1
    s_waitcnt vmcnt(2)
    s_cmpk_ge_u32 s8, 1061
    s_cbranch_scc1 .ap_137
    s_waitcnt vmcnt(1)
.ap_137:
    s_add_u32 s63, s69, 425984
    buffer_load_dwordx4 v[120:123], v1, s[40:43], s63 offen nt
    s_memrealtime s[8:9]
    s_waitcnt vmcnt(8)
    s_waitcnt lgkmcnt(0)
    s_sub_u32 s8, s8, s30
    s_cmpk_ge_u32 s8, 1228
    s_cbranch_scc1 .ap_138
    s_waitcnt vmcnt(5)
    s_cmpk_ge_u32 s8, 1163
    s_cbranch_scc1 .ap_138
    s_waitcnt vmcnt(3)
    s_bitcmp1_b64 s[14:15], 29
    s_cbranch_scc0 1
    s_waitcnt vmcnt(2)
    s_cmpk_ge_u32 s8, 1088
    s_cbranch_scc1 .ap_138
    s_waitcnt vmcnt(1)
.ap_138:
    s_add_u32 s63, s69, 434176
    buffer_load_dwordx4 v[124:127], v1, s[40:43], s63 offen nt
    s_memrealtime s[8:9]
    s_waitcnt vmcnt(8)
    s_waitcnt lgkmcnt(0)
    s_sub_u32 s8, s8, s30
    s_cmpk_ge_u32 s8, 1255
    s_cbranch_scc1 .ap_139
    s_waitcnt vmcnt(5)
    s_cmpk_ge_u32 s8, 1190
    s_cbranch_scc1 .ap_139
    s_waitcnt vmcnt(3)
    s_bitcmp1_b64 s[14:15], 30
    s_cbranch_scc0 1
    s_waitcnt vmcnt(2)
    s_cmpk_ge_u32 s8, 1115
    s_cbranch_scc1 .ap_139
    s_waitcnt vmcnt(1)
.ap_139:
    s_add_u32 s63, s69, 442368
    buffer_load_dwordx4 v[152:155], v1, s[40:43], s63 offen nt
    s_memrealtime s[8:9]
    s_waitcnt vmcnt(8)
    s_waitcnt lgkmcnt(0)
    s_sub_u32 s8, s8, s30
    s_cmpk_ge_u32 s8, 1282
    s_cbranch_scc1 .ap_140
    s_waitcnt vmcnt(5)
    s_cmpk_ge_u32 s8, 1217
    s_cbranch_scc1 .ap_140
    s_waitcnt vmcnt(3)
    s_bitcmp1_b64 s[14:15], 31
    s_cbranch_scc0 1
    s_waitcnt vmcnt(2)
    s_cmpk_ge_u32 s8, 1142
    s_cbranch_scc1 .ap_140
    s_waitcnt vmcnt(1)
.ap_140:
    s_add_u32 s63, s69, 450560
    buffer_load_dwordx4 v[156:159], v1, s[40:43], s63 offen nt
    buffer_load_dwordx4 v[16:19], v7, s[36:39], s58 offen offset:0 sc1
    buffer_load_dwordx4 v[20:23], v7, s[36:39], s58 offen offset:16 sc1
    s_memrealtime s[8:9]
    s_waitcnt vmcnt(8)
    s_waitcnt lgkmcnt(0)
    s_sub_u32 s8, s8, s30
    s_cmpk_ge_u32 s8, 1309
    s_cbranch_scc1 .ap_141
    s_waitcnt vmcnt(5)
    s_cmpk_ge_u32 s8, 1244
    s_cbranch_scc1 .ap_141
    s_waitcnt vmcnt(3)
    s_bitcmp1_b64 s[14:15], 32
    s_cbranch_scc0 1
    s_waitcnt vmcnt(2)
    s_cmpk_ge_u32 s8, 1169
    s_cbranch_scc1 .ap_141
    s_waitcnt vmcnt(1)
.ap_141:
    s_add_u32 s63, s69, 0
    buffer_load_dwordx4 v[160:163], v2, s[44:47], s63 offen nt
    s_memrealtime s[8:9]
    s_waitcnt vmcnt(8)
    s_waitcnt lgkmcnt(0)
    s_sub_u32 s8, s8, s30
    s_cmpk_ge_u32 s8, 1336
    s_cbranch_scc1 .ap_142
    s_waitcnt vmcnt(5)
    s_cmpk_ge_u32 s8, 1271
    s_cbranch_scc1 .ap_142
    s_waitcnt vmcnt(3)
    s_bitcmp1_b64 s[14:15], 33
    s_cbranch_scc0 1
    s_waitcnt vmcnt(2)
    s_cmpk_ge_u32 s8, 1196
    s_cbranch_scc1 .ap_142
    s_waitcnt vmcnt(1)
.ap_142:
    s_add_u32 s63, s69, 8192
    buffer_load_dwordx4 v[164:167], v2, s[44:47], s63 offen nt
    s_memrealtime s[8:9]
    s_waitcnt vmcnt(8)
    s_waitcnt lgkmcnt(0)
    s_sub_u32 s8, s8, s30
    s_cmpk_ge_u32 s8, 1363
    s_cbranch_scc1 .ap_143
    s_waitcnt vmcnt(5)
    s_cmpk_ge_u32 s8, 1298
    s_cbranch_scc1 .ap_143
    s_waitcnt vmcnt(3)
    s_bitcmp1_b64 s[14:15], 34
    s_cbranch_scc0 1
    s_waitcnt vmcnt(2)
    s_cmpk_ge_u32 s8, 1223
    s_cbranch_scc1 .ap_143
    s_waitcnt vmcnt(1)
.ap_143:
    s_add_u32 s63, s69, 16384
    buffer_load_dwordx4 v[168:171], v2, s[44:47], s63 offen nt
    s_waitcnt vmcnt(3)
    s_branch .gpc_145
.gp_144:
    buffer_load_dwordx4 v[16:19], v7, s[36:39], s58 offen offset:0 sc1
    buffer_load_dwordx4 v[20:23], v7, s[36:39], s58 offen offset:16 sc1
    s_waitcnt vmcnt(0)
.gpc_145:
    v_min_u32 v10, v17, v19
    v_max_u32 v11, v17, v19
    v_min3_u32 v10, v10, v21, v23
    v_max3_u32 v11, v11, v21, v23
    v_cmp_eq_u32 vcc, s34, v10
    v_cmp_eq_u32 s[56:57], s34, v11
    s_and_b64 vcc, vcc, s[56:57]
    s_cmp_eq_u64 vcc, exec
    s_nop 2
    s_cbranch_scc1 .gpd_146
    s_sub_u32 s35, s35, 1
    s_cbranch_scc1 .Lexit
    s_sleep 1
    s_branch .gp_144
.gpd_146:
    s_mov_b32 vcc_lo, 0xcccccccc
    s_mov_b32 vcc_hi, 0xcccccccc
    v_cndmask_b32_e64 v24, v16, 0, vcc
    v_cndmask_b32_e64 v25, v18, 0, vcc
    v_cndmask_b32_e64 v26, v20, 0, vcc
    v_cndmask_b32_e64 v27, v22, 0, vcc
    v_cndmask_b32_e32 v28, 0, v16, vcc
    v_cndmask_b32_e32 v29, 0, v18, vcc
    v_cndmask_b32_e32 v30, 0, v20, vcc
    v_cndmask_b32_e32 v31, 0, v22, vcc
    v_mfma_f32_16x16x32_bf16 v[16:19], v[32:35], v[24:27], 0
    v_mfma_f32_16x16x32_bf16 v[32:35], v[40:43], v[24:27], 0
    v_mfma_f32_16x16x32_bf16 v[16:19], v[36:39], v[28:31], v[16:19]
    v_mfma_f32_16x16x32_bf16 v[40:43], v[48:51], v[24:27], 0
    v_mfma_f32_16x16x32_bf16 v[32:35], v[44:47], v[28:31], v[32:35]
    v_mfma_f32_16x16x32_bf16 v[48:51], v[56:59], v[24:27], 0
    v_mfma_f32_16x16x32_bf16 v[40:43], v[52:55], v[28:31], v[40:43]
    v_mfma_f32_16x16x32_bf16 v[56:59], v[64:67], v[24:27], 0
    v_mfma_f32_16x16x32_bf16 v[48:51], v[60:63], v[28:31], v[48:51]
    s_nop 1
    v_add_f32_dpp v10, v17, v16 row_ror:12 row_mask:0xf bank_mask:0x1
    s_memrealtime s[8:9]
    s_waitcnt lgkmcnt(0)
    s_sub_u32 s8, s8, s30
    s_cmpk_ge_u32 s8, 1390
    s_nop 0
    s_cbranch_scc1 .ap_147
    s_waitcnt vmcnt(3)
    s_cmpk_ge_u32 s8, 1325
    s_cbranch_scc1 .ap_147
    s_waitcnt vmcnt(3)
    s_bitcmp1_b64 s[14:15], 35
    s_cbranch_scc0 1
    s_waitcnt vmcnt(2)
    s_cmpk_ge_u32 s8, 1250
    s_cbranch_scc1 .ap_147
    s_waitcnt vmcnt(1)
.ap_147:
    s_add_u32 s63, s69, 24576
    buffer_load_dwordx4 v[172:175], v2, s[44:47], s63 offen nt
    v_mfma_f32_16x16x32_bf16 v[64:67], v[72:75], v[24:27], 0
    v_mfma_f32_16x16x32_bf16 v[56:59], v[68:71], v[28:31], v[56:59]
    v_add_f32_dpp v11, v33, v32 row_ror:12 row_mask:0xf bank_mask:0x1
    v_add_f32_dpp v10, v18, v10 row_ror:8 row_mask:0xf bank_mask:0x1
    v_mfma_f32_16x16x32_bf16 v[72:75], v[80:83], v[24:27], 0
    v_mfma_f32_16x16x32_bf16 v[64:67], v[76:79], v[28:31], v[64:67]
    v_add_f32_dpp v12, v41, v40 row_ror:12 row_mask:0xf bank_mask:0x1
    v_add_f32_dpp v11, v34, v11 row_ror:8 row_mask:0xf bank_mask:0x1
    v_add_f32_dpp v10, v19, v10 row_ror:4 row_mask:0xf bank_mask:0x1
    v_mfma_f32_16x16x32_bf16 v[80:83], v[88:91], v[24:27], 0
    v_mfma_f32_16x16x32_bf16 v[72:75], v[84:87], v[28:31], v[72:75]
    v_add_f32_dpp v13, v49, v48 row_ror:12 row_mask:0xf bank_mask:0x1
    v_add_f32_dpp v12, v42, v12 row_ror:8 row_mask:0xf bank_mask:0x1
    v_add_f32_dpp v11, v35, v11 row_ror:4 row_mask:0xf bank_mask:0x1
    v_mfma_f32_16x16x32_bf16 v[88:91], v[96:99], v[24:27], 0
    v_mfma_f32_16x16x32_bf16 v[80:83], v[92:95], v[28:31], v[80:83]
    v_add_f32_dpp v10, v58, v57 row_ror:12 row_mask:0xf bank_mask:0x2
    v_add_f32_dpp v13, v50, v13 row_ror:8 row_mask:0xf bank_mask:0x1
    v_add_f32_dpp v12, v43, v12 row_ror:4 row_mask:0xf bank_mask:0x1
    s_memrealtime s[8:9]
    s_waitcnt lgkmcnt(0)
    s_sub_u32 s8, s8, s30
    s_cmpk_ge_u32 s8, 1417
    s_nop 0
    s_cbranch_scc1 .ap_148
    s_waitcnt vmcnt(4)
    s_cmpk_ge_u32 s8, 1352
    s_cbranch_scc1 .ap_148
    s_waitcnt vmcnt(3)
    s_bitcmp1_b64 s[14:15], 36
    s_cbranch_scc0 1
    s_waitcnt vmcnt(2)
    s_cmpk_ge_u32 s8, 1277
    s_cbranch_scc1 .ap_148
    s_waitcnt vmcnt(1)
.ap_148:
    s_add_u32 s63, s69, 32768
    buffer_load_dwordx4 v[176:179], v2, s[44:47], s63 offen nt
    v_mfma_f32_16x16x32_bf16 v[96:99], v[104:107], v[24:27], 0
    v_mfma_f32_16x16x32_bf16 v[88:91], v[100:103], v[28:31], v[88:91]
    v_add_f32_dpp v11, v66, v65 row_ror:12 row_mask:0xf bank_mask:0x2
    v_add_f32_dpp v10, v59, v10 row_ror:8 row_mask:0xf bank_mask:0x2
    v_add_f32_dpp v13, v51, v13 row_ror:4 row_mask:0xf bank_mask:0x1
    v_mfma_f32_16x16x32_bf16 v[104:107], v[112:115], v[24:27], 0
    v_mfma_f32_16x16x32_bf16 v[96:99], v[108:111], v[28:31], v[96:99]
    v_add_f32_dpp v12, v74, v73 row_ror:12 row_mask:0xf bank_mask:0x2
    v_add_f32_dpp v11, v67, v11 row_ror:8 row_mask:0xf bank_mask:0x2
    v_add_f32_dpp v10, v56, v10 row_ror:4 row_mask:0xf bank_mask:0x2
    v_mfma_f32_16x16x32_bf16 v[112:115], v[120:123], v[24:27], 0
    v_mfma_f32_16x16x32_bf16 v[104:107], v[116:119], v[28:31], v[104:107]
    v_add_f32_dpp v13, v82, v81 row_ror:12 row_mask:0xf bank_mask:0x2
    v_add_f32_dpp v12, v75, v12 row_ror:8 row_mask:0xf bank_mask:0x2
    v_add_f32_dpp v11, v64, v11 row_ror:4 row_mask:0xf bank_mask:0x2
    v_mfma_f32_16x16x32_bf16 v[120:123], v[128:131], v[24:27], 0
    v_mfma_f32_16x16x32_bf16 v[112:115], v[124:127], v[28:31], v[112:115]
    v_add_f32_dpp v10, v91, v90 row_ror:12 row_mask:0xf bank_mask:0x4
    v_add_f32_dpp v13, v83, v13 row_ror:8 row_mask:0xf bank_mask:0x2
    v_add_f32_dpp v12, v72, v12 row_ror:4 row_mask:0xf bank_mask:0x2
    s_memrealtime s[8:9]
    s_waitcnt lgkmcnt(0)
    s_sub_u32 s8, s8, s30
    s_cmpk_ge_u32 s8, 1444
    s_nop 0
    s_cbranch_scc1 .ap_149
    s_waitcnt vmcnt(5)
    s_cmpk_ge_u32 s8, 1379
    s_cbranch_scc1 .ap_149
    s_waitcnt vmcnt(3)
    s_bitcmp1_b64 s[14:15], 37
    s_cbranch_scc0 1
    s_waitcnt vmcnt(2)
    s_cmpk_ge_u32 s8, 1304
    s_cbranch_scc1 .ap_149
    s_waitcnt vmcnt(1)
.ap_149:
    s_add_u32 s63, s69, 40960
    buffer_load_dwordx4 v[180:183], v2, s[44:47], s63 offen nt
    v_mfma_f32_16x16x32_bf16 v[128:131], v[136:139], v[24:27], 0
    v_mfma_f32_16x16x32_bf16 v[120:123], v[132:135], v[28:31], v[120:123]
    v_add_f32_dpp v11, v99, v98 row_ror:12 row_mask:0xf bank_mask:0x4
    v_add_f32_dpp v10, v88, v10 row_ror:8 row_mask:0xf bank_mask:0x4
    v_add_f32_dpp v13, v80, v13 row_ror:4 row_mask:0xf bank_mask:0x2
    v_mfma_f32_16x16x32_bf16 v[136:139], v[144:147], v[24:27], 0
    v_mfma_f32_16x16x32_bf16 v[128:131], v[140:143], v[28:31], v[128:131]
    v_add_f32_dpp v12, v107, v106 row_ror:12 row_mask:0xf bank_mask:0x4
    v_add_f32_dpp v11, v96, v11 row_ror:8 row_mask:0xf bank_mask:0x4
    v_add_f32_dpp v10, v89, v10 row_ror:4 row_mask:0xf bank_mask:0x4
    v_mfma_f32_16x16x32_bf16 v[144:147], v[152:155], v[24:27], 0
    v_mfma_f32_16x16x32_bf16 v[136:139], v[148:151], v[28:31], v[136:139]
    v_add_f32_dpp v13, v115, v114 row_ror:12 row_mask:0xf bank_mask:0x4
    v_add_f32_dpp v12, v104, v12 row_ror:8 row_mask:0xf bank_mask:0x4
    v_add_f32_dpp v11, v97, v11 row_ror:4 row_mask:0xf bank_mask:0x4
    v_mfma_f32_16x16x32_bf16 v[144:147], v[156:159], v[28:31], v[144:147]
    v_add_f32_dpp v10, v120, v123 row_ror:12 row_mask:0xf bank_mask:0x8
    v_add_f32_dpp v13, v112, v13 row_ror:8 row_mask:0xf bank_mask:0x4
    v_add_f32_dpp v12, v105, v12 row_ror:4 row_mask:0xf bank_mask:0x4
    s_memrealtime s[8:9]
    s_waitcnt lgkmcnt(0)
    s_sub_u32 s8, s8, s30
    s_cmpk_ge_u32 s8, 1471
    s_nop 0
    s_cbranch_scc1 .ap_150
    s_waitcnt vmcnt(5)
    s_cmpk_ge_u32 s8, 1406
    s_cbranch_scc1 .ap_150
    s_waitcnt vmcnt(3)
    s_bitcmp1_b64 s[14:15], 38
    s_cbranch_scc0 1
    s_waitcnt vmcnt(2)
    s_cmpk_ge_u32 s8, 1331
    s_cbranch_scc1 .ap_150
    s_waitcnt vmcnt(1)
.ap_150:
    s_add_u32 s63, s69, 49152
    buffer_load_dwordx4 v[184:187], v2, s[44:47], s63 offen nt
    v_add_f32_dpp v11, v128, v131 row_ror:12 row_mask:0xf bank_mask:0x8
    v_add_f32_dpp v10, v121, v10 row_ror:8 row_mask:0xf bank_mask:0x8
    v_add_f32_dpp v13, v113, v13 row_ror:4 row_mask:0xf bank_mask:0x4
    v_add_f32_dpp v12, v136, v139 row_ror:12 row_mask:0xf bank_mask:0x8
    v_add_f32_dpp v11, v129, v11 row_ror:8 row_mask:0xf bank_mask:0x8
    v_add_f32_dpp v10, v122, v10 row_ror:4 row_mask:0xf bank_mask:0x8
    v_add_f32_dpp v13, v144, v147 row_ror:12 row_mask:0xf bank_mask:0x8
    v_add_f32_dpp v12, v137, v12 row_ror:8 row_mask:0xf bank_mask:0x8
    v_add_f32_dpp v11, v130, v11 row_ror:4 row_mask:0xf bank_mask:0x8
    v_add_f32_dpp v13, v145, v13 row_ror:8 row_mask:0xf bank_mask:0x8
    v_add_f32_dpp v12, v138, v12 row_ror:4 row_mask:0xf bank_mask:0x8
    s_memrealtime s[8:9]
    s_waitcnt lgkmcnt(0)
    s_sub_u32 s8, s8, s30
    s_cmpk_ge_u32 s8, 1498
    s_cbranch_scc1 .ap_151
    s_waitcnt vmcnt(5)
    s_cmpk_ge_u32 s8, 1433
    s_cbranch_scc1 .ap_151
    s_waitcnt vmcnt(3)
    s_bitcmp1_b64 s[14:15], 39
    s_cbranch_scc0 1
    s_waitcnt vmcnt(2)
    s_cmpk_ge_u32 s8, 1358
    s_cbranch_scc1 .ap_151
    s_waitcnt vmcnt(1)
.ap_151:
    s_add_u32 s63, s69, 57344
    buffer_load_dwordx4 v[188:191], v2, s[44:47], s63 offen nt
    v_add_f32_dpp v13, v146, v13 row_ror:4 row_mask:0xf bank_mask:0x8
    s_mov_b32 s60, 0x3db504f3
    s_mov_b32 s61, 0x3db504f3
    v_cvt_pk_bf16_f32 v10, 0, v10
    v_cvt_pk_bf16_f32 v11, 0, v11
    v_cvt_pk_bf16_f32 v12, 0, v12
    v_cvt_pk_bf16_f32 v13, 0, v13
    v_pk_mul_f32 v[10:11], v[10:11], s[60:61]
    v_pk_mul_f32 v[12:13], v[12:13], s[60:61]
    v_cvt_pk_bf16_f32 v10, 0, v10
    v_cvt_pk_bf16_f32 v11, 0, v11
    v_cvt_pk_bf16_f32 v12, 0, v12
    v_cvt_pk_bf16_f32 v13, 0, v13
    v_max_f32 v14, v10, v11
    v_max3_f32 v14, v14, v12, v13
    s_mov_b32 s60, 0x3fb8aa3b
    v_mov_b32 v22, s34
    v_mov_b32 v23, s34
    v_max_f32_dpp v14, v14, v14 quad_perm:[2,3,0,1] row_mask:0xf bank_mask:0xf
    s_nop 1
    v_max_f32_dpp v14, v14, v14 row_ror:4 row_mask:0xf bank_mask:0xf
    s_nop 1
    v_max_f32_dpp v14, v14, v14 row_ror:8 row_mask:0xf bank_mask:0xf
    v_mov_b32 v15, v14
    s_nop 1
    v_permlane16_swap_b32 v15, v14
    v_max_f32 v14, v15, v14
    v_mov_b32 v15, v14
    s_nop 1
    v_permlane32_swap_b32 v15, v14
    v_max_f32 v14, v15, v14
    v_mul_f32 v15, 0xbfb8aa3b, v14
    v_fma_f32 v10, v10, s60, v15
    v_fma_f32 v11, v11, s60, v15
    v_fma_f32 v12, v12, s60, v15
    v_fma_f32 v13, v13, s60, v15
    v_exp_f32 v10, v10
    v_exp_f32 v11, v11
    v_exp_f32 v12, v12
    v_exp_f32 v13, v13
    v_mov_b32 v20, v14
    v_pk_add_f32 v[16:17], v[10:11], v[12:13]
    v_add_f32 v21, v16, v17
    s_lshl3_add_u32 s60, s68, s3
    s_lshl_b32 s60, s60, 5
    s_add_u32 s60, s60, s59
    v_add_f32_dpp v21, v21, v21 quad_perm:[2,3,0,1] row_mask:0xf bank_mask:0xf
    s_nop 1
    v_add_f32_dpp v21, v21, v21 row_ror:4 row_mask:0xf bank_mask:0xf
    s_nop 1
    v_add_f32_dpp v21, v21, v21 row_ror:8 row_mask:0xf bank_mask:0xf
    v_mov_b32 v15, v21
    s_nop 1
    v_permlane16_swap_b32 v15, v21
    v_add_f32 v21, v15, v21
    v_mov_b32 v15, v21
    s_nop 1
    v_permlane32_swap_b32 v15, v21
    v_add_f32 v21, v15, v21
    s_lshl_b32 s60, s3, 4
    s_add_u32 s60, s60, 159104
    v_add_u32 v16, s60, v3
    v_mov_b32 v17, 159232
    v_mov_b32 v18, 1
    s_mov_b64 exec, 3
    ds_write_b64 v16, v[20:21]
    s_mov_b64 exec, 1
    s_waitcnt lgkmcnt(0)
    ds_add_rtn_u32 v18, v17, v18
    s_mov_b64 exec, -1
    v_and_b32 v16, 0x78, v3
    v_add_u32 v16, 159104, v16
    s_waitcnt lgkmcnt(0)
    v_readfirstlane_b32 s60, v18
    s_cmp_lg_u32 s60, 7
    s_nop 3
    s_cbranch_scc1 .ml_152
    ds_read_b64 v[18:19], v16
    s_lshl_b32 s60, s68, 7
    s_add_u32 s60, s60, s59
    s_waitcnt lgkmcnt(0)
    v_mov_b32 v20, v18
    s_nop 1
    v_max_f32_dpp v20, v20, v20 quad_perm:[2,3,0,1] row_mask:0xf bank_mask:0xf
    s_nop 1
    v_max_f32_dpp v20, v20, v20 row_ror:4 row_mask:0xf bank_mask:0xf
    s_nop 1
    v_max_f32_dpp v20, v20, v20 row_ror:8 row_mask:0xf bank_mask:0xf
    v_sub_f32 v18, v18, v20
    v_mul_f32 v18, 0x3fb8aa3b, v18
    v_exp_f32 v18, v18
    s_nop 0
    v_mul_f32 v21, v18, v19
    s_nop 1
    v_add_f32_dpp v21, v21, v21 quad_perm:[2,3,0,1] row_mask:0xf bank_mask:0xf
    s_nop 1
    v_add_f32_dpp v21, v21, v21 row_ror:4 row_mask:0xf bank_mask:0xf
    s_nop 1
    v_add_f32_dpp v21, v21, v21 row_ror:8 row_mask:0xf bank_mask:0xf
    s_mov_b64 exec, 0xff
    buffer_store_dwordx4 v[20:23], v2, s[36:39], s60 offen sc1
    s_mov_b64 exec, -1
.ml_152:
    s_memrealtime s[8:9]
    s_waitcnt lgkmcnt(0)
    s_sub_u32 s8, s8, s30
    s_cmpk_ge_u32 s8, 1525
    s_cbranch_scc1 .ap_153
    s_waitcnt vmcnt(5)
    s_cmpk_ge_u32 s8, 1460
    s_cbranch_scc1 .ap_153
    s_waitcnt vmcnt(3)
    s_bitcmp1_b64 s[14:15], 40
    s_cbranch_scc0 1
    s_waitcnt vmcnt(2)
    s_cmpk_ge_u32 s8, 1385
    s_cbranch_scc1 .ap_153
    s_waitcnt vmcnt(1)
.ap_153:
    s_add_u32 s63, s69, 131072
    buffer_load_dwordx4 v[192:195], v2, s[44:47], s63 offen nt
    s_sub_u32 s57, s65, 9
    s_bitcmp1_b32 s57, 0
    s_cselect_b32 s48, s20, s18
    s_cselect_b32 s49, s21, s19
    s_cselect_b32 s33, 36, 0
    s_and_b32 s49, s49, 0xffff
    s_mov_b32 s50, 0x510000
    s_mov_b32 s51, 0x00020000
    s_mov_b32 s52, s22
    s_and_b32 s53, s23, 0xffff
    s_mov_b32 s54, 0x510000
    s_mov_b32 s55, 0x00020000
    s_lshr_b32 s57, s57, 1
    s_lshl_b32 s57, s57, 7
    s_mul_i32 s101, s64, 1152
    s_add_u32 s101, s101, s57
    s_mul_i32 s56, s3, 73728
    s_add_u32 s101, s101, s56
    s_mul_i32 s56, s64, 72
    s_add_u32 s33, s33, s56
    s_add_u32 s33, s33, s3
    s_mul_i32 s33, s33, 9216
    s_add_u32 s33, s33, s57
    s_bfe_u32 s56, s101, 0x30007
    s_cmp_eq_u32 s56, 3
    s_cselect_b32 s43, 1, 0
    v_bfe_u32 v16, v0, 4, 1
    s_and_b32 s56, s3, 3
    s_lshl_b32 s56, s56, 1
    v_or_b32 v16, s56, v16
    v_and_b32 v6, 7, v0
    v_xor_b32 v16, v16, v6
    v_lshrrev_b32 v6, 3, v0
    v_mul_u32_u24 v6, 9216, v6
    v_lshl_add_u32 v6, v16, 4, v6
    v_bfe_u32 v16, v0, 4, 1
    s_and_b32 s56, s3, 1
    s_lshl_b32 s56, s56, 2
    v_lshl_or_b32 v16, v16, 1, s56
    v_and_b32 v17, 7, v0
    v_xor_b32 v16, v16, v17
    v_lshrrev_b32 v17, 3, v0
    v_mul_u32_u24 v17, 1152, v17
    v_lshl_add_u32 v31, v16, 4, v17
    s_memrealtime s[8:9]
    s_waitcnt vmcnt(8)
    s_waitcnt lgkmcnt(0)
    s_sub_u32 s8, s8, s30
    s_cmpk_ge_u32 s8, 1552
    s_cbranch_scc1 .ap_154
    s_waitcnt vmcnt(5)
    s_cmpk_ge_u32 s8, 1487
    s_cbranch_scc1 .ap_154
    s_waitcnt vmcnt(3)
    s_bitcmp1_b64 s[14:15], 41
    s_cbranch_scc0 1
    s_waitcnt vmcnt(2)
    s_cmpk_ge_u32 s8, 1412
    s_cbranch_scc1 .ap_154
    s_waitcnt vmcnt(1)
.ap_154:
    s_add_u32 s63, s69, 139264
    buffer_load_dwordx4 v[196:199], v2, s[44:47], s63 offen nt
    s_memrealtime s[8:9]
    s_waitcnt vmcnt(8)
    s_waitcnt lgkmcnt(0)
    s_sub_u32 s8, s8, s30
    s_cmpk_ge_u32 s8, 1579
    s_cbranch_scc1 .ap_155
    s_waitcnt vmcnt(5)
    s_cmpk_ge_u32 s8, 1514
    s_cbranch_scc1 .ap_155
    s_waitcnt vmcnt(3)
    s_bitcmp1_b64 s[14:15], 42
    s_cbranch_scc0 1
    s_waitcnt vmcnt(2)
    s_cmpk_ge_u32 s8, 1439
    s_cbranch_scc1 .ap_155
    s_waitcnt vmcnt(1)
.ap_155:
    s_add_u32 s63, s69, 147456
    buffer_load_dwordx4 v[200:203], v2, s[44:47], s63 offen nt
    s_memrealtime s[8:9]
    s_waitcnt vmcnt(8)
    s_waitcnt lgkmcnt(0)
    s_sub_u32 s8, s8, s30
    s_cmpk_ge_u32 s8, 1606
    s_cbranch_scc1 .ap_156
    s_waitcnt vmcnt(5)
    s_cmpk_ge_u32 s8, 1541
    s_cbranch_scc1 .ap_156
    s_waitcnt vmcnt(3)
    s_bitcmp1_b64 s[14:15], 43
    s_cbranch_scc0 1
    s_waitcnt vmcnt(2)
    s_cmpk_ge_u32 s8, 1466
    s_cbranch_scc1 .ap_156
    s_waitcnt vmcnt(1)
.ap_156:
    s_add_u32 s63, s69, 155648
    buffer_load_dwordx4 v[204:207], v2, s[44:47], s63 offen nt
    s_memrealtime s[8:9]
    s_waitcnt vmcnt(8)
    s_waitcnt lgkmcnt(0)
    s_sub_u32 s8, s8, s30
    s_cmpk_ge_u32 s8, 1633
    s_cbranch_scc1 .ap_157
    s_waitcnt vmcnt(5)
    s_cmpk_ge_u32 s8, 1568
    s_cbranch_scc1 .ap_157
    s_waitcnt vmcnt(3)
    s_bitcmp1_b64 s[14:15], 44
    s_cbranch_scc0 1
    s_waitcnt vmcnt(2)
    s_cmpk_ge_u32 s8, 1493
    s_cbranch_scc1 .ap_157
    s_waitcnt vmcnt(1)
.ap_157:
    s_add_u32 s63, s69, 163840
    buffer_load_dwordx4 v[208:211], v2, s[44:47], s63 offen nt
    s_memrealtime s[8:9]
    s_waitcnt vmcnt(8)
    s_waitcnt lgkmcnt(0)
    s_sub_u32 s8, s8, s30
    s_cmpk_ge_u32 s8, 1660
    s_cbranch_scc1 .ap_158
    s_waitcnt vmcnt(5)
    s_cmpk_ge_u32 s8, 1595
    s_cbranch_scc1 .ap_158
    s_waitcnt vmcnt(3)
    s_bitcmp1_b64 s[14:15], 45
    s_cbranch_scc0 1
    s_waitcnt vmcnt(2)
    s_cmpk_ge_u32 s8, 1520
    s_cbranch_scc1 .ap_158
    s_waitcnt vmcnt(1)
.ap_158:
    s_add_u32 s63, s69, 172032
    buffer_load_dwordx4 v[212:215], v2, s[44:47], s63 offen nt
    s_memrealtime s[8:9]
    s_waitcnt vmcnt(8)
    s_waitcnt lgkmcnt(0)
    s_sub_u32 s8, s8, s30
    s_cmpk_ge_u32 s8, 1691
    s_cbranch_scc1 .ap_159
    s_waitcnt vmcnt(5)
    s_cmpk_ge_u32 s8, 1626
    s_cbranch_scc1 .ap_159
    s_waitcnt vmcnt(3)
    s_bitcmp1_b64 s[14:15], 46
    s_cbranch_scc0 1
    s_waitcnt vmcnt(2)
    s_cmpk_ge_u32 s8, 1551
    s_cbranch_scc1 .ap_159
    s_waitcnt vmcnt(1)
.ap_159:
    s_add_u32 s63, s69, 180224
    buffer_load_dwordx4 v[216:219], v2, s[44:47], s63 offen nt
    s_memrealtime s[8:9]
    s_waitcnt vmcnt(8)
    s_waitcnt lgkmcnt(0)
    s_sub_u32 s8, s8, s30
    s_cmpk_ge_u32 s8, 1722
    s_cbranch_scc1 .ap_160
    s_waitcnt vmcnt(5)
    s_cmpk_ge_u32 s8, 1657
    s_cbranch_scc1 .ap_160
    s_waitcnt vmcnt(3)
    s_bitcmp1_b64 s[14:15], 47
    s_cbranch_scc0 1
    s_waitcnt vmcnt(2)
    s_cmpk_ge_u32 s8, 1582
    s_cbranch_scc1 .ap_160
    s_waitcnt vmcnt(1)
.ap_160:
    s_add_u32 s63, s69, 188416
    buffer_load_dwordx4 v[220:223], v2, s[44:47], s63 offen nt
    s_mul_i32 s99, s3, 2304
    s_add_u32 s99, s99, 0x1e000
    buffer_load_dwordx4 v[32:35], v2, s[36:39], s99 offen offset:0 sc1
    buffer_load_dwordx4 v[40:43], v2, s[36:39], s99 offen offset:1024 sc1
    buffer_load_dwordx2 v[48:49], v5, s[36:39], s99 offen offset:0 sc1
    s_memrealtime s[8:9]
    s_waitcnt vmcnt(11)
    s_waitcnt lgkmcnt(0)
    s_sub_u32 s8, s8, s30
    s_cmpk_ge_u32 s8, 1753
    s_cbranch_scc1 .ap_161
    s_waitcnt vmcnt(8)
    s_cmpk_ge_u32 s8, 1688
    s_cbranch_scc1 .ap_161
    s_waitcnt vmcnt(6)
    s_bitcmp1_b64 s[14:15], 48
    s_cbranch_scc0 1
    s_waitcnt vmcnt(5)
    s_cmpk_ge_u32 s8, 1613
    s_cbranch_scc1 .ap_161
    s_waitcnt vmcnt(4)
.ap_161:
    s_add_u32 s63, s69, 262144
    buffer_load_dwordx4 v[224:227], v2, s[44:47], s63 offen nt
    s_memrealtime s[8:9]
    s_waitcnt vmcnt(11)
    s_waitcnt lgkmcnt(0)
    s_sub_u32 s8, s8, s30
    s_cmpk_ge_u32 s8, 1784
    s_cbranch_scc1 .ap_162
    s_waitcnt vmcnt(8)
    s_cmpk_ge_u32 s8, 1719
    s_cbranch_scc1 .ap_162
    s_waitcnt vmcnt(6)
    s_bitcmp1_b64 s[14:15], 49
    s_cbranch_scc0 1
    s_waitcnt vmcnt(5)
    s_cmpk_ge_u32 s8, 1644
    s_cbranch_scc1 .ap_162
    s_waitcnt vmcnt(4)
.ap_162:
    s_add_u32 s63, s69, 270336
    buffer_load_dwordx4 v[228:231], v2, s[44:47], s63 offen nt
    s_mul_i32 s100, s3, 2304
    s_add_u32 s100, s100, 0x27000
    buffer_load_dwordx4 v[56:59], v2, s[36:39], s100 offen offset:0 sc1
    buffer_load_dwordx4 v[64:67], v2, s[36:39], s100 offen offset:1024 sc1
    buffer_load_dwordx2 v[50:51], v5, s[36:39], s100 offen offset:0 sc1
    s_memrealtime s[8:9]
    s_waitcnt vmcnt(14)
    s_waitcnt lgkmcnt(0)
    s_sub_u32 s8, s8, s30
    s_cmpk_ge_u32 s8, 1815
    s_cbranch_scc1 .ap_163
    s_waitcnt vmcnt(11)
    s_cmpk_ge_u32 s8, 1750
    s_cbranch_scc1 .ap_163
    s_waitcnt vmcnt(9)
    s_bitcmp1_b64 s[14:15], 50
    s_cbranch_scc0 1
    s_waitcnt vmcnt(8)
    s_cmpk_ge_u32 s8, 1675
    s_cbranch_scc1 .ap_163
    s_waitcnt vmcnt(4)
.ap_163:
    s_add_u32 s63, s69, 278528
    buffer_load_dwordx4 v[232:235], v2, s[44:47], s63 offen nt
    s_memrealtime s[8:9]
    s_waitcnt vmcnt(14)
    s_waitcnt lgkmcnt(0)
    s_sub_u32 s8, s8, s30
    s_cmpk_ge_u32 s8, 1846
    s_cbranch_scc1 .ap_164
    s_waitcnt vmcnt(11)
    s_cmpk_ge_u32 s8, 1781
    s_cbranch_scc1 .ap_164
    s_waitcnt vmcnt(9)
    s_bitcmp1_b64 s[14:15], 51
    s_cbranch_scc0 1
    s_waitcnt vmcnt(5)
    s_cmpk_ge_u32 s8, 1706
    s_cbranch_scc1 .ap_164
    s_waitcnt vmcnt(4)
.ap_164:
    s_add_u32 s63, s69, 286720
    buffer_load_dwordx4 v[236:239], v2, s[44:47], s63 offen nt
    s_memrealtime s[8:9]
    s_waitcnt vmcnt(14)
    s_waitcnt lgkmcnt(0)
    s_sub_u32 s8, s8, s30
    s_cmpk_ge_u32 s8, 1877
    s_cbranch_scc1 .ap_165
    s_waitcnt vmcnt(11)
    s_cmpk_ge_u32 s8, 1812
    s_cbranch_scc1 .ap_165
    s_waitcnt vmcnt(6)
    s_bitcmp1_b64 s[14:15], 52
    s_cbranch_scc0 1
    s_waitcnt vmcnt(5)
    s_cmpk_ge_u32 s8, 1737
    s_cbranch_scc1 .ap_165
    s_waitcnt vmcnt(1)
.ap_165:
    s_add_u32 s63, s69, 294912
    buffer_load_dwordx4 v[240:243], v2, s[44:47], s63 offen nt
    s_memrealtime s[8:9]
    s_waitcnt vmcnt(14)
    s_waitcnt lgkmcnt(0)
    s_sub_u32 s8, s8, s30
    s_cmpk_ge_u32 s8, 1908
    s_cbranch_scc1 .ap_166
    s_waitcnt vmcnt(11)
    s_cmpk_ge_u32 s8, 1843
    s_cbranch_scc1 .ap_166
    s_waitcnt vmcnt(6)
    s_bitcmp1_b64 s[14:15], 53
    s_cbranch_scc0 1
    s_waitcnt vmcnt(2)
    s_cmpk_ge_u32 s8, 1768
    s_cbranch_scc1 .ap_166
    s_waitcnt vmcnt(1)
.ap_166:
    s_add_u32 s63, s69, 303104
    buffer_load_dwordx4 v[244:247], v2, s[44:47], s63 offen nt
    s_load_dwordx2 s[88:89], s[6:7], s0
    buffer_load_dwordx4 v[24:27], v9, s[36:39], s59 offen offset:0 sc1
    s_memrealtime s[8:9]
    s_waitcnt vmcnt(14)
    s_waitcnt lgkmcnt(0)
    s_sub_u32 s8, s8, s30
    s_cmpk_ge_u32 s8, 1939
    s_cbranch_scc1 .ap_167
    s_waitcnt vmcnt(8)
    s_cmpk_ge_u32 s8, 1874
    s_cbranch_scc1 .ap_167
    s_waitcnt vmcnt(3)
    s_bitcmp1_b64 s[14:15], 54
    s_cbranch_scc0 1
    s_waitcnt vmcnt(2)
    s_cmpk_ge_u32 s8, 1799
    s_cbranch_scc1 .ap_167
    s_waitcnt vmcnt(1)
.ap_167:
    s_add_u32 s63, s69, 311296
    buffer_load_dwordx4 v[248:251], v2, s[44:47], s63 offen nt
    s_memrealtime s[8:9]
    s_waitcnt vmcnt(14)
    s_waitcnt lgkmcnt(0)
    s_sub_u32 s8, s8, s30
    s_cmpk_ge_u32 s8, 1970
    s_cbranch_scc1 .ap_168
    s_waitcnt vmcnt(5)
    s_cmpk_ge_u32 s8, 1905
    s_cbranch_scc1 .ap_168
    s_waitcnt vmcnt(3)
    s_bitcmp1_b64 s[14:15], 55
    s_cbranch_scc0 1
    s_waitcnt vmcnt(2)
    s_cmpk_ge_u32 s8, 1830
    s_cbranch_scc1 .ap_168
    s_waitcnt vmcnt(1)
.ap_168:
    s_add_u32 s63, s69, 319488
    buffer_load_dwordx4 v[252:255], v2, s[44:47], s63 offen nt
    s_memrealtime s[8:9]
    s_waitcnt vmcnt(11)
    s_waitcnt lgkmcnt(0)
    s_sub_u32 s8, s8, s30
    s_cmpk_ge_u32 s8, 2001
    s_cbranch_scc1 .ap_169
    s_waitcnt vmcnt(5)
    s_cmpk_ge_u32 s8, 1936
    s_cbranch_scc1 .ap_169
    s_waitcnt vmcnt(3)
    s_bitcmp1_b64 s[14:15], 56
    s_cbranch_scc0 1
    s_waitcnt vmcnt(2)
    s_cmpk_ge_u32 s8, 1861
    s_cbranch_scc1 .ap_169
    s_waitcnt vmcnt(1)
.ap_169:
    s_add_u32 s63, s69, 393216
    buffer_load_dwordx4 v[36:39], v2, s[44:47], s63 offen nt
    s_memrealtime s[8:9]
    s_waitcnt vmcnt(11)
    s_waitcnt lgkmcnt(0)
    s_sub_u32 s8, s8, s30
    s_cmpk_ge_u32 s8, 2032
    s_cbranch_scc1 .ap_170
    s_waitcnt vmcnt(5)
    s_cmpk_ge_u32 s8, 1967
    s_cbranch_scc1 .ap_170
    s_waitcnt vmcnt(3)
    s_bitcmp1_b64 s[14:15], 57
    s_cbranch_scc0 1
    s_waitcnt vmcnt(2)
    s_cmpk_ge_u32 s8, 1892
    s_cbranch_scc1 .ap_170
    s_waitcnt vmcnt(1)
.ap_170:
    s_add_u32 s63, s69, 401408
    buffer_load_dwordx4 v[44:47], v2, s[44:47], s63 offen nt
    s_memrealtime s[8:9]
    s_waitcnt vmcnt(8)
    s_waitcnt lgkmcnt(0)
    s_sub_u32 s8, s8, s30
    s_cmpk_ge_u32 s8, 2063
    s_cbranch_scc1 .ap_171
    s_waitcnt vmcnt(5)
    s_cmpk_ge_u32 s8, 1998
    s_cbranch_scc1 .ap_171
    s_waitcnt vmcnt(3)
    s_bitcmp1_b64 s[14:15], 58
    s_cbranch_scc0 1
    s_waitcnt vmcnt(2)
    s_cmpk_ge_u32 s8, 1923
    s_cbranch_scc1 .ap_171
    s_waitcnt vmcnt(1)
.ap_171:
    s_add_u32 s63, s69, 409600
    buffer_load_dwordx4 v[52:55], v2, s[44:47], s63 offen nt
    s_waitcnt vmcnt(5)
    s_branch .gpc_173
.gp_172:
    buffer_load_dwordx4 v[24:27], v9, s[36:39], s59 offen offset:0 sc1
    s_waitcnt vmcnt(0)
.gpc_173:
    v_cmp_eq_u32 vcc, s34, v26
    v_cmp_eq_u32 s[56:57], s34, v27
    s_and_b64 vcc, vcc, s[56:57]
    s_cmp_eq_u64 vcc, exec
    s_nop 2
    s_cbranch_scc1 .gpd_174
    s_sub_u32 s35, s35, 1
    s_cbranch_scc1 .Lexit
    s_sleep 1
    s_branch .gp_172
.gpd_174:
    s_lshr_b64 s[88:89], s[88:89], s1
    s_and_b32 s88, s88, 0xff
    s_cmp_eq_u32 s88, 32
    s_cselect_b32 s0, 0xac000, 0
    v_mov_b32 v16, v24
    s_nop 1
    v_max_f32_dpp v16, v16, v16 quad_perm:[2,3,0,1] row_mask:0xf bank_mask:0xf
    v_sub_f32 v17, v24, v16
    v_sub_f32 v18, v14, v16
    v_mul_f32 v17, 0x3fb8aa3b, v17
    v_mul_f32 v18, 0x3fb8aa3b, v18
    v_exp_f32 v17, v17
    v_exp_f32 v18, v18
    v_mul_f32 v17, v17, v25
    s_nop 1
    v_add_f32_dpp v17, v17, v17 quad_perm:[2,3,0,1] row_mask:0xf bank_mask:0xf
    v_rcp_f32 v19, v17
    s_nop 0
    v_fma_f32 v15, -v17, v19, 1.0
    v_fma_f32 v19, v15, v19, v19
    v_mul_f32 v18, v18, v19
    v_mul_f32 v10, v10, v18
    v_mul_f32 v11, v11, v18
    v_mul_f32 v12, v12, v18
    v_mul_f32 v13, v13, v18
    v_mov_b32_dpp v112, v10 quad_perm:[2,3,0,1] row_mask:0xf bank_mask:0xf
    v_mov_b32_dpp v113, v11 quad_perm:[2,3,0,1] row_mask:0xf bank_mask:0xf
    v_mov_b32_dpp v114, v12 quad_perm:[2,3,0,1] row_mask:0xf bank_mask:0xf
    v_mov_b32_dpp v115, v13 quad_perm:[2,3,0,1] row_mask:0xf bank_mask:0xf
    v_cvt_pk_bf16_f32 v96, v10, v112
    v_cvt_pk_bf16_f32 v100, v11, v113
    v_cvt_pk_bf16_f32 v104, v12, v114
    v_cvt_pk_bf16_f32 v108, v13, v115
    v_mov_b32_dpp v97, v96 row_ror:12 row_mask:0xf bank_mask:0xf
    v_mov_b32_dpp v101, v100 row_ror:12 row_mask:0xf bank_mask:0xf
    v_mov_b32_dpp v105, v104 row_ror:12 row_mask:0xf bank_mask:0xf
    v_mov_b32_dpp v109, v108 row_ror:12 row_mask:0xf bank_mask:0xf
    v_mov_b32_dpp v98, v96 row_ror:8 row_mask:0xf bank_mask:0xf
    v_mov_b32_dpp v102, v100 row_ror:8 row_mask:0xf bank_mask:0xf
    v_mov_b32_dpp v106, v104 row_ror:8 row_mask:0xf bank_mask:0xf
    v_mov_b32_dpp v110, v108 row_ror:8 row_mask:0xf bank_mask:0xf
    v_mov_b32_dpp v99, v96 row_ror:4 row_mask:0xf bank_mask:0xf
    v_mov_b32_dpp v103, v100 row_ror:4 row_mask:0xf bank_mask:0xf
    v_mov_b32_dpp v107, v104 row_ror:4 row_mask:0xf bank_mask:0xf
    v_mov_b32_dpp v111, v108 row_ror:4 row_mask:0xf bank_mask:0xf
    v_mov_b32_dpp v96, v96 row_shr:3 row_mask:0xf bank_mask:0x2
    v_mov_b32_dpp v97, v97 row_shr:3 row_mask:0xf bank_mask:0x2
    v_mov_b32_dpp v98, v98 row_shr:3 row_mask:0xf bank_mask:0x2
    v_mov_b32_dpp v99, v99 row_shr:3 row_mask:0xf bank_mask:0x2
    v_mov_b32_dpp v100, v100 row_shr:3 row_mask:0xf bank_mask:0x2
    v_mov_b32_dpp v101, v101 row_shr:3 row_mask:0xf bank_mask:0x2
    v_mov_b32_dpp v102, v102 row_shr:3 row_mask:0xf bank_mask:0x2
    v_mov_b32_dpp v103, v103 row_shr:3 row_mask:0xf bank_mask:0x2
    v_mov_b32_dpp v104, v104 row_shr:3 row_mask:0xf bank_mask:0x2
    v_mov_b32_dpp v105, v105 row_shr:3 row_mask:0xf bank_mask:0x2
    v_mov_b32_dpp v106, v106 row_shr:3 row_mask:0xf bank_mask:0x2
    v_mov_b32_dpp v107, v107 row_shr:3 row_mask:0xf bank_mask:0x2
    v_mov_b32_dpp v108, v108 row_shr:3 row_mask:0xf bank_mask:0x2
    v_mov_b32_dpp v109, v109 row_shr:3 row_mask:0xf bank_mask:0x2
    v_mov_b32_dpp v110, v110 row_shr:3 row_mask:0xf bank_mask:0x2
    v_mov_b32_dpp v111, v111 row_shr:3 row_mask:0xf bank_mask:0x2
    s_memrealtime s[8:9]
    s_waitcnt lgkmcnt(0)
    s_sub_u32 s8, s8, s30
    s_cmpk_ge_u32 s8, 2094
    s_cbranch_scc1 .ap_175
    s_waitcnt vmcnt(5)
    s_cmpk_ge_u32 s8, 2029
    s_cbranch_scc1 .ap_175
    s_waitcnt vmcnt(3)
    s_bitcmp1_b64 s[14:15], 59
    s_cbranch_scc0 1
    s_waitcnt vmcnt(2)
    s_cmpk_ge_u32 s8, 1954
    s_cbranch_scc1 .ap_175
    s_waitcnt vmcnt(1)
.ap_175:
    s_add_u32 s63, s69, 417792
    buffer_load_dwordx4 v[60:63], v2, s[44:47], s63 offen nt
    s_lshl_b32 s60, s3, 10
    s_add_u32 s60, s60, 132096
    v_lshlrev_b32 v10, 5, v0
    v_add_u32 v10, s60, v10
    v_lshrrev_b32 v11, 5, v0
    v_lshlrev_b32 v11, 13, v11
    v_and_b32 v12, 31, v0
    v_lshl_add_u32 v11, v12, 4, v11
    v_add_u32 v9, 132096, v2
    v_mov_b32 v15, s34
    v_mov_b32 v13, 110592
    s_mov_b32 s1, s43
    v_bfe_u32 v16, v0, 1, 3
    v_mul_u32_u24 v16, 1312, v16
    v_lshrrev_b32 v7, 4, v0
    v_lshl_add_u32 v16, v7, 5, v16
    v_and_b32 v7, 1, v0
    v_lshl_add_u32 v16, v7, 4, v16
    v_add_u32 v16, 147456, v16
    s_mul_i32 s56, s3, 1312
    s_add_u32 s56, s56, 147456
    v_add_u32 v17, s56, v3
    v_add_u32 v18, s56, v4
    v_lshrrev_b32 v7, 4, v0
    v_bfe_u32 v8, v0, 1, 1
    v_lshl_add_u32 v7, v7, 1, v8
    v_bfe_u32 v8, v0, 2, 2
    v_lshl_add_u32 v19, v7, 3, v8
    v_lshlrev_b32 v19, 7, v19
    v_and_b32 v7, 3, v7
    v_lshrrev_b32 v8, 1, v8
    v_lshl_add_u32 v7, v7, 1, v8
    v_xor_b32 v7, s3, v7
    v_lshl_add_u32 v19, v7, 4, v19
    v_and_b32 v7, 1, v0
    v_lshl_add_u32 v19, v7, 3, v19
    v_add_u32 v20, 32768, v19
    v_lshrrev_b32 v7, 4, v0
    v_bfe_u32 v8, v0, 2, 2
    v_lshl_add_u32 v21, v7, 3, v8
    v_lshlrev_b32 v21, 7, v21
    v_and_b32 v7, 1, v7
    v_lshrrev_b32 v8, 1, v8
    v_lshl_add_u32 v7, v7, 1, v8
    s_and_b32 s56, s3, 1
    s_lshl_b32 s56, s56, 1
    v_xor_b32 v7, s56, v7
    v_and_b32 v8, 3, v0
    v_lshl_add_u32 v21, v8, 3, v21
    s_lshr_b32 s56, s3, 1
    s_mul_i32 s56, s56, 12288
    s_add_u32 s56, s56, 73728
    v_add_u32 v21, s56, v21
    v_xor_b32 v8, 1, v7
    v_lshl_add_u32 v22, v8, 5, v21
    v_lshl_add_u32 v21, v7, 5, v21
    v_bfe_u32 v7, v0, 1, 3
    v_mul_u32_u24 v23, 1312, v7
    v_mul_u32_u24 v24, 272, v7
    v_and_b32 v7, 48, v0
    s_lshr_b32 s56, s3, 1
    s_mul_i32 s57, s56, 192
    s_add_u32 s57, s57, 110592
    v_add3_u32 v23, v23, v7, s57
    s_mul_i32 s56, s56, 2176
    s_and_b32 s57, s3, 1
    s_lshl_b32 s57, s57, 7
    s_add_u32 s56, s56, s57
    s_add_u32 s56, s56, 122880
    v_add3_u32 v24, v24, v7, s56
    v_and_b32 v7, 1, v0
    v_lshl_add_u32 v24, v7, 6, v24
    v_and_b32 v7, 15, v0
    s_mul_i32 s56, s3, 272
    s_add_u32 s56, s56, 122880
    v_lshl_add_u32 v25, v7, 4, s56
    v_bfe_u32 v26, v0, 1, 4
    v_lshlrev_b32 v26, 4, v26
    s_mul_i32 s56, s3, 72
    v_add_u32 v7, s56, v0
    v_lshrrev_b32 v8, 4, v7
    v_lshlrev_b32 v27, 9, v8
    v_and_b32 v29, 15, v7
    v_lshl_add_u32 v27, v29, 4, v27
    v_and_b32 v29, 7, v7
    v_mul_u32_u24 v29, 1312, v29
    v_and_b32 v7, -8, v7
    v_add3_u32 v29, v29, v7, v13
    v_and_b32 v7, 7, v0
    v_add3_u32 v7, v7, s56, 64
    v_lshrrev_b32 v8, 4, v7
    v_lshlrev_b32 v28, 9, v8
    v_and_b32 v30, 15, v7
    v_lshl_add_u32 v28, v30, 4, v28
    v_and_b32 v30, 7, v7
    v_mul_u32_u24 v30, 1312, v30
    v_and_b32 v7, -8, v7
    v_add3_u32 v30, v30, v7, v13
    s_memrealtime s[8:9]
    s_waitcnt lgkmcnt(0)
    s_sub_u32 s8, s8, s30
    s_cmpk_ge_u32 s8, 2125
    s_cbranch_scc1 .ap_176
    s_waitcnt vmcnt(5)
    s_cmpk_ge_u32 s8, 2060
    s_cbranch_scc1 .ap_176
    s_waitcnt vmcnt(3)
    s_bitcmp1_b64 s[14:15], 60
    s_cbranch_scc0 1
    s_waitcnt vmcnt(2)
    s_cmpk_ge_u32 s8, 1985
    s_cbranch_scc1 .ap_176
    s_waitcnt vmcnt(1)
.ap_176:
    s_add_u32 s63, s69, 425984
    buffer_load_dwordx4 v[68:71], v2, s[44:47], s63 offen nt
    v_perm_b32 v112, v164, v160, s94
    v_perm_b32 v113, v172, v168, s94
    v_perm_b32 v114, v180, v176, s94
    v_perm_b32 v115, v188, v184, s94
    s_nop 1
    v_mfma_f32_16x16x32_bf16 v[128:131], v[96:99], v[112:115], 0
    v_perm_b32 v116, v164, v160, s95
    v_perm_b32 v117, v172, v168, s95
    v_perm_b32 v118, v180, v176, s95
    v_perm_b32 v119, v188, v184, s95
    s_nop 1
    v_mfma_f32_16x16x32_bf16 v[132:135], v[96:99], v[116:119], 0
    v_perm_b32 v120, v165, v161, s94
    v_perm_b32 v121, v173, v169, s94
    v_perm_b32 v122, v181, v177, s94
    v_perm_b32 v123, v189, v185, s94
    s_nop 1
    v_mfma_f32_16x16x32_bf16 v[136:139], v[96:99], v[120:123], 0
    v_perm_b32 v124, v165, v161, s95
    v_perm_b32 v125, v173, v169, s95
    v_perm_b32 v126, v181, v177, s95
    v_perm_b32 v127, v189, v185, s95
    s_nop 1
    v_mfma_f32_16x16x32_bf16 v[140:143], v[96:99], v[124:127], 0
    v_perm_b32 v112, v166, v162, s94
    v_perm_b32 v113, v174, v170, s94
    v_perm_b32 v114, v182, v178, s94
    v_perm_b32 v115, v190, v186, s94
    s_nop 1
    v_mfma_f32_16x16x32_bf16 v[144:147], v[96:99], v[112:115], 0
    v_perm_b32 v116, v166, v162, s95
    v_perm_b32 v117, v174, v170, s95
    v_perm_b32 v118, v182, v178, s95
    v_perm_b32 v119, v190, v186, s95
    s_nop 1
    v_mfma_f32_16x16x32_bf16 v[148:151], v[96:99], v[116:119], 0
    v_perm_b32 v120, v167, v163, s94
    v_perm_b32 v121, v175, v171, s94
    v_perm_b32 v122, v183, v179, s94
    v_perm_b32 v123, v191, v187, s94
    s_nop 1
    v_mfma_f32_16x16x32_bf16 v[152:155], v[96:99], v[120:123], 0
    v_perm_b32 v124, v167, v163, s95
    v_perm_b32 v125, v175, v171, s95
    v_perm_b32 v126, v183, v179, s95
    v_perm_b32 v127, v191, v187, s95
    s_nop 1
    v_mfma_f32_16x16x32_bf16 v[156:159], v[96:99], v[124:127], 0
    s_memrealtime s[8:9]
    s_waitcnt lgkmcnt(0)
    s_sub_u32 s8, s8, s30
    s_cmpk_ge_u32 s8, 2156
    s_nop 3
    s_cbranch_scc1 .ap_177
    s_waitcnt vmcnt(5)
    s_cmpk_ge_u32 s8, 2091
    s_cbranch_scc1 .ap_177
    s_waitcnt vmcnt(3)
    s_bitcmp1_b64 s[14:15], 61
    s_cbranch_scc0 1
    s_waitcnt vmcnt(2)
    s_cmpk_ge_u32 s8, 2016
    s_cbranch_scc1 .ap_177
    s_waitcnt vmcnt(1)
.ap_177:
    s_add_u32 s63, s69, 434176
    buffer_load_dwordx4 v[76:79], v2, s[44:47], s63 offen nt
    v_perm_b32 v112, v196, v192, s94
    v_perm_b32 v113, v204, v200, s94
    v_perm_b32 v114, v212, v208, s94
    v_perm_b32 v115, v220, v216, s94
    s_nop 1
    v_mfma_f32_16x16x32_bf16 v[128:131], v[100:103], v[112:115], v[128:131]
    v_perm_b32 v116, v196, v192, s95
    v_perm_b32 v117, v204, v200, s95
    v_perm_b32 v118, v212, v208, s95
    v_perm_b32 v119, v220, v216, s95
    s_nop 1
    v_mfma_f32_16x16x32_bf16 v[132:135], v[100:103], v[116:119], v[132:135]
    v_perm_b32 v120, v197, v193, s94
    v_perm_b32 v121, v205, v201, s94
    v_perm_b32 v122, v213, v209, s94
    v_perm_b32 v123, v221, v217, s94
    s_nop 1
    v_mfma_f32_16x16x32_bf16 v[136:139], v[100:103], v[120:123], v[136:139]
    v_perm_b32 v124, v197, v193, s95
    v_perm_b32 v125, v205, v201, s95
    v_perm_b32 v126, v213, v209, s95
    v_perm_b32 v127, v221, v217, s95
    s_nop 1
    v_mfma_f32_16x16x32_bf16 v[140:143], v[100:103], v[124:127], v[140:143]
    v_perm_b32 v112, v198, v194, s94
    v_perm_b32 v113, v206, v202, s94
    v_perm_b32 v114, v214, v210, s94
    v_perm_b32 v115, v222, v218, s94
    s_nop 1
    v_mfma_f32_16x16x32_bf16 v[144:147], v[100:103], v[112:115], v[144:147]
    v_perm_b32 v116, v198, v194, s95
    v_perm_b32 v117, v206, v202, s95
    v_perm_b32 v118, v214, v210, s95
    v_perm_b32 v119, v222, v218, s95
    s_nop 1
    v_mfma_f32_16x16x32_bf16 v[148:151], v[100:103], v[116:119], v[148:151]
    v_perm_b32 v120, v199, v195, s94
    v_perm_b32 v121, v207, v203, s94
    v_perm_b32 v122, v215, v211, s94
    v_perm_b32 v123, v223, v219, s94
    s_nop 1
    v_mfma_f32_16x16x32_bf16 v[152:155], v[100:103], v[120:123], v[152:155]
    v_perm_b32 v124, v199, v195, s95
    v_perm_b32 v125, v207, v203, s95
    v_perm_b32 v126, v215, v211, s95
    v_perm_b32 v127, v223, v219, s95
    s_nop 1
    v_mfma_f32_16x16x32_bf16 v[156:159], v[100:103], v[124:127], v[156:159]
    s_memrealtime s[8:9]
    s_waitcnt lgkmcnt(0)
    s_sub_u32 s8, s8, s30
    s_cmpk_ge_u32 s8, 2187
    s_nop 3
    s_cbranch_scc1 .ap_178
    s_waitcnt vmcnt(5)
    s_cmpk_ge_u32 s8, 2122
    s_cbranch_scc1 .ap_178
    s_waitcnt vmcnt(3)
    s_bitcmp1_b64 s[14:15], 62
    s_cbranch_scc0 1
    s_waitcnt vmcnt(2)
    s_cmpk_ge_u32 s8, 2047
    s_cbranch_scc1 .ap_178
    s_waitcnt vmcnt(1)
.ap_178:
    s_add_u32 s63, s69, 442368
    buffer_load_dwordx4 v[84:87], v2, s[44:47], s63 offen nt
    s_waitcnt vmcnt(7)
    v_perm_b32 v112, v228, v224, s94
    v_perm_b32 v113, v236, v232, s94
    v_perm_b32 v114, v244, v240, s94
    v_perm_b32 v115, v252, v248, s94
    s_nop 1
    v_mfma_f32_16x16x32_bf16 v[128:131], v[104:107], v[112:115], v[128:131]
    v_perm_b32 v116, v228, v224, s95
    v_perm_b32 v117, v236, v232, s95
    v_perm_b32 v118, v244, v240, s95
    v_perm_b32 v119, v252, v248, s95
    s_nop 1
    v_mfma_f32_16x16x32_bf16 v[132:135], v[104:107], v[116:119], v[132:135]
    v_perm_b32 v120, v229, v225, s94
    v_perm_b32 v121, v237, v233, s94
    v_perm_b32 v122, v245, v241, s94
    v_perm_b32 v123, v253, v249, s94
    s_nop 1
    v_mfma_f32_16x16x32_bf16 v[136:139], v[104:107], v[120:123], v[136:139]
    v_perm_b32 v124, v229, v225, s95
    v_perm_b32 v125, v237, v233, s95
    v_perm_b32 v126, v245, v241, s95
    v_perm_b32 v127, v253, v249, s95
    s_nop 1
    v_mfma_f32_16x16x32_bf16 v[140:143], v[104:107], v[124:127], v[140:143]
    v_perm_b32 v112, v230, v226, s94
    v_perm_b32 v113, v238, v234, s94
    v_perm_b32 v114, v246, v242, s94
    v_perm_b32 v115, v254, v250, s94
    s_nop 1
    v_mfma_f32_16x16x32_bf16 v[144:147], v[104:107], v[112:115], v[144:147]
    v_perm_b32 v116, v230, v226, s95
    v_perm_b32 v117, v238, v234, s95
    v_perm_b32 v118, v246, v242, s95
    v_perm_b32 v119, v254, v250, s95
    s_nop 1
    v_mfma_f32_16x16x32_bf16 v[148:151], v[104:107], v[116:119], v[148:151]
    v_perm_b32 v120, v231, v227, s94
    v_perm_b32 v121, v239, v235, s94
    v_perm_b32 v122, v247, v243, s94
    v_perm_b32 v123, v255, v251, s94
    s_nop 1
    v_mfma_f32_16x16x32_bf16 v[152:155], v[104:107], v[120:123], v[152:155]
    v_perm_b32 v124, v231, v227, s95
    v_perm_b32 v125, v239, v235, s95
    v_perm_b32 v126, v247, v243, s95
    v_perm_b32 v127, v255, v251, s95
    s_nop 1
    v_mfma_f32_16x16x32_bf16 v[156:159], v[104:107], v[124:127], v[156:159]
    s_memrealtime s[8:9]
    s_waitcnt lgkmcnt(0)
    s_sub_u32 s8, s8, s30
    s_cmpk_ge_u32 s8, 2218
    s_nop 3
    s_cbranch_scc1 .ap_179
    s_waitcnt vmcnt(5)
    s_cmpk_ge_u32 s8, 2153
    s_cbranch_scc1 .ap_179
    s_waitcnt vmcnt(3)
    s_bitcmp1_b64 s[14:15], 63
    s_cbranch_scc0 1
    s_waitcnt vmcnt(2)
    s_cmpk_ge_u32 s8, 2078
    s_cbranch_scc1 .ap_179
    s_waitcnt vmcnt(1)
.ap_179:
    s_add_u32 s63, s69, 450560
    buffer_load_dwordx4 v[92:95], v2, s[44:47], s63 offen nt
    s_setprio 0
    s_waitcnt vmcnt(6)
    v_perm_b32 v160, v44, v36, s94
    v_perm_b32 v164, v44, v36, s95
    v_perm_b32 v168, v45, v37, s94
    v_perm_b32 v172, v45, v37, s95
    v_perm_b32 v176, v46, v38, s94
    v_perm_b32 v180, v46, v38, s95
    v_perm_b32 v184, v47, v39, s94
    v_perm_b32 v188, v47, v39, s95
    s_waitcnt vmcnt(4)
    v_perm_b32 v161, v60, v52, s94
    v_perm_b32 v165, v60, v52, s95
    v_perm_b32 v169, v61, v53, s94
    v_perm_b32 v173, v61, v53, s95
    v_perm_b32 v177, v62, v54, s94
    v_perm_b32 v181, v62, v54, s95
    v_perm_b32 v185, v63, v55, s94
    v_perm_b32 v189, v63, v55, s95
    v_mfma_f32_16x16x16_bf16 v[128:131], v[108:109], v[160:161], v[128:131]
    v_mfma_f32_16x16x16_bf16 v[132:135], v[108:109], v[164:165], v[132:135]
    v_mfma_f32_16x16x16_bf16 v[136:139], v[108:109], v[168:169], v[136:139]
    v_mfma_f32_16x16x16_bf16 v[140:143], v[108:109], v[172:173], v[140:143]
    v_mfma_f32_16x16x16_bf16 v[144:147], v[108:109], v[176:177], v[144:147]
    v_mfma_f32_16x16x16_bf16 v[148:151], v[108:109], v[180:181], v[148:151]
    v_mfma_f32_16x16x16_bf16 v[152:155], v[108:109], v[184:185], v[152:155]
    v_mfma_f32_16x16x16_bf16 v[156:159], v[108:109], v[188:189], v[156:159]
    s_waitcnt vmcnt(2)
    v_perm_b32 v162, v76, v68, s94
    v_perm_b32 v166, v76, v68, s95
    v_perm_b32 v170, v77, v69, s94
    v_perm_b32 v174, v77, v69, s95
    v_perm_b32 v178, v78, v70, s94
    v_perm_b32 v182, v78, v70, s95
    v_perm_b32 v186, v79, v71, s94
    v_perm_b32 v190, v79, v71, s95
    s_lshl4_add_u32 s59, s67, s66
    s_lshl1_add_u32 s59, s59, s68
    s_lshl_b32 s59, s59, 9
    s_add_u32 s59, s59, 0x210000
    s_mov_b32 s60, 0x07060503
    s_mov_b32 s61, 0x07060502
    s_mov_b32 s62, 0x07060501
.Ltail_bc:
    s_waitcnt vmcnt(0)
    v_perm_b32 v163, v92, v84, s94
    v_perm_b32 v167, v92, v84, s95
    v_perm_b32 v171, v93, v85, s94
    v_perm_b32 v175, v93, v85, s95
    v_perm_b32 v179, v94, v86, s94
    v_perm_b32 v183, v94, v86, s95
    v_perm_b32 v187, v95, v87, s94
    v_perm_b32 v191, v95, v87, s95
    v_mfma_f32_16x16x16_bf16 v[128:131], v[110:111], v[162:163], v[128:131]
    v_mfma_f32_16x16x16_bf16 v[132:135], v[110:111], v[166:167], v[132:135]
    v_mfma_f32_16x16x16_bf16 v[136:139], v[110:111], v[170:171], v[136:139]
    v_mfma_f32_16x16x16_bf16 v[140:143], v[110:111], v[174:175], v[140:143]
    v_mfma_f32_16x16x16_bf16 v[144:147], v[110:111], v[178:179], v[144:147]
    v_mfma_f32_16x16x16_bf16 v[148:151], v[110:111], v[182:183], v[148:151]
    v_mfma_f32_16x16x16_bf16 v[152:155], v[110:111], v[186:187], v[152:155]
    v_mfma_f32_16x16x16_bf16 v[156:159], v[110:111], v[190:191], v[156:159]
    s_nop 1
    s_mov_b64 exec, 0xffffffff
    ds_write2_b32 v10, v128, v132 offset0:0 offset1:1
    ds_write2_b32 v10, v136, v140 offset0:2 offset1:3
    s_nop 0
    ds_write2_b32 v10, v144, v148 offset0:4 offset1:5
    s_nop 0
    ds_write2_b32 v10, v152, v156 offset0:6 offset1:7
    s_mov_b64 exec, -1
    s_lshl_b32 s32, s3, 10
    s_add_u32 m0, s32, 73728
    s_add_u32 s56, s33, 0
    buffer_load_dwordx4 v31, s[52:55], s56 offen nt lds
    s_add_u32 m0, s32, 81920
    s_add_u32 s56, s33, 73728
    buffer_load_dwordx4 v31, s[52:55], s56 offen nt lds
    s_add_u32 m0, s32, 90112
    s_add_u32 s56, s33, 147456
    buffer_load_dwordx4 v31, s[52:55], s56 offen nt lds
    s_add_u32 m0, s32, 98304
    s_add_u32 s56, s33, 221184
    buffer_load_dwordx4 v31, s[52:55], s56 offen nt lds
    s_waitcnt lgkmcnt(0)
    s_barrier
    s_cmp_lg_u32 s3, 7
    s_cbranch_scc1 .opub_180
    ds_read_b128 v[196:199], v9 offset:0
    ds_read_b128 v[200:203], v9 offset:1024
    ds_read_b128 v[204:207], v9 offset:2048
    ds_read_b128 v[208:211], v9 offset:3072
    ds_read_b128 v[212:215], v9 offset:4096
    ds_read_b128 v[216:219], v9 offset:5120
    ds_read_b128 v[220:223], v9 offset:6144
    ds_read_b128 v[224:227], v9 offset:7168
    s_waitcnt lgkmcnt(6)
    v_pk_add_f32 v[196:197], v[196:197], v[200:201]
    v_pk_add_f32 v[198:199], v[198:199], v[202:203]
    s_waitcnt lgkmcnt(4)
    v_pk_add_f32 v[204:205], v[204:205], v[208:209]
    v_pk_add_f32 v[206:207], v[206:207], v[210:211]
    v_pk_add_f32 v[196:197], v[196:197], v[204:205]
    v_pk_add_f32 v[198:199], v[198:199], v[206:207]
    s_waitcnt lgkmcnt(2)
    v_pk_add_f32 v[212:213], v[212:213], v[216:217]
    v_pk_add_f32 v[214:215], v[214:215], v[218:219]
    s_waitcnt lgkmcnt(0)
    v_pk_add_f32 v[220:221], v[220:221], v[224:225]
    v_pk_add_f32 v[222:223], v[222:223], v[226:227]
    v_pk_add_f32 v[212:213], v[212:213], v[220:221]
    v_pk_add_f32 v[214:215], v[214:215], v[222:223]
    v_pk_add_f32 v[196:197], v[196:197], v[212:213]
    v_pk_add_f32 v[198:199], v[198:199], v[214:215]
    v_perm_b32 v12, v196, v199, s60
    v_perm_b32 v13, v197, v199, s61
    v_perm_b32 v14, v198, v199, s62
    s_add_u32 s57, s59, 0xac000
    buffer_store_dwordx4 v[12:15], v11, s[36:39], s57 offen
    buffer_store_dwordx4 v[12:15], v11, s[36:39], s59 offen sc1
.opub_180:
    s_barrier
    s_bitcmp1_b32 s1, 0
    s_cbranch_scc1 .lt_181
    s_lshl_b32 s32, s3, 10
    s_add_u32 m0, s32, 0
    s_add_u32 s56, s101, 0
    buffer_load_dwordx4 v6, s[48:51], s56 offen nt lds
    s_add_u32 m0, s32, 8192
    s_add_u32 s56, s101, 589824
    buffer_load_dwordx4 v6, s[48:51], s56 offen nt lds
    s_add_u32 m0, s32, 16384
    s_add_u32 s56, s101, 1179648
    buffer_load_dwordx4 v6, s[48:51], s56 offen nt lds
    s_add_u32 m0, s32, 24576
    s_add_u32 s56, s101, 1769472
    buffer_load_dwordx4 v6, s[48:51], s56 offen nt lds
    s_add_u32 m0, s32, 32768
    s_add_u32 s56, s101, 2359296
    buffer_load_dwordx4 v6, s[48:51], s56 offen nt lds
.lt_181:
    s_lshl_b32 s32, s3, 10
    s_add_u32 m0, s32, 40960
    s_add_u32 s56, s101, 2949120
    buffer_load_dwordx4 v6, s[48:51], s56 offen nt lds
    s_add_u32 m0, s32, 49152
    s_add_u32 s56, s101, 3538944
    buffer_load_dwordx4 v6, s[48:51], s56 offen nt lds
    s_add_u32 m0, s32, 57344
    s_add_u32 s56, s101, 4128768
    buffer_load_dwordx4 v6, s[48:51], s56 offen nt lds
    s_add_u32 m0, s32, 65536
    s_add_u32 s56, s101, 4718592
    buffer_load_dwordx4 v6, s[48:51], s56 offen nt lds
    s_lshl_b32 s32, s3, 10
    s_cmp_ge_u32 s3, 4
    s_cbranch_scc1 .nod_182
    s_add_u32 m0, s32, 106496
    s_add_u32 s56, s33, 294912
    buffer_load_dwordx4 v31, s[52:55], s56 offen nt lds
.nod_182:
    s_branch .gpc_184
.gp_183:
    buffer_load_dwordx4 v[32:35], v2, s[36:39], s99 offen offset:0 sc1
    buffer_load_dwordx4 v[40:43], v2, s[36:39], s99 offen offset:1024 sc1
    buffer_load_dwordx2 v[48:49], v5, s[36:39], s99 offen offset:0 sc1
    buffer_load_dwordx4 v[56:59], v2, s[36:39], s100 offen offset:0 sc1
    buffer_load_dwordx4 v[64:67], v2, s[36:39], s100 offen offset:1024 sc1
    buffer_load_dwordx2 v[50:51], v5, s[36:39], s100 offen offset:0 sc1
    s_waitcnt vmcnt(0)
.gpc_184:
    v_min_u32 v7, v33, v35
    v_max_u32 v8, v33, v35
    v_min3_u32 v7, v7, v41, v43
    v_max3_u32 v8, v8, v41, v43
    v_min3_u32 v7, v7, v49, v57
    v_max3_u32 v8, v8, v49, v57
    v_min3_u32 v7, v7, v59, v65
    v_max3_u32 v8, v8, v59, v65
    v_min3_u32 v7, v7, v67, v51
    v_max3_u32 v8, v8, v67, v51
    v_cmp_eq_u32 vcc, s34, v7
    v_cmp_eq_u32 s[56:57], s34, v8
    s_and_b64 vcc, vcc, s[56:57]
    s_cmp_eq_u64 vcc, exec
    s_nop 2
    s_cbranch_scc1 .gpd_185
    s_sub_u32 s35, s35, 1
    s_cbranch_scc1 .Lexit
    s_sleep 2
    s_branch .gp_183
.gpd_185:
    v_lshlrev_b32 v230, 16, v32
    v_and_b32 v231, 0xffff0000, v32
    v_lshlrev_b32 v240, 16, v56
    v_and_b32 v241, 0xffff0000, v56
    v_lshlrev_b32 v232, 16, v34
    v_and_b32 v233, 0xffff0000, v34
    v_lshlrev_b32 v242, 16, v58
    v_and_b32 v243, 0xffff0000, v58
    v_lshlrev_b32 v234, 16, v40
    v_and_b32 v235, 0xffff0000, v40
    v_lshlrev_b32 v244, 16, v64
    v_and_b32 v245, 0xffff0000, v64
    v_lshlrev_b32 v236, 16, v42
    v_and_b32 v237, 0xffff0000, v42
    v_lshlrev_b32 v246, 16, v66
    v_and_b32 v247, 0xffff0000, v66
    v_lshlrev_b32 v238, 16, v48
    v_and_b32 v239, 0xffff0000, v48
    v_lshlrev_b32 v248, 16, v50
    v_and_b32 v249, 0xffff0000, v50
    s_sub_u32 s63, s65, 9
    s_mul_i32 s42, s64, 18432
    s_mul_i32 s56, s3, 2304
    s_add_u32 s42, s42, s56
    s_add_u32 s42, s42, 0x250000
    s_mul_i32 s41, s64, 36864
    s_add_u32 s41, s41, 0x274000
    s_lshr_b32 s57, s63, 1
    s_lshl3_add_u32 s40, s57, s3
    s_and_b32 s63, s63, 1
    s_lshl1_add_u32 s40, s40, s63
    s_lshl_b32 s40, s40, 8
    s_add_u32 s40, s40, s41
    s_mul_i32 s56, s63, 18432
    s_add_u32 s41, s41, s56
    s_mul_i32 s43, s3, 9
    s_add_u32 s43, s43, s57
    s_lshl3_add_u32 s43, s43, s64
    s_lshl1_add_u32 s43, s43, s63
    s_lshl_b32 s43, s43, 8
    s_add_u32 s43, s43, 0x38c000
    v_mov_b32 v137, s34
    v_mov_b32 v139, s34
    v_mov_b32 v143, s34
    s_add_u32 s57, s40, 0xac000
    s_mov_b64 exec, 0xffff
    buffer_load_dwordx4 v[80:83], v2, s[36:39], s57 offen offset:0 sc1
    s_mov_b64 exec, -1
    s_waitcnt vmcnt(0)
    s_barrier
.Lbc_x:
    s_add_u32 s58, s42, s0
    s_lshl1_add_u32 s42, s42, 0xac000
    s_cmp_eq_u32 s0, 0
    s_cselect_b32 s32, 64, 0
    buffer_load_dwordx4 v[144:147], v2, s[36:39], s58 offen offset:0 sc1
    buffer_load_dwordx4 v[148:151], v2, s[36:39], s58 offen offset:1024 sc1
    buffer_load_dwordx2 v[152:153], v5, s[36:39], s58 offen offset:0 sc1
    ds_read_b64_tr_b16 v[160:161], v19 offset:0
    ds_read_b64_tr_b16 v[162:163], v19 offset:512
    ds_read_b64_tr_b16 v[164:165], v19 offset:8192
    ds_read_b64_tr_b16 v[166:167], v19 offset:8704
    ds_read_b64_tr_b16 v[168:169], v19 offset:16384
    ds_read_b64_tr_b16 v[170:171], v19 offset:16896
    ds_read_b64_tr_b16 v[172:173], v19 offset:24576
    ds_read_b64_tr_b16 v[174:175], v19 offset:25088
    ds_read_b64_tr_b16 v[176:177], v20 offset:0
    ds_read_b64_tr_b16 v[178:179], v20 offset:512
    ds_read_b64_tr_b16 v[180:181], v20 offset:8192
    ds_read_b64_tr_b16 v[182:183], v20 offset:8704
    ds_read_b64_tr_b16 v[184:185], v20 offset:16384
    ds_read_b64_tr_b16 v[186:187], v20 offset:16896
    ds_read_b64_tr_b16 v[188:189], v20 offset:24576
    ds_read_b64_tr_b16 v[190:191], v20 offset:25088
    ds_read_b64_tr_b16 v[192:193], v20 offset:32768
    ds_read_b64_tr_b16 v[194:195], v20 offset:33280
    s_branch .mpw_190
.mp_186:
    s_or_b64 exec, s[88:89], 1
    buffer_load_dwordx4 v[144:147], v2, s[36:39], s58 offen offset:0 sc1
    s_or_b64 exec, s[90:91], 1
    buffer_load_dwordx4 v[148:151], v2, s[36:39], s58 offen offset:1024 sc1
    s_or_b64 exec, s[92:93], 1
    buffer_load_dwordx2 v[152:153], v5, s[36:39], s58 offen offset:0 sc1
    s_mov_b64 exec, -1
    s_sub_u32 s35, s35, 1
    s_cbranch_scc1 .Lexit
    s_sub_u32 vcc_lo, s42, s58
    s_add_u32 s32, s32, 1
    s_cmp_ge_u32 s32, 64
    s_cselect_b32 s58, vcc_lo, s58
.mpw_190:
    s_waitcnt vmcnt(0)
.mpj_187:
    v_cmp_ne_u32 s[88:89], s34, v145
    v_cmp_ne_u32 vcc, s34, v147
    s_or_b64 s[88:89], s[88:89], vcc
    v_cmp_ne_u32 s[90:91], s34, v149
    v_cmp_ne_u32 vcc, s34, v151
    s_or_b64 s[90:91], s[90:91], vcc
    v_cmp_ne_u32 s[92:93], s34, v153
    s_or_b64 vcc, s[88:89], s[90:91]
    s_or_b64 vcc, vcc, s[92:93]
    s_cbranch_scc1 .mp_186
    s_mov_b32 s56, 0x3f803f80
    v_dot2_f32_bf16 v250, v144, s56, 0
    v_dot2_f32_bf16 v251, v144, v144, 0
    v_dot2_f32_bf16 v250, v146, s56, v250
    v_dot2_f32_bf16 v251, v146, v146, v251
    v_dot2_f32_bf16 v250, v148, s56, v250
    v_dot2_f32_bf16 v251, v148, v148, v251
    v_dot2_f32_bf16 v250, v150, s56, v250
    v_dot2_f32_bf16 v251, v150, v150, v251
    s_mov_b64 exec, 0xffffffff
    v_dot2_f32_bf16 v250, v152, s56, v250
    v_dot2_f32_bf16 v251, v152, v152, v251
    s_mov_b64 exec, -1
    s_nop 1
    v_permlane32_swap_b32 v250, v251
    v_add_f32 v250, v250, v251
    v_mov_b32 v252, v250
    s_nop 1
    v_permlane16_swap_b32 v252, v250
    v_add_f32 v250, v252, v250
    v_lshlrev_b32 v220, 16, v144
    v_and_b32 v221, 0xffff0000, v144
    v_add_f32_dpp v250, v250, v250 row_ror:8 row_mask:0xf bank_mask:0xf
    v_lshlrev_b32 v222, 16, v146
    v_and_b32 v223, 0xffff0000, v146
    v_add_f32_dpp v250, v250, v250 row_ror:4 row_mask:0xf bank_mask:0xf
    v_lshlrev_b32 v224, 16, v148
    v_and_b32 v225, 0xffff0000, v148
    v_add_f32_dpp v250, v250, v250 quad_perm:[2,3,0,1] row_mask:0xf bank_mask:0xf
    v_lshlrev_b32 v226, 16, v150
    v_and_b32 v227, 0xffff0000, v150
    v_add_f32_dpp v250, v250, v250 quad_perm:[1,0,3,2] row_mask:0xf bank_mask:0xf
    v_mul_f32 v250, 0x3ae38e39, v250
    v_lshlrev_b32 v228, 16, v152
    v_and_b32 v229, 0xffff0000, v152
    v_readlane_b32 s56, v250, 0
    v_readlane_b32 s57, v250, 32
    s_nop 0
    v_mov_b32 v250, s56
    v_fma_f32 v251, -v250, v250, s57
    v_max_f32 v251, 0, v251
    v_add_f32 v251, 0x3727c5ac, v251
    v_rsq_f32 v252, v251
    s_nop 0
    v_mul_f32 v251, -v250, v252
    v_mul_f32 v250, -v250, v252
    v_mov_b32 v253, v252
    v_pk_fma_f32 v[220:221], v[220:221], v[252:253], v[250:251]
    v_pk_fma_f32 v[222:223], v[222:223], v[252:253], v[250:251]
    v_pk_fma_f32 v[224:225], v[224:225], v[252:253], v[250:251]
    v_pk_fma_f32 v[226:227], v[226:227], v[252:253], v[250:251]
    v_pk_fma_f32 v[228:229], v[228:229], v[252:253], v[250:251]
    v_pk_fma_f32 v[220:221], v[220:221], v[240:241], v[230:231]
    v_pk_fma_f32 v[222:223], v[222:223], v[242:243], v[232:233]
    v_pk_fma_f32 v[224:225], v[224:225], v[244:245], v[234:235]
    v_pk_fma_f32 v[226:227], v[226:227], v[246:247], v[236:237]
    v_pk_fma_f32 v[228:229], v[228:229], v[248:249], v[238:239]
    v_cvt_pk_bf16_f32 v154, v220, v221
    v_cvt_pk_bf16_f32 v155, v222, v223
    v_cvt_pk_bf16_f32 v156, v224, v225
    v_cvt_pk_bf16_f32 v157, v226, v227
    v_cvt_pk_bf16_f32 v158, v228, v229
    ds_write_b64 v17, v[154:155]
    ds_write_b64 v17, v[156:157] offset:512
    ds_write_b32 v18, v158
    s_waitcnt lgkmcnt(0)
    s_barrier
    ds_read_b128 v[96:99], v16 offset:0
    ds_read_b128 v[100:103], v16 offset:128
    ds_read_b128 v[104:107], v16 offset:256
    ds_read_b128 v[108:111], v16 offset:384
    ds_read_b128 v[112:115], v16 offset:512
    ds_read_b128 v[116:119], v16 offset:640
    ds_read_b128 v[120:123], v16 offset:768
    ds_read_b128 v[124:127], v16 offset:896
    ds_read_b128 v[128:131], v16 offset:1024
    s_waitcnt lgkmcnt(8)
    v_mfma_f32_16x16x32_bf16 v[132:135], v[160:163], v[96:99], 0
    s_waitcnt lgkmcnt(7)
    v_mfma_f32_16x16x32_bf16 v[132:135], v[164:167], v[100:103], v[132:135]
    s_waitcnt lgkmcnt(6)
    v_mfma_f32_16x16x32_bf16 v[132:135], v[168:171], v[104:107], v[132:135]
    s_waitcnt lgkmcnt(5)
    v_mfma_f32_16x16x32_bf16 v[132:135], v[172:175], v[108:111], v[132:135]
    s_waitcnt lgkmcnt(4)
    v_mfma_f32_16x16x32_bf16 v[132:135], v[176:179], v[112:115], v[132:135]
    s_waitcnt lgkmcnt(3)
    v_mfma_f32_16x16x32_bf16 v[132:135], v[180:183], v[116:119], v[132:135]
    s_waitcnt lgkmcnt(2)
    v_mfma_f32_16x16x32_bf16 v[132:135], v[184:187], v[120:123], v[132:135]
    s_waitcnt lgkmcnt(1)
    v_mfma_f32_16x16x32_bf16 v[132:135], v[188:191], v[124:127], v[132:135]
    s_waitcnt lgkmcnt(0)
    v_mfma_f32_16x16x32_bf16 v[132:135], v[192:195], v[128:131], v[132:135]
    s_cmp_lg_u32 s63, 0
    s_nop 6
    v_permlane32_swap_b32 v132, v134
    v_permlane32_swap_b32 v133, v135
    v_cndmask_b32 v133, v133, v134, s[96:97]
    v_cndmask_b32 v132, v132, v135, s[96:97]
    s_nop 1
    v_add_f32_dpp v12, v133, v132 quad_perm:[1,0,3,2] row_mask:0xf bank_mask:0xf
    s_nop 1
    s_cbranch_scc1 .up_191
    v_mul_f32 v7, 0xbfb8aa3b, v12
    v_exp_f32 v7, v7
    s_nop 0
    v_add_f32 v7, 1.0, v7
    v_rcp_f32 v7, v7
    s_nop 0
    v_mul_f32 v12, v12, v7
.up_191:
    s_nop 1
    v_mov_b32_dpp v8, v12 quad_perm:[0,0,2,2] row_mask:0xf bank_mask:0xf
    v_mov_b32_dpp v9, v12 quad_perm:[1,1,3,3] row_mask:0xf bank_mask:0xf
    v_cvt_pk_bf16_f32 v136, v8, v9
    v_cvt_pk_bf16_f32 v138, v8, v9
    s_nop 1
    v_permlane32_swap_b32 v136, v138
    s_mov_b64 exec, 0x55555555
    s_add_u32 s57, s40, 0xac000
    buffer_store_dwordx4 v[136:139], v26, s[36:39], s57 offen
    s_cmp_lg_u32 s0, 0
    s_cbranch_scc1 2
    buffer_store_dwordx4 v[136:139], v26, s[36:39], s40 offen sc1
    s_mov_b64 exec, -1
    s_barrier
    s_add_u32 s58, s41, s0
    s_lshl1_add_u32 s41, s41, 0xac000
    s_cmp_eq_u32 s0, 0
    s_cselect_b32 s32, 64, 0
    buffer_load_dwordx4 v[160:163], v27, s[36:39], s58 offen offset:0 sc1
    buffer_load_dwordx4 v[164:167], v27, s[36:39], s58 offen offset:256 sc1
    s_mov_b64 exec, 0xff
    buffer_load_dwordx4 v[168:171], v28, s[36:39], s58 offen offset:0 sc1
    buffer_load_dwordx4 v[172:175], v28, s[36:39], s58 offen offset:256 sc1
    s_mov_b64 exec, -1
    ds_read_b64_tr_b16 v[196:197], v21 offset:0
    ds_read_b64_tr_b16 v[198:199], v21 offset:512
    ds_read_b64_tr_b16 v[208:209], v22 offset:0
    ds_read_b64_tr_b16 v[210:211], v22 offset:512
    ds_read_b64_tr_b16 v[200:201], v21 offset:4096
    ds_read_b64_tr_b16 v[202:203], v21 offset:4608
    ds_read_b64_tr_b16 v[212:213], v22 offset:4096
    ds_read_b64_tr_b16 v[214:215], v22 offset:4608
    ds_read_b64_tr_b16 v[204:205], v21 offset:8192
    ds_read_b64_tr_b16 v[206:207], v21 offset:8704
    ds_read_b64_tr_b16 v[216:217], v22 offset:8192
    ds_read_b64_tr_b16 v[218:219], v22 offset:8704
    s_branch .mpw_196
.mp_192:
    s_or_b64 exec, s[88:89], 1
    buffer_load_dwordx4 v[160:163], v27, s[36:39], s58 offen offset:0 sc1
    s_or_b64 exec, s[90:91], 1
    buffer_load_dwordx4 v[164:167], v27, s[36:39], s58 offen offset:256 sc1
    s_or_b64 exec, s[92:93], 1
    buffer_load_dwordx4 v[168:171], v28, s[36:39], s58 offen offset:0 sc1
    s_or_b64 exec, s[56:57], 1
    buffer_load_dwordx4 v[172:175], v28, s[36:39], s58 offen offset:256 sc1
    s_mov_b64 exec, -1
    s_sub_u32 s35, s35, 1
    s_cbranch_scc1 .Lexit
    s_sub_u32 vcc_lo, s41, s58
    s_add_u32 s32, s32, 1
    s_cmp_ge_u32 s32, 64
    s_cselect_b32 s58, vcc_lo, s58
    s_cmp_eq_u32 s32, 64
    s_cbranch_scc0 .mpi_194
    s_mov_b64 exec, 0x55555555
    buffer_store_dwordx4 v[136:139], v26, s[36:39], s40 offen sc1
    s_mov_b64 exec, -1
.mpi_194:
.mpw_196:
    s_waitcnt vmcnt(0)
.mpj_193:
    v_cmp_ne_u32 s[88:89], s34, v161
    v_cmp_ne_u32 vcc, s34, v163
    s_or_b64 s[88:89], s[88:89], vcc
    v_cmp_ne_u32 s[90:91], s34, v165
    v_cmp_ne_u32 vcc, s34, v167
    s_or_b64 s[90:91], s[90:91], vcc
    v_cmp_ne_u32 s[92:93], s34, v169
    v_cmp_ne_u32 vcc, s34, v171
    s_or_b64 s[92:93], s[92:93], vcc
    s_and_b64 s[92:93], s[92:93], 0xff
    v_cmp_ne_u32 s[56:57], s34, v173
    v_cmp_ne_u32 vcc, s34, v175
    s_or_b64 s[56:57], s[56:57], vcc
    s_and_b64 s[56:57], s[56:57], 0xff
    s_or_b64 vcc, s[88:89], s[90:91]
    s_or_b64 vcc, vcc, s[92:93]
    s_or_b64 vcc, vcc, s[56:57]
    s_cbranch_scc1 .mp_192
    v_and_b32 v161, 0xffff0000, v160
    v_lshlrev_b32 v160, 16, v160
    v_and_b32 v163, 0xffff0000, v162
    v_lshlrev_b32 v162, 16, v162
    v_and_b32 v165, 0xffff0000, v164
    v_lshlrev_b32 v164, 16, v164
    v_and_b32 v167, 0xffff0000, v166
    v_lshlrev_b32 v166, 16, v166
    v_and_b32 v169, 0xffff0000, v168
    v_lshlrev_b32 v168, 16, v168
    v_and_b32 v171, 0xffff0000, v170
    v_lshlrev_b32 v170, 16, v170
    v_and_b32 v173, 0xffff0000, v172
    v_lshlrev_b32 v172, 16, v172
    v_and_b32 v175, 0xffff0000, v174
    v_lshlrev_b32 v174, 16, v174
    v_pk_mul_f32 v[160:161], v[160:161], v[164:165]
    v_pk_mul_f32 v[162:163], v[162:163], v[166:167]
    v_pk_mul_f32 v[168:169], v[168:169], v[172:173]
    v_pk_mul_f32 v[170:171], v[170:171], v[174:175]
    v_cvt_pk_bf16_f32 v160, v160, v161
    v_cvt_pk_bf16_f32 v161, v162, v163
    v_cvt_pk_bf16_f32 v168, v168, v169
    v_cvt_pk_bf16_f32 v169, v170, v171
    ds_write_b64 v29, v[160:161]
    s_mov_b64 exec, 0xff
    ds_write_b64 v30, v[168:169]
    s_mov_b64 exec, -1
    s_waitcnt lgkmcnt(0)
    s_barrier
    s_cmp_ge_u32 s3, 6
    s_cbranch_scc1 .tg_197
    ds_read_b128 v[96:99], v23 offset:0
    ds_read_b128 v[100:103], v23 offset:64
    ds_read_b128 v[104:107], v23 offset:128
    s_waitcnt lgkmcnt(2)
    v_mfma_f32_16x16x32_bf16 v[132:135], v[196:199], v[96:99], 0
    v_mfma_f32_16x16x32_bf16 v[136:139], v[208:211], v[96:99], 0
    s_waitcnt lgkmcnt(1)
    v_mfma_f32_16x16x32_bf16 v[132:135], v[200:203], v[100:103], v[132:135]
    v_mfma_f32_16x16x32_bf16 v[136:139], v[212:215], v[100:103], v[136:139]
    s_waitcnt lgkmcnt(0)
    v_mfma_f32_16x16x32_bf16 v[132:135], v[204:207], v[104:107], v[132:135]
    v_mfma_f32_16x16x32_bf16 v[136:139], v[216:219], v[104:107], v[136:139]
    s_nop 7
    v_cndmask_b32 v132, v132, v136, s[96:97]
    v_cndmask_b32 v133, v133, v137, s[96:97]
    v_cndmask_b32 v134, v134, v138, s[96:97]
    v_cndmask_b32 v135, v135, v139, s[96:97]
    ds_write_b128 v24, v[132:135]
    s_waitcnt lgkmcnt(0)
.tg_197:
    s_barrier
    ds_read_b128 v[112:115], v25 offset:0
    ds_read_b128 v[116:119], v25 offset:2176
    ds_read_b128 v[120:123], v25 offset:4352
    s_mov_b32 s60, 0x07060503
    s_mov_b32 s61, 0x07060502
    s_mov_b32 s62, 0x07060501
    s_waitcnt lgkmcnt(1)
    v_pk_add_f32 v[112:113], v[112:113], v[116:117]
    v_pk_add_f32 v[114:115], v[114:115], v[118:119]
    s_waitcnt lgkmcnt(0)
    v_pk_add_f32 v[112:113], v[112:113], v[120:121]
    v_pk_add_f32 v[114:115], v[114:115], v[122:123]
    v_perm_b32 v140, v112, v115, s60
    v_perm_b32 v141, v113, v115, s61
    v_perm_b32 v142, v114, v115, s62
    s_mov_b64 exec, 0xffff
    buffer_store_dwordx4 v[140:143], v2, s[36:39], s43 offen sc1
    s_mov_b64 exec, -1
    s_nop 0
    s_branch .Lexit
.Latt_n:
    v_and_b32 v8, 1, v0
    v_lshlrev_b32 v8, 8, v8
    v_and_b32 v9, 0x3c, v0
    v_lshl_add_u32 v9, v9, 2, v8
    v_lshlrev_b32 v7, 1, v9
    v_and_b32 v9, 0x3c, v0
    v_lshrrev_b32 v8, 4, v8
    v_and_b32 v9, 2, v0
    v_lshl_add_u32 v9, v9, 6, v8
    s_lshl_b32 s58, s66, 14
    s_lshl_b32 s59, s67, 10
    s_add_u32 s58, s58, s59
    s_add_u32 s58, s58, 0x40000
    s_lshl4_add_u32 s59, s66, s67
    s_lshl_b32 s59, s59, 8
    s_add_u32 s59, s59, 0x200000
    s_memrealtime s[8:9]
    s_waitcnt vmcnt(8)
    s_waitcnt lgkmcnt(0)
    s_sub_u32 s8, s8, s30
    s_cmpk_ge_u32 s8, 1147
    s_cbranch_scc1 .ap_198
    s_waitcnt vmcnt(5)
    s_cmpk_ge_u32 s8, 1082
    s_cbranch_scc1 .ap_198
    s_waitcnt vmcnt(3)
    s_bitcmp1_b64 s[14:15], 26
    s_cbranch_scc0 1
    s_waitcnt vmcnt(2)
    s_cmpk_ge_u32 s8, 1007
    s_cbranch_scc1 .ap_198
    s_waitcnt vmcnt(1)
.ap_198:
    s_add_u32 s63, s69, 409600
    buffer_load_dwordx4 v[88:91], v1, s[40:43], s63 offen nt
    s_memrealtime s[8:9]
    s_waitcnt vmcnt(8)
    s_waitcnt lgkmcnt(0)
    s_sub_u32 s8, s8, s30
    s_cmpk_ge_u32 s8, 1174
    s_cbranch_scc1 .ap_199
    s_waitcnt vmcnt(5)
    s_cmpk_ge_u32 s8, 1109
    s_cbranch_scc1 .ap_199
    s_waitcnt vmcnt(3)
    s_bitcmp1_b64 s[14:15], 27
    s_cbranch_scc0 1
    s_waitcnt vmcnt(2)
    s_cmpk_ge_u32 s8, 1034
    s_cbranch_scc1 .ap_199
    s_waitcnt vmcnt(1)
.ap_199:
    s_add_u32 s63, s69, 417792
    buffer_load_dwordx4 v[92:95], v1, s[40:43], s63 offen nt
    s_memrealtime s[8:9]
    s_waitcnt vmcnt(8)
    s_waitcnt lgkmcnt(0)
    s_sub_u32 s8, s8, s30
    s_cmpk_ge_u32 s8, 1201
    s_cbranch_scc1 .ap_200
    s_waitcnt vmcnt(5)
    s_cmpk_ge_u32 s8, 1136
    s_cbranch_scc1 .ap_200
    s_waitcnt vmcnt(3)
    s_bitcmp1_b64 s[14:15], 28
    s_cbranch_scc0 1
    s_waitcnt vmcnt(2)
    s_cmpk_ge_u32 s8, 1061
    s_cbranch_scc1 .ap_200
    s_waitcnt vmcnt(1)
.ap_200:
    s_add_u32 s63, s69, 425984
    buffer_load_dwordx4 v[120:123], v1, s[40:43], s63 offen nt
    s_memrealtime s[8:9]
    s_waitcnt vmcnt(8)
    s_waitcnt lgkmcnt(0)
    s_sub_u32 s8, s8, s30
    s_cmpk_ge_u32 s8, 1228
    s_cbranch_scc1 .ap_201
    s_waitcnt vmcnt(5)
    s_cmpk_ge_u32 s8, 1163
    s_cbranch_scc1 .ap_201
    s_waitcnt vmcnt(3)
    s_bitcmp1_b64 s[14:15], 29
    s_cbranch_scc0 1
    s_waitcnt vmcnt(2)
    s_cmpk_ge_u32 s8, 1088
    s_cbranch_scc1 .ap_201
    s_waitcnt vmcnt(1)
.ap_201:
    s_add_u32 s63, s69, 434176
    buffer_load_dwordx4 v[124:127], v1, s[40:43], s63 offen nt
    s_memrealtime s[8:9]
    s_waitcnt vmcnt(8)
    s_waitcnt lgkmcnt(0)
    s_sub_u32 s8, s8, s30
    s_cmpk_ge_u32 s8, 1255
    s_cbranch_scc1 .ap_202
    s_waitcnt vmcnt(5)
    s_cmpk_ge_u32 s8, 1190
    s_cbranch_scc1 .ap_202
    s_waitcnt vmcnt(3)
    s_bitcmp1_b64 s[14:15], 30
    s_cbranch_scc0 1
    s_waitcnt vmcnt(2)
    s_cmpk_ge_u32 s8, 1115
    s_cbranch_scc1 .ap_202
    s_waitcnt vmcnt(1)
.ap_202:
    s_add_u32 s63, s69, 442368
    buffer_load_dwordx4 v[152:155], v1, s[40:43], s63 offen nt
    s_memrealtime s[8:9]
    s_waitcnt vmcnt(8)
    s_waitcnt lgkmcnt(0)
    s_sub_u32 s8, s8, s30
    s_cmpk_ge_u32 s8, 1282
    s_cbranch_scc1 .ap_203
    s_waitcnt vmcnt(5)
    s_cmpk_ge_u32 s8, 1217
    s_cbranch_scc1 .ap_203
    s_waitcnt vmcnt(3)
    s_bitcmp1_b64 s[14:15], 31
    s_cbranch_scc0 1
    s_waitcnt vmcnt(2)
    s_cmpk_ge_u32 s8, 1142
    s_cbranch_scc1 .ap_203
    s_waitcnt vmcnt(1)
.ap_203:
    s_add_u32 s63, s69, 450560
    buffer_load_dwordx4 v[156:159], v1, s[40:43], s63 offen nt
    buffer_load_dwordx4 v[16:19], v7, s[36:39], s58 offen offset:0 sc1
    buffer_load_dwordx4 v[20:23], v7, s[36:39], s58 offen offset:16 sc1
    s_memrealtime s[8:9]
    s_waitcnt vmcnt(8)
    s_waitcnt lgkmcnt(0)
    s_sub_u32 s8, s8, s30
    s_cmpk_ge_u32 s8, 1309
    s_cbranch_scc1 .ap_204
    s_waitcnt vmcnt(5)
    s_cmpk_ge_u32 s8, 1244
    s_cbranch_scc1 .ap_204
    s_waitcnt vmcnt(3)
    s_bitcmp1_b64 s[14:15], 32
    s_cbranch_scc0 1
    s_waitcnt vmcnt(2)
    s_cmpk_ge_u32 s8, 1169
    s_cbranch_scc1 .ap_204
    s_waitcnt vmcnt(1)
.ap_204:
    s_add_u32 s63, s69, 0
    buffer_load_dwordx4 v[160:163], v2, s[44:47], s63 offen nt
    s_memrealtime s[8:9]
    s_waitcnt vmcnt(8)
    s_waitcnt lgkmcnt(0)
    s_sub_u32 s8, s8, s30
    s_cmpk_ge_u32 s8, 1336
    s_cbranch_scc1 .ap_205
    s_waitcnt vmcnt(5)
    s_cmpk_ge_u32 s8, 1271
    s_cbranch_scc1 .ap_205
    s_waitcnt vmcnt(3)
    s_bitcmp1_b64 s[14:15], 33
    s_cbranch_scc0 1
    s_waitcnt vmcnt(2)
    s_cmpk_ge_u32 s8, 1196
    s_cbranch_scc1 .ap_205
    s_waitcnt vmcnt(1)
.ap_205:
    s_add_u32 s63, s69, 8192
    buffer_load_dwordx4 v[164:167], v2, s[44:47], s63 offen nt
    s_memrealtime s[8:9]
    s_waitcnt vmcnt(8)
    s_waitcnt lgkmcnt(0)
    s_sub_u32 s8, s8, s30
    s_cmpk_ge_u32 s8, 1363
    s_cbranch_scc1 .ap_206
    s_waitcnt vmcnt(5)
    s_cmpk_ge_u32 s8, 1298
    s_cbranch_scc1 .ap_206
    s_waitcnt vmcnt(3)
    s_bitcmp1_b64 s[14:15], 34
    s_cbranch_scc0 1
    s_waitcnt vmcnt(2)
    s_cmpk_ge_u32 s8, 1223
    s_cbranch_scc1 .ap_206
    s_waitcnt vmcnt(1)
.ap_206:
    s_add_u32 s63, s69, 16384
    buffer_load_dwordx4 v[168:171], v2, s[44:47], s63 offen nt
    s_waitcnt vmcnt(3)
    s_branch .gpc_208
.gp_207:
    buffer_load_dwordx4 v[16:19], v7, s[36:39], s58 offen offset:0 sc1
    buffer_load_dwordx4 v[20:23], v7, s[36:39], s58 offen offset:16 sc1
    s_waitcnt vmcnt(0)
.gpc_208:
    v_min_u32 v10, v17, v19
    v_max_u32 v11, v17, v19
    v_min3_u32 v10, v10, v21, v23
    v_max3_u32 v11, v11, v21, v23
    v_cmp_eq_u32 vcc, s34, v10
    v_cmp_eq_u32 s[56:57], s34, v11
    s_and_b64 vcc, vcc, s[56:57]
    s_cmp_eq_u64 vcc, exec
    s_nop 2
    s_cbranch_scc1 .gpd_209
    s_sub_u32 s35, s35, 1
    s_cbranch_scc1 .Lexit
    s_sleep 1
    s_branch .gp_207
.gpd_209:
    s_mov_b32 vcc_lo, 0xcccccccc
    s_mov_b32 vcc_hi, 0xcccccccc
    v_cndmask_b32_e64 v24, v16, 0, vcc
    v_cndmask_b32_e64 v25, v18, 0, vcc
    v_cndmask_b32_e64 v26, v20, 0, vcc
    v_cndmask_b32_e64 v27, v22, 0, vcc
    v_cndmask_b32_e32 v28, 0, v16, vcc
    v_cndmask_b32_e32 v29, 0, v18, vcc
    v_cndmask_b32_e32 v30, 0, v20, vcc
    v_cndmask_b32_e32 v31, 0, v22, vcc
    v_mfma_f32_16x16x32_bf16 v[16:19], v[32:35], v[24:27], 0
    v_mfma_f32_16x16x32_bf16 v[32:35], v[40:43], v[24:27], 0
    v_mfma_f32_16x16x32_bf16 v[16:19], v[36:39], v[28:31], v[16:19]
    v_mfma_f32_16x16x32_bf16 v[40:43], v[48:51], v[24:27], 0
    v_mfma_f32_16x16x32_bf16 v[32:35], v[44:47], v[28:31], v[32:35]
    v_mfma_f32_16x16x32_bf16 v[48:51], v[56:59], v[24:27], 0
    v_mfma_f32_16x16x32_bf16 v[40:43], v[52:55], v[28:31], v[40:43]
    v_mfma_f32_16x16x32_bf16 v[56:59], v[64:67], v[24:27], 0
    v_mfma_f32_16x16x32_bf16 v[48:51], v[60:63], v[28:31], v[48:51]
    s_nop 1
    v_add_f32_dpp v10, v17, v16 row_ror:12 row_mask:0xf bank_mask:0x1
    s_memrealtime s[8:9]
    s_waitcnt lgkmcnt(0)
    s_sub_u32 s8, s8, s30
    s_cmpk_ge_u32 s8, 1390
    s_nop 0
    s_cbranch_scc1 .ap_210
    s_waitcnt vmcnt(3)
    s_cmpk_ge_u32 s8, 1325
    s_cbranch_scc1 .ap_210
    s_waitcnt vmcnt(3)
    s_bitcmp1_b64 s[14:15], 35
    s_cbranch_scc0 1
    s_waitcnt vmcnt(2)
    s_cmpk_ge_u32 s8, 1250
    s_cbranch_scc1 .ap_210
    s_waitcnt vmcnt(1)
.ap_210:
    s_add_u32 s63, s69, 24576
    buffer_load_dwordx4 v[172:175], v2, s[44:47], s63 offen nt
    v_mfma_f32_16x16x32_bf16 v[64:67], v[72:75], v[24:27], 0
    v_mfma_f32_16x16x32_bf16 v[56:59], v[68:71], v[28:31], v[56:59]
    v_add_f32_dpp v11, v33, v32 row_ror:12 row_mask:0xf bank_mask:0x1
    v_add_f32_dpp v10, v18, v10 row_ror:8 row_mask:0xf bank_mask:0x1
    v_mfma_f32_16x16x32_bf16 v[72:75], v[80:83], v[24:27], 0
    v_mfma_f32_16x16x32_bf16 v[64:67], v[76:79], v[28:31], v[64:67]
    v_add_f32_dpp v12, v41, v40 row_ror:12 row_mask:0xf bank_mask:0x1
    v_add_f32_dpp v11, v34, v11 row_ror:8 row_mask:0xf bank_mask:0x1
    v_add_f32_dpp v10, v19, v10 row_ror:4 row_mask:0xf bank_mask:0x1
    v_mfma_f32_16x16x32_bf16 v[80:83], v[88:91], v[24:27], 0
    v_mfma_f32_16x16x32_bf16 v[72:75], v[84:87], v[28:31], v[72:75]
    v_add_f32_dpp v13, v49, v48 row_ror:12 row_mask:0xf bank_mask:0x1
    v_add_f32_dpp v12, v42, v12 row_ror:8 row_mask:0xf bank_mask:0x1
    v_add_f32_dpp v11, v35, v11 row_ror:4 row_mask:0xf bank_mask:0x1
    v_mfma_f32_16x16x32_bf16 v[88:91], v[96:99], v[24:27], 0
    v_mfma_f32_16x16x32_bf16 v[80:83], v[92:95], v[28:31], v[80:83]
    v_add_f32_dpp v10, v58, v57 row_ror:12 row_mask:0xf bank_mask:0x2
    v_add_f32_dpp v13, v50, v13 row_ror:8 row_mask:0xf bank_mask:0x1
    v_add_f32_dpp v12, v43, v12 row_ror:4 row_mask:0xf bank_mask:0x1
    s_memrealtime s[8:9]
    s_waitcnt lgkmcnt(0)
    s_sub_u32 s8, s8, s30
    s_cmpk_ge_u32 s8, 1417
    s_nop 0
    s_cbranch_scc1 .ap_211
    s_waitcnt vmcnt(4)
    s_cmpk_ge_u32 s8, 1352
    s_cbranch_scc1 .ap_211
    s_waitcnt vmcnt(3)
    s_bitcmp1_b64 s[14:15], 36
    s_cbranch_scc0 1
    s_waitcnt vmcnt(2)
    s_cmpk_ge_u32 s8, 1277
    s_cbranch_scc1 .ap_211
    s_waitcnt vmcnt(1)
.ap_211:
    s_add_u32 s63, s69, 32768
    buffer_load_dwordx4 v[176:179], v2, s[44:47], s63 offen nt
    v_mfma_f32_16x16x32_bf16 v[96:99], v[104:107], v[24:27], 0
    v_mfma_f32_16x16x32_bf16 v[88:91], v[100:103], v[28:31], v[88:91]
    v_add_f32_dpp v11, v66, v65 row_ror:12 row_mask:0xf bank_mask:0x2
    v_add_f32_dpp v10, v59, v10 row_ror:8 row_mask:0xf bank_mask:0x2
    v_add_f32_dpp v13, v51, v13 row_ror:4 row_mask:0xf bank_mask:0x1
    v_mfma_f32_16x16x32_bf16 v[104:107], v[112:115], v[24:27], 0
    v_mfma_f32_16x16x32_bf16 v[96:99], v[108:111], v[28:31], v[96:99]
    v_add_f32_dpp v12, v74, v73 row_ror:12 row_mask:0xf bank_mask:0x2
    v_add_f32_dpp v11, v67, v11 row_ror:8 row_mask:0xf bank_mask:0x2
    v_add_f32_dpp v10, v56, v10 row_ror:4 row_mask:0xf bank_mask:0x2
    v_mfma_f32_16x16x32_bf16 v[112:115], v[120:123], v[24:27], 0
    v_mfma_f32_16x16x32_bf16 v[104:107], v[116:119], v[28:31], v[104:107]
    v_add_f32_dpp v13, v82, v81 row_ror:12 row_mask:0xf bank_mask:0x2
    v_add_f32_dpp v12, v75, v12 row_ror:8 row_mask:0xf bank_mask:0x2
    v_add_f32_dpp v11, v64, v11 row_ror:4 row_mask:0xf bank_mask:0x2
    v_mfma_f32_16x16x32_bf16 v[120:123], v[128:131], v[24:27], 0
    v_mfma_f32_16x16x32_bf16 v[112:115], v[124:127], v[28:31], v[112:115]
    v_add_f32_dpp v10, v91, v90 row_ror:12 row_mask:0xf bank_mask:0x4
    v_add_f32_dpp v13, v83, v13 row_ror:8 row_mask:0xf bank_mask:0x2
    v_add_f32_dpp v12, v72, v12 row_ror:4 row_mask:0xf bank_mask:0x2
    s_memrealtime s[8:9]
    s_waitcnt lgkmcnt(0)
    s_sub_u32 s8, s8, s30
    s_cmpk_ge_u32 s8, 1444
    s_nop 0
    s_cbranch_scc1 .ap_212
    s_waitcnt vmcnt(5)
    s_cmpk_ge_u32 s8, 1379
    s_cbranch_scc1 .ap_212
    s_waitcnt vmcnt(3)
    s_bitcmp1_b64 s[14:15], 37
    s_cbranch_scc0 1
    s_waitcnt vmcnt(2)
    s_cmpk_ge_u32 s8, 1304
    s_cbranch_scc1 .ap_212
    s_waitcnt vmcnt(1)
.ap_212:
    s_add_u32 s63, s69, 40960
    buffer_load_dwordx4 v[180:183], v2, s[44:47], s63 offen nt
    v_mfma_f32_16x16x32_bf16 v[128:131], v[136:139], v[24:27], 0
    v_mfma_f32_16x16x32_bf16 v[120:123], v[132:135], v[28:31], v[120:123]
    v_add_f32_dpp v11, v99, v98 row_ror:12 row_mask:0xf bank_mask:0x4
    v_add_f32_dpp v10, v88, v10 row_ror:8 row_mask:0xf bank_mask:0x4
    v_add_f32_dpp v13, v80, v13 row_ror:4 row_mask:0xf bank_mask:0x2
    v_mfma_f32_16x16x32_bf16 v[136:139], v[144:147], v[24:27], 0
    v_mfma_f32_16x16x32_bf16 v[128:131], v[140:143], v[28:31], v[128:131]
    v_add_f32_dpp v12, v107, v106 row_ror:12 row_mask:0xf bank_mask:0x4
    v_add_f32_dpp v11, v96, v11 row_ror:8 row_mask:0xf bank_mask:0x4
    v_add_f32_dpp v10, v89, v10 row_ror:4 row_mask:0xf bank_mask:0x4
    v_mfma_f32_16x16x32_bf16 v[144:147], v[152:155], v[24:27], 0
    v_mfma_f32_16x16x32_bf16 v[136:139], v[148:151], v[28:31], v[136:139]
    v_add_f32_dpp v13, v115, v114 row_ror:12 row_mask:0xf bank_mask:0x4
    v_add_f32_dpp v12, v104, v12 row_ror:8 row_mask:0xf bank_mask:0x4
    v_add_f32_dpp v11, v97, v11 row_ror:4 row_mask:0xf bank_mask:0x4
    v_mfma_f32_16x16x32_bf16 v[144:147], v[156:159], v[28:31], v[144:147]
    v_add_f32_dpp v10, v120, v123 row_ror:12 row_mask:0xf bank_mask:0x8
    v_add_f32_dpp v13, v112, v13 row_ror:8 row_mask:0xf bank_mask:0x4
    v_add_f32_dpp v12, v105, v12 row_ror:4 row_mask:0xf bank_mask:0x4
    s_memrealtime s[8:9]
    s_waitcnt lgkmcnt(0)
    s_sub_u32 s8, s8, s30
    s_cmpk_ge_u32 s8, 1471
    s_nop 0
    s_cbranch_scc1 .ap_213
    s_waitcnt vmcnt(5)
    s_cmpk_ge_u32 s8, 1406
    s_cbranch_scc1 .ap_213
    s_waitcnt vmcnt(3)
    s_bitcmp1_b64 s[14:15], 38
    s_cbranch_scc0 1
    s_waitcnt vmcnt(2)
    s_cmpk_ge_u32 s8, 1331
    s_cbranch_scc1 .ap_213
    s_waitcnt vmcnt(1)
.ap_213:
    s_add_u32 s63, s69, 49152
    buffer_load_dwordx4 v[184:187], v2, s[44:47], s63 offen nt
    v_add_f32_dpp v11, v128, v131 row_ror:12 row_mask:0xf bank_mask:0x8
    v_add_f32_dpp v10, v121, v10 row_ror:8 row_mask:0xf bank_mask:0x8
    v_add_f32_dpp v13, v113, v13 row_ror:4 row_mask:0xf bank_mask:0x4
    v_add_f32_dpp v12, v136, v139 row_ror:12 row_mask:0xf bank_mask:0x8
    v_add_f32_dpp v11, v129, v11 row_ror:8 row_mask:0xf bank_mask:0x8
    v_add_f32_dpp v10, v122, v10 row_ror:4 row_mask:0xf bank_mask:0x8
    v_add_f32_dpp v13, v144, v147 row_ror:12 row_mask:0xf bank_mask:0x8
    v_add_f32_dpp v12, v137, v12 row_ror:8 row_mask:0xf bank_mask:0x8
    v_add_f32_dpp v11, v130, v11 row_ror:4 row_mask:0xf bank_mask:0x8
    v_add_f32_dpp v13, v145, v13 row_ror:8 row_mask:0xf bank_mask:0x8
    v_add_f32_dpp v12, v138, v12 row_ror:4 row_mask:0xf bank_mask:0x8
    s_memrealtime s[8:9]
    s_waitcnt lgkmcnt(0)
    s_sub_u32 s8, s8, s30
    s_cmpk_ge_u32 s8, 1498
    s_cbranch_scc1 .ap_214
    s_waitcnt vmcnt(5)
    s_cmpk_ge_u32 s8, 1433
    s_cbranch_scc1 .ap_214
    s_waitcnt vmcnt(3)
    s_bitcmp1_b64 s[14:15], 39
    s_cbranch_scc0 1
    s_waitcnt vmcnt(2)
    s_cmpk_ge_u32 s8, 1358
    s_cbranch_scc1 .ap_214
    s_waitcnt vmcnt(1)
.ap_214:
    s_add_u32 s63, s69, 57344
    buffer_load_dwordx4 v[188:191], v2, s[44:47], s63 offen nt
    v_add_f32_dpp v13, v146, v13 row_ror:4 row_mask:0xf bank_mask:0x8
    s_mov_b32 s60, 0x3db504f3
    s_mov_b32 s61, 0x3db504f3
    v_cvt_pk_bf16_f32 v10, 0, v10
    v_cvt_pk_bf16_f32 v11, 0, v11
    v_cvt_pk_bf16_f32 v12, 0, v12
    v_cvt_pk_bf16_f32 v13, 0, v13
    v_pk_mul_f32 v[10:11], v[10:11], s[60:61]
    v_pk_mul_f32 v[12:13], v[12:13], s[60:61]
    v_cvt_pk_bf16_f32 v10, 0, v10
    v_cvt_pk_bf16_f32 v11, 0, v11
    v_cvt_pk_bf16_f32 v12, 0, v12
    v_cvt_pk_bf16_f32 v13, 0, v13
    v_max_f32 v14, v10, v11
    v_max3_f32 v14, v14, v12, v13
    s_mov_b32 s60, 0x3fb8aa3b
    v_mov_b32 v22, s34
    v_mov_b32 v23, s34
    v_max_f32_dpp v14, v14, v14 quad_perm:[2,3,0,1] row_mask:0xf bank_mask:0xf
    s_nop 1
    v_max_f32_dpp v14, v14, v14 row_ror:4 row_mask:0xf bank_mask:0xf
    s_nop 1
    v_max_f32_dpp v14, v14, v14 row_ror:8 row_mask:0xf bank_mask:0xf
    v_mov_b32 v15, v14
    s_nop 1
    v_permlane16_swap_b32 v15, v14
    v_max_f32 v14, v15, v14
    v_mov_b32 v15, v14
    s_nop 1
    v_permlane32_swap_b32 v15, v14
    v_max_f32 v14, v15, v14
    v_mul_f32 v15, 0xbfb8aa3b, v14
    v_fma_f32 v10, v10, s60, v15
    v_fma_f32 v11, v11, s60, v15
    v_fma_f32 v12, v12, s60, v15
    v_fma_f32 v13, v13, s60, v15
    v_exp_f32 v10, v10
    v_exp_f32 v11, v11
    v_exp_f32 v12, v12
    v_exp_f32 v13, v13
    v_mov_b32 v20, v14
    v_pk_add_f32 v[16:17], v[10:11], v[12:13]
    v_add_f32 v21, v16, v17
    s_lshl3_add_u32 s60, s68, s3
    s_lshl_b32 s60, s60, 5
    s_add_u32 s60, s60, s59
    v_add_f32_dpp v21, v21, v21 quad_perm:[2,3,0,1] row_mask:0xf bank_mask:0xf
    s_nop 1
    v_add_f32_dpp v21, v21, v21 row_ror:4 row_mask:0xf bank_mask:0xf
    s_nop 1
    v_add_f32_dpp v21, v21, v21 row_ror:8 row_mask:0xf bank_mask:0xf
    v_mov_b32 v15, v21
    s_nop 1
    v_permlane16_swap_b32 v15, v21
    v_add_f32 v21, v15, v21
    v_mov_b32 v15, v21
    s_nop 1
    v_permlane32_swap_b32 v15, v21
    v_add_f32 v21, v15, v21
    s_lshl_b32 s60, s3, 4
    s_add_u32 s60, s60, 159104
    v_add_u32 v16, s60, v3
    v_mov_b32 v17, 159232
    v_mov_b32 v18, 1
    s_mov_b64 exec, 3
    ds_write_b64 v16, v[20:21]
    s_mov_b64 exec, 1
    s_waitcnt lgkmcnt(0)
    ds_add_rtn_u32 v18, v17, v18
    s_mov_b64 exec, -1
    v_and_b32 v16, 0x78, v3
    v_add_u32 v16, 159104, v16
    s_waitcnt lgkmcnt(0)
    v_readfirstlane_b32 s60, v18
    s_cmp_lg_u32 s60, 7
    s_nop 3
    s_cbranch_scc1 .ml_215
    ds_read_b64 v[18:19], v16
    s_lshl_b32 s60, s68, 7
    s_add_u32 s60, s60, s59
    s_waitcnt lgkmcnt(0)
    v_mov_b32 v20, v18
    s_nop 1
    v_max_f32_dpp v20, v20, v20 quad_perm:[2,3,0,1] row_mask:0xf bank_mask:0xf
    s_nop 1
    v_max_f32_dpp v20, v20, v20 row_ror:4 row_mask:0xf bank_mask:0xf
    s_nop 1
    v_max_f32_dpp v20, v20, v20 row_ror:8 row_mask:0xf bank_mask:0xf
    v_sub_f32 v18, v18, v20
    v_mul_f32 v18, 0x3fb8aa3b, v18
    v_exp_f32 v18, v18
    s_nop 0
    v_mul_f32 v21, v18, v19
    s_nop 1
    v_add_f32_dpp v21, v21, v21 quad_perm:[2,3,0,1] row_mask:0xf bank_mask:0xf
    s_nop 1
    v_add_f32_dpp v21, v21, v21 row_ror:4 row_mask:0xf bank_mask:0xf
    s_nop 1
    v_add_f32_dpp v21, v21, v21 row_ror:8 row_mask:0xf bank_mask:0xf
    s_mov_b64 exec, 0xff
    buffer_store_dwordx4 v[20:23], v2, s[36:39], s60 offen sc1
    s_mov_b64 exec, -1
.ml_215:
    s_memrealtime s[8:9]
    s_waitcnt lgkmcnt(0)
    s_sub_u32 s8, s8, s30
    s_cmpk_ge_u32 s8, 1525
    s_cbranch_scc1 .ap_216
    s_waitcnt vmcnt(5)
    s_cmpk_ge_u32 s8, 1460
    s_cbranch_scc1 .ap_216
    s_waitcnt vmcnt(3)
    s_bitcmp1_b64 s[14:15], 40
    s_cbranch_scc0 1
    s_waitcnt vmcnt(2)
    s_cmpk_ge_u32 s8, 1385
    s_cbranch_scc1 .ap_216
    s_waitcnt vmcnt(1)
.ap_216:
    s_add_u32 s63, s69, 131072
    buffer_load_dwordx4 v[192:195], v2, s[44:47], s63 offen nt
    s_memrealtime s[8:9]
    s_waitcnt vmcnt(8)
    s_waitcnt lgkmcnt(0)
    s_sub_u32 s8, s8, s30
    s_cmpk_ge_u32 s8, 1552
    s_cbranch_scc1 .ap_217
    s_waitcnt vmcnt(5)
    s_cmpk_ge_u32 s8, 1487
    s_cbranch_scc1 .ap_217
    s_waitcnt vmcnt(3)
    s_bitcmp1_b64 s[14:15], 41
    s_cbranch_scc0 1
    s_waitcnt vmcnt(2)
    s_cmpk_ge_u32 s8, 1412
    s_cbranch_scc1 .ap_217
    s_waitcnt vmcnt(1)
.ap_217:
    s_add_u32 s63, s69, 139264
    buffer_load_dwordx4 v[196:199], v2, s[44:47], s63 offen nt
    s_memrealtime s[8:9]
    s_waitcnt vmcnt(8)
    s_waitcnt lgkmcnt(0)
    s_sub_u32 s8, s8, s30
    s_cmpk_ge_u32 s8, 1579
    s_cbranch_scc1 .ap_218
    s_waitcnt vmcnt(5)
    s_cmpk_ge_u32 s8, 1514
    s_cbranch_scc1 .ap_218
    s_waitcnt vmcnt(3)
    s_bitcmp1_b64 s[14:15], 42
    s_cbranch_scc0 1
    s_waitcnt vmcnt(2)
    s_cmpk_ge_u32 s8, 1439
    s_cbranch_scc1 .ap_218
    s_waitcnt vmcnt(1)
.ap_218:
    s_add_u32 s63, s69, 147456
    buffer_load_dwordx4 v[200:203], v2, s[44:47], s63 offen nt
    s_memrealtime s[8:9]
    s_waitcnt vmcnt(8)
    s_waitcnt lgkmcnt(0)
    s_sub_u32 s8, s8, s30
    s_cmpk_ge_u32 s8, 1606
    s_cbranch_scc1 .ap_219
    s_waitcnt vmcnt(5)
    s_cmpk_ge_u32 s8, 1541
    s_cbranch_scc1 .ap_219
    s_waitcnt vmcnt(3)
    s_bitcmp1_b64 s[14:15], 43
    s_cbranch_scc0 1
    s_waitcnt vmcnt(2)
    s_cmpk_ge_u32 s8, 1466
    s_cbranch_scc1 .ap_219
    s_waitcnt vmcnt(1)
.ap_219:
    s_add_u32 s63, s69, 155648
    buffer_load_dwordx4 v[204:207], v2, s[44:47], s63 offen nt
    s_memrealtime s[8:9]
    s_waitcnt vmcnt(8)
    s_waitcnt lgkmcnt(0)
    s_sub_u32 s8, s8, s30
    s_cmpk_ge_u32 s8, 1633
    s_cbranch_scc1 .ap_220
    s_waitcnt vmcnt(5)
    s_cmpk_ge_u32 s8, 1568
    s_cbranch_scc1 .ap_220
    s_waitcnt vmcnt(3)
    s_bitcmp1_b64 s[14:15], 44
    s_cbranch_scc0 1
    s_waitcnt vmcnt(2)
    s_cmpk_ge_u32 s8, 1493
    s_cbranch_scc1 .ap_220
    s_waitcnt vmcnt(1)
.ap_220:
    s_add_u32 s63, s69, 163840
    buffer_load_dwordx4 v[208:211], v2, s[44:47], s63 offen nt
    s_memrealtime s[8:9]
    s_waitcnt vmcnt(8)
    s_waitcnt lgkmcnt(0)
    s_sub_u32 s8, s8, s30
    s_cmpk_ge_u32 s8, 1660
    s_cbranch_scc1 .ap_221
    s_waitcnt vmcnt(5)
    s_cmpk_ge_u32 s8, 1595
    s_cbranch_scc1 .ap_221
    s_waitcnt vmcnt(3)
    s_bitcmp1_b64 s[14:15], 45
    s_cbranch_scc0 1
    s_waitcnt vmcnt(2)
    s_cmpk_ge_u32 s8, 1520
    s_cbranch_scc1 .ap_221
    s_waitcnt vmcnt(1)
.ap_221:
    s_add_u32 s63, s69, 172032
    buffer_load_dwordx4 v[212:215], v2, s[44:47], s63 offen nt
    s_memrealtime s[8:9]
    s_waitcnt vmcnt(8)
    s_waitcnt lgkmcnt(0)
    s_sub_u32 s8, s8, s30
    s_cmpk_ge_u32 s8, 1691
    s_cbranch_scc1 .ap_222
    s_waitcnt vmcnt(5)
    s_cmpk_ge_u32 s8, 1626
    s_cbranch_scc1 .ap_222
    s_waitcnt vmcnt(3)
    s_bitcmp1_b64 s[14:15], 46
    s_cbranch_scc0 1
    s_waitcnt vmcnt(2)
    s_cmpk_ge_u32 s8, 1551
    s_cbranch_scc1 .ap_222
    s_waitcnt vmcnt(1)
.ap_222:
    s_add_u32 s63, s69, 180224
    buffer_load_dwordx4 v[216:219], v2, s[44:47], s63 offen nt
    s_memrealtime s[8:9]
    s_waitcnt vmcnt(8)
    s_waitcnt lgkmcnt(0)
    s_sub_u32 s8, s8, s30
    s_cmpk_ge_u32 s8, 1722
    s_cbranch_scc1 .ap_223
    s_waitcnt vmcnt(5)
    s_cmpk_ge_u32 s8, 1657
    s_cbranch_scc1 .ap_223
    s_waitcnt vmcnt(3)
    s_bitcmp1_b64 s[14:15], 47
    s_cbranch_scc0 1
    s_waitcnt vmcnt(2)
    s_cmpk_ge_u32 s8, 1582
    s_cbranch_scc1 .ap_223
    s_waitcnt vmcnt(1)
.ap_223:
    s_add_u32 s63, s69, 188416
    buffer_load_dwordx4 v[220:223], v2, s[44:47], s63 offen nt
    s_memrealtime s[8:9]
    s_waitcnt vmcnt(8)
    s_waitcnt lgkmcnt(0)
    s_sub_u32 s8, s8, s30
    s_cmpk_ge_u32 s8, 1753
    s_cbranch_scc1 .ap_224
    s_waitcnt vmcnt(5)
    s_cmpk_ge_u32 s8, 1688
    s_cbranch_scc1 .ap_224
    s_waitcnt vmcnt(3)
    s_bitcmp1_b64 s[14:15], 48
    s_cbranch_scc0 1
    s_waitcnt vmcnt(2)
    s_cmpk_ge_u32 s8, 1613
    s_cbranch_scc1 .ap_224
    s_waitcnt vmcnt(1)
.ap_224:
    s_add_u32 s63, s69, 262144
    buffer_load_dwordx4 v[224:227], v2, s[44:47], s63 offen nt
    s_memrealtime s[8:9]
    s_waitcnt vmcnt(8)
    s_waitcnt lgkmcnt(0)
    s_sub_u32 s8, s8, s30
    s_cmpk_ge_u32 s8, 1784
    s_cbranch_scc1 .ap_225
    s_waitcnt vmcnt(5)
    s_cmpk_ge_u32 s8, 1719
    s_cbranch_scc1 .ap_225
    s_waitcnt vmcnt(3)
    s_bitcmp1_b64 s[14:15], 49
    s_cbranch_scc0 1
    s_waitcnt vmcnt(2)
    s_cmpk_ge_u32 s8, 1644
    s_cbranch_scc1 .ap_225
    s_waitcnt vmcnt(1)
.ap_225:
    s_add_u32 s63, s69, 270336
    buffer_load_dwordx4 v[228:231], v2, s[44:47], s63 offen nt
    s_memrealtime s[8:9]
    s_waitcnt vmcnt(8)
    s_waitcnt lgkmcnt(0)
    s_sub_u32 s8, s8, s30
    s_cmpk_ge_u32 s8, 1815
    s_cbranch_scc1 .ap_226
    s_waitcnt vmcnt(5)
    s_cmpk_ge_u32 s8, 1750
    s_cbranch_scc1 .ap_226
    s_waitcnt vmcnt(3)
    s_bitcmp1_b64 s[14:15], 50
    s_cbranch_scc0 1
    s_waitcnt vmcnt(2)
    s_cmpk_ge_u32 s8, 1675
    s_cbranch_scc1 .ap_226
    s_waitcnt vmcnt(1)
.ap_226:
    s_add_u32 s63, s69, 278528
    buffer_load_dwordx4 v[232:235], v2, s[44:47], s63 offen nt
    s_memrealtime s[8:9]
    s_waitcnt vmcnt(8)
    s_waitcnt lgkmcnt(0)
    s_sub_u32 s8, s8, s30
    s_cmpk_ge_u32 s8, 1846
    s_cbranch_scc1 .ap_227
    s_waitcnt vmcnt(5)
    s_cmpk_ge_u32 s8, 1781
    s_cbranch_scc1 .ap_227
    s_waitcnt vmcnt(3)
    s_bitcmp1_b64 s[14:15], 51
    s_cbranch_scc0 1
    s_waitcnt vmcnt(2)
    s_cmpk_ge_u32 s8, 1706
    s_cbranch_scc1 .ap_227
    s_waitcnt vmcnt(1)
.ap_227:
    s_add_u32 s63, s69, 286720
    buffer_load_dwordx4 v[236:239], v2, s[44:47], s63 offen nt
    s_memrealtime s[8:9]
    s_waitcnt vmcnt(8)
    s_waitcnt lgkmcnt(0)
    s_sub_u32 s8, s8, s30
    s_cmpk_ge_u32 s8, 1877
    s_cbranch_scc1 .ap_228
    s_waitcnt vmcnt(5)
    s_cmpk_ge_u32 s8, 1812
    s_cbranch_scc1 .ap_228
    s_waitcnt vmcnt(3)
    s_bitcmp1_b64 s[14:15], 52
    s_cbranch_scc0 1
    s_waitcnt vmcnt(2)
    s_cmpk_ge_u32 s8, 1737
    s_cbranch_scc1 .ap_228
    s_waitcnt vmcnt(1)
.ap_228:
    s_add_u32 s63, s69, 294912
    buffer_load_dwordx4 v[240:243], v2, s[44:47], s63 offen nt
    s_memrealtime s[8:9]
    s_waitcnt vmcnt(8)
    s_waitcnt lgkmcnt(0)
    s_sub_u32 s8, s8, s30
    s_cmpk_ge_u32 s8, 1908
    s_cbranch_scc1 .ap_229
    s_waitcnt vmcnt(5)
    s_cmpk_ge_u32 s8, 1843
    s_cbranch_scc1 .ap_229
    s_waitcnt vmcnt(3)
    s_bitcmp1_b64 s[14:15], 53
    s_cbranch_scc0 1
    s_waitcnt vmcnt(2)
    s_cmpk_ge_u32 s8, 1768
    s_cbranch_scc1 .ap_229
    s_waitcnt vmcnt(1)
.ap_229:
    s_add_u32 s63, s69, 303104
    buffer_load_dwordx4 v[244:247], v2, s[44:47], s63 offen nt
    s_load_dwordx2 s[88:89], s[6:7], s0
    buffer_load_dwordx4 v[24:27], v9, s[36:39], s59 offen offset:0 sc1
    s_memrealtime s[8:9]
    s_waitcnt vmcnt(8)
    s_waitcnt lgkmcnt(0)
    s_sub_u32 s8, s8, s30
    s_cmpk_ge_u32 s8, 1939
    s_cbranch_scc1 .ap_230
    s_waitcnt vmcnt(5)
    s_cmpk_ge_u32 s8, 1874
    s_cbranch_scc1 .ap_230
    s_waitcnt vmcnt(3)
    s_bitcmp1_b64 s[14:15], 54
    s_cbranch_scc0 1
    s_waitcnt vmcnt(2)
    s_cmpk_ge_u32 s8, 1799
    s_cbranch_scc1 .ap_230
    s_waitcnt vmcnt(1)
.ap_230:
    s_add_u32 s63, s69, 311296
    buffer_load_dwordx4 v[248:251], v2, s[44:47], s63 offen nt
    s_sub_u32 s56, s65, 27
    s_lshl3_add_u32 s56, s56, s3
    s_cmp_ge_u32 s56, 11
    s_cbranch_scc1 .cpf_231
    s_getpc_b64 s[8:9]
.Lcpf_pc:
    s_cmp_ge_u32 s56, 6
    s_mov_b32 s57, .Lcpf_pc-.Ltail_ar
    s_cselect_b32 s57, .Lcpf_pc-.Ltail_bc+6144, s57
    s_lshl_b32 s56, s56, 10
    s_sub_u32 s56, s57, s56
    s_sub_u32 s8, s8, s56
    s_subb_u32 s9, s9, 0
    v_mov_b32 v41, s9
    v_add_co_u32 v40, vcc, s8, v2
    s_nop 1
    v_addc_co_u32 v41, vcc, 0, v41, vcc
    global_load_dwordx4 v[32:35], v[40:41], off
.cpf_231:
    s_memrealtime s[8:9]
    s_waitcnt vmcnt(8)
    s_waitcnt lgkmcnt(0)
    s_sub_u32 s8, s8, s30
    s_cmpk_ge_u32 s8, 1970
    s_cbranch_scc1 .ap_232
    s_waitcnt vmcnt(5)
    s_cmpk_ge_u32 s8, 1905
    s_cbranch_scc1 .ap_232
    s_waitcnt vmcnt(3)
    s_bitcmp1_b64 s[14:15], 55
    s_cbranch_scc0 1
    s_waitcnt vmcnt(2)
    s_cmpk_ge_u32 s8, 1830
    s_cbranch_scc1 .ap_232
    s_waitcnt vmcnt(1)
.ap_232:
    s_add_u32 s63, s69, 319488
    buffer_load_dwordx4 v[252:255], v2, s[44:47], s63 offen nt
    s_memrealtime s[8:9]
    s_waitcnt vmcnt(8)
    s_waitcnt lgkmcnt(0)
    s_sub_u32 s8, s8, s30
    s_cmpk_ge_u32 s8, 2001
    s_cbranch_scc1 .ap_233
    s_waitcnt vmcnt(5)
    s_cmpk_ge_u32 s8, 1936
    s_cbranch_scc1 .ap_233
    s_waitcnt vmcnt(3)
    s_bitcmp1_b64 s[14:15], 56
    s_cbranch_scc0 1
    s_waitcnt vmcnt(2)
    s_cmpk_ge_u32 s8, 1861
    s_cbranch_scc1 .ap_233
    s_waitcnt vmcnt(1)
.ap_233:
    s_add_u32 s63, s69, 393216
    buffer_load_dwordx4 v[36:39], v2, s[44:47], s63 offen nt
    s_memrealtime s[8:9]
    s_waitcnt vmcnt(8)
    s_waitcnt lgkmcnt(0)
    s_sub_u32 s8, s8, s30
    s_cmpk_ge_u32 s8, 2032
    s_cbranch_scc1 .ap_234
    s_waitcnt vmcnt(5)
    s_cmpk_ge_u32 s8, 1967
    s_cbranch_scc1 .ap_234
    s_waitcnt vmcnt(3)
    s_bitcmp1_b64 s[14:15], 57
    s_cbranch_scc0 1
    s_waitcnt vmcnt(2)
    s_cmpk_ge_u32 s8, 1892
    s_cbranch_scc1 .ap_234
    s_waitcnt vmcnt(1)
.ap_234:
    s_add_u32 s63, s69, 401408
    buffer_load_dwordx4 v[44:47], v2, s[44:47], s63 offen nt
    s_memrealtime s[8:9]
    s_waitcnt vmcnt(8)
    s_waitcnt lgkmcnt(0)
    s_sub_u32 s8, s8, s30
    s_cmpk_ge_u32 s8, 2063
    s_cbranch_scc1 .ap_235
    s_waitcnt vmcnt(5)
    s_cmpk_ge_u32 s8, 1998
    s_cbranch_scc1 .ap_235
    s_waitcnt vmcnt(3)
    s_bitcmp1_b64 s[14:15], 58
    s_cbranch_scc0 1
    s_waitcnt vmcnt(2)
    s_cmpk_ge_u32 s8, 1923
    s_cbranch_scc1 .ap_235
    s_waitcnt vmcnt(1)
.ap_235:
    s_add_u32 s63, s69, 409600
    buffer_load_dwordx4 v[52:55], v2, s[44:47], s63 offen nt
    s_waitcnt vmcnt(5)
    s_branch .gpc_237
.gp_236:
    buffer_load_dwordx4 v[24:27], v9, s[36:39], s59 offen offset:0 sc1
    s_waitcnt vmcnt(0)
.gpc_237:
    v_cmp_eq_u32 vcc, s34, v26
    v_cmp_eq_u32 s[56:57], s34, v27
    s_and_b64 vcc, vcc, s[56:57]
    s_cmp_eq_u64 vcc, exec
    s_nop 2
    s_cbranch_scc1 .gpd_238
    s_sub_u32 s35, s35, 1
    s_cbranch_scc1 .Lexit
    s_sleep 1
    s_branch .gp_236
.gpd_238:
    s_lshr_b64 s[88:89], s[88:89], s1
    s_and_b32 s88, s88, 0xff
    s_cmp_eq_u32 s88, 32
    s_cselect_b32 s0, 0xac000, 0
    v_mov_b32 v16, v24
    s_nop 1
    v_max_f32_dpp v16, v16, v16 quad_perm:[2,3,0,1] row_mask:0xf bank_mask:0xf
    v_sub_f32 v17, v24, v16
    v_sub_f32 v18, v14, v16
    v_mul_f32 v17, 0x3fb8aa3b, v17
    v_mul_f32 v18, 0x3fb8aa3b, v18
    v_exp_f32 v17, v17
    v_exp_f32 v18, v18
    v_mul_f32 v17, v17, v25
    s_nop 1
    v_add_f32_dpp v17, v17, v17 quad_perm:[2,3,0,1] row_mask:0xf bank_mask:0xf
    v_rcp_f32 v19, v17
    s_nop 0
    v_fma_f32 v15, -v17, v19, 1.0
    v_fma_f32 v19, v15, v19, v19
    v_mul_f32 v18, v18, v19
    v_mul_f32 v10, v10, v18
    v_mul_f32 v11, v11, v18
    v_mul_f32 v12, v12, v18
    v_mul_f32 v13, v13, v18
    v_mov_b32_dpp v112, v10 quad_perm:[2,3,0,1] row_mask:0xf bank_mask:0xf
    v_mov_b32_dpp v113, v11 quad_perm:[2,3,0,1] row_mask:0xf bank_mask:0xf
    v_mov_b32_dpp v114, v12 quad_perm:[2,3,0,1] row_mask:0xf bank_mask:0xf
    v_mov_b32_dpp v115, v13 quad_perm:[2,3,0,1] row_mask:0xf bank_mask:0xf
    v_cvt_pk_bf16_f32 v96, v10, v112
    v_cvt_pk_bf16_f32 v100, v11, v113
    v_cvt_pk_bf16_f32 v104, v12, v114
    v_cvt_pk_bf16_f32 v108, v13, v115
    v_mov_b32_dpp v97, v96 row_ror:12 row_mask:0xf bank_mask:0xf
    v_mov_b32_dpp v101, v100 row_ror:12 row_mask:0xf bank_mask:0xf
    v_mov_b32_dpp v105, v104 row_ror:12 row_mask:0xf bank_mask:0xf
    v_mov_b32_dpp v109, v108 row_ror:12 row_mask:0xf bank_mask:0xf
    v_mov_b32_dpp v98, v96 row_ror:8 row_mask:0xf bank_mask:0xf
    v_mov_b32_dpp v102, v100 row_ror:8 row_mask:0xf bank_mask:0xf
    v_mov_b32_dpp v106, v104 row_ror:8 row_mask:0xf bank_mask:0xf
    v_mov_b32_dpp v110, v108 row_ror:8 row_mask:0xf bank_mask:0xf
    v_mov_b32_dpp v99, v96 row_ror:4 row_mask:0xf bank_mask:0xf
    v_mov_b32_dpp v103, v100 row_ror:4 row_mask:0xf bank_mask:0xf
    v_mov_b32_dpp v107, v104 row_ror:4 row_mask:0xf bank_mask:0xf
    v_mov_b32_dpp v111, v108 row_ror:4 row_mask:0xf bank_mask:0xf
    v_mov_b32_dpp v96, v96 row_shr:3 row_mask:0xf bank_mask:0x2
    v_mov_b32_dpp v97, v97 row_shr:3 row_mask:0xf bank_mask:0x2
    v_mov_b32_dpp v98, v98 row_shr:3 row_mask:0xf bank_mask:0x2
    v_mov_b32_dpp v99, v99 row_shr:3 row_mask:0xf bank_mask:0x2
    v_mov_b32_dpp v100, v100 row_shr:3 row_mask:0xf bank_mask:0x2
    v_mov_b32_dpp v101, v101 row_shr:3 row_mask:0xf bank_mask:0x2
    v_mov_b32_dpp v102, v102 row_shr:3 row_mask:0xf bank_mask:0x2
    v_mov_b32_dpp v103, v103 row_shr:3 row_mask:0xf bank_mask:0x2
    v_mov_b32_dpp v104, v104 row_shr:3 row_mask:0xf bank_mask:0x2
    v_mov_b32_dpp v105, v105 row_shr:3 row_mask:0xf bank_mask:0x2
    v_mov_b32_dpp v106, v106 row_shr:3 row_mask:0xf bank_mask:0x2
    v_mov_b32_dpp v107, v107 row_shr:3 row_mask:0xf bank_mask:0x2
    v_mov_b32_dpp v108, v108 row_shr:3 row_mask:0xf bank_mask:0x2
    v_mov_b32_dpp v109, v109 row_shr:3 row_mask:0xf bank_mask:0x2
    v_mov_b32_dpp v110, v110 row_shr:3 row_mask:0xf bank_mask:0x2
    v_mov_b32_dpp v111, v111 row_shr:3 row_mask:0xf bank_mask:0x2
    s_memrealtime s[8:9]
    s_waitcnt lgkmcnt(0)
    s_sub_u32 s8, s8, s30
    s_cmpk_ge_u32 s8, 2094
    s_cbranch_scc1 .ap_239
    s_waitcnt vmcnt(5)
    s_cmpk_ge_u32 s8, 2029
    s_cbranch_scc1 .ap_239
    s_waitcnt vmcnt(3)
    s_bitcmp1_b64 s[14:15], 59
    s_cbranch_scc0 1
    s_waitcnt vmcnt(2)
    s_cmpk_ge_u32 s8, 1954
    s_cbranch_scc1 .ap_239
    s_waitcnt vmcnt(1)
.ap_239:
    s_add_u32 s63, s69, 417792
    buffer_load_dwordx4 v[60:63], v2, s[44:47], s63 offen nt
    s_lshl_b32 s60, s3, 10
    s_add_u32 s60, s60, 132096
    v_lshlrev_b32 v10, 5, v0
    v_add_u32 v10, s60, v10
    v_lshrrev_b32 v11, 5, v0
    v_lshlrev_b32 v11, 13, v11
    v_and_b32 v12, 31, v0
    v_lshl_add_u32 v11, v12, 4, v11
    v_add_u32 v9, 132096, v2
    v_mov_b32 v15, s34
    s_memrealtime s[8:9]
    s_waitcnt lgkmcnt(0)
    s_sub_u32 s8, s8, s30
    s_cmpk_ge_u32 s8, 2125
    s_cbranch_scc1 .ap_240
    s_waitcnt vmcnt(5)
    s_cmpk_ge_u32 s8, 2060
    s_cbranch_scc1 .ap_240
    s_waitcnt vmcnt(3)
    s_bitcmp1_b64 s[14:15], 60
    s_cbranch_scc0 1
    s_waitcnt vmcnt(2)
    s_cmpk_ge_u32 s8, 1985
    s_cbranch_scc1 .ap_240
    s_waitcnt vmcnt(1)
.ap_240:
    s_add_u32 s63, s69, 425984
    buffer_load_dwordx4 v[68:71], v2, s[44:47], s63 offen nt
    v_perm_b32 v112, v164, v160, s94
    v_perm_b32 v113, v172, v168, s94
    v_perm_b32 v114, v180, v176, s94
    v_perm_b32 v115, v188, v184, s94
    s_nop 1
    v_mfma_f32_16x16x32_bf16 v[128:131], v[96:99], v[112:115], 0
    v_perm_b32 v116, v164, v160, s95
    v_perm_b32 v117, v172, v168, s95
    v_perm_b32 v118, v180, v176, s95
    v_perm_b32 v119, v188, v184, s95
    s_nop 1
    v_mfma_f32_16x16x32_bf16 v[132:135], v[96:99], v[116:119], 0
    v_perm_b32 v120, v165, v161, s94
    v_perm_b32 v121, v173, v169, s94
    v_perm_b32 v122, v181, v177, s94
    v_perm_b32 v123, v189, v185, s94
    s_nop 1
    v_mfma_f32_16x16x32_bf16 v[136:139], v[96:99], v[120:123], 0
    v_perm_b32 v124, v165, v161, s95
    v_perm_b32 v125, v173, v169, s95
    v_perm_b32 v126, v181, v177, s95
    v_perm_b32 v127, v189, v185, s95
    s_nop 1
    v_mfma_f32_16x16x32_bf16 v[140:143], v[96:99], v[124:127], 0
    v_perm_b32 v112, v166, v162, s94
    v_perm_b32 v113, v174, v170, s94
    v_perm_b32 v114, v182, v178, s94
    v_perm_b32 v115, v190, v186, s94
    s_nop 1
    v_mfma_f32_16x16x32_bf16 v[144:147], v[96:99], v[112:115], 0
    v_perm_b32 v116, v166, v162, s95
    v_perm_b32 v117, v174, v170, s95
    v_perm_b32 v118, v182, v178, s95
    v_perm_b32 v119, v190, v186, s95
    s_nop 1
    v_mfma_f32_16x16x32_bf16 v[148:151], v[96:99], v[116:119], 0
    v_perm_b32 v120, v167, v163, s94
    v_perm_b32 v121, v175, v171, s94
    v_perm_b32 v122, v183, v179, s94
    v_perm_b32 v123, v191, v187, s94
    s_nop 1
    v_mfma_f32_16x16x32_bf16 v[152:155], v[96:99], v[120:123], 0
    v_perm_b32 v124, v167, v163, s95
    v_perm_b32 v125, v175, v171, s95
    v_perm_b32 v126, v183, v179, s95
    v_perm_b32 v127, v191, v187, s95
    s_nop 1
    v_mfma_f32_16x16x32_bf16 v[156:159], v[96:99], v[124:127], 0
    s_memrealtime s[8:9]
    s_waitcnt lgkmcnt(0)
    s_sub_u32 s8, s8, s30
    s_cmpk_ge_u32 s8, 2156
    s_nop 3
    s_cbranch_scc1 .ap_241
    s_waitcnt vmcnt(5)
    s_cmpk_ge_u32 s8, 2091
    s_cbranch_scc1 .ap_241
    s_waitcnt vmcnt(3)
    s_bitcmp1_b64 s[14:15], 61
    s_cbranch_scc0 1
    s_waitcnt vmcnt(2)
    s_cmpk_ge_u32 s8, 2016
    s_cbranch_scc1 .ap_241
    s_waitcnt vmcnt(1)
.ap_241:
    s_add_u32 s63, s69, 434176
    buffer_load_dwordx4 v[76:79], v2, s[44:47], s63 offen nt
    v_perm_b32 v112, v196, v192, s94
    v_perm_b32 v113, v204, v200, s94
    v_perm_b32 v114, v212, v208, s94
    v_perm_b32 v115, v220, v216, s94
    s_nop 1
    v_mfma_f32_16x16x32_bf16 v[128:131], v[100:103], v[112:115], v[128:131]
    v_perm_b32 v116, v196, v192, s95
    v_perm_b32 v117, v204, v200, s95
    v_perm_b32 v118, v212, v208, s95
    v_perm_b32 v119, v220, v216, s95
    s_nop 1
    v_mfma_f32_16x16x32_bf16 v[132:135], v[100:103], v[116:119], v[132:135]
    v_perm_b32 v120, v197, v193, s94
    v_perm_b32 v121, v205, v201, s94
    v_perm_b32 v122, v213, v209, s94
    v_perm_b32 v123, v221, v217, s94
    s_nop 1
    v_mfma_f32_16x16x32_bf16 v[136:139], v[100:103], v[120:123], v[136:139]
    v_perm_b32 v124, v197, v193, s95
    v_perm_b32 v125, v205, v201, s95
    v_perm_b32 v126, v213, v209, s95
    v_perm_b32 v127, v221, v217, s95
    s_nop 1
    v_mfma_f32_16x16x32_bf16 v[140:143], v[100:103], v[124:127], v[140:143]
    v_perm_b32 v112, v198, v194, s94
    v_perm_b32 v113, v206, v202, s94
    v_perm_b32 v114, v214, v210, s94
    v_perm_b32 v115, v222, v218, s94
    s_nop 1
    v_mfma_f32_16x16x32_bf16 v[144:147], v[100:103], v[112:115], v[144:147]
    v_perm_b32 v116, v198, v194, s95
    v_perm_b32 v117, v206, v202, s95
    v_perm_b32 v118, v214, v210, s95
    v_perm_b32 v119, v222, v218, s95
    s_nop 1
    v_mfma_f32_16x16x32_bf16 v[148:151], v[100:103], v[116:119], v[148:151]
    v_perm_b32 v120, v199, v195, s94
    v_perm_b32 v121, v207, v203, s94
    v_perm_b32 v122, v215, v211, s94
    v_perm_b32 v123, v223, v219, s94
    s_nop 1
    v_mfma_f32_16x16x32_bf16 v[152:155], v[100:103], v[120:123], v[152:155]
    v_perm_b32 v124, v199, v195, s95
    v_perm_b32 v125, v207, v203, s95
    v_perm_b32 v126, v215, v211, s95
    v_perm_b32 v127, v223, v219, s95
    s_nop 1
    v_mfma_f32_16x16x32_bf16 v[156:159], v[100:103], v[124:127], v[156:159]
    s_memrealtime s[8:9]
    s_waitcnt lgkmcnt(0)
    s_sub_u32 s8, s8, s30
    s_cmpk_ge_u32 s8, 2187
    s_nop 3
    s_cbranch_scc1 .ap_242
    s_waitcnt vmcnt(5)
    s_cmpk_ge_u32 s8, 2122
    s_cbranch_scc1 .ap_242
    s_waitcnt vmcnt(3)
    s_bitcmp1_b64 s[14:15], 62
    s_cbranch_scc0 1
    s_waitcnt vmcnt(2)
    s_cmpk_ge_u32 s8, 2047
    s_cbranch_scc1 .ap_242
    s_waitcnt vmcnt(1)
.ap_242:
    s_add_u32 s63, s69, 442368
    buffer_load_dwordx4 v[84:87], v2, s[44:47], s63 offen nt
    s_waitcnt vmcnt(7)
    v_perm_b32 v112, v228, v224, s94
    v_perm_b32 v113, v236, v232, s94
    v_perm_b32 v114, v244, v240, s94
    v_perm_b32 v115, v252, v248, s94
    s_nop 1
    v_mfma_f32_16x16x32_bf16 v[128:131], v[104:107], v[112:115], v[128:131]
    v_perm_b32 v116, v228, v224, s95
    v_perm_b32 v117, v236, v232, s95
    v_perm_b32 v118, v244, v240, s95
    v_perm_b32 v119, v252, v248, s95
    s_nop 1
    v_mfma_f32_16x16x32_bf16 v[132:135], v[104:107], v[116:119], v[132:135]
    v_perm_b32 v120, v229, v225, s94
    v_perm_b32 v121, v237, v233, s94
    v_perm_b32 v122, v245, v241, s94
    v_perm_b32 v123, v253, v249, s94
    s_nop 1
    v_mfma_f32_16x16x32_bf16 v[136:139], v[104:107], v[120:123], v[136:139]
    v_perm_b32 v124, v229, v225, s95
    v_perm_b32 v125, v237, v233, s95
    v_perm_b32 v126, v245, v241, s95
    v_perm_b32 v127, v253, v249, s95
    s_nop 1
    v_mfma_f32_16x16x32_bf16 v[140:143], v[104:107], v[124:127], v[140:143]
    v_perm_b32 v112, v230, v226, s94
    v_perm_b32 v113, v238, v234, s94
    v_perm_b32 v114, v246, v242, s94
    v_perm_b32 v115, v254, v250, s94
    s_nop 1
    v_mfma_f32_16x16x32_bf16 v[144:147], v[104:107], v[112:115], v[144:147]
    v_perm_b32 v116, v230, v226, s95
    v_perm_b32 v117, v238, v234, s95
    v_perm_b32 v118, v246, v242, s95
    v_perm_b32 v119, v254, v250, s95
    s_nop 1
    v_mfma_f32_16x16x32_bf16 v[148:151], v[104:107], v[116:119], v[148:151]
    v_perm_b32 v120, v231, v227, s94
    v_perm_b32 v121, v239, v235, s94
    v_perm_b32 v122, v247, v243, s94
    v_perm_b32 v123, v255, v251, s94
    s_nop 1
    v_mfma_f32_16x16x32_bf16 v[152:155], v[104:107], v[120:123], v[152:155]
    v_perm_b32 v124, v231, v227, s95
    v_perm_b32 v125, v239, v235, s95
    v_perm_b32 v126, v247, v243, s95
    v_perm_b32 v127, v255, v251, s95
    s_nop 1
    v_mfma_f32_16x16x32_bf16 v[156:159], v[104:107], v[124:127], v[156:159]
    s_memrealtime s[8:9]
    s_waitcnt lgkmcnt(0)
    s_sub_u32 s8, s8, s30
    s_cmpk_ge_u32 s8, 2218
    s_nop 3
    s_cbranch_scc1 .ap_243
    s_waitcnt vmcnt(5)
    s_cmpk_ge_u32 s8, 2153
    s_cbranch_scc1 .ap_243
    s_waitcnt vmcnt(3)
    s_bitcmp1_b64 s[14:15], 63
    s_cbranch_scc0 1
    s_waitcnt vmcnt(2)
    s_cmpk_ge_u32 s8, 2078
    s_cbranch_scc1 .ap_243
    s_waitcnt vmcnt(1)
.ap_243:
    s_add_u32 s63, s69, 450560
    buffer_load_dwordx4 v[92:95], v2, s[44:47], s63 offen nt
    s_setprio 0
    s_waitcnt vmcnt(6)
    v_perm_b32 v160, v44, v36, s94
    v_perm_b32 v164, v44, v36, s95
    v_perm_b32 v168, v45, v37, s94
    v_perm_b32 v172, v45, v37, s95
    v_perm_b32 v176, v46, v38, s94
    v_perm_b32 v180, v46, v38, s95
    v_perm_b32 v184, v47, v39, s94
    v_perm_b32 v188, v47, v39, s95
    s_waitcnt vmcnt(4)
    v_perm_b32 v161, v60, v52, s94
    v_perm_b32 v165, v60, v52, s95
    v_perm_b32 v169, v61, v53, s94
    v_perm_b32 v173, v61, v53, s95
    v_perm_b32 v177, v62, v54, s94
    v_perm_b32 v181, v62, v54, s95
    v_perm_b32 v185, v63, v55, s94
    v_perm_b32 v189, v63, v55, s95
    v_mfma_f32_16x16x16_bf16 v[128:131], v[108:109], v[160:161], v[128:131]
    v_mfma_f32_16x16x16_bf16 v[132:135], v[108:109], v[164:165], v[132:135]
    v_mfma_f32_16x16x16_bf16 v[136:139], v[108:109], v[168:169], v[136:139]
    v_mfma_f32_16x16x16_bf16 v[140:143], v[108:109], v[172:173], v[140:143]
    v_mfma_f32_16x16x16_bf16 v[144:147], v[108:109], v[176:177], v[144:147]
    v_mfma_f32_16x16x16_bf16 v[148:151], v[108:109], v[180:181], v[148:151]
    v_mfma_f32_16x16x16_bf16 v[152:155], v[108:109], v[184:185], v[152:155]
    v_mfma_f32_16x16x16_bf16 v[156:159], v[108:109], v[188:189], v[156:159]
    s_waitcnt vmcnt(2)
    v_perm_b32 v162, v76, v68, s94
    v_perm_b32 v166, v76, v68, s95
    v_perm_b32 v170, v77, v69, s94
    v_perm_b32 v174, v77, v69, s95
    v_perm_b32 v178, v78, v70, s94
    v_perm_b32 v182, v78, v70, s95
    v_perm_b32 v186, v79, v71, s94
    v_perm_b32 v190, v79, v71, s95
    s_lshl4_add_u32 s59, s67, s66
    s_lshl1_add_u32 s59, s59, s68
    s_lshl_b32 s59, s59, 9
    s_add_u32 s59, s59, 0x210000
    s_mov_b32 s60, 0x07060503
    s_mov_b32 s61, 0x07060502
    s_mov_b32 s62, 0x07060501
.Ltail_n:
    s_waitcnt vmcnt(0)
    v_perm_b32 v163, v92, v84, s94
    v_perm_b32 v167, v92, v84, s95
    v_perm_b32 v171, v93, v85, s94
    v_perm_b32 v175, v93, v85, s95
    v_perm_b32 v179, v94, v86, s94
    v_perm_b32 v183, v94, v86, s95
    v_perm_b32 v187, v95, v87, s94
    v_perm_b32 v191, v95, v87, s95
    v_mfma_f32_16x16x16_bf16 v[128:131], v[110:111], v[162:163], v[128:131]
    v_mfma_f32_16x16x16_bf16 v[132:135], v[110:111], v[166:167], v[132:135]
    v_mfma_f32_16x16x16_bf16 v[136:139], v[110:111], v[170:171], v[136:139]
    v_mfma_f32_16x16x16_bf16 v[140:143], v[110:111], v[174:175], v[140:143]
    v_mfma_f32_16x16x16_bf16 v[144:147], v[110:111], v[178:179], v[144:147]
    v_mfma_f32_16x16x16_bf16 v[148:151], v[110:111], v[182:183], v[148:151]
    v_mfma_f32_16x16x16_bf16 v[152:155], v[110:111], v[186:187], v[152:155]
    v_mfma_f32_16x16x16_bf16 v[156:159], v[110:111], v[190:191], v[156:159]
    s_nop 1
    s_mov_b64 exec, 0xffffffff
    ds_write2_b32 v10, v128, v132 offset0:0 offset1:1
    ds_write2_b32 v10, v136, v140 offset0:2 offset1:3
    s_nop 0
    ds_write2_b32 v10, v144, v148 offset0:4 offset1:5
    s_nop 0
    ds_write2_b32 v10, v152, v156 offset0:6 offset1:7
    s_mov_b64 exec, -1
    s_waitcnt lgkmcnt(0)
    s_barrier
    s_cmp_lg_u32 s3, 7
    s_cbranch_scc1 .opub_244
    ds_read_b128 v[196:199], v9 offset:0
    ds_read_b128 v[200:203], v9 offset:1024
    ds_read_b128 v[204:207], v9 offset:2048
    ds_read_b128 v[208:211], v9 offset:3072
    ds_read_b128 v[212:215], v9 offset:4096
    ds_read_b128 v[216:219], v9 offset:5120
    ds_read_b128 v[220:223], v9 offset:6144
    ds_read_b128 v[224:227], v9 offset:7168
    s_waitcnt lgkmcnt(6)
    v_pk_add_f32 v[196:197], v[196:197], v[200:201]
    v_pk_add_f32 v[198:199], v[198:199], v[202:203]
    s_waitcnt lgkmcnt(4)
    v_pk_add_f32 v[204:205], v[204:205], v[208:209]
    v_pk_add_f32 v[206:207], v[206:207], v[210:211]
    v_pk_add_f32 v[196:197], v[196:197], v[204:205]
    v_pk_add_f32 v[198:199], v[198:199], v[206:207]
    s_waitcnt lgkmcnt(2)
    v_pk_add_f32 v[212:213], v[212:213], v[216:217]
    v_pk_add_f32 v[214:215], v[214:215], v[218:219]
    s_waitcnt lgkmcnt(0)
    v_pk_add_f32 v[220:221], v[220:221], v[224:225]
    v_pk_add_f32 v[222:223], v[222:223], v[226:227]
    v_pk_add_f32 v[212:213], v[212:213], v[220:221]
    v_pk_add_f32 v[214:215], v[214:215], v[222:223]
    v_pk_add_f32 v[196:197], v[196:197], v[212:213]
    v_pk_add_f32 v[198:199], v[198:199], v[214:215]
    v_perm_b32 v12, v196, v199, s60
    v_perm_b32 v13, v197, v199, s61
    v_perm_b32 v14, v198, v199, s62
    s_add_u32 s57, s59, 0xac000
    buffer_store_dwordx4 v[12:15], v11, s[36:39], s57 offen
    buffer_store_dwordx4 v[12:15], v11, s[36:39], s59 offen sc1
.opub_244:
.Lexit:
.Lend:
s_endpgm
.section .rodata,"a"
.p2align 6
.amdhsa_kernel adaLN_cond__sliding_block_cached__moe_arch_mod__decode_kernel
  .amdhsa_next_free_vgpr 256
  .amdhsa_next_free_sgpr 102
  .amdhsa_accum_offset 256
  .amdhsa_group_segment_fixed_size 0
  .amdhsa_kernarg_size 120
  .amdhsa_user_sgpr_count 2
  .amdhsa_user_sgpr_kernarg_segment_ptr 1
  .amdhsa_system_sgpr_workgroup_id_x 1
.end_amdhsa_kernel
```
